```python
import torch

def _softmax(x, axis=-1):
    return torch.softmax(x, dim=axis)
def _gelu(x):
    return torch.nn.functional.gelu(x, approximate="tanh")
def _silu(x):
    return torch.nn.functional.silu(x)
def _sigmoid(x):
    return torch.sigmoid(x)
def _layernorm(x, axis=-1, eps=1e-5):
    m = x.mean(dim=axis, keepdim=True)
    v = x.var(dim=axis, keepdim=True, unbiased=False)
    return (x - m) / torch.sqrt(v + eps)
def _scatter_add(tgt, idx, src, axis=0):
    return tgt.clone().index_add_(axis, idx, src)
def _segment_sum(src, seg, n):
    out = torch.zeros((n,) + src.shape[1:], dtype=src.dtype)
    return out.index_add_(0, seg, src)
def _pad(x, pw):
    flat = tuple(v for pair in reversed(pw) for v in pair)
    return torch.nn.functional.pad(x, flat)

kernel_name = 'recurrent_scan__gqa_block_cached__dense_activation_gelu__prompt'

def setup_inputs():

    _w = (lambda a: (lambda t: t.to(torch.bfloat16) if t.is_floating_point() else t)(torch.as_tensor(a)))
    def _A_setup():
        B, Sq, D = 1, 2048, 640
        Hq, Hkv, Sk, Dh = 32, 32, 2048, 192
        assert Hq % Hkv == 0, (Hq, Hkv)
        return {
            "x": _w((lambda *s: torch.randn(*s, dtype=torch.bfloat16) * 0.05)(B, Sq, D)),
            "k_cache": _w((lambda *s: torch.randn(*s, dtype=torch.bfloat16) * 3.2)(B, Hkv, Sk, Dh)),
            "v_cache": _w((lambda *s: torch.randn(*s, dtype=torch.bfloat16) * 3.2)(B, Hkv, Sk, Dh)),
            "wq": _w((lambda *s: torch.randn(*s, dtype=torch.bfloat16) * 3.2)(D, Hq * Dh) * (D ** -0.5)),
            "wo": _w((lambda *s: torch.randn(*s, dtype=torch.bfloat16) * 3.2)(Hq * Dh, D) * ((Hq * Dh) ** -0.5)),
        }
    _A_in = _A_setup()

    def _B_setup():
        B, S, D, F = 1, 2048, 640, 1536
        return {
            "x": _w((lambda *s: torch.randn(*s, dtype=torch.bfloat16) * 0.05)(B, S, D)),
            "w1": _w((lambda *s: torch.randn(*s, dtype=torch.bfloat16) * 3.2)(D, F) * (D ** -0.5)),
            "b1": _w((lambda *s: torch.randn(*s, dtype=torch.bfloat16) * 3.2)(F) * 0.01),
            "w2": _w((lambda *s: torch.randn(*s, dtype=torch.bfloat16) * 0.4)(F, D) * (F ** -0.5)),
            "b2": _w((lambda *s: torch.randn(*s, dtype=torch.bfloat16) * 0.4)(D) * 0.01),
        }
    _B_in = _B_setup()

    return {
        "A_x": _A_in["x"],
        "A_k_cache": _A_in["k_cache"],
        "A_v_cache": _A_in["v_cache"],
        "A_wq": _A_in["wq"],
        "A_wo": _A_in["wo"],
        "B_x": _B_in["x"],
        "B_w1": _B_in["w1"],
        "B_b1": _B_in["b1"],
        "B_w2": _B_in["w2"],
        "B_b2": _B_in["b2"],
    }

def reference(A_x, A_k_cache, A_v_cache, A_wq, A_wo, B_x, B_w1, B_b1, B_w2, B_b2):
    def _A_ref(x, k_cache, v_cache, wq, wo):
        B, Sq, D = x.shape
        Hq, Dh = 32, 192
        Hkv = k_cache.shape[1]
        rep = Hq // Hkv
        q = (lambda x, *d: x.permute(*d))((x @ wq).reshape(B, Sq, Hq, Dh), 0, 2, 1, 3)
        k = (lambda x, n, axis: torch.repeat_interleave(x, n, dim=axis))(k_cache, rep, axis=1)
        v = (lambda x, n, axis: torch.repeat_interleave(x, n, dim=axis))(v_cache, rep, axis=1)
        scores = torch.einsum("bhqd,bhkd->bhqk", q, k) * (Dh ** -0.5)
        p = _softmax(scores, axis=-1)
        o = torch.einsum("bhqk,bhkd->bhqd", p, v)
        return (lambda x, *d: x.permute(*d))(o, 0, 2, 1, 3).reshape(B, Sq, Hq * Dh) @ wo

    def _B_ref(x, w1, b1, w2, b2):
        h = torch.einsum("bsd,df->bsf", x, w1) + b1
        h = _gelu(h)
        return torch.einsum("bsf,fd->bsd", h, w2) + b2

    x = A_x
    xn = _layernorm(x, axis=-1)
    s = _A_ref(xn, A_k_cache, A_v_cache, A_wq, A_wo)
    g = _silu(_B_ref(xn, B_w1, B_b1, B_w2, B_b2))
    return x + s * g
```

```asm
; @launch grid=(256,1,1) block=(256,1,1) lds=163840
.amdgcn_target "amdgcn-amd-amdhsa--gfx950"
.text
.globl recurrent_scan__gqa_block_cached__dense_activation_gelu__prompt_kernel
.p2align 8
.type recurrent_scan__gqa_block_cached__dense_activation_gelu__prompt_kernel,@function
recurrent_scan__gqa_block_cached__dense_activation_gelu__prompt_kernel:
s_cmp_ge_u32 s2, 256
s_cbranch_scc1 L_done
s_load_dwordx16 s[76:91], s[0:1], 0
s_load_dwordx8 s[92:99], s[0:1], 64
s_load_dwordx2 s[100:101], s[0:1], 96
s_memrealtime s[70:71]
s_getpc_b64 s[64:65]
L_pc:
s_mov_b32 s67, 32768
s_bitcmp1_b32 s2, 0
s_cselect_b32 s66, L_fo-L_pc-4096, s67
s_bitcmp1_b32 s2, 3
s_cselect_b32 s66, s66, 0
v_lshlrev_b32 v98, 7, v0
v_add_u32 v98, s66, v98
global_load_dword v99, v98, s[64:65]
v_lshrrev_b32 v14, 6, v0
v_and_b32 v0, 63, v0
v_readfirstlane_b32 s52, v14
s_and_b32 s64, s2, 7
s_lshr_b32 s65, s2, 3
s_and_b32 s66, s65, 3
s_lshl_b32 s64, s64, 2
s_add_u32 s53, s64, s66
s_lshr_b32 s54, s65, 2
s_lshl_b32 s65, s54, 4
s_lshl_b32 s66, s52, 2
s_add_u32 s55, s65, s66
s_lshr_b32 s66, s53, 1
s_add_u32 s67, s65, s66
s_mul_i32 s74, s67, 20480
v_and_b32 v3, 15, v0
v_lshrrev_b32 v4, 4, v0
v_mul_u32_u24 v5, 1280, v3
v_mul_u32_u24 v6, 320, v14
v_lshlrev_b32 v7, 3, v4
v_add3_u32 v5, v5, v6, v7
v_mov_b32 v96, 0
v_mov_b32 v94, 0
s_or_b32 s56, s2, s52
s_waitcnt lgkmcnt(0)
s_mov_b32 s28, s76
s_and_b32 s29, s77, 0xffff
s_mov_b32 s30, 2621440
s_mov_b32 s31, 0x20000
s_mov_b32 s32, s98
s_and_b32 s33, s99, 0xffff
s_mov_b32 s34, 256
s_mov_b32 s35, 0x20000
s_cmp_lg_u32 s56, 0
s_cbranch_scc1 L_nonc
s_or_b32 s56, s70, 1
v_mov_b32 v80, s56
v_mov_b32 v81, s71
buffer_store_dwordx2 v[80:81], v96, s[32:35], 0 offen sc1
L_nonc:
s_bitcmp1_b32 s53, 0
s_cbranch_scc1 L_nox
buffer_load_dwordx2 v[100:101], v5, s[28:31], s74 offen
buffer_load_dwordx2 v[102:103], v5, s[28:31], s74 offen offset:32
buffer_load_dwordx2 v[104:105], v5, s[28:31], s74 offen offset:64
buffer_load_dwordx2 v[106:107], v5, s[28:31], s74 offen offset:96
buffer_load_dwordx2 v[108:109], v5, s[28:31], s74 offen offset:128
buffer_load_dwordx2 v[110:111], v5, s[28:31], s74 offen offset:160
buffer_load_dwordx2 v[112:113], v5, s[28:31], s74 offen offset:192
buffer_load_dwordx2 v[114:115], v5, s[28:31], s74 offen offset:224
buffer_load_dwordx2 v[116:117], v5, s[28:31], s74 offen offset:256
buffer_load_dwordx2 v[118:119], v5, s[28:31], s74 offen offset:288
L_nox:
v_add_u32 v82, 0, v0
v_mul_u32_u24 v83, 2731, v82
v_lshrrev_b32 v83, 16, v83
v_mul_u32_u24 v97, 24, v83
v_sub_u32 v82, v82, v97
v_and_b32 v97, 6, v83
v_xor_b32 v82, v82, v97
v_lshlrev_b32 v82, 4, v82
v_mul_u32_u24 v97, 12288, v83
v_add_u32 v97, v97, v82
v_add_u32 v247, 0, v97
v_mul_u32_u24 v97, 384, v83
v_add_u32 v97, v97, v82
v_add_u32 v84, 128, v97
v_add_u32 v82, 64, v0
v_mul_u32_u24 v83, 2731, v82
v_lshrrev_b32 v83, 16, v83
v_mul_u32_u24 v97, 24, v83
v_sub_u32 v82, v82, v97
v_and_b32 v97, 6, v83
v_xor_b32 v82, v82, v97
v_lshlrev_b32 v82, 4, v82
v_mul_u32_u24 v97, 12288, v83
v_add_u32 v97, v97, v82
v_add_u32 v248, 4294966272, v97
v_mul_u32_u24 v97, 384, v83
v_add_u32 v97, v97, v82
v_add_u32 v85, 4294966400, v97
v_add_u32 v82, 128, v0
v_mul_u32_u24 v83, 2731, v82
v_lshrrev_b32 v83, 16, v83
v_mul_u32_u24 v97, 24, v83
v_sub_u32 v82, v82, v97
v_and_b32 v97, 6, v83
v_xor_b32 v82, v82, v97
v_lshlrev_b32 v82, 4, v82
v_mul_u32_u24 v97, 12288, v83
v_add_u32 v97, v97, v82
v_add_u32 v249, 4294965248, v97
v_mul_u32_u24 v97, 384, v83
v_add_u32 v97, v97, v82
v_add_u32 v86, 4294965376, v97
v_lshrrev_b32 v83, 3, v0
v_and_b32 v82, 7, v0
v_and_b32 v97, 6, v83
v_xor_b32 v82, v82, v97
v_lshlrev_b32 v82, 4, v82
v_mul_u32_u24 v97, 3072, v83
v_add_u32 v250, v97, v82
s_mul_i32 s64, s53, 384
s_add_u32 s12, s82, s64
s_addc_u32 s13, s83, 0
s_and_b32 s13, s13, 0xffff
s_sub_u32 s14, 7864320, s64
s_mov_b32 s15, 0x20000
s_lshr_b32 s75, s53, 3
s_lshl_b32 s75, s75, 2
s_and_b32 s59, s53, 3
s_add_u32 s69, s75, s59
s_mul_i32 s75, s69, 192
s_and_b32 s59, s2, 1
s_lshl_b32 s59, s59, 7
s_add_u32 s75, s75, s59
s_add_u32 s16, s88, s75
s_addc_u32 s17, s89, 0
s_and_b32 s17, s17, 0xffff
s_sub_u32 s18, 1966080, s75
s_mov_b32 s19, 0x20000
s_mul_i32 s68, s52, 6144
s_mul_i32 s64, s52, 196608
s_mul_i32 s65, s52, 49152
s_mul_i32 s66, s55, 20480
s_lshl_b32 s61, s52, 11
s_add_u32 m0, s68, 73728
s_nop 0
buffer_load_dwordx4 v247, s[12:15], s64 offen lds
buffer_load_dwordx4 v248, s[12:15], s64 offen offset:1024 lds
buffer_load_dwordx4 v249, s[12:15], s64 offen offset:2048 lds
s_add_u32 s64, s64, 98304
s_add_u32 m0, s68, 76800
s_nop 0
buffer_load_dwordx4 v247, s[12:15], s64 offen lds
buffer_load_dwordx4 v248, s[12:15], s64 offen offset:1024 lds
buffer_load_dwordx4 v249, s[12:15], s64 offen offset:2048 lds
s_add_u32 s64, s64, 688128
s_add_u32 m0, s61, 49152
s_nop 0
buffer_load_dwordx4 v250, s[16:19], s65 offen lds
s_add_u32 s65, s65, 23552
buffer_load_dwordx4 v250, s[16:19], s65 offen offset:1024 lds
s_add_u32 s65, s65, 173056
s_mov_b32 s24, s90
s_and_b32 s25, s91, 0xffff
s_mov_b32 s26, 3072
s_mov_b32 s27, 0x20000
buffer_load_dwordx2 v[88:89], v7, s[24:27], s75 offen
buffer_load_dwordx2 v[90:91], v7, s[24:27], s75 offen offset:32
buffer_load_dwordx2 v[92:93], v7, s[24:27], s75 offen offset:64
buffer_load_dwordx2 v[124:125], v7, s[24:27], s75 offen offset:96
s_add_u32 m0, s68, 98304
s_nop 0
buffer_load_dwordx4 v247, s[12:15], s64 offen lds
buffer_load_dwordx4 v248, s[12:15], s64 offen offset:1024 lds
buffer_load_dwordx4 v249, s[12:15], s64 offen offset:2048 lds
s_add_u32 s64, s64, 98304
s_add_u32 m0, s68, 101376
s_nop 0
buffer_load_dwordx4 v247, s[12:15], s64 offen lds
buffer_load_dwordx4 v248, s[12:15], s64 offen offset:1024 lds
buffer_load_dwordx4 v249, s[12:15], s64 offen offset:2048 lds
s_add_u32 s64, s64, 688128
s_add_u32 m0, s61, 57344
s_nop 0
buffer_load_dwordx4 v250, s[16:19], s65 offen lds
s_add_u32 s65, s65, 23552
buffer_load_dwordx4 v250, s[16:19], s65 offen offset:1024 lds
s_add_u32 s65, s65, 173056
s_mul_i32 s56, s53, 786432
s_add_u32 s4, s78, s56
s_addc_u32 s5, s79, 0
s_sub_u32 s4, s4, 128
s_subb_u32 s5, s5, 0
s_and_b32 s5, s5, 0xffff
s_mov_b32 s6, 786560
s_mov_b32 s7, 0x20000
s_add_u32 s8, s80, s56
s_addc_u32 s9, s81, 0
s_sub_u32 s8, s8, 128
s_subb_u32 s9, s9, 0
s_and_b32 s9, s9, 0xffff
s_mov_b32 s10, 786560
s_mov_b32 s11, 0x20000
s_mov_b32 s20, s100
s_and_b32 s21, s101, 0xffff
s_mov_b32 s22, 83886080
s_mov_b32 s23, 0x20000
s_mov_b32 s36, s96
s_and_b32 s37, s97, 0xffff
s_mov_b32 s38, 2621440
s_mov_b32 s39, 0x20000
s_mov_b32 s44, s94
s_and_b32 s45, s95, 0xffff
s_mov_b32 s46, 1280
s_mov_b32 s47, 0x20000
s_mov_b32 s40, s84
s_and_b32 s41, s85, 0xffff
s_mov_b32 s42, 7864320
s_mov_b32 s43, 0x20000
s_mov_b32 s48, s92
s_and_b32 s49, s93, 0xffff
s_mov_b32 s50, 1966080
s_mov_b32 s51, 0x20000
s_and_b32 s3, s2, 3
s_bfe_u32 s56, s2, 0x10002
s_lshl_b32 s56, s56, 3
s_bfe_u32 s72, s2, 0x30003
s_add_u32 s72, s72, s56
s_lshr_b32 s73, s2, 6
s_lshr_b32 s76, s52, 1
s_and_b32 s77, s52, 1
s_lshl_b32 s58, s54, 7
s_add_u32 s58, s58, 75563008
s_bitcmp1_b32 s53, 0
s_cbranch_scc1 L_noln
v_lshlrev_b32 v8, 6, v3
v_add_u32 v8, 147456, v8
v_lshl_add_u32 v9, v14, 2, v4
v_lshl_add_u32 v9, v9, 2, v8
v_mul_u32_u24 v10, 5120, v14
v_lshl_add_u32 v10, v0, 4, v10
s_mov_b32 s56, 0x3f803f80
s_mov_b32 s57, 0x3f80
s_mov_b32 s60, 0x3f800000
s_waitcnt vmcnt(20)
v_dot2_f32_bf16 v11, v100, s56, 0
v_dot2_f32_bf16 v12, v101, s56, 0
v_dot2_f32_bf16 v11, v102, s56, v11
v_dot2_f32_bf16 v12, v103, s56, v12
v_dot2_f32_bf16 v11, v104, s56, v11
v_dot2_f32_bf16 v12, v105, s56, v12
v_dot2_f32_bf16 v11, v106, s56, v11
v_dot2_f32_bf16 v12, v107, s56, v12
v_dot2_f32_bf16 v11, v108, s56, v11
v_dot2_f32_bf16 v12, v109, s56, v12
v_dot2_f32_bf16 v11, v110, s56, v11
v_dot2_f32_bf16 v12, v111, s56, v12
v_dot2_f32_bf16 v11, v112, s56, v11
v_dot2_f32_bf16 v12, v113, s56, v12
v_dot2_f32_bf16 v11, v114, s56, v11
v_dot2_f32_bf16 v12, v115, s56, v12
v_dot2_f32_bf16 v11, v116, s56, v11
v_dot2_f32_bf16 v12, v117, s56, v12
v_dot2_f32_bf16 v11, v118, s56, v11
v_dot2_f32_bf16 v12, v119, s56, v12
s_nop 2
v_add_f32 v11, v11, v12
ds_write_b32 v9, v11
s_waitcnt lgkmcnt(0)
s_barrier
ds_read_b128 v[16:19], v8
ds_read_b128 v[20:23], v8 offset:16
ds_read_b128 v[24:27], v8 offset:32
ds_read_b128 v[28:31], v8 offset:48
s_waitcnt lgkmcnt(0)
v_pk_add_f32 v[16:17], v[16:17], v[24:25]
v_pk_add_f32 v[18:19], v[18:19], v[26:27]
v_pk_add_f32 v[20:21], v[20:21], v[28:29]
v_pk_add_f32 v[22:23], v[22:23], v[30:31]
v_pk_add_f32 v[16:17], v[16:17], v[20:21]
v_pk_add_f32 v[18:19], v[18:19], v[22:23]
v_pk_add_f32 v[16:17], v[16:17], v[18:19]
v_add_f32 v16, v16, v17
v_mul_f32 v13, 0xbacccccd, v16
v_dot2_f32_bf16 v40, v100, s57, v13
v_dot2_f32_bf16 v41, v100, s60, v13
v_dot2_f32_bf16 v42, v101, s57, v13
v_dot2_f32_bf16 v43, v101, s60, v13
v_dot2_f32_bf16 v44, v102, s57, v13
v_dot2_f32_bf16 v45, v102, s60, v13
v_dot2_f32_bf16 v46, v103, s57, v13
v_dot2_f32_bf16 v47, v103, s60, v13
v_dot2_f32_bf16 v48, v104, s57, v13
v_dot2_f32_bf16 v49, v104, s60, v13
v_dot2_f32_bf16 v50, v105, s57, v13
v_dot2_f32_bf16 v51, v105, s60, v13
v_dot2_f32_bf16 v52, v106, s57, v13
v_dot2_f32_bf16 v53, v106, s60, v13
v_dot2_f32_bf16 v54, v107, s57, v13
v_dot2_f32_bf16 v55, v107, s60, v13
v_dot2_f32_bf16 v56, v108, s57, v13
v_dot2_f32_bf16 v57, v108, s60, v13
v_dot2_f32_bf16 v58, v109, s57, v13
v_dot2_f32_bf16 v59, v109, s60, v13
v_dot2_f32_bf16 v60, v110, s57, v13
v_dot2_f32_bf16 v61, v110, s60, v13
v_dot2_f32_bf16 v62, v111, s57, v13
v_dot2_f32_bf16 v63, v111, s60, v13
v_dot2_f32_bf16 v64, v112, s57, v13
v_dot2_f32_bf16 v65, v112, s60, v13
v_dot2_f32_bf16 v66, v113, s57, v13
v_dot2_f32_bf16 v67, v113, s60, v13
v_dot2_f32_bf16 v68, v114, s57, v13
v_dot2_f32_bf16 v69, v114, s60, v13
v_dot2_f32_bf16 v70, v115, s57, v13
v_dot2_f32_bf16 v71, v115, s60, v13
v_dot2_f32_bf16 v72, v116, s57, v13
v_dot2_f32_bf16 v73, v116, s60, v13
v_dot2_f32_bf16 v74, v117, s57, v13
v_dot2_f32_bf16 v75, v117, s60, v13
v_dot2_f32_bf16 v76, v118, s57, v13
v_dot2_f32_bf16 v77, v118, s60, v13
v_dot2_f32_bf16 v78, v119, s57, v13
v_dot2_f32_bf16 v79, v119, s60, v13
v_pk_mul_f32 v[36:37], v[40:41], v[40:41]
v_pk_mul_f32 v[38:39], v[42:43], v[42:43]
v_pk_fma_f32 v[36:37], v[44:45], v[44:45], v[36:37]
v_pk_fma_f32 v[38:39], v[46:47], v[46:47], v[38:39]
v_pk_fma_f32 v[36:37], v[48:49], v[48:49], v[36:37]
v_pk_fma_f32 v[38:39], v[50:51], v[50:51], v[38:39]
v_pk_fma_f32 v[36:37], v[52:53], v[52:53], v[36:37]
v_pk_fma_f32 v[38:39], v[54:55], v[54:55], v[38:39]
v_pk_fma_f32 v[36:37], v[56:57], v[56:57], v[36:37]
v_pk_fma_f32 v[38:39], v[58:59], v[58:59], v[38:39]
v_pk_fma_f32 v[36:37], v[60:61], v[60:61], v[36:37]
v_pk_fma_f32 v[38:39], v[62:63], v[62:63], v[38:39]
v_pk_fma_f32 v[36:37], v[64:65], v[64:65], v[36:37]
v_pk_fma_f32 v[38:39], v[66:67], v[66:67], v[38:39]
v_pk_fma_f32 v[36:37], v[68:69], v[68:69], v[36:37]
v_pk_fma_f32 v[38:39], v[70:71], v[70:71], v[38:39]
v_pk_fma_f32 v[36:37], v[72:73], v[72:73], v[36:37]
v_pk_fma_f32 v[38:39], v[74:75], v[74:75], v[38:39]
v_pk_fma_f32 v[36:37], v[76:77], v[76:77], v[36:37]
v_pk_fma_f32 v[38:39], v[78:79], v[78:79], v[38:39]
v_pk_add_f32 v[36:37], v[36:37], v[38:39]
v_add_f32 v11, v36, v37
ds_write_b32 v9, v11 offset:1024
s_waitcnt lgkmcnt(0)
s_barrier
ds_read_b128 v[16:19], v8 offset:1024
ds_read_b128 v[20:23], v8 offset:1040
ds_read_b128 v[24:27], v8 offset:1056
ds_read_b128 v[28:31], v8 offset:1072
s_waitcnt lgkmcnt(0)
v_pk_add_f32 v[16:17], v[16:17], v[24:25]
v_pk_add_f32 v[18:19], v[18:19], v[26:27]
v_pk_add_f32 v[20:21], v[20:21], v[28:29]
v_pk_add_f32 v[22:23], v[22:23], v[30:31]
v_pk_add_f32 v[16:17], v[16:17], v[20:21]
v_pk_add_f32 v[18:19], v[18:19], v[22:23]
v_pk_add_f32 v[16:17], v[16:17], v[18:19]
v_add_f32 v16, v16, v17
v_mov_b32 v12, 0x3727c5ac
v_fmac_f32 v12, 0x3acccccd, v16
v_rsq_f32 v12, v12
s_nop 0
v_mul_f32 v12, 0x3dd53b95, v12
v_pk_mul_f32 v[40:41], v[40:41], v[12:13] op_sel_hi:[1,0]
v_pk_mul_f32 v[42:43], v[42:43], v[12:13] op_sel_hi:[1,0]
v_pk_mul_f32 v[44:45], v[44:45], v[12:13] op_sel_hi:[1,0]
v_pk_mul_f32 v[46:47], v[46:47], v[12:13] op_sel_hi:[1,0]
v_cvt_pk_bf16_f32 v16, v40, v41
v_cvt_pk_bf16_f32 v17, v42, v43
v_cvt_pk_bf16_f32 v18, v44, v45
v_cvt_pk_bf16_f32 v19, v46, v47
buffer_store_dwordx4 v[16:19], v10, s[20:23], s74 offen sc1
v_pk_mul_f32 v[48:49], v[48:49], v[12:13] op_sel_hi:[1,0]
v_pk_mul_f32 v[50:51], v[50:51], v[12:13] op_sel_hi:[1,0]
v_pk_mul_f32 v[52:53], v[52:53], v[12:13] op_sel_hi:[1,0]
v_pk_mul_f32 v[54:55], v[54:55], v[12:13] op_sel_hi:[1,0]
v_cvt_pk_bf16_f32 v20, v48, v49
v_cvt_pk_bf16_f32 v21, v50, v51
v_cvt_pk_bf16_f32 v22, v52, v53
v_cvt_pk_bf16_f32 v23, v54, v55
buffer_store_dwordx4 v[20:23], v10, s[20:23], s74 offen offset:1024 sc1
v_pk_mul_f32 v[56:57], v[56:57], v[12:13] op_sel_hi:[1,0]
v_pk_mul_f32 v[58:59], v[58:59], v[12:13] op_sel_hi:[1,0]
v_pk_mul_f32 v[60:61], v[60:61], v[12:13] op_sel_hi:[1,0]
v_pk_mul_f32 v[62:63], v[62:63], v[12:13] op_sel_hi:[1,0]
v_cvt_pk_bf16_f32 v24, v56, v57
v_cvt_pk_bf16_f32 v25, v58, v59
v_cvt_pk_bf16_f32 v26, v60, v61
v_cvt_pk_bf16_f32 v27, v62, v63
buffer_store_dwordx4 v[24:27], v10, s[20:23], s74 offen offset:2048 sc1
v_pk_mul_f32 v[64:65], v[64:65], v[12:13] op_sel_hi:[1,0]
v_pk_mul_f32 v[66:67], v[66:67], v[12:13] op_sel_hi:[1,0]
v_pk_mul_f32 v[68:69], v[68:69], v[12:13] op_sel_hi:[1,0]
v_pk_mul_f32 v[70:71], v[70:71], v[12:13] op_sel_hi:[1,0]
v_cvt_pk_bf16_f32 v28, v64, v65
v_cvt_pk_bf16_f32 v29, v66, v67
v_cvt_pk_bf16_f32 v30, v68, v69
v_cvt_pk_bf16_f32 v31, v70, v71
buffer_store_dwordx4 v[28:31], v10, s[20:23], s74 offen offset:3072 sc1
v_pk_mul_f32 v[72:73], v[72:73], v[12:13] op_sel_hi:[1,0]
v_pk_mul_f32 v[74:75], v[74:75], v[12:13] op_sel_hi:[1,0]
v_pk_mul_f32 v[76:77], v[76:77], v[12:13] op_sel_hi:[1,0]
v_pk_mul_f32 v[78:79], v[78:79], v[12:13] op_sel_hi:[1,0]
v_cvt_pk_bf16_f32 v32, v72, v73
v_cvt_pk_bf16_f32 v33, v74, v75
v_cvt_pk_bf16_f32 v34, v76, v77
v_cvt_pk_bf16_f32 v35, v78, v79
s_add_u32 s74, s74, 4096
buffer_store_dwordx4 v[32:35], v10, s[20:23], s74 offen sc1
s_cmp_lg_u32 s52, 0
s_cbranch_scc1 L_ln2
buffer_load_dwordx2 v[94:95], v96, s[32:35], 0 offen sc1
L_ln2:
s_waitcnt vmcnt(0)
s_barrier
L_noln:
s_cmp_lg_u32 s52, 0
s_cbranch_scc1 L_w0a
v_mov_b32 v14, v94
v_mov_b32 v15, v95
s_nop 0
v_readfirstlane_b32 s70, v14
v_readfirstlane_b32 s71, v15
s_nop 0
s_cmp_eq_u32 s70, 0
s_cbranch_scc0 L_pnon_ok
s_mov_b32 s74, 262144
L_pnon:
buffer_load_dwordx2 v[14:15], v96, s[32:35], 0 offen sc1
s_waitcnt vmcnt(0)
v_readfirstlane_b32 s70, v14
v_readfirstlane_b32 s71, v15
s_nop 0
s_cmp_eq_u32 s70, 0
s_cbranch_scc0 L_pnon_ok
s_sleep 8
s_sub_u32 s74, s74, 1
s_cmp_lg_u32 s74, 0
s_cbranch_scc1 L_pnon
L_pnon_ok:
s_bitcmp1_b32 s53, 0
s_cbranch_scc1 L_w0a
s_lshl_b32 s56, s53, 2
s_add_u32 s56, s56, s58
buffer_store_dwordx2 v[14:15], v96, s[20:23], s56 offen sc1
L_w0a:
v_mov_b32 v7, v84
v_mov_b32 v8, v85
v_mov_b32 v9, v86
v_lshlrev_b32 v17, 4, v0
v_add_u32 v251, 0, v17
v_lshlrev_b32 v17, 4, v0
v_add_u32 v252, 20480, v17
v_lshlrev_b32 v17, 4, v0
v_add_u32 v253, 40960, v17
v_lshlrev_b32 v17, 4, v0
v_add_u32 v254, 61440, v17
v_lshrrev_b32 v16, 2, v0
v_and_b32 v17, 6, v16
v_and_b32 v18, 3, v0
v_lshrrev_b32 v19, 1, v18
v_and_b32 v20, 1, v18
v_lshlrev_b32 v20, 3, v20
v_mul_u32_u24 v21, 384, v16
v_add_u32 v21, 73728, v21
v_add_u32 v22, 0, v19
v_xor_b32 v22, v22, v17
v_lshlrev_b32 v22, 4, v22
v_add3_u32 v3, v21, v22, v20
v_add_u32 v3, 24576, v3
v_add_u32 v22, 2, v19
v_xor_b32 v22, v22, v17
v_lshlrev_b32 v22, 4, v22
v_add3_u32 v4, v21, v22, v20
v_add_u32 v4, 24576, v4
v_add_u32 v22, 4, v19
v_xor_b32 v22, v22, v17
v_lshlrev_b32 v22, 4, v22
v_add3_u32 v5, v21, v22, v20
v_add_u32 v5, 24576, v5
v_add_u32 v22, 6, v19
v_xor_b32 v22, v22, v17
v_lshlrev_b32 v22, 4, v22
v_add3_u32 v6, v21, v22, v20
v_add_u32 v6, 24576, v6
v_add_u32 v22, 0, v18
v_xor_b32 v22, v22, v17
v_lshlrev_b32 v22, 4, v22
v_add_u32 v240, v21, v22
v_add_u32 v242, 49152, v240
v_add_u32 v22, 4, v18
v_xor_b32 v22, v22, v17
v_lshlrev_b32 v22, 4, v22
v_add_u32 v241, v21, v22
v_add_u32 v243, 49152, v241
v_lshlrev_b32 v21, 7, v16
v_add_u32 v21, 49152, v21
v_add_u32 v22, 0, v19
v_xor_b32 v22, v22, v17
v_lshlrev_b32 v22, 4, v22
v_add3_u32 v244, v21, v22, v20
v_add_u32 v22, 2, v19
v_xor_b32 v22, v22, v17
v_lshlrev_b32 v22, 4, v22
v_add3_u32 v245, v21, v22, v20
v_add_u32 v22, 4, v19
v_xor_b32 v22, v22, v17
v_lshlrev_b32 v22, 4, v22
v_add3_u32 v246, v21, v22, v20
v_add_u32 v22, 6, v19
v_xor_b32 v22, v22, v17
v_lshlrev_b32 v22, 4, v22
v_add3_u32 v255, v21, v22, v20
v_and_b32 v16, 15, v0
v_and_b32 v17, 6, v16
v_lshrrev_b32 v18, 4, v0
v_mul_u32_u24 v21, 384, v16
v_add_u32 v22, 0, v18
v_xor_b32 v22, v22, v17
v_lshlrev_b32 v22, 4, v22
v_add_u32 v1, v21, v22
v_add_u32 v22, 4, v18
v_xor_b32 v22, v22, v17
v_lshlrev_b32 v22, 4, v22
v_add_u32 v2, v21, v22
v_lshlrev_b32 v40, 3, v16
v_mov_b32 v41, 149504
s_waitcnt vmcnt(0)
s_movk_i32 s60, 11904
s_bitcmp1_b32 s53, 0
s_cbranch_scc0 L_nopf
s_lshl_b32 s56, s54, 2
s_add_u32 s56, s56, s52
s_lshl_b32 s56, s56, 4
s_add_u32 s56, s56, 127
s_mul_i32 s57, s56, 3072
s_mul_i32 s56, s56, 12288
v_lshrrev_b32 v120, 2, v0
v_and_b32 v121, 3, v0
v_min_u32 v121, 2, v121
v_lshlrev_b32 v121, 7, v121
v_mul_u32_u24 v122, 12288, v120
v_add3_u32 v122, v122, v121, s60
v_bfe_u32 v121, v0, 1, 1
v_mul_u32_u24 v121, 192, v121
v_mul_u32_u24 v123, 3072, v120
v_add_u32 v123, v123, v121
v_and_b32 v121, 1, v0
v_mul_u32_u24 v121, 124, v121
v_add_u32 v123, v123, v121
v_add_u32 v123, 2880, v123
buffer_load_dword v121, v122, s[12:15], s56 offen
buffer_load_dword v121, v122, s[12:15], s56 offen offset:384
buffer_load_dword v121, v123, s[16:19], s57 offen
L_nopf:
v_lshlrev_b32 v160, 16, v88
v_and_b32 v161, 0xffff0000, v88
v_lshlrev_b32 v162, 16, v89
v_and_b32 v163, 0xffff0000, v89
v_mul_f32 v160, 0x3dd53b95, v160
v_mul_f32 v161, 0x3dd53b95, v161
v_mul_f32 v162, 0x3dd53b95, v162
v_mul_f32 v163, 0x3dd53b95, v163
v_mov_b32 v164, v160
v_mov_b32 v165, v161
v_mov_b32 v166, v162
v_mov_b32 v167, v163
v_mov_b32 v168, v160
v_mov_b32 v169, v161
v_mov_b32 v170, v162
v_mov_b32 v171, v163
v_mov_b32 v172, v160
v_mov_b32 v173, v161
v_mov_b32 v174, v162
v_mov_b32 v175, v163
v_lshlrev_b32 v176, 16, v90
v_and_b32 v177, 0xffff0000, v90
v_lshlrev_b32 v178, 16, v91
v_and_b32 v179, 0xffff0000, v91
v_mul_f32 v176, 0x3dd53b95, v176
v_mul_f32 v177, 0x3dd53b95, v177
v_mul_f32 v178, 0x3dd53b95, v178
v_mul_f32 v179, 0x3dd53b95, v179
v_mov_b32 v180, v176
v_mov_b32 v181, v177
v_mov_b32 v182, v178
v_mov_b32 v183, v179
v_mov_b32 v184, v176
v_mov_b32 v185, v177
v_mov_b32 v186, v178
v_mov_b32 v187, v179
v_mov_b32 v188, v176
v_mov_b32 v189, v177
v_mov_b32 v190, v178
v_mov_b32 v191, v179
v_lshlrev_b32 v16, 16, v92
v_and_b32 v17, 0xffff0000, v92
v_lshlrev_b32 v18, 16, v93
v_and_b32 v19, 0xffff0000, v93
v_mul_f32 v16, 0x3dd53b95, v16
v_mul_f32 v17, 0x3dd53b95, v17
v_mul_f32 v18, 0x3dd53b95, v18
v_mul_f32 v19, 0x3dd53b95, v19
v_mov_b32 v20, v16
v_mov_b32 v21, v17
v_mov_b32 v22, v18
v_mov_b32 v23, v19
v_mov_b32 v24, v16
v_mov_b32 v25, v17
v_mov_b32 v26, v18
v_mov_b32 v27, v19
v_mov_b32 v28, v16
v_mov_b32 v29, v17
v_mov_b32 v30, v18
v_mov_b32 v31, v19
v_lshlrev_b32 v48, 16, v124
v_and_b32 v49, 0xffff0000, v124
v_lshlrev_b32 v50, 16, v125
v_and_b32 v51, 0xffff0000, v125
v_mul_f32 v48, 0x3dd53b95, v48
v_mul_f32 v49, 0x3dd53b95, v49
v_mul_f32 v50, 0x3dd53b95, v50
v_mul_f32 v51, 0x3dd53b95, v51
v_mov_b32 v52, v48
v_mov_b32 v53, v49
v_mov_b32 v54, v50
v_mov_b32 v55, v51
v_mov_b32 v56, v48
v_mov_b32 v57, v49
v_mov_b32 v58, v50
v_mov_b32 v59, v51
v_mov_b32 v60, v48
v_mov_b32 v61, v49
v_mov_b32 v62, v50
v_mov_b32 v63, v51
s_cmp_lg_u32 s52, 0
s_cbranch_scc1 L_w0b
s_mov_b32 s56, s64
s_mov_b32 s57, s65
s_mov_b32 s74, 262144
L_pln:
buffer_load_dwordx2 v[14:15], v40, s[20:23], s58 offen sc1
s_waitcnt vmcnt(0)
v_cmp_ne_u32 vcc, s70, v14
v_cmp_ne_u32 s[64:65], s71, v15
s_nop 0
s_or_b32 s64, vcc_lo, s64
s_and_b32 s64, s64, 0xffff
s_cmp_lg_u32 s64, 0
s_cbranch_scc0 L_pln_ok
s_sleep 2
s_sub_u32 s74, s74, 1
s_cmp_lg_u32 s74, 0
s_cbranch_scc1 L_pln
L_pln_ok:
s_mov_b32 s64, s56
s_mov_b32 s65, s57
v_mov_b32 v42, s70
v_mov_b32 v43, s71
ds_write_b64 v41, v[42:43]
s_waitcnt lgkmcnt(0)
L_w0b:
s_barrier
buffer_load_dwordx4 v[64:67], v251, s[20:23], s66 offen sc1
buffer_load_dwordx4 v[68:71], v251, s[20:23], s66 offen offset:1024 sc1
buffer_load_dwordx4 v[72:75], v252, s[20:23], s66 offen sc1
buffer_load_dwordx4 v[76:79], v252, s[20:23], s66 offen offset:1024 sc1
buffer_load_dwordx4 v[80:83], v253, s[20:23], s66 offen sc1
buffer_load_dwordx4 v[84:87], v253, s[20:23], s66 offen offset:1024 sc1
buffer_load_dwordx4 v[88:91], v254, s[20:23], s66 offen sc1
buffer_load_dwordx4 v[92:95], v254, s[20:23], s66 offen offset:1024 sc1
s_add_u32 s66, s66, 2048
buffer_load_dwordx4 v[96:99], v251, s[20:23], s66 offen sc1
buffer_load_dwordx4 v[100:103], v251, s[20:23], s66 offen offset:1024 sc1
buffer_load_dwordx4 v[104:107], v252, s[20:23], s66 offen sc1
buffer_load_dwordx4 v[108:111], v252, s[20:23], s66 offen offset:1024 sc1
buffer_load_dwordx4 v[112:115], v253, s[20:23], s66 offen sc1
buffer_load_dwordx4 v[116:119], v253, s[20:23], s66 offen offset:1024 sc1
buffer_load_dwordx4 v[120:123], v254, s[20:23], s66 offen sc1
buffer_load_dwordx4 v[124:127], v254, s[20:23], s66 offen offset:1024 sc1
s_add_u32 s66, s66, 2048
ds_read_b64 v[42:43], v41
s_bitcmp1_b32 s2, 0
s_cbranch_scc1 L_fo
ds_read_b64_tr_b16 v[208:209], v240
ds_read_b64_tr_b16 v[210:211], v240 offset:6144
ds_read_b64_tr_b16 v[212:213], v240 offset:12288
ds_read_b64_tr_b16 v[214:215], v240 offset:18432
ds_read_b64_tr_b16 v[216:217], v240 offset:8
ds_read_b64_tr_b16 v[218:219], v240 offset:6152
ds_read_b64_tr_b16 v[220:221], v240 offset:12296
ds_read_b64_tr_b16 v[222:223], v240 offset:18440
ds_read_b64_tr_b16 v[224:225], v241
ds_read_b64_tr_b16 v[226:227], v241 offset:6144
ds_read_b64_tr_b16 v[228:229], v241 offset:12288
ds_read_b64_tr_b16 v[230:231], v241 offset:18432
s_waitcnt lgkmcnt(8)
v_readfirstlane_b32 s70, v42
v_readfirstlane_b32 s71, v43
s_waitcnt vmcnt(8)
v_mfma_f32_16x16x32_bf16 a[0:3], v[208:211], v[64:67], 0
s_add_u32 m0, s68, 122880
ds_read_b64_tr_b16 v[232:233], v241 offset:8
v_mfma_f32_16x16x32_bf16 a[0:3], v[212:215], v[68:71], a[0:3]
buffer_load_dwordx4 v247, s[12:15], s64 offen lds
v_mfma_f32_16x16x32_bf16 a[4:7], v[212:215], v[76:79], 0
ds_read_b64_tr_b16 v[234:235], v241 offset:6152
v_mfma_f32_16x16x32_bf16 a[4:7], v[208:211], v[72:75], a[4:7]
v_mfma_f32_16x16x32_bf16 a[8:11], v[208:211], v[80:83], 0
ds_read_b64_tr_b16 v[236:237], v241 offset:12296
v_mfma_f32_16x16x32_bf16 a[8:11], v[212:215], v[84:87], a[8:11]
v_mfma_f32_16x16x32_bf16 a[12:15], v[212:215], v[92:95], 0
ds_read_b64_tr_b16 v[238:239], v241 offset:18440
v_mfma_f32_16x16x32_bf16 a[12:15], v[208:211], v[88:91], a[12:15]
s_waitcnt lgkmcnt(8)
v_mfma_f32_16x16x32_bf16 a[16:19], v[216:219], v[64:67], 0
ds_read_b64_tr_b16 v[192:193], v240 offset:128
buffer_load_dwordx4 v248, s[12:15], s64 offen offset:1024 lds
v_mfma_f32_16x16x32_bf16 a[16:19], v[220:223], v[68:71], a[16:19]
v_mfma_f32_16x16x32_bf16 a[20:23], v[220:223], v[76:79], 0
ds_read_b64_tr_b16 v[194:195], v240 offset:6272
v_mfma_f32_16x16x32_bf16 a[20:23], v[216:219], v[72:75], a[20:23]
v_mfma_f32_16x16x32_bf16 a[24:27], v[216:219], v[80:83], 0
ds_read_b64_tr_b16 v[196:197], v240 offset:12416
v_mfma_f32_16x16x32_bf16 a[24:27], v[220:223], v[84:87], a[24:27]
v_mfma_f32_16x16x32_bf16 a[28:31], v[220:223], v[92:95], 0
ds_read_b64_tr_b16 v[198:199], v240 offset:18560
v_mfma_f32_16x16x32_bf16 a[28:31], v[216:219], v[88:91], a[28:31]
s_waitcnt lgkmcnt(8)
v_mfma_f32_16x16x32_bf16 a[32:35], v[224:227], v[64:67], 0
ds_read_b64_tr_b16 v[200:201], v240 offset:136
buffer_load_dwordx4 v249, s[12:15], s64 offen offset:2048 lds
v_mfma_f32_16x16x32_bf16 a[32:35], v[228:231], v[68:71], a[32:35]
s_add_u32 s64, s64, 98304
s_add_u32 m0, s68, 125952
v_mfma_f32_16x16x32_bf16 a[36:39], v[228:231], v[76:79], 0
ds_read_b64_tr_b16 v[202:203], v240 offset:6280
v_mfma_f32_16x16x32_bf16 a[36:39], v[224:227], v[72:75], a[36:39]
v_mfma_f32_16x16x32_bf16 a[40:43], v[224:227], v[80:83], 0
ds_read_b64_tr_b16 v[204:205], v240 offset:12424
v_mfma_f32_16x16x32_bf16 a[40:43], v[228:231], v[84:87], a[40:43]
v_mfma_f32_16x16x32_bf16 a[44:47], v[228:231], v[92:95], 0
ds_read_b64_tr_b16 v[206:207], v240 offset:18568
v_mfma_f32_16x16x32_bf16 a[44:47], v[224:227], v[88:91], a[44:47]
s_waitcnt lgkmcnt(8)
v_mfma_f32_16x16x32_bf16 a[48:51], v[232:235], v[64:67], 0
ds_read_b64_tr_b16 v[208:209], v241 offset:128
buffer_load_dwordx4 v247, s[12:15], s64 offen lds
v_mfma_f32_16x16x32_bf16 a[48:51], v[236:239], v[68:71], a[48:51]
v_mfma_f32_16x16x32_bf16 a[52:55], v[236:239], v[76:79], 0
ds_read_b64_tr_b16 v[210:211], v241 offset:6272
v_mfma_f32_16x16x32_bf16 a[52:55], v[232:235], v[72:75], a[52:55]
v_mfma_f32_16x16x32_bf16 a[56:59], v[232:235], v[80:83], 0
ds_read_b64_tr_b16 v[212:213], v241 offset:12416
v_mfma_f32_16x16x32_bf16 a[56:59], v[236:239], v[84:87], a[56:59]
v_mfma_f32_16x16x32_bf16 a[60:63], v[236:239], v[92:95], 0
ds_read_b64_tr_b16 v[214:215], v241 offset:18560
v_mfma_f32_16x16x32_bf16 a[60:63], v[232:235], v[88:91], a[60:63]
s_waitcnt lgkmcnt(8)
v_mfma_f32_16x16x32_bf16 a[64:67], v[192:195], v[64:67], 0
ds_read_b64_tr_b16 v[216:217], v241 offset:136
buffer_load_dwordx4 v248, s[12:15], s64 offen offset:1024 lds
v_mfma_f32_16x16x32_bf16 a[64:67], v[196:199], v[68:71], a[64:67]
v_mfma_f32_16x16x32_bf16 a[68:71], v[196:199], v[76:79], 0
ds_read_b64_tr_b16 v[218:219], v241 offset:6280
v_mfma_f32_16x16x32_bf16 a[68:71], v[192:195], v[72:75], a[68:71]
v_mfma_f32_16x16x32_bf16 a[72:75], v[192:195], v[80:83], 0
ds_read_b64_tr_b16 v[220:221], v241 offset:12424
v_mfma_f32_16x16x32_bf16 a[72:75], v[196:199], v[84:87], a[72:75]
v_mfma_f32_16x16x32_bf16 a[76:79], v[196:199], v[92:95], 0
ds_read_b64_tr_b16 v[222:223], v241 offset:18568
v_mfma_f32_16x16x32_bf16 a[76:79], v[192:195], v[88:91], a[76:79]
s_waitcnt lgkmcnt(8)
buffer_load_dwordx4 v249, s[12:15], s64 offen offset:2048 lds
v_mfma_f32_16x16x32_bf16 a[80:83], v[200:203], v[64:67], 0
s_add_u32 s64, s64, 688128
s_add_u32 m0, s61, 65536
ds_read_b64_tr_b16 v[224:225], v240 offset:256
v_mfma_f32_16x16x32_bf16 a[80:83], v[204:207], v[68:71], a[80:83]
v_mfma_f32_16x16x32_bf16 a[84:87], v[204:207], v[76:79], 0
ds_read_b64_tr_b16 v[226:227], v240 offset:6400
v_mfma_f32_16x16x32_bf16 a[84:87], v[200:203], v[72:75], a[84:87]
v_mfma_f32_16x16x32_bf16 a[88:91], v[200:203], v[80:83], 0
ds_read_b64_tr_b16 v[228:229], v240 offset:12544
v_mfma_f32_16x16x32_bf16 a[88:91], v[204:207], v[84:87], a[88:91]
v_mfma_f32_16x16x32_bf16 a[92:95], v[204:207], v[92:95], 0
ds_read_b64_tr_b16 v[230:231], v240 offset:18688
v_mfma_f32_16x16x32_bf16 a[92:95], v[200:203], v[88:91], a[92:95]
s_waitcnt lgkmcnt(8)
buffer_load_dwordx4 v250, s[16:19], s65 offen lds
v_mfma_f32_16x16x32_bf16 a[96:99], v[208:211], v[64:67], 0
s_add_u32 s65, s65, 23552
ds_read_b64_tr_b16 v[232:233], v240 offset:264
v_mfma_f32_16x16x32_bf16 a[96:99], v[212:215], v[68:71], a[96:99]
v_mfma_f32_16x16x32_bf16 a[100:103], v[212:215], v[76:79], 0
ds_read_b64_tr_b16 v[234:235], v240 offset:6408
v_mfma_f32_16x16x32_bf16 a[100:103], v[208:211], v[72:75], a[100:103]
v_mfma_f32_16x16x32_bf16 a[104:107], v[208:211], v[80:83], 0
ds_read_b64_tr_b16 v[236:237], v240 offset:12552
v_mfma_f32_16x16x32_bf16 a[104:107], v[212:215], v[84:87], a[104:107]
v_mfma_f32_16x16x32_bf16 a[108:111], v[212:215], v[92:95], 0
ds_read_b64_tr_b16 v[238:239], v240 offset:18696
v_mfma_f32_16x16x32_bf16 a[108:111], v[208:211], v[88:91], a[108:111]
s_waitcnt lgkmcnt(8)
buffer_load_dwordx4 v250, s[16:19], s65 offen offset:1024 lds
v_mfma_f32_16x16x32_bf16 a[112:115], v[216:219], v[64:67], 0
s_add_u32 s65, s65, 173056
ds_read_b64_tr_b16 v[192:193], v241 offset:256
v_mfma_f32_16x16x32_bf16 a[112:115], v[220:223], v[68:71], a[112:115]
v_mfma_f32_16x16x32_bf16 a[116:119], v[220:223], v[76:79], 0
ds_read_b64_tr_b16 v[194:195], v241 offset:6400
v_mfma_f32_16x16x32_bf16 a[116:119], v[216:219], v[72:75], a[116:119]
v_mfma_f32_16x16x32_bf16 a[120:123], v[216:219], v[80:83], 0
ds_read_b64_tr_b16 v[196:197], v241 offset:12544
v_mfma_f32_16x16x32_bf16 a[120:123], v[220:223], v[84:87], a[120:123]
v_mfma_f32_16x16x32_bf16 a[124:127], v[220:223], v[92:95], 0
ds_read_b64_tr_b16 v[198:199], v241 offset:18688
v_mfma_f32_16x16x32_bf16 a[124:127], v[216:219], v[88:91], a[124:127]
s_waitcnt lgkmcnt(8)
buffer_load_dwordx4 v[128:131], v251, s[20:23], s66 offen sc1
v_mfma_f32_16x16x32_bf16 a[128:131], v[224:227], v[64:67], 0
ds_read_b64_tr_b16 v[200:201], v241 offset:264
v_mfma_f32_16x16x32_bf16 a[128:131], v[228:231], v[68:71], a[128:131]
v_mfma_f32_16x16x32_bf16 a[132:135], v[228:231], v[76:79], 0
ds_read_b64_tr_b16 v[202:203], v241 offset:6408
v_mfma_f32_16x16x32_bf16 a[132:135], v[224:227], v[72:75], a[132:135]
v_mfma_f32_16x16x32_bf16 a[136:139], v[224:227], v[80:83], 0
ds_read_b64_tr_b16 v[204:205], v241 offset:12552
v_mfma_f32_16x16x32_bf16 a[136:139], v[228:231], v[84:87], a[136:139]
v_mfma_f32_16x16x32_bf16 a[140:143], v[228:231], v[92:95], 0
ds_read_b64_tr_b16 v[206:207], v241 offset:18696
buffer_load_dwordx4 v[132:135], v251, s[20:23], s66 offen offset:1024 sc1
v_mfma_f32_16x16x32_bf16 a[140:143], v[224:227], v[88:91], a[140:143]
s_waitcnt lgkmcnt(8)
v_mfma_f32_16x16x32_bf16 a[144:147], v[232:235], v[64:67], 0
ds_read_b64_tr_b16 v[208:209], v244
v_mfma_f32_16x16x32_bf16 a[144:147], v[236:239], v[68:71], a[144:147]
v_mfma_f32_16x16x32_bf16 a[148:151], v[236:239], v[76:79], 0
ds_read_b64_tr_b16 v[210:211], v244 offset:2048
v_mfma_f32_16x16x32_bf16 a[148:151], v[232:235], v[72:75], a[148:151]
v_mfma_f32_16x16x32_bf16 a[152:155], v[232:235], v[80:83], 0
ds_read_b64_tr_b16 v[212:213], v244 offset:4096
v_mfma_f32_16x16x32_bf16 a[152:155], v[236:239], v[84:87], a[152:155]
v_mfma_f32_16x16x32_bf16 a[156:159], v[236:239], v[92:95], 0
ds_read_b64_tr_b16 v[214:215], v244 offset:6144
buffer_load_dwordx4 v[136:139], v252, s[20:23], s66 offen sc1
v_mfma_f32_16x16x32_bf16 a[156:159], v[232:235], v[88:91], a[156:159]
s_waitcnt lgkmcnt(8)
v_mfma_f32_16x16x32_bf16 a[160:163], v[192:195], v[64:67], 0
ds_read_b64_tr_b16 v[216:217], v245
v_mfma_f32_16x16x32_bf16 a[160:163], v[196:199], v[68:71], a[160:163]
v_mfma_f32_16x16x32_bf16 a[164:167], v[196:199], v[76:79], 0
ds_read_b64_tr_b16 v[218:219], v245 offset:2048
v_mfma_f32_16x16x32_bf16 a[164:167], v[192:195], v[72:75], a[164:167]
v_mfma_f32_16x16x32_bf16 a[168:171], v[192:195], v[80:83], 0
ds_read_b64_tr_b16 v[220:221], v245 offset:4096
v_mfma_f32_16x16x32_bf16 a[168:171], v[196:199], v[84:87], a[168:171]
v_mfma_f32_16x16x32_bf16 a[172:175], v[196:199], v[92:95], 0
ds_read_b64_tr_b16 v[222:223], v245 offset:6144
buffer_load_dwordx4 v[140:143], v252, s[20:23], s66 offen offset:1024 sc1
v_mfma_f32_16x16x32_bf16 a[172:175], v[192:195], v[88:91], a[172:175]
s_waitcnt lgkmcnt(8)
v_mfma_f32_16x16x32_bf16 a[176:179], v[200:203], v[64:67], 0
ds_read_b64_tr_b16 v[224:225], v246
v_mfma_f32_16x16x32_bf16 a[176:179], v[204:207], v[68:71], a[176:179]
v_mfma_f32_16x16x32_bf16 a[180:183], v[204:207], v[76:79], 0
ds_read_b64_tr_b16 v[226:227], v246 offset:2048
v_mfma_f32_16x16x32_bf16 a[180:183], v[200:203], v[72:75], a[180:183]
v_mfma_f32_16x16x32_bf16 a[184:187], v[200:203], v[80:83], 0
ds_read_b64_tr_b16 v[228:229], v246 offset:4096
v_mfma_f32_16x16x32_bf16 a[184:187], v[204:207], v[84:87], a[184:187]
v_mfma_f32_16x16x32_bf16 a[188:191], v[204:207], v[92:95], 0
ds_read_b64_tr_b16 v[230:231], v246 offset:6144
buffer_load_dwordx4 v[144:147], v253, s[20:23], s66 offen sc1
v_mfma_f32_16x16x32_bf16 a[188:191], v[200:203], v[88:91], a[188:191]
s_waitcnt lgkmcnt(8)
v_mfma_f32_16x16x32_bf16 v[160:163], v[208:211], v[64:67], v[160:163]
ds_read_b64_tr_b16 v[232:233], v255
v_mfma_f32_16x16x32_bf16 v[160:163], v[212:215], v[68:71], v[160:163]
v_mfma_f32_16x16x32_bf16 v[164:167], v[212:215], v[76:79], v[164:167]
ds_read_b64_tr_b16 v[234:235], v255 offset:2048
v_mfma_f32_16x16x32_bf16 v[164:167], v[208:211], v[72:75], v[164:167]
v_mfma_f32_16x16x32_bf16 v[168:171], v[208:211], v[80:83], v[168:171]
ds_read_b64_tr_b16 v[236:237], v255 offset:4096
v_mfma_f32_16x16x32_bf16 v[168:171], v[212:215], v[84:87], v[168:171]
buffer_load_dwordx4 v[148:151], v253, s[20:23], s66 offen offset:1024 sc1
v_mfma_f32_16x16x32_bf16 v[172:175], v[212:215], v[92:95], v[172:175]
ds_read_b64_tr_b16 v[238:239], v255 offset:6144
v_mfma_f32_16x16x32_bf16 v[172:175], v[208:211], v[88:91], v[172:175]
s_waitcnt lgkmcnt(8)
v_mfma_f32_16x16x32_bf16 v[176:179], v[216:219], v[64:67], v[176:179]
v_mfma_f32_16x16x32_bf16 v[176:179], v[220:223], v[68:71], v[176:179]
v_mfma_f32_16x16x32_bf16 v[180:183], v[220:223], v[76:79], v[180:183]
v_mfma_f32_16x16x32_bf16 v[180:183], v[216:219], v[72:75], v[180:183]
v_mfma_f32_16x16x32_bf16 v[184:187], v[216:219], v[80:83], v[184:187]
v_mfma_f32_16x16x32_bf16 v[184:187], v[220:223], v[84:87], v[184:187]
buffer_load_dwordx4 v[152:155], v254, s[20:23], s66 offen sc1
v_mfma_f32_16x16x32_bf16 v[188:191], v[220:223], v[92:95], v[188:191]
s_waitcnt vmcnt(23) lgkmcnt(0)
s_barrier
v_mfma_f32_16x16x32_bf16 v[188:191], v[216:219], v[88:91], v[188:191]
s_waitcnt lgkmcnt(0)
ds_read_b64_tr_b16 v[192:193], v240 offset:24576
v_mfma_f32_16x16x32_bf16 v[16:19], v[224:227], v[64:67], v[16:19]
ds_read_b64_tr_b16 v[194:195], v240 offset:30720
v_mfma_f32_16x16x32_bf16 v[16:19], v[228:231], v[68:71], v[16:19]
ds_read_b64_tr_b16 v[196:197], v240 offset:36864
v_mfma_f32_16x16x32_bf16 v[20:23], v[228:231], v[76:79], v[20:23]
ds_read_b64_tr_b16 v[198:199], v240 offset:43008
v_mfma_f32_16x16x32_bf16 v[20:23], v[224:227], v[72:75], v[20:23]
v_mfma_f32_16x16x32_bf16 v[24:27], v[224:227], v[80:83], v[24:27]
ds_read_b64_tr_b16 v[200:201], v240 offset:24584
v_mfma_f32_16x16x32_bf16 v[24:27], v[228:231], v[84:87], v[24:27]
ds_read_b64_tr_b16 v[202:203], v240 offset:30728
buffer_load_dwordx4 v[156:159], v254, s[20:23], s66 offen offset:1024 sc1
v_mfma_f32_16x16x32_bf16 v[28:31], v[228:231], v[92:95], v[28:31]
s_add_u32 s66, s66, 2048
ds_read_b64_tr_b16 v[204:205], v240 offset:36872
v_mfma_f32_16x16x32_bf16 v[28:31], v[224:227], v[88:91], v[28:31]
s_waitcnt lgkmcnt(7)
ds_read_b64_tr_b16 v[206:207], v240 offset:43016
v_mfma_f32_16x16x32_bf16 v[48:51], v[232:235], v[64:67], v[48:51]
v_mfma_f32_16x16x32_bf16 v[48:51], v[236:239], v[68:71], v[48:51]
ds_read_b64_tr_b16 v[208:209], v241 offset:24576
v_mfma_f32_16x16x32_bf16 v[52:55], v[236:239], v[76:79], v[52:55]
ds_read_b64_tr_b16 v[210:211], v241 offset:30720
v_mfma_f32_16x16x32_bf16 v[52:55], v[232:235], v[72:75], v[52:55]
ds_read_b64_tr_b16 v[212:213], v241 offset:36864
v_mfma_f32_16x16x32_bf16 v[56:59], v[232:235], v[80:83], v[56:59]
ds_read_b64_tr_b16 v[214:215], v241 offset:43008
v_mfma_f32_16x16x32_bf16 v[56:59], v[236:239], v[84:87], v[56:59]
v_mfma_f32_16x16x32_bf16 v[60:63], v[236:239], v[92:95], v[60:63]
s_waitcnt vmcnt(16)
v_mfma_f32_16x16x32_bf16 v[60:63], v[232:235], v[88:91], v[60:63]
s_waitcnt lgkmcnt(8)
v_mfma_f32_16x16x32_bf16 a[0:3], v[192:195], v[96:99], a[0:3]
s_add_u32 m0, s68, 73728
ds_read_b64_tr_b16 v[216:217], v241 offset:24584
v_mfma_f32_16x16x32_bf16 a[0:3], v[196:199], v[100:103], a[0:3]
buffer_load_dwordx4 v247, s[12:15], s64 offen lds
v_mfma_f32_16x16x32_bf16 a[4:7], v[196:199], v[108:111], a[4:7]
ds_read_b64_tr_b16 v[218:219], v241 offset:30728
v_mfma_f32_16x16x32_bf16 a[4:7], v[192:195], v[104:107], a[4:7]
v_mfma_f32_16x16x32_bf16 a[8:11], v[192:195], v[112:115], a[8:11]
ds_read_b64_tr_b16 v[220:221], v241 offset:36872
v_mfma_f32_16x16x32_bf16 a[8:11], v[196:199], v[116:119], a[8:11]
v_mfma_f32_16x16x32_bf16 a[12:15], v[196:199], v[124:127], a[12:15]
ds_read_b64_tr_b16 v[222:223], v241 offset:43016
v_mfma_f32_16x16x32_bf16 a[12:15], v[192:195], v[120:123], a[12:15]
s_waitcnt lgkmcnt(8)
v_mfma_f32_16x16x32_bf16 a[16:19], v[200:203], v[96:99], a[16:19]
ds_read_b64_tr_b16 v[224:225], v240 offset:24704
buffer_load_dwordx4 v248, s[12:15], s64 offen offset:1024 lds
v_mfma_f32_16x16x32_bf16 a[16:19], v[204:207], v[100:103], a[16:19]
v_mfma_f32_16x16x32_bf16 a[20:23], v[204:207], v[108:111], a[20:23]
ds_read_b64_tr_b16 v[226:227], v240 offset:30848
v_mfma_f32_16x16x32_bf16 a[20:23], v[200:203], v[104:107], a[20:23]
v_mfma_f32_16x16x32_bf16 a[24:27], v[200:203], v[112:115], a[24:27]
ds_read_b64_tr_b16 v[228:229], v240 offset:36992
v_mfma_f32_16x16x32_bf16 a[24:27], v[204:207], v[116:119], a[24:27]
v_mfma_f32_16x16x32_bf16 a[28:31], v[204:207], v[124:127], a[28:31]
ds_read_b64_tr_b16 v[230:231], v240 offset:43136
v_mfma_f32_16x16x32_bf16 a[28:31], v[200:203], v[120:123], a[28:31]
s_waitcnt lgkmcnt(8)
v_mfma_f32_16x16x32_bf16 a[32:35], v[208:211], v[96:99], a[32:35]
ds_read_b64_tr_b16 v[232:233], v240 offset:24712
buffer_load_dwordx4 v249, s[12:15], s64 offen offset:2048 lds
v_mfma_f32_16x16x32_bf16 a[32:35], v[212:215], v[100:103], a[32:35]
s_add_u32 s64, s64, 98304
s_add_u32 m0, s68, 76800
v_mfma_f32_16x16x32_bf16 a[36:39], v[212:215], v[108:111], a[36:39]
ds_read_b64_tr_b16 v[234:235], v240 offset:30856
v_mfma_f32_16x16x32_bf16 a[36:39], v[208:211], v[104:107], a[36:39]
v_mfma_f32_16x16x32_bf16 a[40:43], v[208:211], v[112:115], a[40:43]
ds_read_b64_tr_b16 v[236:237], v240 offset:37000
v_mfma_f32_16x16x32_bf16 a[40:43], v[212:215], v[116:119], a[40:43]
v_mfma_f32_16x16x32_bf16 a[44:47], v[212:215], v[124:127], a[44:47]
ds_read_b64_tr_b16 v[238:239], v240 offset:43144
v_mfma_f32_16x16x32_bf16 a[44:47], v[208:211], v[120:123], a[44:47]
s_waitcnt lgkmcnt(8)
v_mfma_f32_16x16x32_bf16 a[48:51], v[216:219], v[96:99], a[48:51]
ds_read_b64_tr_b16 v[192:193], v241 offset:24704
buffer_load_dwordx4 v247, s[12:15], s64 offen lds
v_mfma_f32_16x16x32_bf16 a[48:51], v[220:223], v[100:103], a[48:51]
v_mfma_f32_16x16x32_bf16 a[52:55], v[220:223], v[108:111], a[52:55]
ds_read_b64_tr_b16 v[194:195], v241 offset:30848
v_mfma_f32_16x16x32_bf16 a[52:55], v[216:219], v[104:107], a[52:55]
v_mfma_f32_16x16x32_bf16 a[56:59], v[216:219], v[112:115], a[56:59]
ds_read_b64_tr_b16 v[196:197], v241 offset:36992
v_mfma_f32_16x16x32_bf16 a[56:59], v[220:223], v[116:119], a[56:59]
v_mfma_f32_16x16x32_bf16 a[60:63], v[220:223], v[124:127], a[60:63]
ds_read_b64_tr_b16 v[198:199], v241 offset:43136
v_mfma_f32_16x16x32_bf16 a[60:63], v[216:219], v[120:123], a[60:63]
s_waitcnt lgkmcnt(8)
v_mfma_f32_16x16x32_bf16 a[64:67], v[224:227], v[96:99], a[64:67]
ds_read_b64_tr_b16 v[200:201], v241 offset:24712
buffer_load_dwordx4 v248, s[12:15], s64 offen offset:1024 lds
v_mfma_f32_16x16x32_bf16 a[64:67], v[228:231], v[100:103], a[64:67]
v_mfma_f32_16x16x32_bf16 a[68:71], v[228:231], v[108:111], a[68:71]
ds_read_b64_tr_b16 v[202:203], v241 offset:30856
v_mfma_f32_16x16x32_bf16 a[68:71], v[224:227], v[104:107], a[68:71]
v_mfma_f32_16x16x32_bf16 a[72:75], v[224:227], v[112:115], a[72:75]
ds_read_b64_tr_b16 v[204:205], v241 offset:37000
v_mfma_f32_16x16x32_bf16 a[72:75], v[228:231], v[116:119], a[72:75]
v_mfma_f32_16x16x32_bf16 a[76:79], v[228:231], v[124:127], a[76:79]
ds_read_b64_tr_b16 v[206:207], v241 offset:43144
v_mfma_f32_16x16x32_bf16 a[76:79], v[224:227], v[120:123], a[76:79]
s_waitcnt lgkmcnt(8)
buffer_load_dwordx4 v249, s[12:15], s64 offen offset:2048 lds
v_mfma_f32_16x16x32_bf16 a[80:83], v[232:235], v[96:99], a[80:83]
s_add_u32 s64, s64, 688128
s_add_u32 m0, s61, 49152
ds_read_b64_tr_b16 v[208:209], v240 offset:24832
v_mfma_f32_16x16x32_bf16 a[80:83], v[236:239], v[100:103], a[80:83]
v_mfma_f32_16x16x32_bf16 a[84:87], v[236:239], v[108:111], a[84:87]
ds_read_b64_tr_b16 v[210:211], v240 offset:30976
v_mfma_f32_16x16x32_bf16 a[84:87], v[232:235], v[104:107], a[84:87]
v_mfma_f32_16x16x32_bf16 a[88:91], v[232:235], v[112:115], a[88:91]
ds_read_b64_tr_b16 v[212:213], v240 offset:37120
v_mfma_f32_16x16x32_bf16 a[88:91], v[236:239], v[116:119], a[88:91]
v_mfma_f32_16x16x32_bf16 a[92:95], v[236:239], v[124:127], a[92:95]
ds_read_b64_tr_b16 v[214:215], v240 offset:43264
v_mfma_f32_16x16x32_bf16 a[92:95], v[232:235], v[120:123], a[92:95]
s_waitcnt lgkmcnt(8)
buffer_load_dwordx4 v250, s[16:19], s65 offen lds
v_mfma_f32_16x16x32_bf16 a[96:99], v[192:195], v[96:99], a[96:99]
s_add_u32 s65, s65, 23552
ds_read_b64_tr_b16 v[216:217], v240 offset:24840
v_mfma_f32_16x16x32_bf16 a[96:99], v[196:199], v[100:103], a[96:99]
v_mfma_f32_16x16x32_bf16 a[100:103], v[196:199], v[108:111], a[100:103]
ds_read_b64_tr_b16 v[218:219], v240 offset:30984
v_mfma_f32_16x16x32_bf16 a[100:103], v[192:195], v[104:107], a[100:103]
v_mfma_f32_16x16x32_bf16 a[104:107], v[192:195], v[112:115], a[104:107]
ds_read_b64_tr_b16 v[220:221], v240 offset:37128
v_mfma_f32_16x16x32_bf16 a[104:107], v[196:199], v[116:119], a[104:107]
v_mfma_f32_16x16x32_bf16 a[108:111], v[196:199], v[124:127], a[108:111]
ds_read_b64_tr_b16 v[222:223], v240 offset:43272
v_mfma_f32_16x16x32_bf16 a[108:111], v[192:195], v[120:123], a[108:111]
s_waitcnt lgkmcnt(8)
buffer_load_dwordx4 v250, s[16:19], s65 offen offset:1024 lds
v_mfma_f32_16x16x32_bf16 a[112:115], v[200:203], v[96:99], a[112:115]
s_add_u32 s65, s65, 173056
ds_read_b64_tr_b16 v[224:225], v241 offset:24832
v_mfma_f32_16x16x32_bf16 a[112:115], v[204:207], v[100:103], a[112:115]
v_mfma_f32_16x16x32_bf16 a[116:119], v[204:207], v[108:111], a[116:119]
ds_read_b64_tr_b16 v[226:227], v241 offset:30976
v_mfma_f32_16x16x32_bf16 a[116:119], v[200:203], v[104:107], a[116:119]
v_mfma_f32_16x16x32_bf16 a[120:123], v[200:203], v[112:115], a[120:123]
ds_read_b64_tr_b16 v[228:229], v241 offset:37120
v_mfma_f32_16x16x32_bf16 a[120:123], v[204:207], v[116:119], a[120:123]
v_mfma_f32_16x16x32_bf16 a[124:127], v[204:207], v[124:127], a[124:127]
ds_read_b64_tr_b16 v[230:231], v241 offset:43264
v_mfma_f32_16x16x32_bf16 a[124:127], v[200:203], v[120:123], a[124:127]
s_waitcnt lgkmcnt(8)
buffer_load_dwordx4 v[64:67], v251, s[20:23], s66 offen sc1
v_mfma_f32_16x16x32_bf16 a[128:131], v[208:211], v[96:99], a[128:131]
ds_read_b64_tr_b16 v[232:233], v241 offset:24840
v_mfma_f32_16x16x32_bf16 a[128:131], v[212:215], v[100:103], a[128:131]
v_mfma_f32_16x16x32_bf16 a[132:135], v[212:215], v[108:111], a[132:135]
ds_read_b64_tr_b16 v[234:235], v241 offset:30984
v_mfma_f32_16x16x32_bf16 a[132:135], v[208:211], v[104:107], a[132:135]
v_mfma_f32_16x16x32_bf16 a[136:139], v[208:211], v[112:115], a[136:139]
ds_read_b64_tr_b16 v[236:237], v241 offset:37128
v_mfma_f32_16x16x32_bf16 a[136:139], v[212:215], v[116:119], a[136:139]
v_mfma_f32_16x16x32_bf16 a[140:143], v[212:215], v[124:127], a[140:143]
ds_read_b64_tr_b16 v[238:239], v241 offset:43272
buffer_load_dwordx4 v[68:71], v251, s[20:23], s66 offen offset:1024 sc1
v_mfma_f32_16x16x32_bf16 a[140:143], v[208:211], v[120:123], a[140:143]
s_waitcnt lgkmcnt(8)
v_mfma_f32_16x16x32_bf16 a[144:147], v[216:219], v[96:99], a[144:147]
ds_read_b64_tr_b16 v[192:193], v244 offset:8192
v_mfma_f32_16x16x32_bf16 a[144:147], v[220:223], v[100:103], a[144:147]
v_mfma_f32_16x16x32_bf16 a[148:151], v[220:223], v[108:111], a[148:151]
ds_read_b64_tr_b16 v[194:195], v244 offset:10240
v_mfma_f32_16x16x32_bf16 a[148:151], v[216:219], v[104:107], a[148:151]
v_mfma_f32_16x16x32_bf16 a[152:155], v[216:219], v[112:115], a[152:155]
ds_read_b64_tr_b16 v[196:197], v244 offset:12288
v_mfma_f32_16x16x32_bf16 a[152:155], v[220:223], v[116:119], a[152:155]
v_mfma_f32_16x16x32_bf16 a[156:159], v[220:223], v[124:127], a[156:159]
ds_read_b64_tr_b16 v[198:199], v244 offset:14336
buffer_load_dwordx4 v[72:75], v252, s[20:23], s66 offen sc1
v_mfma_f32_16x16x32_bf16 a[156:159], v[216:219], v[120:123], a[156:159]
s_waitcnt lgkmcnt(8)
v_mfma_f32_16x16x32_bf16 a[160:163], v[224:227], v[96:99], a[160:163]
ds_read_b64_tr_b16 v[200:201], v245 offset:8192
v_mfma_f32_16x16x32_bf16 a[160:163], v[228:231], v[100:103], a[160:163]
v_mfma_f32_16x16x32_bf16 a[164:167], v[228:231], v[108:111], a[164:167]
ds_read_b64_tr_b16 v[202:203], v245 offset:10240
v_mfma_f32_16x16x32_bf16 a[164:167], v[224:227], v[104:107], a[164:167]
v_mfma_f32_16x16x32_bf16 a[168:171], v[224:227], v[112:115], a[168:171]
ds_read_b64_tr_b16 v[204:205], v245 offset:12288
v_mfma_f32_16x16x32_bf16 a[168:171], v[228:231], v[116:119], a[168:171]
v_mfma_f32_16x16x32_bf16 a[172:175], v[228:231], v[124:127], a[172:175]
ds_read_b64_tr_b16 v[206:207], v245 offset:14336
buffer_load_dwordx4 v[76:79], v252, s[20:23], s66 offen offset:1024 sc1
v_mfma_f32_16x16x32_bf16 a[172:175], v[224:227], v[120:123], a[172:175]
s_waitcnt lgkmcnt(8)
v_mfma_f32_16x16x32_bf16 a[176:179], v[232:235], v[96:99], a[176:179]
ds_read_b64_tr_b16 v[208:209], v246 offset:8192
v_mfma_f32_16x16x32_bf16 a[176:179], v[236:239], v[100:103], a[176:179]
v_mfma_f32_16x16x32_bf16 a[180:183], v[236:239], v[108:111], a[180:183]
ds_read_b64_tr_b16 v[210:211], v246 offset:10240
v_mfma_f32_16x16x32_bf16 a[180:183], v[232:235], v[104:107], a[180:183]
v_mfma_f32_16x16x32_bf16 a[184:187], v[232:235], v[112:115], a[184:187]
ds_read_b64_tr_b16 v[212:213], v246 offset:12288
v_mfma_f32_16x16x32_bf16 a[184:187], v[236:239], v[116:119], a[184:187]
v_mfma_f32_16x16x32_bf16 a[188:191], v[236:239], v[124:127], a[188:191]
ds_read_b64_tr_b16 v[214:215], v246 offset:14336
buffer_load_dwordx4 v[80:83], v253, s[20:23], s66 offen sc1
v_mfma_f32_16x16x32_bf16 a[188:191], v[232:235], v[120:123], a[188:191]
s_waitcnt lgkmcnt(8)
v_mfma_f32_16x16x32_bf16 v[160:163], v[192:195], v[96:99], v[160:163]
ds_read_b64_tr_b16 v[216:217], v255 offset:8192
v_mfma_f32_16x16x32_bf16 v[160:163], v[196:199], v[100:103], v[160:163]
v_mfma_f32_16x16x32_bf16 v[164:167], v[196:199], v[108:111], v[164:167]
ds_read_b64_tr_b16 v[218:219], v255 offset:10240
v_mfma_f32_16x16x32_bf16 v[164:167], v[192:195], v[104:107], v[164:167]
v_mfma_f32_16x16x32_bf16 v[168:171], v[192:195], v[112:115], v[168:171]
ds_read_b64_tr_b16 v[220:221], v255 offset:12288
v_mfma_f32_16x16x32_bf16 v[168:171], v[196:199], v[116:119], v[168:171]
buffer_load_dwordx4 v[84:87], v253, s[20:23], s66 offen offset:1024 sc1
v_mfma_f32_16x16x32_bf16 v[172:175], v[196:199], v[124:127], v[172:175]
ds_read_b64_tr_b16 v[222:223], v255 offset:14336
v_mfma_f32_16x16x32_bf16 v[172:175], v[192:195], v[120:123], v[172:175]
s_waitcnt lgkmcnt(8)
v_mfma_f32_16x16x32_bf16 v[176:179], v[200:203], v[96:99], v[176:179]
v_mfma_f32_16x16x32_bf16 v[176:179], v[204:207], v[100:103], v[176:179]
v_mfma_f32_16x16x32_bf16 v[180:183], v[204:207], v[108:111], v[180:183]
v_mfma_f32_16x16x32_bf16 v[180:183], v[200:203], v[104:107], v[180:183]
v_mfma_f32_16x16x32_bf16 v[184:187], v[200:203], v[112:115], v[184:187]
v_mfma_f32_16x16x32_bf16 v[184:187], v[204:207], v[116:119], v[184:187]
buffer_load_dwordx4 v[88:91], v254, s[20:23], s66 offen sc1
v_mfma_f32_16x16x32_bf16 v[188:191], v[204:207], v[124:127], v[188:191]
s_waitcnt vmcnt(23) lgkmcnt(0)
s_barrier
v_mfma_f32_16x16x32_bf16 v[188:191], v[200:203], v[120:123], v[188:191]
s_waitcnt lgkmcnt(0)
ds_read_b64_tr_b16 v[224:225], v242
v_mfma_f32_16x16x32_bf16 v[16:19], v[208:211], v[96:99], v[16:19]
ds_read_b64_tr_b16 v[226:227], v242 offset:6144
v_mfma_f32_16x16x32_bf16 v[16:19], v[212:215], v[100:103], v[16:19]
ds_read_b64_tr_b16 v[228:229], v242 offset:12288
v_mfma_f32_16x16x32_bf16 v[20:23], v[212:215], v[108:111], v[20:23]
ds_read_b64_tr_b16 v[230:231], v242 offset:18432
v_mfma_f32_16x16x32_bf16 v[20:23], v[208:211], v[104:107], v[20:23]
v_mfma_f32_16x16x32_bf16 v[24:27], v[208:211], v[112:115], v[24:27]
ds_read_b64_tr_b16 v[232:233], v242 offset:8
v_mfma_f32_16x16x32_bf16 v[24:27], v[212:215], v[116:119], v[24:27]
ds_read_b64_tr_b16 v[234:235], v242 offset:6152
buffer_load_dwordx4 v[92:95], v254, s[20:23], s66 offen offset:1024 sc1
v_mfma_f32_16x16x32_bf16 v[28:31], v[212:215], v[124:127], v[28:31]
s_add_u32 s66, s66, 2048
ds_read_b64_tr_b16 v[236:237], v242 offset:12296
v_mfma_f32_16x16x32_bf16 v[28:31], v[208:211], v[120:123], v[28:31]
s_waitcnt lgkmcnt(7)
ds_read_b64_tr_b16 v[238:239], v242 offset:18440
v_mfma_f32_16x16x32_bf16 v[48:51], v[216:219], v[96:99], v[48:51]
v_mfma_f32_16x16x32_bf16 v[48:51], v[220:223], v[100:103], v[48:51]
ds_read_b64_tr_b16 v[192:193], v243
v_mfma_f32_16x16x32_bf16 v[52:55], v[220:223], v[108:111], v[52:55]
ds_read_b64_tr_b16 v[194:195], v243 offset:6144
v_mfma_f32_16x16x32_bf16 v[52:55], v[216:219], v[104:107], v[52:55]
ds_read_b64_tr_b16 v[196:197], v243 offset:12288
v_mfma_f32_16x16x32_bf16 v[56:59], v[216:219], v[112:115], v[56:59]
ds_read_b64_tr_b16 v[198:199], v243 offset:18432
v_mfma_f32_16x16x32_bf16 v[56:59], v[220:223], v[116:119], v[56:59]
v_mfma_f32_16x16x32_bf16 v[60:63], v[220:223], v[124:127], v[60:63]
s_waitcnt vmcnt(16)
v_mfma_f32_16x16x32_bf16 v[60:63], v[216:219], v[120:123], v[60:63]
s_waitcnt lgkmcnt(8)
v_mfma_f32_16x16x32_bf16 a[0:3], v[224:227], v[128:131], a[0:3]
s_add_u32 m0, s68, 98304
ds_read_b64_tr_b16 v[200:201], v243 offset:8
v_mfma_f32_16x16x32_bf16 a[0:3], v[228:231], v[132:135], a[0:3]
buffer_load_dwordx4 v247, s[12:15], s64 offen lds
v_mfma_f32_16x16x32_bf16 a[4:7], v[228:231], v[140:143], a[4:7]
ds_read_b64_tr_b16 v[202:203], v243 offset:6152
v_mfma_f32_16x16x32_bf16 a[4:7], v[224:227], v[136:139], a[4:7]
v_mfma_f32_16x16x32_bf16 a[8:11], v[224:227], v[144:147], a[8:11]
ds_read_b64_tr_b16 v[204:205], v243 offset:12296
v_mfma_f32_16x16x32_bf16 a[8:11], v[228:231], v[148:151], a[8:11]
v_mfma_f32_16x16x32_bf16 a[12:15], v[228:231], v[156:159], a[12:15]
ds_read_b64_tr_b16 v[206:207], v243 offset:18440
v_mfma_f32_16x16x32_bf16 a[12:15], v[224:227], v[152:155], a[12:15]
s_waitcnt lgkmcnt(8)
v_mfma_f32_16x16x32_bf16 a[16:19], v[232:235], v[128:131], a[16:19]
ds_read_b64_tr_b16 v[208:209], v242 offset:128
buffer_load_dwordx4 v248, s[12:15], s64 offen offset:1024 lds
v_mfma_f32_16x16x32_bf16 a[16:19], v[236:239], v[132:135], a[16:19]
v_mfma_f32_16x16x32_bf16 a[20:23], v[236:239], v[140:143], a[20:23]
ds_read_b64_tr_b16 v[210:211], v242 offset:6272
v_mfma_f32_16x16x32_bf16 a[20:23], v[232:235], v[136:139], a[20:23]
v_mfma_f32_16x16x32_bf16 a[24:27], v[232:235], v[144:147], a[24:27]
ds_read_b64_tr_b16 v[212:213], v242 offset:12416
v_mfma_f32_16x16x32_bf16 a[24:27], v[236:239], v[148:151], a[24:27]
v_mfma_f32_16x16x32_bf16 a[28:31], v[236:239], v[156:159], a[28:31]
ds_read_b64_tr_b16 v[214:215], v242 offset:18560
v_mfma_f32_16x16x32_bf16 a[28:31], v[232:235], v[152:155], a[28:31]
s_waitcnt lgkmcnt(8)
v_mfma_f32_16x16x32_bf16 a[32:35], v[192:195], v[128:131], a[32:35]
ds_read_b64_tr_b16 v[216:217], v242 offset:136
buffer_load_dwordx4 v249, s[12:15], s64 offen offset:2048 lds
v_mfma_f32_16x16x32_bf16 a[32:35], v[196:199], v[132:135], a[32:35]
s_add_u32 s64, s64, 98304
s_add_u32 m0, s68, 101376
v_mfma_f32_16x16x32_bf16 a[36:39], v[196:199], v[140:143], a[36:39]
ds_read_b64_tr_b16 v[218:219], v242 offset:6280
v_mfma_f32_16x16x32_bf16 a[36:39], v[192:195], v[136:139], a[36:39]
v_mfma_f32_16x16x32_bf16 a[40:43], v[192:195], v[144:147], a[40:43]
ds_read_b64_tr_b16 v[220:221], v242 offset:12424
v_mfma_f32_16x16x32_bf16 a[40:43], v[196:199], v[148:151], a[40:43]
v_mfma_f32_16x16x32_bf16 a[44:47], v[196:199], v[156:159], a[44:47]
ds_read_b64_tr_b16 v[222:223], v242 offset:18568
v_mfma_f32_16x16x32_bf16 a[44:47], v[192:195], v[152:155], a[44:47]
s_waitcnt lgkmcnt(8)
v_mfma_f32_16x16x32_bf16 a[48:51], v[200:203], v[128:131], a[48:51]
ds_read_b64_tr_b16 v[224:225], v243 offset:128
buffer_load_dwordx4 v247, s[12:15], s64 offen lds
v_mfma_f32_16x16x32_bf16 a[48:51], v[204:207], v[132:135], a[48:51]
v_mfma_f32_16x16x32_bf16 a[52:55], v[204:207], v[140:143], a[52:55]
ds_read_b64_tr_b16 v[226:227], v243 offset:6272
v_mfma_f32_16x16x32_bf16 a[52:55], v[200:203], v[136:139], a[52:55]
v_mfma_f32_16x16x32_bf16 a[56:59], v[200:203], v[144:147], a[56:59]
ds_read_b64_tr_b16 v[228:229], v243 offset:12416
v_mfma_f32_16x16x32_bf16 a[56:59], v[204:207], v[148:151], a[56:59]
v_mfma_f32_16x16x32_bf16 a[60:63], v[204:207], v[156:159], a[60:63]
ds_read_b64_tr_b16 v[230:231], v243 offset:18560
v_mfma_f32_16x16x32_bf16 a[60:63], v[200:203], v[152:155], a[60:63]
s_waitcnt lgkmcnt(8)
v_mfma_f32_16x16x32_bf16 a[64:67], v[208:211], v[128:131], a[64:67]
ds_read_b64_tr_b16 v[232:233], v243 offset:136
buffer_load_dwordx4 v248, s[12:15], s64 offen offset:1024 lds
v_mfma_f32_16x16x32_bf16 a[64:67], v[212:215], v[132:135], a[64:67]
v_mfma_f32_16x16x32_bf16 a[68:71], v[212:215], v[140:143], a[68:71]
ds_read_b64_tr_b16 v[234:235], v243 offset:6280
v_mfma_f32_16x16x32_bf16 a[68:71], v[208:211], v[136:139], a[68:71]
v_mfma_f32_16x16x32_bf16 a[72:75], v[208:211], v[144:147], a[72:75]
ds_read_b64_tr_b16 v[236:237], v243 offset:12424
v_mfma_f32_16x16x32_bf16 a[72:75], v[212:215], v[148:151], a[72:75]
v_mfma_f32_16x16x32_bf16 a[76:79], v[212:215], v[156:159], a[76:79]
ds_read_b64_tr_b16 v[238:239], v243 offset:18568
v_mfma_f32_16x16x32_bf16 a[76:79], v[208:211], v[152:155], a[76:79]
s_waitcnt lgkmcnt(8)
buffer_load_dwordx4 v249, s[12:15], s64 offen offset:2048 lds
v_mfma_f32_16x16x32_bf16 a[80:83], v[216:219], v[128:131], a[80:83]
s_add_u32 s64, s64, 688128
s_add_u32 m0, s61, 57344
ds_read_b64_tr_b16 v[192:193], v242 offset:256
v_mfma_f32_16x16x32_bf16 a[80:83], v[220:223], v[132:135], a[80:83]
v_mfma_f32_16x16x32_bf16 a[84:87], v[220:223], v[140:143], a[84:87]
ds_read_b64_tr_b16 v[194:195], v242 offset:6400
v_mfma_f32_16x16x32_bf16 a[84:87], v[216:219], v[136:139], a[84:87]
v_mfma_f32_16x16x32_bf16 a[88:91], v[216:219], v[144:147], a[88:91]
ds_read_b64_tr_b16 v[196:197], v242 offset:12544
v_mfma_f32_16x16x32_bf16 a[88:91], v[220:223], v[148:151], a[88:91]
v_mfma_f32_16x16x32_bf16 a[92:95], v[220:223], v[156:159], a[92:95]
ds_read_b64_tr_b16 v[198:199], v242 offset:18688
v_mfma_f32_16x16x32_bf16 a[92:95], v[216:219], v[152:155], a[92:95]
s_waitcnt lgkmcnt(8)
buffer_load_dwordx4 v250, s[16:19], s65 offen lds
v_mfma_f32_16x16x32_bf16 a[96:99], v[224:227], v[128:131], a[96:99]
s_add_u32 s65, s65, 23552
ds_read_b64_tr_b16 v[200:201], v242 offset:264
v_mfma_f32_16x16x32_bf16 a[96:99], v[228:231], v[132:135], a[96:99]
v_mfma_f32_16x16x32_bf16 a[100:103], v[228:231], v[140:143], a[100:103]
ds_read_b64_tr_b16 v[202:203], v242 offset:6408
v_mfma_f32_16x16x32_bf16 a[100:103], v[224:227], v[136:139], a[100:103]
v_mfma_f32_16x16x32_bf16 a[104:107], v[224:227], v[144:147], a[104:107]
ds_read_b64_tr_b16 v[204:205], v242 offset:12552
v_mfma_f32_16x16x32_bf16 a[104:107], v[228:231], v[148:151], a[104:107]
v_mfma_f32_16x16x32_bf16 a[108:111], v[228:231], v[156:159], a[108:111]
ds_read_b64_tr_b16 v[206:207], v242 offset:18696
v_mfma_f32_16x16x32_bf16 a[108:111], v[224:227], v[152:155], a[108:111]
s_waitcnt lgkmcnt(8)
buffer_load_dwordx4 v250, s[16:19], s65 offen offset:1024 lds
v_mfma_f32_16x16x32_bf16 a[112:115], v[232:235], v[128:131], a[112:115]
s_add_u32 s65, s65, 173056
ds_read_b64_tr_b16 v[208:209], v243 offset:256
v_mfma_f32_16x16x32_bf16 a[112:115], v[236:239], v[132:135], a[112:115]
v_mfma_f32_16x16x32_bf16 a[116:119], v[236:239], v[140:143], a[116:119]
ds_read_b64_tr_b16 v[210:211], v243 offset:6400
v_mfma_f32_16x16x32_bf16 a[116:119], v[232:235], v[136:139], a[116:119]
v_mfma_f32_16x16x32_bf16 a[120:123], v[232:235], v[144:147], a[120:123]
ds_read_b64_tr_b16 v[212:213], v243 offset:12544
v_mfma_f32_16x16x32_bf16 a[120:123], v[236:239], v[148:151], a[120:123]
v_mfma_f32_16x16x32_bf16 a[124:127], v[236:239], v[156:159], a[124:127]
ds_read_b64_tr_b16 v[214:215], v243 offset:18688
v_mfma_f32_16x16x32_bf16 a[124:127], v[232:235], v[152:155], a[124:127]
s_waitcnt lgkmcnt(8)
buffer_load_dwordx4 v[96:99], v251, s[20:23], s66 offen sc1
v_mfma_f32_16x16x32_bf16 a[128:131], v[192:195], v[128:131], a[128:131]
ds_read_b64_tr_b16 v[216:217], v243 offset:264
v_mfma_f32_16x16x32_bf16 a[128:131], v[196:199], v[132:135], a[128:131]
v_mfma_f32_16x16x32_bf16 a[132:135], v[196:199], v[140:143], a[132:135]
ds_read_b64_tr_b16 v[218:219], v243 offset:6408
v_mfma_f32_16x16x32_bf16 a[132:135], v[192:195], v[136:139], a[132:135]
v_mfma_f32_16x16x32_bf16 a[136:139], v[192:195], v[144:147], a[136:139]
ds_read_b64_tr_b16 v[220:221], v243 offset:12552
v_mfma_f32_16x16x32_bf16 a[136:139], v[196:199], v[148:151], a[136:139]
v_mfma_f32_16x16x32_bf16 a[140:143], v[196:199], v[156:159], a[140:143]
ds_read_b64_tr_b16 v[222:223], v243 offset:18696
buffer_load_dwordx4 v[100:103], v251, s[20:23], s66 offen offset:1024 sc1
v_mfma_f32_16x16x32_bf16 a[140:143], v[192:195], v[152:155], a[140:143]
s_waitcnt lgkmcnt(8)
v_mfma_f32_16x16x32_bf16 a[144:147], v[200:203], v[128:131], a[144:147]
ds_read_b64_tr_b16 v[224:225], v244 offset:16384
v_mfma_f32_16x16x32_bf16 a[144:147], v[204:207], v[132:135], a[144:147]
v_mfma_f32_16x16x32_bf16 a[148:151], v[204:207], v[140:143], a[148:151]
ds_read_b64_tr_b16 v[226:227], v244 offset:18432
v_mfma_f32_16x16x32_bf16 a[148:151], v[200:203], v[136:139], a[148:151]
v_mfma_f32_16x16x32_bf16 a[152:155], v[200:203], v[144:147], a[152:155]
ds_read_b64_tr_b16 v[228:229], v244 offset:20480
v_mfma_f32_16x16x32_bf16 a[152:155], v[204:207], v[148:151], a[152:155]
v_mfma_f32_16x16x32_bf16 a[156:159], v[204:207], v[156:159], a[156:159]
ds_read_b64_tr_b16 v[230:231], v244 offset:22528
buffer_load_dwordx4 v[104:107], v252, s[20:23], s66 offen sc1
v_mfma_f32_16x16x32_bf16 a[156:159], v[200:203], v[152:155], a[156:159]
s_waitcnt lgkmcnt(8)
v_mfma_f32_16x16x32_bf16 a[160:163], v[208:211], v[128:131], a[160:163]
ds_read_b64_tr_b16 v[232:233], v245 offset:16384
v_mfma_f32_16x16x32_bf16 a[160:163], v[212:215], v[132:135], a[160:163]
v_mfma_f32_16x16x32_bf16 a[164:167], v[212:215], v[140:143], a[164:167]
ds_read_b64_tr_b16 v[234:235], v245 offset:18432
v_mfma_f32_16x16x32_bf16 a[164:167], v[208:211], v[136:139], a[164:167]
v_mfma_f32_16x16x32_bf16 a[168:171], v[208:211], v[144:147], a[168:171]
ds_read_b64_tr_b16 v[236:237], v245 offset:20480
v_mfma_f32_16x16x32_bf16 a[168:171], v[212:215], v[148:151], a[168:171]
v_mfma_f32_16x16x32_bf16 a[172:175], v[212:215], v[156:159], a[172:175]
ds_read_b64_tr_b16 v[238:239], v245 offset:22528
buffer_load_dwordx4 v[108:111], v252, s[20:23], s66 offen offset:1024 sc1
v_mfma_f32_16x16x32_bf16 a[172:175], v[208:211], v[152:155], a[172:175]
s_waitcnt lgkmcnt(8)
v_mfma_f32_16x16x32_bf16 a[176:179], v[216:219], v[128:131], a[176:179]
ds_read_b64_tr_b16 v[192:193], v246 offset:16384
v_mfma_f32_16x16x32_bf16 a[176:179], v[220:223], v[132:135], a[176:179]
v_mfma_f32_16x16x32_bf16 a[180:183], v[220:223], v[140:143], a[180:183]
ds_read_b64_tr_b16 v[194:195], v246 offset:18432
v_mfma_f32_16x16x32_bf16 a[180:183], v[216:219], v[136:139], a[180:183]
v_mfma_f32_16x16x32_bf16 a[184:187], v[216:219], v[144:147], a[184:187]
ds_read_b64_tr_b16 v[196:197], v246 offset:20480
v_mfma_f32_16x16x32_bf16 a[184:187], v[220:223], v[148:151], a[184:187]
v_mfma_f32_16x16x32_bf16 a[188:191], v[220:223], v[156:159], a[188:191]
ds_read_b64_tr_b16 v[198:199], v246 offset:22528
buffer_load_dwordx4 v[112:115], v253, s[20:23], s66 offen sc1
v_mfma_f32_16x16x32_bf16 a[188:191], v[216:219], v[152:155], a[188:191]
s_waitcnt lgkmcnt(8)
v_mfma_f32_16x16x32_bf16 v[160:163], v[224:227], v[128:131], v[160:163]
ds_read_b64_tr_b16 v[200:201], v255 offset:16384
v_mfma_f32_16x16x32_bf16 v[160:163], v[228:231], v[132:135], v[160:163]
v_mfma_f32_16x16x32_bf16 v[164:167], v[228:231], v[140:143], v[164:167]
ds_read_b64_tr_b16 v[202:203], v255 offset:18432
v_mfma_f32_16x16x32_bf16 v[164:167], v[224:227], v[136:139], v[164:167]
v_mfma_f32_16x16x32_bf16 v[168:171], v[224:227], v[144:147], v[168:171]
ds_read_b64_tr_b16 v[204:205], v255 offset:20480
v_mfma_f32_16x16x32_bf16 v[168:171], v[228:231], v[148:151], v[168:171]
buffer_load_dwordx4 v[116:119], v253, s[20:23], s66 offen offset:1024 sc1
v_mfma_f32_16x16x32_bf16 v[172:175], v[228:231], v[156:159], v[172:175]
ds_read_b64_tr_b16 v[206:207], v255 offset:22528
v_mfma_f32_16x16x32_bf16 v[172:175], v[224:227], v[152:155], v[172:175]
s_waitcnt lgkmcnt(8)
v_mfma_f32_16x16x32_bf16 v[176:179], v[232:235], v[128:131], v[176:179]
v_mfma_f32_16x16x32_bf16 v[176:179], v[236:239], v[132:135], v[176:179]
v_mfma_f32_16x16x32_bf16 v[180:183], v[236:239], v[140:143], v[180:183]
v_mfma_f32_16x16x32_bf16 v[180:183], v[232:235], v[136:139], v[180:183]
v_mfma_f32_16x16x32_bf16 v[184:187], v[232:235], v[144:147], v[184:187]
v_mfma_f32_16x16x32_bf16 v[184:187], v[236:239], v[148:151], v[184:187]
buffer_load_dwordx4 v[120:123], v254, s[20:23], s66 offen sc1
v_mfma_f32_16x16x32_bf16 v[188:191], v[236:239], v[156:159], v[188:191]
s_waitcnt vmcnt(23) lgkmcnt(0)
s_barrier
v_mfma_f32_16x16x32_bf16 v[188:191], v[232:235], v[152:155], v[188:191]
s_waitcnt lgkmcnt(0)
ds_read_b64_tr_b16 v[208:209], v240
v_mfma_f32_16x16x32_bf16 v[16:19], v[192:195], v[128:131], v[16:19]
ds_read_b64_tr_b16 v[210:211], v240 offset:6144
v_mfma_f32_16x16x32_bf16 v[16:19], v[196:199], v[132:135], v[16:19]
ds_read_b64_tr_b16 v[212:213], v240 offset:12288
v_mfma_f32_16x16x32_bf16 v[20:23], v[196:199], v[140:143], v[20:23]
ds_read_b64_tr_b16 v[214:215], v240 offset:18432
v_mfma_f32_16x16x32_bf16 v[20:23], v[192:195], v[136:139], v[20:23]
v_mfma_f32_16x16x32_bf16 v[24:27], v[192:195], v[144:147], v[24:27]
ds_read_b64_tr_b16 v[216:217], v240 offset:8
v_mfma_f32_16x16x32_bf16 v[24:27], v[196:199], v[148:151], v[24:27]
ds_read_b64_tr_b16 v[218:219], v240 offset:6152
buffer_load_dwordx4 v[124:127], v254, s[20:23], s66 offen offset:1024 sc1
v_mfma_f32_16x16x32_bf16 v[28:31], v[196:199], v[156:159], v[28:31]
s_add_u32 s66, s66, 2048
ds_read_b64_tr_b16 v[220:221], v240 offset:12296
v_mfma_f32_16x16x32_bf16 v[28:31], v[192:195], v[152:155], v[28:31]
s_waitcnt lgkmcnt(7)
ds_read_b64_tr_b16 v[222:223], v240 offset:18440
v_mfma_f32_16x16x32_bf16 v[48:51], v[200:203], v[128:131], v[48:51]
v_mfma_f32_16x16x32_bf16 v[48:51], v[204:207], v[132:135], v[48:51]
ds_read_b64_tr_b16 v[224:225], v241
v_mfma_f32_16x16x32_bf16 v[52:55], v[204:207], v[140:143], v[52:55]
ds_read_b64_tr_b16 v[226:227], v241 offset:6144
v_mfma_f32_16x16x32_bf16 v[52:55], v[200:203], v[136:139], v[52:55]
ds_read_b64_tr_b16 v[228:229], v241 offset:12288
v_mfma_f32_16x16x32_bf16 v[56:59], v[200:203], v[144:147], v[56:59]
ds_read_b64_tr_b16 v[230:231], v241 offset:18432
v_mfma_f32_16x16x32_bf16 v[56:59], v[204:207], v[148:151], v[56:59]
v_mfma_f32_16x16x32_bf16 v[60:63], v[204:207], v[156:159], v[60:63]
s_waitcnt vmcnt(16)
v_mfma_f32_16x16x32_bf16 v[60:63], v[200:203], v[152:155], v[60:63]
s_waitcnt lgkmcnt(8)
v_mfma_f32_16x16x32_bf16 a[0:3], v[208:211], v[64:67], a[0:3]
s_add_u32 m0, s68, 122880
ds_read_b64_tr_b16 v[232:233], v241 offset:8
v_mfma_f32_16x16x32_bf16 a[0:3], v[212:215], v[68:71], a[0:3]
buffer_load_dwordx4 v247, s[12:15], s64 offen lds
v_mfma_f32_16x16x32_bf16 a[4:7], v[212:215], v[76:79], a[4:7]
ds_read_b64_tr_b16 v[234:235], v241 offset:6152
v_mfma_f32_16x16x32_bf16 a[4:7], v[208:211], v[72:75], a[4:7]
v_mfma_f32_16x16x32_bf16 a[8:11], v[208:211], v[80:83], a[8:11]
ds_read_b64_tr_b16 v[236:237], v241 offset:12296
v_mfma_f32_16x16x32_bf16 a[8:11], v[212:215], v[84:87], a[8:11]
v_mfma_f32_16x16x32_bf16 a[12:15], v[212:215], v[92:95], a[12:15]
ds_read_b64_tr_b16 v[238:239], v241 offset:18440
v_mfma_f32_16x16x32_bf16 a[12:15], v[208:211], v[88:91], a[12:15]
s_waitcnt lgkmcnt(8)
v_mfma_f32_16x16x32_bf16 a[16:19], v[216:219], v[64:67], a[16:19]
ds_read_b64_tr_b16 v[192:193], v240 offset:128
buffer_load_dwordx4 v248, s[12:15], s64 offen offset:1024 lds
v_mfma_f32_16x16x32_bf16 a[16:19], v[220:223], v[68:71], a[16:19]
v_mfma_f32_16x16x32_bf16 a[20:23], v[220:223], v[76:79], a[20:23]
ds_read_b64_tr_b16 v[194:195], v240 offset:6272
v_mfma_f32_16x16x32_bf16 a[20:23], v[216:219], v[72:75], a[20:23]
v_mfma_f32_16x16x32_bf16 a[24:27], v[216:219], v[80:83], a[24:27]
ds_read_b64_tr_b16 v[196:197], v240 offset:12416
v_mfma_f32_16x16x32_bf16 a[24:27], v[220:223], v[84:87], a[24:27]
v_mfma_f32_16x16x32_bf16 a[28:31], v[220:223], v[92:95], a[28:31]
ds_read_b64_tr_b16 v[198:199], v240 offset:18560
v_mfma_f32_16x16x32_bf16 a[28:31], v[216:219], v[88:91], a[28:31]
s_waitcnt lgkmcnt(8)
v_mfma_f32_16x16x32_bf16 a[32:35], v[224:227], v[64:67], a[32:35]
ds_read_b64_tr_b16 v[200:201], v240 offset:136
buffer_load_dwordx4 v249, s[12:15], s64 offen offset:2048 lds
v_mfma_f32_16x16x32_bf16 a[32:35], v[228:231], v[68:71], a[32:35]
s_add_u32 s64, s64, 98304
s_add_u32 m0, s68, 125952
v_mfma_f32_16x16x32_bf16 a[36:39], v[228:231], v[76:79], a[36:39]
ds_read_b64_tr_b16 v[202:203], v240 offset:6280
v_mfma_f32_16x16x32_bf16 a[36:39], v[224:227], v[72:75], a[36:39]
v_mfma_f32_16x16x32_bf16 a[40:43], v[224:227], v[80:83], a[40:43]
ds_read_b64_tr_b16 v[204:205], v240 offset:12424
v_mfma_f32_16x16x32_bf16 a[40:43], v[228:231], v[84:87], a[40:43]
v_mfma_f32_16x16x32_bf16 a[44:47], v[228:231], v[92:95], a[44:47]
ds_read_b64_tr_b16 v[206:207], v240 offset:18568
v_mfma_f32_16x16x32_bf16 a[44:47], v[224:227], v[88:91], a[44:47]
s_waitcnt lgkmcnt(8)
v_mfma_f32_16x16x32_bf16 a[48:51], v[232:235], v[64:67], a[48:51]
ds_read_b64_tr_b16 v[208:209], v241 offset:128
buffer_load_dwordx4 v247, s[12:15], s64 offen lds
v_mfma_f32_16x16x32_bf16 a[48:51], v[236:239], v[68:71], a[48:51]
v_mfma_f32_16x16x32_bf16 a[52:55], v[236:239], v[76:79], a[52:55]
ds_read_b64_tr_b16 v[210:211], v241 offset:6272
v_mfma_f32_16x16x32_bf16 a[52:55], v[232:235], v[72:75], a[52:55]
v_mfma_f32_16x16x32_bf16 a[56:59], v[232:235], v[80:83], a[56:59]
ds_read_b64_tr_b16 v[212:213], v241 offset:12416
v_mfma_f32_16x16x32_bf16 a[56:59], v[236:239], v[84:87], a[56:59]
v_mfma_f32_16x16x32_bf16 a[60:63], v[236:239], v[92:95], a[60:63]
ds_read_b64_tr_b16 v[214:215], v241 offset:18560
v_mfma_f32_16x16x32_bf16 a[60:63], v[232:235], v[88:91], a[60:63]
s_waitcnt lgkmcnt(8)
v_mfma_f32_16x16x32_bf16 a[64:67], v[192:195], v[64:67], a[64:67]
ds_read_b64_tr_b16 v[216:217], v241 offset:136
buffer_load_dwordx4 v248, s[12:15], s64 offen offset:1024 lds
v_mfma_f32_16x16x32_bf16 a[64:67], v[196:199], v[68:71], a[64:67]
v_mfma_f32_16x16x32_bf16 a[68:71], v[196:199], v[76:79], a[68:71]
ds_read_b64_tr_b16 v[218:219], v241 offset:6280
v_mfma_f32_16x16x32_bf16 a[68:71], v[192:195], v[72:75], a[68:71]
v_mfma_f32_16x16x32_bf16 a[72:75], v[192:195], v[80:83], a[72:75]
ds_read_b64_tr_b16 v[220:221], v241 offset:12424
v_mfma_f32_16x16x32_bf16 a[72:75], v[196:199], v[84:87], a[72:75]
v_mfma_f32_16x16x32_bf16 a[76:79], v[196:199], v[92:95], a[76:79]
ds_read_b64_tr_b16 v[222:223], v241 offset:18568
v_mfma_f32_16x16x32_bf16 a[76:79], v[192:195], v[88:91], a[76:79]
s_waitcnt lgkmcnt(8)
buffer_load_dwordx4 v249, s[12:15], s64 offen offset:2048 lds
v_mfma_f32_16x16x32_bf16 a[80:83], v[200:203], v[64:67], a[80:83]
s_add_u32 s64, s64, 688128
s_add_u32 m0, s61, 65536
ds_read_b64_tr_b16 v[224:225], v240 offset:256
v_mfma_f32_16x16x32_bf16 a[80:83], v[204:207], v[68:71], a[80:83]
v_mfma_f32_16x16x32_bf16 a[84:87], v[204:207], v[76:79], a[84:87]
ds_read_b64_tr_b16 v[226:227], v240 offset:6400
v_mfma_f32_16x16x32_bf16 a[84:87], v[200:203], v[72:75], a[84:87]
v_mfma_f32_16x16x32_bf16 a[88:91], v[200:203], v[80:83], a[88:91]
ds_read_b64_tr_b16 v[228:229], v240 offset:12544
v_mfma_f32_16x16x32_bf16 a[88:91], v[204:207], v[84:87], a[88:91]
v_mfma_f32_16x16x32_bf16 a[92:95], v[204:207], v[92:95], a[92:95]
ds_read_b64_tr_b16 v[230:231], v240 offset:18688
v_mfma_f32_16x16x32_bf16 a[92:95], v[200:203], v[88:91], a[92:95]
s_waitcnt lgkmcnt(8)
buffer_load_dwordx4 v250, s[16:19], s65 offen lds
v_mfma_f32_16x16x32_bf16 a[96:99], v[208:211], v[64:67], a[96:99]
s_add_u32 s65, s65, 23552
ds_read_b64_tr_b16 v[232:233], v240 offset:264
v_mfma_f32_16x16x32_bf16 a[96:99], v[212:215], v[68:71], a[96:99]
v_mfma_f32_16x16x32_bf16 a[100:103], v[212:215], v[76:79], a[100:103]
ds_read_b64_tr_b16 v[234:235], v240 offset:6408
v_mfma_f32_16x16x32_bf16 a[100:103], v[208:211], v[72:75], a[100:103]
v_mfma_f32_16x16x32_bf16 a[104:107], v[208:211], v[80:83], a[104:107]
ds_read_b64_tr_b16 v[236:237], v240 offset:12552
v_mfma_f32_16x16x32_bf16 a[104:107], v[212:215], v[84:87], a[104:107]
v_mfma_f32_16x16x32_bf16 a[108:111], v[212:215], v[92:95], a[108:111]
ds_read_b64_tr_b16 v[238:239], v240 offset:18696
v_mfma_f32_16x16x32_bf16 a[108:111], v[208:211], v[88:91], a[108:111]
s_waitcnt lgkmcnt(8)
buffer_load_dwordx4 v250, s[16:19], s65 offen offset:1024 lds
v_mfma_f32_16x16x32_bf16 a[112:115], v[216:219], v[64:67], a[112:115]
s_add_u32 s65, s65, 173056
ds_read_b64_tr_b16 v[192:193], v241 offset:256
v_mfma_f32_16x16x32_bf16 a[112:115], v[220:223], v[68:71], a[112:115]
v_mfma_f32_16x16x32_bf16 a[116:119], v[220:223], v[76:79], a[116:119]
ds_read_b64_tr_b16 v[194:195], v241 offset:6400
v_mfma_f32_16x16x32_bf16 a[116:119], v[216:219], v[72:75], a[116:119]
v_mfma_f32_16x16x32_bf16 a[120:123], v[216:219], v[80:83], a[120:123]
ds_read_b64_tr_b16 v[196:197], v241 offset:12544
v_mfma_f32_16x16x32_bf16 a[120:123], v[220:223], v[84:87], a[120:123]
v_mfma_f32_16x16x32_bf16 a[124:127], v[220:223], v[92:95], a[124:127]
ds_read_b64_tr_b16 v[198:199], v241 offset:18688
v_mfma_f32_16x16x32_bf16 a[124:127], v[216:219], v[88:91], a[124:127]
s_waitcnt lgkmcnt(8)
buffer_load_dwordx4 v[128:131], v251, s[20:23], s66 offen sc1
v_mfma_f32_16x16x32_bf16 a[128:131], v[224:227], v[64:67], a[128:131]
ds_read_b64_tr_b16 v[200:201], v241 offset:264
v_mfma_f32_16x16x32_bf16 a[128:131], v[228:231], v[68:71], a[128:131]
v_mfma_f32_16x16x32_bf16 a[132:135], v[228:231], v[76:79], a[132:135]
ds_read_b64_tr_b16 v[202:203], v241 offset:6408
v_mfma_f32_16x16x32_bf16 a[132:135], v[224:227], v[72:75], a[132:135]
v_mfma_f32_16x16x32_bf16 a[136:139], v[224:227], v[80:83], a[136:139]
ds_read_b64_tr_b16 v[204:205], v241 offset:12552
v_mfma_f32_16x16x32_bf16 a[136:139], v[228:231], v[84:87], a[136:139]
v_mfma_f32_16x16x32_bf16 a[140:143], v[228:231], v[92:95], a[140:143]
ds_read_b64_tr_b16 v[206:207], v241 offset:18696
buffer_load_dwordx4 v[132:135], v251, s[20:23], s66 offen offset:1024 sc1
v_mfma_f32_16x16x32_bf16 a[140:143], v[224:227], v[88:91], a[140:143]
s_waitcnt lgkmcnt(8)
v_mfma_f32_16x16x32_bf16 a[144:147], v[232:235], v[64:67], a[144:147]
ds_read_b64_tr_b16 v[208:209], v244
v_mfma_f32_16x16x32_bf16 a[144:147], v[236:239], v[68:71], a[144:147]
v_mfma_f32_16x16x32_bf16 a[148:151], v[236:239], v[76:79], a[148:151]
ds_read_b64_tr_b16 v[210:211], v244 offset:2048
v_mfma_f32_16x16x32_bf16 a[148:151], v[232:235], v[72:75], a[148:151]
v_mfma_f32_16x16x32_bf16 a[152:155], v[232:235], v[80:83], a[152:155]
ds_read_b64_tr_b16 v[212:213], v244 offset:4096
v_mfma_f32_16x16x32_bf16 a[152:155], v[236:239], v[84:87], a[152:155]
v_mfma_f32_16x16x32_bf16 a[156:159], v[236:239], v[92:95], a[156:159]
ds_read_b64_tr_b16 v[214:215], v244 offset:6144
buffer_load_dwordx4 v[136:139], v252, s[20:23], s66 offen sc1
v_mfma_f32_16x16x32_bf16 a[156:159], v[232:235], v[88:91], a[156:159]
s_waitcnt lgkmcnt(8)
v_mfma_f32_16x16x32_bf16 a[160:163], v[192:195], v[64:67], a[160:163]
ds_read_b64_tr_b16 v[216:217], v245
v_mfma_f32_16x16x32_bf16 a[160:163], v[196:199], v[68:71], a[160:163]
v_mfma_f32_16x16x32_bf16 a[164:167], v[196:199], v[76:79], a[164:167]
ds_read_b64_tr_b16 v[218:219], v245 offset:2048
v_mfma_f32_16x16x32_bf16 a[164:167], v[192:195], v[72:75], a[164:167]
v_mfma_f32_16x16x32_bf16 a[168:171], v[192:195], v[80:83], a[168:171]
ds_read_b64_tr_b16 v[220:221], v245 offset:4096
v_mfma_f32_16x16x32_bf16 a[168:171], v[196:199], v[84:87], a[168:171]
v_mfma_f32_16x16x32_bf16 a[172:175], v[196:199], v[92:95], a[172:175]
ds_read_b64_tr_b16 v[222:223], v245 offset:6144
buffer_load_dwordx4 v[140:143], v252, s[20:23], s66 offen offset:1024 sc1
v_mfma_f32_16x16x32_bf16 a[172:175], v[192:195], v[88:91], a[172:175]
s_waitcnt lgkmcnt(8)
v_mfma_f32_16x16x32_bf16 a[176:179], v[200:203], v[64:67], a[176:179]
ds_read_b64_tr_b16 v[224:225], v246
v_mfma_f32_16x16x32_bf16 a[176:179], v[204:207], v[68:71], a[176:179]
v_mfma_f32_16x16x32_bf16 a[180:183], v[204:207], v[76:79], a[180:183]
ds_read_b64_tr_b16 v[226:227], v246 offset:2048
v_mfma_f32_16x16x32_bf16 a[180:183], v[200:203], v[72:75], a[180:183]
v_mfma_f32_16x16x32_bf16 a[184:187], v[200:203], v[80:83], a[184:187]
ds_read_b64_tr_b16 v[228:229], v246 offset:4096
v_mfma_f32_16x16x32_bf16 a[184:187], v[204:207], v[84:87], a[184:187]
v_mfma_f32_16x16x32_bf16 a[188:191], v[204:207], v[92:95], a[188:191]
ds_read_b64_tr_b16 v[230:231], v246 offset:6144
buffer_load_dwordx4 v[144:147], v253, s[20:23], s66 offen sc1
v_mfma_f32_16x16x32_bf16 a[188:191], v[200:203], v[88:91], a[188:191]
s_waitcnt lgkmcnt(8)
v_mfma_f32_16x16x32_bf16 v[160:163], v[208:211], v[64:67], v[160:163]
ds_read_b64_tr_b16 v[232:233], v255
v_mfma_f32_16x16x32_bf16 v[160:163], v[212:215], v[68:71], v[160:163]
v_mfma_f32_16x16x32_bf16 v[164:167], v[212:215], v[76:79], v[164:167]
ds_read_b64_tr_b16 v[234:235], v255 offset:2048
v_mfma_f32_16x16x32_bf16 v[164:167], v[208:211], v[72:75], v[164:167]
v_mfma_f32_16x16x32_bf16 v[168:171], v[208:211], v[80:83], v[168:171]
ds_read_b64_tr_b16 v[236:237], v255 offset:4096
v_mfma_f32_16x16x32_bf16 v[168:171], v[212:215], v[84:87], v[168:171]
buffer_load_dwordx4 v[148:151], v253, s[20:23], s66 offen offset:1024 sc1
v_mfma_f32_16x16x32_bf16 v[172:175], v[212:215], v[92:95], v[172:175]
ds_read_b64_tr_b16 v[238:239], v255 offset:6144
v_mfma_f32_16x16x32_bf16 v[172:175], v[208:211], v[88:91], v[172:175]
s_waitcnt lgkmcnt(8)
v_mfma_f32_16x16x32_bf16 v[176:179], v[216:219], v[64:67], v[176:179]
v_mfma_f32_16x16x32_bf16 v[176:179], v[220:223], v[68:71], v[176:179]
v_mfma_f32_16x16x32_bf16 v[180:183], v[220:223], v[76:79], v[180:183]
v_mfma_f32_16x16x32_bf16 v[180:183], v[216:219], v[72:75], v[180:183]
v_mfma_f32_16x16x32_bf16 v[184:187], v[216:219], v[80:83], v[184:187]
v_mfma_f32_16x16x32_bf16 v[184:187], v[220:223], v[84:87], v[184:187]
buffer_load_dwordx4 v[152:155], v254, s[20:23], s66 offen sc1
v_mfma_f32_16x16x32_bf16 v[188:191], v[220:223], v[92:95], v[188:191]
s_waitcnt vmcnt(23) lgkmcnt(0)
s_barrier
v_mfma_f32_16x16x32_bf16 v[188:191], v[216:219], v[88:91], v[188:191]
s_waitcnt lgkmcnt(0)
ds_read_b64_tr_b16 v[192:193], v240 offset:24576
v_mfma_f32_16x16x32_bf16 v[16:19], v[224:227], v[64:67], v[16:19]
ds_read_b64_tr_b16 v[194:195], v240 offset:30720
v_mfma_f32_16x16x32_bf16 v[16:19], v[228:231], v[68:71], v[16:19]
ds_read_b64_tr_b16 v[196:197], v240 offset:36864
v_mfma_f32_16x16x32_bf16 v[20:23], v[228:231], v[76:79], v[20:23]
ds_read_b64_tr_b16 v[198:199], v240 offset:43008
v_mfma_f32_16x16x32_bf16 v[20:23], v[224:227], v[72:75], v[20:23]
v_mfma_f32_16x16x32_bf16 v[24:27], v[224:227], v[80:83], v[24:27]
ds_read_b64_tr_b16 v[200:201], v240 offset:24584
v_mfma_f32_16x16x32_bf16 v[24:27], v[228:231], v[84:87], v[24:27]
ds_read_b64_tr_b16 v[202:203], v240 offset:30728
buffer_load_dwordx4 v[156:159], v254, s[20:23], s66 offen offset:1024 sc1
v_mfma_f32_16x16x32_bf16 v[28:31], v[228:231], v[92:95], v[28:31]
s_add_u32 s66, s66, 2048
ds_read_b64_tr_b16 v[204:205], v240 offset:36872
v_mfma_f32_16x16x32_bf16 v[28:31], v[224:227], v[88:91], v[28:31]
s_waitcnt lgkmcnt(7)
ds_read_b64_tr_b16 v[206:207], v240 offset:43016
v_mfma_f32_16x16x32_bf16 v[48:51], v[232:235], v[64:67], v[48:51]
v_mfma_f32_16x16x32_bf16 v[48:51], v[236:239], v[68:71], v[48:51]
ds_read_b64_tr_b16 v[208:209], v241 offset:24576
v_mfma_f32_16x16x32_bf16 v[52:55], v[236:239], v[76:79], v[52:55]
ds_read_b64_tr_b16 v[210:211], v241 offset:30720
v_mfma_f32_16x16x32_bf16 v[52:55], v[232:235], v[72:75], v[52:55]
ds_read_b64_tr_b16 v[212:213], v241 offset:36864
v_mfma_f32_16x16x32_bf16 v[56:59], v[232:235], v[80:83], v[56:59]
ds_read_b64_tr_b16 v[214:215], v241 offset:43008
v_mfma_f32_16x16x32_bf16 v[56:59], v[236:239], v[84:87], v[56:59]
v_mfma_f32_16x16x32_bf16 v[60:63], v[236:239], v[92:95], v[60:63]
s_waitcnt vmcnt(16)
v_mfma_f32_16x16x32_bf16 v[60:63], v[232:235], v[88:91], v[60:63]
s_waitcnt lgkmcnt(8)
v_mfma_f32_16x16x32_bf16 a[0:3], v[192:195], v[96:99], a[0:3]
s_add_u32 m0, s68, 73728
ds_read_b64_tr_b16 v[216:217], v241 offset:24584
v_mfma_f32_16x16x32_bf16 a[0:3], v[196:199], v[100:103], a[0:3]
buffer_load_dwordx4 v247, s[12:15], s64 offen lds
v_mfma_f32_16x16x32_bf16 a[4:7], v[196:199], v[108:111], a[4:7]
ds_read_b64_tr_b16 v[218:219], v241 offset:30728
v_mfma_f32_16x16x32_bf16 a[4:7], v[192:195], v[104:107], a[4:7]
v_mfma_f32_16x16x32_bf16 a[8:11], v[192:195], v[112:115], a[8:11]
ds_read_b64_tr_b16 v[220:221], v241 offset:36872
v_mfma_f32_16x16x32_bf16 a[8:11], v[196:199], v[116:119], a[8:11]
v_mfma_f32_16x16x32_bf16 a[12:15], v[196:199], v[124:127], a[12:15]
ds_read_b64_tr_b16 v[222:223], v241 offset:43016
v_mfma_f32_16x16x32_bf16 a[12:15], v[192:195], v[120:123], a[12:15]
s_waitcnt lgkmcnt(8)
v_mfma_f32_16x16x32_bf16 a[16:19], v[200:203], v[96:99], a[16:19]
ds_read_b64_tr_b16 v[224:225], v240 offset:24704
buffer_load_dwordx4 v248, s[12:15], s64 offen offset:1024 lds
v_mfma_f32_16x16x32_bf16 a[16:19], v[204:207], v[100:103], a[16:19]
v_mfma_f32_16x16x32_bf16 a[20:23], v[204:207], v[108:111], a[20:23]
ds_read_b64_tr_b16 v[226:227], v240 offset:30848
v_mfma_f32_16x16x32_bf16 a[20:23], v[200:203], v[104:107], a[20:23]
v_mfma_f32_16x16x32_bf16 a[24:27], v[200:203], v[112:115], a[24:27]
ds_read_b64_tr_b16 v[228:229], v240 offset:36992
v_mfma_f32_16x16x32_bf16 a[24:27], v[204:207], v[116:119], a[24:27]
v_mfma_f32_16x16x32_bf16 a[28:31], v[204:207], v[124:127], a[28:31]
ds_read_b64_tr_b16 v[230:231], v240 offset:43136
v_mfma_f32_16x16x32_bf16 a[28:31], v[200:203], v[120:123], a[28:31]
s_waitcnt lgkmcnt(8)
v_mfma_f32_16x16x32_bf16 a[32:35], v[208:211], v[96:99], a[32:35]
ds_read_b64_tr_b16 v[232:233], v240 offset:24712
buffer_load_dwordx4 v249, s[12:15], s64 offen offset:2048 lds
v_mfma_f32_16x16x32_bf16 a[32:35], v[212:215], v[100:103], a[32:35]
s_add_u32 s64, s64, 98304
s_add_u32 m0, s68, 76800
v_mfma_f32_16x16x32_bf16 a[36:39], v[212:215], v[108:111], a[36:39]
ds_read_b64_tr_b16 v[234:235], v240 offset:30856
v_mfma_f32_16x16x32_bf16 a[36:39], v[208:211], v[104:107], a[36:39]
v_mfma_f32_16x16x32_bf16 a[40:43], v[208:211], v[112:115], a[40:43]
ds_read_b64_tr_b16 v[236:237], v240 offset:37000
v_mfma_f32_16x16x32_bf16 a[40:43], v[212:215], v[116:119], a[40:43]
v_mfma_f32_16x16x32_bf16 a[44:47], v[212:215], v[124:127], a[44:47]
ds_read_b64_tr_b16 v[238:239], v240 offset:43144
v_mfma_f32_16x16x32_bf16 a[44:47], v[208:211], v[120:123], a[44:47]
s_waitcnt lgkmcnt(8)
v_mfma_f32_16x16x32_bf16 a[48:51], v[216:219], v[96:99], a[48:51]
ds_read_b64_tr_b16 v[192:193], v241 offset:24704
buffer_load_dwordx4 v247, s[12:15], s64 offen lds
v_mfma_f32_16x16x32_bf16 a[48:51], v[220:223], v[100:103], a[48:51]
v_mfma_f32_16x16x32_bf16 a[52:55], v[220:223], v[108:111], a[52:55]
ds_read_b64_tr_b16 v[194:195], v241 offset:30848
v_mfma_f32_16x16x32_bf16 a[52:55], v[216:219], v[104:107], a[52:55]
v_mfma_f32_16x16x32_bf16 a[56:59], v[216:219], v[112:115], a[56:59]
ds_read_b64_tr_b16 v[196:197], v241 offset:36992
v_mfma_f32_16x16x32_bf16 a[56:59], v[220:223], v[116:119], a[56:59]
v_mfma_f32_16x16x32_bf16 a[60:63], v[220:223], v[124:127], a[60:63]
ds_read_b64_tr_b16 v[198:199], v241 offset:43136
v_mfma_f32_16x16x32_bf16 a[60:63], v[216:219], v[120:123], a[60:63]
s_waitcnt lgkmcnt(8)
v_mfma_f32_16x16x32_bf16 a[64:67], v[224:227], v[96:99], a[64:67]
ds_read_b64_tr_b16 v[200:201], v241 offset:24712
buffer_load_dwordx4 v248, s[12:15], s64 offen offset:1024 lds
v_mfma_f32_16x16x32_bf16 a[64:67], v[228:231], v[100:103], a[64:67]
v_mfma_f32_16x16x32_bf16 a[68:71], v[228:231], v[108:111], a[68:71]
ds_read_b64_tr_b16 v[202:203], v241 offset:30856
v_mfma_f32_16x16x32_bf16 a[68:71], v[224:227], v[104:107], a[68:71]
v_mfma_f32_16x16x32_bf16 a[72:75], v[224:227], v[112:115], a[72:75]
ds_read_b64_tr_b16 v[204:205], v241 offset:37000
v_mfma_f32_16x16x32_bf16 a[72:75], v[228:231], v[116:119], a[72:75]
v_mfma_f32_16x16x32_bf16 a[76:79], v[228:231], v[124:127], a[76:79]
ds_read_b64_tr_b16 v[206:207], v241 offset:43144
v_mfma_f32_16x16x32_bf16 a[76:79], v[224:227], v[120:123], a[76:79]
s_waitcnt lgkmcnt(8)
buffer_load_dwordx4 v249, s[12:15], s64 offen offset:2048 lds
v_mfma_f32_16x16x32_bf16 a[80:83], v[232:235], v[96:99], a[80:83]
s_add_u32 s64, s64, 688128
s_add_u32 m0, s61, 49152
ds_read_b64_tr_b16 v[208:209], v240 offset:24832
v_mfma_f32_16x16x32_bf16 a[80:83], v[236:239], v[100:103], a[80:83]
v_mfma_f32_16x16x32_bf16 a[84:87], v[236:239], v[108:111], a[84:87]
ds_read_b64_tr_b16 v[210:211], v240 offset:30976
v_mfma_f32_16x16x32_bf16 a[84:87], v[232:235], v[104:107], a[84:87]
v_mfma_f32_16x16x32_bf16 a[88:91], v[232:235], v[112:115], a[88:91]
ds_read_b64_tr_b16 v[212:213], v240 offset:37120
v_mfma_f32_16x16x32_bf16 a[88:91], v[236:239], v[116:119], a[88:91]
v_mfma_f32_16x16x32_bf16 a[92:95], v[236:239], v[124:127], a[92:95]
ds_read_b64_tr_b16 v[214:215], v240 offset:43264
v_mfma_f32_16x16x32_bf16 a[92:95], v[232:235], v[120:123], a[92:95]
s_waitcnt lgkmcnt(8)
buffer_load_dwordx4 v250, s[16:19], s65 offen lds
v_mfma_f32_16x16x32_bf16 a[96:99], v[192:195], v[96:99], a[96:99]
s_add_u32 s65, s65, 23552
ds_read_b64_tr_b16 v[216:217], v240 offset:24840
v_mfma_f32_16x16x32_bf16 a[96:99], v[196:199], v[100:103], a[96:99]
v_mfma_f32_16x16x32_bf16 a[100:103], v[196:199], v[108:111], a[100:103]
ds_read_b64_tr_b16 v[218:219], v240 offset:30984
v_mfma_f32_16x16x32_bf16 a[100:103], v[192:195], v[104:107], a[100:103]
v_mfma_f32_16x16x32_bf16 a[104:107], v[192:195], v[112:115], a[104:107]
ds_read_b64_tr_b16 v[220:221], v240 offset:37128
v_mfma_f32_16x16x32_bf16 a[104:107], v[196:199], v[116:119], a[104:107]
v_mfma_f32_16x16x32_bf16 a[108:111], v[196:199], v[124:127], a[108:111]
ds_read_b64_tr_b16 v[222:223], v240 offset:43272
v_mfma_f32_16x16x32_bf16 a[108:111], v[192:195], v[120:123], a[108:111]
s_waitcnt lgkmcnt(8)
buffer_load_dwordx4 v250, s[16:19], s65 offen offset:1024 lds
v_mfma_f32_16x16x32_bf16 a[112:115], v[200:203], v[96:99], a[112:115]
s_add_u32 s65, s65, 173056
ds_read_b64_tr_b16 v[224:225], v241 offset:24832
v_mfma_f32_16x16x32_bf16 a[112:115], v[204:207], v[100:103], a[112:115]
v_mfma_f32_16x16x32_bf16 a[116:119], v[204:207], v[108:111], a[116:119]
ds_read_b64_tr_b16 v[226:227], v241 offset:30976
v_mfma_f32_16x16x32_bf16 a[116:119], v[200:203], v[104:107], a[116:119]
v_mfma_f32_16x16x32_bf16 a[120:123], v[200:203], v[112:115], a[120:123]
ds_read_b64_tr_b16 v[228:229], v241 offset:37120
v_mfma_f32_16x16x32_bf16 a[120:123], v[204:207], v[116:119], a[120:123]
v_mfma_f32_16x16x32_bf16 a[124:127], v[204:207], v[124:127], a[124:127]
ds_read_b64_tr_b16 v[230:231], v241 offset:43264
v_mfma_f32_16x16x32_bf16 a[124:127], v[200:203], v[120:123], a[124:127]
s_waitcnt lgkmcnt(8)
buffer_load_dwordx4 v[64:67], v251, s[20:23], s66 offen sc1
v_mfma_f32_16x16x32_bf16 a[128:131], v[208:211], v[96:99], a[128:131]
ds_read_b64_tr_b16 v[232:233], v241 offset:24840
v_mfma_f32_16x16x32_bf16 a[128:131], v[212:215], v[100:103], a[128:131]
v_mfma_f32_16x16x32_bf16 a[132:135], v[212:215], v[108:111], a[132:135]
ds_read_b64_tr_b16 v[234:235], v241 offset:30984
v_mfma_f32_16x16x32_bf16 a[132:135], v[208:211], v[104:107], a[132:135]
v_mfma_f32_16x16x32_bf16 a[136:139], v[208:211], v[112:115], a[136:139]
ds_read_b64_tr_b16 v[236:237], v241 offset:37128
v_mfma_f32_16x16x32_bf16 a[136:139], v[212:215], v[116:119], a[136:139]
v_mfma_f32_16x16x32_bf16 a[140:143], v[212:215], v[124:127], a[140:143]
ds_read_b64_tr_b16 v[238:239], v241 offset:43272
buffer_load_dwordx4 v[68:71], v251, s[20:23], s66 offen offset:1024 sc1
v_mfma_f32_16x16x32_bf16 a[140:143], v[208:211], v[120:123], a[140:143]
s_waitcnt lgkmcnt(8)
v_mfma_f32_16x16x32_bf16 a[144:147], v[216:219], v[96:99], a[144:147]
ds_read_b64_tr_b16 v[192:193], v244 offset:8192
v_mfma_f32_16x16x32_bf16 a[144:147], v[220:223], v[100:103], a[144:147]
v_mfma_f32_16x16x32_bf16 a[148:151], v[220:223], v[108:111], a[148:151]
ds_read_b64_tr_b16 v[194:195], v244 offset:10240
v_mfma_f32_16x16x32_bf16 a[148:151], v[216:219], v[104:107], a[148:151]
v_mfma_f32_16x16x32_bf16 a[152:155], v[216:219], v[112:115], a[152:155]
ds_read_b64_tr_b16 v[196:197], v244 offset:12288
v_mfma_f32_16x16x32_bf16 a[152:155], v[220:223], v[116:119], a[152:155]
v_mfma_f32_16x16x32_bf16 a[156:159], v[220:223], v[124:127], a[156:159]
ds_read_b64_tr_b16 v[198:199], v244 offset:14336
buffer_load_dwordx4 v[72:75], v252, s[20:23], s66 offen sc1
v_mfma_f32_16x16x32_bf16 a[156:159], v[216:219], v[120:123], a[156:159]
s_waitcnt lgkmcnt(8)
v_mfma_f32_16x16x32_bf16 a[160:163], v[224:227], v[96:99], a[160:163]
ds_read_b64_tr_b16 v[200:201], v245 offset:8192
v_mfma_f32_16x16x32_bf16 a[160:163], v[228:231], v[100:103], a[160:163]
v_mfma_f32_16x16x32_bf16 a[164:167], v[228:231], v[108:111], a[164:167]
ds_read_b64_tr_b16 v[202:203], v245 offset:10240
v_mfma_f32_16x16x32_bf16 a[164:167], v[224:227], v[104:107], a[164:167]
v_mfma_f32_16x16x32_bf16 a[168:171], v[224:227], v[112:115], a[168:171]
ds_read_b64_tr_b16 v[204:205], v245 offset:12288
v_mfma_f32_16x16x32_bf16 a[168:171], v[228:231], v[116:119], a[168:171]
v_mfma_f32_16x16x32_bf16 a[172:175], v[228:231], v[124:127], a[172:175]
ds_read_b64_tr_b16 v[206:207], v245 offset:14336
buffer_load_dwordx4 v[76:79], v252, s[20:23], s66 offen offset:1024 sc1
v_mfma_f32_16x16x32_bf16 a[172:175], v[224:227], v[120:123], a[172:175]
s_waitcnt lgkmcnt(8)
v_mfma_f32_16x16x32_bf16 a[176:179], v[232:235], v[96:99], a[176:179]
ds_read_b64_tr_b16 v[208:209], v246 offset:8192
v_mfma_f32_16x16x32_bf16 a[176:179], v[236:239], v[100:103], a[176:179]
v_mfma_f32_16x16x32_bf16 a[180:183], v[236:239], v[108:111], a[180:183]
ds_read_b64_tr_b16 v[210:211], v246 offset:10240
v_mfma_f32_16x16x32_bf16 a[180:183], v[232:235], v[104:107], a[180:183]
v_mfma_f32_16x16x32_bf16 a[184:187], v[232:235], v[112:115], a[184:187]
ds_read_b64_tr_b16 v[212:213], v246 offset:12288
v_mfma_f32_16x16x32_bf16 a[184:187], v[236:239], v[116:119], a[184:187]
v_mfma_f32_16x16x32_bf16 a[188:191], v[236:239], v[124:127], a[188:191]
ds_read_b64_tr_b16 v[214:215], v246 offset:14336
buffer_load_dwordx4 v[80:83], v253, s[20:23], s66 offen sc1
v_mfma_f32_16x16x32_bf16 a[188:191], v[232:235], v[120:123], a[188:191]
s_waitcnt lgkmcnt(8)
v_mfma_f32_16x16x32_bf16 v[160:163], v[192:195], v[96:99], v[160:163]
ds_read_b64_tr_b16 v[216:217], v255 offset:8192
v_mfma_f32_16x16x32_bf16 v[160:163], v[196:199], v[100:103], v[160:163]
v_mfma_f32_16x16x32_bf16 v[164:167], v[196:199], v[108:111], v[164:167]
ds_read_b64_tr_b16 v[218:219], v255 offset:10240
v_mfma_f32_16x16x32_bf16 v[164:167], v[192:195], v[104:107], v[164:167]
v_mfma_f32_16x16x32_bf16 v[168:171], v[192:195], v[112:115], v[168:171]
ds_read_b64_tr_b16 v[220:221], v255 offset:12288
v_mfma_f32_16x16x32_bf16 v[168:171], v[196:199], v[116:119], v[168:171]
buffer_load_dwordx4 v[84:87], v253, s[20:23], s66 offen offset:1024 sc1
v_mfma_f32_16x16x32_bf16 v[172:175], v[196:199], v[124:127], v[172:175]
ds_read_b64_tr_b16 v[222:223], v255 offset:14336
v_mfma_f32_16x16x32_bf16 v[172:175], v[192:195], v[120:123], v[172:175]
s_waitcnt lgkmcnt(8)
v_mfma_f32_16x16x32_bf16 v[176:179], v[200:203], v[96:99], v[176:179]
v_mfma_f32_16x16x32_bf16 v[176:179], v[204:207], v[100:103], v[176:179]
v_mfma_f32_16x16x32_bf16 v[180:183], v[204:207], v[108:111], v[180:183]
v_mfma_f32_16x16x32_bf16 v[180:183], v[200:203], v[104:107], v[180:183]
v_mfma_f32_16x16x32_bf16 v[184:187], v[200:203], v[112:115], v[184:187]
v_mfma_f32_16x16x32_bf16 v[184:187], v[204:207], v[116:119], v[184:187]
buffer_load_dwordx4 v[88:91], v254, s[20:23], s66 offen sc1
v_mfma_f32_16x16x32_bf16 v[188:191], v[204:207], v[124:127], v[188:191]
s_waitcnt vmcnt(23) lgkmcnt(0)
s_barrier
v_mfma_f32_16x16x32_bf16 v[188:191], v[200:203], v[120:123], v[188:191]
s_waitcnt lgkmcnt(0)
ds_read_b64_tr_b16 v[224:225], v242
v_mfma_f32_16x16x32_bf16 v[16:19], v[208:211], v[96:99], v[16:19]
ds_read_b64_tr_b16 v[226:227], v242 offset:6144
v_mfma_f32_16x16x32_bf16 v[16:19], v[212:215], v[100:103], v[16:19]
ds_read_b64_tr_b16 v[228:229], v242 offset:12288
v_mfma_f32_16x16x32_bf16 v[20:23], v[212:215], v[108:111], v[20:23]
ds_read_b64_tr_b16 v[230:231], v242 offset:18432
v_mfma_f32_16x16x32_bf16 v[20:23], v[208:211], v[104:107], v[20:23]
v_mfma_f32_16x16x32_bf16 v[24:27], v[208:211], v[112:115], v[24:27]
ds_read_b64_tr_b16 v[232:233], v242 offset:8
v_mfma_f32_16x16x32_bf16 v[24:27], v[212:215], v[116:119], v[24:27]
ds_read_b64_tr_b16 v[234:235], v242 offset:6152
buffer_load_dwordx4 v[92:95], v254, s[20:23], s66 offen offset:1024 sc1
v_mfma_f32_16x16x32_bf16 v[28:31], v[212:215], v[124:127], v[28:31]
s_add_u32 s66, s66, 2048
ds_read_b64_tr_b16 v[236:237], v242 offset:12296
v_mfma_f32_16x16x32_bf16 v[28:31], v[208:211], v[120:123], v[28:31]
s_waitcnt lgkmcnt(7)
ds_read_b64_tr_b16 v[238:239], v242 offset:18440
v_mfma_f32_16x16x32_bf16 v[48:51], v[216:219], v[96:99], v[48:51]
v_mfma_f32_16x16x32_bf16 v[48:51], v[220:223], v[100:103], v[48:51]
ds_read_b64_tr_b16 v[192:193], v243
v_mfma_f32_16x16x32_bf16 v[52:55], v[220:223], v[108:111], v[52:55]
ds_read_b64_tr_b16 v[194:195], v243 offset:6144
v_mfma_f32_16x16x32_bf16 v[52:55], v[216:219], v[104:107], v[52:55]
ds_read_b64_tr_b16 v[196:197], v243 offset:12288
v_mfma_f32_16x16x32_bf16 v[56:59], v[216:219], v[112:115], v[56:59]
ds_read_b64_tr_b16 v[198:199], v243 offset:18432
v_mfma_f32_16x16x32_bf16 v[56:59], v[220:223], v[116:119], v[56:59]
v_mfma_f32_16x16x32_bf16 v[60:63], v[220:223], v[124:127], v[60:63]
s_waitcnt vmcnt(16)
v_mfma_f32_16x16x32_bf16 v[60:63], v[216:219], v[120:123], v[60:63]
s_waitcnt lgkmcnt(8)
v_mfma_f32_16x16x32_bf16 a[0:3], v[224:227], v[128:131], a[0:3]
s_add_u32 m0, s68, 98304
ds_read_b64_tr_b16 v[200:201], v243 offset:8
v_mfma_f32_16x16x32_bf16 a[0:3], v[228:231], v[132:135], a[0:3]
buffer_load_dwordx4 v247, s[12:15], s64 offen lds
v_mfma_f32_16x16x32_bf16 a[4:7], v[228:231], v[140:143], a[4:7]
ds_read_b64_tr_b16 v[202:203], v243 offset:6152
v_mfma_f32_16x16x32_bf16 a[4:7], v[224:227], v[136:139], a[4:7]
v_mfma_f32_16x16x32_bf16 a[8:11], v[224:227], v[144:147], a[8:11]
ds_read_b64_tr_b16 v[204:205], v243 offset:12296
v_mfma_f32_16x16x32_bf16 a[8:11], v[228:231], v[148:151], a[8:11]
v_mfma_f32_16x16x32_bf16 a[12:15], v[228:231], v[156:159], a[12:15]
ds_read_b64_tr_b16 v[206:207], v243 offset:18440
v_mfma_f32_16x16x32_bf16 a[12:15], v[224:227], v[152:155], a[12:15]
s_waitcnt lgkmcnt(8)
v_mfma_f32_16x16x32_bf16 a[16:19], v[232:235], v[128:131], a[16:19]
ds_read_b64_tr_b16 v[208:209], v242 offset:128
buffer_load_dwordx4 v248, s[12:15], s64 offen offset:1024 lds
v_mfma_f32_16x16x32_bf16 a[16:19], v[236:239], v[132:135], a[16:19]
v_mfma_f32_16x16x32_bf16 a[20:23], v[236:239], v[140:143], a[20:23]
ds_read_b64_tr_b16 v[210:211], v242 offset:6272
v_mfma_f32_16x16x32_bf16 a[20:23], v[232:235], v[136:139], a[20:23]
v_mfma_f32_16x16x32_bf16 a[24:27], v[232:235], v[144:147], a[24:27]
ds_read_b64_tr_b16 v[212:213], v242 offset:12416
v_mfma_f32_16x16x32_bf16 a[24:27], v[236:239], v[148:151], a[24:27]
v_mfma_f32_16x16x32_bf16 a[28:31], v[236:239], v[156:159], a[28:31]
ds_read_b64_tr_b16 v[214:215], v242 offset:18560
v_mfma_f32_16x16x32_bf16 a[28:31], v[232:235], v[152:155], a[28:31]
s_waitcnt lgkmcnt(8)
v_mfma_f32_16x16x32_bf16 a[32:35], v[192:195], v[128:131], a[32:35]
ds_read_b64_tr_b16 v[216:217], v242 offset:136
buffer_load_dwordx4 v249, s[12:15], s64 offen offset:2048 lds
v_mfma_f32_16x16x32_bf16 a[32:35], v[196:199], v[132:135], a[32:35]
s_add_u32 s64, s64, 98304
s_add_u32 m0, s68, 101376
v_mfma_f32_16x16x32_bf16 a[36:39], v[196:199], v[140:143], a[36:39]
ds_read_b64_tr_b16 v[218:219], v242 offset:6280
v_mfma_f32_16x16x32_bf16 a[36:39], v[192:195], v[136:139], a[36:39]
v_mfma_f32_16x16x32_bf16 a[40:43], v[192:195], v[144:147], a[40:43]
ds_read_b64_tr_b16 v[220:221], v242 offset:12424
v_mfma_f32_16x16x32_bf16 a[40:43], v[196:199], v[148:151], a[40:43]
v_mfma_f32_16x16x32_bf16 a[44:47], v[196:199], v[156:159], a[44:47]
ds_read_b64_tr_b16 v[222:223], v242 offset:18568
v_mfma_f32_16x16x32_bf16 a[44:47], v[192:195], v[152:155], a[44:47]
s_waitcnt lgkmcnt(8)
v_mfma_f32_16x16x32_bf16 a[48:51], v[200:203], v[128:131], a[48:51]
ds_read_b64_tr_b16 v[224:225], v243 offset:128
buffer_load_dwordx4 v247, s[12:15], s64 offen lds
v_mfma_f32_16x16x32_bf16 a[48:51], v[204:207], v[132:135], a[48:51]
v_mfma_f32_16x16x32_bf16 a[52:55], v[204:207], v[140:143], a[52:55]
ds_read_b64_tr_b16 v[226:227], v243 offset:6272
v_mfma_f32_16x16x32_bf16 a[52:55], v[200:203], v[136:139], a[52:55]
v_mfma_f32_16x16x32_bf16 a[56:59], v[200:203], v[144:147], a[56:59]
ds_read_b64_tr_b16 v[228:229], v243 offset:12416
v_mfma_f32_16x16x32_bf16 a[56:59], v[204:207], v[148:151], a[56:59]
v_mfma_f32_16x16x32_bf16 a[60:63], v[204:207], v[156:159], a[60:63]
ds_read_b64_tr_b16 v[230:231], v243 offset:18560
v_mfma_f32_16x16x32_bf16 a[60:63], v[200:203], v[152:155], a[60:63]
s_waitcnt lgkmcnt(8)
v_mfma_f32_16x16x32_bf16 a[64:67], v[208:211], v[128:131], a[64:67]
ds_read_b64_tr_b16 v[232:233], v243 offset:136
buffer_load_dwordx4 v248, s[12:15], s64 offen offset:1024 lds
v_mfma_f32_16x16x32_bf16 a[64:67], v[212:215], v[132:135], a[64:67]
v_mfma_f32_16x16x32_bf16 a[68:71], v[212:215], v[140:143], a[68:71]
ds_read_b64_tr_b16 v[234:235], v243 offset:6280
v_mfma_f32_16x16x32_bf16 a[68:71], v[208:211], v[136:139], a[68:71]
v_mfma_f32_16x16x32_bf16 a[72:75], v[208:211], v[144:147], a[72:75]
ds_read_b64_tr_b16 v[236:237], v243 offset:12424
v_mfma_f32_16x16x32_bf16 a[72:75], v[212:215], v[148:151], a[72:75]
v_mfma_f32_16x16x32_bf16 a[76:79], v[212:215], v[156:159], a[76:79]
ds_read_b64_tr_b16 v[238:239], v243 offset:18568
v_mfma_f32_16x16x32_bf16 a[76:79], v[208:211], v[152:155], a[76:79]
s_waitcnt lgkmcnt(8)
buffer_load_dwordx4 v249, s[12:15], s64 offen offset:2048 lds
v_mfma_f32_16x16x32_bf16 a[80:83], v[216:219], v[128:131], a[80:83]
s_add_u32 s64, s64, 688128
s_add_u32 m0, s61, 57344
ds_read_b64_tr_b16 v[192:193], v242 offset:256
v_mfma_f32_16x16x32_bf16 a[80:83], v[220:223], v[132:135], a[80:83]
v_mfma_f32_16x16x32_bf16 a[84:87], v[220:223], v[140:143], a[84:87]
ds_read_b64_tr_b16 v[194:195], v242 offset:6400
v_mfma_f32_16x16x32_bf16 a[84:87], v[216:219], v[136:139], a[84:87]
v_mfma_f32_16x16x32_bf16 a[88:91], v[216:219], v[144:147], a[88:91]
ds_read_b64_tr_b16 v[196:197], v242 offset:12544
v_mfma_f32_16x16x32_bf16 a[88:91], v[220:223], v[148:151], a[88:91]
v_mfma_f32_16x16x32_bf16 a[92:95], v[220:223], v[156:159], a[92:95]
ds_read_b64_tr_b16 v[198:199], v242 offset:18688
v_mfma_f32_16x16x32_bf16 a[92:95], v[216:219], v[152:155], a[92:95]
s_waitcnt lgkmcnt(8)
buffer_load_dwordx4 v250, s[16:19], s65 offen lds
v_mfma_f32_16x16x32_bf16 a[96:99], v[224:227], v[128:131], a[96:99]
s_add_u32 s65, s65, 23552
ds_read_b64_tr_b16 v[200:201], v242 offset:264
v_mfma_f32_16x16x32_bf16 a[96:99], v[228:231], v[132:135], a[96:99]
v_mfma_f32_16x16x32_bf16 a[100:103], v[228:231], v[140:143], a[100:103]
ds_read_b64_tr_b16 v[202:203], v242 offset:6408
v_mfma_f32_16x16x32_bf16 a[100:103], v[224:227], v[136:139], a[100:103]
v_mfma_f32_16x16x32_bf16 a[104:107], v[224:227], v[144:147], a[104:107]
ds_read_b64_tr_b16 v[204:205], v242 offset:12552
v_mfma_f32_16x16x32_bf16 a[104:107], v[228:231], v[148:151], a[104:107]
v_mfma_f32_16x16x32_bf16 a[108:111], v[228:231], v[156:159], a[108:111]
ds_read_b64_tr_b16 v[206:207], v242 offset:18696
v_mfma_f32_16x16x32_bf16 a[108:111], v[224:227], v[152:155], a[108:111]
s_waitcnt lgkmcnt(8)
buffer_load_dwordx4 v250, s[16:19], s65 offen offset:1024 lds
v_mfma_f32_16x16x32_bf16 a[112:115], v[232:235], v[128:131], a[112:115]
s_add_u32 s65, s65, 173056
ds_read_b64_tr_b16 v[208:209], v243 offset:256
v_mfma_f32_16x16x32_bf16 a[112:115], v[236:239], v[132:135], a[112:115]
v_mfma_f32_16x16x32_bf16 a[116:119], v[236:239], v[140:143], a[116:119]
ds_read_b64_tr_b16 v[210:211], v243 offset:6400
v_mfma_f32_16x16x32_bf16 a[116:119], v[232:235], v[136:139], a[116:119]
v_mfma_f32_16x16x32_bf16 a[120:123], v[232:235], v[144:147], a[120:123]
ds_read_b64_tr_b16 v[212:213], v243 offset:12544
v_mfma_f32_16x16x32_bf16 a[120:123], v[236:239], v[148:151], a[120:123]
v_mfma_f32_16x16x32_bf16 a[124:127], v[236:239], v[156:159], a[124:127]
ds_read_b64_tr_b16 v[214:215], v243 offset:18688
v_mfma_f32_16x16x32_bf16 a[124:127], v[232:235], v[152:155], a[124:127]
s_waitcnt lgkmcnt(8)
buffer_load_dwordx4 v[96:99], v251, s[20:23], s66 offen sc1
v_mfma_f32_16x16x32_bf16 a[128:131], v[192:195], v[128:131], a[128:131]
ds_read_b64_tr_b16 v[216:217], v243 offset:264
v_mfma_f32_16x16x32_bf16 a[128:131], v[196:199], v[132:135], a[128:131]
v_mfma_f32_16x16x32_bf16 a[132:135], v[196:199], v[140:143], a[132:135]
ds_read_b64_tr_b16 v[218:219], v243 offset:6408
v_mfma_f32_16x16x32_bf16 a[132:135], v[192:195], v[136:139], a[132:135]
v_mfma_f32_16x16x32_bf16 a[136:139], v[192:195], v[144:147], a[136:139]
ds_read_b64_tr_b16 v[220:221], v243 offset:12552
v_mfma_f32_16x16x32_bf16 a[136:139], v[196:199], v[148:151], a[136:139]
v_mfma_f32_16x16x32_bf16 a[140:143], v[196:199], v[156:159], a[140:143]
ds_read_b64_tr_b16 v[222:223], v243 offset:18696
buffer_load_dwordx4 v[100:103], v251, s[20:23], s66 offen offset:1024 sc1
v_mfma_f32_16x16x32_bf16 a[140:143], v[192:195], v[152:155], a[140:143]
s_waitcnt lgkmcnt(8)
v_mfma_f32_16x16x32_bf16 a[144:147], v[200:203], v[128:131], a[144:147]
ds_read_b64_tr_b16 v[224:225], v244 offset:16384
v_mfma_f32_16x16x32_bf16 a[144:147], v[204:207], v[132:135], a[144:147]
v_mfma_f32_16x16x32_bf16 a[148:151], v[204:207], v[140:143], a[148:151]
ds_read_b64_tr_b16 v[226:227], v244 offset:18432
v_mfma_f32_16x16x32_bf16 a[148:151], v[200:203], v[136:139], a[148:151]
v_mfma_f32_16x16x32_bf16 a[152:155], v[200:203], v[144:147], a[152:155]
ds_read_b64_tr_b16 v[228:229], v244 offset:20480
v_mfma_f32_16x16x32_bf16 a[152:155], v[204:207], v[148:151], a[152:155]
v_mfma_f32_16x16x32_bf16 a[156:159], v[204:207], v[156:159], a[156:159]
ds_read_b64_tr_b16 v[230:231], v244 offset:22528
buffer_load_dwordx4 v[104:107], v252, s[20:23], s66 offen sc1
v_mfma_f32_16x16x32_bf16 a[156:159], v[200:203], v[152:155], a[156:159]
s_waitcnt lgkmcnt(8)
v_mfma_f32_16x16x32_bf16 a[160:163], v[208:211], v[128:131], a[160:163]
ds_read_b64_tr_b16 v[232:233], v245 offset:16384
v_mfma_f32_16x16x32_bf16 a[160:163], v[212:215], v[132:135], a[160:163]
v_mfma_f32_16x16x32_bf16 a[164:167], v[212:215], v[140:143], a[164:167]
ds_read_b64_tr_b16 v[234:235], v245 offset:18432
v_mfma_f32_16x16x32_bf16 a[164:167], v[208:211], v[136:139], a[164:167]
v_mfma_f32_16x16x32_bf16 a[168:171], v[208:211], v[144:147], a[168:171]
ds_read_b64_tr_b16 v[236:237], v245 offset:20480
v_mfma_f32_16x16x32_bf16 a[168:171], v[212:215], v[148:151], a[168:171]
v_mfma_f32_16x16x32_bf16 a[172:175], v[212:215], v[156:159], a[172:175]
ds_read_b64_tr_b16 v[238:239], v245 offset:22528
buffer_load_dwordx4 v[108:111], v252, s[20:23], s66 offen offset:1024 sc1
v_mfma_f32_16x16x32_bf16 a[172:175], v[208:211], v[152:155], a[172:175]
s_waitcnt lgkmcnt(8)
v_mfma_f32_16x16x32_bf16 a[176:179], v[216:219], v[128:131], a[176:179]
ds_read_b64_tr_b16 v[192:193], v246 offset:16384
v_mfma_f32_16x16x32_bf16 a[176:179], v[220:223], v[132:135], a[176:179]
v_mfma_f32_16x16x32_bf16 a[180:183], v[220:223], v[140:143], a[180:183]
ds_read_b64_tr_b16 v[194:195], v246 offset:18432
v_mfma_f32_16x16x32_bf16 a[180:183], v[216:219], v[136:139], a[180:183]
v_mfma_f32_16x16x32_bf16 a[184:187], v[216:219], v[144:147], a[184:187]
ds_read_b64_tr_b16 v[196:197], v246 offset:20480
v_mfma_f32_16x16x32_bf16 a[184:187], v[220:223], v[148:151], a[184:187]
v_mfma_f32_16x16x32_bf16 a[188:191], v[220:223], v[156:159], a[188:191]
ds_read_b64_tr_b16 v[198:199], v246 offset:22528
buffer_load_dwordx4 v[112:115], v253, s[20:23], s66 offen sc1
v_mfma_f32_16x16x32_bf16 a[188:191], v[216:219], v[152:155], a[188:191]
s_waitcnt lgkmcnt(8)
v_mfma_f32_16x16x32_bf16 v[160:163], v[224:227], v[128:131], v[160:163]
ds_read_b64_tr_b16 v[200:201], v255 offset:16384
v_mfma_f32_16x16x32_bf16 v[160:163], v[228:231], v[132:135], v[160:163]
v_mfma_f32_16x16x32_bf16 v[164:167], v[228:231], v[140:143], v[164:167]
ds_read_b64_tr_b16 v[202:203], v255 offset:18432
v_mfma_f32_16x16x32_bf16 v[164:167], v[224:227], v[136:139], v[164:167]
v_mfma_f32_16x16x32_bf16 v[168:171], v[224:227], v[144:147], v[168:171]
ds_read_b64_tr_b16 v[204:205], v255 offset:20480
v_mfma_f32_16x16x32_bf16 v[168:171], v[228:231], v[148:151], v[168:171]
buffer_load_dwordx4 v[116:119], v253, s[20:23], s66 offen offset:1024 sc1
v_mfma_f32_16x16x32_bf16 v[172:175], v[228:231], v[156:159], v[172:175]
ds_read_b64_tr_b16 v[206:207], v255 offset:22528
v_mfma_f32_16x16x32_bf16 v[172:175], v[224:227], v[152:155], v[172:175]
s_waitcnt lgkmcnt(8)
v_mfma_f32_16x16x32_bf16 v[176:179], v[232:235], v[128:131], v[176:179]
v_mfma_f32_16x16x32_bf16 v[176:179], v[236:239], v[132:135], v[176:179]
v_mfma_f32_16x16x32_bf16 v[180:183], v[236:239], v[140:143], v[180:183]
v_mfma_f32_16x16x32_bf16 v[180:183], v[232:235], v[136:139], v[180:183]
v_mfma_f32_16x16x32_bf16 v[184:187], v[232:235], v[144:147], v[184:187]
v_mfma_f32_16x16x32_bf16 v[184:187], v[236:239], v[148:151], v[184:187]
buffer_load_dwordx4 v[120:123], v254, s[20:23], s66 offen sc1
v_mfma_f32_16x16x32_bf16 v[188:191], v[236:239], v[156:159], v[188:191]
s_waitcnt vmcnt(23) lgkmcnt(0)
s_barrier
v_mfma_f32_16x16x32_bf16 v[188:191], v[232:235], v[152:155], v[188:191]
s_waitcnt lgkmcnt(0)
ds_read_b64_tr_b16 v[208:209], v240
v_mfma_f32_16x16x32_bf16 v[16:19], v[192:195], v[128:131], v[16:19]
ds_read_b64_tr_b16 v[210:211], v240 offset:6144
v_mfma_f32_16x16x32_bf16 v[16:19], v[196:199], v[132:135], v[16:19]
ds_read_b64_tr_b16 v[212:213], v240 offset:12288
v_mfma_f32_16x16x32_bf16 v[20:23], v[196:199], v[140:143], v[20:23]
ds_read_b64_tr_b16 v[214:215], v240 offset:18432
v_mfma_f32_16x16x32_bf16 v[20:23], v[192:195], v[136:139], v[20:23]
v_mfma_f32_16x16x32_bf16 v[24:27], v[192:195], v[144:147], v[24:27]
ds_read_b64_tr_b16 v[216:217], v240 offset:8
v_mfma_f32_16x16x32_bf16 v[24:27], v[196:199], v[148:151], v[24:27]
ds_read_b64_tr_b16 v[218:219], v240 offset:6152
buffer_load_dwordx4 v[124:127], v254, s[20:23], s66 offen offset:1024 sc1
v_mfma_f32_16x16x32_bf16 v[28:31], v[196:199], v[156:159], v[28:31]
s_add_u32 s66, s66, 2048
ds_read_b64_tr_b16 v[220:221], v240 offset:12296
v_mfma_f32_16x16x32_bf16 v[28:31], v[192:195], v[152:155], v[28:31]
s_waitcnt lgkmcnt(7)
ds_read_b64_tr_b16 v[222:223], v240 offset:18440
v_mfma_f32_16x16x32_bf16 v[48:51], v[200:203], v[128:131], v[48:51]
v_mfma_f32_16x16x32_bf16 v[48:51], v[204:207], v[132:135], v[48:51]
ds_read_b64_tr_b16 v[224:225], v241
v_mfma_f32_16x16x32_bf16 v[52:55], v[204:207], v[140:143], v[52:55]
ds_read_b64_tr_b16 v[226:227], v241 offset:6144
v_mfma_f32_16x16x32_bf16 v[52:55], v[200:203], v[136:139], v[52:55]
ds_read_b64_tr_b16 v[228:229], v241 offset:12288
v_mfma_f32_16x16x32_bf16 v[56:59], v[200:203], v[144:147], v[56:59]
ds_read_b64_tr_b16 v[230:231], v241 offset:18432
v_mfma_f32_16x16x32_bf16 v[56:59], v[204:207], v[148:151], v[56:59]
v_mfma_f32_16x16x32_bf16 v[60:63], v[204:207], v[156:159], v[60:63]
s_waitcnt vmcnt(16)
v_mfma_f32_16x16x32_bf16 v[60:63], v[200:203], v[152:155], v[60:63]
s_waitcnt lgkmcnt(8)
v_mfma_f32_16x16x32_bf16 a[0:3], v[208:211], v[64:67], a[0:3]
s_add_u32 m0, s68, 122880
ds_read_b64_tr_b16 v[232:233], v241 offset:8
v_mfma_f32_16x16x32_bf16 a[0:3], v[212:215], v[68:71], a[0:3]
buffer_load_dwordx4 v247, s[12:15], s64 offen lds
v_mfma_f32_16x16x32_bf16 a[4:7], v[212:215], v[76:79], a[4:7]
ds_read_b64_tr_b16 v[234:235], v241 offset:6152
v_mfma_f32_16x16x32_bf16 a[4:7], v[208:211], v[72:75], a[4:7]
s_getpc_b64 s[34:35]
L_pc3e:
s_bfe_u32 s74, s2, 0x10003
s_lshl_b32 s74, s74, 2
s_add_u32 s74, s74, s52
s_min_u32 s74, s74, 4
s_lshl_b32 s74, s74, 13
s_add_u32 s56, s74, L_mide-L_pc3e
s_add_u32 s74, s74, L_common-L_pc3e-8192
s_cmp_eq_u32 s56, L_mide-L_pc3e
s_cselect_b32 s74, s56, s74
s_ashr_i32 s56, s74, 31
s_add_u32 s34, s34, s74
s_addc_u32 s35, s35, s56
v_mfma_f32_16x16x32_bf16 a[8:11], v[208:211], v[80:83], a[8:11]
ds_read_b64_tr_b16 v[236:237], v241 offset:12296
v_mfma_f32_16x16x32_bf16 a[8:11], v[212:215], v[84:87], a[8:11]
v_lshlrev_b32 v47, 7, v0
v_mfma_f32_16x16x32_bf16 a[12:15], v[212:215], v[92:95], a[12:15]
ds_read_b64_tr_b16 v[238:239], v241 offset:18440
buffer_load_dwordx4 v248, s[12:15], s64 offen offset:1024 lds
v_mfma_f32_16x16x32_bf16 a[12:15], v[208:211], v[88:91], a[12:15]
s_waitcnt lgkmcnt(8)
v_mfma_f32_16x16x32_bf16 a[16:19], v[216:219], v[64:67], a[16:19]
ds_read_b64_tr_b16 v[192:193], v240 offset:128
v_mfma_f32_16x16x32_bf16 a[16:19], v[220:223], v[68:71], a[16:19]
global_load_dword v47, v47, s[34:35]
v_mfma_f32_16x16x32_bf16 a[20:23], v[220:223], v[76:79], a[20:23]
ds_read_b64_tr_b16 v[194:195], v240 offset:6272
v_mfma_f32_16x16x32_bf16 a[20:23], v[216:219], v[72:75], a[20:23]
v_mfma_f32_16x16x32_bf16 a[24:27], v[216:219], v[80:83], a[24:27]
ds_read_b64_tr_b16 v[196:197], v240 offset:12416
buffer_load_dwordx4 v249, s[12:15], s64 offen offset:2048 lds
v_mfma_f32_16x16x32_bf16 a[24:27], v[220:223], v[84:87], a[24:27]
s_add_u32 s64, s64, 98304
s_add_u32 m0, s68, 125952
v_mfma_f32_16x16x32_bf16 a[28:31], v[220:223], v[92:95], a[28:31]
ds_read_b64_tr_b16 v[198:199], v240 offset:18560
v_mfma_f32_16x16x32_bf16 a[28:31], v[216:219], v[88:91], a[28:31]
s_waitcnt lgkmcnt(8)
v_mfma_f32_16x16x32_bf16 a[32:35], v[224:227], v[64:67], a[32:35]
ds_read_b64_tr_b16 v[200:201], v240 offset:136
v_mfma_f32_16x16x32_bf16 a[32:35], v[228:231], v[68:71], a[32:35]
buffer_load_dwordx4 v247, s[12:15], s64 offen lds
v_mfma_f32_16x16x32_bf16 a[36:39], v[228:231], v[76:79], a[36:39]
ds_read_b64_tr_b16 v[202:203], v240 offset:6280
v_mfma_f32_16x16x32_bf16 a[36:39], v[224:227], v[72:75], a[36:39]
v_mfma_f32_16x16x32_bf16 a[40:43], v[224:227], v[80:83], a[40:43]
ds_read_b64_tr_b16 v[204:205], v240 offset:12424
v_mfma_f32_16x16x32_bf16 a[40:43], v[228:231], v[84:87], a[40:43]
v_mfma_f32_16x16x32_bf16 a[44:47], v[228:231], v[92:95], a[44:47]
ds_read_b64_tr_b16 v[206:207], v240 offset:18568
v_mfma_f32_16x16x32_bf16 a[44:47], v[224:227], v[88:91], a[44:47]
s_waitcnt lgkmcnt(8)
buffer_load_dwordx4 v248, s[12:15], s64 offen offset:1024 lds
v_mfma_f32_16x16x32_bf16 a[48:51], v[232:235], v[64:67], a[48:51]
ds_read_b64_tr_b16 v[208:209], v241 offset:128
v_mfma_f32_16x16x32_bf16 a[48:51], v[236:239], v[68:71], a[48:51]
v_mfma_f32_16x16x32_bf16 a[52:55], v[236:239], v[76:79], a[52:55]
ds_read_b64_tr_b16 v[210:211], v241 offset:6272
v_mfma_f32_16x16x32_bf16 a[52:55], v[232:235], v[72:75], a[52:55]
v_mfma_f32_16x16x32_bf16 a[56:59], v[232:235], v[80:83], a[56:59]
ds_read_b64_tr_b16 v[212:213], v241 offset:12416
v_mfma_f32_16x16x32_bf16 a[56:59], v[236:239], v[84:87], a[56:59]
buffer_load_dwordx4 v249, s[12:15], s64 offen offset:2048 lds
v_mfma_f32_16x16x32_bf16 a[60:63], v[236:239], v[92:95], a[60:63]
s_add_u32 s64, s64, 688128
s_add_u32 m0, s61, 65536
ds_read_b64_tr_b16 v[214:215], v241 offset:18560
v_mfma_f32_16x16x32_bf16 a[60:63], v[232:235], v[88:91], a[60:63]
s_waitcnt lgkmcnt(8)
v_mfma_f32_16x16x32_bf16 a[64:67], v[192:195], v[64:67], a[64:67]
ds_read_b64_tr_b16 v[216:217], v241 offset:136
v_mfma_f32_16x16x32_bf16 a[64:67], v[196:199], v[68:71], a[64:67]
v_mfma_f32_16x16x32_bf16 a[68:71], v[196:199], v[76:79], a[68:71]
ds_read_b64_tr_b16 v[218:219], v241 offset:6280
buffer_load_dwordx4 v250, s[16:19], s65 offen lds
v_mfma_f32_16x16x32_bf16 a[68:71], v[192:195], v[72:75], a[68:71]
s_add_u32 s65, s65, 23552
v_mfma_f32_16x16x32_bf16 a[72:75], v[192:195], v[80:83], a[72:75]
ds_read_b64_tr_b16 v[220:221], v241 offset:12424
v_mfma_f32_16x16x32_bf16 a[72:75], v[196:199], v[84:87], a[72:75]
v_mfma_f32_16x16x32_bf16 a[76:79], v[196:199], v[92:95], a[76:79]
ds_read_b64_tr_b16 v[222:223], v241 offset:18568
v_mfma_f32_16x16x32_bf16 a[76:79], v[192:195], v[88:91], a[76:79]
s_waitcnt lgkmcnt(8)
v_mfma_f32_16x16x32_bf16 a[80:83], v[200:203], v[64:67], a[80:83]
ds_read_b64_tr_b16 v[224:225], v240 offset:256
buffer_load_dwordx4 v250, s[16:19], s65 offen offset:1024 lds
v_mfma_f32_16x16x32_bf16 a[80:83], v[204:207], v[68:71], a[80:83]
s_add_u32 s65, s65, 173056
v_mfma_f32_16x16x32_bf16 a[84:87], v[204:207], v[76:79], a[84:87]
ds_read_b64_tr_b16 v[226:227], v240 offset:6400
v_mfma_f32_16x16x32_bf16 a[84:87], v[200:203], v[72:75], a[84:87]
v_mfma_f32_16x16x32_bf16 a[88:91], v[200:203], v[80:83], a[88:91]
ds_read_b64_tr_b16 v[228:229], v240 offset:12544
v_mfma_f32_16x16x32_bf16 a[88:91], v[204:207], v[84:87], a[88:91]
v_mfma_f32_16x16x32_bf16 a[92:95], v[204:207], v[92:95], a[92:95]
ds_read_b64_tr_b16 v[230:231], v240 offset:18688
buffer_load_dwordx4 v[128:131], v251, s[20:23], s66 offen sc1
v_mfma_f32_16x16x32_bf16 a[92:95], v[200:203], v[88:91], a[92:95]
s_waitcnt lgkmcnt(8)
v_mfma_f32_16x16x32_bf16 a[96:99], v[208:211], v[64:67], a[96:99]
ds_read_b64_tr_b16 v[232:233], v240 offset:264
v_mfma_f32_16x16x32_bf16 a[96:99], v[212:215], v[68:71], a[96:99]
v_mfma_f32_16x16x32_bf16 a[100:103], v[212:215], v[76:79], a[100:103]
ds_read_b64_tr_b16 v[234:235], v240 offset:6408
v_mfma_f32_16x16x32_bf16 a[100:103], v[208:211], v[72:75], a[100:103]
buffer_load_dwordx4 v[132:135], v251, s[20:23], s66 offen offset:1024 sc1
v_mfma_f32_16x16x32_bf16 a[104:107], v[208:211], v[80:83], a[104:107]
ds_read_b64_tr_b16 v[236:237], v240 offset:12552
v_mfma_f32_16x16x32_bf16 a[104:107], v[212:215], v[84:87], a[104:107]
v_mfma_f32_16x16x32_bf16 a[108:111], v[212:215], v[92:95], a[108:111]
ds_read_b64_tr_b16 v[238:239], v240 offset:18696
v_mfma_f32_16x16x32_bf16 a[108:111], v[208:211], v[88:91], a[108:111]
s_waitcnt lgkmcnt(8)
v_mfma_f32_16x16x32_bf16 a[112:115], v[216:219], v[64:67], a[112:115]
ds_read_b64_tr_b16 v[192:193], v241 offset:256
v_mfma_f32_16x16x32_bf16 a[112:115], v[220:223], v[68:71], a[112:115]
buffer_load_dwordx4 v[136:139], v252, s[20:23], s66 offen sc1
v_mfma_f32_16x16x32_bf16 a[116:119], v[220:223], v[76:79], a[116:119]
ds_read_b64_tr_b16 v[194:195], v241 offset:6400
v_mfma_f32_16x16x32_bf16 a[116:119], v[216:219], v[72:75], a[116:119]
v_mfma_f32_16x16x32_bf16 a[120:123], v[216:219], v[80:83], a[120:123]
ds_read_b64_tr_b16 v[196:197], v241 offset:12544
v_mfma_f32_16x16x32_bf16 a[120:123], v[220:223], v[84:87], a[120:123]
v_mfma_f32_16x16x32_bf16 a[124:127], v[220:223], v[92:95], a[124:127]
ds_read_b64_tr_b16 v[198:199], v241 offset:18688
v_mfma_f32_16x16x32_bf16 a[124:127], v[216:219], v[88:91], a[124:127]
s_waitcnt lgkmcnt(8)
buffer_load_dwordx4 v[140:143], v252, s[20:23], s66 offen offset:1024 sc1
v_mfma_f32_16x16x32_bf16 a[128:131], v[224:227], v[64:67], a[128:131]
ds_read_b64_tr_b16 v[200:201], v241 offset:264
v_mfma_f32_16x16x32_bf16 a[128:131], v[228:231], v[68:71], a[128:131]
v_mfma_f32_16x16x32_bf16 a[132:135], v[228:231], v[76:79], a[132:135]
ds_read_b64_tr_b16 v[202:203], v241 offset:6408
v_mfma_f32_16x16x32_bf16 a[132:135], v[224:227], v[72:75], a[132:135]
v_mfma_f32_16x16x32_bf16 a[136:139], v[224:227], v[80:83], a[136:139]
ds_read_b64_tr_b16 v[204:205], v241 offset:12552
buffer_load_dwordx4 v[144:147], v253, s[20:23], s66 offen sc1
v_mfma_f32_16x16x32_bf16 a[136:139], v[228:231], v[84:87], a[136:139]
v_mfma_f32_16x16x32_bf16 a[140:143], v[228:231], v[92:95], a[140:143]
ds_read_b64_tr_b16 v[206:207], v241 offset:18696
v_mfma_f32_16x16x32_bf16 a[140:143], v[224:227], v[88:91], a[140:143]
s_waitcnt lgkmcnt(8)
v_mfma_f32_16x16x32_bf16 a[144:147], v[232:235], v[64:67], a[144:147]
ds_read_b64_tr_b16 v[208:209], v244
v_mfma_f32_16x16x32_bf16 a[144:147], v[236:239], v[68:71], a[144:147]
v_mfma_f32_16x16x32_bf16 a[148:151], v[236:239], v[76:79], a[148:151]
ds_read_b64_tr_b16 v[210:211], v244 offset:2048
buffer_load_dwordx4 v[148:151], v253, s[20:23], s66 offen offset:1024 sc1
v_mfma_f32_16x16x32_bf16 a[148:151], v[232:235], v[72:75], a[148:151]
v_mfma_f32_16x16x32_bf16 a[152:155], v[232:235], v[80:83], a[152:155]
ds_read_b64_tr_b16 v[212:213], v244 offset:4096
v_mfma_f32_16x16x32_bf16 a[152:155], v[236:239], v[84:87], a[152:155]
v_mfma_f32_16x16x32_bf16 a[156:159], v[236:239], v[92:95], a[156:159]
ds_read_b64_tr_b16 v[214:215], v244 offset:6144
v_mfma_f32_16x16x32_bf16 a[156:159], v[232:235], v[88:91], a[156:159]
s_waitcnt lgkmcnt(8)
buffer_load_dwordx4 v[152:155], v254, s[20:23], s66 offen sc1
v_mfma_f32_16x16x32_bf16 a[160:163], v[192:195], v[64:67], a[160:163]
ds_read_b64_tr_b16 v[216:217], v245
v_mfma_f32_16x16x32_bf16 a[160:163], v[196:199], v[68:71], a[160:163]
v_mfma_f32_16x16x32_bf16 a[164:167], v[196:199], v[76:79], a[164:167]
ds_read_b64_tr_b16 v[218:219], v245 offset:2048
v_mfma_f32_16x16x32_bf16 a[164:167], v[192:195], v[72:75], a[164:167]
v_mfma_f32_16x16x32_bf16 a[168:171], v[192:195], v[80:83], a[168:171]
ds_read_b64_tr_b16 v[220:221], v245 offset:4096
v_mfma_f32_16x16x32_bf16 a[168:171], v[196:199], v[84:87], a[168:171]
buffer_load_dwordx4 v[156:159], v254, s[20:23], s66 offen offset:1024 sc1
v_mfma_f32_16x16x32_bf16 a[172:175], v[196:199], v[92:95], a[172:175]
s_add_u32 s66, s66, 2048
s_add_u32 s57, s68, 0
ds_read_b64_tr_b16 v[222:223], v245 offset:6144
v_mfma_f32_16x16x32_bf16 a[172:175], v[192:195], v[88:91], a[172:175]
s_waitcnt lgkmcnt(8)
s_add_u32 m0, s68, 0
v_mfma_f32_16x16x32_bf16 a[176:179], v[200:203], v[64:67], a[176:179]
ds_read_b64_tr_b16 v[224:225], v246
v_mfma_f32_16x16x32_bf16 a[176:179], v[204:207], v[68:71], a[176:179]
v_mfma_f32_16x16x32_bf16 a[180:183], v[204:207], v[76:79], a[180:183]
ds_read_b64_tr_b16 v[226:227], v246 offset:2048
v_mfma_f32_16x16x32_bf16 a[180:183], v[200:203], v[72:75], a[180:183]
buffer_load_dwordx4 v7, s[4:7], s57 offen lds
v_mfma_f32_16x16x32_bf16 a[184:187], v[200:203], v[80:83], a[184:187]
ds_read_b64_tr_b16 v[228:229], v246 offset:4096
v_mfma_f32_16x16x32_bf16 a[184:187], v[204:207], v[84:87], a[184:187]
v_mfma_f32_16x16x32_bf16 a[188:191], v[204:207], v[92:95], a[188:191]
ds_read_b64_tr_b16 v[230:231], v246 offset:6144
v_mfma_f32_16x16x32_bf16 a[188:191], v[200:203], v[88:91], a[188:191]
s_waitcnt lgkmcnt(8)
v_mfma_f32_16x16x32_bf16 v[160:163], v[208:211], v[64:67], v[160:163]
ds_read_b64_tr_b16 v[232:233], v255
buffer_load_dwordx4 v8, s[4:7], s57 offen offset:1024 lds
v_mfma_f32_16x16x32_bf16 v[160:163], v[212:215], v[68:71], v[160:163]
v_mfma_f32_16x16x32_bf16 v[164:167], v[212:215], v[76:79], v[164:167]
ds_read_b64_tr_b16 v[234:235], v255 offset:2048
v_mfma_f32_16x16x32_bf16 v[164:167], v[208:211], v[72:75], v[164:167]
v_mfma_f32_16x16x32_bf16 v[168:171], v[208:211], v[80:83], v[168:171]
ds_read_b64_tr_b16 v[236:237], v255 offset:4096
v_mfma_f32_16x16x32_bf16 v[168:171], v[212:215], v[84:87], v[168:171]
v_mfma_f32_16x16x32_bf16 v[172:175], v[212:215], v[92:95], v[172:175]
ds_read_b64_tr_b16 v[238:239], v255 offset:6144
buffer_load_dwordx4 v9, s[4:7], s57 offen offset:2048 lds
v_mfma_f32_16x16x32_bf16 v[172:175], v[208:211], v[88:91], v[172:175]
s_waitcnt lgkmcnt(8)
s_add_u32 s57, s68, 3072
s_add_u32 m0, s68, 3072
v_mfma_f32_16x16x32_bf16 v[176:179], v[216:219], v[64:67], v[176:179]
v_mfma_f32_16x16x32_bf16 v[176:179], v[220:223], v[68:71], v[176:179]
v_mfma_f32_16x16x32_bf16 v[180:183], v[220:223], v[76:79], v[180:183]
v_mfma_f32_16x16x32_bf16 v[180:183], v[216:219], v[72:75], v[180:183]
v_mfma_f32_16x16x32_bf16 v[184:187], v[216:219], v[80:83], v[184:187]
buffer_load_dwordx4 v7, s[4:7], s57 offen lds
v_mfma_f32_16x16x32_bf16 v[184:187], v[220:223], v[84:87], v[184:187]
v_mfma_f32_16x16x32_bf16 v[188:191], v[220:223], v[92:95], v[188:191]
s_waitcnt vmcnt(29) lgkmcnt(0)
s_barrier
v_mfma_f32_16x16x32_bf16 v[188:191], v[216:219], v[88:91], v[188:191]
s_waitcnt lgkmcnt(0)
ds_read_b64_tr_b16 v[192:193], v240 offset:24576
v_mfma_f32_16x16x32_bf16 v[16:19], v[224:227], v[64:67], v[16:19]
ds_read_b64_tr_b16 v[194:195], v240 offset:30720
v_mfma_f32_16x16x32_bf16 v[16:19], v[228:231], v[68:71], v[16:19]
ds_read_b64_tr_b16 v[196:197], v240 offset:36864
buffer_load_dwordx4 v8, s[4:7], s57 offen offset:1024 lds
v_mfma_f32_16x16x32_bf16 v[20:23], v[228:231], v[76:79], v[20:23]
ds_read_b64_tr_b16 v[198:199], v240 offset:43008
v_mfma_f32_16x16x32_bf16 v[20:23], v[224:227], v[72:75], v[20:23]
v_mfma_f32_16x16x32_bf16 v[24:27], v[224:227], v[80:83], v[24:27]
ds_read_b64_tr_b16 v[200:201], v240 offset:24584
v_mfma_f32_16x16x32_bf16 v[24:27], v[228:231], v[84:87], v[24:27]
ds_read_b64_tr_b16 v[202:203], v240 offset:30728
v_mfma_f32_16x16x32_bf16 v[28:31], v[228:231], v[92:95], v[28:31]
ds_read_b64_tr_b16 v[204:205], v240 offset:36872
v_mfma_f32_16x16x32_bf16 v[28:31], v[224:227], v[88:91], v[28:31]
s_waitcnt lgkmcnt(7)
ds_read_b64_tr_b16 v[206:207], v240 offset:43016
buffer_load_dwordx4 v9, s[4:7], s57 offen offset:2048 lds
v_mfma_f32_16x16x32_bf16 v[48:51], v[232:235], v[64:67], v[48:51]
v_mfma_f32_16x16x32_bf16 v[48:51], v[236:239], v[68:71], v[48:51]
ds_read_b64_tr_b16 v[208:209], v241 offset:24576
v_mfma_f32_16x16x32_bf16 v[52:55], v[236:239], v[76:79], v[52:55]
ds_read_b64_tr_b16 v[210:211], v241 offset:30720
v_mfma_f32_16x16x32_bf16 v[52:55], v[232:235], v[72:75], v[52:55]
ds_read_b64_tr_b16 v[212:213], v241 offset:36864
v_mfma_f32_16x16x32_bf16 v[56:59], v[232:235], v[80:83], v[56:59]
ds_read_b64_tr_b16 v[214:215], v241 offset:43008
v_mfma_f32_16x16x32_bf16 v[56:59], v[236:239], v[84:87], v[56:59]
v_mfma_f32_16x16x32_bf16 v[60:63], v[236:239], v[92:95], v[60:63]
s_waitcnt vmcnt(23)
v_mfma_f32_16x16x32_bf16 v[60:63], v[232:235], v[88:91], v[60:63]
s_waitcnt lgkmcnt(8)
v_mfma_f32_16x16x32_bf16 a[0:3], v[192:195], v[96:99], a[0:3]
s_add_u32 m0, s68, 73728
ds_read_b64_tr_b16 v[216:217], v241 offset:24584
v_mfma_f32_16x16x32_bf16 a[0:3], v[196:199], v[100:103], a[0:3]
buffer_load_dwordx4 v247, s[12:15], s64 offen lds
v_mfma_f32_16x16x32_bf16 a[4:7], v[196:199], v[108:111], a[4:7]
ds_read_b64_tr_b16 v[218:219], v241 offset:30728
v_mfma_f32_16x16x32_bf16 a[4:7], v[192:195], v[104:107], a[4:7]
v_mfma_f32_16x16x32_bf16 a[8:11], v[192:195], v[112:115], a[8:11]
ds_read_b64_tr_b16 v[220:221], v241 offset:36872
v_mfma_f32_16x16x32_bf16 a[8:11], v[196:199], v[116:119], a[8:11]
v_mfma_f32_16x16x32_bf16 a[12:15], v[196:199], v[124:127], a[12:15]
ds_read_b64_tr_b16 v[222:223], v241 offset:43016
buffer_load_dwordx4 v248, s[12:15], s64 offen offset:1024 lds
v_mfma_f32_16x16x32_bf16 a[12:15], v[192:195], v[120:123], a[12:15]
s_waitcnt lgkmcnt(8)
v_mfma_f32_16x16x32_bf16 a[16:19], v[200:203], v[96:99], a[16:19]
ds_read_b64_tr_b16 v[224:225], v240 offset:24704
v_mfma_f32_16x16x32_bf16 a[16:19], v[204:207], v[100:103], a[16:19]
v_mfma_f32_16x16x32_bf16 a[20:23], v[204:207], v[108:111], a[20:23]
ds_read_b64_tr_b16 v[226:227], v240 offset:30848
v_mfma_f32_16x16x32_bf16 a[20:23], v[200:203], v[104:107], a[20:23]
v_mfma_f32_16x16x32_bf16 a[24:27], v[200:203], v[112:115], a[24:27]
ds_read_b64_tr_b16 v[228:229], v240 offset:36992
buffer_load_dwordx4 v249, s[12:15], s64 offen offset:2048 lds
v_mfma_f32_16x16x32_bf16 a[24:27], v[204:207], v[116:119], a[24:27]
s_add_u32 s64, s64, 98304
s_add_u32 m0, s68, 76800
v_mfma_f32_16x16x32_bf16 a[28:31], v[204:207], v[124:127], a[28:31]
ds_read_b64_tr_b16 v[230:231], v240 offset:43136
v_mfma_f32_16x16x32_bf16 a[28:31], v[200:203], v[120:123], a[28:31]
s_waitcnt lgkmcnt(8)
v_mfma_f32_16x16x32_bf16 a[32:35], v[208:211], v[96:99], a[32:35]
ds_read_b64_tr_b16 v[232:233], v240 offset:24712
v_mfma_f32_16x16x32_bf16 a[32:35], v[212:215], v[100:103], a[32:35]
buffer_load_dwordx4 v247, s[12:15], s64 offen lds
v_mfma_f32_16x16x32_bf16 a[36:39], v[212:215], v[108:111], a[36:39]
ds_read_b64_tr_b16 v[234:235], v240 offset:30856
v_mfma_f32_16x16x32_bf16 a[36:39], v[208:211], v[104:107], a[36:39]
v_mfma_f32_16x16x32_bf16 a[40:43], v[208:211], v[112:115], a[40:43]
ds_read_b64_tr_b16 v[236:237], v240 offset:37000
v_mfma_f32_16x16x32_bf16 a[40:43], v[212:215], v[116:119], a[40:43]
v_mfma_f32_16x16x32_bf16 a[44:47], v[212:215], v[124:127], a[44:47]
ds_read_b64_tr_b16 v[238:239], v240 offset:43144
v_mfma_f32_16x16x32_bf16 a[44:47], v[208:211], v[120:123], a[44:47]
s_waitcnt lgkmcnt(8)
buffer_load_dwordx4 v248, s[12:15], s64 offen offset:1024 lds
v_mfma_f32_16x16x32_bf16 a[48:51], v[216:219], v[96:99], a[48:51]
ds_read_b64_tr_b16 v[192:193], v241 offset:24704
v_mfma_f32_16x16x32_bf16 a[48:51], v[220:223], v[100:103], a[48:51]
v_mfma_f32_16x16x32_bf16 a[52:55], v[220:223], v[108:111], a[52:55]
ds_read_b64_tr_b16 v[194:195], v241 offset:30848
v_mfma_f32_16x16x32_bf16 a[52:55], v[216:219], v[104:107], a[52:55]
v_mfma_f32_16x16x32_bf16 a[56:59], v[216:219], v[112:115], a[56:59]
ds_read_b64_tr_b16 v[196:197], v241 offset:36992
v_mfma_f32_16x16x32_bf16 a[56:59], v[220:223], v[116:119], a[56:59]
buffer_load_dwordx4 v249, s[12:15], s64 offen offset:2048 lds
v_mfma_f32_16x16x32_bf16 a[60:63], v[220:223], v[124:127], a[60:63]
s_add_u32 s64, s64, 688128
s_add_u32 m0, s61, 49152
ds_read_b64_tr_b16 v[198:199], v241 offset:43136
v_mfma_f32_16x16x32_bf16 a[60:63], v[216:219], v[120:123], a[60:63]
s_waitcnt lgkmcnt(8)
v_mfma_f32_16x16x32_bf16 a[64:67], v[224:227], v[96:99], a[64:67]
ds_read_b64_tr_b16 v[200:201], v241 offset:24712
v_mfma_f32_16x16x32_bf16 a[64:67], v[228:231], v[100:103], a[64:67]
v_mfma_f32_16x16x32_bf16 a[68:71], v[228:231], v[108:111], a[68:71]
ds_read_b64_tr_b16 v[202:203], v241 offset:30856
buffer_load_dwordx4 v250, s[16:19], s65 offen lds
v_mfma_f32_16x16x32_bf16 a[68:71], v[224:227], v[104:107], a[68:71]
s_add_u32 s65, s65, 23552
v_mfma_f32_16x16x32_bf16 a[72:75], v[224:227], v[112:115], a[72:75]
ds_read_b64_tr_b16 v[204:205], v241 offset:37000
v_mfma_f32_16x16x32_bf16 a[72:75], v[228:231], v[116:119], a[72:75]
v_mfma_f32_16x16x32_bf16 a[76:79], v[228:231], v[124:127], a[76:79]
ds_read_b64_tr_b16 v[206:207], v241 offset:43144
v_mfma_f32_16x16x32_bf16 a[76:79], v[224:227], v[120:123], a[76:79]
s_waitcnt lgkmcnt(8)
v_mfma_f32_16x16x32_bf16 a[80:83], v[232:235], v[96:99], a[80:83]
ds_read_b64_tr_b16 v[208:209], v240 offset:24832
buffer_load_dwordx4 v250, s[16:19], s65 offen offset:1024 lds
v_mfma_f32_16x16x32_bf16 a[80:83], v[236:239], v[100:103], a[80:83]
s_add_u32 s65, s65, 173056
v_mfma_f32_16x16x32_bf16 a[84:87], v[236:239], v[108:111], a[84:87]
ds_read_b64_tr_b16 v[210:211], v240 offset:30976
v_mfma_f32_16x16x32_bf16 a[84:87], v[232:235], v[104:107], a[84:87]
v_mfma_f32_16x16x32_bf16 a[88:91], v[232:235], v[112:115], a[88:91]
ds_read_b64_tr_b16 v[212:213], v240 offset:37120
v_mfma_f32_16x16x32_bf16 a[88:91], v[236:239], v[116:119], a[88:91]
v_mfma_f32_16x16x32_bf16 a[92:95], v[236:239], v[124:127], a[92:95]
ds_read_b64_tr_b16 v[214:215], v240 offset:43264
buffer_load_dwordx4 v[64:67], v251, s[20:23], s66 offen sc1
v_mfma_f32_16x16x32_bf16 a[92:95], v[232:235], v[120:123], a[92:95]
s_waitcnt lgkmcnt(8)
v_mfma_f32_16x16x32_bf16 a[96:99], v[192:195], v[96:99], a[96:99]
ds_read_b64_tr_b16 v[216:217], v240 offset:24840
v_mfma_f32_16x16x32_bf16 a[96:99], v[196:199], v[100:103], a[96:99]
v_mfma_f32_16x16x32_bf16 a[100:103], v[196:199], v[108:111], a[100:103]
ds_read_b64_tr_b16 v[218:219], v240 offset:30984
v_mfma_f32_16x16x32_bf16 a[100:103], v[192:195], v[104:107], a[100:103]
buffer_load_dwordx4 v[68:71], v251, s[20:23], s66 offen offset:1024 sc1
v_mfma_f32_16x16x32_bf16 a[104:107], v[192:195], v[112:115], a[104:107]
ds_read_b64_tr_b16 v[220:221], v240 offset:37128
v_mfma_f32_16x16x32_bf16 a[104:107], v[196:199], v[116:119], a[104:107]
v_mfma_f32_16x16x32_bf16 a[108:111], v[196:199], v[124:127], a[108:111]
ds_read_b64_tr_b16 v[222:223], v240 offset:43272
v_mfma_f32_16x16x32_bf16 a[108:111], v[192:195], v[120:123], a[108:111]
s_waitcnt lgkmcnt(8)
v_mfma_f32_16x16x32_bf16 a[112:115], v[200:203], v[96:99], a[112:115]
ds_read_b64_tr_b16 v[224:225], v241 offset:24832
v_mfma_f32_16x16x32_bf16 a[112:115], v[204:207], v[100:103], a[112:115]
buffer_load_dwordx4 v[72:75], v252, s[20:23], s66 offen sc1
v_mfma_f32_16x16x32_bf16 a[116:119], v[204:207], v[108:111], a[116:119]
ds_read_b64_tr_b16 v[226:227], v241 offset:30976
v_mfma_f32_16x16x32_bf16 a[116:119], v[200:203], v[104:107], a[116:119]
v_mfma_f32_16x16x32_bf16 a[120:123], v[200:203], v[112:115], a[120:123]
ds_read_b64_tr_b16 v[228:229], v241 offset:37120
v_mfma_f32_16x16x32_bf16 a[120:123], v[204:207], v[116:119], a[120:123]
v_mfma_f32_16x16x32_bf16 a[124:127], v[204:207], v[124:127], a[124:127]
ds_read_b64_tr_b16 v[230:231], v241 offset:43264
v_mfma_f32_16x16x32_bf16 a[124:127], v[200:203], v[120:123], a[124:127]
s_waitcnt lgkmcnt(8)
buffer_load_dwordx4 v[76:79], v252, s[20:23], s66 offen offset:1024 sc1
v_mfma_f32_16x16x32_bf16 a[128:131], v[208:211], v[96:99], a[128:131]
ds_read_b64_tr_b16 v[232:233], v241 offset:24840
v_mfma_f32_16x16x32_bf16 a[128:131], v[212:215], v[100:103], a[128:131]
v_mfma_f32_16x16x32_bf16 a[132:135], v[212:215], v[108:111], a[132:135]
ds_read_b64_tr_b16 v[234:235], v241 offset:30984
v_mfma_f32_16x16x32_bf16 a[132:135], v[208:211], v[104:107], a[132:135]
v_mfma_f32_16x16x32_bf16 a[136:139], v[208:211], v[112:115], a[136:139]
ds_read_b64_tr_b16 v[236:237], v241 offset:37128
buffer_load_dwordx4 v[80:83], v253, s[20:23], s66 offen sc1
v_mfma_f32_16x16x32_bf16 a[136:139], v[212:215], v[116:119], a[136:139]
v_mfma_f32_16x16x32_bf16 a[140:143], v[212:215], v[124:127], a[140:143]
ds_read_b64_tr_b16 v[238:239], v241 offset:43272
v_mfma_f32_16x16x32_bf16 a[140:143], v[208:211], v[120:123], a[140:143]
s_waitcnt lgkmcnt(8)
v_mfma_f32_16x16x32_bf16 a[144:147], v[216:219], v[96:99], a[144:147]
ds_read_b64_tr_b16 v[192:193], v244 offset:8192
v_mfma_f32_16x16x32_bf16 a[144:147], v[220:223], v[100:103], a[144:147]
v_mfma_f32_16x16x32_bf16 a[148:151], v[220:223], v[108:111], a[148:151]
ds_read_b64_tr_b16 v[194:195], v244 offset:10240
buffer_load_dwordx4 v[84:87], v253, s[20:23], s66 offen offset:1024 sc1
v_mfma_f32_16x16x32_bf16 a[148:151], v[216:219], v[104:107], a[148:151]
v_mfma_f32_16x16x32_bf16 a[152:155], v[216:219], v[112:115], a[152:155]
ds_read_b64_tr_b16 v[196:197], v244 offset:12288
v_mfma_f32_16x16x32_bf16 a[152:155], v[220:223], v[116:119], a[152:155]
v_mfma_f32_16x16x32_bf16 a[156:159], v[220:223], v[124:127], a[156:159]
ds_read_b64_tr_b16 v[198:199], v244 offset:14336
v_mfma_f32_16x16x32_bf16 a[156:159], v[216:219], v[120:123], a[156:159]
s_waitcnt lgkmcnt(8)
buffer_load_dwordx4 v[88:91], v254, s[20:23], s66 offen sc1
v_mfma_f32_16x16x32_bf16 a[160:163], v[224:227], v[96:99], a[160:163]
ds_read_b64_tr_b16 v[200:201], v245 offset:8192
v_mfma_f32_16x16x32_bf16 a[160:163], v[228:231], v[100:103], a[160:163]
v_mfma_f32_16x16x32_bf16 a[164:167], v[228:231], v[108:111], a[164:167]
ds_read_b64_tr_b16 v[202:203], v245 offset:10240
v_mfma_f32_16x16x32_bf16 a[164:167], v[224:227], v[104:107], a[164:167]
v_mfma_f32_16x16x32_bf16 a[168:171], v[224:227], v[112:115], a[168:171]
ds_read_b64_tr_b16 v[204:205], v245 offset:12288
v_mfma_f32_16x16x32_bf16 a[168:171], v[228:231], v[116:119], a[168:171]
buffer_load_dwordx4 v[92:95], v254, s[20:23], s66 offen offset:1024 sc1
v_mfma_f32_16x16x32_bf16 a[172:175], v[228:231], v[124:127], a[172:175]
s_add_u32 s66, s66, 2048
s_add_u32 s57, s68, 24576
ds_read_b64_tr_b16 v[206:207], v245 offset:14336
v_mfma_f32_16x16x32_bf16 a[172:175], v[224:227], v[120:123], a[172:175]
s_waitcnt lgkmcnt(8)
s_add_u32 m0, s68, 24576
v_mfma_f32_16x16x32_bf16 a[176:179], v[232:235], v[96:99], a[176:179]
ds_read_b64_tr_b16 v[208:209], v246 offset:8192
v_mfma_f32_16x16x32_bf16 a[176:179], v[236:239], v[100:103], a[176:179]
v_mfma_f32_16x16x32_bf16 a[180:183], v[236:239], v[108:111], a[180:183]
ds_read_b64_tr_b16 v[210:211], v246 offset:10240
v_mfma_f32_16x16x32_bf16 a[180:183], v[232:235], v[104:107], a[180:183]
buffer_load_dwordx4 v7, s[4:7], s57 offen lds
v_mfma_f32_16x16x32_bf16 a[184:187], v[232:235], v[112:115], a[184:187]
ds_read_b64_tr_b16 v[212:213], v246 offset:12288
v_mfma_f32_16x16x32_bf16 a[184:187], v[236:239], v[116:119], a[184:187]
v_mfma_f32_16x16x32_bf16 a[188:191], v[236:239], v[124:127], a[188:191]
ds_read_b64_tr_b16 v[214:215], v246 offset:14336
v_mfma_f32_16x16x32_bf16 a[188:191], v[232:235], v[120:123], a[188:191]
s_waitcnt lgkmcnt(8)
v_mfma_f32_16x16x32_bf16 v[160:163], v[192:195], v[96:99], v[160:163]
ds_read_b64_tr_b16 v[216:217], v255 offset:8192
buffer_load_dwordx4 v8, s[4:7], s57 offen offset:1024 lds
v_mfma_f32_16x16x32_bf16 v[160:163], v[196:199], v[100:103], v[160:163]
v_mfma_f32_16x16x32_bf16 v[164:167], v[196:199], v[108:111], v[164:167]
ds_read_b64_tr_b16 v[218:219], v255 offset:10240
v_mfma_f32_16x16x32_bf16 v[164:167], v[192:195], v[104:107], v[164:167]
v_mfma_f32_16x16x32_bf16 v[168:171], v[192:195], v[112:115], v[168:171]
ds_read_b64_tr_b16 v[220:221], v255 offset:12288
v_mfma_f32_16x16x32_bf16 v[168:171], v[196:199], v[116:119], v[168:171]
v_mfma_f32_16x16x32_bf16 v[172:175], v[196:199], v[124:127], v[172:175]
ds_read_b64_tr_b16 v[222:223], v255 offset:14336
buffer_load_dwordx4 v9, s[4:7], s57 offen offset:2048 lds
v_mfma_f32_16x16x32_bf16 v[172:175], v[192:195], v[120:123], v[172:175]
s_waitcnt lgkmcnt(8)
s_add_u32 s57, s68, 27648
s_add_u32 m0, s68, 27648
v_mfma_f32_16x16x32_bf16 v[176:179], v[200:203], v[96:99], v[176:179]
v_mfma_f32_16x16x32_bf16 v[176:179], v[204:207], v[100:103], v[176:179]
v_mfma_f32_16x16x32_bf16 v[180:183], v[204:207], v[108:111], v[180:183]
v_mfma_f32_16x16x32_bf16 v[180:183], v[200:203], v[104:107], v[180:183]
v_mfma_f32_16x16x32_bf16 v[184:187], v[200:203], v[112:115], v[184:187]
buffer_load_dwordx4 v7, s[4:7], s57 offen lds
v_mfma_f32_16x16x32_bf16 v[184:187], v[204:207], v[116:119], v[184:187]
v_mfma_f32_16x16x32_bf16 v[188:191], v[204:207], v[124:127], v[188:191]
s_waitcnt vmcnt(34) lgkmcnt(0)
s_barrier
v_mfma_f32_16x16x32_bf16 v[188:191], v[200:203], v[120:123], v[188:191]
s_waitcnt lgkmcnt(0)
ds_read_b64_tr_b16 v[224:225], v242
v_mfma_f32_16x16x32_bf16 v[16:19], v[208:211], v[96:99], v[16:19]
ds_read_b64_tr_b16 v[226:227], v242 offset:6144
v_mfma_f32_16x16x32_bf16 v[16:19], v[212:215], v[100:103], v[16:19]
ds_read_b64_tr_b16 v[228:229], v242 offset:12288
buffer_load_dwordx4 v8, s[4:7], s57 offen offset:1024 lds
v_mfma_f32_16x16x32_bf16 v[20:23], v[212:215], v[108:111], v[20:23]
ds_read_b64_tr_b16 v[230:231], v242 offset:18432
v_mfma_f32_16x16x32_bf16 v[20:23], v[208:211], v[104:107], v[20:23]
v_mfma_f32_16x16x32_bf16 v[24:27], v[208:211], v[112:115], v[24:27]
ds_read_b64_tr_b16 v[232:233], v242 offset:8
v_mfma_f32_16x16x32_bf16 v[24:27], v[212:215], v[116:119], v[24:27]
ds_read_b64_tr_b16 v[234:235], v242 offset:6152
v_mfma_f32_16x16x32_bf16 v[28:31], v[212:215], v[124:127], v[28:31]
ds_read_b64_tr_b16 v[236:237], v242 offset:12296
v_mfma_f32_16x16x32_bf16 v[28:31], v[208:211], v[120:123], v[28:31]
s_waitcnt lgkmcnt(7)
ds_read_b64_tr_b16 v[238:239], v242 offset:18440
buffer_load_dwordx4 v9, s[4:7], s57 offen offset:2048 lds
v_mfma_f32_16x16x32_bf16 v[48:51], v[216:219], v[96:99], v[48:51]
v_mfma_f32_16x16x32_bf16 v[48:51], v[220:223], v[100:103], v[48:51]
ds_read_b64_tr_b16 v[192:193], v243
v_mfma_f32_16x16x32_bf16 v[52:55], v[220:223], v[108:111], v[52:55]
ds_read_b64_tr_b16 v[194:195], v243 offset:6144
v_mfma_f32_16x16x32_bf16 v[52:55], v[216:219], v[104:107], v[52:55]
ds_read_b64_tr_b16 v[196:197], v243 offset:12288
v_mfma_f32_16x16x32_bf16 v[56:59], v[216:219], v[112:115], v[56:59]
ds_read_b64_tr_b16 v[198:199], v243 offset:18432
v_mfma_f32_16x16x32_bf16 v[56:59], v[220:223], v[116:119], v[56:59]
v_mfma_f32_16x16x32_bf16 v[60:63], v[220:223], v[124:127], v[60:63]
s_waitcnt vmcnt(28)
v_mfma_f32_16x16x32_bf16 v[60:63], v[216:219], v[120:123], v[60:63]
s_waitcnt lgkmcnt(8)
v_mfma_f32_16x16x32_bf16 a[0:3], v[224:227], v[128:131], a[0:3]
s_add_u32 s57, s68, 0
s_add_u32 m0, s68, 98304
ds_read_b64_tr_b16 v[200:201], v243 offset:8
v_mfma_f32_16x16x32_bf16 a[0:3], v[228:231], v[132:135], a[0:3]
buffer_load_dwordx4 v7, s[8:11], s57 offen lds
v_mfma_f32_16x16x32_bf16 a[4:7], v[228:231], v[140:143], a[4:7]
s_mov_b32 s64, 0x3dd53b95
ds_read_b64_tr_b16 v[202:203], v243 offset:6152
v_mfma_f32_16x16x32_bf16 a[4:7], v[224:227], v[136:139], a[4:7]
s_mov_b32 s65, 0xc2b669c2
v_mfma_f32_16x16x32_bf16 a[8:11], v[224:227], v[144:147], a[8:11]
s_mul_i32 s66, s55, 245760
ds_read_b64_tr_b16 v[204:205], v243 offset:12296
v_mfma_f32_16x16x32_bf16 a[8:11], v[228:231], v[148:151], a[8:11]
s_add_u32 s66, s66, 4390912
v_mfma_f32_16x16x32_bf16 a[12:15], v[228:231], v[156:159], a[12:15]
s_mul_i32 s67, s69, 3072
ds_read_b64_tr_b16 v[206:207], v243 offset:18440
v_mfma_f32_16x16x32_bf16 a[12:15], v[224:227], v[152:155], a[12:15]
s_waitcnt lgkmcnt(8)
s_add_u32 s59, s66, s67
v_mfma_f32_16x16x32_bf16 a[16:19], v[232:235], v[128:131], a[16:19]
s_add_u32 s58, s59, 1024
ds_read_b64_tr_b16 v[208:209], v242 offset:128
v_mfma_f32_16x16x32_bf16 a[16:19], v[236:239], v[132:135], a[16:19]
s_lshl_b32 s13, s72, 1
v_mfma_f32_16x16x32_bf16 a[20:23], v[236:239], v[140:143], a[20:23]
s_add_u32 s13, s13, s77
ds_read_b64_tr_b16 v[210:211], v242 offset:6272
v_mfma_f32_16x16x32_bf16 a[20:23], v[232:235], v[136:139], a[20:23]
s_lshl_b32 s13, s13, 8
v_mfma_f32_16x16x32_bf16 a[24:27], v[232:235], v[144:147], a[24:27]
s_add_u32 s14, s13, 75513856
ds_read_b64_tr_b16 v[212:213], v242 offset:12416
v_mfma_f32_16x16x32_bf16 a[24:27], v[236:239], v[148:151], a[24:27]
s_lshl_b32 s74, s3, 1
v_mfma_f32_16x16x32_bf16 a[28:31], v[236:239], v[156:159], a[28:31]
s_add_u32 s74, s74, s76
ds_read_b64_tr_b16 v[214:215], v242 offset:18560
v_mfma_f32_16x16x32_bf16 a[28:31], v[232:235], v[152:155], a[28:31]
s_waitcnt lgkmcnt(8)
s_lshl_b32 s74, s74, 2
v_mfma_f32_16x16x32_bf16 a[32:35], v[192:195], v[128:131], a[32:35]
s_lshl_b32 s12, 15, s74
ds_read_b64_tr_b16 v[216:217], v242 offset:136
v_mfma_f32_16x16x32_bf16 a[32:35], v[196:199], v[132:135], a[32:35]
s_lshl_b32 s74, s3, 3
v_mfma_f32_16x16x32_bf16 a[36:39], v[196:199], v[140:143], a[36:39]
s_lshl_b32 s67, s76, 1
ds_read_b64_tr_b16 v[218:219], v242 offset:6280
v_mfma_f32_16x16x32_bf16 a[36:39], v[192:195], v[136:139], a[36:39]
s_add_u32 s74, s74, s67
v_mfma_f32_16x16x32_bf16 a[40:43], v[192:195], v[144:147], a[40:43]
s_lshl_b32 s60, 0x33, s74
ds_read_b64_tr_b16 v[220:221], v242 offset:12424
v_mfma_f32_16x16x32_bf16 a[40:43], v[196:199], v[148:151], a[40:43]
s_lshl_b32 s74, s55, 6
buffer_load_dwordx4 v8, s[8:11], s57 offen offset:1024 lds
v_mfma_f32_16x16x32_bf16 a[44:47], v[196:199], v[156:159], a[44:47]
s_and_b32 s74, s74, 0xffffff00
ds_read_b64_tr_b16 v[222:223], v242 offset:18568
v_mfma_f32_16x16x32_bf16 a[44:47], v[192:195], v[152:155], a[44:47]
s_waitcnt lgkmcnt(8)
s_lshl_b32 s67, s53, 3
v_mfma_f32_16x16x32_bf16 a[48:51], v[200:203], v[128:131], a[48:51]
s_add_u32 s54, s74, s67
ds_read_b64_tr_b16 v[224:225], v243 offset:128
v_mfma_f32_16x16x32_bf16 a[48:51], v[204:207], v[132:135], a[48:51]
v_mfma_f32_16x16x32_bf16 a[52:55], v[204:207], v[140:143], a[52:55]
ds_read_b64_tr_b16 v[226:227], v243 offset:6272
v_mfma_f32_16x16x32_bf16 a[52:55], v[200:203], v[136:139], a[52:55]
v_mfma_f32_16x16x32_bf16 a[56:59], v[200:203], v[144:147], a[56:59]
ds_read_b64_tr_b16 v[228:229], v243 offset:12416
v_mfma_f32_16x16x32_bf16 a[56:59], v[204:207], v[148:151], a[56:59]
v_mfma_f32_16x16x32_bf16 a[60:63], v[204:207], v[156:159], a[60:63]
ds_read_b64_tr_b16 v[230:231], v243 offset:18560
v_mfma_f32_16x16x32_bf16 a[60:63], v[200:203], v[152:155], a[60:63]
s_waitcnt lgkmcnt(8)
v_mfma_f32_16x16x32_bf16 a[64:67], v[208:211], v[128:131], a[64:67]
ds_read_b64_tr_b16 v[232:233], v243 offset:136
v_mfma_f32_16x16x32_bf16 a[64:67], v[212:215], v[132:135], a[64:67]
v_mfma_f32_16x16x32_bf16 a[68:71], v[212:215], v[140:143], a[68:71]
ds_read_b64_tr_b16 v[234:235], v243 offset:6280
v_mfma_f32_16x16x32_bf16 a[68:71], v[208:211], v[136:139], a[68:71]
v_mfma_f32_16x16x32_bf16 a[72:75], v[208:211], v[144:147], a[72:75]
ds_read_b64_tr_b16 v[236:237], v243 offset:12424
v_mfma_f32_16x16x32_bf16 a[72:75], v[212:215], v[148:151], a[72:75]
v_mfma_f32_16x16x32_bf16 a[76:79], v[212:215], v[156:159], a[76:79]
ds_read_b64_tr_b16 v[238:239], v243 offset:18568
v_mfma_f32_16x16x32_bf16 a[76:79], v[208:211], v[152:155], a[76:79]
s_waitcnt lgkmcnt(8)
v_mfma_f32_16x16x32_bf16 a[80:83], v[216:219], v[128:131], a[80:83]
ds_read_b64_tr_b16 v[192:193], v242 offset:256
v_mfma_f32_16x16x32_bf16 a[80:83], v[220:223], v[132:135], a[80:83]
v_mfma_f32_16x16x32_bf16 a[84:87], v[220:223], v[140:143], a[84:87]
ds_read_b64_tr_b16 v[194:195], v242 offset:6400
buffer_load_dwordx4 v9, s[8:11], s57 offen offset:2048 lds
v_mfma_f32_16x16x32_bf16 a[84:87], v[216:219], v[136:139], a[84:87]
s_add_u32 s57, s68, 3072
s_add_u32 m0, s68, 101376
v_mfma_f32_16x16x32_bf16 a[88:91], v[216:219], v[144:147], a[88:91]
ds_read_b64_tr_b16 v[196:197], v242 offset:12544
v_mfma_f32_16x16x32_bf16 a[88:91], v[220:223], v[148:151], a[88:91]
v_mfma_f32_16x16x32_bf16 a[92:95], v[220:223], v[156:159], a[92:95]
ds_read_b64_tr_b16 v[198:199], v242 offset:18688
v_mfma_f32_16x16x32_bf16 a[92:95], v[216:219], v[152:155], a[92:95]
s_waitcnt lgkmcnt(8)
v_mfma_f32_16x16x32_bf16 a[96:99], v[224:227], v[128:131], a[96:99]
ds_read_b64_tr_b16 v[200:201], v242 offset:264
v_mfma_f32_16x16x32_bf16 a[96:99], v[228:231], v[132:135], a[96:99]
v_mfma_f32_16x16x32_bf16 a[100:103], v[228:231], v[140:143], a[100:103]
ds_read_b64_tr_b16 v[202:203], v242 offset:6408
v_mfma_f32_16x16x32_bf16 a[100:103], v[224:227], v[136:139], a[100:103]
v_mfma_f32_16x16x32_bf16 a[104:107], v[224:227], v[144:147], a[104:107]
ds_read_b64_tr_b16 v[204:205], v242 offset:12552
v_mfma_f32_16x16x32_bf16 a[104:107], v[228:231], v[148:151], a[104:107]
v_mfma_f32_16x16x32_bf16 a[108:111], v[228:231], v[156:159], a[108:111]
ds_read_b64_tr_b16 v[206:207], v242 offset:18696
v_mfma_f32_16x16x32_bf16 a[108:111], v[224:227], v[152:155], a[108:111]
s_waitcnt lgkmcnt(8)
v_mfma_f32_16x16x32_bf16 a[112:115], v[232:235], v[128:131], a[112:115]
ds_read_b64_tr_b16 v[208:209], v243 offset:256
v_mfma_f32_16x16x32_bf16 a[112:115], v[236:239], v[132:135], a[112:115]
v_mfma_f32_16x16x32_bf16 a[116:119], v[236:239], v[140:143], a[116:119]
ds_read_b64_tr_b16 v[210:211], v243 offset:6400
v_mfma_f32_16x16x32_bf16 a[116:119], v[232:235], v[136:139], a[116:119]
v_mfma_f32_16x16x32_bf16 a[120:123], v[232:235], v[144:147], a[120:123]
ds_read_b64_tr_b16 v[212:213], v243 offset:12544
v_mfma_f32_16x16x32_bf16 a[120:123], v[236:239], v[148:151], a[120:123]
v_mfma_f32_16x16x32_bf16 a[124:127], v[236:239], v[156:159], a[124:127]
ds_read_b64_tr_b16 v[214:215], v243 offset:18688
v_mfma_f32_16x16x32_bf16 a[124:127], v[232:235], v[152:155], a[124:127]
s_waitcnt lgkmcnt(8)
buffer_load_dwordx4 v7, s[8:11], s57 offen lds
v_mfma_f32_16x16x32_bf16 a[128:131], v[192:195], v[128:131], a[128:131]
ds_read_b64_tr_b16 v[216:217], v243 offset:264
v_mfma_f32_16x16x32_bf16 a[128:131], v[196:199], v[132:135], a[128:131]
v_mfma_f32_16x16x32_bf16 a[132:135], v[196:199], v[140:143], a[132:135]
ds_read_b64_tr_b16 v[218:219], v243 offset:6408
v_mfma_f32_16x16x32_bf16 a[132:135], v[192:195], v[136:139], a[132:135]
v_mfma_f32_16x16x32_bf16 a[136:139], v[192:195], v[144:147], a[136:139]
ds_read_b64_tr_b16 v[220:221], v243 offset:12552
v_mfma_f32_16x16x32_bf16 a[136:139], v[196:199], v[148:151], a[136:139]
v_mfma_f32_16x16x32_bf16 a[140:143], v[196:199], v[156:159], a[140:143]
ds_read_b64_tr_b16 v[222:223], v243 offset:18696
v_mfma_f32_16x16x32_bf16 a[140:143], v[192:195], v[152:155], a[140:143]
s_waitcnt lgkmcnt(8)
v_mfma_f32_16x16x32_bf16 a[144:147], v[200:203], v[128:131], a[144:147]
ds_read_b64_tr_b16 v[224:225], v244 offset:16384
v_mfma_f32_16x16x32_bf16 a[144:147], v[204:207], v[132:135], a[144:147]
v_mfma_f32_16x16x32_bf16 a[148:151], v[204:207], v[140:143], a[148:151]
ds_read_b64_tr_b16 v[226:227], v244 offset:18432
v_mfma_f32_16x16x32_bf16 a[148:151], v[200:203], v[136:139], a[148:151]
v_mfma_f32_16x16x32_bf16 a[152:155], v[200:203], v[144:147], a[152:155]
ds_read_b64_tr_b16 v[228:229], v244 offset:20480
v_mfma_f32_16x16x32_bf16 a[152:155], v[204:207], v[148:151], a[152:155]
v_mfma_f32_16x16x32_bf16 a[156:159], v[204:207], v[156:159], a[156:159]
ds_read_b64_tr_b16 v[230:231], v244 offset:22528
v_mfma_f32_16x16x32_bf16 a[156:159], v[200:203], v[152:155], a[156:159]
s_waitcnt lgkmcnt(8)
v_mfma_f32_16x16x32_bf16 a[160:163], v[208:211], v[128:131], a[160:163]
ds_read_b64_tr_b16 v[232:233], v245 offset:16384
v_mfma_f32_16x16x32_bf16 a[160:163], v[212:215], v[132:135], a[160:163]
v_mfma_f32_16x16x32_bf16 a[164:167], v[212:215], v[140:143], a[164:167]
ds_read_b64_tr_b16 v[234:235], v245 offset:18432
v_mfma_f32_16x16x32_bf16 a[164:167], v[208:211], v[136:139], a[164:167]
buffer_load_dwordx4 v8, s[8:11], s57 offen offset:1024 lds
v_mfma_f32_16x16x32_bf16 a[168:171], v[208:211], v[144:147], a[168:171]
ds_read_b64_tr_b16 v[236:237], v245 offset:20480
v_mfma_f32_16x16x32_bf16 a[168:171], v[212:215], v[148:151], a[168:171]
v_mfma_f32_16x16x32_bf16 a[172:175], v[212:215], v[156:159], a[172:175]
ds_read_b64_tr_b16 v[238:239], v245 offset:22528
v_mfma_f32_16x16x32_bf16 a[172:175], v[208:211], v[152:155], a[172:175]
s_waitcnt lgkmcnt(8)
v_mfma_f32_16x16x32_bf16 a[176:179], v[216:219], v[128:131], a[176:179]
ds_read_b64_tr_b16 v[192:193], v246 offset:16384
v_mfma_f32_16x16x32_bf16 a[176:179], v[220:223], v[132:135], a[176:179]
v_mfma_f32_16x16x32_bf16 a[180:183], v[220:223], v[140:143], a[180:183]
ds_read_b64_tr_b16 v[194:195], v246 offset:18432
v_mfma_f32_16x16x32_bf16 a[180:183], v[216:219], v[136:139], a[180:183]
v_mfma_f32_16x16x32_bf16 a[184:187], v[216:219], v[144:147], a[184:187]
ds_read_b64_tr_b16 v[196:197], v246 offset:20480
v_mfma_f32_16x16x32_bf16 a[184:187], v[220:223], v[148:151], a[184:187]
v_mfma_f32_16x16x32_bf16 a[188:191], v[220:223], v[156:159], a[188:191]
ds_read_b64_tr_b16 v[198:199], v246 offset:22528
v_mfma_f32_16x16x32_bf16 a[188:191], v[216:219], v[152:155], a[188:191]
s_waitcnt lgkmcnt(8)
v_mfma_f32_16x16x32_bf16 v[160:163], v[224:227], v[128:131], v[160:163]
ds_read_b64_tr_b16 v[200:201], v255 offset:16384
v_mfma_f32_16x16x32_bf16 v[160:163], v[228:231], v[132:135], v[160:163]
v_mfma_f32_16x16x32_bf16 v[164:167], v[228:231], v[140:143], v[164:167]
ds_read_b64_tr_b16 v[202:203], v255 offset:18432
v_mov_b32 v14, 0xc1b0e49c
v_mfma_f32_16x16x32_bf16 v[164:167], v[224:227], v[136:139], v[164:167]
v_mfma_f32_16x16x32_bf16 v[168:171], v[224:227], v[144:147], v[168:171]
ds_read_b64_tr_b16 v[204:205], v255 offset:20480
v_mfma_f32_16x16x32_bf16 v[168:171], v[228:231], v[148:151], v[168:171]
v_mfma_f32_16x16x32_bf16 v[172:175], v[228:231], v[156:159], v[172:175]
ds_read_b64_tr_b16 v[206:207], v255 offset:22528
v_lshlrev_b32 v10, 4, v0
v_mfma_f32_16x16x32_bf16 v[172:175], v[224:227], v[152:155], v[172:175]
s_waitcnt lgkmcnt(8)
v_mfma_f32_16x16x32_bf16 v[176:179], v[232:235], v[128:131], v[176:179]
buffer_load_dwordx4 v9, s[8:11], s57 offen offset:2048 lds
v_mfma_f32_16x16x32_bf16 v[176:179], v[236:239], v[132:135], v[176:179]
v_mfma_f32_16x16x32_bf16 v[180:183], v[236:239], v[140:143], v[180:183]
v_mfma_f32_16x16x32_bf16 v[180:183], v[232:235], v[136:139], v[180:183]
v_mfma_f32_16x16x32_bf16 v[184:187], v[232:235], v[144:147], v[184:187]
v_mfma_f32_16x16x32_bf16 v[184:187], v[236:239], v[148:151], v[184:187]
v_mfma_f32_16x16x32_bf16 v[188:191], v[236:239], v[156:159], v[188:191]
s_waitcnt vmcnt(20) lgkmcnt(0)
s_barrier
v_mfma_f32_16x16x32_bf16 v[188:191], v[232:235], v[152:155], v[188:191]
s_waitcnt lgkmcnt(0)
ds_read_b64_tr_b16 v[208:209], v246
v_mfma_f32_16x16x32_bf16 v[16:19], v[192:195], v[128:131], v[16:19]
ds_read_b64_tr_b16 v[210:211], v246 offset:2048
v_mfma_f32_16x16x32_bf16 v[16:19], v[196:199], v[132:135], v[16:19]
ds_read_b64_tr_b16 v[212:213], v246 offset:4096
v_mfma_f32_16x16x32_bf16 v[20:23], v[196:199], v[140:143], v[20:23]
ds_read_b64_tr_b16 v[214:215], v246 offset:6144
v_mfma_f32_16x16x32_bf16 v[20:23], v[192:195], v[136:139], v[20:23]
v_mfma_f32_16x16x32_bf16 v[24:27], v[192:195], v[144:147], v[24:27]
ds_read_b64_tr_b16 v[216:217], v255
v_mfma_f32_16x16x32_bf16 v[24:27], v[196:199], v[148:151], v[24:27]
ds_read_b64_tr_b16 v[218:219], v255 offset:2048
v_mfma_f32_16x16x32_bf16 v[28:31], v[196:199], v[156:159], v[28:31]
ds_read_b64_tr_b16 v[220:221], v255 offset:4096
v_mfma_f32_16x16x32_bf16 v[28:31], v[192:195], v[152:155], v[28:31]
s_waitcnt lgkmcnt(7)
ds_read_b64_tr_b16 v[222:223], v255 offset:6144
v_mfma_f32_16x16x32_bf16 v[48:51], v[200:203], v[128:131], v[48:51]
v_mfma_f32_16x16x32_bf16 v[48:51], v[204:207], v[132:135], v[48:51]
ds_read_b64_tr_b16 v[224:225], v244
v_mfma_f32_16x16x32_bf16 v[52:55], v[204:207], v[140:143], v[52:55]
ds_read_b64_tr_b16 v[226:227], v244 offset:2048
v_mfma_f32_16x16x32_bf16 v[52:55], v[200:203], v[136:139], v[52:55]
ds_read_b64_tr_b16 v[228:229], v244 offset:4096
v_mfma_f32_16x16x32_bf16 v[56:59], v[200:203], v[144:147], v[56:59]
ds_read_b64_tr_b16 v[230:231], v244 offset:6144
v_mfma_f32_16x16x32_bf16 v[56:59], v[204:207], v[148:151], v[56:59]
v_mfma_f32_16x16x32_bf16 v[60:63], v[204:207], v[156:159], v[60:63]
s_waitcnt vmcnt(12)
v_mfma_f32_16x16x32_bf16 v[60:63], v[200:203], v[152:155], v[60:63]
s_waitcnt lgkmcnt(8)
v_mfma_f32_16x16x32_bf16 v[16:19], v[208:211], v[64:67], v[16:19]
s_add_u32 s57, s68, 24576
ds_read_b64_tr_b16 v[232:233], v245
ds_read_b64_tr_b16 v[234:235], v245 offset:2048
v_mfma_f32_16x16x32_bf16 v[16:19], v[212:215], v[68:71], v[16:19]
s_add_u32 m0, s68, 122880
v_mfma_f32_16x16x32_bf16 v[20:23], v[212:215], v[76:79], v[20:23]
buffer_load_dwordx4 v7, s[8:11], s57 offen lds
v_mfma_f32_16x16x32_bf16 v[20:23], v[208:211], v[72:75], v[20:23]
v_mfma_f32_16x16x32_bf16 v[24:27], v[208:211], v[80:83], v[24:27]
ds_read_b64_tr_b16 v[236:237], v245 offset:4096
ds_read_b64_tr_b16 v[238:239], v245 offset:6144
v_mfma_f32_16x16x32_bf16 v[24:27], v[212:215], v[84:87], v[24:27]
v_mfma_f32_16x16x32_bf16 v[28:31], v[212:215], v[92:95], v[28:31]
v_mfma_f32_16x16x32_bf16 v[28:31], v[208:211], v[88:91], v[28:31]
s_waitcnt lgkmcnt(8)
v_mfma_f32_16x16x32_bf16 v[48:51], v[216:219], v[64:67], v[48:51]
ds_read_b64_tr_b16 v[192:193], v240
ds_read_b64_tr_b16 v[194:195], v240 offset:6144
v_mfma_f32_16x16x32_bf16 v[48:51], v[220:223], v[68:71], v[48:51]
v_mfma_f32_16x16x32_bf16 v[52:55], v[220:223], v[76:79], v[52:55]
v_mfma_f32_16x16x32_bf16 v[52:55], v[216:219], v[72:75], v[52:55]
v_mfma_f32_16x16x32_bf16 v[56:59], v[216:219], v[80:83], v[56:59]
ds_read_b64_tr_b16 v[196:197], v240 offset:12288
ds_read_b64_tr_b16 v[198:199], v240 offset:18432
v_mfma_f32_16x16x32_bf16 v[56:59], v[220:223], v[84:87], v[56:59]
v_mfma_f32_16x16x32_bf16 v[60:63], v[220:223], v[92:95], v[60:63]
v_mfma_f32_16x16x32_bf16 v[60:63], v[216:219], v[88:91], v[60:63]
s_waitcnt lgkmcnt(8)
v_mfma_f32_16x16x32_bf16 v[160:163], v[224:227], v[64:67], v[160:163]
ds_read_b64_tr_b16 v[200:201], v240 offset:8
ds_read_b64_tr_b16 v[202:203], v240 offset:6152
v_mfma_f32_16x16x32_bf16 v[160:163], v[228:231], v[68:71], v[160:163]
v_mfma_f32_16x16x32_bf16 v[164:167], v[228:231], v[76:79], v[164:167]
buffer_load_dwordx4 v8, s[8:11], s57 offen offset:1024 lds
v_mfma_f32_16x16x32_bf16 v[164:167], v[224:227], v[72:75], v[164:167]
v_mfma_f32_16x16x32_bf16 v[168:171], v[224:227], v[80:83], v[168:171]
ds_read_b64_tr_b16 v[204:205], v240 offset:12296
ds_read_b64_tr_b16 v[206:207], v240 offset:18440
v_mfma_f32_16x16x32_bf16 v[168:171], v[228:231], v[84:87], v[168:171]
v_mul_f32 v96, v16, v16
v_mul_f32 v97, v17, v17
v_mfma_f32_16x16x32_bf16 v[172:175], v[228:231], v[92:95], v[172:175]
v_mul_f32 v98, v18, v18
v_mul_f32 v99, v19, v19
v_mfma_f32_16x16x32_bf16 v[172:175], v[224:227], v[88:91], v[172:175]
s_waitcnt lgkmcnt(8)
v_fma_f32 v96, v96, s65, v14
v_fma_f32 v97, v97, s65, v14
v_mfma_f32_16x16x32_bf16 v[176:179], v[232:235], v[64:67], v[176:179]
ds_read_b64_tr_b16 v[208:209], v241
ds_read_b64_tr_b16 v[210:211], v241 offset:6144
v_mfma_f32_16x16x32_bf16 v[176:179], v[236:239], v[68:71], v[176:179]
v_fma_f32 v98, v98, s65, v14
v_fma_f32 v99, v99, s65, v14
v_mfma_f32_16x16x32_bf16 v[180:183], v[236:239], v[76:79], v[180:183]
v_mul_f32 v96, v96, v16
v_mul_f32 v97, v97, v17
v_mfma_f32_16x16x32_bf16 v[180:183], v[232:235], v[72:75], v[180:183]
v_mul_f32 v98, v98, v18
v_mul_f32 v99, v99, v19
v_mfma_f32_16x16x32_bf16 v[184:187], v[232:235], v[80:83], v[184:187]
ds_read_b64_tr_b16 v[212:213], v241 offset:12288
ds_read_b64_tr_b16 v[214:215], v241 offset:18432
v_mfma_f32_16x16x32_bf16 v[184:187], v[236:239], v[84:87], v[184:187]
v_exp_f32 v96, v96
v_mfma_f32_16x16x32_bf16 v[188:191], v[236:239], v[92:95], v[188:191]
v_exp_f32 v97, v97
v_mfma_f32_16x16x32_bf16 v[188:191], v[232:235], v[88:91], v[188:191]
s_waitcnt lgkmcnt(8)
v_exp_f32 v98, v98
v_mfma_f32_16x16x32_bf16 a[0:3], v[192:195], v[64:67], a[0:3]
ds_read_b64_tr_b16 v[216:217], v241 offset:8
ds_read_b64_tr_b16 v[218:219], v241 offset:6152
v_mfma_f32_16x16x32_bf16 a[0:3], v[196:199], v[68:71], a[0:3]
v_exp_f32 v99, v99
v_mfma_f32_16x16x32_bf16 a[4:7], v[196:199], v[76:79], a[4:7]
v_fma_f32 v96, v96, s64, s64
v_fma_f32 v97, v97, s64, s64
v_mfma_f32_16x16x32_bf16 a[4:7], v[192:195], v[72:75], a[4:7]
v_fma_f32 v98, v98, s64, s64
v_fma_f32 v99, v99, s64, s64
v_mfma_f32_16x16x32_bf16 a[8:11], v[192:195], v[80:83], a[8:11]
ds_read_b64_tr_b16 v[220:221], v241 offset:12296
ds_read_b64_tr_b16 v[222:223], v241 offset:18440
v_mfma_f32_16x16x32_bf16 a[8:11], v[196:199], v[84:87], a[8:11]
buffer_load_dwordx4 v9, s[8:11], s57 offen offset:2048 lds
v_mul_f32 v104, v20, v20
v_mfma_f32_16x16x32_bf16 a[12:15], v[196:199], v[92:95], a[12:15]
s_add_u32 s57, s68, 27648
s_add_u32 m0, s68, 125952
v_mul_f32 v105, v21, v21
v_mfma_f32_16x16x32_bf16 a[12:15], v[192:195], v[88:91], a[12:15]
s_waitcnt lgkmcnt(8)
v_rcp_f32 v96, v96
v_mfma_f32_16x16x32_bf16 a[16:19], v[200:203], v[64:67], a[16:19]
ds_read_b64_tr_b16 v[224:225], v240 offset:128
ds_read_b64_tr_b16 v[226:227], v240 offset:6272
v_mfma_f32_16x16x32_bf16 a[16:19], v[204:207], v[68:71], a[16:19]
v_rcp_f32 v97, v97
v_mfma_f32_16x16x32_bf16 a[20:23], v[204:207], v[76:79], a[20:23]
v_rcp_f32 v98, v98
v_mfma_f32_16x16x32_bf16 a[20:23], v[200:203], v[72:75], a[20:23]
v_rcp_f32 v99, v99
v_mfma_f32_16x16x32_bf16 a[24:27], v[200:203], v[80:83], a[24:27]
ds_read_b64_tr_b16 v[228:229], v240 offset:12416
ds_read_b64_tr_b16 v[230:231], v240 offset:18560
v_mfma_f32_16x16x32_bf16 a[24:27], v[204:207], v[84:87], a[24:27]
v_mul_f32 v96, v96, v16
v_mul_f32 v97, v97, v17
v_mfma_f32_16x16x32_bf16 a[28:31], v[204:207], v[92:95], a[28:31]
v_mul_f32 v98, v98, v18
v_mul_f32 v99, v99, v19
v_mfma_f32_16x16x32_bf16 a[28:31], v[200:203], v[88:91], a[28:31]
s_waitcnt lgkmcnt(8)
v_cvt_pk_bf16_f32 v100, v96, v97
v_cvt_pk_bf16_f32 v101, v98, v99
v_mfma_f32_16x16x32_bf16 a[32:35], v[208:211], v[64:67], a[32:35]
ds_read_b64_tr_b16 v[232:233], v240 offset:136
ds_read_b64_tr_b16 v[234:235], v240 offset:6280
v_mfma_f32_16x16x32_bf16 a[32:35], v[212:215], v[68:71], a[32:35]
v_mul_f32 v96, v48, v48
v_mul_f32 v97, v49, v49
v_mfma_f32_16x16x32_bf16 a[36:39], v[212:215], v[76:79], a[36:39]
v_mul_f32 v98, v50, v50
v_mul_f32 v99, v51, v51
v_mfma_f32_16x16x32_bf16 a[36:39], v[208:211], v[72:75], a[36:39]
v_fma_f32 v96, v96, s65, v14
v_fma_f32 v97, v97, s65, v14
v_mfma_f32_16x16x32_bf16 a[40:43], v[208:211], v[80:83], a[40:43]
ds_read_b64_tr_b16 v[236:237], v240 offset:12424
ds_read_b64_tr_b16 v[238:239], v240 offset:18568
v_mfma_f32_16x16x32_bf16 a[40:43], v[212:215], v[84:87], a[40:43]
v_fma_f32 v98, v98, s65, v14
v_fma_f32 v99, v99, s65, v14
v_mfma_f32_16x16x32_bf16 a[44:47], v[212:215], v[92:95], a[44:47]
buffer_load_dwordx4 v7, s[8:11], s57 offen lds
v_mul_f32 v96, v96, v48
v_mfma_f32_16x16x32_bf16 a[44:47], v[208:211], v[88:91], a[44:47]
s_waitcnt lgkmcnt(8)
v_mul_f32 v97, v97, v49
v_mul_f32 v98, v98, v50
v_mfma_f32_16x16x32_bf16 a[48:51], v[216:219], v[64:67], a[48:51]
ds_read_b64_tr_b16 v[192:193], v241 offset:128
ds_read_b64_tr_b16 v[194:195], v241 offset:6272
v_mfma_f32_16x16x32_bf16 a[48:51], v[220:223], v[68:71], a[48:51]
v_mul_f32 v99, v99, v51
v_mul_f32 v106, v22, v22
v_mfma_f32_16x16x32_bf16 a[52:55], v[220:223], v[76:79], a[52:55]
v_exp_f32 v96, v96
v_mfma_f32_16x16x32_bf16 a[52:55], v[216:219], v[72:75], a[52:55]
v_exp_f32 v97, v97
v_mfma_f32_16x16x32_bf16 a[56:59], v[216:219], v[80:83], a[56:59]
ds_read_b64_tr_b16 v[196:197], v241 offset:12416
ds_read_b64_tr_b16 v[198:199], v241 offset:18560
v_mfma_f32_16x16x32_bf16 a[56:59], v[220:223], v[84:87], a[56:59]
v_exp_f32 v98, v98
v_mfma_f32_16x16x32_bf16 a[60:63], v[220:223], v[92:95], a[60:63]
v_exp_f32 v99, v99
v_mfma_f32_16x16x32_bf16 a[60:63], v[216:219], v[88:91], a[60:63]
s_waitcnt lgkmcnt(8)
v_fma_f32 v96, v96, s64, s64
v_fma_f32 v97, v97, s64, s64
v_mfma_f32_16x16x32_bf16 a[64:67], v[224:227], v[64:67], a[64:67]
ds_read_b64_tr_b16 v[200:201], v241 offset:136
ds_read_b64_tr_b16 v[202:203], v241 offset:6280
v_mfma_f32_16x16x32_bf16 a[64:67], v[228:231], v[68:71], a[64:67]
v_fma_f32 v98, v98, s64, s64
v_fma_f32 v99, v99, s64, s64
v_mfma_f32_16x16x32_bf16 a[68:71], v[228:231], v[76:79], a[68:71]
v_rcp_f32 v96, v96
v_mfma_f32_16x16x32_bf16 a[68:71], v[224:227], v[72:75], a[68:71]
v_rcp_f32 v97, v97
v_mfma_f32_16x16x32_bf16 a[72:75], v[224:227], v[80:83], a[72:75]
ds_read_b64_tr_b16 v[204:205], v241 offset:12424
ds_read_b64_tr_b16 v[206:207], v241 offset:18568
v_mfma_f32_16x16x32_bf16 a[72:75], v[228:231], v[84:87], a[72:75]
v_rcp_f32 v98, v98
v_mfma_f32_16x16x32_bf16 a[76:79], v[228:231], v[92:95], a[76:79]
v_rcp_f32 v99, v99
v_mfma_f32_16x16x32_bf16 a[76:79], v[224:227], v[88:91], a[76:79]
s_waitcnt lgkmcnt(8)
v_mul_f32 v96, v96, v48
v_mul_f32 v97, v97, v49
v_mfma_f32_16x16x32_bf16 a[80:83], v[232:235], v[64:67], a[80:83]
ds_read_b64_tr_b16 v[208:209], v240 offset:256
ds_read_b64_tr_b16 v[210:211], v240 offset:6400
v_mfma_f32_16x16x32_bf16 a[80:83], v[236:239], v[68:71], a[80:83]
buffer_load_dwordx4 v8, s[8:11], s57 offen offset:1024 lds
v_mul_f32 v98, v98, v50
v_mfma_f32_16x16x32_bf16 a[84:87], v[236:239], v[76:79], a[84:87]
v_mul_f32 v99, v99, v51
v_cvt_pk_bf16_f32 v102, v96, v97
v_mfma_f32_16x16x32_bf16 a[84:87], v[232:235], v[72:75], a[84:87]
v_cvt_pk_bf16_f32 v103, v98, v99
v_mul_f32 v107, v23, v23
v_mfma_f32_16x16x32_bf16 a[88:91], v[232:235], v[80:83], a[88:91]
s_add_u32 s74, s58, 0
ds_read_b64_tr_b16 v[212:213], v240 offset:12544
ds_read_b64_tr_b16 v[214:215], v240 offset:18688
v_mfma_f32_16x16x32_bf16 a[88:91], v[236:239], v[84:87], a[88:91]
buffer_store_dwordx4 v[100:103], v10, s[20:23], s74 offen sc1
v_fma_f32 v104, v104, s65, v14
v_mfma_f32_16x16x32_bf16 a[92:95], v[236:239], v[92:95], a[92:95]
v_fma_f32 v105, v105, s65, v14
v_fma_f32 v106, v106, s65, v14
v_mfma_f32_16x16x32_bf16 a[92:95], v[232:235], v[88:91], a[92:95]
s_waitcnt lgkmcnt(8)
v_fma_f32 v107, v107, s65, v14
v_mul_f32 v104, v104, v20
v_mfma_f32_16x16x32_bf16 a[96:99], v[192:195], v[64:67], a[96:99]
ds_read_b64_tr_b16 v[216:217], v240 offset:264
ds_read_b64_tr_b16 v[218:219], v240 offset:6408
v_mfma_f32_16x16x32_bf16 a[96:99], v[196:199], v[68:71], a[96:99]
v_mul_f32 v105, v105, v21
v_mul_f32 v106, v106, v22
v_mfma_f32_16x16x32_bf16 a[100:103], v[196:199], v[76:79], a[100:103]
v_mul_f32 v107, v107, v23
v_accvgpr_read_b32 v128, a0
v_mfma_f32_16x16x32_bf16 a[100:103], v[192:195], v[72:75], a[100:103]
v_exp_f32 v104, v104
v_mfma_f32_16x16x32_bf16 a[104:107], v[192:195], v[80:83], a[104:107]
ds_read_b64_tr_b16 v[220:221], v240 offset:12552
ds_read_b64_tr_b16 v[222:223], v240 offset:18696
v_mfma_f32_16x16x32_bf16 a[104:107], v[196:199], v[84:87], a[104:107]
v_exp_f32 v105, v105
v_mfma_f32_16x16x32_bf16 a[108:111], v[196:199], v[92:95], a[108:111]
v_exp_f32 v106, v106
v_mfma_f32_16x16x32_bf16 a[108:111], v[192:195], v[88:91], a[108:111]
s_waitcnt lgkmcnt(8)
v_exp_f32 v107, v107
v_mfma_f32_16x16x32_bf16 a[112:115], v[200:203], v[64:67], a[112:115]
ds_read_b64_tr_b16 v[224:225], v241 offset:256
ds_read_b64_tr_b16 v[226:227], v241 offset:6400
v_mfma_f32_16x16x32_bf16 a[112:115], v[204:207], v[68:71], a[112:115]
v_fma_f32 v104, v104, s64, s64
v_fma_f32 v105, v105, s64, s64
v_mfma_f32_16x16x32_bf16 a[116:119], v[204:207], v[76:79], a[116:119]
buffer_load_dwordx4 v9, s[8:11], s57 offen offset:2048 lds
v_fma_f32 v106, v106, s64, s64
v_mfma_f32_16x16x32_bf16 a[116:119], v[200:203], v[72:75], a[116:119]
v_fma_f32 v107, v107, s64, s64
v_accvgpr_read_b32 v129, a1
v_mfma_f32_16x16x32_bf16 a[120:123], v[200:203], v[80:83], a[120:123]
ds_read_b64_tr_b16 v[228:229], v241 offset:12544
ds_read_b64_tr_b16 v[230:231], v241 offset:18688
v_mfma_f32_16x16x32_bf16 a[120:123], v[204:207], v[84:87], a[120:123]
v_rcp_f32 v104, v104
v_mfma_f32_16x16x32_bf16 a[124:127], v[204:207], v[92:95], a[124:127]
v_rcp_f32 v105, v105
v_mfma_f32_16x16x32_bf16 a[124:127], v[200:203], v[88:91], a[124:127]
s_waitcnt lgkmcnt(8)
v_rcp_f32 v106, v106
v_mfma_f32_16x16x32_bf16 a[128:131], v[208:211], v[64:67], a[128:131]
ds_read_b64_tr_b16 v[232:233], v241 offset:264
ds_read_b64_tr_b16 v[234:235], v241 offset:6408
v_mfma_f32_16x16x32_bf16 a[128:131], v[212:215], v[68:71], a[128:131]
v_rcp_f32 v107, v107
v_mfma_f32_16x16x32_bf16 a[132:135], v[212:215], v[76:79], a[132:135]
v_mul_f32 v104, v104, v20
v_mul_f32 v105, v105, v21
v_mfma_f32_16x16x32_bf16 a[132:135], v[208:211], v[72:75], a[132:135]
v_mul_f32 v106, v106, v22
v_mul_f32 v107, v107, v23
v_mfma_f32_16x16x32_bf16 a[136:139], v[208:211], v[80:83], a[136:139]
ds_read_b64_tr_b16 v[236:237], v241 offset:12552
ds_read_b64_tr_b16 v[238:239], v241 offset:18696
v_mfma_f32_16x16x32_bf16 a[136:139], v[212:215], v[84:87], a[136:139]
v_cvt_pk_bf16_f32 v108, v104, v105
v_cvt_pk_bf16_f32 v109, v106, v107
v_mfma_f32_16x16x32_bf16 a[140:143], v[212:215], v[92:95], a[140:143]
v_mul_f32 v104, v52, v52
v_mul_f32 v105, v53, v53
v_mfma_f32_16x16x32_bf16 a[140:143], v[208:211], v[88:91], a[140:143]
s_waitcnt lgkmcnt(8)
v_mul_f32 v106, v54, v54
v_mul_f32 v107, v55, v55
v_mfma_f32_16x16x32_bf16 a[144:147], v[216:219], v[64:67], a[144:147]
v_fma_f32 v104, v104, s65, v14
v_fma_f32 v105, v105, s65, v14
v_mfma_f32_16x16x32_bf16 a[144:147], v[220:223], v[68:71], a[144:147]
v_fma_f32 v106, v106, s65, v14
v_fma_f32 v107, v107, s65, v14
v_mfma_f32_16x16x32_bf16 a[148:151], v[220:223], v[76:79], a[148:151]
v_mul_f32 v104, v104, v52
v_mul_f32 v105, v105, v53
v_mfma_f32_16x16x32_bf16 a[148:151], v[216:219], v[72:75], a[148:151]
v_mul_f32 v106, v106, v54
v_mul_f32 v107, v107, v55
v_mfma_f32_16x16x32_bf16 a[152:155], v[216:219], v[80:83], a[152:155]
v_exp_f32 v104, v104
v_mfma_f32_16x16x32_bf16 a[152:155], v[220:223], v[84:87], a[152:155]
v_exp_f32 v105, v105
v_mfma_f32_16x16x32_bf16 a[156:159], v[220:223], v[92:95], a[156:159]
s_waitcnt vmcnt(7) lgkmcnt(0)
s_barrier
v_accvgpr_read_b32 v130, a2
v_mfma_f32_16x16x32_bf16 a[156:159], v[216:219], v[88:91], a[156:159]
s_waitcnt lgkmcnt(0)
s_add_u32 s57, s68, 49152
ds_read_b128 v[192:195], v1
v_mfma_f32_16x16x32_bf16 a[160:163], v[224:227], v[64:67], a[160:163]
s_add_u32 m0, s68, 49152
v_exp_f32 v106, v106
v_mfma_f32_16x16x32_bf16 a[160:163], v[228:231], v[68:71], a[160:163]
ds_read_b128 v[196:199], v2
buffer_load_dwordx4 v7, s[4:7], s57 offen lds
v_mfma_f32_16x16x32_bf16 a[164:167], v[228:231], v[76:79], a[164:167]
buffer_load_dwordx4 v8, s[4:7], s57 offen offset:1024 lds
v_accvgpr_read_b32 v131, a3
v_mfma_f32_16x16x32_bf16 a[164:167], v[224:227], v[72:75], a[164:167]
ds_read_b128 v[200:203], v1 offset:128
v_accvgpr_read_b32 v132, a16
v_mfma_f32_16x16x32_bf16 a[168:171], v[224:227], v[80:83], a[168:171]
v_exp_f32 v107, v107
v_mfma_f32_16x16x32_bf16 a[168:171], v[228:231], v[84:87], a[168:171]
ds_read_b128 v[204:207], v2 offset:128
buffer_load_dwordx4 v9, s[4:7], s57 offen offset:2048 lds
v_mfma_f32_16x16x32_bf16 a[172:175], v[228:231], v[92:95], a[172:175]
s_add_u32 s57, s68, 52224
s_add_u32 m0, s68, 52224
v_fma_f32 v104, v104, s64, s64
v_mfma_f32_16x16x32_bf16 a[172:175], v[224:227], v[88:91], a[172:175]
s_waitcnt lgkmcnt(4)
ds_read_b128 v[208:211], v1 offset:256
buffer_load_dwordx4 v7, s[4:7], s57 offen lds
v_mfma_f32_16x16x32_bf16 a[176:179], v[232:235], v[64:67], a[176:179]
v_fma_f32 v105, v105, s64, s64
v_fma_f32 v106, v106, s64, s64
v_mfma_f32_16x16x32_bf16 a[176:179], v[236:239], v[68:71], a[176:179]
ds_read_b128 v[212:215], v2 offset:256
v_fma_f32 v107, v107, s64, s64
v_mfma_f32_16x16x32_bf16 a[180:183], v[236:239], v[76:79], a[180:183]
buffer_load_dwordx4 v8, s[4:7], s57 offen offset:1024 lds
v_accvgpr_read_b32 v133, a17
v_mfma_f32_16x16x32_bf16 a[180:183], v[232:235], v[72:75], a[180:183]
v_rcp_f32 v104, v104
v_mfma_f32_16x16x32_bf16 a[184:187], v[232:235], v[80:83], a[184:187]
buffer_load_dwordx4 v9, s[4:7], s57 offen offset:2048 lds
v_accvgpr_read_b32 v134, a18
v_mfma_f32_16x16x32_bf16 a[184:187], v[236:239], v[84:87], a[184:187]
v_rcp_f32 v105, v105
v_mfma_f32_16x16x32_bf16 a[188:191], v[236:239], v[92:95], a[188:191]
v_rcp_f32 v106, v106
v_mfma_f32_16x16x32_bf16 a[188:191], v[232:235], v[88:91], a[188:191]
v_rcp_f32 v107, v107
L_mide:
s_nop 7
v_mul_f32 v104, v104, v52
v_mul_f32 v105, v105, v53
v_mul_f32 v106, v106, v54
v_mul_f32 v107, v107, v55
v_cvt_pk_bf16_f32 v110, v104, v105
v_cvt_pk_bf16_f32 v111, v106, v107
s_add_u32 s75, s58, 245760
buffer_store_dwordx4 v[108:111], v10, s[20:23], s75 offen sc1
v_pk_mul_f32 v[96:97], v[24:25], v[24:25]
v_pk_mul_f32 v[98:99], v[26:27], v[26:27]
v_pk_fma_f32 v[96:97], v[96:97], s[64:65], v[14:15] op_sel:[0,1,0] op_sel_hi:[1,1,0]
v_pk_fma_f32 v[98:99], v[98:99], s[64:65], v[14:15] op_sel:[0,1,0] op_sel_hi:[1,1,0]
v_pk_mul_f32 v[96:97], v[96:97], v[24:25]
v_pk_mul_f32 v[98:99], v[98:99], v[26:27]
v_exp_f32 v96, v96
v_exp_f32 v97, v97
v_exp_f32 v98, v98
v_exp_f32 v99, v99
s_nop 0
v_pk_fma_f32 v[96:97], v[96:97], s[64:65], s[64:65] op_sel_hi:[1,0,0]
v_pk_fma_f32 v[98:99], v[98:99], s[64:65], s[64:65] op_sel_hi:[1,0,0]
v_rcp_f32 v96, v96
v_rcp_f32 v97, v97
v_rcp_f32 v98, v98
v_rcp_f32 v99, v99
s_nop 0
v_pk_mul_f32 v[96:97], v[96:97], v[24:25]
v_pk_mul_f32 v[98:99], v[98:99], v[26:27]
v_cvt_pk_bf16_f32 v100, v96, v97
v_cvt_pk_bf16_f32 v101, v98, v99
v_pk_mul_f32 v[96:97], v[56:57], v[56:57]
v_pk_mul_f32 v[98:99], v[58:59], v[58:59]
v_pk_fma_f32 v[96:97], v[96:97], s[64:65], v[14:15] op_sel:[0,1,0] op_sel_hi:[1,1,0]
v_pk_fma_f32 v[98:99], v[98:99], s[64:65], v[14:15] op_sel:[0,1,0] op_sel_hi:[1,1,0]
v_pk_mul_f32 v[96:97], v[96:97], v[56:57]
v_pk_mul_f32 v[98:99], v[98:99], v[58:59]
v_exp_f32 v96, v96
v_exp_f32 v97, v97
v_exp_f32 v98, v98
v_exp_f32 v99, v99
s_nop 0
v_pk_fma_f32 v[96:97], v[96:97], s[64:65], s[64:65] op_sel_hi:[1,0,0]
v_pk_fma_f32 v[98:99], v[98:99], s[64:65], s[64:65] op_sel_hi:[1,0,0]
v_rcp_f32 v96, v96
v_rcp_f32 v97, v97
v_rcp_f32 v98, v98
v_rcp_f32 v99, v99
s_nop 0
v_pk_mul_f32 v[96:97], v[96:97], v[56:57]
v_pk_mul_f32 v[98:99], v[98:99], v[58:59]
v_cvt_pk_bf16_f32 v102, v96, v97
v_cvt_pk_bf16_f32 v103, v98, v99
s_add_u32 s74, s58, 491520
buffer_store_dwordx4 v[100:103], v10, s[20:23], s74 offen sc1
v_pk_mul_f32 v[104:105], v[28:29], v[28:29]
v_pk_mul_f32 v[106:107], v[30:31], v[30:31]
v_pk_fma_f32 v[104:105], v[104:105], s[64:65], v[14:15] op_sel:[0,1,0] op_sel_hi:[1,1,0]
v_pk_fma_f32 v[106:107], v[106:107], s[64:65], v[14:15] op_sel:[0,1,0] op_sel_hi:[1,1,0]
v_pk_mul_f32 v[104:105], v[104:105], v[28:29]
v_pk_mul_f32 v[106:107], v[106:107], v[30:31]
v_exp_f32 v104, v104
v_exp_f32 v105, v105
v_exp_f32 v106, v106
v_exp_f32 v107, v107
s_nop 0
v_pk_fma_f32 v[104:105], v[104:105], s[64:65], s[64:65] op_sel_hi:[1,0,0]
v_pk_fma_f32 v[106:107], v[106:107], s[64:65], s[64:65] op_sel_hi:[1,0,0]
v_rcp_f32 v104, v104
v_rcp_f32 v105, v105
v_rcp_f32 v106, v106
v_rcp_f32 v107, v107
s_nop 0
v_pk_mul_f32 v[104:105], v[104:105], v[28:29]
v_pk_mul_f32 v[106:107], v[106:107], v[30:31]
v_cvt_pk_bf16_f32 v108, v104, v105
v_cvt_pk_bf16_f32 v109, v106, v107
v_pk_mul_f32 v[104:105], v[60:61], v[60:61]
v_pk_mul_f32 v[106:107], v[62:63], v[62:63]
v_pk_fma_f32 v[104:105], v[104:105], s[64:65], v[14:15] op_sel:[0,1,0] op_sel_hi:[1,1,0]
v_pk_fma_f32 v[106:107], v[106:107], s[64:65], v[14:15] op_sel:[0,1,0] op_sel_hi:[1,1,0]
v_pk_mul_f32 v[104:105], v[104:105], v[60:61]
v_pk_mul_f32 v[106:107], v[106:107], v[62:63]
v_exp_f32 v104, v104
v_exp_f32 v105, v105
v_exp_f32 v106, v106
v_exp_f32 v107, v107
s_nop 0
v_pk_fma_f32 v[104:105], v[104:105], s[64:65], s[64:65] op_sel_hi:[1,0,0]
v_pk_fma_f32 v[106:107], v[106:107], s[64:65], s[64:65] op_sel_hi:[1,0,0]
v_rcp_f32 v104, v104
v_rcp_f32 v105, v105
v_rcp_f32 v106, v106
v_rcp_f32 v107, v107
s_nop 0
v_pk_mul_f32 v[104:105], v[104:105], v[60:61]
v_pk_mul_f32 v[106:107], v[106:107], v[62:63]
v_cvt_pk_bf16_f32 v110, v104, v105
v_cvt_pk_bf16_f32 v111, v106, v107
s_add_u32 s75, s58, 737280
buffer_store_dwordx4 v[108:111], v10, s[20:23], s75 offen sc1
v_accvgpr_read_b32 v135, a19
v_cvt_pk_bf16_f32 v136, v128, v129
v_cvt_pk_bf16_f32 v137, v130, v131
v_cvt_pk_bf16_f32 v138, v132, v133
v_cvt_pk_bf16_f32 v139, v134, v135
v_accvgpr_write_b32 a192, v136
v_accvgpr_write_b32 a193, v137
v_accvgpr_write_b32 a194, v138
v_accvgpr_write_b32 a195, v139
v_accvgpr_read_b32 v144, a4
v_accvgpr_read_b32 v145, a5
v_accvgpr_read_b32 v146, a6
v_accvgpr_read_b32 v147, a7
v_accvgpr_read_b32 v148, a20
v_accvgpr_read_b32 v149, a21
v_accvgpr_read_b32 v150, a22
v_accvgpr_read_b32 v151, a23
v_cvt_pk_bf16_f32 v152, v144, v145
v_cvt_pk_bf16_f32 v153, v146, v147
v_cvt_pk_bf16_f32 v154, v148, v149
v_cvt_pk_bf16_f32 v155, v150, v151
v_accvgpr_write_b32 a216, v152
v_accvgpr_write_b32 a217, v153
v_accvgpr_write_b32 a218, v154
v_accvgpr_write_b32 a219, v155
v_accvgpr_read_b32 v128, a8
v_accvgpr_read_b32 v129, a9
v_accvgpr_read_b32 v130, a10
v_accvgpr_read_b32 v131, a11
v_accvgpr_read_b32 v132, a24
v_accvgpr_read_b32 v133, a25
v_accvgpr_read_b32 v134, a26
v_accvgpr_read_b32 v135, a27
v_cvt_pk_bf16_f32 v136, v128, v129
v_cvt_pk_bf16_f32 v137, v130, v131
v_cvt_pk_bf16_f32 v138, v132, v133
v_cvt_pk_bf16_f32 v139, v134, v135
v_accvgpr_write_b32 a240, v136
v_accvgpr_write_b32 a241, v137
v_accvgpr_write_b32 a242, v138
v_accvgpr_write_b32 a243, v139
v_accvgpr_read_b32 v144, a12
v_accvgpr_read_b32 v145, a13
v_accvgpr_read_b32 v146, a14
v_accvgpr_read_b32 v147, a15
v_accvgpr_read_b32 v148, a28
v_accvgpr_read_b32 v149, a29
v_accvgpr_read_b32 v150, a30
v_accvgpr_read_b32 v151, a31
v_cvt_pk_bf16_f32 v40, v144, v145
v_cvt_pk_bf16_f32 v41, v146, v147
v_cvt_pk_bf16_f32 v42, v148, v149
v_cvt_pk_bf16_f32 v43, v150, v151
v_accvgpr_read_b32 v128, a32
v_accvgpr_read_b32 v129, a33
v_accvgpr_read_b32 v130, a34
v_accvgpr_read_b32 v131, a35
v_accvgpr_read_b32 v132, a48
v_accvgpr_read_b32 v133, a49
v_accvgpr_read_b32 v134, a50
v_accvgpr_read_b32 v135, a51
v_cvt_pk_bf16_f32 v136, v128, v129
v_cvt_pk_bf16_f32 v137, v130, v131
v_cvt_pk_bf16_f32 v138, v132, v133
v_cvt_pk_bf16_f32 v139, v134, v135
v_accvgpr_write_b32 a196, v136
v_accvgpr_write_b32 a197, v137
v_accvgpr_write_b32 a198, v138
v_accvgpr_write_b32 a199, v139
v_accvgpr_read_b32 v144, a36
v_accvgpr_read_b32 v145, a37
v_accvgpr_read_b32 v146, a38
v_accvgpr_read_b32 v147, a39
v_accvgpr_read_b32 v148, a52
v_accvgpr_read_b32 v149, a53
v_accvgpr_read_b32 v150, a54
v_accvgpr_read_b32 v151, a55
v_cvt_pk_bf16_f32 v152, v144, v145
v_cvt_pk_bf16_f32 v153, v146, v147
v_cvt_pk_bf16_f32 v154, v148, v149
v_cvt_pk_bf16_f32 v155, v150, v151
v_accvgpr_write_b32 a220, v152
v_accvgpr_write_b32 a221, v153
v_accvgpr_write_b32 a222, v154
v_accvgpr_write_b32 a223, v155
v_accvgpr_read_b32 v128, a40
v_accvgpr_read_b32 v129, a41
v_accvgpr_read_b32 v130, a42
v_accvgpr_read_b32 v131, a43
v_accvgpr_read_b32 v132, a56
v_accvgpr_read_b32 v133, a57
v_accvgpr_read_b32 v134, a58
v_accvgpr_read_b32 v135, a59
v_cvt_pk_bf16_f32 v136, v128, v129
v_cvt_pk_bf16_f32 v137, v130, v131
v_cvt_pk_bf16_f32 v138, v132, v133
v_cvt_pk_bf16_f32 v139, v134, v135
v_accvgpr_write_b32 a244, v136
v_accvgpr_write_b32 a245, v137
v_accvgpr_write_b32 a246, v138
v_accvgpr_write_b32 a247, v139
v_accvgpr_read_b32 v144, a44
v_accvgpr_read_b32 v145, a45
v_accvgpr_read_b32 v146, a46
v_accvgpr_read_b32 v147, a47
v_accvgpr_read_b32 v148, a60
v_accvgpr_read_b32 v149, a61
v_accvgpr_read_b32 v150, a62
v_accvgpr_read_b32 v151, a63
v_cvt_pk_bf16_f32 v44, v144, v145
v_cvt_pk_bf16_f32 v45, v146, v147
v_cvt_pk_bf16_f32 v46, v148, v149
v_cvt_pk_bf16_f32 v47, v150, v151
v_accvgpr_read_b32 v128, a64
v_accvgpr_read_b32 v129, a65
v_accvgpr_read_b32 v130, a66
v_accvgpr_read_b32 v131, a67
v_accvgpr_read_b32 v132, a80
v_accvgpr_read_b32 v133, a81
v_accvgpr_read_b32 v134, a82
v_accvgpr_read_b32 v135, a83
v_cvt_pk_bf16_f32 v136, v128, v129
v_cvt_pk_bf16_f32 v137, v130, v131
v_cvt_pk_bf16_f32 v138, v132, v133
v_cvt_pk_bf16_f32 v139, v134, v135
v_accvgpr_write_b32 a200, v136
v_accvgpr_write_b32 a201, v137
v_accvgpr_write_b32 a202, v138
v_accvgpr_write_b32 a203, v139
v_accvgpr_read_b32 v144, a68
v_accvgpr_read_b32 v145, a69
v_accvgpr_read_b32 v146, a70
v_accvgpr_read_b32 v147, a71
v_accvgpr_read_b32 v148, a84
v_accvgpr_read_b32 v149, a85
v_accvgpr_read_b32 v150, a86
v_accvgpr_read_b32 v151, a87
v_cvt_pk_bf16_f32 v152, v144, v145
v_cvt_pk_bf16_f32 v153, v146, v147
v_cvt_pk_bf16_f32 v154, v148, v149
v_cvt_pk_bf16_f32 v155, v150, v151
v_accvgpr_write_b32 a224, v152
v_accvgpr_write_b32 a225, v153
v_accvgpr_write_b32 a226, v154
v_accvgpr_write_b32 a227, v155
v_accvgpr_read_b32 v128, a72
v_accvgpr_read_b32 v129, a73
v_accvgpr_read_b32 v130, a74
v_accvgpr_read_b32 v131, a75
v_accvgpr_read_b32 v132, a88
v_accvgpr_read_b32 v133, a89
v_accvgpr_read_b32 v134, a90
v_accvgpr_read_b32 v135, a91
v_cvt_pk_bf16_f32 v136, v128, v129
v_cvt_pk_bf16_f32 v137, v130, v131
v_cvt_pk_bf16_f32 v138, v132, v133
v_cvt_pk_bf16_f32 v139, v134, v135
v_accvgpr_write_b32 a248, v136
v_accvgpr_write_b32 a249, v137
v_accvgpr_write_b32 a250, v138
v_accvgpr_write_b32 a251, v139
v_accvgpr_read_b32 v144, a76
v_accvgpr_read_b32 v145, a77
v_accvgpr_read_b32 v146, a78
v_accvgpr_read_b32 v147, a79
v_accvgpr_read_b32 v148, a92
v_accvgpr_read_b32 v149, a93
v_accvgpr_read_b32 v150, a94
v_accvgpr_read_b32 v151, a95
v_cvt_pk_bf16_f32 v48, v144, v145
v_cvt_pk_bf16_f32 v49, v146, v147
v_cvt_pk_bf16_f32 v50, v148, v149
v_cvt_pk_bf16_f32 v51, v150, v151
v_accvgpr_read_b32 v128, a96
v_accvgpr_read_b32 v129, a97
v_accvgpr_read_b32 v130, a98
v_accvgpr_read_b32 v131, a99
v_accvgpr_read_b32 v132, a112
v_accvgpr_read_b32 v133, a113
v_accvgpr_read_b32 v134, a114
v_accvgpr_read_b32 v135, a115
v_cvt_pk_bf16_f32 v136, v128, v129
v_cvt_pk_bf16_f32 v137, v130, v131
v_cvt_pk_bf16_f32 v138, v132, v133
v_cvt_pk_bf16_f32 v139, v134, v135
v_accvgpr_write_b32 a204, v136
v_accvgpr_write_b32 a205, v137
v_accvgpr_write_b32 a206, v138
v_accvgpr_write_b32 a207, v139
v_accvgpr_read_b32 v144, a100
v_accvgpr_read_b32 v145, a101
v_accvgpr_read_b32 v146, a102
v_accvgpr_read_b32 v147, a103
v_accvgpr_read_b32 v148, a116
v_accvgpr_read_b32 v149, a117
v_accvgpr_read_b32 v150, a118
v_accvgpr_read_b32 v151, a119
v_cvt_pk_bf16_f32 v152, v144, v145
v_cvt_pk_bf16_f32 v153, v146, v147
v_cvt_pk_bf16_f32 v154, v148, v149
v_cvt_pk_bf16_f32 v155, v150, v151
v_accvgpr_write_b32 a228, v152
v_accvgpr_write_b32 a229, v153
v_accvgpr_write_b32 a230, v154
v_accvgpr_write_b32 a231, v155
v_accvgpr_read_b32 v128, a104
v_accvgpr_read_b32 v129, a105
v_accvgpr_read_b32 v130, a106
v_accvgpr_read_b32 v131, a107
v_accvgpr_read_b32 v132, a120
v_accvgpr_read_b32 v133, a121
v_accvgpr_read_b32 v134, a122
v_accvgpr_read_b32 v135, a123
v_cvt_pk_bf16_f32 v136, v128, v129
v_cvt_pk_bf16_f32 v137, v130, v131
v_cvt_pk_bf16_f32 v138, v132, v133
v_cvt_pk_bf16_f32 v139, v134, v135
v_accvgpr_write_b32 a252, v136
v_accvgpr_write_b32 a253, v137
v_accvgpr_write_b32 a254, v138
v_accvgpr_write_b32 a255, v139
v_accvgpr_read_b32 v144, a108
v_accvgpr_read_b32 v145, a109
v_accvgpr_read_b32 v146, a110
v_accvgpr_read_b32 v147, a111
v_accvgpr_read_b32 v148, a124
v_accvgpr_read_b32 v149, a125
v_accvgpr_read_b32 v150, a126
v_accvgpr_read_b32 v151, a127
v_cvt_pk_bf16_f32 v52, v144, v145
v_cvt_pk_bf16_f32 v53, v146, v147
v_cvt_pk_bf16_f32 v54, v148, v149
v_cvt_pk_bf16_f32 v55, v150, v151
v_accvgpr_read_b32 v128, a128
v_accvgpr_read_b32 v129, a129
v_accvgpr_read_b32 v130, a130
v_accvgpr_read_b32 v131, a131
v_accvgpr_read_b32 v132, a144
v_accvgpr_read_b32 v133, a145
v_accvgpr_read_b32 v134, a146
v_accvgpr_read_b32 v135, a147
v_cvt_pk_bf16_f32 v136, v128, v129
v_cvt_pk_bf16_f32 v137, v130, v131
v_cvt_pk_bf16_f32 v138, v132, v133
v_cvt_pk_bf16_f32 v139, v134, v135
v_accvgpr_write_b32 a208, v136
v_accvgpr_write_b32 a209, v137
v_accvgpr_write_b32 a210, v138
v_accvgpr_write_b32 a211, v139
v_accvgpr_read_b32 v144, a132
v_accvgpr_read_b32 v145, a133
v_accvgpr_read_b32 v146, a134
v_accvgpr_read_b32 v147, a135
v_accvgpr_read_b32 v148, a148
v_accvgpr_read_b32 v149, a149
v_accvgpr_read_b32 v150, a150
v_accvgpr_read_b32 v151, a151
v_cvt_pk_bf16_f32 v152, v144, v145
v_cvt_pk_bf16_f32 v153, v146, v147
v_cvt_pk_bf16_f32 v154, v148, v149
v_cvt_pk_bf16_f32 v155, v150, v151
v_accvgpr_write_b32 a232, v152
v_accvgpr_write_b32 a233, v153
v_accvgpr_write_b32 a234, v154
v_accvgpr_write_b32 a235, v155
v_accvgpr_read_b32 v128, a136
v_accvgpr_read_b32 v129, a137
v_accvgpr_read_b32 v130, a138
v_accvgpr_read_b32 v131, a139
v_accvgpr_read_b32 v132, a152
v_accvgpr_read_b32 v133, a153
v_accvgpr_read_b32 v134, a154
v_accvgpr_read_b32 v135, a155
v_cvt_pk_bf16_f32 v32, v128, v129
v_cvt_pk_bf16_f32 v33, v130, v131
v_cvt_pk_bf16_f32 v34, v132, v133
v_cvt_pk_bf16_f32 v35, v134, v135
v_accvgpr_read_b32 v144, a140
v_accvgpr_read_b32 v145, a141
v_accvgpr_read_b32 v146, a142
v_accvgpr_read_b32 v147, a143
v_accvgpr_read_b32 v148, a156
v_accvgpr_read_b32 v149, a157
v_accvgpr_read_b32 v150, a158
v_accvgpr_read_b32 v151, a159
v_cvt_pk_bf16_f32 v56, v144, v145
v_cvt_pk_bf16_f32 v57, v146, v147
v_cvt_pk_bf16_f32 v58, v148, v149
v_cvt_pk_bf16_f32 v59, v150, v151
v_accvgpr_read_b32 v128, a160
v_accvgpr_read_b32 v129, a161
v_accvgpr_read_b32 v130, a162
v_accvgpr_read_b32 v131, a163
v_accvgpr_read_b32 v132, a176
v_accvgpr_read_b32 v133, a177
v_accvgpr_read_b32 v134, a178
v_accvgpr_read_b32 v135, a179
v_cvt_pk_bf16_f32 v136, v128, v129
v_cvt_pk_bf16_f32 v137, v130, v131
v_cvt_pk_bf16_f32 v138, v132, v133
v_cvt_pk_bf16_f32 v139, v134, v135
v_accvgpr_write_b32 a212, v136
v_accvgpr_write_b32 a213, v137
v_accvgpr_write_b32 a214, v138
v_accvgpr_write_b32 a215, v139
v_accvgpr_read_b32 v144, a164
v_accvgpr_read_b32 v145, a165
v_accvgpr_read_b32 v146, a166
v_accvgpr_read_b32 v147, a167
v_accvgpr_read_b32 v148, a180
v_accvgpr_read_b32 v149, a181
v_accvgpr_read_b32 v150, a182
v_accvgpr_read_b32 v151, a183
v_cvt_pk_bf16_f32 v152, v144, v145
v_cvt_pk_bf16_f32 v153, v146, v147
v_cvt_pk_bf16_f32 v154, v148, v149
v_cvt_pk_bf16_f32 v155, v150, v151
v_accvgpr_write_b32 a236, v152
v_accvgpr_write_b32 a237, v153
v_accvgpr_write_b32 a238, v154
v_accvgpr_write_b32 a239, v155
v_accvgpr_read_b32 v128, a168
v_accvgpr_read_b32 v129, a169
v_accvgpr_read_b32 v130, a170
v_accvgpr_read_b32 v131, a171
v_accvgpr_read_b32 v132, a184
v_accvgpr_read_b32 v133, a185
v_accvgpr_read_b32 v134, a186
v_accvgpr_read_b32 v135, a187
v_cvt_pk_bf16_f32 v36, v128, v129
v_cvt_pk_bf16_f32 v37, v130, v131
v_cvt_pk_bf16_f32 v38, v132, v133
v_cvt_pk_bf16_f32 v39, v134, v135
v_accvgpr_read_b32 v144, a172
v_accvgpr_read_b32 v145, a173
v_accvgpr_read_b32 v146, a174
v_accvgpr_read_b32 v147, a175
v_accvgpr_read_b32 v148, a188
v_accvgpr_read_b32 v149, a189
v_accvgpr_read_b32 v150, a190
v_accvgpr_read_b32 v151, a191
v_cvt_pk_bf16_f32 v60, v144, v145
v_cvt_pk_bf16_f32 v61, v146, v147
v_cvt_pk_bf16_f32 v62, v148, v149
v_cvt_pk_bf16_f32 v63, v150, v151
ds_read_b64 v[244:245], v3
ds_read_b64 v[246:247], v4 offset:6144
ds_read_b64 v[248:249], v5 offset:12288
ds_read_b64 v[250:251], v6 offset:18432
s_waitcnt lgkmcnt(0)
v_and_b32 v244, 0x7fff7fff, v244
v_and_b32 v245, 0x7fff7fff, v245
v_and_b32 v246, 0x7fff7fff, v246
v_and_b32 v247, 0x7fff7fff, v247
v_and_b32 v248, 0x7fff7fff, v248
v_and_b32 v249, 0x7fff7fff, v249
v_and_b32 v250, 0x7fff7fff, v250
v_and_b32 v251, 0x7fff7fff, v251
v_pk_max_u16 v244, v244, v248
v_pk_max_u16 v245, v245, v249
v_pk_max_u16 v246, v246, v250
v_pk_max_u16 v247, v247, v251
v_pk_max_u16 v244, v244, v245
v_pk_max_u16 v246, v246, v247
v_pk_max_u16 v244, v244, v246
v_lshlrev_b32 v245, 16, v244
v_max_u32 v244, v244, v245
v_cmp_le_u32 vcc, 0x3c800000, v244
s_mov_b32 s32, 0xc2400000
s_mov_b32 s33, 0x5f800000
s_cmp_lg_u64 vcc, 0
s_cselect_b32 s32, 0xc2cc0000, s32
s_cselect_b32 s33, 0x44800000, s33
v_mfma_f32_16x16x32_bf16 v[64:67], v[192:195], a[192:195], 0
v_mul_f32 v240, v160, v160
v_mul_f32 v241, v161, v161
v_mfma_f32_16x16x32_bf16 v[64:67], v[196:199], a[196:199], v[64:67]
s_waitcnt lgkmcnt(0)
ds_read_b128 v[216:219], v1 offset:6144
v_mul_f32 v242, v162, v162
v_mfma_f32_16x16x32_bf16 v[64:67], v[200:203], a[200:203], v[64:67]
v_mul_f32 v243, v163, v163
v_fma_f32 v240, v240, s65, v14
v_mfma_f32_16x16x32_bf16 v[64:67], v[204:207], a[204:207], v[64:67]
s_waitcnt lgkmcnt(1)
v_fma_f32 v241, v241, s65, v14
v_fma_f32 v242, v242, s65, v14
v_mfma_f32_16x16x32_bf16 v[64:67], v[208:211], a[208:211], v[64:67]
ds_read_b128 v[220:223], v2 offset:6144
v_fma_f32 v243, v243, s65, v14
v_mfma_f32_16x16x32_bf16 v[64:67], v[212:215], a[212:215], v[64:67]
v_mul_f32 v240, v240, v160
v_mul_f32 v241, v241, v161
v_mfma_f32_16x16x32_bf16 v[68:71], v[212:215], a[236:239], 0
v_mul_f32 v242, v242, v162
v_mul_f32 v243, v243, v163
v_mfma_f32_16x16x32_bf16 v[68:71], v[208:211], a[232:235], v[68:71]
ds_read_b128 v[224:227], v1 offset:6272
v_mul_f32 v248, v164, v164
v_mfma_f32_16x16x32_bf16 v[68:71], v[204:207], a[228:231], v[68:71]
v_exp_f32 v240, v240
v_mfma_f32_16x16x32_bf16 v[68:71], v[200:203], a[224:227], v[68:71]
v_exp_f32 v241, v241
v_mfma_f32_16x16x32_bf16 v[68:71], v[196:199], a[220:223], v[68:71]
ds_read_b128 v[228:231], v2 offset:6272
v_mul_f32 v249, v165, v165
v_mfma_f32_16x16x32_bf16 v[68:71], v[192:195], a[216:219], v[68:71]
v_exp_f32 v242, v242
v_mfma_f32_16x16x32_bf16 v[72:75], v[192:195], a[240:243], 0
v_exp_f32 v243, v243
v_mfma_f32_16x16x32_bf16 v[72:75], v[196:199], a[244:247], v[72:75]
ds_read_b128 v[232:235], v1 offset:6400
v_max3_f32 v16, v64, v65, v66
v_mfma_f32_16x16x32_bf16 v[72:75], v[200:203], a[248:251], v[72:75]
v_max_f32 v16, v16, v67
v_fma_f32 v240, v240, s64, s64
v_mfma_f32_16x16x32_bf16 v[72:75], v[204:207], a[252:255], v[72:75]
v_fma_f32 v241, v241, s64, s64
v_fma_f32 v242, v242, s64, s64
v_mfma_f32_16x16x32_bf16 v[72:75], v[208:211], v[32:35], v[72:75]
ds_read_b128 v[236:239], v2 offset:6400
v_fma_f32 v243, v243, s64, s64
v_mfma_f32_16x16x32_bf16 v[72:75], v[212:215], v[36:39], v[72:75]
v_rcp_f32 v240, v240
v_mfma_f32_16x16x32_bf16 v[76:79], v[212:215], v[60:63], 0
v_rcp_f32 v241, v241
v_mfma_f32_16x16x32_bf16 v[76:79], v[208:211], v[56:59], v[76:79]
v_max3_f32 v20, v68, v69, v70
v_max_f32 v20, v20, v71
v_mfma_f32_16x16x32_bf16 v[76:79], v[204:207], v[52:55], v[76:79]
v_rcp_f32 v242, v242
v_mfma_f32_16x16x32_bf16 v[76:79], v[200:203], v[48:51], v[76:79]
v_rcp_f32 v243, v243
v_mfma_f32_16x16x32_bf16 v[76:79], v[196:199], v[44:47], v[76:79]
v_mul_f32 v240, v240, v160
v_mul_f32 v241, v241, v161
v_mfma_f32_16x16x32_bf16 v[76:79], v[192:195], v[40:43], v[76:79]
s_waitcnt lgkmcnt(0)
v_mul_f32 v242, v242, v162
v_mul_f32 v243, v243, v163
v_mfma_f32_16x16x32_bf16 v[80:83], v[216:219], a[192:195], 0
v_cvt_pk_bf16_f32 v244, v240, v241
v_cvt_pk_bf16_f32 v245, v242, v243
v_mfma_f32_16x16x32_bf16 v[80:83], v[220:223], a[196:199], v[80:83]
ds_read_b128 v[192:195], v1 offset:12288
v_max3_f32 v24, v72, v73, v74
v_mfma_f32_16x16x32_bf16 v[80:83], v[224:227], a[200:203], v[80:83]
v_max_f32 v24, v24, v75
v_mul_f32 v240, v176, v176
v_mfma_f32_16x16x32_bf16 v[80:83], v[228:231], a[204:207], v[80:83]
v_mul_f32 v241, v177, v177
v_mul_f32 v242, v178, v178
v_mfma_f32_16x16x32_bf16 v[80:83], v[232:235], a[208:211], v[80:83]
ds_read_b128 v[196:199], v2 offset:12288
v_mul_f32 v243, v179, v179
v_mfma_f32_16x16x32_bf16 v[80:83], v[236:239], a[212:215], v[80:83]
v_fma_f32 v240, v240, s65, v14
v_fma_f32 v241, v241, s65, v14
v_mfma_f32_16x16x32_bf16 v[84:87], v[236:239], a[236:239], 0
v_fma_f32 v242, v242, s65, v14
v_fma_f32 v243, v243, s65, v14
v_mfma_f32_16x16x32_bf16 v[84:87], v[232:235], a[232:235], v[84:87]
ds_read_b128 v[200:203], v1 offset:12416
v_max3_f32 v28, v76, v77, v78
v_mfma_f32_16x16x32_bf16 v[84:87], v[228:231], a[228:231], v[84:87]
v_max_f32 v28, v28, v79
v_mul_f32 v240, v240, v176
v_mfma_f32_16x16x32_bf16 v[84:87], v[224:227], a[224:227], v[84:87]
v_mul_f32 v241, v241, v177
v_mul_f32 v242, v242, v178
v_mfma_f32_16x16x32_bf16 v[84:87], v[220:223], a[220:223], v[84:87]
ds_read_b128 v[204:207], v2 offset:12416
v_mul_f32 v243, v243, v179
v_mfma_f32_16x16x32_bf16 v[84:87], v[216:219], a[216:219], v[84:87]
v_exp_f32 v240, v240
v_mfma_f32_16x16x32_bf16 v[88:91], v[216:219], a[240:243], 0
v_exp_f32 v241, v241
v_mfma_f32_16x16x32_bf16 v[88:91], v[220:223], a[244:247], v[88:91]
ds_read_b128 v[208:211], v1 offset:12544
v_max3_f32 v16, v16, v80, v81
v_mfma_f32_16x16x32_bf16 v[88:91], v[224:227], a[248:251], v[88:91]
v_max3_f32 v16, v16, v82, v83
v_mul_f32 v250, v166, v166
v_mfma_f32_16x16x32_bf16 v[88:91], v[228:231], a[252:255], v[88:91]
v_exp_f32 v242, v242
v_mfma_f32_16x16x32_bf16 v[88:91], v[232:235], v[32:35], v[88:91]
ds_read_b128 v[212:215], v2 offset:12544
v_mul_f32 v251, v167, v167
v_mfma_f32_16x16x32_bf16 v[88:91], v[236:239], v[36:39], v[88:91]
v_exp_f32 v243, v243
v_mfma_f32_16x16x32_bf16 v[92:95], v[236:239], v[60:63], 0
v_fma_f32 v240, v240, s64, s64
v_fma_f32 v241, v241, s64, s64
v_mfma_f32_16x16x32_bf16 v[92:95], v[232:235], v[56:59], v[92:95]
v_max3_f32 v20, v20, v84, v85
v_max3_f32 v20, v20, v86, v87
v_mfma_f32_16x16x32_bf16 v[92:95], v[228:231], v[52:55], v[92:95]
v_fma_f32 v242, v242, s64, s64
v_fma_f32 v243, v243, s64, s64
v_mfma_f32_16x16x32_bf16 v[92:95], v[224:227], v[48:51], v[92:95]
v_rcp_f32 v240, v240
v_mfma_f32_16x16x32_bf16 v[92:95], v[220:223], v[44:47], v[92:95]
v_rcp_f32 v241, v241
v_mfma_f32_16x16x32_bf16 v[92:95], v[216:219], v[40:43], v[92:95]
s_waitcnt lgkmcnt(0)
v_rcp_f32 v242, v242
v_mfma_f32_16x16x32_bf16 v[96:99], v[192:195], a[192:195], 0
v_rcp_f32 v243, v243
v_mfma_f32_16x16x32_bf16 v[96:99], v[196:199], a[196:199], v[96:99]
ds_read_b128 v[216:219], v1 offset:18432
v_max3_f32 v24, v24, v88, v89
v_mfma_f32_16x16x32_bf16 v[96:99], v[200:203], a[200:203], v[96:99]
v_max3_f32 v24, v24, v90, v91
v_mul_f32 v240, v240, v176
v_mfma_f32_16x16x32_bf16 v[96:99], v[204:207], a[204:207], v[96:99]
v_mul_f32 v241, v241, v177
v_mul_f32 v242, v242, v178
v_mfma_f32_16x16x32_bf16 v[96:99], v[208:211], a[208:211], v[96:99]
ds_read_b128 v[220:223], v2 offset:18432
v_mul_f32 v243, v243, v179
v_mfma_f32_16x16x32_bf16 v[96:99], v[212:215], a[212:215], v[96:99]
v_cvt_pk_bf16_f32 v246, v240, v241
v_cvt_pk_bf16_f32 v247, v242, v243
v_mfma_f32_16x16x32_bf16 v[100:103], v[212:215], a[236:239], 0
s_add_u32 s74, s59, 0
buffer_store_dwordx4 v[244:247], v10, s[20:23], s74 offen sc1
v_fma_f32 v248, v248, s65, v14
v_mfma_f32_16x16x32_bf16 v[100:103], v[208:211], a[232:235], v[100:103]
ds_read_b128 v[224:227], v1 offset:18560
v_max3_f32 v28, v28, v92, v93
v_mfma_f32_16x16x32_bf16 v[100:103], v[204:207], a[228:231], v[100:103]
v_max3_f32 v28, v28, v94, v95
v_fma_f32 v249, v249, s65, v14
v_mfma_f32_16x16x32_bf16 v[100:103], v[200:203], a[224:227], v[100:103]
v_fma_f32 v250, v250, s65, v14
v_fma_f32 v251, v251, s65, v14
v_mfma_f32_16x16x32_bf16 v[100:103], v[196:199], a[220:223], v[100:103]
ds_read_b128 v[228:231], v2 offset:18560
v_mul_f32 v248, v248, v164
v_mfma_f32_16x16x32_bf16 v[100:103], v[192:195], a[216:219], v[100:103]
v_mul_f32 v249, v249, v165
v_mul_f32 v250, v250, v166
v_mfma_f32_16x16x32_bf16 v[104:107], v[192:195], a[240:243], 0
v_mul_f32 v251, v251, v167
v_mfma_f32_16x16x32_bf16 v[104:107], v[196:199], a[244:247], v[104:107]
ds_read_b128 v[232:235], v1 offset:18688
v_max3_f32 v16, v16, v96, v97
v_mfma_f32_16x16x32_bf16 v[104:107], v[200:203], a[248:251], v[104:107]
v_max3_f32 v16, v16, v98, v99
v_mfma_f32_16x16x32_bf16 v[104:107], v[204:207], a[252:255], v[104:107]
v_exp_f32 v248, v248
v_mfma_f32_16x16x32_bf16 v[104:107], v[208:211], v[32:35], v[104:107]
ds_read_b128 v[236:239], v2 offset:18688
v_mfma_f32_16x16x32_bf16 v[104:107], v[212:215], v[36:39], v[104:107]
v_exp_f32 v249, v249
v_mfma_f32_16x16x32_bf16 v[108:111], v[212:215], v[60:63], 0
v_exp_f32 v250, v250
v_mfma_f32_16x16x32_bf16 v[108:111], v[208:211], v[56:59], v[108:111]
v_max3_f32 v20, v20, v100, v101
v_max3_f32 v20, v20, v102, v103
v_mfma_f32_16x16x32_bf16 v[108:111], v[204:207], v[52:55], v[108:111]
v_exp_f32 v251, v251
v_mfma_f32_16x16x32_bf16 v[108:111], v[200:203], v[48:51], v[108:111]
v_fma_f32 v248, v248, s64, s64
v_fma_f32 v249, v249, s64, s64
v_mfma_f32_16x16x32_bf16 v[108:111], v[196:199], v[44:47], v[108:111]
v_fma_f32 v250, v250, s64, s64
v_fma_f32 v251, v251, s64, s64
v_mfma_f32_16x16x32_bf16 v[108:111], v[192:195], v[40:43], v[108:111]
s_waitcnt lgkmcnt(0)
v_rcp_f32 v248, v248
v_mfma_f32_16x16x32_bf16 v[112:115], v[216:219], a[192:195], 0
v_rcp_f32 v249, v249
v_mfma_f32_16x16x32_bf16 v[112:115], v[220:223], a[196:199], v[112:115]
v_max3_f32 v24, v24, v104, v105
v_max3_f32 v24, v24, v106, v107
v_mfma_f32_16x16x32_bf16 v[112:115], v[224:227], a[200:203], v[112:115]
v_rcp_f32 v250, v250
v_mfma_f32_16x16x32_bf16 v[112:115], v[228:231], a[204:207], v[112:115]
v_rcp_f32 v251, v251
v_mfma_f32_16x16x32_bf16 v[112:115], v[232:235], a[208:211], v[112:115]
v_mul_f32 v248, v248, v164
v_mul_f32 v249, v249, v165
v_mfma_f32_16x16x32_bf16 v[112:115], v[236:239], a[212:215], v[112:115]
v_mul_f32 v250, v250, v166
v_mul_f32 v251, v251, v167
v_mfma_f32_16x16x32_bf16 v[116:119], v[236:239], a[236:239], 0
v_cvt_pk_bf16_f32 v252, v248, v249
v_cvt_pk_bf16_f32 v253, v250, v251
v_mfma_f32_16x16x32_bf16 v[116:119], v[232:235], a[232:235], v[116:119]
v_max3_f32 v28, v28, v108, v109
v_max3_f32 v28, v28, v110, v111
v_mfma_f32_16x16x32_bf16 v[116:119], v[228:231], a[228:231], v[116:119]
v_mul_f32 v248, v180, v180
v_mul_f32 v249, v181, v181
v_mfma_f32_16x16x32_bf16 v[116:119], v[224:227], a[224:227], v[116:119]
v_mul_f32 v250, v182, v182
v_mul_f32 v251, v183, v183
v_mfma_f32_16x16x32_bf16 v[116:119], v[220:223], a[220:223], v[116:119]
v_fma_f32 v248, v248, s65, v14
v_fma_f32 v249, v249, s65, v14
v_mfma_f32_16x16x32_bf16 v[116:119], v[216:219], a[216:219], v[116:119]
v_fma_f32 v250, v250, s65, v14
v_fma_f32 v251, v251, s65, v14
v_mfma_f32_16x16x32_bf16 v[120:123], v[216:219], a[240:243], 0
v_mul_f32 v248, v248, v180
v_mul_f32 v249, v249, v181
v_mfma_f32_16x16x32_bf16 v[120:123], v[220:223], a[244:247], v[120:123]
v_max3_f32 v16, v16, v112, v113
v_max3_f32 v16, v16, v114, v115
v_mfma_f32_16x16x32_bf16 v[120:123], v[224:227], a[248:251], v[120:123]
v_mul_f32 v250, v250, v182
v_mul_f32 v251, v251, v183
v_mfma_f32_16x16x32_bf16 v[120:123], v[228:231], a[252:255], v[120:123]
v_exp_f32 v248, v248
v_mfma_f32_16x16x32_bf16 v[120:123], v[232:235], v[32:35], v[120:123]
v_exp_f32 v249, v249
v_mfma_f32_16x16x32_bf16 v[120:123], v[236:239], v[36:39], v[120:123]
v_exp_f32 v250, v250
v_mfma_f32_16x16x32_bf16 v[124:127], v[236:239], v[60:63], 0
v_exp_f32 v251, v251
v_mfma_f32_16x16x32_bf16 v[124:127], v[232:235], v[56:59], v[124:127]
v_max3_f32 v20, v20, v116, v117
v_max3_f32 v20, v20, v118, v119
v_mfma_f32_16x16x32_bf16 v[124:127], v[228:231], v[52:55], v[124:127]
v_fma_f32 v248, v248, s64, s64
v_fma_f32 v249, v249, s64, s64
v_mfma_f32_16x16x32_bf16 v[124:127], v[224:227], v[48:51], v[124:127]
v_fma_f32 v250, v250, s64, s64
v_fma_f32 v251, v251, s64, s64
v_mfma_f32_16x16x32_bf16 v[124:127], v[220:223], v[44:47], v[124:127]
v_rcp_f32 v248, v248
v_mfma_f32_16x16x32_bf16 v[124:127], v[216:219], v[40:43], v[124:127]
v_rcp_f32 v249, v249
s_waitcnt vmcnt(17)
s_barrier
v_add_u32 v1, 24576, v1
v_add_u32 v2, 24576, v2
s_nop 4
ds_read_b128 v[192:195], v1
ds_read_b128 v[196:199], v2
ds_read_b128 v[200:203], v1 offset:128
ds_read_b128 v[204:207], v2 offset:128
ds_read_b128 v[208:211], v1 offset:256
ds_read_b128 v[212:215], v2 offset:256
v_max3_f32 v24, v24, v120, v121
v_max3_f32 v24, v24, v122, v123
v_max3_f32 v28, v28, v124, v125
v_max3_f32 v28, v28, v126, v127
v_mov_b32 v17, v16
v_mov_b32 v21, v20
v_mov_b32 v25, v24
v_mov_b32 v29, v28
v_permlane32_swap_b32 v16, v17
v_permlane32_swap_b32 v20, v21
v_permlane32_swap_b32 v24, v25
v_permlane32_swap_b32 v28, v29
v_max_f32 v16, v16, v17
v_max_f32 v20, v20, v21
v_max_f32 v24, v24, v25
v_max_f32 v28, v28, v29
v_mov_b32 v17, v16
v_mov_b32 v21, v20
v_mov_b32 v25, v24
v_mov_b32 v29, v28
v_permlane16_swap_b32 v16, v17
v_permlane16_swap_b32 v20, v21
v_permlane16_swap_b32 v24, v25
v_permlane16_swap_b32 v28, v29
v_max_f32 v16, v16, v17
v_max_f32 v20, v20, v21
v_max_f32 v24, v24, v25
v_max_f32 v28, v28, v29
v_sub_f32 v16, s32, v16
v_sub_f32 v20, s32, v20
v_sub_f32 v24, s32, v24
v_sub_f32 v28, s32, v28
v_mov_b32 v17, v16
v_mov_b32 v18, v16
v_mov_b32 v19, v16
v_mov_b32 v21, v20
v_mov_b32 v22, v20
v_mov_b32 v23, v20
v_mov_b32 v25, v24
v_mov_b32 v26, v24
v_mov_b32 v27, v24
v_mov_b32 v29, v28
v_mov_b32 v30, v28
v_mov_b32 v31, v28
v_rcp_f32 v250, v250
v_rcp_f32 v251, v251
v_mul_f32 v248, v248, v180
v_mul_f32 v249, v249, v181
v_mul_f32 v250, v250, v182
v_mul_f32 v251, v251, v183
v_cvt_pk_bf16_f32 v254, v248, v249
v_cvt_pk_bf16_f32 v255, v250, v251
s_add_u32 s75, s59, 245760
buffer_store_dwordx4 v[252:255], v10, s[20:23], s75 offen sc1
v_pk_mul_f32 v[240:241], v[168:169], v[168:169]
v_pk_mul_f32 v[242:243], v[170:171], v[170:171]
v_pk_fma_f32 v[240:241], v[240:241], s[64:65], v[14:15] op_sel:[0,1,0] op_sel_hi:[1,1,0]
v_pk_fma_f32 v[242:243], v[242:243], s[64:65], v[14:15] op_sel:[0,1,0] op_sel_hi:[1,1,0]
v_pk_mul_f32 v[240:241], v[240:241], v[168:169]
v_pk_mul_f32 v[242:243], v[242:243], v[170:171]
v_exp_f32 v240, v240
v_exp_f32 v241, v241
v_exp_f32 v242, v242
v_exp_f32 v243, v243
s_nop 0
v_pk_fma_f32 v[240:241], v[240:241], s[64:65], s[64:65] op_sel_hi:[1,0,0]
v_pk_fma_f32 v[242:243], v[242:243], s[64:65], s[64:65] op_sel_hi:[1,0,0]
v_rcp_f32 v240, v240
v_rcp_f32 v241, v241
v_rcp_f32 v242, v242
v_rcp_f32 v243, v243
s_nop 0
v_pk_mul_f32 v[240:241], v[240:241], v[168:169]
v_pk_mul_f32 v[242:243], v[242:243], v[170:171]
v_cvt_pk_bf16_f32 v244, v240, v241
v_cvt_pk_bf16_f32 v245, v242, v243
v_pk_mul_f32 v[240:241], v[184:185], v[184:185]
v_pk_mul_f32 v[242:243], v[186:187], v[186:187]
v_pk_fma_f32 v[240:241], v[240:241], s[64:65], v[14:15] op_sel:[0,1,0] op_sel_hi:[1,1,0]
v_pk_fma_f32 v[242:243], v[242:243], s[64:65], v[14:15] op_sel:[0,1,0] op_sel_hi:[1,1,0]
v_pk_mul_f32 v[240:241], v[240:241], v[184:185]
v_pk_mul_f32 v[242:243], v[242:243], v[186:187]
v_exp_f32 v240, v240
v_exp_f32 v241, v241
v_exp_f32 v242, v242
v_exp_f32 v243, v243
s_nop 0
v_pk_fma_f32 v[240:241], v[240:241], s[64:65], s[64:65] op_sel_hi:[1,0,0]
v_pk_fma_f32 v[242:243], v[242:243], s[64:65], s[64:65] op_sel_hi:[1,0,0]
v_rcp_f32 v240, v240
v_rcp_f32 v241, v241
v_rcp_f32 v242, v242
v_rcp_f32 v243, v243
s_nop 0
v_pk_mul_f32 v[240:241], v[240:241], v[184:185]
v_pk_mul_f32 v[242:243], v[242:243], v[186:187]
v_cvt_pk_bf16_f32 v246, v240, v241
v_cvt_pk_bf16_f32 v247, v242, v243
s_add_u32 s74, s59, 491520
buffer_store_dwordx4 v[244:247], v10, s[20:23], s74 offen sc1
v_pk_mul_f32 v[248:249], v[172:173], v[172:173]
v_pk_mul_f32 v[250:251], v[174:175], v[174:175]
v_pk_fma_f32 v[248:249], v[248:249], s[64:65], v[14:15] op_sel:[0,1,0] op_sel_hi:[1,1,0]
v_pk_fma_f32 v[250:251], v[250:251], s[64:65], v[14:15] op_sel:[0,1,0] op_sel_hi:[1,1,0]
v_pk_mul_f32 v[248:249], v[248:249], v[172:173]
v_pk_mul_f32 v[250:251], v[250:251], v[174:175]
v_exp_f32 v248, v248
v_exp_f32 v249, v249
v_exp_f32 v250, v250
v_exp_f32 v251, v251
s_nop 0
v_pk_fma_f32 v[248:249], v[248:249], s[64:65], s[64:65] op_sel_hi:[1,0,0]
v_pk_fma_f32 v[250:251], v[250:251], s[64:65], s[64:65] op_sel_hi:[1,0,0]
v_rcp_f32 v248, v248
v_rcp_f32 v249, v249
v_rcp_f32 v250, v250
v_rcp_f32 v251, v251
s_nop 0
v_pk_mul_f32 v[248:249], v[248:249], v[172:173]
v_pk_mul_f32 v[250:251], v[250:251], v[174:175]
v_cvt_pk_bf16_f32 v252, v248, v249
v_cvt_pk_bf16_f32 v253, v250, v251
v_pk_mul_f32 v[248:249], v[188:189], v[188:189]
v_pk_mul_f32 v[250:251], v[190:191], v[190:191]
v_pk_fma_f32 v[248:249], v[248:249], s[64:65], v[14:15] op_sel:[0,1,0] op_sel_hi:[1,1,0]
v_pk_fma_f32 v[250:251], v[250:251], s[64:65], v[14:15] op_sel:[0,1,0] op_sel_hi:[1,1,0]
v_pk_mul_f32 v[248:249], v[248:249], v[188:189]
v_pk_mul_f32 v[250:251], v[250:251], v[190:191]
v_exp_f32 v248, v248
v_exp_f32 v249, v249
v_exp_f32 v250, v250
v_exp_f32 v251, v251
s_nop 0
v_pk_fma_f32 v[248:249], v[248:249], s[64:65], s[64:65] op_sel_hi:[1,0,0]
v_pk_fma_f32 v[250:251], v[250:251], s[64:65], s[64:65] op_sel_hi:[1,0,0]
v_rcp_f32 v248, v248
v_rcp_f32 v249, v249
v_rcp_f32 v250, v250
v_rcp_f32 v251, v251
s_nop 0
v_pk_mul_f32 v[248:249], v[248:249], v[188:189]
v_pk_mul_f32 v[250:251], v[250:251], v[190:191]
v_cvt_pk_bf16_f32 v254, v248, v249
v_cvt_pk_bf16_f32 v255, v250, v251
s_add_u32 s75, s59, 737280
buffer_store_dwordx4 v[252:255], v10, s[20:23], s75 offen sc1
L_common:
v_pk_add_f32 v[64:65], v[64:65], v[16:17]
v_pk_add_f32 v[66:67], v[66:67], v[16:17]
v_exp_f32 v64, v64
v_exp_f32 v65, v65
v_exp_f32 v66, v66
v_exp_f32 v67, v67
v_pk_add_f32 v[68:69], v[68:69], v[20:21]
v_pk_add_f32 v[70:71], v[70:71], v[20:21]
v_exp_f32 v68, v68
v_exp_f32 v69, v69
v_exp_f32 v70, v70
v_exp_f32 v71, v71
v_pk_add_f32 v[240:241], v[64:65], v[66:67]
v_cvt_pk_bf16_f32 v128, v64, v65
v_cvt_pk_bf16_f32 v129, v66, v67
v_pk_add_f32 v[72:73], v[72:73], v[24:25]
v_pk_add_f32 v[74:75], v[74:75], v[24:25]
v_exp_f32 v72, v72
v_exp_f32 v73, v73
v_exp_f32 v74, v74
v_exp_f32 v75, v75
v_pk_add_f32 v[242:243], v[68:69], v[70:71]
v_cvt_pk_bf16_f32 v136, v68, v69
v_cvt_pk_bf16_f32 v137, v70, v71
v_pk_add_f32 v[76:77], v[76:77], v[28:29]
v_pk_add_f32 v[78:79], v[78:79], v[28:29]
v_exp_f32 v76, v76
v_exp_f32 v77, v77
v_exp_f32 v78, v78
v_exp_f32 v79, v79
v_pk_add_f32 v[244:245], v[72:73], v[74:75]
v_cvt_pk_bf16_f32 v144, v72, v73
v_cvt_pk_bf16_f32 v145, v74, v75
v_pk_add_f32 v[80:81], v[80:81], v[16:17]
v_pk_add_f32 v[82:83], v[82:83], v[16:17]
v_exp_f32 v80, v80
v_exp_f32 v81, v81
v_exp_f32 v82, v82
v_exp_f32 v83, v83
v_pk_add_f32 v[246:247], v[76:77], v[78:79]
v_cvt_pk_bf16_f32 v152, v76, v77
v_cvt_pk_bf16_f32 v153, v78, v79
v_pk_add_f32 v[84:85], v[84:85], v[20:21]
v_pk_add_f32 v[86:87], v[86:87], v[20:21]
v_exp_f32 v84, v84
v_exp_f32 v85, v85
v_exp_f32 v86, v86
v_exp_f32 v87, v87
v_pk_add_f32 v[240:241], v[240:241], v[80:81]
v_pk_add_f32 v[240:241], v[240:241], v[82:83]
v_cvt_pk_bf16_f32 v130, v80, v81
v_cvt_pk_bf16_f32 v131, v82, v83
v_pk_add_f32 v[88:89], v[88:89], v[24:25]
v_pk_add_f32 v[90:91], v[90:91], v[24:25]
v_exp_f32 v88, v88
v_exp_f32 v89, v89
v_exp_f32 v90, v90
v_exp_f32 v91, v91
v_pk_add_f32 v[242:243], v[242:243], v[84:85]
v_pk_add_f32 v[242:243], v[242:243], v[86:87]
v_cvt_pk_bf16_f32 v138, v84, v85
v_cvt_pk_bf16_f32 v139, v86, v87
v_pk_add_f32 v[92:93], v[92:93], v[28:29]
v_pk_add_f32 v[94:95], v[94:95], v[28:29]
v_exp_f32 v92, v92
v_exp_f32 v93, v93
v_exp_f32 v94, v94
v_exp_f32 v95, v95
v_pk_add_f32 v[244:245], v[244:245], v[88:89]
v_pk_add_f32 v[244:245], v[244:245], v[90:91]
v_cvt_pk_bf16_f32 v146, v88, v89
v_cvt_pk_bf16_f32 v147, v90, v91
v_pk_add_f32 v[96:97], v[96:97], v[16:17]
v_pk_add_f32 v[98:99], v[98:99], v[16:17]
v_exp_f32 v96, v96
v_exp_f32 v97, v97
v_exp_f32 v98, v98
v_exp_f32 v99, v99
v_pk_add_f32 v[246:247], v[246:247], v[92:93]
v_pk_add_f32 v[246:247], v[246:247], v[94:95]
v_cvt_pk_bf16_f32 v154, v92, v93
v_cvt_pk_bf16_f32 v155, v94, v95
v_pk_add_f32 v[100:101], v[100:101], v[20:21]
v_pk_add_f32 v[102:103], v[102:103], v[20:21]
v_exp_f32 v100, v100
v_exp_f32 v101, v101
v_exp_f32 v102, v102
v_exp_f32 v103, v103
v_pk_add_f32 v[240:241], v[240:241], v[96:97]
v_pk_add_f32 v[240:241], v[240:241], v[98:99]
v_cvt_pk_bf16_f32 v132, v96, v97
v_cvt_pk_bf16_f32 v133, v98, v99
v_pk_add_f32 v[104:105], v[104:105], v[24:25]
v_pk_add_f32 v[106:107], v[106:107], v[24:25]
v_exp_f32 v104, v104
v_exp_f32 v105, v105
v_exp_f32 v106, v106
v_exp_f32 v107, v107
v_pk_add_f32 v[242:243], v[242:243], v[100:101]
v_pk_add_f32 v[242:243], v[242:243], v[102:103]
v_cvt_pk_bf16_f32 v140, v100, v101
v_cvt_pk_bf16_f32 v141, v102, v103
v_pk_add_f32 v[108:109], v[108:109], v[28:29]
v_pk_add_f32 v[110:111], v[110:111], v[28:29]
v_exp_f32 v108, v108
v_exp_f32 v109, v109
v_exp_f32 v110, v110
v_exp_f32 v111, v111
v_pk_add_f32 v[244:245], v[244:245], v[104:105]
v_pk_add_f32 v[244:245], v[244:245], v[106:107]
v_cvt_pk_bf16_f32 v148, v104, v105
v_cvt_pk_bf16_f32 v149, v106, v107
v_pk_add_f32 v[112:113], v[112:113], v[16:17]
v_pk_add_f32 v[114:115], v[114:115], v[16:17]
v_exp_f32 v112, v112
v_exp_f32 v113, v113
v_exp_f32 v114, v114
v_exp_f32 v115, v115
v_pk_add_f32 v[246:247], v[246:247], v[108:109]
v_pk_add_f32 v[246:247], v[246:247], v[110:111]
v_cvt_pk_bf16_f32 v156, v108, v109
v_cvt_pk_bf16_f32 v157, v110, v111
v_pk_add_f32 v[116:117], v[116:117], v[20:21]
v_pk_add_f32 v[118:119], v[118:119], v[20:21]
v_exp_f32 v116, v116
v_exp_f32 v117, v117
v_exp_f32 v118, v118
v_exp_f32 v119, v119
v_pk_add_f32 v[240:241], v[240:241], v[112:113]
v_pk_add_f32 v[240:241], v[240:241], v[114:115]
v_cvt_pk_bf16_f32 v134, v112, v113
v_cvt_pk_bf16_f32 v135, v114, v115
v_pk_add_f32 v[120:121], v[120:121], v[24:25]
v_pk_add_f32 v[122:123], v[122:123], v[24:25]
v_exp_f32 v120, v120
v_exp_f32 v121, v121
v_exp_f32 v122, v122
v_exp_f32 v123, v123
v_pk_add_f32 v[242:243], v[242:243], v[116:117]
v_pk_add_f32 v[242:243], v[242:243], v[118:119]
v_cvt_pk_bf16_f32 v142, v116, v117
v_cvt_pk_bf16_f32 v143, v118, v119
v_pk_add_f32 v[124:125], v[124:125], v[28:29]
v_pk_add_f32 v[126:127], v[126:127], v[28:29]
v_exp_f32 v124, v124
v_exp_f32 v125, v125
v_exp_f32 v126, v126
v_exp_f32 v127, v127
v_pk_add_f32 v[244:245], v[244:245], v[120:121]
v_pk_add_f32 v[244:245], v[244:245], v[122:123]
v_cvt_pk_bf16_f32 v150, v120, v121
v_cvt_pk_bf16_f32 v151, v122, v123
s_nop 0
v_pk_add_f32 v[246:247], v[246:247], v[124:125]
v_pk_add_f32 v[246:247], v[246:247], v[126:127]
v_cvt_pk_bf16_f32 v158, v124, v125
v_cvt_pk_bf16_f32 v159, v126, v127
v_add_f32 v10, v240, v241
v_add_f32 v11, v242, v243
v_add_f32 v12, v244, v245
v_add_f32 v13, v246, v247
s_add_u32 s56, s68, 73728
s_mov_b32 s63, 5
s_add_u32 s74, s54, 75513856
v_mov_b32 v14, s70
v_mov_b32 v15, s71
v_lshlrev_b32 v245, 4, v0
v_mov_b32 v246, 2139193217
v_mov_b32 v247, 2139193217
v_mov_b32 v248, 2139193217
v_mov_b32 v249, 2139193217
s_lshl_b32 s34, s72, 2
s_add_u32 s34, s34, s73
s_lshl_b32 s34, s34, 2
s_add_u32 s34, s34, s3
s_lshl_b32 s34, s34, 2
s_add_u32 s34, s34, s52
s_mul_i32 s34, s34, 10240
s_add_u32 s34, s34, 62914560
v_lshlrev_b32 v251, 7, v0
v_mov_b32 v252, 0
s_waitcnt lgkmcnt(0)
s_getpc_b64 s[16:17]
L_pc2:
s_lshr_b32 s19, s2, 3
s_lshl_b32 s19, s19, 2
s_add_u32 s19, s19, s52
s_lshl_b32 s18, s52, 13
s_add_u32 s18, s18, L_tail-L_pc2
s_add_u32 s16, s16, s18
s_addc_u32 s17, s17, 0
s_mul_i32 s18, s19, 15360
s_mul_i32 s24, s3, 1966080
s_add_u32 s18, s18, s24
s_add_u32 s26, s18, 8192
s_mul_i32 s19, s19, 3840
s_mul_i32 s24, s3, 491520
s_add_u32 s19, s19, s24
s_brev_b32 s27, 1
v_mfma_f32_16x16x32_bf16 v[64:67], v[192:195], a[192:195], v[16:19]
v_add_u32 v255, 0, v0
v_mul_u32_u24 v253, 3277, v255
v_mfma_f32_16x16x32_bf16 v[64:67], v[196:199], a[196:199], v[64:67]
s_waitcnt lgkmcnt(0)
ds_read_b128 v[216:219], v1 offset:6144
v_lshrrev_b32 v253, 16, v253
v_mfma_f32_16x16x32_bf16 v[64:67], v[200:203], a[200:203], v[64:67]
s_add_u32 s57, s56, 3072
v_mul_u32_u24 v254, 20, v253
v_sub_u32 v254, v255, v254
v_mfma_f32_16x16x32_bf16 v[64:67], v[204:207], a[204:207], v[64:67]
s_waitcnt lgkmcnt(1)
v_lshrrev_b32 v255, 1, v253
v_and_b32 v255, 2, v255
v_mfma_f32_16x16x32_bf16 v[64:67], v[208:211], a[208:211], v[64:67]
s_sub_u32 s58, s56, 24576
ds_read_b128 v[220:223], v2 offset:6144
v_xor_b32 v254, v254, v255
v_mfma_f32_16x16x32_bf16 v[64:67], v[212:215], a[212:215], v[64:67]
s_sub_u32 s59, s56, 21504
v_mul_u32_u24 v255, 80, v253
v_add_u32 v255, v255, v254
v_mfma_f32_16x16x32_bf16 v[68:71], v[212:215], a[236:239], v[20:23]
v_lshlrev_b32 v240, 4, v255
v_add_u32 v255, 64, v0
v_mfma_f32_16x16x32_bf16 v[68:71], v[208:211], a[232:235], v[68:71]
ds_read_b128 v[224:227], v1 offset:6272
v_mul_u32_u24 v253, 3277, v255
v_mfma_f32_16x16x32_bf16 v[68:71], v[204:207], a[228:231], v[68:71]
s_add_u32 m0, s68, 0
v_lshrrev_b32 v253, 16, v253
v_mul_u32_u24 v254, 20, v253
v_mfma_f32_16x16x32_bf16 v[68:71], v[200:203], a[224:227], v[68:71]
v_sub_u32 v254, v255, v254
v_lshrrev_b32 v255, 1, v253
v_mfma_f32_16x16x32_bf16 v[68:71], v[196:199], a[220:223], v[68:71]
ds_read_b128 v[228:231], v2 offset:6272
v_and_b32 v255, 2, v255
v_mfma_f32_16x16x32_bf16 v[68:71], v[192:195], a[216:219], v[68:71]
buffer_load_dwordx4 v7, s[4:7], s56 offen lds
v_xor_b32 v254, v254, v255
v_mfma_f32_16x16x32_bf16 v[72:75], v[192:195], a[240:243], v[24:27]
v_exp_f32 v64, v64
v_mfma_f32_16x16x32_bf16 v[72:75], v[196:199], a[244:247], v[72:75]
ds_read_b128 v[232:235], v1 offset:6400
v_add_f32 v10, v10, v64
v_mfma_f32_16x16x32_bf16 v[72:75], v[200:203], a[248:251], v[72:75]
v_exp_f32 v65, v65
v_mfma_f32_16x16x32_bf16 v[72:75], v[204:207], a[252:255], v[72:75]
v_add_f32 v10, v10, v65
v_cvt_pk_bf16_f32 v160, v64, v65
v_mfma_f32_16x16x32_bf16 v[72:75], v[208:211], v[32:35], v[72:75]
ds_read_b128 v[236:239], v2 offset:6400
v_mul_u32_u24 v255, 80, v253
v_mfma_f32_16x16x32_bf16 v[72:75], v[212:215], v[36:39], v[72:75]
v_exp_f32 v66, v66
v_mfma_f32_16x16x32_bf16 v[76:79], v[212:215], v[60:63], v[28:31]
v_add_f32 v10, v10, v66
v_add_u32 v255, v255, v254
v_mfma_f32_16x16x32_bf16 v[76:79], v[208:211], v[56:59], v[76:79]
v_exp_f32 v67, v67
v_mfma_f32_16x16x32_bf16 v[76:79], v[204:207], v[52:55], v[76:79]
v_add_f32 v10, v10, v67
v_cvt_pk_bf16_f32 v161, v66, v67
v_mfma_f32_16x16x32_bf16 v[76:79], v[200:203], v[48:51], v[76:79]
v_exp_f32 v68, v68
v_mfma_f32_16x16x32_bf16 v[76:79], v[196:199], v[44:47], v[76:79]
v_add_f32 v11, v11, v68
v_lshlrev_b32 v241, 4, v255
v_mfma_f32_16x16x32_bf16 v[76:79], v[192:195], v[40:43], v[76:79]
s_waitcnt lgkmcnt(0)
buffer_load_dwordx4 v8, s[4:7], s56 offen offset:1024 lds
v_subrev_u32 v241, 1024, v241
v_mfma_f32_16x16x32_bf16 v[80:83], v[216:219], a[192:195], v[16:19]
v_exp_f32 v69, v69
v_mfma_f32_16x16x32_bf16 v[80:83], v[220:223], a[196:199], v[80:83]
ds_read_b128 v[192:195], v1 offset:12288
v_add_f32 v11, v11, v69
v_mfma_f32_16x16x32_bf16 v[80:83], v[224:227], a[200:203], v[80:83]
v_cvt_pk_bf16_f32 v168, v68, v69
v_add_u32 v255, 128, v0
v_mfma_f32_16x16x32_bf16 v[80:83], v[228:231], a[204:207], v[80:83]
v_exp_f32 v70, v70
v_mfma_f32_16x16x32_bf16 v[80:83], v[232:235], a[208:211], v[80:83]
ds_read_b128 v[196:199], v2 offset:12288
v_add_f32 v11, v11, v70
v_mfma_f32_16x16x32_bf16 v[80:83], v[236:239], a[212:215], v[80:83]
v_mul_u32_u24 v253, 3277, v255
v_lshrrev_b32 v253, 16, v253
v_mfma_f32_16x16x32_bf16 v[84:87], v[236:239], a[236:239], v[20:23]
v_exp_f32 v71, v71
v_mfma_f32_16x16x32_bf16 v[84:87], v[232:235], a[232:235], v[84:87]
ds_read_b128 v[200:203], v1 offset:12416
v_add_f32 v11, v11, v71
v_mfma_f32_16x16x32_bf16 v[84:87], v[228:231], a[228:231], v[84:87]
v_exp_f32 v72, v72
v_mfma_f32_16x16x32_bf16 v[84:87], v[224:227], a[224:227], v[84:87]
v_cvt_pk_bf16_f32 v169, v70, v71
v_add_f32 v12, v12, v72
v_mfma_f32_16x16x32_bf16 v[84:87], v[220:223], a[220:223], v[84:87]
ds_read_b128 v[204:207], v2 offset:12416
v_mul_u32_u24 v254, 20, v253
v_mfma_f32_16x16x32_bf16 v[84:87], v[216:219], a[216:219], v[84:87]
buffer_load_dwordx4 v9, s[4:7], s56 offen offset:2048 lds
v_sub_u32 v254, v255, v254
v_mfma_f32_16x16x32_bf16 v[88:91], v[216:219], a[240:243], v[24:27]
v_exp_f32 v73, v73
v_mfma_f32_16x16x32_bf16 v[88:91], v[220:223], a[244:247], v[88:91]
ds_read_b128 v[208:211], v1 offset:12544
v_add_f32 v12, v12, v73
v_mfma_f32_16x16x32_bf16 v[88:91], v[224:227], a[248:251], v[88:91]
v_exp_f32 v74, v74
v_mfma_f32_16x16x32_bf16 v[88:91], v[228:231], a[252:255], v[88:91]
v_cvt_pk_bf16_f32 v176, v72, v73
v_add_f32 v12, v12, v74
v_mfma_f32_16x16x32_bf16 v[88:91], v[232:235], v[32:35], v[88:91]
ds_read_b128 v[212:215], v2 offset:12544
v_lshrrev_b32 v255, 1, v253
v_mfma_f32_16x16x32_bf16 v[88:91], v[236:239], v[36:39], v[88:91]
v_exp_f32 v75, v75
v_mfma_f32_16x16x32_bf16 v[92:95], v[236:239], v[60:63], v[28:31]
v_add_f32 v12, v12, v75
v_cvt_pk_bf16_f32 v177, v74, v75
v_mfma_f32_16x16x32_bf16 v[92:95], v[232:235], v[56:59], v[92:95]
v_exp_f32 v76, v76
v_mfma_f32_16x16x32_bf16 v[92:95], v[228:231], v[52:55], v[92:95]
s_add_u32 m0, s68, 3072
v_add_f32 v13, v13, v76
v_and_b32 v255, 2, v255
v_mfma_f32_16x16x32_bf16 v[92:95], v[224:227], v[48:51], v[92:95]
v_xor_b32 v254, v254, v255
v_mul_u32_u24 v255, 80, v253
v_mfma_f32_16x16x32_bf16 v[92:95], v[220:223], v[44:47], v[92:95]
v_exp_f32 v77, v77
v_mfma_f32_16x16x32_bf16 v[92:95], v[216:219], v[40:43], v[92:95]
s_waitcnt lgkmcnt(0)
buffer_load_dwordx4 v7, s[4:7], s57 offen lds
v_add_f32 v13, v13, v77
v_mfma_f32_16x16x32_bf16 v[96:99], v[192:195], a[192:195], v[16:19]
v_cvt_pk_bf16_f32 v184, v76, v77
v_add_u32 v255, v255, v254
v_mfma_f32_16x16x32_bf16 v[96:99], v[196:199], a[196:199], v[96:99]
ds_read_b128 v[216:219], v1 offset:18432
v_lshlrev_b32 v242, 4, v255
v_mfma_f32_16x16x32_bf16 v[96:99], v[200:203], a[200:203], v[96:99]
v_exp_f32 v78, v78
v_mfma_f32_16x16x32_bf16 v[96:99], v[204:207], a[204:207], v[96:99]
v_add_f32 v13, v13, v78
v_subrev_u32 v242, 2048, v242
v_mfma_f32_16x16x32_bf16 v[96:99], v[208:211], a[208:211], v[96:99]
ds_read_b128 v[220:223], v2 offset:18432
v_add_u32 v255, 192, v0
v_mfma_f32_16x16x32_bf16 v[96:99], v[212:215], a[212:215], v[96:99]
v_exp_f32 v79, v79
v_mfma_f32_16x16x32_bf16 v[100:103], v[212:215], a[236:239], v[20:23]
v_exp_f32 v80, v80
v_mfma_f32_16x16x32_bf16 v[100:103], v[208:211], a[232:235], v[100:103]
ds_read_b128 v[224:227], v1 offset:18560
v_add_f32 v13, v13, v79
v_mfma_f32_16x16x32_bf16 v[100:103], v[204:207], a[228:231], v[100:103]
v_cvt_pk_bf16_f32 v185, v78, v79
v_add_f32 v10, v10, v80
v_mfma_f32_16x16x32_bf16 v[100:103], v[200:203], a[224:227], v[100:103]
v_exp_f32 v81, v81
v_mfma_f32_16x16x32_bf16 v[100:103], v[196:199], a[220:223], v[100:103]
ds_read_b128 v[228:231], v2 offset:18560
v_add_f32 v10, v10, v81
v_mfma_f32_16x16x32_bf16 v[100:103], v[192:195], a[216:219], v[100:103]
buffer_load_dwordx4 v8, s[4:7], s57 offen offset:1024 lds
v_cvt_pk_bf16_f32 v162, v80, v81
v_mfma_f32_16x16x32_bf16 v[104:107], v[192:195], a[240:243], v[24:27]
v_exp_f32 v82, v82
v_mfma_f32_16x16x32_bf16 v[104:107], v[196:199], a[244:247], v[104:107]
ds_read_b128 v[232:235], v1 offset:18688
v_add_f32 v10, v10, v82
v_mfma_f32_16x16x32_bf16 v[104:107], v[200:203], a[248:251], v[104:107]
v_mul_u32_u24 v253, 3277, v255
v_lshrrev_b32 v253, 16, v253
v_mfma_f32_16x16x32_bf16 v[104:107], v[204:207], a[252:255], v[104:107]
v_exp_f32 v83, v83
v_mfma_f32_16x16x32_bf16 v[104:107], v[208:211], v[32:35], v[104:107]
ds_read_b128 v[236:239], v2 offset:18688
v_add_f32 v10, v10, v83
v_mfma_f32_16x16x32_bf16 v[104:107], v[212:215], v[36:39], v[104:107]
v_exp_f32 v84, v84
v_mfma_f32_16x16x32_bf16 v[108:111], v[212:215], v[60:63], v[28:31]
v_cvt_pk_bf16_f32 v163, v82, v83
v_add_f32 v11, v11, v84
v_mfma_f32_16x16x32_bf16 v[108:111], v[208:211], v[56:59], v[108:111]
v_mul_u32_u24 v254, 20, v253
v_sub_u32 v254, v255, v254
v_mfma_f32_16x16x32_bf16 v[108:111], v[204:207], v[52:55], v[108:111]
v_exp_f32 v85, v85
v_mfma_f32_16x16x32_bf16 v[108:111], v[200:203], v[48:51], v[108:111]
v_add_f32 v11, v11, v85
v_cvt_pk_bf16_f32 v170, v84, v85
v_mfma_f32_16x16x32_bf16 v[108:111], v[196:199], v[44:47], v[108:111]
v_lshrrev_b32 v255, 1, v253
v_and_b32 v255, 2, v255
v_mfma_f32_16x16x32_bf16 v[108:111], v[192:195], v[40:43], v[108:111]
s_waitcnt lgkmcnt(0)
buffer_load_dwordx4 v9, s[4:7], s57 offen offset:2048 lds
v_xor_b32 v254, v254, v255
v_mfma_f32_16x16x32_bf16 v[112:115], v[216:219], a[192:195], v[16:19]
v_exp_f32 v86, v86
v_mfma_f32_16x16x32_bf16 v[112:115], v[220:223], a[196:199], v[112:115]
ds_read_b64_tr_b16 v[192:193], v3
v_add_f32 v11, v11, v86
v_mfma_f32_16x16x32_bf16 v[112:115], v[224:227], a[200:203], v[112:115]
ds_read_b64_tr_b16 v[194:195], v3 offset:6144
v_mul_u32_u24 v255, 80, v253
v_mfma_f32_16x16x32_bf16 v[112:115], v[228:231], a[204:207], v[112:115]
v_exp_f32 v87, v87
v_mfma_f32_16x16x32_bf16 v[112:115], v[232:235], a[208:211], v[112:115]
ds_read_b64_tr_b16 v[196:197], v3 offset:12288
v_add_f32 v11, v11, v87
v_mfma_f32_16x16x32_bf16 v[112:115], v[236:239], a[212:215], v[112:115]
ds_read_b64_tr_b16 v[198:199], v3 offset:18432
v_cvt_pk_bf16_f32 v171, v86, v87
v_mfma_f32_16x16x32_bf16 v[116:119], v[236:239], a[236:239], v[20:23]
v_exp_f32 v88, v88
v_mfma_f32_16x16x32_bf16 v[116:119], v[232:235], a[232:235], v[116:119]
ds_read_b64_tr_b16 v[200:201], v4
v_add_f32 v12, v12, v88
v_mfma_f32_16x16x32_bf16 v[116:119], v[228:231], a[228:231], v[116:119]
s_add_u32 m0, s68, 73728
ds_read_b64_tr_b16 v[202:203], v4 offset:6144
v_add_u32 v255, v255, v254
v_mfma_f32_16x16x32_bf16 v[116:119], v[224:227], a[224:227], v[116:119]
v_exp_f32 v89, v89
v_mfma_f32_16x16x32_bf16 v[116:119], v[220:223], a[220:223], v[116:119]
ds_read_b64_tr_b16 v[204:205], v4 offset:12288
v_add_f32 v12, v12, v89
v_mfma_f32_16x16x32_bf16 v[116:119], v[216:219], a[216:219], v[116:119]
ds_read_b64_tr_b16 v[206:207], v4 offset:18432
buffer_load_dwordx4 v7, s[8:11], s58 offen lds
v_mfma_f32_16x16x32_bf16 v[120:123], v[216:219], a[240:243], v[24:27]
v_exp_f32 v90, v90
v_mfma_f32_16x16x32_bf16 v[120:123], v[220:223], a[244:247], v[120:123]
ds_read_b64_tr_b16 v[208:209], v5
v_cvt_pk_bf16_f32 v178, v88, v89
v_mfma_f32_16x16x32_bf16 v[120:123], v[224:227], a[248:251], v[120:123]
ds_read_b64_tr_b16 v[210:211], v5 offset:6144
v_add_f32 v12, v12, v90
v_mfma_f32_16x16x32_bf16 v[120:123], v[228:231], a[252:255], v[120:123]
v_exp_f32 v91, v91
v_mfma_f32_16x16x32_bf16 v[120:123], v[232:235], v[32:35], v[120:123]
ds_read_b64_tr_b16 v[212:213], v5 offset:12288
v_add_f32 v12, v12, v91
v_mfma_f32_16x16x32_bf16 v[120:123], v[236:239], v[36:39], v[120:123]
ds_read_b64_tr_b16 v[214:215], v5 offset:18432
v_cvt_pk_bf16_f32 v179, v90, v91
v_mfma_f32_16x16x32_bf16 v[124:127], v[236:239], v[60:63], v[28:31]
v_exp_f32 v92, v92
v_mfma_f32_16x16x32_bf16 v[124:127], v[232:235], v[56:59], v[124:127]
v_exp_f32 v93, v93
v_mfma_f32_16x16x32_bf16 v[124:127], v[228:231], v[52:55], v[124:127]
v_add_f32 v13, v13, v92
v_add_f32 v13, v13, v93
v_mfma_f32_16x16x32_bf16 v[124:127], v[224:227], v[48:51], v[124:127]
v_exp_f32 v94, v94
v_mfma_f32_16x16x32_bf16 v[124:127], v[220:223], v[44:47], v[124:127]
v_cvt_pk_bf16_f32 v186, v92, v93
v_add_f32 v13, v13, v94
v_mfma_f32_16x16x32_bf16 v[124:127], v[216:219], v[40:43], v[124:127]
s_waitcnt lgkmcnt(8)
buffer_load_dwordx4 v8, s[8:11], s58 offen offset:1024 lds
v_lshlrev_b32 v243, 4, v255
v_mfma_f32_16x16x32_bf16 a[0:3], v[192:195], v[128:131], 0
ds_read_b64_tr_b16 v[216:217], v6
v_subrev_u32 v243, 3072, v243
v_mfma_f32_16x16x32_bf16 a[0:3], v[196:199], v[132:135], a[0:3]
v_exp_f32 v95, v95
v_mfma_f32_16x16x32_bf16 a[4:7], v[196:199], v[140:143], 0
ds_read_b64_tr_b16 v[218:219], v6 offset:6144
v_add_f32 v13, v13, v95
v_mfma_f32_16x16x32_bf16 a[4:7], v[192:195], v[136:139], a[4:7]
v_exp_f32 v96, v96
v_mfma_f32_16x16x32_bf16 a[8:11], v[192:195], v[144:147], 0
ds_read_b64_tr_b16 v[220:221], v6 offset:12288
v_cvt_pk_bf16_f32 v187, v94, v95
v_mfma_f32_16x16x32_bf16 a[8:11], v[196:199], v[148:151], a[8:11]
v_exp_f32 v97, v97
v_mfma_f32_16x16x32_bf16 a[12:15], v[196:199], v[156:159], 0
ds_read_b64_tr_b16 v[222:223], v6 offset:18432
v_add_f32 v10, v10, v96
v_mfma_f32_16x16x32_bf16 a[12:15], v[192:195], v[152:155], a[12:15]
s_waitcnt lgkmcnt(8)
v_add_f32 v10, v10, v97
v_cvt_pk_bf16_f32 v164, v96, v97
v_mfma_f32_16x16x32_bf16 a[16:19], v[200:203], v[128:131], 0
ds_read_b64_tr_b16 v[224:225], v3 offset:128
v_add_u32 v255, 256, v0
v_mfma_f32_16x16x32_bf16 a[16:19], v[204:207], v[132:135], a[16:19]
v_exp_f32 v98, v98
v_mfma_f32_16x16x32_bf16 a[20:23], v[204:207], v[140:143], 0
ds_read_b64_tr_b16 v[226:227], v3 offset:6272
v_add_u32 v1, 24576, v1
v_mfma_f32_16x16x32_bf16 a[20:23], v[200:203], v[136:139], a[20:23]
buffer_load_dwordx4 v9, s[8:11], s58 offen offset:2048 lds
v_add_f32 v10, v10, v98
v_mfma_f32_16x16x32_bf16 a[24:27], v[200:203], v[144:147], 0
ds_read_b64_tr_b16 v[228:229], v3 offset:12416
v_add_u32 v2, 24576, v2
v_mfma_f32_16x16x32_bf16 a[24:27], v[204:207], v[148:151], a[24:27]
v_exp_f32 v99, v99
v_mfma_f32_16x16x32_bf16 a[28:31], v[204:207], v[156:159], 0
ds_read_b64_tr_b16 v[230:231], v3 offset:18560
v_add_f32 v10, v10, v99
v_mfma_f32_16x16x32_bf16 a[28:31], v[200:203], v[152:155], a[28:31]
s_waitcnt lgkmcnt(8)
v_exp_f32 v100, v100
v_mfma_f32_16x16x32_bf16 a[32:35], v[208:211], v[128:131], 0
ds_read_b64_tr_b16 v[232:233], v4 offset:128
v_cvt_pk_bf16_f32 v165, v98, v99
v_mfma_f32_16x16x32_bf16 a[32:35], v[212:215], v[132:135], a[32:35]
v_exp_f32 v101, v101
v_mfma_f32_16x16x32_bf16 a[36:39], v[212:215], v[140:143], 0
ds_read_b64_tr_b16 v[234:235], v4 offset:6272
v_add_f32 v11, v11, v100
v_mfma_f32_16x16x32_bf16 a[36:39], v[208:211], v[136:139], a[36:39]
v_exp_f32 v102, v102
v_mfma_f32_16x16x32_bf16 a[40:43], v[208:211], v[144:147], 0
s_add_u32 m0, s68, 76800
ds_read_b64_tr_b16 v[236:237], v4 offset:12416
v_add_f32 v11, v11, v101
v_mfma_f32_16x16x32_bf16 a[40:43], v[212:215], v[148:151], a[40:43]
v_cvt_pk_bf16_f32 v172, v100, v101
v_add_f32 v11, v11, v102
v_mfma_f32_16x16x32_bf16 a[44:47], v[212:215], v[156:159], 0
ds_read_b64_tr_b16 v[238:239], v4 offset:18560
v_mul_u32_u24 v253, 3277, v255
v_mfma_f32_16x16x32_bf16 a[44:47], v[208:211], v[152:155], a[44:47]
s_waitcnt lgkmcnt(8)
buffer_load_dwordx4 v7, s[8:11], s59 offen lds
v_lshrrev_b32 v253, 16, v253
v_mfma_f32_16x16x32_bf16 a[48:51], v[216:219], v[128:131], 0
ds_read_b64_tr_b16 v[192:193], v5 offset:128
v_mul_u32_u24 v254, 20, v253
v_mfma_f32_16x16x32_bf16 a[48:51], v[220:223], v[132:135], a[48:51]
v_exp_f32 v103, v103
v_mfma_f32_16x16x32_bf16 a[52:55], v[220:223], v[140:143], 0
ds_read_b64_tr_b16 v[194:195], v5 offset:6272
v_add_f32 v11, v11, v103
v_mfma_f32_16x16x32_bf16 a[52:55], v[216:219], v[136:139], a[52:55]
v_exp_f32 v104, v104
v_mfma_f32_16x16x32_bf16 a[56:59], v[216:219], v[144:147], 0
ds_read_b64_tr_b16 v[196:197], v5 offset:12416
v_cvt_pk_bf16_f32 v173, v102, v103
v_mfma_f32_16x16x32_bf16 a[56:59], v[220:223], v[148:151], a[56:59]
v_exp_f32 v105, v105
v_mfma_f32_16x16x32_bf16 a[60:63], v[220:223], v[156:159], 0
ds_read_b64_tr_b16 v[198:199], v5 offset:18560
v_add_f32 v12, v12, v104
v_mfma_f32_16x16x32_bf16 a[60:63], v[216:219], v[152:155], a[60:63]
s_waitcnt lgkmcnt(8)
v_exp_f32 v106, v106
v_mfma_f32_16x16x32_bf16 a[64:67], v[224:227], v[128:131], 0
ds_read_b64_tr_b16 v[200:201], v6 offset:128
v_add_f32 v12, v12, v105
v_mfma_f32_16x16x32_bf16 a[64:67], v[228:231], v[132:135], a[64:67]
v_exp_f32 v107, v107
v_mfma_f32_16x16x32_bf16 a[68:71], v[228:231], v[140:143], 0
ds_read_b64_tr_b16 v[202:203], v6 offset:6272
v_cvt_pk_bf16_f32 v180, v104, v105
v_mfma_f32_16x16x32_bf16 a[68:71], v[224:227], v[136:139], a[68:71]
buffer_load_dwordx4 v8, s[8:11], s59 offen offset:1024 lds
v_add_f32 v12, v12, v106
v_mfma_f32_16x16x32_bf16 a[72:75], v[224:227], v[144:147], 0
ds_read_b64_tr_b16 v[204:205], v6 offset:12416
v_add_f32 v12, v12, v107
v_mfma_f32_16x16x32_bf16 a[72:75], v[228:231], v[148:151], a[72:75]
v_exp_f32 v108, v108
v_mfma_f32_16x16x32_bf16 a[76:79], v[228:231], v[156:159], 0
ds_read_b64_tr_b16 v[206:207], v6 offset:18560
v_cvt_pk_bf16_f32 v181, v106, v107
v_mfma_f32_16x16x32_bf16 a[76:79], v[224:227], v[152:155], a[76:79]
s_waitcnt lgkmcnt(8)
v_exp_f32 v109, v109
v_mfma_f32_16x16x32_bf16 a[80:83], v[232:235], v[128:131], 0
ds_read_b64_tr_b16 v[208:209], v3 offset:256
v_add_f32 v13, v13, v108
v_mfma_f32_16x16x32_bf16 a[80:83], v[236:239], v[132:135], a[80:83]
v_exp_f32 v110, v110
v_mfma_f32_16x16x32_bf16 a[84:87], v[236:239], v[140:143], 0
ds_read_b64_tr_b16 v[210:211], v3 offset:6400
v_add_f32 v13, v13, v109
v_mfma_f32_16x16x32_bf16 a[84:87], v[232:235], v[136:139], a[84:87]
v_cvt_pk_bf16_f32 v188, v108, v109
v_add_f32 v13, v13, v110
v_mfma_f32_16x16x32_bf16 a[88:91], v[232:235], v[144:147], 0
ds_read_b64_tr_b16 v[212:213], v3 offset:12544
v_sub_u32 v254, v255, v254
v_mfma_f32_16x16x32_bf16 a[88:91], v[236:239], v[148:151], a[88:91]
v_exp_f32 v111, v111
v_mfma_f32_16x16x32_bf16 a[92:95], v[236:239], v[156:159], 0
ds_read_b64_tr_b16 v[214:215], v3 offset:18688
v_add_f32 v13, v13, v111
v_mfma_f32_16x16x32_bf16 a[92:95], v[232:235], v[152:155], a[92:95]
s_waitcnt lgkmcnt(8)
buffer_load_dwordx4 v9, s[8:11], s59 offen offset:2048 lds
v_cvt_pk_bf16_f32 v189, v110, v111
v_mfma_f32_16x16x32_bf16 a[96:99], v[192:195], v[128:131], 0
ds_read_b64_tr_b16 v[216:217], v4 offset:256
v_lshrrev_b32 v255, 1, v253
v_mfma_f32_16x16x32_bf16 a[96:99], v[196:199], v[132:135], a[96:99]
v_exp_f32 v112, v112
v_mfma_f32_16x16x32_bf16 a[100:103], v[196:199], v[140:143], 0
ds_read_b64_tr_b16 v[218:219], v4 offset:6400
v_add_f32 v10, v10, v112
v_mfma_f32_16x16x32_bf16 a[100:103], v[192:195], v[136:139], a[100:103]
v_exp_f32 v113, v113
v_mfma_f32_16x16x32_bf16 a[104:107], v[192:195], v[144:147], 0
ds_read_b64_tr_b16 v[220:221], v4 offset:12544
v_add_f32 v10, v10, v113
v_mfma_f32_16x16x32_bf16 a[104:107], v[196:199], v[148:151], a[104:107]
v_exp_f32 v114, v114
v_mfma_f32_16x16x32_bf16 a[108:111], v[196:199], v[156:159], 0
ds_read_b64_tr_b16 v[222:223], v4 offset:18688
v_cvt_pk_bf16_f32 v166, v112, v113
v_mfma_f32_16x16x32_bf16 a[108:111], v[192:195], v[152:155], a[108:111]
s_waitcnt lgkmcnt(8)
v_exp_f32 v115, v115
v_mfma_f32_16x16x32_bf16 a[112:115], v[200:203], v[128:131], 0
s_add_u32 s56, s56, 24576
ds_read_b64_tr_b16 v[224:225], v5 offset:256
v_add_f32 v10, v10, v114
v_mfma_f32_16x16x32_bf16 a[112:115], v[204:207], v[132:135], a[112:115]
v_exp_f32 v116, v116
v_mfma_f32_16x16x32_bf16 a[116:119], v[204:207], v[140:143], 0
ds_read_b64_tr_b16 v[226:227], v5 offset:6400
v_add_f32 v10, v10, v115
v_mfma_f32_16x16x32_bf16 a[116:119], v[200:203], v[136:139], a[116:119]
v_cvt_pk_bf16_f32 v167, v114, v115
v_add_f32 v11, v11, v116
v_mfma_f32_16x16x32_bf16 a[120:123], v[200:203], v[144:147], 0
ds_read_b64_tr_b16 v[228:229], v5 offset:12544
v_and_b32 v255, 2, v255
v_mfma_f32_16x16x32_bf16 a[120:123], v[204:207], v[148:151], a[120:123]
v_exp_f32 v117, v117
v_mfma_f32_16x16x32_bf16 a[124:127], v[204:207], v[156:159], 0
ds_read_b64_tr_b16 v[230:231], v5 offset:18688
v_add_f32 v11, v11, v117
v_mfma_f32_16x16x32_bf16 a[124:127], v[200:203], v[152:155], a[124:127]
s_waitcnt lgkmcnt(8)
v_exp_f32 v118, v118
v_mfma_f32_16x16x32_bf16 a[128:131], v[208:211], v[128:131], 0
ds_read_b64_tr_b16 v[232:233], v6 offset:256
v_cvt_pk_bf16_f32 v174, v116, v117
v_mfma_f32_16x16x32_bf16 a[128:131], v[212:215], v[132:135], a[128:131]
v_add_f32 v11, v11, v118
v_xor_b32 v254, v254, v255
v_mfma_f32_16x16x32_bf16 a[132:135], v[212:215], v[140:143], 0
ds_read_b64_tr_b16 v[234:235], v6 offset:6400
v_mul_u32_u24 v255, 80, v253
v_mfma_f32_16x16x32_bf16 a[132:135], v[208:211], v[136:139], a[132:135]
v_exp_f32 v119, v119
v_mfma_f32_16x16x32_bf16 a[136:139], v[208:211], v[144:147], 0
ds_read_b64_tr_b16 v[236:237], v6 offset:12544
v_add_f32 v11, v11, v119
v_mfma_f32_16x16x32_bf16 a[136:139], v[212:215], v[148:151], a[136:139]
v_exp_f32 v120, v120
v_mfma_f32_16x16x32_bf16 a[140:143], v[212:215], v[156:159], 0
ds_read_b64_tr_b16 v[238:239], v6 offset:18688
v_cvt_pk_bf16_f32 v175, v118, v119
v_mfma_f32_16x16x32_bf16 a[140:143], v[208:211], v[152:155], a[140:143]
s_waitcnt lgkmcnt(8)
v_exp_f32 v121, v121
v_mfma_f32_16x16x32_bf16 a[144:147], v[216:219], v[128:131], 0
v_add_f32 v12, v12, v120
v_add_f32 v12, v12, v121
v_mfma_f32_16x16x32_bf16 a[144:147], v[220:223], v[132:135], a[144:147]
v_cvt_pk_bf16_f32 v182, v120, v121
v_add_u32 v255, v255, v254
v_mfma_f32_16x16x32_bf16 a[148:151], v[220:223], v[140:143], 0
v_exp_f32 v122, v122
v_mfma_f32_16x16x32_bf16 a[148:151], v[216:219], v[136:139], a[148:151]
v_add_f32 v12, v12, v122
v_lshlrev_b32 v244, 4, v255
v_mfma_f32_16x16x32_bf16 a[152:155], v[216:219], v[144:147], 0
v_and_b32 v253, 31, v0
v_lshlrev_b32 v253, 3, v253
v_mfma_f32_16x16x32_bf16 a[152:155], v[220:223], v[148:151], a[152:155]
v_exp_f32 v123, v123
v_mfma_f32_16x16x32_bf16 a[156:159], v[220:223], v[156:159], 0
v_add_f32 v12, v12, v123
v_cvt_pk_bf16_f32 v183, v122, v123
v_mfma_f32_16x16x32_bf16 a[156:159], v[216:219], v[152:155], a[156:159]
s_waitcnt lgkmcnt(4)
v_exp_f32 v124, v124
v_mfma_f32_16x16x32_bf16 a[160:163], v[224:227], v[128:131], 0
s_waitcnt vmcnt(12) lgkmcnt(0)
s_barrier
v_add_f32 v13, v13, v124
v_mfma_f32_16x16x32_bf16 a[160:163], v[228:231], v[132:135], a[160:163]
ds_read_b128 v[192:195], v1
buffer_store_dwordx2 v[14:15], v252, s[20:23], s74 offen sc1
v_mfma_f32_16x16x32_bf16 a[164:167], v[228:231], v[140:143], 0
v_add_u32 v3, 24576, v3
v_mfma_f32_16x16x32_bf16 a[164:167], v[224:227], v[136:139], a[164:167]
ds_read_b128 v[196:199], v2
v_mfma_f32_16x16x32_bf16 a[168:171], v[224:227], v[144:147], 0
v_add_u32 v4, 24576, v4
v_mfma_f32_16x16x32_bf16 a[168:171], v[228:231], v[148:151], a[168:171]
ds_read_b128 v[200:203], v1 offset:128
v_mfma_f32_16x16x32_bf16 a[172:175], v[228:231], v[156:159], 0
v_add_u32 v5, 24576, v5
v_mfma_f32_16x16x32_bf16 a[172:175], v[224:227], v[152:155], a[172:175]
s_waitcnt lgkmcnt(3)
ds_read_b128 v[204:207], v2 offset:128
v_mfma_f32_16x16x32_bf16 a[176:179], v[232:235], v[128:131], 0
v_add_u32 v6, 24576, v6
v_mfma_f32_16x16x32_bf16 a[176:179], v[236:239], v[132:135], a[176:179]
ds_read_b128 v[208:211], v1 offset:256
v_mfma_f32_16x16x32_bf16 a[180:183], v[236:239], v[140:143], 0
v_exp_f32 v125, v125
v_mfma_f32_16x16x32_bf16 a[180:183], v[232:235], v[136:139], a[180:183]
ds_read_b128 v[212:215], v2 offset:256
v_add_f32 v13, v13, v125
v_mfma_f32_16x16x32_bf16 a[184:187], v[232:235], v[144:147], 0
v_exp_f32 v126, v126
v_mfma_f32_16x16x32_bf16 a[184:187], v[236:239], v[148:151], a[184:187]
v_exp_f32 v127, v127
v_mfma_f32_16x16x32_bf16 a[188:191], v[236:239], v[156:159], 0
v_cvt_pk_bf16_f32 v190, v124, v125
v_add_f32 v13, v13, v126
v_mfma_f32_16x16x32_bf16 a[188:191], v[232:235], v[152:155], a[188:191]
s_waitcnt lgkmcnt(4)
v_add_f32 v13, v13, v127
v_cvt_pk_bf16_f32 v191, v126, v127
.p2align 6
L_loop:
v_mfma_f32_16x16x32_bf16 v[64:67], v[192:195], a[192:195], v[16:19]
v_mfma_f32_16x16x32_bf16 v[64:67], v[196:199], a[196:199], v[64:67]
s_waitcnt lgkmcnt(2)
ds_read_b128 v[216:219], v1 offset:6144
v_mfma_f32_16x16x32_bf16 v[64:67], v[200:203], a[200:203], v[64:67]
s_add_u32 s57, s56, 3072
v_mfma_f32_16x16x32_bf16 v[64:67], v[204:207], a[204:207], v[64:67]
s_waitcnt lgkmcnt(1)
v_mfma_f32_16x16x32_bf16 v[64:67], v[208:211], a[208:211], v[64:67]
s_sub_u32 s58, s56, 24576
ds_read_b128 v[220:223], v2 offset:6144
v_mfma_f32_16x16x32_bf16 v[64:67], v[212:215], a[212:215], v[64:67]
s_sub_u32 s59, s56, 21504
v_mfma_f32_16x16x32_bf16 v[68:71], v[212:215], a[236:239], v[20:23]
v_mfma_f32_16x16x32_bf16 v[68:71], v[208:211], a[232:235], v[68:71]
ds_read_b128 v[224:227], v1 offset:6272
v_mfma_f32_16x16x32_bf16 v[68:71], v[204:207], a[228:231], v[68:71]
s_add_u32 m0, s68, 24576
v_mfma_f32_16x16x32_bf16 v[68:71], v[200:203], a[224:227], v[68:71]
v_mfma_f32_16x16x32_bf16 v[68:71], v[196:199], a[220:223], v[68:71]
ds_read_b128 v[228:231], v2 offset:6272
v_mfma_f32_16x16x32_bf16 v[68:71], v[192:195], a[216:219], v[68:71]
buffer_load_dwordx4 v7, s[4:7], s56 offen lds
v_mfma_f32_16x16x32_bf16 v[72:75], v[192:195], a[240:243], v[24:27]
v_exp_f32 v64, v64
v_mfma_f32_16x16x32_bf16 v[72:75], v[196:199], a[244:247], v[72:75]
ds_read_b128 v[232:235], v1 offset:6400
v_add_f32 v10, v10, v64
v_mfma_f32_16x16x32_bf16 v[72:75], v[200:203], a[248:251], v[72:75]
v_exp_f32 v65, v65
v_mfma_f32_16x16x32_bf16 v[72:75], v[204:207], a[252:255], v[72:75]
v_add_f32 v10, v10, v65
v_cvt_pk_bf16_f32 v128, v64, v65
v_mfma_f32_16x16x32_bf16 v[72:75], v[208:211], v[32:35], v[72:75]
ds_read_b128 v[236:239], v2 offset:6400
v_mfma_f32_16x16x32_bf16 v[72:75], v[212:215], v[36:39], v[72:75]
v_exp_f32 v66, v66
v_mfma_f32_16x16x32_bf16 v[76:79], v[212:215], v[60:63], v[28:31]
v_add_f32 v10, v10, v66
v_mfma_f32_16x16x32_bf16 v[76:79], v[208:211], v[56:59], v[76:79]
v_exp_f32 v67, v67
v_mfma_f32_16x16x32_bf16 v[76:79], v[204:207], v[52:55], v[76:79]
v_add_f32 v10, v10, v67
v_cvt_pk_bf16_f32 v129, v66, v67
v_mfma_f32_16x16x32_bf16 v[76:79], v[200:203], v[48:51], v[76:79]
v_exp_f32 v68, v68
v_mfma_f32_16x16x32_bf16 v[76:79], v[196:199], v[44:47], v[76:79]
v_add_f32 v11, v11, v68
v_mfma_f32_16x16x32_bf16 v[76:79], v[192:195], v[40:43], v[76:79]
s_waitcnt lgkmcnt(0)
buffer_load_dwordx4 v8, s[4:7], s56 offen offset:1024 lds
v_mfma_f32_16x16x32_bf16 v[80:83], v[216:219], a[192:195], v[16:19]
v_exp_f32 v69, v69
v_mfma_f32_16x16x32_bf16 v[80:83], v[220:223], a[196:199], v[80:83]
ds_read_b128 v[192:195], v1 offset:12288
v_add_f32 v11, v11, v69
v_mfma_f32_16x16x32_bf16 v[80:83], v[224:227], a[200:203], v[80:83]
v_cvt_pk_bf16_f32 v136, v68, v69
v_mfma_f32_16x16x32_bf16 v[80:83], v[228:231], a[204:207], v[80:83]
v_exp_f32 v70, v70
v_mfma_f32_16x16x32_bf16 v[80:83], v[232:235], a[208:211], v[80:83]
ds_read_b128 v[196:199], v2 offset:12288
v_add_f32 v11, v11, v70
v_mfma_f32_16x16x32_bf16 v[80:83], v[236:239], a[212:215], v[80:83]
v_mfma_f32_16x16x32_bf16 v[84:87], v[236:239], a[236:239], v[20:23]
v_exp_f32 v71, v71
v_mfma_f32_16x16x32_bf16 v[84:87], v[232:235], a[232:235], v[84:87]
ds_read_b128 v[200:203], v1 offset:12416
v_add_f32 v11, v11, v71
v_mfma_f32_16x16x32_bf16 v[84:87], v[228:231], a[228:231], v[84:87]
v_exp_f32 v72, v72
v_mfma_f32_16x16x32_bf16 v[84:87], v[224:227], a[224:227], v[84:87]
v_cvt_pk_bf16_f32 v137, v70, v71
v_add_f32 v12, v12, v72
v_mfma_f32_16x16x32_bf16 v[84:87], v[220:223], a[220:223], v[84:87]
ds_read_b128 v[204:207], v2 offset:12416
v_mfma_f32_16x16x32_bf16 v[84:87], v[216:219], a[216:219], v[84:87]
buffer_load_dwordx4 v9, s[4:7], s56 offen offset:2048 lds
v_mfma_f32_16x16x32_bf16 v[88:91], v[216:219], a[240:243], v[24:27]
v_exp_f32 v73, v73
v_mfma_f32_16x16x32_bf16 v[88:91], v[220:223], a[244:247], v[88:91]
ds_read_b128 v[208:211], v1 offset:12544
v_add_f32 v12, v12, v73
v_mfma_f32_16x16x32_bf16 v[88:91], v[224:227], a[248:251], v[88:91]
v_exp_f32 v74, v74
v_mfma_f32_16x16x32_bf16 v[88:91], v[228:231], a[252:255], v[88:91]
v_cvt_pk_bf16_f32 v144, v72, v73
v_add_f32 v12, v12, v74
v_mfma_f32_16x16x32_bf16 v[88:91], v[232:235], v[32:35], v[88:91]
ds_read_b128 v[212:215], v2 offset:12544
v_mfma_f32_16x16x32_bf16 v[88:91], v[236:239], v[36:39], v[88:91]
v_exp_f32 v75, v75
v_mfma_f32_16x16x32_bf16 v[92:95], v[236:239], v[60:63], v[28:31]
v_add_f32 v12, v12, v75
v_cvt_pk_bf16_f32 v145, v74, v75
v_mfma_f32_16x16x32_bf16 v[92:95], v[232:235], v[56:59], v[92:95]
v_exp_f32 v76, v76
v_mfma_f32_16x16x32_bf16 v[92:95], v[228:231], v[52:55], v[92:95]
s_add_u32 m0, s68, 27648
v_add_f32 v13, v13, v76
v_mfma_f32_16x16x32_bf16 v[92:95], v[224:227], v[48:51], v[92:95]
v_mfma_f32_16x16x32_bf16 v[92:95], v[220:223], v[44:47], v[92:95]
v_exp_f32 v77, v77
v_mfma_f32_16x16x32_bf16 v[92:95], v[216:219], v[40:43], v[92:95]
s_waitcnt lgkmcnt(0)
buffer_load_dwordx4 v7, s[4:7], s57 offen lds
v_add_f32 v13, v13, v77
v_mfma_f32_16x16x32_bf16 v[96:99], v[192:195], a[192:195], v[16:19]
v_cvt_pk_bf16_f32 v152, v76, v77
v_mfma_f32_16x16x32_bf16 v[96:99], v[196:199], a[196:199], v[96:99]
ds_read_b128 v[216:219], v1 offset:18432
v_mfma_f32_16x16x32_bf16 v[96:99], v[200:203], a[200:203], v[96:99]
v_exp_f32 v78, v78
v_mfma_f32_16x16x32_bf16 v[96:99], v[204:207], a[204:207], v[96:99]
v_add_f32 v13, v13, v78
v_mfma_f32_16x16x32_bf16 v[96:99], v[208:211], a[208:211], v[96:99]
ds_read_b128 v[220:223], v2 offset:18432
v_mfma_f32_16x16x32_bf16 v[96:99], v[212:215], a[212:215], v[96:99]
v_exp_f32 v79, v79
v_mfma_f32_16x16x32_bf16 v[100:103], v[212:215], a[236:239], v[20:23]
v_exp_f32 v80, v80
v_mfma_f32_16x16x32_bf16 v[100:103], v[208:211], a[232:235], v[100:103]
ds_read_b128 v[224:227], v1 offset:18560
v_add_f32 v13, v13, v79
v_mfma_f32_16x16x32_bf16 v[100:103], v[204:207], a[228:231], v[100:103]
v_cvt_pk_bf16_f32 v153, v78, v79
v_add_f32 v10, v10, v80
v_mfma_f32_16x16x32_bf16 v[100:103], v[200:203], a[224:227], v[100:103]
v_exp_f32 v81, v81
v_mfma_f32_16x16x32_bf16 v[100:103], v[196:199], a[220:223], v[100:103]
ds_read_b128 v[228:231], v2 offset:18560
v_add_f32 v10, v10, v81
v_mfma_f32_16x16x32_bf16 v[100:103], v[192:195], a[216:219], v[100:103]
buffer_load_dwordx4 v8, s[4:7], s57 offen offset:1024 lds
v_cvt_pk_bf16_f32 v130, v80, v81
v_mfma_f32_16x16x32_bf16 v[104:107], v[192:195], a[240:243], v[24:27]
v_exp_f32 v82, v82
v_mfma_f32_16x16x32_bf16 v[104:107], v[196:199], a[244:247], v[104:107]
ds_read_b128 v[232:235], v1 offset:18688
v_add_f32 v10, v10, v82
v_mfma_f32_16x16x32_bf16 v[104:107], v[200:203], a[248:251], v[104:107]
v_mfma_f32_16x16x32_bf16 v[104:107], v[204:207], a[252:255], v[104:107]
v_exp_f32 v83, v83
v_mfma_f32_16x16x32_bf16 v[104:107], v[208:211], v[32:35], v[104:107]
ds_read_b128 v[236:239], v2 offset:18688
v_add_f32 v10, v10, v83
v_mfma_f32_16x16x32_bf16 v[104:107], v[212:215], v[36:39], v[104:107]
v_exp_f32 v84, v84
v_mfma_f32_16x16x32_bf16 v[108:111], v[212:215], v[60:63], v[28:31]
v_cvt_pk_bf16_f32 v131, v82, v83
v_add_f32 v11, v11, v84
v_mfma_f32_16x16x32_bf16 v[108:111], v[208:211], v[56:59], v[108:111]
v_mfma_f32_16x16x32_bf16 v[108:111], v[204:207], v[52:55], v[108:111]
v_exp_f32 v85, v85
v_mfma_f32_16x16x32_bf16 v[108:111], v[200:203], v[48:51], v[108:111]
v_add_f32 v11, v11, v85
v_cvt_pk_bf16_f32 v138, v84, v85
v_mfma_f32_16x16x32_bf16 v[108:111], v[196:199], v[44:47], v[108:111]
v_mfma_f32_16x16x32_bf16 v[108:111], v[192:195], v[40:43], v[108:111]
s_waitcnt lgkmcnt(0)
buffer_load_dwordx4 v9, s[4:7], s57 offen offset:2048 lds
v_mfma_f32_16x16x32_bf16 v[112:115], v[216:219], a[192:195], v[16:19]
v_exp_f32 v86, v86
v_mfma_f32_16x16x32_bf16 v[112:115], v[220:223], a[196:199], v[112:115]
ds_read_b64_tr_b16 v[192:193], v3
v_add_f32 v11, v11, v86
v_mfma_f32_16x16x32_bf16 v[112:115], v[224:227], a[200:203], v[112:115]
ds_read_b64_tr_b16 v[194:195], v3 offset:6144
v_mfma_f32_16x16x32_bf16 v[112:115], v[228:231], a[204:207], v[112:115]
v_exp_f32 v87, v87
v_mfma_f32_16x16x32_bf16 v[112:115], v[232:235], a[208:211], v[112:115]
ds_read_b64_tr_b16 v[196:197], v3 offset:12288
v_add_f32 v11, v11, v87
v_mfma_f32_16x16x32_bf16 v[112:115], v[236:239], a[212:215], v[112:115]
ds_read_b64_tr_b16 v[198:199], v3 offset:18432
v_cvt_pk_bf16_f32 v139, v86, v87
v_mfma_f32_16x16x32_bf16 v[116:119], v[236:239], a[236:239], v[20:23]
v_exp_f32 v88, v88
v_mfma_f32_16x16x32_bf16 v[116:119], v[232:235], a[232:235], v[116:119]
ds_read_b64_tr_b16 v[200:201], v4
v_add_f32 v12, v12, v88
v_mfma_f32_16x16x32_bf16 v[116:119], v[228:231], a[228:231], v[116:119]
s_add_u32 m0, s68, 98304
ds_read_b64_tr_b16 v[202:203], v4 offset:6144
v_mfma_f32_16x16x32_bf16 v[116:119], v[224:227], a[224:227], v[116:119]
v_exp_f32 v89, v89
v_mfma_f32_16x16x32_bf16 v[116:119], v[220:223], a[220:223], v[116:119]
ds_read_b64_tr_b16 v[204:205], v4 offset:12288
v_add_f32 v12, v12, v89
v_mfma_f32_16x16x32_bf16 v[116:119], v[216:219], a[216:219], v[116:119]
ds_read_b64_tr_b16 v[206:207], v4 offset:18432
buffer_load_dwordx4 v7, s[8:11], s58 offen lds
v_mfma_f32_16x16x32_bf16 v[120:123], v[216:219], a[240:243], v[24:27]
v_exp_f32 v90, v90
v_mfma_f32_16x16x32_bf16 v[120:123], v[220:223], a[244:247], v[120:123]
ds_read_b64_tr_b16 v[208:209], v5
v_cvt_pk_bf16_f32 v146, v88, v89
v_mfma_f32_16x16x32_bf16 v[120:123], v[224:227], a[248:251], v[120:123]
ds_read_b64_tr_b16 v[210:211], v5 offset:6144
v_add_f32 v12, v12, v90
v_mfma_f32_16x16x32_bf16 v[120:123], v[228:231], a[252:255], v[120:123]
v_exp_f32 v91, v91
v_mfma_f32_16x16x32_bf16 v[120:123], v[232:235], v[32:35], v[120:123]
ds_read_b64_tr_b16 v[212:213], v5 offset:12288
v_add_f32 v12, v12, v91
v_mfma_f32_16x16x32_bf16 v[120:123], v[236:239], v[36:39], v[120:123]
ds_read_b64_tr_b16 v[214:215], v5 offset:18432
v_cvt_pk_bf16_f32 v147, v90, v91
v_mfma_f32_16x16x32_bf16 v[124:127], v[236:239], v[60:63], v[28:31]
v_exp_f32 v92, v92
v_mfma_f32_16x16x32_bf16 v[124:127], v[232:235], v[56:59], v[124:127]
v_exp_f32 v93, v93
v_mfma_f32_16x16x32_bf16 v[124:127], v[228:231], v[52:55], v[124:127]
v_add_f32 v13, v13, v92
v_add_f32 v13, v13, v93
v_mfma_f32_16x16x32_bf16 v[124:127], v[224:227], v[48:51], v[124:127]
v_exp_f32 v94, v94
v_mfma_f32_16x16x32_bf16 v[124:127], v[220:223], v[44:47], v[124:127]
v_cvt_pk_bf16_f32 v154, v92, v93
v_add_f32 v13, v13, v94
v_mfma_f32_16x16x32_bf16 v[124:127], v[216:219], v[40:43], v[124:127]
s_waitcnt lgkmcnt(8)
buffer_load_dwordx4 v8, s[8:11], s58 offen offset:1024 lds
v_mfma_f32_16x16x32_bf16 a[0:3], v[192:195], v[160:163], a[0:3]
ds_read_b64_tr_b16 v[216:217], v6
v_mfma_f32_16x16x32_bf16 a[0:3], v[196:199], v[164:167], a[0:3]
v_exp_f32 v95, v95
v_mfma_f32_16x16x32_bf16 a[4:7], v[196:199], v[172:175], a[4:7]
ds_read_b64_tr_b16 v[218:219], v6 offset:6144
v_add_f32 v13, v13, v95
v_mfma_f32_16x16x32_bf16 a[4:7], v[192:195], v[168:171], a[4:7]
v_exp_f32 v96, v96
v_mfma_f32_16x16x32_bf16 a[8:11], v[192:195], v[176:179], a[8:11]
ds_read_b64_tr_b16 v[220:221], v6 offset:12288
v_cvt_pk_bf16_f32 v155, v94, v95
v_mfma_f32_16x16x32_bf16 a[8:11], v[196:199], v[180:183], a[8:11]
v_exp_f32 v97, v97
v_mfma_f32_16x16x32_bf16 a[12:15], v[196:199], v[188:191], a[12:15]
ds_read_b64_tr_b16 v[222:223], v6 offset:18432
v_add_f32 v10, v10, v96
v_mfma_f32_16x16x32_bf16 a[12:15], v[192:195], v[184:187], a[12:15]
s_waitcnt lgkmcnt(8)
v_add_f32 v10, v10, v97
v_cvt_pk_bf16_f32 v132, v96, v97
v_mfma_f32_16x16x32_bf16 a[16:19], v[200:203], v[160:163], a[16:19]
ds_read_b64_tr_b16 v[224:225], v3 offset:128
v_mfma_f32_16x16x32_bf16 a[16:19], v[204:207], v[164:167], a[16:19]
v_exp_f32 v98, v98
v_mfma_f32_16x16x32_bf16 a[20:23], v[204:207], v[172:175], a[20:23]
ds_read_b64_tr_b16 v[226:227], v3 offset:6272
v_add_u32 v1, 4294918144, v1
v_mfma_f32_16x16x32_bf16 a[20:23], v[200:203], v[168:171], a[20:23]
buffer_load_dwordx4 v9, s[8:11], s58 offen offset:2048 lds
v_add_f32 v10, v10, v98
v_mfma_f32_16x16x32_bf16 a[24:27], v[200:203], v[176:179], a[24:27]
ds_read_b64_tr_b16 v[228:229], v3 offset:12416
v_add_u32 v2, 4294918144, v2
v_mfma_f32_16x16x32_bf16 a[24:27], v[204:207], v[180:183], a[24:27]
v_exp_f32 v99, v99
v_mfma_f32_16x16x32_bf16 a[28:31], v[204:207], v[188:191], a[28:31]
ds_read_b64_tr_b16 v[230:231], v3 offset:18560
v_add_f32 v10, v10, v99
v_mfma_f32_16x16x32_bf16 a[28:31], v[200:203], v[184:187], a[28:31]
s_waitcnt lgkmcnt(8)
v_exp_f32 v100, v100
v_mfma_f32_16x16x32_bf16 a[32:35], v[208:211], v[160:163], a[32:35]
ds_read_b64_tr_b16 v[232:233], v4 offset:128
v_cvt_pk_bf16_f32 v133, v98, v99
v_mfma_f32_16x16x32_bf16 a[32:35], v[212:215], v[164:167], a[32:35]
v_exp_f32 v101, v101
v_mfma_f32_16x16x32_bf16 a[36:39], v[212:215], v[172:175], a[36:39]
ds_read_b64_tr_b16 v[234:235], v4 offset:6272
v_add_f32 v11, v11, v100
v_mfma_f32_16x16x32_bf16 a[36:39], v[208:211], v[168:171], a[36:39]
v_exp_f32 v102, v102
v_mfma_f32_16x16x32_bf16 a[40:43], v[208:211], v[176:179], a[40:43]
s_add_u32 m0, s68, 101376
ds_read_b64_tr_b16 v[236:237], v4 offset:12416
v_add_f32 v11, v11, v101
v_mfma_f32_16x16x32_bf16 a[40:43], v[212:215], v[180:183], a[40:43]
v_cvt_pk_bf16_f32 v140, v100, v101
v_add_f32 v11, v11, v102
v_mfma_f32_16x16x32_bf16 a[44:47], v[212:215], v[188:191], a[44:47]
ds_read_b64_tr_b16 v[238:239], v4 offset:18560
v_mfma_f32_16x16x32_bf16 a[44:47], v[208:211], v[184:187], a[44:47]
s_waitcnt lgkmcnt(8)
buffer_load_dwordx4 v7, s[8:11], s59 offen lds
v_mfma_f32_16x16x32_bf16 a[48:51], v[216:219], v[160:163], a[48:51]
ds_read_b64_tr_b16 v[192:193], v5 offset:128
v_mfma_f32_16x16x32_bf16 a[48:51], v[220:223], v[164:167], a[48:51]
v_exp_f32 v103, v103
v_mfma_f32_16x16x32_bf16 a[52:55], v[220:223], v[172:175], a[52:55]
ds_read_b64_tr_b16 v[194:195], v5 offset:6272
v_add_f32 v11, v11, v103
v_mfma_f32_16x16x32_bf16 a[52:55], v[216:219], v[168:171], a[52:55]
v_exp_f32 v104, v104
v_mfma_f32_16x16x32_bf16 a[56:59], v[216:219], v[176:179], a[56:59]
ds_read_b64_tr_b16 v[196:197], v5 offset:12416
v_cvt_pk_bf16_f32 v141, v102, v103
v_mfma_f32_16x16x32_bf16 a[56:59], v[220:223], v[180:183], a[56:59]
v_exp_f32 v105, v105
v_mfma_f32_16x16x32_bf16 a[60:63], v[220:223], v[188:191], a[60:63]
ds_read_b64_tr_b16 v[198:199], v5 offset:18560
v_add_f32 v12, v12, v104
v_mfma_f32_16x16x32_bf16 a[60:63], v[216:219], v[184:187], a[60:63]
s_waitcnt lgkmcnt(8)
v_exp_f32 v106, v106
v_mfma_f32_16x16x32_bf16 a[64:67], v[224:227], v[160:163], a[64:67]
ds_read_b64_tr_b16 v[200:201], v6 offset:128
v_add_f32 v12, v12, v105
v_mfma_f32_16x16x32_bf16 a[64:67], v[228:231], v[164:167], a[64:67]
v_exp_f32 v107, v107
v_mfma_f32_16x16x32_bf16 a[68:71], v[228:231], v[172:175], a[68:71]
ds_read_b64_tr_b16 v[202:203], v6 offset:6272
v_cvt_pk_bf16_f32 v148, v104, v105
v_mfma_f32_16x16x32_bf16 a[68:71], v[224:227], v[168:171], a[68:71]
buffer_load_dwordx4 v8, s[8:11], s59 offen offset:1024 lds
v_add_f32 v12, v12, v106
v_mfma_f32_16x16x32_bf16 a[72:75], v[224:227], v[176:179], a[72:75]
ds_read_b64_tr_b16 v[204:205], v6 offset:12416
v_add_f32 v12, v12, v107
v_mfma_f32_16x16x32_bf16 a[72:75], v[228:231], v[180:183], a[72:75]
v_exp_f32 v108, v108
v_mfma_f32_16x16x32_bf16 a[76:79], v[228:231], v[188:191], a[76:79]
ds_read_b64_tr_b16 v[206:207], v6 offset:18560
v_cvt_pk_bf16_f32 v149, v106, v107
v_mfma_f32_16x16x32_bf16 a[76:79], v[224:227], v[184:187], a[76:79]
s_waitcnt lgkmcnt(8)
v_exp_f32 v109, v109
v_mfma_f32_16x16x32_bf16 a[80:83], v[232:235], v[160:163], a[80:83]
ds_read_b64_tr_b16 v[208:209], v3 offset:256
v_add_f32 v13, v13, v108
v_mfma_f32_16x16x32_bf16 a[80:83], v[236:239], v[164:167], a[80:83]
v_exp_f32 v110, v110
v_mfma_f32_16x16x32_bf16 a[84:87], v[236:239], v[172:175], a[84:87]
ds_read_b64_tr_b16 v[210:211], v3 offset:6400
v_add_f32 v13, v13, v109
v_mfma_f32_16x16x32_bf16 a[84:87], v[232:235], v[168:171], a[84:87]
v_cvt_pk_bf16_f32 v156, v108, v109
v_add_f32 v13, v13, v110
v_mfma_f32_16x16x32_bf16 a[88:91], v[232:235], v[176:179], a[88:91]
ds_read_b64_tr_b16 v[212:213], v3 offset:12544
v_mfma_f32_16x16x32_bf16 a[88:91], v[236:239], v[180:183], a[88:91]
v_exp_f32 v111, v111
v_mfma_f32_16x16x32_bf16 a[92:95], v[236:239], v[188:191], a[92:95]
ds_read_b64_tr_b16 v[214:215], v3 offset:18688
v_add_f32 v13, v13, v111
v_mfma_f32_16x16x32_bf16 a[92:95], v[232:235], v[184:187], a[92:95]
s_waitcnt lgkmcnt(8)
buffer_load_dwordx4 v9, s[8:11], s59 offen offset:2048 lds
v_cvt_pk_bf16_f32 v157, v110, v111
v_mfma_f32_16x16x32_bf16 a[96:99], v[192:195], v[160:163], a[96:99]
ds_read_b64_tr_b16 v[216:217], v4 offset:256
v_mfma_f32_16x16x32_bf16 a[96:99], v[196:199], v[164:167], a[96:99]
v_exp_f32 v112, v112
v_mfma_f32_16x16x32_bf16 a[100:103], v[196:199], v[172:175], a[100:103]
ds_read_b64_tr_b16 v[218:219], v4 offset:6400
v_add_f32 v10, v10, v112
v_mfma_f32_16x16x32_bf16 a[100:103], v[192:195], v[168:171], a[100:103]
v_exp_f32 v113, v113
v_mfma_f32_16x16x32_bf16 a[104:107], v[192:195], v[176:179], a[104:107]
ds_read_b64_tr_b16 v[220:221], v4 offset:12544
v_add_f32 v10, v10, v113
v_mfma_f32_16x16x32_bf16 a[104:107], v[196:199], v[180:183], a[104:107]
v_exp_f32 v114, v114
v_mfma_f32_16x16x32_bf16 a[108:111], v[196:199], v[188:191], a[108:111]
ds_read_b64_tr_b16 v[222:223], v4 offset:18688
v_cvt_pk_bf16_f32 v134, v112, v113
v_mfma_f32_16x16x32_bf16 a[108:111], v[192:195], v[184:187], a[108:111]
s_waitcnt lgkmcnt(8)
v_exp_f32 v115, v115
v_mfma_f32_16x16x32_bf16 a[112:115], v[200:203], v[160:163], a[112:115]
s_add_u32 s56, s56, 24576
ds_read_b64_tr_b16 v[224:225], v5 offset:256
v_add_f32 v10, v10, v114
v_mfma_f32_16x16x32_bf16 a[112:115], v[204:207], v[164:167], a[112:115]
v_exp_f32 v116, v116
v_mfma_f32_16x16x32_bf16 a[116:119], v[204:207], v[172:175], a[116:119]
ds_read_b64_tr_b16 v[226:227], v5 offset:6400
v_add_f32 v10, v10, v115
v_mfma_f32_16x16x32_bf16 a[116:119], v[200:203], v[168:171], a[116:119]
v_cvt_pk_bf16_f32 v135, v114, v115
v_add_f32 v11, v11, v116
v_mfma_f32_16x16x32_bf16 a[120:123], v[200:203], v[176:179], a[120:123]
ds_read_b64_tr_b16 v[228:229], v5 offset:12544
v_mfma_f32_16x16x32_bf16 a[120:123], v[204:207], v[180:183], a[120:123]
v_exp_f32 v117, v117
v_mfma_f32_16x16x32_bf16 a[124:127], v[204:207], v[188:191], a[124:127]
ds_read_b64_tr_b16 v[230:231], v5 offset:18688
v_add_f32 v11, v11, v117
v_mfma_f32_16x16x32_bf16 a[124:127], v[200:203], v[184:187], a[124:127]
s_waitcnt lgkmcnt(8)
v_exp_f32 v118, v118
v_mfma_f32_16x16x32_bf16 a[128:131], v[208:211], v[160:163], a[128:131]
ds_read_b64_tr_b16 v[232:233], v6 offset:256
v_cvt_pk_bf16_f32 v142, v116, v117
v_mfma_f32_16x16x32_bf16 a[128:131], v[212:215], v[164:167], a[128:131]
v_add_f32 v11, v11, v118
v_mfma_f32_16x16x32_bf16 a[132:135], v[212:215], v[172:175], a[132:135]
ds_read_b64_tr_b16 v[234:235], v6 offset:6400
v_mfma_f32_16x16x32_bf16 a[132:135], v[208:211], v[168:171], a[132:135]
v_exp_f32 v119, v119
v_mfma_f32_16x16x32_bf16 a[136:139], v[208:211], v[176:179], a[136:139]
ds_read_b64_tr_b16 v[236:237], v6 offset:12544
v_add_f32 v11, v11, v119
v_mfma_f32_16x16x32_bf16 a[136:139], v[212:215], v[180:183], a[136:139]
v_exp_f32 v120, v120
v_mfma_f32_16x16x32_bf16 a[140:143], v[212:215], v[188:191], a[140:143]
ds_read_b64_tr_b16 v[238:239], v6 offset:18688
v_cvt_pk_bf16_f32 v143, v118, v119
v_mfma_f32_16x16x32_bf16 a[140:143], v[208:211], v[184:187], a[140:143]
s_waitcnt lgkmcnt(8)
v_exp_f32 v121, v121
v_mfma_f32_16x16x32_bf16 a[144:147], v[216:219], v[160:163], a[144:147]
v_add_f32 v12, v12, v120
v_add_f32 v12, v12, v121
v_mfma_f32_16x16x32_bf16 a[144:147], v[220:223], v[164:167], a[144:147]
v_cvt_pk_bf16_f32 v150, v120, v121
v_mfma_f32_16x16x32_bf16 a[148:151], v[220:223], v[172:175], a[148:151]
v_exp_f32 v122, v122
v_mfma_f32_16x16x32_bf16 a[148:151], v[216:219], v[168:171], a[148:151]
v_add_f32 v12, v12, v122
v_mfma_f32_16x16x32_bf16 a[152:155], v[216:219], v[176:179], a[152:155]
v_mfma_f32_16x16x32_bf16 a[152:155], v[220:223], v[180:183], a[152:155]
v_exp_f32 v123, v123
v_mfma_f32_16x16x32_bf16 a[156:159], v[220:223], v[188:191], a[156:159]
v_add_f32 v12, v12, v123
v_cvt_pk_bf16_f32 v151, v122, v123
v_mfma_f32_16x16x32_bf16 a[156:159], v[216:219], v[184:187], a[156:159]
s_waitcnt lgkmcnt(4)
v_exp_f32 v124, v124
v_mfma_f32_16x16x32_bf16 a[160:163], v[224:227], v[160:163], a[160:163]
s_waitcnt vmcnt(12) lgkmcnt(0)
s_barrier
v_add_f32 v13, v13, v124
v_mfma_f32_16x16x32_bf16 a[160:163], v[228:231], v[164:167], a[160:163]
ds_read_b128 v[192:195], v1
v_mfma_f32_16x16x32_bf16 a[164:167], v[228:231], v[172:175], a[164:167]
v_add_u32 v3, 4294918144, v3
v_mfma_f32_16x16x32_bf16 a[164:167], v[224:227], v[168:171], a[164:167]
ds_read_b128 v[196:199], v2
v_mfma_f32_16x16x32_bf16 a[168:171], v[224:227], v[176:179], a[168:171]
v_add_u32 v4, 4294918144, v4
v_mfma_f32_16x16x32_bf16 a[168:171], v[228:231], v[180:183], a[168:171]
ds_read_b128 v[200:203], v1 offset:128
v_mfma_f32_16x16x32_bf16 a[172:175], v[228:231], v[188:191], a[172:175]
v_add_u32 v5, 4294918144, v5
v_mfma_f32_16x16x32_bf16 a[172:175], v[224:227], v[184:187], a[172:175]
s_waitcnt lgkmcnt(3)
buffer_store_dwordx4 v[246:249], v245, s[20:23], s34 offen sc1
ds_read_b128 v[204:207], v2 offset:128
v_mfma_f32_16x16x32_bf16 a[176:179], v[232:235], v[160:163], a[176:179]
v_add_u32 v6, 4294918144, v6
v_mfma_f32_16x16x32_bf16 a[176:179], v[236:239], v[164:167], a[176:179]
ds_read_b128 v[208:211], v1 offset:256
v_mfma_f32_16x16x32_bf16 a[180:183], v[236:239], v[172:175], a[180:183]
s_sub_u32 s63, s63, 1
v_exp_f32 v125, v125
v_mfma_f32_16x16x32_bf16 a[180:183], v[232:235], v[168:171], a[180:183]
ds_read_b128 v[212:215], v2 offset:256
v_add_f32 v13, v13, v125
v_mfma_f32_16x16x32_bf16 a[184:187], v[232:235], v[176:179], a[184:187]
v_exp_f32 v126, v126
v_mfma_f32_16x16x32_bf16 a[184:187], v[236:239], v[180:183], a[184:187]
v_exp_f32 v127, v127
v_mfma_f32_16x16x32_bf16 a[188:191], v[236:239], v[188:191], a[188:191]
v_cvt_pk_bf16_f32 v158, v124, v125
v_add_f32 v13, v13, v126
v_mfma_f32_16x16x32_bf16 a[188:191], v[232:235], v[184:187], a[188:191]
s_waitcnt lgkmcnt(4)
v_add_f32 v13, v13, v127
v_cvt_pk_bf16_f32 v159, v126, v127
v_mfma_f32_16x16x32_bf16 v[64:67], v[192:195], a[192:195], v[16:19]
v_mfma_f32_16x16x32_bf16 v[64:67], v[196:199], a[196:199], v[64:67]
s_waitcnt lgkmcnt(2)
ds_read_b128 v[216:219], v1 offset:6144
v_mfma_f32_16x16x32_bf16 v[64:67], v[200:203], a[200:203], v[64:67]
s_add_u32 s57, s56, 3072
v_mfma_f32_16x16x32_bf16 v[64:67], v[204:207], a[204:207], v[64:67]
s_waitcnt lgkmcnt(1)
v_mfma_f32_16x16x32_bf16 v[64:67], v[208:211], a[208:211], v[64:67]
s_sub_u32 s58, s56, 24576
ds_read_b128 v[220:223], v2 offset:6144
v_mfma_f32_16x16x32_bf16 v[64:67], v[212:215], a[212:215], v[64:67]
s_sub_u32 s59, s56, 21504
v_mfma_f32_16x16x32_bf16 v[68:71], v[212:215], a[236:239], v[20:23]
v_mfma_f32_16x16x32_bf16 v[68:71], v[208:211], a[232:235], v[68:71]
ds_read_b128 v[224:227], v1 offset:6272
v_mfma_f32_16x16x32_bf16 v[68:71], v[204:207], a[228:231], v[68:71]
s_add_u32 m0, s68, 49152
v_mfma_f32_16x16x32_bf16 v[68:71], v[200:203], a[224:227], v[68:71]
v_mfma_f32_16x16x32_bf16 v[68:71], v[196:199], a[220:223], v[68:71]
ds_read_b128 v[228:231], v2 offset:6272
v_mfma_f32_16x16x32_bf16 v[68:71], v[192:195], a[216:219], v[68:71]
buffer_load_dwordx4 v7, s[4:7], s56 offen lds
v_mfma_f32_16x16x32_bf16 v[72:75], v[192:195], a[240:243], v[24:27]
v_exp_f32 v64, v64
v_mfma_f32_16x16x32_bf16 v[72:75], v[196:199], a[244:247], v[72:75]
ds_read_b128 v[232:235], v1 offset:6400
v_add_f32 v10, v10, v64
v_mfma_f32_16x16x32_bf16 v[72:75], v[200:203], a[248:251], v[72:75]
v_exp_f32 v65, v65
v_mfma_f32_16x16x32_bf16 v[72:75], v[204:207], a[252:255], v[72:75]
v_add_f32 v10, v10, v65
v_cvt_pk_bf16_f32 v160, v64, v65
v_mfma_f32_16x16x32_bf16 v[72:75], v[208:211], v[32:35], v[72:75]
ds_read_b128 v[236:239], v2 offset:6400
v_mfma_f32_16x16x32_bf16 v[72:75], v[212:215], v[36:39], v[72:75]
v_exp_f32 v66, v66
v_mfma_f32_16x16x32_bf16 v[76:79], v[212:215], v[60:63], v[28:31]
v_add_f32 v10, v10, v66
v_mfma_f32_16x16x32_bf16 v[76:79], v[208:211], v[56:59], v[76:79]
v_exp_f32 v67, v67
v_mfma_f32_16x16x32_bf16 v[76:79], v[204:207], v[52:55], v[76:79]
s_add_u32 s34, s34, 1024
v_add_f32 v10, v10, v67
v_cvt_pk_bf16_f32 v161, v66, v67
v_mfma_f32_16x16x32_bf16 v[76:79], v[200:203], v[48:51], v[76:79]
v_exp_f32 v68, v68
v_mfma_f32_16x16x32_bf16 v[76:79], v[196:199], v[44:47], v[76:79]
v_add_f32 v11, v11, v68
v_mfma_f32_16x16x32_bf16 v[76:79], v[192:195], v[40:43], v[76:79]
s_waitcnt lgkmcnt(0)
buffer_load_dwordx4 v8, s[4:7], s56 offen offset:1024 lds
v_mfma_f32_16x16x32_bf16 v[80:83], v[216:219], a[192:195], v[16:19]
v_exp_f32 v69, v69
v_mfma_f32_16x16x32_bf16 v[80:83], v[220:223], a[196:199], v[80:83]
ds_read_b128 v[192:195], v1 offset:12288
v_add_f32 v11, v11, v69
v_mfma_f32_16x16x32_bf16 v[80:83], v[224:227], a[200:203], v[80:83]
v_cvt_pk_bf16_f32 v168, v68, v69
v_mfma_f32_16x16x32_bf16 v[80:83], v[228:231], a[204:207], v[80:83]
v_exp_f32 v70, v70
v_mfma_f32_16x16x32_bf16 v[80:83], v[232:235], a[208:211], v[80:83]
ds_read_b128 v[196:199], v2 offset:12288
v_add_f32 v11, v11, v70
v_mfma_f32_16x16x32_bf16 v[80:83], v[236:239], a[212:215], v[80:83]
v_mfma_f32_16x16x32_bf16 v[84:87], v[236:239], a[236:239], v[20:23]
v_exp_f32 v71, v71
v_mfma_f32_16x16x32_bf16 v[84:87], v[232:235], a[232:235], v[84:87]
ds_read_b128 v[200:203], v1 offset:12416
v_add_f32 v11, v11, v71
v_mfma_f32_16x16x32_bf16 v[84:87], v[228:231], a[228:231], v[84:87]
v_exp_f32 v72, v72
v_mfma_f32_16x16x32_bf16 v[84:87], v[224:227], a[224:227], v[84:87]
v_cvt_pk_bf16_f32 v169, v70, v71
v_add_f32 v12, v12, v72
v_mfma_f32_16x16x32_bf16 v[84:87], v[220:223], a[220:223], v[84:87]
ds_read_b128 v[204:207], v2 offset:12416
v_mfma_f32_16x16x32_bf16 v[84:87], v[216:219], a[216:219], v[84:87]
buffer_load_dwordx4 v9, s[4:7], s56 offen offset:2048 lds
v_mfma_f32_16x16x32_bf16 v[88:91], v[216:219], a[240:243], v[24:27]
v_exp_f32 v73, v73
v_mfma_f32_16x16x32_bf16 v[88:91], v[220:223], a[244:247], v[88:91]
ds_read_b128 v[208:211], v1 offset:12544
v_add_f32 v12, v12, v73
v_mfma_f32_16x16x32_bf16 v[88:91], v[224:227], a[248:251], v[88:91]
v_exp_f32 v74, v74
v_mfma_f32_16x16x32_bf16 v[88:91], v[228:231], a[252:255], v[88:91]
v_cvt_pk_bf16_f32 v176, v72, v73
v_add_f32 v12, v12, v74
v_mfma_f32_16x16x32_bf16 v[88:91], v[232:235], v[32:35], v[88:91]
ds_read_b128 v[212:215], v2 offset:12544
v_mfma_f32_16x16x32_bf16 v[88:91], v[236:239], v[36:39], v[88:91]
v_exp_f32 v75, v75
v_mfma_f32_16x16x32_bf16 v[92:95], v[236:239], v[60:63], v[28:31]
v_add_f32 v12, v12, v75
v_cvt_pk_bf16_f32 v177, v74, v75
v_mfma_f32_16x16x32_bf16 v[92:95], v[232:235], v[56:59], v[92:95]
v_exp_f32 v76, v76
v_mfma_f32_16x16x32_bf16 v[92:95], v[228:231], v[52:55], v[92:95]
s_add_u32 m0, s68, 52224
v_add_f32 v13, v13, v76
v_mfma_f32_16x16x32_bf16 v[92:95], v[224:227], v[48:51], v[92:95]
v_mfma_f32_16x16x32_bf16 v[92:95], v[220:223], v[44:47], v[92:95]
v_exp_f32 v77, v77
v_mfma_f32_16x16x32_bf16 v[92:95], v[216:219], v[40:43], v[92:95]
s_waitcnt lgkmcnt(0)
buffer_load_dwordx4 v7, s[4:7], s57 offen lds
v_add_f32 v13, v13, v77
v_mfma_f32_16x16x32_bf16 v[96:99], v[192:195], a[192:195], v[16:19]
v_cvt_pk_bf16_f32 v184, v76, v77
v_mfma_f32_16x16x32_bf16 v[96:99], v[196:199], a[196:199], v[96:99]
ds_read_b128 v[216:219], v1 offset:18432
v_mfma_f32_16x16x32_bf16 v[96:99], v[200:203], a[200:203], v[96:99]
v_exp_f32 v78, v78
v_mfma_f32_16x16x32_bf16 v[96:99], v[204:207], a[204:207], v[96:99]
v_add_f32 v13, v13, v78
v_mfma_f32_16x16x32_bf16 v[96:99], v[208:211], a[208:211], v[96:99]
ds_read_b128 v[220:223], v2 offset:18432
v_mfma_f32_16x16x32_bf16 v[96:99], v[212:215], a[212:215], v[96:99]
v_exp_f32 v79, v79
v_mfma_f32_16x16x32_bf16 v[100:103], v[212:215], a[236:239], v[20:23]
v_exp_f32 v80, v80
v_mfma_f32_16x16x32_bf16 v[100:103], v[208:211], a[232:235], v[100:103]
ds_read_b128 v[224:227], v1 offset:18560
v_add_f32 v13, v13, v79
v_mfma_f32_16x16x32_bf16 v[100:103], v[204:207], a[228:231], v[100:103]
v_cvt_pk_bf16_f32 v185, v78, v79
v_add_f32 v10, v10, v80
v_mfma_f32_16x16x32_bf16 v[100:103], v[200:203], a[224:227], v[100:103]
v_exp_f32 v81, v81
v_mfma_f32_16x16x32_bf16 v[100:103], v[196:199], a[220:223], v[100:103]
ds_read_b128 v[228:231], v2 offset:18560
v_add_f32 v10, v10, v81
v_mfma_f32_16x16x32_bf16 v[100:103], v[192:195], a[216:219], v[100:103]
buffer_load_dwordx4 v8, s[4:7], s57 offen offset:1024 lds
v_cvt_pk_bf16_f32 v162, v80, v81
v_mfma_f32_16x16x32_bf16 v[104:107], v[192:195], a[240:243], v[24:27]
v_exp_f32 v82, v82
v_mfma_f32_16x16x32_bf16 v[104:107], v[196:199], a[244:247], v[104:107]
ds_read_b128 v[232:235], v1 offset:18688
v_add_f32 v10, v10, v82
v_mfma_f32_16x16x32_bf16 v[104:107], v[200:203], a[248:251], v[104:107]
v_mfma_f32_16x16x32_bf16 v[104:107], v[204:207], a[252:255], v[104:107]
v_exp_f32 v83, v83
v_mfma_f32_16x16x32_bf16 v[104:107], v[208:211], v[32:35], v[104:107]
ds_read_b128 v[236:239], v2 offset:18688
v_add_f32 v10, v10, v83
v_mfma_f32_16x16x32_bf16 v[104:107], v[212:215], v[36:39], v[104:107]
v_exp_f32 v84, v84
v_mfma_f32_16x16x32_bf16 v[108:111], v[212:215], v[60:63], v[28:31]
v_cvt_pk_bf16_f32 v163, v82, v83
v_add_f32 v11, v11, v84
v_mfma_f32_16x16x32_bf16 v[108:111], v[208:211], v[56:59], v[108:111]
v_mfma_f32_16x16x32_bf16 v[108:111], v[204:207], v[52:55], v[108:111]
v_exp_f32 v85, v85
v_mfma_f32_16x16x32_bf16 v[108:111], v[200:203], v[48:51], v[108:111]
v_add_f32 v11, v11, v85
v_cvt_pk_bf16_f32 v170, v84, v85
v_mfma_f32_16x16x32_bf16 v[108:111], v[196:199], v[44:47], v[108:111]
v_mfma_f32_16x16x32_bf16 v[108:111], v[192:195], v[40:43], v[108:111]
s_waitcnt lgkmcnt(0)
buffer_load_dwordx4 v9, s[4:7], s57 offen offset:2048 lds
v_mfma_f32_16x16x32_bf16 v[112:115], v[216:219], a[192:195], v[16:19]
v_exp_f32 v86, v86
v_mfma_f32_16x16x32_bf16 v[112:115], v[220:223], a[196:199], v[112:115]
ds_read_b64_tr_b16 v[192:193], v3
v_add_f32 v11, v11, v86
v_mfma_f32_16x16x32_bf16 v[112:115], v[224:227], a[200:203], v[112:115]
ds_read_b64_tr_b16 v[194:195], v3 offset:6144
v_mfma_f32_16x16x32_bf16 v[112:115], v[228:231], a[204:207], v[112:115]
v_exp_f32 v87, v87
v_mfma_f32_16x16x32_bf16 v[112:115], v[232:235], a[208:211], v[112:115]
ds_read_b64_tr_b16 v[196:197], v3 offset:12288
v_add_f32 v11, v11, v87
v_mfma_f32_16x16x32_bf16 v[112:115], v[236:239], a[212:215], v[112:115]
ds_read_b64_tr_b16 v[198:199], v3 offset:18432
v_cvt_pk_bf16_f32 v171, v86, v87
v_mfma_f32_16x16x32_bf16 v[116:119], v[236:239], a[236:239], v[20:23]
v_exp_f32 v88, v88
v_mfma_f32_16x16x32_bf16 v[116:119], v[232:235], a[232:235], v[116:119]
ds_read_b64_tr_b16 v[200:201], v4
v_add_f32 v12, v12, v88
v_mfma_f32_16x16x32_bf16 v[116:119], v[228:231], a[228:231], v[116:119]
s_add_u32 m0, s68, 122880
ds_read_b64_tr_b16 v[202:203], v4 offset:6144
v_mfma_f32_16x16x32_bf16 v[116:119], v[224:227], a[224:227], v[116:119]
v_exp_f32 v89, v89
v_mfma_f32_16x16x32_bf16 v[116:119], v[220:223], a[220:223], v[116:119]
ds_read_b64_tr_b16 v[204:205], v4 offset:12288
v_add_f32 v12, v12, v89
v_mfma_f32_16x16x32_bf16 v[116:119], v[216:219], a[216:219], v[116:119]
ds_read_b64_tr_b16 v[206:207], v4 offset:18432
buffer_load_dwordx4 v7, s[8:11], s58 offen lds
v_mfma_f32_16x16x32_bf16 v[120:123], v[216:219], a[240:243], v[24:27]
v_exp_f32 v90, v90
v_mfma_f32_16x16x32_bf16 v[120:123], v[220:223], a[244:247], v[120:123]
ds_read_b64_tr_b16 v[208:209], v5
v_cvt_pk_bf16_f32 v178, v88, v89
v_mfma_f32_16x16x32_bf16 v[120:123], v[224:227], a[248:251], v[120:123]
ds_read_b64_tr_b16 v[210:211], v5 offset:6144
v_add_f32 v12, v12, v90
v_mfma_f32_16x16x32_bf16 v[120:123], v[228:231], a[252:255], v[120:123]
v_exp_f32 v91, v91
v_mfma_f32_16x16x32_bf16 v[120:123], v[232:235], v[32:35], v[120:123]
ds_read_b64_tr_b16 v[212:213], v5 offset:12288
v_add_f32 v12, v12, v91
v_mfma_f32_16x16x32_bf16 v[120:123], v[236:239], v[36:39], v[120:123]
ds_read_b64_tr_b16 v[214:215], v5 offset:18432
v_cvt_pk_bf16_f32 v179, v90, v91
v_mfma_f32_16x16x32_bf16 v[124:127], v[236:239], v[60:63], v[28:31]
v_exp_f32 v92, v92
v_mfma_f32_16x16x32_bf16 v[124:127], v[232:235], v[56:59], v[124:127]
v_exp_f32 v93, v93
v_mfma_f32_16x16x32_bf16 v[124:127], v[228:231], v[52:55], v[124:127]
v_add_f32 v13, v13, v92
v_add_f32 v13, v13, v93
v_mfma_f32_16x16x32_bf16 v[124:127], v[224:227], v[48:51], v[124:127]
v_exp_f32 v94, v94
v_mfma_f32_16x16x32_bf16 v[124:127], v[220:223], v[44:47], v[124:127]
v_cvt_pk_bf16_f32 v186, v92, v93
v_add_f32 v13, v13, v94
v_mfma_f32_16x16x32_bf16 v[124:127], v[216:219], v[40:43], v[124:127]
s_waitcnt lgkmcnt(8)
buffer_load_dwordx4 v8, s[8:11], s58 offen offset:1024 lds
v_mfma_f32_16x16x32_bf16 a[0:3], v[192:195], v[128:131], a[0:3]
ds_read_b64_tr_b16 v[216:217], v6
v_mfma_f32_16x16x32_bf16 a[0:3], v[196:199], v[132:135], a[0:3]
v_exp_f32 v95, v95
v_mfma_f32_16x16x32_bf16 a[4:7], v[196:199], v[140:143], a[4:7]
ds_read_b64_tr_b16 v[218:219], v6 offset:6144
v_add_f32 v13, v13, v95
v_mfma_f32_16x16x32_bf16 a[4:7], v[192:195], v[136:139], a[4:7]
v_exp_f32 v96, v96
v_mfma_f32_16x16x32_bf16 a[8:11], v[192:195], v[144:147], a[8:11]
ds_read_b64_tr_b16 v[220:221], v6 offset:12288
v_cvt_pk_bf16_f32 v187, v94, v95
v_mfma_f32_16x16x32_bf16 a[8:11], v[196:199], v[148:151], a[8:11]
v_exp_f32 v97, v97
v_mfma_f32_16x16x32_bf16 a[12:15], v[196:199], v[156:159], a[12:15]
ds_read_b64_tr_b16 v[222:223], v6 offset:18432
v_add_f32 v10, v10, v96
v_mfma_f32_16x16x32_bf16 a[12:15], v[192:195], v[152:155], a[12:15]
s_waitcnt lgkmcnt(8)
v_add_f32 v10, v10, v97
v_cvt_pk_bf16_f32 v164, v96, v97
v_mfma_f32_16x16x32_bf16 a[16:19], v[200:203], v[128:131], a[16:19]
ds_read_b64_tr_b16 v[224:225], v3 offset:128
v_mfma_f32_16x16x32_bf16 a[16:19], v[204:207], v[132:135], a[16:19]
v_exp_f32 v98, v98
v_mfma_f32_16x16x32_bf16 a[20:23], v[204:207], v[140:143], a[20:23]
ds_read_b64_tr_b16 v[226:227], v3 offset:6272
v_add_u32 v1, 24576, v1
v_mfma_f32_16x16x32_bf16 a[20:23], v[200:203], v[136:139], a[20:23]
buffer_load_dwordx4 v9, s[8:11], s58 offen offset:2048 lds
v_add_f32 v10, v10, v98
v_mfma_f32_16x16x32_bf16 a[24:27], v[200:203], v[144:147], a[24:27]
ds_read_b64_tr_b16 v[228:229], v3 offset:12416
v_add_u32 v2, 24576, v2
v_mfma_f32_16x16x32_bf16 a[24:27], v[204:207], v[148:151], a[24:27]
v_exp_f32 v99, v99
v_mfma_f32_16x16x32_bf16 a[28:31], v[204:207], v[156:159], a[28:31]
ds_read_b64_tr_b16 v[230:231], v3 offset:18560
v_add_f32 v10, v10, v99
v_mfma_f32_16x16x32_bf16 a[28:31], v[200:203], v[152:155], a[28:31]
s_waitcnt lgkmcnt(8)
v_exp_f32 v100, v100
v_mfma_f32_16x16x32_bf16 a[32:35], v[208:211], v[128:131], a[32:35]
ds_read_b64_tr_b16 v[232:233], v4 offset:128
v_cvt_pk_bf16_f32 v165, v98, v99
v_mfma_f32_16x16x32_bf16 a[32:35], v[212:215], v[132:135], a[32:35]
v_exp_f32 v101, v101
v_mfma_f32_16x16x32_bf16 a[36:39], v[212:215], v[140:143], a[36:39]
ds_read_b64_tr_b16 v[234:235], v4 offset:6272
v_add_f32 v11, v11, v100
v_mfma_f32_16x16x32_bf16 a[36:39], v[208:211], v[136:139], a[36:39]
v_exp_f32 v102, v102
v_mfma_f32_16x16x32_bf16 a[40:43], v[208:211], v[144:147], a[40:43]
s_add_u32 m0, s68, 125952
ds_read_b64_tr_b16 v[236:237], v4 offset:12416
v_add_f32 v11, v11, v101
v_mfma_f32_16x16x32_bf16 a[40:43], v[212:215], v[148:151], a[40:43]
v_cvt_pk_bf16_f32 v172, v100, v101
v_add_f32 v11, v11, v102
v_mfma_f32_16x16x32_bf16 a[44:47], v[212:215], v[156:159], a[44:47]
ds_read_b64_tr_b16 v[238:239], v4 offset:18560
v_mfma_f32_16x16x32_bf16 a[44:47], v[208:211], v[152:155], a[44:47]
s_waitcnt lgkmcnt(8)
buffer_load_dwordx4 v7, s[8:11], s59 offen lds
v_mfma_f32_16x16x32_bf16 a[48:51], v[216:219], v[128:131], a[48:51]
ds_read_b64_tr_b16 v[192:193], v5 offset:128
v_mfma_f32_16x16x32_bf16 a[48:51], v[220:223], v[132:135], a[48:51]
v_exp_f32 v103, v103
v_mfma_f32_16x16x32_bf16 a[52:55], v[220:223], v[140:143], a[52:55]
ds_read_b64_tr_b16 v[194:195], v5 offset:6272
v_add_f32 v11, v11, v103
v_mfma_f32_16x16x32_bf16 a[52:55], v[216:219], v[136:139], a[52:55]
v_exp_f32 v104, v104
v_mfma_f32_16x16x32_bf16 a[56:59], v[216:219], v[144:147], a[56:59]
ds_read_b64_tr_b16 v[196:197], v5 offset:12416
v_cvt_pk_bf16_f32 v173, v102, v103
v_mfma_f32_16x16x32_bf16 a[56:59], v[220:223], v[148:151], a[56:59]
v_exp_f32 v105, v105
v_mfma_f32_16x16x32_bf16 a[60:63], v[220:223], v[156:159], a[60:63]
ds_read_b64_tr_b16 v[198:199], v5 offset:18560
v_add_f32 v12, v12, v104
v_mfma_f32_16x16x32_bf16 a[60:63], v[216:219], v[152:155], a[60:63]
s_waitcnt lgkmcnt(8)
v_exp_f32 v106, v106
v_mfma_f32_16x16x32_bf16 a[64:67], v[224:227], v[128:131], a[64:67]
ds_read_b64_tr_b16 v[200:201], v6 offset:128
v_add_f32 v12, v12, v105
v_mfma_f32_16x16x32_bf16 a[64:67], v[228:231], v[132:135], a[64:67]
v_exp_f32 v107, v107
v_mfma_f32_16x16x32_bf16 a[68:71], v[228:231], v[140:143], a[68:71]
ds_read_b64_tr_b16 v[202:203], v6 offset:6272
v_cvt_pk_bf16_f32 v180, v104, v105
v_mfma_f32_16x16x32_bf16 a[68:71], v[224:227], v[136:139], a[68:71]
buffer_load_dwordx4 v8, s[8:11], s59 offen offset:1024 lds
v_add_f32 v12, v12, v106
v_mfma_f32_16x16x32_bf16 a[72:75], v[224:227], v[144:147], a[72:75]
ds_read_b64_tr_b16 v[204:205], v6 offset:12416
v_add_f32 v12, v12, v107
v_mfma_f32_16x16x32_bf16 a[72:75], v[228:231], v[148:151], a[72:75]
v_exp_f32 v108, v108
v_mfma_f32_16x16x32_bf16 a[76:79], v[228:231], v[156:159], a[76:79]
ds_read_b64_tr_b16 v[206:207], v6 offset:18560
v_cvt_pk_bf16_f32 v181, v106, v107
v_mfma_f32_16x16x32_bf16 a[76:79], v[224:227], v[152:155], a[76:79]
s_waitcnt lgkmcnt(8)
v_exp_f32 v109, v109
v_mfma_f32_16x16x32_bf16 a[80:83], v[232:235], v[128:131], a[80:83]
ds_read_b64_tr_b16 v[208:209], v3 offset:256
v_add_f32 v13, v13, v108
v_mfma_f32_16x16x32_bf16 a[80:83], v[236:239], v[132:135], a[80:83]
v_exp_f32 v110, v110
v_mfma_f32_16x16x32_bf16 a[84:87], v[236:239], v[140:143], a[84:87]
ds_read_b64_tr_b16 v[210:211], v3 offset:6400
v_add_f32 v13, v13, v109
v_mfma_f32_16x16x32_bf16 a[84:87], v[232:235], v[136:139], a[84:87]
v_cvt_pk_bf16_f32 v188, v108, v109
v_add_f32 v13, v13, v110
v_mfma_f32_16x16x32_bf16 a[88:91], v[232:235], v[144:147], a[88:91]
ds_read_b64_tr_b16 v[212:213], v3 offset:12544
v_mfma_f32_16x16x32_bf16 a[88:91], v[236:239], v[148:151], a[88:91]
v_exp_f32 v111, v111
v_mfma_f32_16x16x32_bf16 a[92:95], v[236:239], v[156:159], a[92:95]
ds_read_b64_tr_b16 v[214:215], v3 offset:18688
v_add_f32 v13, v13, v111
v_mfma_f32_16x16x32_bf16 a[92:95], v[232:235], v[152:155], a[92:95]
s_waitcnt lgkmcnt(8)
buffer_load_dwordx4 v9, s[8:11], s59 offen offset:2048 lds
v_cvt_pk_bf16_f32 v189, v110, v111
v_mfma_f32_16x16x32_bf16 a[96:99], v[192:195], v[128:131], a[96:99]
ds_read_b64_tr_b16 v[216:217], v4 offset:256
v_mfma_f32_16x16x32_bf16 a[96:99], v[196:199], v[132:135], a[96:99]
v_exp_f32 v112, v112
v_mfma_f32_16x16x32_bf16 a[100:103], v[196:199], v[140:143], a[100:103]
ds_read_b64_tr_b16 v[218:219], v4 offset:6400
v_add_f32 v10, v10, v112
v_mfma_f32_16x16x32_bf16 a[100:103], v[192:195], v[136:139], a[100:103]
v_exp_f32 v113, v113
v_mfma_f32_16x16x32_bf16 a[104:107], v[192:195], v[144:147], a[104:107]
ds_read_b64_tr_b16 v[220:221], v4 offset:12544
v_add_f32 v10, v10, v113
v_mfma_f32_16x16x32_bf16 a[104:107], v[196:199], v[148:151], a[104:107]
v_exp_f32 v114, v114
v_mfma_f32_16x16x32_bf16 a[108:111], v[196:199], v[156:159], a[108:111]
ds_read_b64_tr_b16 v[222:223], v4 offset:18688
v_cvt_pk_bf16_f32 v166, v112, v113
v_mfma_f32_16x16x32_bf16 a[108:111], v[192:195], v[152:155], a[108:111]
s_waitcnt lgkmcnt(8)
v_exp_f32 v115, v115
v_mfma_f32_16x16x32_bf16 a[112:115], v[200:203], v[128:131], a[112:115]
s_add_u32 s56, s56, 24576
ds_read_b64_tr_b16 v[224:225], v5 offset:256
v_add_f32 v10, v10, v114
v_mfma_f32_16x16x32_bf16 a[112:115], v[204:207], v[132:135], a[112:115]
v_exp_f32 v116, v116
v_mfma_f32_16x16x32_bf16 a[116:119], v[204:207], v[140:143], a[116:119]
ds_read_b64_tr_b16 v[226:227], v5 offset:6400
v_add_f32 v10, v10, v115
v_mfma_f32_16x16x32_bf16 a[116:119], v[200:203], v[136:139], a[116:119]
v_cvt_pk_bf16_f32 v167, v114, v115
v_add_f32 v11, v11, v116
v_mfma_f32_16x16x32_bf16 a[120:123], v[200:203], v[144:147], a[120:123]
s_cmp_eq_u32 s63, 0
s_cselect_b32 s24, s18, s27
ds_read_b64_tr_b16 v[228:229], v5 offset:12544
v_mfma_f32_16x16x32_bf16 a[120:123], v[204:207], v[148:151], a[120:123]
v_exp_f32 v117, v117
v_mfma_f32_16x16x32_bf16 a[124:127], v[204:207], v[156:159], a[124:127]
ds_read_b64_tr_b16 v[230:231], v5 offset:18688
v_add_f32 v11, v11, v117
v_mfma_f32_16x16x32_bf16 a[124:127], v[200:203], v[152:155], a[124:127]
s_waitcnt lgkmcnt(8)
v_exp_f32 v118, v118
v_mfma_f32_16x16x32_bf16 a[128:131], v[208:211], v[128:131], a[128:131]
ds_read_b64_tr_b16 v[232:233], v6 offset:256
v_cvt_pk_bf16_f32 v174, v116, v117
v_mfma_f32_16x16x32_bf16 a[128:131], v[212:215], v[132:135], a[128:131]
v_add_f32 v11, v11, v118
v_mfma_f32_16x16x32_bf16 a[132:135], v[212:215], v[140:143], a[132:135]
ds_read_b64_tr_b16 v[234:235], v6 offset:6400
v_mfma_f32_16x16x32_bf16 a[132:135], v[208:211], v[136:139], a[132:135]
v_exp_f32 v119, v119
v_mfma_f32_16x16x32_bf16 a[136:139], v[208:211], v[144:147], a[136:139]
ds_read_b64_tr_b16 v[236:237], v6 offset:12544
v_add_f32 v11, v11, v119
v_mfma_f32_16x16x32_bf16 a[136:139], v[212:215], v[148:151], a[136:139]
v_exp_f32 v120, v120
v_mfma_f32_16x16x32_bf16 a[140:143], v[212:215], v[156:159], a[140:143]
ds_read_b64_tr_b16 v[238:239], v6 offset:18688
v_cvt_pk_bf16_f32 v175, v118, v119
v_mfma_f32_16x16x32_bf16 a[140:143], v[208:211], v[152:155], a[140:143]
s_waitcnt lgkmcnt(8)
v_exp_f32 v121, v121
v_mfma_f32_16x16x32_bf16 a[144:147], v[216:219], v[128:131], a[144:147]
v_add_f32 v12, v12, v120
v_add_f32 v12, v12, v121
v_mfma_f32_16x16x32_bf16 a[144:147], v[220:223], v[132:135], a[144:147]
v_cvt_pk_bf16_f32 v182, v120, v121
v_mfma_f32_16x16x32_bf16 a[148:151], v[220:223], v[140:143], a[148:151]
v_exp_f32 v122, v122
v_mfma_f32_16x16x32_bf16 a[148:151], v[216:219], v[136:139], a[148:151]
v_add_f32 v12, v12, v122
v_mfma_f32_16x16x32_bf16 a[152:155], v[216:219], v[144:147], a[152:155]
v_mfma_f32_16x16x32_bf16 a[152:155], v[220:223], v[148:151], a[152:155]
v_exp_f32 v123, v123
v_mfma_f32_16x16x32_bf16 a[156:159], v[220:223], v[156:159], a[156:159]
v_add_f32 v12, v12, v123
v_cvt_pk_bf16_f32 v183, v122, v123
v_mfma_f32_16x16x32_bf16 a[156:159], v[216:219], v[152:155], a[156:159]
s_waitcnt lgkmcnt(4)
v_exp_f32 v124, v124
v_mfma_f32_16x16x32_bf16 a[160:163], v[224:227], v[128:131], a[160:163]
s_waitcnt vmcnt(12) lgkmcnt(0)
s_barrier
v_add_f32 v13, v13, v124
v_mfma_f32_16x16x32_bf16 a[160:163], v[228:231], v[132:135], a[160:163]
ds_read_b128 v[192:195], v1
v_mfma_f32_16x16x32_bf16 a[164:167], v[228:231], v[140:143], a[164:167]
v_add_u32 v3, 24576, v3
v_mfma_f32_16x16x32_bf16 a[164:167], v[224:227], v[136:139], a[164:167]
buffer_load_dword v254, v251, s[40:43], s24 offen
ds_read_b128 v[196:199], v2
v_mfma_f32_16x16x32_bf16 a[168:171], v[224:227], v[144:147], a[168:171]
v_add_u32 v4, 24576, v4
v_mfma_f32_16x16x32_bf16 a[168:171], v[228:231], v[148:151], a[168:171]
ds_read_b128 v[200:203], v1 offset:128
v_mfma_f32_16x16x32_bf16 a[172:175], v[228:231], v[156:159], a[172:175]
v_add_u32 v5, 24576, v5
v_mfma_f32_16x16x32_bf16 a[172:175], v[224:227], v[152:155], a[172:175]
s_waitcnt lgkmcnt(3)
ds_read_b128 v[204:207], v2 offset:128
v_mfma_f32_16x16x32_bf16 a[176:179], v[232:235], v[128:131], a[176:179]
v_add_u32 v6, 24576, v6
v_mfma_f32_16x16x32_bf16 a[176:179], v[236:239], v[132:135], a[176:179]
ds_read_b128 v[208:211], v1 offset:256
v_mfma_f32_16x16x32_bf16 a[180:183], v[236:239], v[140:143], a[180:183]
v_exp_f32 v125, v125
v_mfma_f32_16x16x32_bf16 a[180:183], v[232:235], v[136:139], a[180:183]
ds_read_b128 v[212:215], v2 offset:256
v_add_f32 v13, v13, v125
v_mfma_f32_16x16x32_bf16 a[184:187], v[232:235], v[144:147], a[184:187]
v_exp_f32 v126, v126
v_mfma_f32_16x16x32_bf16 a[184:187], v[236:239], v[148:151], a[184:187]
v_exp_f32 v127, v127
v_mfma_f32_16x16x32_bf16 a[188:191], v[236:239], v[156:159], a[188:191]
v_cvt_pk_bf16_f32 v190, v124, v125
v_add_f32 v13, v13, v126
v_mfma_f32_16x16x32_bf16 a[188:191], v[232:235], v[152:155], a[188:191]
s_waitcnt lgkmcnt(4)
v_add_f32 v13, v13, v127
v_cvt_pk_bf16_f32 v191, v126, v127
v_mfma_f32_16x16x32_bf16 v[64:67], v[192:195], a[192:195], v[16:19]
v_mfma_f32_16x16x32_bf16 v[64:67], v[196:199], a[196:199], v[64:67]
s_waitcnt lgkmcnt(2)
ds_read_b128 v[216:219], v1 offset:6144
v_mfma_f32_16x16x32_bf16 v[64:67], v[200:203], a[200:203], v[64:67]
s_add_u32 s57, s56, 3072
v_mfma_f32_16x16x32_bf16 v[64:67], v[204:207], a[204:207], v[64:67]
s_waitcnt lgkmcnt(1)
v_mfma_f32_16x16x32_bf16 v[64:67], v[208:211], a[208:211], v[64:67]
s_sub_u32 s58, s56, 24576
ds_read_b128 v[220:223], v2 offset:6144
v_mfma_f32_16x16x32_bf16 v[64:67], v[212:215], a[212:215], v[64:67]
s_sub_u32 s59, s56, 21504
v_mfma_f32_16x16x32_bf16 v[68:71], v[212:215], a[236:239], v[20:23]
v_mfma_f32_16x16x32_bf16 v[68:71], v[208:211], a[232:235], v[68:71]
ds_read_b128 v[224:227], v1 offset:6272
v_mfma_f32_16x16x32_bf16 v[68:71], v[204:207], a[228:231], v[68:71]
s_add_u32 m0, s68, 0
v_mfma_f32_16x16x32_bf16 v[68:71], v[200:203], a[224:227], v[68:71]
v_mfma_f32_16x16x32_bf16 v[68:71], v[196:199], a[220:223], v[68:71]
ds_read_b128 v[228:231], v2 offset:6272
v_mfma_f32_16x16x32_bf16 v[68:71], v[192:195], a[216:219], v[68:71]
buffer_load_dwordx4 v7, s[4:7], s56 offen lds
v_mfma_f32_16x16x32_bf16 v[72:75], v[192:195], a[240:243], v[24:27]
v_exp_f32 v64, v64
v_mfma_f32_16x16x32_bf16 v[72:75], v[196:199], a[244:247], v[72:75]
ds_read_b128 v[232:235], v1 offset:6400
v_add_f32 v10, v10, v64
v_mfma_f32_16x16x32_bf16 v[72:75], v[200:203], a[248:251], v[72:75]
v_exp_f32 v65, v65
v_mfma_f32_16x16x32_bf16 v[72:75], v[204:207], a[252:255], v[72:75]
v_add_f32 v10, v10, v65
v_cvt_pk_bf16_f32 v128, v64, v65
v_mfma_f32_16x16x32_bf16 v[72:75], v[208:211], v[32:35], v[72:75]
ds_read_b128 v[236:239], v2 offset:6400
v_mfma_f32_16x16x32_bf16 v[72:75], v[212:215], v[36:39], v[72:75]
v_exp_f32 v66, v66
v_mfma_f32_16x16x32_bf16 v[76:79], v[212:215], v[60:63], v[28:31]
v_add_f32 v10, v10, v66
v_mfma_f32_16x16x32_bf16 v[76:79], v[208:211], v[56:59], v[76:79]
v_exp_f32 v67, v67
v_mfma_f32_16x16x32_bf16 v[76:79], v[204:207], v[52:55], v[76:79]
v_add_f32 v10, v10, v67
v_cvt_pk_bf16_f32 v129, v66, v67
v_mfma_f32_16x16x32_bf16 v[76:79], v[200:203], v[48:51], v[76:79]
v_exp_f32 v68, v68
v_mfma_f32_16x16x32_bf16 v[76:79], v[196:199], v[44:47], v[76:79]
v_add_f32 v11, v11, v68
v_mfma_f32_16x16x32_bf16 v[76:79], v[192:195], v[40:43], v[76:79]
s_waitcnt lgkmcnt(0)
buffer_load_dwordx4 v8, s[4:7], s56 offen offset:1024 lds
v_mfma_f32_16x16x32_bf16 v[80:83], v[216:219], a[192:195], v[16:19]
v_exp_f32 v69, v69
v_mfma_f32_16x16x32_bf16 v[80:83], v[220:223], a[196:199], v[80:83]
ds_read_b128 v[192:195], v1 offset:12288
v_add_f32 v11, v11, v69
v_mfma_f32_16x16x32_bf16 v[80:83], v[224:227], a[200:203], v[80:83]
v_cvt_pk_bf16_f32 v136, v68, v69
v_mfma_f32_16x16x32_bf16 v[80:83], v[228:231], a[204:207], v[80:83]
v_exp_f32 v70, v70
v_mfma_f32_16x16x32_bf16 v[80:83], v[232:235], a[208:211], v[80:83]
ds_read_b128 v[196:199], v2 offset:12288
v_add_f32 v11, v11, v70
v_mfma_f32_16x16x32_bf16 v[80:83], v[236:239], a[212:215], v[80:83]
v_mfma_f32_16x16x32_bf16 v[84:87], v[236:239], a[236:239], v[20:23]
v_exp_f32 v71, v71
v_mfma_f32_16x16x32_bf16 v[84:87], v[232:235], a[232:235], v[84:87]
ds_read_b128 v[200:203], v1 offset:12416
v_add_f32 v11, v11, v71
v_mfma_f32_16x16x32_bf16 v[84:87], v[228:231], a[228:231], v[84:87]
v_exp_f32 v72, v72
v_mfma_f32_16x16x32_bf16 v[84:87], v[224:227], a[224:227], v[84:87]
v_cvt_pk_bf16_f32 v137, v70, v71
v_add_f32 v12, v12, v72
v_mfma_f32_16x16x32_bf16 v[84:87], v[220:223], a[220:223], v[84:87]
ds_read_b128 v[204:207], v2 offset:12416
v_mfma_f32_16x16x32_bf16 v[84:87], v[216:219], a[216:219], v[84:87]
buffer_load_dwordx4 v9, s[4:7], s56 offen offset:2048 lds
v_mfma_f32_16x16x32_bf16 v[88:91], v[216:219], a[240:243], v[24:27]
v_exp_f32 v73, v73
v_mfma_f32_16x16x32_bf16 v[88:91], v[220:223], a[244:247], v[88:91]
ds_read_b128 v[208:211], v1 offset:12544
v_add_f32 v12, v12, v73
v_mfma_f32_16x16x32_bf16 v[88:91], v[224:227], a[248:251], v[88:91]
v_exp_f32 v74, v74
v_mfma_f32_16x16x32_bf16 v[88:91], v[228:231], a[252:255], v[88:91]
v_cvt_pk_bf16_f32 v144, v72, v73
v_add_f32 v12, v12, v74
v_mfma_f32_16x16x32_bf16 v[88:91], v[232:235], v[32:35], v[88:91]
ds_read_b128 v[212:215], v2 offset:12544
v_mfma_f32_16x16x32_bf16 v[88:91], v[236:239], v[36:39], v[88:91]
v_exp_f32 v75, v75
v_mfma_f32_16x16x32_bf16 v[92:95], v[236:239], v[60:63], v[28:31]
v_add_f32 v12, v12, v75
v_cvt_pk_bf16_f32 v145, v74, v75
v_mfma_f32_16x16x32_bf16 v[92:95], v[232:235], v[56:59], v[92:95]
v_exp_f32 v76, v76
v_mfma_f32_16x16x32_bf16 v[92:95], v[228:231], v[52:55], v[92:95]
s_add_u32 m0, s68, 3072
v_add_f32 v13, v13, v76
v_mfma_f32_16x16x32_bf16 v[92:95], v[224:227], v[48:51], v[92:95]
v_mfma_f32_16x16x32_bf16 v[92:95], v[220:223], v[44:47], v[92:95]
v_exp_f32 v77, v77
v_mfma_f32_16x16x32_bf16 v[92:95], v[216:219], v[40:43], v[92:95]
s_waitcnt lgkmcnt(0)
buffer_load_dwordx4 v7, s[4:7], s57 offen lds
v_add_f32 v13, v13, v77
v_mfma_f32_16x16x32_bf16 v[96:99], v[192:195], a[192:195], v[16:19]
v_cvt_pk_bf16_f32 v152, v76, v77
v_mfma_f32_16x16x32_bf16 v[96:99], v[196:199], a[196:199], v[96:99]
ds_read_b128 v[216:219], v1 offset:18432
v_mfma_f32_16x16x32_bf16 v[96:99], v[200:203], a[200:203], v[96:99]
v_exp_f32 v78, v78
v_mfma_f32_16x16x32_bf16 v[96:99], v[204:207], a[204:207], v[96:99]
v_add_f32 v13, v13, v78
v_mfma_f32_16x16x32_bf16 v[96:99], v[208:211], a[208:211], v[96:99]
ds_read_b128 v[220:223], v2 offset:18432
v_mfma_f32_16x16x32_bf16 v[96:99], v[212:215], a[212:215], v[96:99]
v_exp_f32 v79, v79
v_mfma_f32_16x16x32_bf16 v[100:103], v[212:215], a[236:239], v[20:23]
v_exp_f32 v80, v80
v_mfma_f32_16x16x32_bf16 v[100:103], v[208:211], a[232:235], v[100:103]
ds_read_b128 v[224:227], v1 offset:18560
v_add_f32 v13, v13, v79
v_mfma_f32_16x16x32_bf16 v[100:103], v[204:207], a[228:231], v[100:103]
v_cvt_pk_bf16_f32 v153, v78, v79
v_add_f32 v10, v10, v80
v_mfma_f32_16x16x32_bf16 v[100:103], v[200:203], a[224:227], v[100:103]
v_exp_f32 v81, v81
v_mfma_f32_16x16x32_bf16 v[100:103], v[196:199], a[220:223], v[100:103]
ds_read_b128 v[228:231], v2 offset:18560
v_add_f32 v10, v10, v81
v_mfma_f32_16x16x32_bf16 v[100:103], v[192:195], a[216:219], v[100:103]
buffer_load_dwordx4 v8, s[4:7], s57 offen offset:1024 lds
v_cvt_pk_bf16_f32 v130, v80, v81
v_mfma_f32_16x16x32_bf16 v[104:107], v[192:195], a[240:243], v[24:27]
v_exp_f32 v82, v82
v_mfma_f32_16x16x32_bf16 v[104:107], v[196:199], a[244:247], v[104:107]
ds_read_b128 v[232:235], v1 offset:18688
v_add_f32 v10, v10, v82
v_mfma_f32_16x16x32_bf16 v[104:107], v[200:203], a[248:251], v[104:107]
v_mfma_f32_16x16x32_bf16 v[104:107], v[204:207], a[252:255], v[104:107]
v_exp_f32 v83, v83
v_mfma_f32_16x16x32_bf16 v[104:107], v[208:211], v[32:35], v[104:107]
ds_read_b128 v[236:239], v2 offset:18688
v_add_f32 v10, v10, v83
v_mfma_f32_16x16x32_bf16 v[104:107], v[212:215], v[36:39], v[104:107]
v_exp_f32 v84, v84
v_mfma_f32_16x16x32_bf16 v[108:111], v[212:215], v[60:63], v[28:31]
v_cvt_pk_bf16_f32 v131, v82, v83
v_add_f32 v11, v11, v84
v_mfma_f32_16x16x32_bf16 v[108:111], v[208:211], v[56:59], v[108:111]
v_mfma_f32_16x16x32_bf16 v[108:111], v[204:207], v[52:55], v[108:111]
v_exp_f32 v85, v85
v_mfma_f32_16x16x32_bf16 v[108:111], v[200:203], v[48:51], v[108:111]
v_add_f32 v11, v11, v85
v_cvt_pk_bf16_f32 v138, v84, v85
v_mfma_f32_16x16x32_bf16 v[108:111], v[196:199], v[44:47], v[108:111]
v_mfma_f32_16x16x32_bf16 v[108:111], v[192:195], v[40:43], v[108:111]
s_waitcnt lgkmcnt(0)
buffer_load_dwordx4 v9, s[4:7], s57 offen offset:2048 lds
v_mfma_f32_16x16x32_bf16 v[112:115], v[216:219], a[192:195], v[16:19]
v_exp_f32 v86, v86
v_mfma_f32_16x16x32_bf16 v[112:115], v[220:223], a[196:199], v[112:115]
ds_read_b64_tr_b16 v[192:193], v3
v_add_f32 v11, v11, v86
v_mfma_f32_16x16x32_bf16 v[112:115], v[224:227], a[200:203], v[112:115]
ds_read_b64_tr_b16 v[194:195], v3 offset:6144
v_mfma_f32_16x16x32_bf16 v[112:115], v[228:231], a[204:207], v[112:115]
v_exp_f32 v87, v87
v_mfma_f32_16x16x32_bf16 v[112:115], v[232:235], a[208:211], v[112:115]
ds_read_b64_tr_b16 v[196:197], v3 offset:12288
v_add_f32 v11, v11, v87
v_mfma_f32_16x16x32_bf16 v[112:115], v[236:239], a[212:215], v[112:115]
ds_read_b64_tr_b16 v[198:199], v3 offset:18432
v_cvt_pk_bf16_f32 v139, v86, v87
v_mfma_f32_16x16x32_bf16 v[116:119], v[236:239], a[236:239], v[20:23]
v_exp_f32 v88, v88
v_mfma_f32_16x16x32_bf16 v[116:119], v[232:235], a[232:235], v[116:119]
ds_read_b64_tr_b16 v[200:201], v4
v_add_f32 v12, v12, v88
v_mfma_f32_16x16x32_bf16 v[116:119], v[228:231], a[228:231], v[116:119]
s_add_u32 m0, s68, 73728
ds_read_b64_tr_b16 v[202:203], v4 offset:6144
v_mfma_f32_16x16x32_bf16 v[116:119], v[224:227], a[224:227], v[116:119]
v_exp_f32 v89, v89
v_mfma_f32_16x16x32_bf16 v[116:119], v[220:223], a[220:223], v[116:119]
ds_read_b64_tr_b16 v[204:205], v4 offset:12288
v_add_f32 v12, v12, v89
v_mfma_f32_16x16x32_bf16 v[116:119], v[216:219], a[216:219], v[116:119]
ds_read_b64_tr_b16 v[206:207], v4 offset:18432
buffer_load_dwordx4 v7, s[8:11], s58 offen lds
v_mfma_f32_16x16x32_bf16 v[120:123], v[216:219], a[240:243], v[24:27]
v_exp_f32 v90, v90
v_mfma_f32_16x16x32_bf16 v[120:123], v[220:223], a[244:247], v[120:123]
ds_read_b64_tr_b16 v[208:209], v5
v_cvt_pk_bf16_f32 v146, v88, v89
v_mfma_f32_16x16x32_bf16 v[120:123], v[224:227], a[248:251], v[120:123]
ds_read_b64_tr_b16 v[210:211], v5 offset:6144
v_add_f32 v12, v12, v90
v_mfma_f32_16x16x32_bf16 v[120:123], v[228:231], a[252:255], v[120:123]
v_exp_f32 v91, v91
v_mfma_f32_16x16x32_bf16 v[120:123], v[232:235], v[32:35], v[120:123]
ds_read_b64_tr_b16 v[212:213], v5 offset:12288
v_add_f32 v12, v12, v91
v_mfma_f32_16x16x32_bf16 v[120:123], v[236:239], v[36:39], v[120:123]
ds_read_b64_tr_b16 v[214:215], v5 offset:18432
v_cvt_pk_bf16_f32 v147, v90, v91
v_mfma_f32_16x16x32_bf16 v[124:127], v[236:239], v[60:63], v[28:31]
v_exp_f32 v92, v92
v_mfma_f32_16x16x32_bf16 v[124:127], v[232:235], v[56:59], v[124:127]
v_exp_f32 v93, v93
v_mfma_f32_16x16x32_bf16 v[124:127], v[228:231], v[52:55], v[124:127]
v_add_f32 v13, v13, v92
v_add_f32 v13, v13, v93
v_mfma_f32_16x16x32_bf16 v[124:127], v[224:227], v[48:51], v[124:127]
v_exp_f32 v94, v94
v_mfma_f32_16x16x32_bf16 v[124:127], v[220:223], v[44:47], v[124:127]
v_cvt_pk_bf16_f32 v154, v92, v93
v_add_f32 v13, v13, v94
v_mfma_f32_16x16x32_bf16 v[124:127], v[216:219], v[40:43], v[124:127]
s_waitcnt lgkmcnt(8)
buffer_load_dwordx4 v8, s[8:11], s58 offen offset:1024 lds
v_mfma_f32_16x16x32_bf16 a[0:3], v[192:195], v[160:163], a[0:3]
ds_read_b64_tr_b16 v[216:217], v6
v_mfma_f32_16x16x32_bf16 a[0:3], v[196:199], v[164:167], a[0:3]
v_exp_f32 v95, v95
v_mfma_f32_16x16x32_bf16 a[4:7], v[196:199], v[172:175], a[4:7]
ds_read_b64_tr_b16 v[218:219], v6 offset:6144
v_add_f32 v13, v13, v95
v_mfma_f32_16x16x32_bf16 a[4:7], v[192:195], v[168:171], a[4:7]
v_exp_f32 v96, v96
v_mfma_f32_16x16x32_bf16 a[8:11], v[192:195], v[176:179], a[8:11]
ds_read_b64_tr_b16 v[220:221], v6 offset:12288
v_cvt_pk_bf16_f32 v155, v94, v95
v_mfma_f32_16x16x32_bf16 a[8:11], v[196:199], v[180:183], a[8:11]
v_exp_f32 v97, v97
v_mfma_f32_16x16x32_bf16 a[12:15], v[196:199], v[188:191], a[12:15]
ds_read_b64_tr_b16 v[222:223], v6 offset:18432
v_add_f32 v10, v10, v96
v_mfma_f32_16x16x32_bf16 a[12:15], v[192:195], v[184:187], a[12:15]
s_waitcnt lgkmcnt(8)
v_add_f32 v10, v10, v97
v_cvt_pk_bf16_f32 v132, v96, v97
v_mfma_f32_16x16x32_bf16 a[16:19], v[200:203], v[160:163], a[16:19]
ds_read_b64_tr_b16 v[224:225], v3 offset:128
v_mfma_f32_16x16x32_bf16 a[16:19], v[204:207], v[164:167], a[16:19]
v_exp_f32 v98, v98
v_mfma_f32_16x16x32_bf16 a[20:23], v[204:207], v[172:175], a[20:23]
ds_read_b64_tr_b16 v[226:227], v3 offset:6272
v_add_u32 v1, 24576, v1
v_mfma_f32_16x16x32_bf16 a[20:23], v[200:203], v[168:171], a[20:23]
buffer_load_dwordx4 v9, s[8:11], s58 offen offset:2048 lds
v_add_f32 v10, v10, v98
v_mfma_f32_16x16x32_bf16 a[24:27], v[200:203], v[176:179], a[24:27]
ds_read_b64_tr_b16 v[228:229], v3 offset:12416
v_add_u32 v2, 24576, v2
v_mfma_f32_16x16x32_bf16 a[24:27], v[204:207], v[180:183], a[24:27]
v_exp_f32 v99, v99
v_mfma_f32_16x16x32_bf16 a[28:31], v[204:207], v[188:191], a[28:31]
ds_read_b64_tr_b16 v[230:231], v3 offset:18560
v_add_f32 v10, v10, v99
v_mfma_f32_16x16x32_bf16 a[28:31], v[200:203], v[184:187], a[28:31]
s_waitcnt lgkmcnt(8)
v_exp_f32 v100, v100
v_mfma_f32_16x16x32_bf16 a[32:35], v[208:211], v[160:163], a[32:35]
ds_read_b64_tr_b16 v[232:233], v4 offset:128
v_cvt_pk_bf16_f32 v133, v98, v99
v_mfma_f32_16x16x32_bf16 a[32:35], v[212:215], v[164:167], a[32:35]
v_exp_f32 v101, v101
v_mfma_f32_16x16x32_bf16 a[36:39], v[212:215], v[172:175], a[36:39]
ds_read_b64_tr_b16 v[234:235], v4 offset:6272
v_add_f32 v11, v11, v100
v_mfma_f32_16x16x32_bf16 a[36:39], v[208:211], v[168:171], a[36:39]
v_exp_f32 v102, v102
v_mfma_f32_16x16x32_bf16 a[40:43], v[208:211], v[176:179], a[40:43]
s_add_u32 m0, s68, 76800
ds_read_b64_tr_b16 v[236:237], v4 offset:12416
v_add_f32 v11, v11, v101
v_mfma_f32_16x16x32_bf16 a[40:43], v[212:215], v[180:183], a[40:43]
v_cvt_pk_bf16_f32 v140, v100, v101
v_add_f32 v11, v11, v102
v_mfma_f32_16x16x32_bf16 a[44:47], v[212:215], v[188:191], a[44:47]
ds_read_b64_tr_b16 v[238:239], v4 offset:18560
v_mfma_f32_16x16x32_bf16 a[44:47], v[208:211], v[184:187], a[44:47]
s_waitcnt lgkmcnt(8)
buffer_load_dwordx4 v7, s[8:11], s59 offen lds
v_mfma_f32_16x16x32_bf16 a[48:51], v[216:219], v[160:163], a[48:51]
ds_read_b64_tr_b16 v[192:193], v5 offset:128
v_mfma_f32_16x16x32_bf16 a[48:51], v[220:223], v[164:167], a[48:51]
v_exp_f32 v103, v103
v_mfma_f32_16x16x32_bf16 a[52:55], v[220:223], v[172:175], a[52:55]
ds_read_b64_tr_b16 v[194:195], v5 offset:6272
v_add_f32 v11, v11, v103
v_mfma_f32_16x16x32_bf16 a[52:55], v[216:219], v[168:171], a[52:55]
v_exp_f32 v104, v104
v_mfma_f32_16x16x32_bf16 a[56:59], v[216:219], v[176:179], a[56:59]
ds_read_b64_tr_b16 v[196:197], v5 offset:12416
v_cvt_pk_bf16_f32 v141, v102, v103
v_mfma_f32_16x16x32_bf16 a[56:59], v[220:223], v[180:183], a[56:59]
v_exp_f32 v105, v105
v_mfma_f32_16x16x32_bf16 a[60:63], v[220:223], v[188:191], a[60:63]
ds_read_b64_tr_b16 v[198:199], v5 offset:18560
v_add_f32 v12, v12, v104
v_mfma_f32_16x16x32_bf16 a[60:63], v[216:219], v[184:187], a[60:63]
s_waitcnt lgkmcnt(8)
v_exp_f32 v106, v106
v_mfma_f32_16x16x32_bf16 a[64:67], v[224:227], v[160:163], a[64:67]
ds_read_b64_tr_b16 v[200:201], v6 offset:128
v_add_f32 v12, v12, v105
v_mfma_f32_16x16x32_bf16 a[64:67], v[228:231], v[164:167], a[64:67]
v_exp_f32 v107, v107
v_mfma_f32_16x16x32_bf16 a[68:71], v[228:231], v[172:175], a[68:71]
ds_read_b64_tr_b16 v[202:203], v6 offset:6272
v_cvt_pk_bf16_f32 v148, v104, v105
v_mfma_f32_16x16x32_bf16 a[68:71], v[224:227], v[168:171], a[68:71]
buffer_load_dwordx4 v8, s[8:11], s59 offen offset:1024 lds
v_add_f32 v12, v12, v106
v_mfma_f32_16x16x32_bf16 a[72:75], v[224:227], v[176:179], a[72:75]
ds_read_b64_tr_b16 v[204:205], v6 offset:12416
v_add_f32 v12, v12, v107
v_mfma_f32_16x16x32_bf16 a[72:75], v[228:231], v[180:183], a[72:75]
v_exp_f32 v108, v108
v_mfma_f32_16x16x32_bf16 a[76:79], v[228:231], v[188:191], a[76:79]
ds_read_b64_tr_b16 v[206:207], v6 offset:18560
v_cvt_pk_bf16_f32 v149, v106, v107
v_mfma_f32_16x16x32_bf16 a[76:79], v[224:227], v[184:187], a[76:79]
s_waitcnt lgkmcnt(8)
v_exp_f32 v109, v109
v_mfma_f32_16x16x32_bf16 a[80:83], v[232:235], v[160:163], a[80:83]
ds_read_b64_tr_b16 v[208:209], v3 offset:256
v_add_f32 v13, v13, v108
v_mfma_f32_16x16x32_bf16 a[80:83], v[236:239], v[164:167], a[80:83]
v_exp_f32 v110, v110
v_mfma_f32_16x16x32_bf16 a[84:87], v[236:239], v[172:175], a[84:87]
ds_read_b64_tr_b16 v[210:211], v3 offset:6400
v_add_f32 v13, v13, v109
v_mfma_f32_16x16x32_bf16 a[84:87], v[232:235], v[168:171], a[84:87]
v_cvt_pk_bf16_f32 v156, v108, v109
v_add_f32 v13, v13, v110
v_mfma_f32_16x16x32_bf16 a[88:91], v[232:235], v[176:179], a[88:91]
ds_read_b64_tr_b16 v[212:213], v3 offset:12544
v_mfma_f32_16x16x32_bf16 a[88:91], v[236:239], v[180:183], a[88:91]
v_exp_f32 v111, v111
v_mfma_f32_16x16x32_bf16 a[92:95], v[236:239], v[188:191], a[92:95]
ds_read_b64_tr_b16 v[214:215], v3 offset:18688
v_add_f32 v13, v13, v111
v_mfma_f32_16x16x32_bf16 a[92:95], v[232:235], v[184:187], a[92:95]
s_waitcnt lgkmcnt(8)
buffer_load_dwordx4 v9, s[8:11], s59 offen offset:2048 lds
v_cvt_pk_bf16_f32 v157, v110, v111
v_mfma_f32_16x16x32_bf16 a[96:99], v[192:195], v[160:163], a[96:99]
ds_read_b64_tr_b16 v[216:217], v4 offset:256
v_mfma_f32_16x16x32_bf16 a[96:99], v[196:199], v[164:167], a[96:99]
v_exp_f32 v112, v112
v_mfma_f32_16x16x32_bf16 a[100:103], v[196:199], v[172:175], a[100:103]
ds_read_b64_tr_b16 v[218:219], v4 offset:6400
v_add_f32 v10, v10, v112
v_mfma_f32_16x16x32_bf16 a[100:103], v[192:195], v[168:171], a[100:103]
v_exp_f32 v113, v113
v_mfma_f32_16x16x32_bf16 a[104:107], v[192:195], v[176:179], a[104:107]
ds_read_b64_tr_b16 v[220:221], v4 offset:12544
v_add_f32 v10, v10, v113
v_mfma_f32_16x16x32_bf16 a[104:107], v[196:199], v[180:183], a[104:107]
v_exp_f32 v114, v114
v_mfma_f32_16x16x32_bf16 a[108:111], v[196:199], v[188:191], a[108:111]
ds_read_b64_tr_b16 v[222:223], v4 offset:18688
v_cvt_pk_bf16_f32 v134, v112, v113
v_mfma_f32_16x16x32_bf16 a[108:111], v[192:195], v[184:187], a[108:111]
s_waitcnt lgkmcnt(8)
v_exp_f32 v115, v115
v_mfma_f32_16x16x32_bf16 a[112:115], v[200:203], v[160:163], a[112:115]
s_add_u32 s56, s56, 24576
ds_read_b64_tr_b16 v[224:225], v5 offset:256
v_add_f32 v10, v10, v114
v_mfma_f32_16x16x32_bf16 a[112:115], v[204:207], v[164:167], a[112:115]
v_exp_f32 v116, v116
v_mfma_f32_16x16x32_bf16 a[116:119], v[204:207], v[172:175], a[116:119]
ds_read_b64_tr_b16 v[226:227], v5 offset:6400
v_add_f32 v10, v10, v115
v_mfma_f32_16x16x32_bf16 a[116:119], v[200:203], v[168:171], a[116:119]
v_cvt_pk_bf16_f32 v135, v114, v115
v_add_f32 v11, v11, v116
v_mfma_f32_16x16x32_bf16 a[120:123], v[200:203], v[176:179], a[120:123]
s_cmp_eq_u32 s63, 0
s_cselect_b32 s24, s26, s27
ds_read_b64_tr_b16 v[228:229], v5 offset:12544
v_mfma_f32_16x16x32_bf16 a[120:123], v[204:207], v[180:183], a[120:123]
v_exp_f32 v117, v117
v_mfma_f32_16x16x32_bf16 a[124:127], v[204:207], v[188:191], a[124:127]
ds_read_b64_tr_b16 v[230:231], v5 offset:18688
v_add_f32 v11, v11, v117
v_mfma_f32_16x16x32_bf16 a[124:127], v[200:203], v[184:187], a[124:127]
s_waitcnt lgkmcnt(8)
v_exp_f32 v118, v118
v_mfma_f32_16x16x32_bf16 a[128:131], v[208:211], v[160:163], a[128:131]
ds_read_b64_tr_b16 v[232:233], v6 offset:256
v_cvt_pk_bf16_f32 v142, v116, v117
v_mfma_f32_16x16x32_bf16 a[128:131], v[212:215], v[164:167], a[128:131]
v_add_f32 v11, v11, v118
v_mfma_f32_16x16x32_bf16 a[132:135], v[212:215], v[172:175], a[132:135]
ds_read_b64_tr_b16 v[234:235], v6 offset:6400
v_mfma_f32_16x16x32_bf16 a[132:135], v[208:211], v[168:171], a[132:135]
v_exp_f32 v119, v119
v_mfma_f32_16x16x32_bf16 a[136:139], v[208:211], v[176:179], a[136:139]
ds_read_b64_tr_b16 v[236:237], v6 offset:12544
v_add_f32 v11, v11, v119
v_mfma_f32_16x16x32_bf16 a[136:139], v[212:215], v[180:183], a[136:139]
v_exp_f32 v120, v120
v_mfma_f32_16x16x32_bf16 a[140:143], v[212:215], v[188:191], a[140:143]
ds_read_b64_tr_b16 v[238:239], v6 offset:18688
v_cvt_pk_bf16_f32 v143, v118, v119
v_mfma_f32_16x16x32_bf16 a[140:143], v[208:211], v[184:187], a[140:143]
s_waitcnt lgkmcnt(8)
v_exp_f32 v121, v121
v_mfma_f32_16x16x32_bf16 a[144:147], v[216:219], v[160:163], a[144:147]
v_add_f32 v12, v12, v120
v_add_f32 v12, v12, v121
v_mfma_f32_16x16x32_bf16 a[144:147], v[220:223], v[164:167], a[144:147]
v_cvt_pk_bf16_f32 v150, v120, v121
v_mfma_f32_16x16x32_bf16 a[148:151], v[220:223], v[172:175], a[148:151]
v_exp_f32 v122, v122
v_mfma_f32_16x16x32_bf16 a[148:151], v[216:219], v[168:171], a[148:151]
v_add_f32 v12, v12, v122
v_mfma_f32_16x16x32_bf16 a[152:155], v[216:219], v[176:179], a[152:155]
v_mfma_f32_16x16x32_bf16 a[152:155], v[220:223], v[180:183], a[152:155]
v_exp_f32 v123, v123
v_mfma_f32_16x16x32_bf16 a[156:159], v[220:223], v[188:191], a[156:159]
v_add_f32 v12, v12, v123
v_cvt_pk_bf16_f32 v151, v122, v123
v_mfma_f32_16x16x32_bf16 a[156:159], v[216:219], v[184:187], a[156:159]
s_waitcnt lgkmcnt(4)
v_exp_f32 v124, v124
v_mfma_f32_16x16x32_bf16 a[160:163], v[224:227], v[160:163], a[160:163]
s_waitcnt vmcnt(12) lgkmcnt(0)
s_barrier
v_add_f32 v13, v13, v124
v_mfma_f32_16x16x32_bf16 a[160:163], v[228:231], v[164:167], a[160:163]
ds_read_b128 v[192:195], v1
v_mfma_f32_16x16x32_bf16 a[164:167], v[228:231], v[172:175], a[164:167]
v_add_u32 v3, 24576, v3
v_mfma_f32_16x16x32_bf16 a[164:167], v[224:227], v[168:171], a[164:167]
buffer_load_dword v254, v251, s[40:43], s24 offen
ds_read_b128 v[196:199], v2
v_mfma_f32_16x16x32_bf16 a[168:171], v[224:227], v[176:179], a[168:171]
v_add_u32 v4, 24576, v4
v_mfma_f32_16x16x32_bf16 a[168:171], v[228:231], v[180:183], a[168:171]
ds_read_b128 v[200:203], v1 offset:128
v_mfma_f32_16x16x32_bf16 a[172:175], v[228:231], v[188:191], a[172:175]
v_add_u32 v5, 24576, v5
v_mfma_f32_16x16x32_bf16 a[172:175], v[224:227], v[184:187], a[172:175]
s_waitcnt lgkmcnt(3)
ds_read_b128 v[204:207], v2 offset:128
v_mfma_f32_16x16x32_bf16 a[176:179], v[232:235], v[160:163], a[176:179]
v_add_u32 v6, 24576, v6
v_mfma_f32_16x16x32_bf16 a[176:179], v[236:239], v[164:167], a[176:179]
ds_read_b128 v[208:211], v1 offset:256
v_mfma_f32_16x16x32_bf16 a[180:183], v[236:239], v[172:175], a[180:183]
v_exp_f32 v125, v125
v_mfma_f32_16x16x32_bf16 a[180:183], v[232:235], v[168:171], a[180:183]
ds_read_b128 v[212:215], v2 offset:256
v_add_f32 v13, v13, v125
v_mfma_f32_16x16x32_bf16 a[184:187], v[232:235], v[176:179], a[184:187]
v_exp_f32 v126, v126
v_mfma_f32_16x16x32_bf16 a[184:187], v[236:239], v[180:183], a[184:187]
v_exp_f32 v127, v127
v_mfma_f32_16x16x32_bf16 a[188:191], v[236:239], v[188:191], a[188:191]
v_cvt_pk_bf16_f32 v158, v124, v125
v_add_f32 v13, v13, v126
v_mfma_f32_16x16x32_bf16 a[188:191], v[232:235], v[184:187], a[188:191]
s_waitcnt lgkmcnt(4)
v_add_f32 v13, v13, v127
v_cvt_pk_bf16_f32 v159, v126, v127
v_mfma_f32_16x16x32_bf16 v[64:67], v[192:195], a[192:195], v[16:19]
v_mfma_f32_16x16x32_bf16 v[64:67], v[196:199], a[196:199], v[64:67]
s_waitcnt lgkmcnt(2)
ds_read_b128 v[216:219], v1 offset:6144
v_mfma_f32_16x16x32_bf16 v[64:67], v[200:203], a[200:203], v[64:67]
s_add_u32 s57, s56, 3072
v_mfma_f32_16x16x32_bf16 v[64:67], v[204:207], a[204:207], v[64:67]
s_waitcnt lgkmcnt(1)
v_mfma_f32_16x16x32_bf16 v[64:67], v[208:211], a[208:211], v[64:67]
s_sub_u32 s58, s56, 24576
ds_read_b128 v[220:223], v2 offset:6144
v_mfma_f32_16x16x32_bf16 v[64:67], v[212:215], a[212:215], v[64:67]
s_sub_u32 s59, s56, 21504
v_mfma_f32_16x16x32_bf16 v[68:71], v[212:215], a[236:239], v[20:23]
v_mfma_f32_16x16x32_bf16 v[68:71], v[208:211], a[232:235], v[68:71]
ds_read_b128 v[224:227], v1 offset:6272
v_mfma_f32_16x16x32_bf16 v[68:71], v[204:207], a[228:231], v[68:71]
s_add_u32 m0, s68, 24576
v_mfma_f32_16x16x32_bf16 v[68:71], v[200:203], a[224:227], v[68:71]
v_mfma_f32_16x16x32_bf16 v[68:71], v[196:199], a[220:223], v[68:71]
ds_read_b128 v[228:231], v2 offset:6272
v_mfma_f32_16x16x32_bf16 v[68:71], v[192:195], a[216:219], v[68:71]
buffer_load_dwordx4 v7, s[4:7], s56 offen lds
v_mfma_f32_16x16x32_bf16 v[72:75], v[192:195], a[240:243], v[24:27]
v_exp_f32 v64, v64
v_mfma_f32_16x16x32_bf16 v[72:75], v[196:199], a[244:247], v[72:75]
ds_read_b128 v[232:235], v1 offset:6400
v_add_f32 v10, v10, v64
v_mfma_f32_16x16x32_bf16 v[72:75], v[200:203], a[248:251], v[72:75]
v_exp_f32 v65, v65
v_mfma_f32_16x16x32_bf16 v[72:75], v[204:207], a[252:255], v[72:75]
v_add_f32 v10, v10, v65
v_cvt_pk_bf16_f32 v160, v64, v65
v_mfma_f32_16x16x32_bf16 v[72:75], v[208:211], v[32:35], v[72:75]
ds_read_b128 v[236:239], v2 offset:6400
v_mfma_f32_16x16x32_bf16 v[72:75], v[212:215], v[36:39], v[72:75]
v_exp_f32 v66, v66
v_mfma_f32_16x16x32_bf16 v[76:79], v[212:215], v[60:63], v[28:31]
v_add_f32 v10, v10, v66
v_mfma_f32_16x16x32_bf16 v[76:79], v[208:211], v[56:59], v[76:79]
v_exp_f32 v67, v67
v_mfma_f32_16x16x32_bf16 v[76:79], v[204:207], v[52:55], v[76:79]
v_add_f32 v10, v10, v67
v_cvt_pk_bf16_f32 v161, v66, v67
v_mfma_f32_16x16x32_bf16 v[76:79], v[200:203], v[48:51], v[76:79]
v_exp_f32 v68, v68
v_mfma_f32_16x16x32_bf16 v[76:79], v[196:199], v[44:47], v[76:79]
v_add_f32 v11, v11, v68
v_mfma_f32_16x16x32_bf16 v[76:79], v[192:195], v[40:43], v[76:79]
s_waitcnt lgkmcnt(0)
buffer_load_dwordx4 v8, s[4:7], s56 offen offset:1024 lds
v_mfma_f32_16x16x32_bf16 v[80:83], v[216:219], a[192:195], v[16:19]
v_exp_f32 v69, v69
v_mfma_f32_16x16x32_bf16 v[80:83], v[220:223], a[196:199], v[80:83]
ds_read_b128 v[192:195], v1 offset:12288
v_add_f32 v11, v11, v69
v_mfma_f32_16x16x32_bf16 v[80:83], v[224:227], a[200:203], v[80:83]
v_cvt_pk_bf16_f32 v168, v68, v69
v_mfma_f32_16x16x32_bf16 v[80:83], v[228:231], a[204:207], v[80:83]
v_exp_f32 v70, v70
v_mfma_f32_16x16x32_bf16 v[80:83], v[232:235], a[208:211], v[80:83]
ds_read_b128 v[196:199], v2 offset:12288
v_add_f32 v11, v11, v70
v_mfma_f32_16x16x32_bf16 v[80:83], v[236:239], a[212:215], v[80:83]
v_mfma_f32_16x16x32_bf16 v[84:87], v[236:239], a[236:239], v[20:23]
v_exp_f32 v71, v71
v_mfma_f32_16x16x32_bf16 v[84:87], v[232:235], a[232:235], v[84:87]
ds_read_b128 v[200:203], v1 offset:12416
v_add_f32 v11, v11, v71
v_mfma_f32_16x16x32_bf16 v[84:87], v[228:231], a[228:231], v[84:87]
v_exp_f32 v72, v72
v_mfma_f32_16x16x32_bf16 v[84:87], v[224:227], a[224:227], v[84:87]
v_cvt_pk_bf16_f32 v169, v70, v71
v_add_f32 v12, v12, v72
v_mfma_f32_16x16x32_bf16 v[84:87], v[220:223], a[220:223], v[84:87]
ds_read_b128 v[204:207], v2 offset:12416
v_mfma_f32_16x16x32_bf16 v[84:87], v[216:219], a[216:219], v[84:87]
buffer_load_dwordx4 v9, s[4:7], s56 offen offset:2048 lds
v_mfma_f32_16x16x32_bf16 v[88:91], v[216:219], a[240:243], v[24:27]
v_exp_f32 v73, v73
v_mfma_f32_16x16x32_bf16 v[88:91], v[220:223], a[244:247], v[88:91]
ds_read_b128 v[208:211], v1 offset:12544
v_add_f32 v12, v12, v73
v_mfma_f32_16x16x32_bf16 v[88:91], v[224:227], a[248:251], v[88:91]
v_exp_f32 v74, v74
v_mfma_f32_16x16x32_bf16 v[88:91], v[228:231], a[252:255], v[88:91]
v_cvt_pk_bf16_f32 v176, v72, v73
v_add_f32 v12, v12, v74
v_mfma_f32_16x16x32_bf16 v[88:91], v[232:235], v[32:35], v[88:91]
ds_read_b128 v[212:215], v2 offset:12544
v_mfma_f32_16x16x32_bf16 v[88:91], v[236:239], v[36:39], v[88:91]
v_exp_f32 v75, v75
v_mfma_f32_16x16x32_bf16 v[92:95], v[236:239], v[60:63], v[28:31]
v_add_f32 v12, v12, v75
v_cvt_pk_bf16_f32 v177, v74, v75
v_mfma_f32_16x16x32_bf16 v[92:95], v[232:235], v[56:59], v[92:95]
v_exp_f32 v76, v76
v_mfma_f32_16x16x32_bf16 v[92:95], v[228:231], v[52:55], v[92:95]
s_add_u32 m0, s68, 27648
v_add_f32 v13, v13, v76
v_mfma_f32_16x16x32_bf16 v[92:95], v[224:227], v[48:51], v[92:95]
v_mfma_f32_16x16x32_bf16 v[92:95], v[220:223], v[44:47], v[92:95]
v_exp_f32 v77, v77
v_mfma_f32_16x16x32_bf16 v[92:95], v[216:219], v[40:43], v[92:95]
s_waitcnt lgkmcnt(0)
buffer_load_dwordx4 v7, s[4:7], s57 offen lds
v_add_f32 v13, v13, v77
v_mfma_f32_16x16x32_bf16 v[96:99], v[192:195], a[192:195], v[16:19]
v_cvt_pk_bf16_f32 v184, v76, v77
v_mfma_f32_16x16x32_bf16 v[96:99], v[196:199], a[196:199], v[96:99]
ds_read_b128 v[216:219], v1 offset:18432
v_mfma_f32_16x16x32_bf16 v[96:99], v[200:203], a[200:203], v[96:99]
v_exp_f32 v78, v78
v_mfma_f32_16x16x32_bf16 v[96:99], v[204:207], a[204:207], v[96:99]
v_add_f32 v13, v13, v78
v_mfma_f32_16x16x32_bf16 v[96:99], v[208:211], a[208:211], v[96:99]
ds_read_b128 v[220:223], v2 offset:18432
v_mfma_f32_16x16x32_bf16 v[96:99], v[212:215], a[212:215], v[96:99]
v_exp_f32 v79, v79
v_mfma_f32_16x16x32_bf16 v[100:103], v[212:215], a[236:239], v[20:23]
v_exp_f32 v80, v80
v_mfma_f32_16x16x32_bf16 v[100:103], v[208:211], a[232:235], v[100:103]
ds_read_b128 v[224:227], v1 offset:18560
v_add_f32 v13, v13, v79
v_mfma_f32_16x16x32_bf16 v[100:103], v[204:207], a[228:231], v[100:103]
v_cvt_pk_bf16_f32 v185, v78, v79
v_add_f32 v10, v10, v80
v_mfma_f32_16x16x32_bf16 v[100:103], v[200:203], a[224:227], v[100:103]
v_exp_f32 v81, v81
v_mfma_f32_16x16x32_bf16 v[100:103], v[196:199], a[220:223], v[100:103]
ds_read_b128 v[228:231], v2 offset:18560
v_add_f32 v10, v10, v81
v_mfma_f32_16x16x32_bf16 v[100:103], v[192:195], a[216:219], v[100:103]
buffer_load_dwordx4 v8, s[4:7], s57 offen offset:1024 lds
v_cvt_pk_bf16_f32 v162, v80, v81
v_mfma_f32_16x16x32_bf16 v[104:107], v[192:195], a[240:243], v[24:27]
v_exp_f32 v82, v82
v_mfma_f32_16x16x32_bf16 v[104:107], v[196:199], a[244:247], v[104:107]
ds_read_b128 v[232:235], v1 offset:18688
v_add_f32 v10, v10, v82
v_mfma_f32_16x16x32_bf16 v[104:107], v[200:203], a[248:251], v[104:107]
v_mfma_f32_16x16x32_bf16 v[104:107], v[204:207], a[252:255], v[104:107]
v_exp_f32 v83, v83
v_mfma_f32_16x16x32_bf16 v[104:107], v[208:211], v[32:35], v[104:107]
ds_read_b128 v[236:239], v2 offset:18688
v_add_f32 v10, v10, v83
v_mfma_f32_16x16x32_bf16 v[104:107], v[212:215], v[36:39], v[104:107]
v_exp_f32 v84, v84
v_mfma_f32_16x16x32_bf16 v[108:111], v[212:215], v[60:63], v[28:31]
v_cvt_pk_bf16_f32 v163, v82, v83
v_add_f32 v11, v11, v84
v_mfma_f32_16x16x32_bf16 v[108:111], v[208:211], v[56:59], v[108:111]
v_mfma_f32_16x16x32_bf16 v[108:111], v[204:207], v[52:55], v[108:111]
v_exp_f32 v85, v85
v_mfma_f32_16x16x32_bf16 v[108:111], v[200:203], v[48:51], v[108:111]
v_add_f32 v11, v11, v85
v_cvt_pk_bf16_f32 v170, v84, v85
v_mfma_f32_16x16x32_bf16 v[108:111], v[196:199], v[44:47], v[108:111]
v_mfma_f32_16x16x32_bf16 v[108:111], v[192:195], v[40:43], v[108:111]
s_waitcnt lgkmcnt(0)
buffer_load_dwordx4 v9, s[4:7], s57 offen offset:2048 lds
v_mfma_f32_16x16x32_bf16 v[112:115], v[216:219], a[192:195], v[16:19]
v_exp_f32 v86, v86
v_mfma_f32_16x16x32_bf16 v[112:115], v[220:223], a[196:199], v[112:115]
ds_read_b64_tr_b16 v[192:193], v3
v_add_f32 v11, v11, v86
v_mfma_f32_16x16x32_bf16 v[112:115], v[224:227], a[200:203], v[112:115]
ds_read_b64_tr_b16 v[194:195], v3 offset:6144
v_mfma_f32_16x16x32_bf16 v[112:115], v[228:231], a[204:207], v[112:115]
v_exp_f32 v87, v87
v_mfma_f32_16x16x32_bf16 v[112:115], v[232:235], a[208:211], v[112:115]
ds_read_b64_tr_b16 v[196:197], v3 offset:12288
v_add_f32 v11, v11, v87
v_mfma_f32_16x16x32_bf16 v[112:115], v[236:239], a[212:215], v[112:115]
ds_read_b64_tr_b16 v[198:199], v3 offset:18432
v_cvt_pk_bf16_f32 v171, v86, v87
v_mfma_f32_16x16x32_bf16 v[116:119], v[236:239], a[236:239], v[20:23]
v_exp_f32 v88, v88
v_mfma_f32_16x16x32_bf16 v[116:119], v[232:235], a[232:235], v[116:119]
ds_read_b64_tr_b16 v[200:201], v4
v_add_f32 v12, v12, v88
v_mfma_f32_16x16x32_bf16 v[116:119], v[228:231], a[228:231], v[116:119]
s_add_u32 m0, s68, 98304
ds_read_b64_tr_b16 v[202:203], v4 offset:6144
v_mfma_f32_16x16x32_bf16 v[116:119], v[224:227], a[224:227], v[116:119]
v_exp_f32 v89, v89
v_mfma_f32_16x16x32_bf16 v[116:119], v[220:223], a[220:223], v[116:119]
ds_read_b64_tr_b16 v[204:205], v4 offset:12288
v_add_f32 v12, v12, v89
v_mfma_f32_16x16x32_bf16 v[116:119], v[216:219], a[216:219], v[116:119]
ds_read_b64_tr_b16 v[206:207], v4 offset:18432
buffer_load_dwordx4 v7, s[8:11], s58 offen lds
v_mfma_f32_16x16x32_bf16 v[120:123], v[216:219], a[240:243], v[24:27]
v_exp_f32 v90, v90
v_mfma_f32_16x16x32_bf16 v[120:123], v[220:223], a[244:247], v[120:123]
ds_read_b64_tr_b16 v[208:209], v5
v_cvt_pk_bf16_f32 v178, v88, v89
v_mfma_f32_16x16x32_bf16 v[120:123], v[224:227], a[248:251], v[120:123]
ds_read_b64_tr_b16 v[210:211], v5 offset:6144
v_add_f32 v12, v12, v90
v_mfma_f32_16x16x32_bf16 v[120:123], v[228:231], a[252:255], v[120:123]
v_exp_f32 v91, v91
v_mfma_f32_16x16x32_bf16 v[120:123], v[232:235], v[32:35], v[120:123]
ds_read_b64_tr_b16 v[212:213], v5 offset:12288
v_add_f32 v12, v12, v91
v_mfma_f32_16x16x32_bf16 v[120:123], v[236:239], v[36:39], v[120:123]
ds_read_b64_tr_b16 v[214:215], v5 offset:18432
v_cvt_pk_bf16_f32 v179, v90, v91
v_mfma_f32_16x16x32_bf16 v[124:127], v[236:239], v[60:63], v[28:31]
v_exp_f32 v92, v92
v_mfma_f32_16x16x32_bf16 v[124:127], v[232:235], v[56:59], v[124:127]
v_exp_f32 v93, v93
v_mfma_f32_16x16x32_bf16 v[124:127], v[228:231], v[52:55], v[124:127]
v_add_f32 v13, v13, v92
v_add_f32 v13, v13, v93
v_mfma_f32_16x16x32_bf16 v[124:127], v[224:227], v[48:51], v[124:127]
v_exp_f32 v94, v94
v_mfma_f32_16x16x32_bf16 v[124:127], v[220:223], v[44:47], v[124:127]
v_cvt_pk_bf16_f32 v186, v92, v93
v_add_f32 v13, v13, v94
v_mfma_f32_16x16x32_bf16 v[124:127], v[216:219], v[40:43], v[124:127]
s_waitcnt lgkmcnt(8)
buffer_load_dwordx4 v8, s[8:11], s58 offen offset:1024 lds
v_mfma_f32_16x16x32_bf16 a[0:3], v[192:195], v[128:131], a[0:3]
ds_read_b64_tr_b16 v[216:217], v6
v_mfma_f32_16x16x32_bf16 a[0:3], v[196:199], v[132:135], a[0:3]
v_exp_f32 v95, v95
v_mfma_f32_16x16x32_bf16 a[4:7], v[196:199], v[140:143], a[4:7]
ds_read_b64_tr_b16 v[218:219], v6 offset:6144
v_add_f32 v13, v13, v95
v_mfma_f32_16x16x32_bf16 a[4:7], v[192:195], v[136:139], a[4:7]
v_exp_f32 v96, v96
v_mfma_f32_16x16x32_bf16 a[8:11], v[192:195], v[144:147], a[8:11]
ds_read_b64_tr_b16 v[220:221], v6 offset:12288
v_cvt_pk_bf16_f32 v187, v94, v95
v_mfma_f32_16x16x32_bf16 a[8:11], v[196:199], v[148:151], a[8:11]
v_exp_f32 v97, v97
v_mfma_f32_16x16x32_bf16 a[12:15], v[196:199], v[156:159], a[12:15]
ds_read_b64_tr_b16 v[222:223], v6 offset:18432
v_add_f32 v10, v10, v96
v_mfma_f32_16x16x32_bf16 a[12:15], v[192:195], v[152:155], a[12:15]
s_waitcnt lgkmcnt(8)
v_add_f32 v10, v10, v97
v_cvt_pk_bf16_f32 v164, v96, v97
v_mfma_f32_16x16x32_bf16 a[16:19], v[200:203], v[128:131], a[16:19]
ds_read_b64_tr_b16 v[224:225], v3 offset:128
v_mfma_f32_16x16x32_bf16 a[16:19], v[204:207], v[132:135], a[16:19]
v_exp_f32 v98, v98
v_mfma_f32_16x16x32_bf16 a[20:23], v[204:207], v[140:143], a[20:23]
ds_read_b64_tr_b16 v[226:227], v3 offset:6272
v_add_u32 v1, 4294918144, v1
v_mfma_f32_16x16x32_bf16 a[20:23], v[200:203], v[136:139], a[20:23]
buffer_load_dwordx4 v9, s[8:11], s58 offen offset:2048 lds
v_add_f32 v10, v10, v98
v_mfma_f32_16x16x32_bf16 a[24:27], v[200:203], v[144:147], a[24:27]
ds_read_b64_tr_b16 v[228:229], v3 offset:12416
v_add_u32 v2, 4294918144, v2
v_mfma_f32_16x16x32_bf16 a[24:27], v[204:207], v[148:151], a[24:27]
v_exp_f32 v99, v99
v_mfma_f32_16x16x32_bf16 a[28:31], v[204:207], v[156:159], a[28:31]
ds_read_b64_tr_b16 v[230:231], v3 offset:18560
v_add_f32 v10, v10, v99
v_mfma_f32_16x16x32_bf16 a[28:31], v[200:203], v[152:155], a[28:31]
s_waitcnt lgkmcnt(8)
v_exp_f32 v100, v100
v_mfma_f32_16x16x32_bf16 a[32:35], v[208:211], v[128:131], a[32:35]
ds_read_b64_tr_b16 v[232:233], v4 offset:128
v_cvt_pk_bf16_f32 v165, v98, v99
v_mfma_f32_16x16x32_bf16 a[32:35], v[212:215], v[132:135], a[32:35]
v_exp_f32 v101, v101
v_mfma_f32_16x16x32_bf16 a[36:39], v[212:215], v[140:143], a[36:39]
ds_read_b64_tr_b16 v[234:235], v4 offset:6272
v_add_f32 v11, v11, v100
v_mfma_f32_16x16x32_bf16 a[36:39], v[208:211], v[136:139], a[36:39]
v_exp_f32 v102, v102
v_mfma_f32_16x16x32_bf16 a[40:43], v[208:211], v[144:147], a[40:43]
s_add_u32 m0, s68, 101376
ds_read_b64_tr_b16 v[236:237], v4 offset:12416
v_add_f32 v11, v11, v101
v_mfma_f32_16x16x32_bf16 a[40:43], v[212:215], v[148:151], a[40:43]
v_cvt_pk_bf16_f32 v172, v100, v101
v_add_f32 v11, v11, v102
v_mfma_f32_16x16x32_bf16 a[44:47], v[212:215], v[156:159], a[44:47]
ds_read_b64_tr_b16 v[238:239], v4 offset:18560
v_mfma_f32_16x16x32_bf16 a[44:47], v[208:211], v[152:155], a[44:47]
s_waitcnt lgkmcnt(8)
buffer_load_dwordx4 v7, s[8:11], s59 offen lds
v_mfma_f32_16x16x32_bf16 a[48:51], v[216:219], v[128:131], a[48:51]
ds_read_b64_tr_b16 v[192:193], v5 offset:128
v_mfma_f32_16x16x32_bf16 a[48:51], v[220:223], v[132:135], a[48:51]
v_exp_f32 v103, v103
v_mfma_f32_16x16x32_bf16 a[52:55], v[220:223], v[140:143], a[52:55]
ds_read_b64_tr_b16 v[194:195], v5 offset:6272
v_add_f32 v11, v11, v103
v_mfma_f32_16x16x32_bf16 a[52:55], v[216:219], v[136:139], a[52:55]
v_exp_f32 v104, v104
v_mfma_f32_16x16x32_bf16 a[56:59], v[216:219], v[144:147], a[56:59]
ds_read_b64_tr_b16 v[196:197], v5 offset:12416
v_cvt_pk_bf16_f32 v173, v102, v103
v_mfma_f32_16x16x32_bf16 a[56:59], v[220:223], v[148:151], a[56:59]
v_exp_f32 v105, v105
v_mfma_f32_16x16x32_bf16 a[60:63], v[220:223], v[156:159], a[60:63]
ds_read_b64_tr_b16 v[198:199], v5 offset:18560
v_add_f32 v12, v12, v104
v_mfma_f32_16x16x32_bf16 a[60:63], v[216:219], v[152:155], a[60:63]
s_waitcnt lgkmcnt(8)
v_exp_f32 v106, v106
v_mfma_f32_16x16x32_bf16 a[64:67], v[224:227], v[128:131], a[64:67]
ds_read_b64_tr_b16 v[200:201], v6 offset:128
v_add_f32 v12, v12, v105
v_mfma_f32_16x16x32_bf16 a[64:67], v[228:231], v[132:135], a[64:67]
v_exp_f32 v107, v107
v_mfma_f32_16x16x32_bf16 a[68:71], v[228:231], v[140:143], a[68:71]
ds_read_b64_tr_b16 v[202:203], v6 offset:6272
v_cvt_pk_bf16_f32 v180, v104, v105
v_mfma_f32_16x16x32_bf16 a[68:71], v[224:227], v[136:139], a[68:71]
buffer_load_dwordx4 v8, s[8:11], s59 offen offset:1024 lds
v_add_f32 v12, v12, v106
v_mfma_f32_16x16x32_bf16 a[72:75], v[224:227], v[144:147], a[72:75]
ds_read_b64_tr_b16 v[204:205], v6 offset:12416
v_add_f32 v12, v12, v107
v_mfma_f32_16x16x32_bf16 a[72:75], v[228:231], v[148:151], a[72:75]
v_exp_f32 v108, v108
v_mfma_f32_16x16x32_bf16 a[76:79], v[228:231], v[156:159], a[76:79]
ds_read_b64_tr_b16 v[206:207], v6 offset:18560
v_cvt_pk_bf16_f32 v181, v106, v107
v_mfma_f32_16x16x32_bf16 a[76:79], v[224:227], v[152:155], a[76:79]
s_waitcnt lgkmcnt(8)
v_exp_f32 v109, v109
v_mfma_f32_16x16x32_bf16 a[80:83], v[232:235], v[128:131], a[80:83]
ds_read_b64_tr_b16 v[208:209], v3 offset:256
v_add_f32 v13, v13, v108
v_mfma_f32_16x16x32_bf16 a[80:83], v[236:239], v[132:135], a[80:83]
v_exp_f32 v110, v110
v_mfma_f32_16x16x32_bf16 a[84:87], v[236:239], v[140:143], a[84:87]
ds_read_b64_tr_b16 v[210:211], v3 offset:6400
v_add_f32 v13, v13, v109
v_mfma_f32_16x16x32_bf16 a[84:87], v[232:235], v[136:139], a[84:87]
v_cvt_pk_bf16_f32 v188, v108, v109
v_add_f32 v13, v13, v110
v_mfma_f32_16x16x32_bf16 a[88:91], v[232:235], v[144:147], a[88:91]
ds_read_b64_tr_b16 v[212:213], v3 offset:12544
v_mfma_f32_16x16x32_bf16 a[88:91], v[236:239], v[148:151], a[88:91]
v_exp_f32 v111, v111
v_mfma_f32_16x16x32_bf16 a[92:95], v[236:239], v[156:159], a[92:95]
ds_read_b64_tr_b16 v[214:215], v3 offset:18688
v_add_f32 v13, v13, v111
v_mfma_f32_16x16x32_bf16 a[92:95], v[232:235], v[152:155], a[92:95]
s_waitcnt lgkmcnt(8)
buffer_load_dwordx4 v9, s[8:11], s59 offen offset:2048 lds
v_cvt_pk_bf16_f32 v189, v110, v111
v_mfma_f32_16x16x32_bf16 a[96:99], v[192:195], v[128:131], a[96:99]
ds_read_b64_tr_b16 v[216:217], v4 offset:256
v_mfma_f32_16x16x32_bf16 a[96:99], v[196:199], v[132:135], a[96:99]
v_exp_f32 v112, v112
v_mfma_f32_16x16x32_bf16 a[100:103], v[196:199], v[140:143], a[100:103]
ds_read_b64_tr_b16 v[218:219], v4 offset:6400
v_add_f32 v10, v10, v112
v_mfma_f32_16x16x32_bf16 a[100:103], v[192:195], v[136:139], a[100:103]
v_exp_f32 v113, v113
v_mfma_f32_16x16x32_bf16 a[104:107], v[192:195], v[144:147], a[104:107]
ds_read_b64_tr_b16 v[220:221], v4 offset:12544
v_add_f32 v10, v10, v113
v_mfma_f32_16x16x32_bf16 a[104:107], v[196:199], v[148:151], a[104:107]
v_exp_f32 v114, v114
v_mfma_f32_16x16x32_bf16 a[108:111], v[196:199], v[156:159], a[108:111]
ds_read_b64_tr_b16 v[222:223], v4 offset:18688
v_cvt_pk_bf16_f32 v166, v112, v113
v_mfma_f32_16x16x32_bf16 a[108:111], v[192:195], v[152:155], a[108:111]
s_waitcnt lgkmcnt(8)
v_exp_f32 v115, v115
v_mfma_f32_16x16x32_bf16 a[112:115], v[200:203], v[128:131], a[112:115]
s_add_u32 s56, s56, 24576
ds_read_b64_tr_b16 v[224:225], v5 offset:256
v_add_f32 v10, v10, v114
v_mfma_f32_16x16x32_bf16 a[112:115], v[204:207], v[132:135], a[112:115]
v_exp_f32 v116, v116
v_mfma_f32_16x16x32_bf16 a[116:119], v[204:207], v[140:143], a[116:119]
ds_read_b64_tr_b16 v[226:227], v5 offset:6400
v_add_f32 v10, v10, v115
v_mfma_f32_16x16x32_bf16 a[116:119], v[200:203], v[136:139], a[116:119]
v_cvt_pk_bf16_f32 v167, v114, v115
v_add_f32 v11, v11, v116
v_mfma_f32_16x16x32_bf16 a[120:123], v[200:203], v[144:147], a[120:123]
s_cmp_eq_u32 s63, 0
s_cselect_b32 s24, s19, s27
ds_read_b64_tr_b16 v[228:229], v5 offset:12544
v_mfma_f32_16x16x32_bf16 a[120:123], v[204:207], v[148:151], a[120:123]
v_exp_f32 v117, v117
v_mfma_f32_16x16x32_bf16 a[124:127], v[204:207], v[156:159], a[124:127]
ds_read_b64_tr_b16 v[230:231], v5 offset:18688
v_add_f32 v11, v11, v117
v_mfma_f32_16x16x32_bf16 a[124:127], v[200:203], v[152:155], a[124:127]
s_waitcnt lgkmcnt(8)
v_exp_f32 v118, v118
v_mfma_f32_16x16x32_bf16 a[128:131], v[208:211], v[128:131], a[128:131]
ds_read_b64_tr_b16 v[232:233], v6 offset:256
v_cvt_pk_bf16_f32 v174, v116, v117
v_mfma_f32_16x16x32_bf16 a[128:131], v[212:215], v[132:135], a[128:131]
v_add_f32 v11, v11, v118
v_mfma_f32_16x16x32_bf16 a[132:135], v[212:215], v[140:143], a[132:135]
ds_read_b64_tr_b16 v[234:235], v6 offset:6400
v_mfma_f32_16x16x32_bf16 a[132:135], v[208:211], v[136:139], a[132:135]
v_exp_f32 v119, v119
v_mfma_f32_16x16x32_bf16 a[136:139], v[208:211], v[144:147], a[136:139]
ds_read_b64_tr_b16 v[236:237], v6 offset:12544
v_add_f32 v11, v11, v119
v_mfma_f32_16x16x32_bf16 a[136:139], v[212:215], v[148:151], a[136:139]
v_exp_f32 v120, v120
v_mfma_f32_16x16x32_bf16 a[140:143], v[212:215], v[156:159], a[140:143]
ds_read_b64_tr_b16 v[238:239], v6 offset:18688
v_cvt_pk_bf16_f32 v175, v118, v119
v_mfma_f32_16x16x32_bf16 a[140:143], v[208:211], v[152:155], a[140:143]
s_waitcnt lgkmcnt(8)
v_exp_f32 v121, v121
v_mfma_f32_16x16x32_bf16 a[144:147], v[216:219], v[128:131], a[144:147]
v_add_f32 v12, v12, v120
v_add_f32 v12, v12, v121
v_mfma_f32_16x16x32_bf16 a[144:147], v[220:223], v[132:135], a[144:147]
v_cvt_pk_bf16_f32 v182, v120, v121
v_mfma_f32_16x16x32_bf16 a[148:151], v[220:223], v[140:143], a[148:151]
v_exp_f32 v122, v122
v_mfma_f32_16x16x32_bf16 a[148:151], v[216:219], v[136:139], a[148:151]
v_add_f32 v12, v12, v122
v_mfma_f32_16x16x32_bf16 a[152:155], v[216:219], v[144:147], a[152:155]
v_mfma_f32_16x16x32_bf16 a[152:155], v[220:223], v[148:151], a[152:155]
v_exp_f32 v123, v123
v_mfma_f32_16x16x32_bf16 a[156:159], v[220:223], v[156:159], a[156:159]
v_add_f32 v12, v12, v123
v_cvt_pk_bf16_f32 v183, v122, v123
v_mfma_f32_16x16x32_bf16 a[156:159], v[216:219], v[152:155], a[156:159]
s_waitcnt lgkmcnt(4)
v_exp_f32 v124, v124
v_mfma_f32_16x16x32_bf16 a[160:163], v[224:227], v[128:131], a[160:163]
s_waitcnt vmcnt(12) lgkmcnt(0)
s_barrier
v_add_f32 v13, v13, v124
v_mfma_f32_16x16x32_bf16 a[160:163], v[228:231], v[132:135], a[160:163]
ds_read_b128 v[192:195], v1
v_mfma_f32_16x16x32_bf16 a[164:167], v[228:231], v[140:143], a[164:167]
v_add_u32 v3, 4294918144, v3
v_mfma_f32_16x16x32_bf16 a[164:167], v[224:227], v[136:139], a[164:167]
buffer_load_dword v254, v251, s[48:51], s24 offen
ds_read_b128 v[196:199], v2
v_mfma_f32_16x16x32_bf16 a[168:171], v[224:227], v[144:147], a[168:171]
v_add_u32 v4, 4294918144, v4
v_mfma_f32_16x16x32_bf16 a[168:171], v[228:231], v[148:151], a[168:171]
ds_read_b128 v[200:203], v1 offset:128
v_mfma_f32_16x16x32_bf16 a[172:175], v[228:231], v[156:159], a[172:175]
v_add_u32 v5, 4294918144, v5
v_mfma_f32_16x16x32_bf16 a[172:175], v[224:227], v[152:155], a[172:175]
s_waitcnt lgkmcnt(3)
buffer_store_dwordx4 v[246:249], v245, s[20:23], s34 offen sc1
ds_read_b128 v[204:207], v2 offset:128
v_mfma_f32_16x16x32_bf16 a[176:179], v[232:235], v[128:131], a[176:179]
v_add_u32 v6, 4294918144, v6
v_mfma_f32_16x16x32_bf16 a[176:179], v[236:239], v[132:135], a[176:179]
ds_read_b128 v[208:211], v1 offset:256
v_mfma_f32_16x16x32_bf16 a[180:183], v[236:239], v[140:143], a[180:183]
v_exp_f32 v125, v125
v_mfma_f32_16x16x32_bf16 a[180:183], v[232:235], v[136:139], a[180:183]
ds_read_b128 v[212:215], v2 offset:256
v_add_f32 v13, v13, v125
v_mfma_f32_16x16x32_bf16 a[184:187], v[232:235], v[144:147], a[184:187]
v_exp_f32 v126, v126
v_mfma_f32_16x16x32_bf16 a[184:187], v[236:239], v[148:151], a[184:187]
v_exp_f32 v127, v127
v_mfma_f32_16x16x32_bf16 a[188:191], v[236:239], v[156:159], a[188:191]
v_cvt_pk_bf16_f32 v190, v124, v125
v_add_f32 v13, v13, v126
v_mfma_f32_16x16x32_bf16 a[188:191], v[232:235], v[152:155], a[188:191]
s_waitcnt lgkmcnt(4)
v_add_f32 v13, v13, v127
v_cvt_pk_bf16_f32 v191, v126, v127
v_mfma_f32_16x16x32_bf16 v[64:67], v[192:195], a[192:195], v[16:19]
v_mfma_f32_16x16x32_bf16 v[64:67], v[196:199], a[196:199], v[64:67]
s_waitcnt lgkmcnt(2)
ds_read_b128 v[216:219], v1 offset:6144
v_mfma_f32_16x16x32_bf16 v[64:67], v[200:203], a[200:203], v[64:67]
s_add_u32 s57, s56, 3072
v_mfma_f32_16x16x32_bf16 v[64:67], v[204:207], a[204:207], v[64:67]
s_waitcnt lgkmcnt(1)
v_mfma_f32_16x16x32_bf16 v[64:67], v[208:211], a[208:211], v[64:67]
s_sub_u32 s58, s56, 24576
ds_read_b128 v[220:223], v2 offset:6144
v_mfma_f32_16x16x32_bf16 v[64:67], v[212:215], a[212:215], v[64:67]
s_sub_u32 s59, s56, 21504
v_mfma_f32_16x16x32_bf16 v[68:71], v[212:215], a[236:239], v[20:23]
v_mfma_f32_16x16x32_bf16 v[68:71], v[208:211], a[232:235], v[68:71]
ds_read_b128 v[224:227], v1 offset:6272
v_mfma_f32_16x16x32_bf16 v[68:71], v[204:207], a[228:231], v[68:71]
s_add_u32 m0, s68, 49152
v_mfma_f32_16x16x32_bf16 v[68:71], v[200:203], a[224:227], v[68:71]
v_mfma_f32_16x16x32_bf16 v[68:71], v[196:199], a[220:223], v[68:71]
ds_read_b128 v[228:231], v2 offset:6272
v_mfma_f32_16x16x32_bf16 v[68:71], v[192:195], a[216:219], v[68:71]
buffer_load_dwordx4 v7, s[4:7], s56 offen lds
v_mfma_f32_16x16x32_bf16 v[72:75], v[192:195], a[240:243], v[24:27]
v_exp_f32 v64, v64
v_mfma_f32_16x16x32_bf16 v[72:75], v[196:199], a[244:247], v[72:75]
ds_read_b128 v[232:235], v1 offset:6400
v_add_f32 v10, v10, v64
v_mfma_f32_16x16x32_bf16 v[72:75], v[200:203], a[248:251], v[72:75]
v_exp_f32 v65, v65
v_mfma_f32_16x16x32_bf16 v[72:75], v[204:207], a[252:255], v[72:75]
v_add_f32 v10, v10, v65
v_cvt_pk_bf16_f32 v128, v64, v65
v_mfma_f32_16x16x32_bf16 v[72:75], v[208:211], v[32:35], v[72:75]
ds_read_b128 v[236:239], v2 offset:6400
v_mfma_f32_16x16x32_bf16 v[72:75], v[212:215], v[36:39], v[72:75]
v_exp_f32 v66, v66
v_mfma_f32_16x16x32_bf16 v[76:79], v[212:215], v[60:63], v[28:31]
v_add_f32 v10, v10, v66
v_mfma_f32_16x16x32_bf16 v[76:79], v[208:211], v[56:59], v[76:79]
v_exp_f32 v67, v67
v_mfma_f32_16x16x32_bf16 v[76:79], v[204:207], v[52:55], v[76:79]
s_add_u32 s34, s34, 1024
v_add_f32 v10, v10, v67
v_cvt_pk_bf16_f32 v129, v66, v67
v_mfma_f32_16x16x32_bf16 v[76:79], v[200:203], v[48:51], v[76:79]
v_exp_f32 v68, v68
v_mfma_f32_16x16x32_bf16 v[76:79], v[196:199], v[44:47], v[76:79]
v_add_f32 v11, v11, v68
v_mfma_f32_16x16x32_bf16 v[76:79], v[192:195], v[40:43], v[76:79]
s_waitcnt lgkmcnt(0)
buffer_load_dwordx4 v8, s[4:7], s56 offen offset:1024 lds
v_mfma_f32_16x16x32_bf16 v[80:83], v[216:219], a[192:195], v[16:19]
v_exp_f32 v69, v69
v_mfma_f32_16x16x32_bf16 v[80:83], v[220:223], a[196:199], v[80:83]
ds_read_b128 v[192:195], v1 offset:12288
v_add_f32 v11, v11, v69
v_mfma_f32_16x16x32_bf16 v[80:83], v[224:227], a[200:203], v[80:83]
v_cvt_pk_bf16_f32 v136, v68, v69
v_mfma_f32_16x16x32_bf16 v[80:83], v[228:231], a[204:207], v[80:83]
v_exp_f32 v70, v70
v_mfma_f32_16x16x32_bf16 v[80:83], v[232:235], a[208:211], v[80:83]
ds_read_b128 v[196:199], v2 offset:12288
v_add_f32 v11, v11, v70
v_mfma_f32_16x16x32_bf16 v[80:83], v[236:239], a[212:215], v[80:83]
v_mfma_f32_16x16x32_bf16 v[84:87], v[236:239], a[236:239], v[20:23]
v_exp_f32 v71, v71
v_mfma_f32_16x16x32_bf16 v[84:87], v[232:235], a[232:235], v[84:87]
ds_read_b128 v[200:203], v1 offset:12416
v_add_f32 v11, v11, v71
v_mfma_f32_16x16x32_bf16 v[84:87], v[228:231], a[228:231], v[84:87]
v_exp_f32 v72, v72
v_mfma_f32_16x16x32_bf16 v[84:87], v[224:227], a[224:227], v[84:87]
v_cvt_pk_bf16_f32 v137, v70, v71
v_add_f32 v12, v12, v72
v_mfma_f32_16x16x32_bf16 v[84:87], v[220:223], a[220:223], v[84:87]
ds_read_b128 v[204:207], v2 offset:12416
v_mfma_f32_16x16x32_bf16 v[84:87], v[216:219], a[216:219], v[84:87]
buffer_load_dwordx4 v9, s[4:7], s56 offen offset:2048 lds
v_mfma_f32_16x16x32_bf16 v[88:91], v[216:219], a[240:243], v[24:27]
v_exp_f32 v73, v73
v_mfma_f32_16x16x32_bf16 v[88:91], v[220:223], a[244:247], v[88:91]
ds_read_b128 v[208:211], v1 offset:12544
v_add_f32 v12, v12, v73
v_mfma_f32_16x16x32_bf16 v[88:91], v[224:227], a[248:251], v[88:91]
v_exp_f32 v74, v74
v_mfma_f32_16x16x32_bf16 v[88:91], v[228:231], a[252:255], v[88:91]
v_cvt_pk_bf16_f32 v144, v72, v73
v_add_f32 v12, v12, v74
v_mfma_f32_16x16x32_bf16 v[88:91], v[232:235], v[32:35], v[88:91]
ds_read_b128 v[212:215], v2 offset:12544
v_mfma_f32_16x16x32_bf16 v[88:91], v[236:239], v[36:39], v[88:91]
v_exp_f32 v75, v75
v_mfma_f32_16x16x32_bf16 v[92:95], v[236:239], v[60:63], v[28:31]
v_add_f32 v12, v12, v75
v_cvt_pk_bf16_f32 v145, v74, v75
v_mfma_f32_16x16x32_bf16 v[92:95], v[232:235], v[56:59], v[92:95]
v_exp_f32 v76, v76
v_mfma_f32_16x16x32_bf16 v[92:95], v[228:231], v[52:55], v[92:95]
s_add_u32 m0, s68, 52224
v_add_f32 v13, v13, v76
v_mfma_f32_16x16x32_bf16 v[92:95], v[224:227], v[48:51], v[92:95]
v_mfma_f32_16x16x32_bf16 v[92:95], v[220:223], v[44:47], v[92:95]
v_exp_f32 v77, v77
v_mfma_f32_16x16x32_bf16 v[92:95], v[216:219], v[40:43], v[92:95]
s_waitcnt lgkmcnt(0)
buffer_load_dwordx4 v7, s[4:7], s57 offen lds
v_add_f32 v13, v13, v77
v_mfma_f32_16x16x32_bf16 v[96:99], v[192:195], a[192:195], v[16:19]
v_cvt_pk_bf16_f32 v152, v76, v77
v_mfma_f32_16x16x32_bf16 v[96:99], v[196:199], a[196:199], v[96:99]
ds_read_b128 v[216:219], v1 offset:18432
v_mfma_f32_16x16x32_bf16 v[96:99], v[200:203], a[200:203], v[96:99]
v_exp_f32 v78, v78
v_mfma_f32_16x16x32_bf16 v[96:99], v[204:207], a[204:207], v[96:99]
v_add_f32 v13, v13, v78
v_mfma_f32_16x16x32_bf16 v[96:99], v[208:211], a[208:211], v[96:99]
ds_read_b128 v[220:223], v2 offset:18432
v_mfma_f32_16x16x32_bf16 v[96:99], v[212:215], a[212:215], v[96:99]
v_exp_f32 v79, v79
v_mfma_f32_16x16x32_bf16 v[100:103], v[212:215], a[236:239], v[20:23]
v_exp_f32 v80, v80
v_mfma_f32_16x16x32_bf16 v[100:103], v[208:211], a[232:235], v[100:103]
ds_read_b128 v[224:227], v1 offset:18560
v_add_f32 v13, v13, v79
v_mfma_f32_16x16x32_bf16 v[100:103], v[204:207], a[228:231], v[100:103]
v_cvt_pk_bf16_f32 v153, v78, v79
v_add_f32 v10, v10, v80
v_mfma_f32_16x16x32_bf16 v[100:103], v[200:203], a[224:227], v[100:103]
v_exp_f32 v81, v81
v_mfma_f32_16x16x32_bf16 v[100:103], v[196:199], a[220:223], v[100:103]
ds_read_b128 v[228:231], v2 offset:18560
v_add_f32 v10, v10, v81
v_mfma_f32_16x16x32_bf16 v[100:103], v[192:195], a[216:219], v[100:103]
buffer_load_dwordx4 v8, s[4:7], s57 offen offset:1024 lds
v_cvt_pk_bf16_f32 v130, v80, v81
v_mfma_f32_16x16x32_bf16 v[104:107], v[192:195], a[240:243], v[24:27]
v_exp_f32 v82, v82
v_mfma_f32_16x16x32_bf16 v[104:107], v[196:199], a[244:247], v[104:107]
ds_read_b128 v[232:235], v1 offset:18688
v_add_f32 v10, v10, v82
v_mfma_f32_16x16x32_bf16 v[104:107], v[200:203], a[248:251], v[104:107]
v_mfma_f32_16x16x32_bf16 v[104:107], v[204:207], a[252:255], v[104:107]
v_exp_f32 v83, v83
v_mfma_f32_16x16x32_bf16 v[104:107], v[208:211], v[32:35], v[104:107]
ds_read_b128 v[236:239], v2 offset:18688
v_add_f32 v10, v10, v83
v_mfma_f32_16x16x32_bf16 v[104:107], v[212:215], v[36:39], v[104:107]
v_exp_f32 v84, v84
v_mfma_f32_16x16x32_bf16 v[108:111], v[212:215], v[60:63], v[28:31]
v_cvt_pk_bf16_f32 v131, v82, v83
v_add_f32 v11, v11, v84
v_mfma_f32_16x16x32_bf16 v[108:111], v[208:211], v[56:59], v[108:111]
v_mfma_f32_16x16x32_bf16 v[108:111], v[204:207], v[52:55], v[108:111]
v_exp_f32 v85, v85
v_mfma_f32_16x16x32_bf16 v[108:111], v[200:203], v[48:51], v[108:111]
v_add_f32 v11, v11, v85
v_cvt_pk_bf16_f32 v138, v84, v85
v_mfma_f32_16x16x32_bf16 v[108:111], v[196:199], v[44:47], v[108:111]
v_mfma_f32_16x16x32_bf16 v[108:111], v[192:195], v[40:43], v[108:111]
s_waitcnt lgkmcnt(0)
buffer_load_dwordx4 v9, s[4:7], s57 offen offset:2048 lds
v_mfma_f32_16x16x32_bf16 v[112:115], v[216:219], a[192:195], v[16:19]
v_exp_f32 v86, v86
v_mfma_f32_16x16x32_bf16 v[112:115], v[220:223], a[196:199], v[112:115]
ds_read_b64_tr_b16 v[192:193], v3
v_add_f32 v11, v11, v86
v_mfma_f32_16x16x32_bf16 v[112:115], v[224:227], a[200:203], v[112:115]
ds_read_b64_tr_b16 v[194:195], v3 offset:6144
v_mfma_f32_16x16x32_bf16 v[112:115], v[228:231], a[204:207], v[112:115]
v_exp_f32 v87, v87
v_mfma_f32_16x16x32_bf16 v[112:115], v[232:235], a[208:211], v[112:115]
ds_read_b64_tr_b16 v[196:197], v3 offset:12288
v_add_f32 v11, v11, v87
v_mfma_f32_16x16x32_bf16 v[112:115], v[236:239], a[212:215], v[112:115]
ds_read_b64_tr_b16 v[198:199], v3 offset:18432
v_cvt_pk_bf16_f32 v139, v86, v87
v_mfma_f32_16x16x32_bf16 v[116:119], v[236:239], a[236:239], v[20:23]
v_exp_f32 v88, v88
v_mfma_f32_16x16x32_bf16 v[116:119], v[232:235], a[232:235], v[116:119]
ds_read_b64_tr_b16 v[200:201], v4
v_add_f32 v12, v12, v88
v_mfma_f32_16x16x32_bf16 v[116:119], v[228:231], a[228:231], v[116:119]
s_add_u32 m0, s68, 122880
ds_read_b64_tr_b16 v[202:203], v4 offset:6144
v_mfma_f32_16x16x32_bf16 v[116:119], v[224:227], a[224:227], v[116:119]
v_exp_f32 v89, v89
v_mfma_f32_16x16x32_bf16 v[116:119], v[220:223], a[220:223], v[116:119]
ds_read_b64_tr_b16 v[204:205], v4 offset:12288
v_add_f32 v12, v12, v89
v_mfma_f32_16x16x32_bf16 v[116:119], v[216:219], a[216:219], v[116:119]
ds_read_b64_tr_b16 v[206:207], v4 offset:18432
buffer_load_dwordx4 v7, s[8:11], s58 offen lds
v_mfma_f32_16x16x32_bf16 v[120:123], v[216:219], a[240:243], v[24:27]
v_exp_f32 v90, v90
v_mfma_f32_16x16x32_bf16 v[120:123], v[220:223], a[244:247], v[120:123]
ds_read_b64_tr_b16 v[208:209], v5
v_cvt_pk_bf16_f32 v146, v88, v89
v_mfma_f32_16x16x32_bf16 v[120:123], v[224:227], a[248:251], v[120:123]
ds_read_b64_tr_b16 v[210:211], v5 offset:6144
v_add_f32 v12, v12, v90
v_mfma_f32_16x16x32_bf16 v[120:123], v[228:231], a[252:255], v[120:123]
v_exp_f32 v91, v91
v_mfma_f32_16x16x32_bf16 v[120:123], v[232:235], v[32:35], v[120:123]
ds_read_b64_tr_b16 v[212:213], v5 offset:12288
v_add_f32 v12, v12, v91
v_mfma_f32_16x16x32_bf16 v[120:123], v[236:239], v[36:39], v[120:123]
ds_read_b64_tr_b16 v[214:215], v5 offset:18432
v_cvt_pk_bf16_f32 v147, v90, v91
v_mfma_f32_16x16x32_bf16 v[124:127], v[236:239], v[60:63], v[28:31]
v_exp_f32 v92, v92
v_mfma_f32_16x16x32_bf16 v[124:127], v[232:235], v[56:59], v[124:127]
v_exp_f32 v93, v93
v_mfma_f32_16x16x32_bf16 v[124:127], v[228:231], v[52:55], v[124:127]
v_add_f32 v13, v13, v92
v_add_f32 v13, v13, v93
v_mfma_f32_16x16x32_bf16 v[124:127], v[224:227], v[48:51], v[124:127]
v_exp_f32 v94, v94
v_mfma_f32_16x16x32_bf16 v[124:127], v[220:223], v[44:47], v[124:127]
v_cvt_pk_bf16_f32 v154, v92, v93
v_add_f32 v13, v13, v94
v_mfma_f32_16x16x32_bf16 v[124:127], v[216:219], v[40:43], v[124:127]
s_waitcnt lgkmcnt(8)
buffer_load_dwordx4 v8, s[8:11], s58 offen offset:1024 lds
v_mfma_f32_16x16x32_bf16 a[0:3], v[192:195], v[160:163], a[0:3]
ds_read_b64_tr_b16 v[216:217], v6
v_mfma_f32_16x16x32_bf16 a[0:3], v[196:199], v[164:167], a[0:3]
v_exp_f32 v95, v95
v_mfma_f32_16x16x32_bf16 a[4:7], v[196:199], v[172:175], a[4:7]
ds_read_b64_tr_b16 v[218:219], v6 offset:6144
v_add_f32 v13, v13, v95
v_mfma_f32_16x16x32_bf16 a[4:7], v[192:195], v[168:171], a[4:7]
v_exp_f32 v96, v96
v_mfma_f32_16x16x32_bf16 a[8:11], v[192:195], v[176:179], a[8:11]
ds_read_b64_tr_b16 v[220:221], v6 offset:12288
v_cvt_pk_bf16_f32 v155, v94, v95
v_mfma_f32_16x16x32_bf16 a[8:11], v[196:199], v[180:183], a[8:11]
v_exp_f32 v97, v97
v_mfma_f32_16x16x32_bf16 a[12:15], v[196:199], v[188:191], a[12:15]
ds_read_b64_tr_b16 v[222:223], v6 offset:18432
v_add_f32 v10, v10, v96
v_mfma_f32_16x16x32_bf16 a[12:15], v[192:195], v[184:187], a[12:15]
s_waitcnt lgkmcnt(8)
v_add_f32 v10, v10, v97
v_cvt_pk_bf16_f32 v132, v96, v97
v_mfma_f32_16x16x32_bf16 a[16:19], v[200:203], v[160:163], a[16:19]
ds_read_b64_tr_b16 v[224:225], v3 offset:128
v_mfma_f32_16x16x32_bf16 a[16:19], v[204:207], v[164:167], a[16:19]
v_exp_f32 v98, v98
v_mfma_f32_16x16x32_bf16 a[20:23], v[204:207], v[172:175], a[20:23]
ds_read_b64_tr_b16 v[226:227], v3 offset:6272
v_add_u32 v1, 24576, v1
v_mfma_f32_16x16x32_bf16 a[20:23], v[200:203], v[168:171], a[20:23]
buffer_load_dwordx4 v9, s[8:11], s58 offen offset:2048 lds
v_add_f32 v10, v10, v98
v_mfma_f32_16x16x32_bf16 a[24:27], v[200:203], v[176:179], a[24:27]
ds_read_b64_tr_b16 v[228:229], v3 offset:12416
v_add_u32 v2, 24576, v2
v_mfma_f32_16x16x32_bf16 a[24:27], v[204:207], v[180:183], a[24:27]
v_exp_f32 v99, v99
v_mfma_f32_16x16x32_bf16 a[28:31], v[204:207], v[188:191], a[28:31]
ds_read_b64_tr_b16 v[230:231], v3 offset:18560
v_add_f32 v10, v10, v99
v_mfma_f32_16x16x32_bf16 a[28:31], v[200:203], v[184:187], a[28:31]
s_waitcnt lgkmcnt(8)
v_exp_f32 v100, v100
v_mfma_f32_16x16x32_bf16 a[32:35], v[208:211], v[160:163], a[32:35]
ds_read_b64_tr_b16 v[232:233], v4 offset:128
v_cvt_pk_bf16_f32 v133, v98, v99
v_mfma_f32_16x16x32_bf16 a[32:35], v[212:215], v[164:167], a[32:35]
v_exp_f32 v101, v101
v_mfma_f32_16x16x32_bf16 a[36:39], v[212:215], v[172:175], a[36:39]
ds_read_b64_tr_b16 v[234:235], v4 offset:6272
v_add_f32 v11, v11, v100
v_mfma_f32_16x16x32_bf16 a[36:39], v[208:211], v[168:171], a[36:39]
v_exp_f32 v102, v102
v_mfma_f32_16x16x32_bf16 a[40:43], v[208:211], v[176:179], a[40:43]
s_add_u32 m0, s68, 125952
ds_read_b64_tr_b16 v[236:237], v4 offset:12416
v_add_f32 v11, v11, v101
v_mfma_f32_16x16x32_bf16 a[40:43], v[212:215], v[180:183], a[40:43]
v_cvt_pk_bf16_f32 v140, v100, v101
v_add_f32 v11, v11, v102
v_mfma_f32_16x16x32_bf16 a[44:47], v[212:215], v[188:191], a[44:47]
ds_read_b64_tr_b16 v[238:239], v4 offset:18560
v_mfma_f32_16x16x32_bf16 a[44:47], v[208:211], v[184:187], a[44:47]
s_waitcnt lgkmcnt(8)
buffer_load_dwordx4 v7, s[8:11], s59 offen lds
v_mfma_f32_16x16x32_bf16 a[48:51], v[216:219], v[160:163], a[48:51]
ds_read_b64_tr_b16 v[192:193], v5 offset:128
v_mfma_f32_16x16x32_bf16 a[48:51], v[220:223], v[164:167], a[48:51]
v_exp_f32 v103, v103
v_mfma_f32_16x16x32_bf16 a[52:55], v[220:223], v[172:175], a[52:55]
ds_read_b64_tr_b16 v[194:195], v5 offset:6272
v_add_f32 v11, v11, v103
v_mfma_f32_16x16x32_bf16 a[52:55], v[216:219], v[168:171], a[52:55]
v_exp_f32 v104, v104
v_mfma_f32_16x16x32_bf16 a[56:59], v[216:219], v[176:179], a[56:59]
ds_read_b64_tr_b16 v[196:197], v5 offset:12416
v_cvt_pk_bf16_f32 v141, v102, v103
v_mfma_f32_16x16x32_bf16 a[56:59], v[220:223], v[180:183], a[56:59]
v_exp_f32 v105, v105
v_mfma_f32_16x16x32_bf16 a[60:63], v[220:223], v[188:191], a[60:63]
ds_read_b64_tr_b16 v[198:199], v5 offset:18560
v_add_f32 v12, v12, v104
v_mfma_f32_16x16x32_bf16 a[60:63], v[216:219], v[184:187], a[60:63]
s_waitcnt lgkmcnt(8)
v_exp_f32 v106, v106
v_mfma_f32_16x16x32_bf16 a[64:67], v[224:227], v[160:163], a[64:67]
ds_read_b64_tr_b16 v[200:201], v6 offset:128
v_add_f32 v12, v12, v105
v_mfma_f32_16x16x32_bf16 a[64:67], v[228:231], v[164:167], a[64:67]
v_exp_f32 v107, v107
v_mfma_f32_16x16x32_bf16 a[68:71], v[228:231], v[172:175], a[68:71]
ds_read_b64_tr_b16 v[202:203], v6 offset:6272
v_cvt_pk_bf16_f32 v148, v104, v105
v_mfma_f32_16x16x32_bf16 a[68:71], v[224:227], v[168:171], a[68:71]
buffer_load_dwordx4 v8, s[8:11], s59 offen offset:1024 lds
v_add_f32 v12, v12, v106
v_mfma_f32_16x16x32_bf16 a[72:75], v[224:227], v[176:179], a[72:75]
ds_read_b64_tr_b16 v[204:205], v6 offset:12416
v_add_f32 v12, v12, v107
v_mfma_f32_16x16x32_bf16 a[72:75], v[228:231], v[180:183], a[72:75]
v_exp_f32 v108, v108
v_mfma_f32_16x16x32_bf16 a[76:79], v[228:231], v[188:191], a[76:79]
ds_read_b64_tr_b16 v[206:207], v6 offset:18560
v_cvt_pk_bf16_f32 v149, v106, v107
v_mfma_f32_16x16x32_bf16 a[76:79], v[224:227], v[184:187], a[76:79]
s_waitcnt lgkmcnt(8)
v_exp_f32 v109, v109
v_mfma_f32_16x16x32_bf16 a[80:83], v[232:235], v[160:163], a[80:83]
ds_read_b64_tr_b16 v[208:209], v3 offset:256
v_add_f32 v13, v13, v108
v_mfma_f32_16x16x32_bf16 a[80:83], v[236:239], v[164:167], a[80:83]
v_exp_f32 v110, v110
v_mfma_f32_16x16x32_bf16 a[84:87], v[236:239], v[172:175], a[84:87]
ds_read_b64_tr_b16 v[210:211], v3 offset:6400
v_add_f32 v13, v13, v109
v_mfma_f32_16x16x32_bf16 a[84:87], v[232:235], v[168:171], a[84:87]
v_cvt_pk_bf16_f32 v156, v108, v109
v_add_f32 v13, v13, v110
v_mfma_f32_16x16x32_bf16 a[88:91], v[232:235], v[176:179], a[88:91]
ds_read_b64_tr_b16 v[212:213], v3 offset:12544
v_mfma_f32_16x16x32_bf16 a[88:91], v[236:239], v[180:183], a[88:91]
v_exp_f32 v111, v111
v_mfma_f32_16x16x32_bf16 a[92:95], v[236:239], v[188:191], a[92:95]
ds_read_b64_tr_b16 v[214:215], v3 offset:18688
v_add_f32 v13, v13, v111
v_mfma_f32_16x16x32_bf16 a[92:95], v[232:235], v[184:187], a[92:95]
s_waitcnt lgkmcnt(8)
buffer_load_dwordx4 v9, s[8:11], s59 offen offset:2048 lds
v_cvt_pk_bf16_f32 v157, v110, v111
v_mfma_f32_16x16x32_bf16 a[96:99], v[192:195], v[160:163], a[96:99]
ds_read_b64_tr_b16 v[216:217], v4 offset:256
v_mfma_f32_16x16x32_bf16 a[96:99], v[196:199], v[164:167], a[96:99]
v_exp_f32 v112, v112
v_mfma_f32_16x16x32_bf16 a[100:103], v[196:199], v[172:175], a[100:103]
ds_read_b64_tr_b16 v[218:219], v4 offset:6400
v_add_f32 v10, v10, v112
v_mfma_f32_16x16x32_bf16 a[100:103], v[192:195], v[168:171], a[100:103]
v_exp_f32 v113, v113
v_mfma_f32_16x16x32_bf16 a[104:107], v[192:195], v[176:179], a[104:107]
ds_read_b64_tr_b16 v[220:221], v4 offset:12544
v_add_f32 v10, v10, v113
v_mfma_f32_16x16x32_bf16 a[104:107], v[196:199], v[180:183], a[104:107]
v_exp_f32 v114, v114
v_mfma_f32_16x16x32_bf16 a[108:111], v[196:199], v[188:191], a[108:111]
ds_read_b64_tr_b16 v[222:223], v4 offset:18688
v_cvt_pk_bf16_f32 v134, v112, v113
v_mfma_f32_16x16x32_bf16 a[108:111], v[192:195], v[184:187], a[108:111]
s_waitcnt lgkmcnt(8)
v_exp_f32 v115, v115
v_mfma_f32_16x16x32_bf16 a[112:115], v[200:203], v[160:163], a[112:115]
s_add_u32 s56, s56, 24576
ds_read_b64_tr_b16 v[224:225], v5 offset:256
v_add_f32 v10, v10, v114
v_mfma_f32_16x16x32_bf16 a[112:115], v[204:207], v[164:167], a[112:115]
v_exp_f32 v116, v116
v_mfma_f32_16x16x32_bf16 a[116:119], v[204:207], v[172:175], a[116:119]
ds_read_b64_tr_b16 v[226:227], v5 offset:6400
v_add_f32 v10, v10, v115
v_mfma_f32_16x16x32_bf16 a[116:119], v[200:203], v[168:171], a[116:119]
v_cvt_pk_bf16_f32 v135, v114, v115
v_add_f32 v11, v11, v116
v_mfma_f32_16x16x32_bf16 a[120:123], v[200:203], v[176:179], a[120:123]
ds_read_b64_tr_b16 v[228:229], v5 offset:12544
v_mfma_f32_16x16x32_bf16 a[120:123], v[204:207], v[180:183], a[120:123]
v_exp_f32 v117, v117
v_mfma_f32_16x16x32_bf16 a[124:127], v[204:207], v[188:191], a[124:127]
ds_read_b64_tr_b16 v[230:231], v5 offset:18688
v_add_f32 v11, v11, v117
v_mfma_f32_16x16x32_bf16 a[124:127], v[200:203], v[184:187], a[124:127]
s_waitcnt lgkmcnt(8)
v_exp_f32 v118, v118
v_mfma_f32_16x16x32_bf16 a[128:131], v[208:211], v[160:163], a[128:131]
ds_read_b64_tr_b16 v[232:233], v6 offset:256
v_cvt_pk_bf16_f32 v142, v116, v117
v_mfma_f32_16x16x32_bf16 a[128:131], v[212:215], v[164:167], a[128:131]
v_add_f32 v11, v11, v118
v_mfma_f32_16x16x32_bf16 a[132:135], v[212:215], v[172:175], a[132:135]
ds_read_b64_tr_b16 v[234:235], v6 offset:6400
v_mfma_f32_16x16x32_bf16 a[132:135], v[208:211], v[168:171], a[132:135]
v_exp_f32 v119, v119
v_mfma_f32_16x16x32_bf16 a[136:139], v[208:211], v[176:179], a[136:139]
ds_read_b64_tr_b16 v[236:237], v6 offset:12544
v_add_f32 v11, v11, v119
v_mfma_f32_16x16x32_bf16 a[136:139], v[212:215], v[180:183], a[136:139]
v_exp_f32 v120, v120
v_mfma_f32_16x16x32_bf16 a[140:143], v[212:215], v[188:191], a[140:143]
ds_read_b64_tr_b16 v[238:239], v6 offset:18688
v_cvt_pk_bf16_f32 v143, v118, v119
v_mfma_f32_16x16x32_bf16 a[140:143], v[208:211], v[184:187], a[140:143]
s_waitcnt lgkmcnt(8)
v_exp_f32 v121, v121
v_mfma_f32_16x16x32_bf16 a[144:147], v[216:219], v[160:163], a[144:147]
v_add_f32 v12, v12, v120
v_add_f32 v12, v12, v121
v_mfma_f32_16x16x32_bf16 a[144:147], v[220:223], v[164:167], a[144:147]
v_cvt_pk_bf16_f32 v150, v120, v121
v_mfma_f32_16x16x32_bf16 a[148:151], v[220:223], v[172:175], a[148:151]
v_exp_f32 v122, v122
v_mfma_f32_16x16x32_bf16 a[148:151], v[216:219], v[168:171], a[148:151]
v_add_f32 v12, v12, v122
v_mfma_f32_16x16x32_bf16 a[152:155], v[216:219], v[176:179], a[152:155]
v_mfma_f32_16x16x32_bf16 a[152:155], v[220:223], v[180:183], a[152:155]
v_exp_f32 v123, v123
v_mfma_f32_16x16x32_bf16 a[156:159], v[220:223], v[188:191], a[156:159]
v_add_f32 v12, v12, v123
v_cvt_pk_bf16_f32 v151, v122, v123
v_mfma_f32_16x16x32_bf16 a[156:159], v[216:219], v[184:187], a[156:159]
s_waitcnt lgkmcnt(4)
v_exp_f32 v124, v124
v_mfma_f32_16x16x32_bf16 a[160:163], v[224:227], v[160:163], a[160:163]
s_waitcnt vmcnt(12) lgkmcnt(0)
s_barrier
v_add_f32 v13, v13, v124
v_mfma_f32_16x16x32_bf16 a[160:163], v[228:231], v[164:167], a[160:163]
ds_read_b128 v[192:195], v1
v_mfma_f32_16x16x32_bf16 a[164:167], v[228:231], v[172:175], a[164:167]
v_add_u32 v3, 24576, v3
v_mfma_f32_16x16x32_bf16 a[164:167], v[224:227], v[168:171], a[164:167]
global_load_dword v254, v251, s[16:17]
ds_read_b128 v[196:199], v2
v_mfma_f32_16x16x32_bf16 a[168:171], v[224:227], v[176:179], a[168:171]
v_add_u32 v4, 24576, v4
v_mfma_f32_16x16x32_bf16 a[168:171], v[228:231], v[180:183], a[168:171]
ds_read_b128 v[200:203], v1 offset:128
v_mfma_f32_16x16x32_bf16 a[172:175], v[228:231], v[188:191], a[172:175]
v_add_u32 v5, 24576, v5
v_mfma_f32_16x16x32_bf16 a[172:175], v[224:227], v[184:187], a[172:175]
s_waitcnt lgkmcnt(3)
ds_read_b128 v[204:207], v2 offset:128
v_mfma_f32_16x16x32_bf16 a[176:179], v[232:235], v[160:163], a[176:179]
v_add_u32 v6, 24576, v6
v_mfma_f32_16x16x32_bf16 a[176:179], v[236:239], v[164:167], a[176:179]
ds_read_b128 v[208:211], v1 offset:256
v_mfma_f32_16x16x32_bf16 a[180:183], v[236:239], v[172:175], a[180:183]
s_cmp_eq_u32 s63, 0
v_exp_f32 v125, v125
v_mfma_f32_16x16x32_bf16 a[180:183], v[232:235], v[168:171], a[180:183]
ds_read_b128 v[212:215], v2 offset:256
v_add_f32 v13, v13, v125
v_mfma_f32_16x16x32_bf16 a[184:187], v[232:235], v[176:179], a[184:187]
v_exp_f32 v126, v126
v_mfma_f32_16x16x32_bf16 a[184:187], v[236:239], v[180:183], a[184:187]
v_exp_f32 v127, v127
v_mfma_f32_16x16x32_bf16 a[188:191], v[236:239], v[188:191], a[188:191]
v_cvt_pk_bf16_f32 v158, v124, v125
v_add_f32 v13, v13, v126
v_mfma_f32_16x16x32_bf16 a[188:191], v[232:235], v[184:187], a[188:191]
s_waitcnt lgkmcnt(4)
v_add_f32 v13, v13, v127
v_cvt_pk_bf16_f32 v159, v126, v127
s_cbranch_scc1 L_tail
v_mfma_f32_16x16x32_bf16 v[64:67], v[192:195], a[192:195], v[16:19]
v_mfma_f32_16x16x32_bf16 v[64:67], v[196:199], a[196:199], v[64:67]
s_waitcnt lgkmcnt(2)
ds_read_b128 v[216:219], v1 offset:6144
v_mfma_f32_16x16x32_bf16 v[64:67], v[200:203], a[200:203], v[64:67]
s_add_u32 s57, s56, 3072
v_mfma_f32_16x16x32_bf16 v[64:67], v[204:207], a[204:207], v[64:67]
s_waitcnt lgkmcnt(1)
v_mfma_f32_16x16x32_bf16 v[64:67], v[208:211], a[208:211], v[64:67]
s_sub_u32 s58, s56, 24576
ds_read_b128 v[220:223], v2 offset:6144
v_mfma_f32_16x16x32_bf16 v[64:67], v[212:215], a[212:215], v[64:67]
s_sub_u32 s59, s56, 21504
v_mfma_f32_16x16x32_bf16 v[68:71], v[212:215], a[236:239], v[20:23]
v_mfma_f32_16x16x32_bf16 v[68:71], v[208:211], a[232:235], v[68:71]
ds_read_b128 v[224:227], v1 offset:6272
v_mfma_f32_16x16x32_bf16 v[68:71], v[204:207], a[228:231], v[68:71]
s_add_u32 m0, s68, 0
v_mfma_f32_16x16x32_bf16 v[68:71], v[200:203], a[224:227], v[68:71]
v_mfma_f32_16x16x32_bf16 v[68:71], v[196:199], a[220:223], v[68:71]
ds_read_b128 v[228:231], v2 offset:6272
v_mfma_f32_16x16x32_bf16 v[68:71], v[192:195], a[216:219], v[68:71]
buffer_load_dwordx4 v7, s[4:7], s56 offen lds
v_mfma_f32_16x16x32_bf16 v[72:75], v[192:195], a[240:243], v[24:27]
v_exp_f32 v64, v64
v_mfma_f32_16x16x32_bf16 v[72:75], v[196:199], a[244:247], v[72:75]
ds_read_b128 v[232:235], v1 offset:6400
v_add_f32 v10, v10, v64
v_mfma_f32_16x16x32_bf16 v[72:75], v[200:203], a[248:251], v[72:75]
v_exp_f32 v65, v65
v_mfma_f32_16x16x32_bf16 v[72:75], v[204:207], a[252:255], v[72:75]
v_add_f32 v10, v10, v65
v_cvt_pk_bf16_f32 v160, v64, v65
v_mfma_f32_16x16x32_bf16 v[72:75], v[208:211], v[32:35], v[72:75]
ds_read_b128 v[236:239], v2 offset:6400
v_mfma_f32_16x16x32_bf16 v[72:75], v[212:215], v[36:39], v[72:75]
v_exp_f32 v66, v66
v_mfma_f32_16x16x32_bf16 v[76:79], v[212:215], v[60:63], v[28:31]
v_add_f32 v10, v10, v66
v_mfma_f32_16x16x32_bf16 v[76:79], v[208:211], v[56:59], v[76:79]
v_exp_f32 v67, v67
v_mfma_f32_16x16x32_bf16 v[76:79], v[204:207], v[52:55], v[76:79]
v_add_f32 v10, v10, v67
v_cvt_pk_bf16_f32 v161, v66, v67
v_mfma_f32_16x16x32_bf16 v[76:79], v[200:203], v[48:51], v[76:79]
v_exp_f32 v68, v68
v_mfma_f32_16x16x32_bf16 v[76:79], v[196:199], v[44:47], v[76:79]
v_add_f32 v11, v11, v68
v_mfma_f32_16x16x32_bf16 v[76:79], v[192:195], v[40:43], v[76:79]
s_waitcnt lgkmcnt(0)
buffer_load_dwordx4 v8, s[4:7], s56 offen offset:1024 lds
v_mfma_f32_16x16x32_bf16 v[80:83], v[216:219], a[192:195], v[16:19]
v_exp_f32 v69, v69
v_mfma_f32_16x16x32_bf16 v[80:83], v[220:223], a[196:199], v[80:83]
ds_read_b128 v[192:195], v1 offset:12288
v_add_f32 v11, v11, v69
v_mfma_f32_16x16x32_bf16 v[80:83], v[224:227], a[200:203], v[80:83]
v_cvt_pk_bf16_f32 v168, v68, v69
v_mfma_f32_16x16x32_bf16 v[80:83], v[228:231], a[204:207], v[80:83]
v_exp_f32 v70, v70
v_mfma_f32_16x16x32_bf16 v[80:83], v[232:235], a[208:211], v[80:83]
ds_read_b128 v[196:199], v2 offset:12288
v_add_f32 v11, v11, v70
v_mfma_f32_16x16x32_bf16 v[80:83], v[236:239], a[212:215], v[80:83]
v_mfma_f32_16x16x32_bf16 v[84:87], v[236:239], a[236:239], v[20:23]
v_exp_f32 v71, v71
v_mfma_f32_16x16x32_bf16 v[84:87], v[232:235], a[232:235], v[84:87]
ds_read_b128 v[200:203], v1 offset:12416
v_add_f32 v11, v11, v71
v_mfma_f32_16x16x32_bf16 v[84:87], v[228:231], a[228:231], v[84:87]
v_exp_f32 v72, v72
v_mfma_f32_16x16x32_bf16 v[84:87], v[224:227], a[224:227], v[84:87]
v_cvt_pk_bf16_f32 v169, v70, v71
v_add_f32 v12, v12, v72
v_mfma_f32_16x16x32_bf16 v[84:87], v[220:223], a[220:223], v[84:87]
ds_read_b128 v[204:207], v2 offset:12416
v_mfma_f32_16x16x32_bf16 v[84:87], v[216:219], a[216:219], v[84:87]
buffer_load_dwordx4 v9, s[4:7], s56 offen offset:2048 lds
v_mfma_f32_16x16x32_bf16 v[88:91], v[216:219], a[240:243], v[24:27]
v_exp_f32 v73, v73
v_mfma_f32_16x16x32_bf16 v[88:91], v[220:223], a[244:247], v[88:91]
ds_read_b128 v[208:211], v1 offset:12544
v_add_f32 v12, v12, v73
v_mfma_f32_16x16x32_bf16 v[88:91], v[224:227], a[248:251], v[88:91]
v_exp_f32 v74, v74
v_mfma_f32_16x16x32_bf16 v[88:91], v[228:231], a[252:255], v[88:91]
v_cvt_pk_bf16_f32 v176, v72, v73
v_add_f32 v12, v12, v74
v_mfma_f32_16x16x32_bf16 v[88:91], v[232:235], v[32:35], v[88:91]
ds_read_b128 v[212:215], v2 offset:12544
v_mfma_f32_16x16x32_bf16 v[88:91], v[236:239], v[36:39], v[88:91]
v_exp_f32 v75, v75
v_mfma_f32_16x16x32_bf16 v[92:95], v[236:239], v[60:63], v[28:31]
v_add_f32 v12, v12, v75
v_cvt_pk_bf16_f32 v177, v74, v75
v_mfma_f32_16x16x32_bf16 v[92:95], v[232:235], v[56:59], v[92:95]
v_exp_f32 v76, v76
v_mfma_f32_16x16x32_bf16 v[92:95], v[228:231], v[52:55], v[92:95]
s_add_u32 m0, s68, 3072
v_add_f32 v13, v13, v76
v_mfma_f32_16x16x32_bf16 v[92:95], v[224:227], v[48:51], v[92:95]
v_mfma_f32_16x16x32_bf16 v[92:95], v[220:223], v[44:47], v[92:95]
v_exp_f32 v77, v77
v_mfma_f32_16x16x32_bf16 v[92:95], v[216:219], v[40:43], v[92:95]
s_waitcnt lgkmcnt(0)
buffer_load_dwordx4 v7, s[4:7], s57 offen lds
v_add_f32 v13, v13, v77
v_mfma_f32_16x16x32_bf16 v[96:99], v[192:195], a[192:195], v[16:19]
v_cvt_pk_bf16_f32 v184, v76, v77
v_mfma_f32_16x16x32_bf16 v[96:99], v[196:199], a[196:199], v[96:99]
ds_read_b128 v[216:219], v1 offset:18432
v_mfma_f32_16x16x32_bf16 v[96:99], v[200:203], a[200:203], v[96:99]
v_exp_f32 v78, v78
v_mfma_f32_16x16x32_bf16 v[96:99], v[204:207], a[204:207], v[96:99]
v_add_f32 v13, v13, v78
v_mfma_f32_16x16x32_bf16 v[96:99], v[208:211], a[208:211], v[96:99]
ds_read_b128 v[220:223], v2 offset:18432
v_mfma_f32_16x16x32_bf16 v[96:99], v[212:215], a[212:215], v[96:99]
v_exp_f32 v79, v79
v_mfma_f32_16x16x32_bf16 v[100:103], v[212:215], a[236:239], v[20:23]
v_exp_f32 v80, v80
v_mfma_f32_16x16x32_bf16 v[100:103], v[208:211], a[232:235], v[100:103]
ds_read_b128 v[224:227], v1 offset:18560
v_add_f32 v13, v13, v79
v_mfma_f32_16x16x32_bf16 v[100:103], v[204:207], a[228:231], v[100:103]
v_cvt_pk_bf16_f32 v185, v78, v79
v_add_f32 v10, v10, v80
v_mfma_f32_16x16x32_bf16 v[100:103], v[200:203], a[224:227], v[100:103]
v_exp_f32 v81, v81
v_mfma_f32_16x16x32_bf16 v[100:103], v[196:199], a[220:223], v[100:103]
ds_read_b128 v[228:231], v2 offset:18560
v_add_f32 v10, v10, v81
v_mfma_f32_16x16x32_bf16 v[100:103], v[192:195], a[216:219], v[100:103]
buffer_load_dwordx4 v8, s[4:7], s57 offen offset:1024 lds
v_cvt_pk_bf16_f32 v162, v80, v81
v_mfma_f32_16x16x32_bf16 v[104:107], v[192:195], a[240:243], v[24:27]
v_exp_f32 v82, v82
v_mfma_f32_16x16x32_bf16 v[104:107], v[196:199], a[244:247], v[104:107]
ds_read_b128 v[232:235], v1 offset:18688
v_add_f32 v10, v10, v82
v_mfma_f32_16x16x32_bf16 v[104:107], v[200:203], a[248:251], v[104:107]
v_mfma_f32_16x16x32_bf16 v[104:107], v[204:207], a[252:255], v[104:107]
v_exp_f32 v83, v83
v_mfma_f32_16x16x32_bf16 v[104:107], v[208:211], v[32:35], v[104:107]
ds_read_b128 v[236:239], v2 offset:18688
v_add_f32 v10, v10, v83
v_mfma_f32_16x16x32_bf16 v[104:107], v[212:215], v[36:39], v[104:107]
v_exp_f32 v84, v84
v_mfma_f32_16x16x32_bf16 v[108:111], v[212:215], v[60:63], v[28:31]
v_cvt_pk_bf16_f32 v163, v82, v83
v_add_f32 v11, v11, v84
v_mfma_f32_16x16x32_bf16 v[108:111], v[208:211], v[56:59], v[108:111]
v_mfma_f32_16x16x32_bf16 v[108:111], v[204:207], v[52:55], v[108:111]
v_exp_f32 v85, v85
v_mfma_f32_16x16x32_bf16 v[108:111], v[200:203], v[48:51], v[108:111]
v_add_f32 v11, v11, v85
v_cvt_pk_bf16_f32 v170, v84, v85
v_mfma_f32_16x16x32_bf16 v[108:111], v[196:199], v[44:47], v[108:111]
v_mfma_f32_16x16x32_bf16 v[108:111], v[192:195], v[40:43], v[108:111]
s_waitcnt lgkmcnt(0)
buffer_load_dwordx4 v9, s[4:7], s57 offen offset:2048 lds
v_mfma_f32_16x16x32_bf16 v[112:115], v[216:219], a[192:195], v[16:19]
v_exp_f32 v86, v86
v_mfma_f32_16x16x32_bf16 v[112:115], v[220:223], a[196:199], v[112:115]
ds_read_b64_tr_b16 v[192:193], v3
v_add_f32 v11, v11, v86
v_mfma_f32_16x16x32_bf16 v[112:115], v[224:227], a[200:203], v[112:115]
ds_read_b64_tr_b16 v[194:195], v3 offset:6144
v_mfma_f32_16x16x32_bf16 v[112:115], v[228:231], a[204:207], v[112:115]
v_exp_f32 v87, v87
v_mfma_f32_16x16x32_bf16 v[112:115], v[232:235], a[208:211], v[112:115]
ds_read_b64_tr_b16 v[196:197], v3 offset:12288
v_add_f32 v11, v11, v87
v_mfma_f32_16x16x32_bf16 v[112:115], v[236:239], a[212:215], v[112:115]
ds_read_b64_tr_b16 v[198:199], v3 offset:18432
v_cvt_pk_bf16_f32 v171, v86, v87
v_mfma_f32_16x16x32_bf16 v[116:119], v[236:239], a[236:239], v[20:23]
v_exp_f32 v88, v88
v_mfma_f32_16x16x32_bf16 v[116:119], v[232:235], a[232:235], v[116:119]
ds_read_b64_tr_b16 v[200:201], v4
v_add_f32 v12, v12, v88
v_mfma_f32_16x16x32_bf16 v[116:119], v[228:231], a[228:231], v[116:119]
s_add_u32 m0, s68, 73728
ds_read_b64_tr_b16 v[202:203], v4 offset:6144
v_mfma_f32_16x16x32_bf16 v[116:119], v[224:227], a[224:227], v[116:119]
v_exp_f32 v89, v89
v_mfma_f32_16x16x32_bf16 v[116:119], v[220:223], a[220:223], v[116:119]
ds_read_b64_tr_b16 v[204:205], v4 offset:12288
v_add_f32 v12, v12, v89
v_mfma_f32_16x16x32_bf16 v[116:119], v[216:219], a[216:219], v[116:119]
ds_read_b64_tr_b16 v[206:207], v4 offset:18432
buffer_load_dwordx4 v7, s[8:11], s58 offen lds
v_mfma_f32_16x16x32_bf16 v[120:123], v[216:219], a[240:243], v[24:27]
v_exp_f32 v90, v90
v_mfma_f32_16x16x32_bf16 v[120:123], v[220:223], a[244:247], v[120:123]
ds_read_b64_tr_b16 v[208:209], v5
v_cvt_pk_bf16_f32 v178, v88, v89
v_mfma_f32_16x16x32_bf16 v[120:123], v[224:227], a[248:251], v[120:123]
ds_read_b64_tr_b16 v[210:211], v5 offset:6144
v_add_f32 v12, v12, v90
v_mfma_f32_16x16x32_bf16 v[120:123], v[228:231], a[252:255], v[120:123]
v_exp_f32 v91, v91
v_mfma_f32_16x16x32_bf16 v[120:123], v[232:235], v[32:35], v[120:123]
ds_read_b64_tr_b16 v[212:213], v5 offset:12288
v_add_f32 v12, v12, v91
v_mfma_f32_16x16x32_bf16 v[120:123], v[236:239], v[36:39], v[120:123]
ds_read_b64_tr_b16 v[214:215], v5 offset:18432
v_cvt_pk_bf16_f32 v179, v90, v91
v_mfma_f32_16x16x32_bf16 v[124:127], v[236:239], v[60:63], v[28:31]
v_exp_f32 v92, v92
v_mfma_f32_16x16x32_bf16 v[124:127], v[232:235], v[56:59], v[124:127]
v_exp_f32 v93, v93
v_mfma_f32_16x16x32_bf16 v[124:127], v[228:231], v[52:55], v[124:127]
v_add_f32 v13, v13, v92
v_add_f32 v13, v13, v93
v_mfma_f32_16x16x32_bf16 v[124:127], v[224:227], v[48:51], v[124:127]
v_exp_f32 v94, v94
v_mfma_f32_16x16x32_bf16 v[124:127], v[220:223], v[44:47], v[124:127]
v_cvt_pk_bf16_f32 v186, v92, v93
v_add_f32 v13, v13, v94
v_mfma_f32_16x16x32_bf16 v[124:127], v[216:219], v[40:43], v[124:127]
s_waitcnt lgkmcnt(8)
buffer_load_dwordx4 v8, s[8:11], s58 offen offset:1024 lds
v_mfma_f32_16x16x32_bf16 a[0:3], v[192:195], v[128:131], a[0:3]
ds_read_b64_tr_b16 v[216:217], v6
v_mfma_f32_16x16x32_bf16 a[0:3], v[196:199], v[132:135], a[0:3]
v_exp_f32 v95, v95
v_mfma_f32_16x16x32_bf16 a[4:7], v[196:199], v[140:143], a[4:7]
ds_read_b64_tr_b16 v[218:219], v6 offset:6144
v_add_f32 v13, v13, v95
v_mfma_f32_16x16x32_bf16 a[4:7], v[192:195], v[136:139], a[4:7]
v_exp_f32 v96, v96
v_mfma_f32_16x16x32_bf16 a[8:11], v[192:195], v[144:147], a[8:11]
ds_read_b64_tr_b16 v[220:221], v6 offset:12288
v_cvt_pk_bf16_f32 v187, v94, v95
v_mfma_f32_16x16x32_bf16 a[8:11], v[196:199], v[148:151], a[8:11]
v_exp_f32 v97, v97
v_mfma_f32_16x16x32_bf16 a[12:15], v[196:199], v[156:159], a[12:15]
ds_read_b64_tr_b16 v[222:223], v6 offset:18432
v_add_f32 v10, v10, v96
v_mfma_f32_16x16x32_bf16 a[12:15], v[192:195], v[152:155], a[12:15]
s_waitcnt lgkmcnt(8)
v_add_f32 v10, v10, v97
v_cvt_pk_bf16_f32 v164, v96, v97
v_mfma_f32_16x16x32_bf16 a[16:19], v[200:203], v[128:131], a[16:19]
ds_read_b64_tr_b16 v[224:225], v3 offset:128
v_mfma_f32_16x16x32_bf16 a[16:19], v[204:207], v[132:135], a[16:19]
v_exp_f32 v98, v98
v_mfma_f32_16x16x32_bf16 a[20:23], v[204:207], v[140:143], a[20:23]
ds_read_b64_tr_b16 v[226:227], v3 offset:6272
v_add_u32 v1, 24576, v1
v_mfma_f32_16x16x32_bf16 a[20:23], v[200:203], v[136:139], a[20:23]
buffer_load_dwordx4 v9, s[8:11], s58 offen offset:2048 lds
v_add_f32 v10, v10, v98
v_mfma_f32_16x16x32_bf16 a[24:27], v[200:203], v[144:147], a[24:27]
ds_read_b64_tr_b16 v[228:229], v3 offset:12416
v_add_u32 v2, 24576, v2
v_mfma_f32_16x16x32_bf16 a[24:27], v[204:207], v[148:151], a[24:27]
v_exp_f32 v99, v99
v_mfma_f32_16x16x32_bf16 a[28:31], v[204:207], v[156:159], a[28:31]
ds_read_b64_tr_b16 v[230:231], v3 offset:18560
v_add_f32 v10, v10, v99
v_mfma_f32_16x16x32_bf16 a[28:31], v[200:203], v[152:155], a[28:31]
s_waitcnt lgkmcnt(8)
v_exp_f32 v100, v100
v_mfma_f32_16x16x32_bf16 a[32:35], v[208:211], v[128:131], a[32:35]
ds_read_b64_tr_b16 v[232:233], v4 offset:128
v_cvt_pk_bf16_f32 v165, v98, v99
v_mfma_f32_16x16x32_bf16 a[32:35], v[212:215], v[132:135], a[32:35]
v_exp_f32 v101, v101
v_mfma_f32_16x16x32_bf16 a[36:39], v[212:215], v[140:143], a[36:39]
ds_read_b64_tr_b16 v[234:235], v4 offset:6272
v_add_f32 v11, v11, v100
v_mfma_f32_16x16x32_bf16 a[36:39], v[208:211], v[136:139], a[36:39]
v_exp_f32 v102, v102
v_mfma_f32_16x16x32_bf16 a[40:43], v[208:211], v[144:147], a[40:43]
s_add_u32 m0, s68, 76800
ds_read_b64_tr_b16 v[236:237], v4 offset:12416
v_add_f32 v11, v11, v101
v_mfma_f32_16x16x32_bf16 a[40:43], v[212:215], v[148:151], a[40:43]
v_cvt_pk_bf16_f32 v172, v100, v101
v_add_f32 v11, v11, v102
v_mfma_f32_16x16x32_bf16 a[44:47], v[212:215], v[156:159], a[44:47]
ds_read_b64_tr_b16 v[238:239], v4 offset:18560
v_mfma_f32_16x16x32_bf16 a[44:47], v[208:211], v[152:155], a[44:47]
s_waitcnt lgkmcnt(8)
buffer_load_dwordx4 v7, s[8:11], s59 offen lds
v_mfma_f32_16x16x32_bf16 a[48:51], v[216:219], v[128:131], a[48:51]
ds_read_b64_tr_b16 v[192:193], v5 offset:128
v_mfma_f32_16x16x32_bf16 a[48:51], v[220:223], v[132:135], a[48:51]
v_exp_f32 v103, v103
v_mfma_f32_16x16x32_bf16 a[52:55], v[220:223], v[140:143], a[52:55]
ds_read_b64_tr_b16 v[194:195], v5 offset:6272
v_add_f32 v11, v11, v103
v_mfma_f32_16x16x32_bf16 a[52:55], v[216:219], v[136:139], a[52:55]
v_exp_f32 v104, v104
v_mfma_f32_16x16x32_bf16 a[56:59], v[216:219], v[144:147], a[56:59]
ds_read_b64_tr_b16 v[196:197], v5 offset:12416
v_cvt_pk_bf16_f32 v173, v102, v103
v_mfma_f32_16x16x32_bf16 a[56:59], v[220:223], v[148:151], a[56:59]
v_exp_f32 v105, v105
v_mfma_f32_16x16x32_bf16 a[60:63], v[220:223], v[156:159], a[60:63]
ds_read_b64_tr_b16 v[198:199], v5 offset:18560
v_add_f32 v12, v12, v104
v_mfma_f32_16x16x32_bf16 a[60:63], v[216:219], v[152:155], a[60:63]
s_waitcnt lgkmcnt(8)
v_exp_f32 v106, v106
v_mfma_f32_16x16x32_bf16 a[64:67], v[224:227], v[128:131], a[64:67]
ds_read_b64_tr_b16 v[200:201], v6 offset:128
v_add_f32 v12, v12, v105
v_mfma_f32_16x16x32_bf16 a[64:67], v[228:231], v[132:135], a[64:67]
v_exp_f32 v107, v107
v_mfma_f32_16x16x32_bf16 a[68:71], v[228:231], v[140:143], a[68:71]
ds_read_b64_tr_b16 v[202:203], v6 offset:6272
v_cvt_pk_bf16_f32 v180, v104, v105
v_mfma_f32_16x16x32_bf16 a[68:71], v[224:227], v[136:139], a[68:71]
buffer_load_dwordx4 v8, s[8:11], s59 offen offset:1024 lds
v_add_f32 v12, v12, v106
v_mfma_f32_16x16x32_bf16 a[72:75], v[224:227], v[144:147], a[72:75]
ds_read_b64_tr_b16 v[204:205], v6 offset:12416
v_add_f32 v12, v12, v107
v_mfma_f32_16x16x32_bf16 a[72:75], v[228:231], v[148:151], a[72:75]
v_exp_f32 v108, v108
v_mfma_f32_16x16x32_bf16 a[76:79], v[228:231], v[156:159], a[76:79]
ds_read_b64_tr_b16 v[206:207], v6 offset:18560
v_cvt_pk_bf16_f32 v181, v106, v107
v_mfma_f32_16x16x32_bf16 a[76:79], v[224:227], v[152:155], a[76:79]
s_waitcnt lgkmcnt(8)
v_exp_f32 v109, v109
v_mfma_f32_16x16x32_bf16 a[80:83], v[232:235], v[128:131], a[80:83]
ds_read_b64_tr_b16 v[208:209], v3 offset:256
v_add_f32 v13, v13, v108
v_mfma_f32_16x16x32_bf16 a[80:83], v[236:239], v[132:135], a[80:83]
v_exp_f32 v110, v110
v_mfma_f32_16x16x32_bf16 a[84:87], v[236:239], v[140:143], a[84:87]
ds_read_b64_tr_b16 v[210:211], v3 offset:6400
v_add_f32 v13, v13, v109
v_mfma_f32_16x16x32_bf16 a[84:87], v[232:235], v[136:139], a[84:87]
v_cvt_pk_bf16_f32 v188, v108, v109
v_add_f32 v13, v13, v110
v_mfma_f32_16x16x32_bf16 a[88:91], v[232:235], v[144:147], a[88:91]
ds_read_b64_tr_b16 v[212:213], v3 offset:12544
v_mfma_f32_16x16x32_bf16 a[88:91], v[236:239], v[148:151], a[88:91]
v_exp_f32 v111, v111
v_mfma_f32_16x16x32_bf16 a[92:95], v[236:239], v[156:159], a[92:95]
ds_read_b64_tr_b16 v[214:215], v3 offset:18688
v_add_f32 v13, v13, v111
v_mfma_f32_16x16x32_bf16 a[92:95], v[232:235], v[152:155], a[92:95]
s_waitcnt lgkmcnt(8)
buffer_load_dwordx4 v9, s[8:11], s59 offen offset:2048 lds
v_cvt_pk_bf16_f32 v189, v110, v111
v_mfma_f32_16x16x32_bf16 a[96:99], v[192:195], v[128:131], a[96:99]
ds_read_b64_tr_b16 v[216:217], v4 offset:256
v_mfma_f32_16x16x32_bf16 a[96:99], v[196:199], v[132:135], a[96:99]
v_exp_f32 v112, v112
v_mfma_f32_16x16x32_bf16 a[100:103], v[196:199], v[140:143], a[100:103]
ds_read_b64_tr_b16 v[218:219], v4 offset:6400
v_add_f32 v10, v10, v112
v_mfma_f32_16x16x32_bf16 a[100:103], v[192:195], v[136:139], a[100:103]
v_exp_f32 v113, v113
v_mfma_f32_16x16x32_bf16 a[104:107], v[192:195], v[144:147], a[104:107]
ds_read_b64_tr_b16 v[220:221], v4 offset:12544
v_add_f32 v10, v10, v113
v_mfma_f32_16x16x32_bf16 a[104:107], v[196:199], v[148:151], a[104:107]
v_exp_f32 v114, v114
v_mfma_f32_16x16x32_bf16 a[108:111], v[196:199], v[156:159], a[108:111]
ds_read_b64_tr_b16 v[222:223], v4 offset:18688
v_cvt_pk_bf16_f32 v166, v112, v113
v_mfma_f32_16x16x32_bf16 a[108:111], v[192:195], v[152:155], a[108:111]
s_waitcnt lgkmcnt(8)
v_exp_f32 v115, v115
v_mfma_f32_16x16x32_bf16 a[112:115], v[200:203], v[128:131], a[112:115]
s_add_u32 s56, s56, 24576
ds_read_b64_tr_b16 v[224:225], v5 offset:256
v_add_f32 v10, v10, v114
v_mfma_f32_16x16x32_bf16 a[112:115], v[204:207], v[132:135], a[112:115]
v_exp_f32 v116, v116
v_mfma_f32_16x16x32_bf16 a[116:119], v[204:207], v[140:143], a[116:119]
ds_read_b64_tr_b16 v[226:227], v5 offset:6400
v_add_f32 v10, v10, v115
v_mfma_f32_16x16x32_bf16 a[116:119], v[200:203], v[136:139], a[116:119]
v_cvt_pk_bf16_f32 v167, v114, v115
v_add_f32 v11, v11, v116
v_mfma_f32_16x16x32_bf16 a[120:123], v[200:203], v[144:147], a[120:123]
ds_read_b64_tr_b16 v[228:229], v5 offset:12544
v_mfma_f32_16x16x32_bf16 a[120:123], v[204:207], v[148:151], a[120:123]
v_exp_f32 v117, v117
v_mfma_f32_16x16x32_bf16 a[124:127], v[204:207], v[156:159], a[124:127]
ds_read_b64_tr_b16 v[230:231], v5 offset:18688
v_add_f32 v11, v11, v117
v_mfma_f32_16x16x32_bf16 a[124:127], v[200:203], v[152:155], a[124:127]
s_waitcnt lgkmcnt(8)
v_exp_f32 v118, v118
v_mfma_f32_16x16x32_bf16 a[128:131], v[208:211], v[128:131], a[128:131]
ds_read_b64_tr_b16 v[232:233], v6 offset:256
v_cvt_pk_bf16_f32 v174, v116, v117
v_mfma_f32_16x16x32_bf16 a[128:131], v[212:215], v[132:135], a[128:131]
v_add_f32 v11, v11, v118
v_mfma_f32_16x16x32_bf16 a[132:135], v[212:215], v[140:143], a[132:135]
ds_read_b64_tr_b16 v[234:235], v6 offset:6400
v_mfma_f32_16x16x32_bf16 a[132:135], v[208:211], v[136:139], a[132:135]
v_exp_f32 v119, v119
v_mfma_f32_16x16x32_bf16 a[136:139], v[208:211], v[144:147], a[136:139]
ds_read_b64_tr_b16 v[236:237], v6 offset:12544
v_add_f32 v11, v11, v119
v_mfma_f32_16x16x32_bf16 a[136:139], v[212:215], v[148:151], a[136:139]
v_exp_f32 v120, v120
v_mfma_f32_16x16x32_bf16 a[140:143], v[212:215], v[156:159], a[140:143]
ds_read_b64_tr_b16 v[238:239], v6 offset:18688
v_cvt_pk_bf16_f32 v175, v118, v119
v_mfma_f32_16x16x32_bf16 a[140:143], v[208:211], v[152:155], a[140:143]
s_waitcnt lgkmcnt(8)
v_exp_f32 v121, v121
v_mfma_f32_16x16x32_bf16 a[144:147], v[216:219], v[128:131], a[144:147]
v_add_f32 v12, v12, v120
v_add_f32 v12, v12, v121
v_mfma_f32_16x16x32_bf16 a[144:147], v[220:223], v[132:135], a[144:147]
v_cvt_pk_bf16_f32 v182, v120, v121
v_mfma_f32_16x16x32_bf16 a[148:151], v[220:223], v[140:143], a[148:151]
v_exp_f32 v122, v122
v_mfma_f32_16x16x32_bf16 a[148:151], v[216:219], v[136:139], a[148:151]
v_add_f32 v12, v12, v122
v_mfma_f32_16x16x32_bf16 a[152:155], v[216:219], v[144:147], a[152:155]
v_mfma_f32_16x16x32_bf16 a[152:155], v[220:223], v[148:151], a[152:155]
v_exp_f32 v123, v123
v_mfma_f32_16x16x32_bf16 a[156:159], v[220:223], v[156:159], a[156:159]
v_add_f32 v12, v12, v123
v_cvt_pk_bf16_f32 v183, v122, v123
v_mfma_f32_16x16x32_bf16 a[156:159], v[216:219], v[152:155], a[156:159]
s_waitcnt lgkmcnt(4)
v_exp_f32 v124, v124
v_mfma_f32_16x16x32_bf16 a[160:163], v[224:227], v[128:131], a[160:163]
s_waitcnt vmcnt(12) lgkmcnt(0)
s_barrier
v_add_f32 v13, v13, v124
v_mfma_f32_16x16x32_bf16 a[160:163], v[228:231], v[132:135], a[160:163]
ds_read_b128 v[192:195], v1
v_mfma_f32_16x16x32_bf16 a[164:167], v[228:231], v[140:143], a[164:167]
v_add_u32 v3, 24576, v3
v_mfma_f32_16x16x32_bf16 a[164:167], v[224:227], v[136:139], a[164:167]
ds_read_b128 v[196:199], v2
v_mfma_f32_16x16x32_bf16 a[168:171], v[224:227], v[144:147], a[168:171]
v_add_u32 v4, 24576, v4
v_mfma_f32_16x16x32_bf16 a[168:171], v[228:231], v[148:151], a[168:171]
ds_read_b128 v[200:203], v1 offset:128
v_mfma_f32_16x16x32_bf16 a[172:175], v[228:231], v[156:159], a[172:175]
v_add_u32 v5, 24576, v5
v_mfma_f32_16x16x32_bf16 a[172:175], v[224:227], v[152:155], a[172:175]
s_waitcnt lgkmcnt(3)
ds_read_b128 v[204:207], v2 offset:128
v_mfma_f32_16x16x32_bf16 a[176:179], v[232:235], v[128:131], a[176:179]
v_add_u32 v6, 24576, v6
v_mfma_f32_16x16x32_bf16 a[176:179], v[236:239], v[132:135], a[176:179]
ds_read_b128 v[208:211], v1 offset:256
v_mfma_f32_16x16x32_bf16 a[180:183], v[236:239], v[140:143], a[180:183]
v_exp_f32 v125, v125
v_mfma_f32_16x16x32_bf16 a[180:183], v[232:235], v[136:139], a[180:183]
ds_read_b128 v[212:215], v2 offset:256
v_add_f32 v13, v13, v125
v_mfma_f32_16x16x32_bf16 a[184:187], v[232:235], v[144:147], a[184:187]
v_exp_f32 v126, v126
v_mfma_f32_16x16x32_bf16 a[184:187], v[236:239], v[148:151], a[184:187]
v_exp_f32 v127, v127
v_mfma_f32_16x16x32_bf16 a[188:191], v[236:239], v[156:159], a[188:191]
v_cvt_pk_bf16_f32 v190, v124, v125
v_add_f32 v13, v13, v126
v_mfma_f32_16x16x32_bf16 a[188:191], v[232:235], v[152:155], a[188:191]
s_waitcnt lgkmcnt(4)
v_add_f32 v13, v13, v127
v_cvt_pk_bf16_f32 v191, v126, v127
s_branch L_loop
L_tail:
v_mfma_f32_16x16x32_bf16 v[64:67], v[192:195], a[192:195], v[16:19]
v_mfma_f32_16x16x32_bf16 v[64:67], v[196:199], a[196:199], v[64:67]
s_waitcnt lgkmcnt(2)
ds_read_b128 v[216:219], v1 offset:6144
v_mfma_f32_16x16x32_bf16 v[64:67], v[200:203], a[200:203], v[64:67]
buffer_load_dwordx2 v[14:15], v253, s[20:23], s14 offen sc1
v_mfma_f32_16x16x32_bf16 v[64:67], v[204:207], a[204:207], v[64:67]
s_waitcnt lgkmcnt(1)
v_mfma_f32_16x16x32_bf16 v[64:67], v[208:211], a[208:211], v[64:67]
s_lshl_b32 s64, s3, 1
s_add_u32 s64, s64, s76
ds_read_b128 v[220:223], v2 offset:6144
v_mfma_f32_16x16x32_bf16 v[64:67], v[212:215], a[212:215], v[64:67]
s_mul_i32 s65, s77, 40960
s_mul_i32 s66, s73, 320
s_add_u32 s65, s65, s66
v_mfma_f32_16x16x32_bf16 v[68:71], v[212:215], a[236:239], v[20:23]
s_mul_i32 s58, s64, 245760
s_add_u32 s58, s58, s65
s_mul_i32 s15, s64, 983040
v_mfma_f32_16x16x32_bf16 v[68:71], v[208:211], a[232:235], v[68:71]
s_add_u32 s15, s15, s65
s_mul_i32 s65, s13, 3840
ds_read_b128 v[224:227], v1 offset:6272
v_mfma_f32_16x16x32_bf16 v[68:71], v[204:207], a[228:231], v[68:71]
s_add_u32 s65, s65, 4194304
s_mul_i32 s56, s64, 6144
s_add_u32 s56, s56, s65
v_mfma_f32_16x16x32_bf16 v[68:71], v[200:203], a[224:227], v[68:71]
s_add_u32 s56, s56, 196608
s_mul_i32 s75, s64, 24576
s_add_u32 s75, s75, s65
v_mfma_f32_16x16x32_bf16 v[68:71], v[196:199], a[220:223], v[68:71]
s_mul_i32 s61, s52, 10240
s_add_u32 s24, s3, 0
ds_read_b128 v[228:231], v2 offset:6272
v_mfma_f32_16x16x32_bf16 v[68:71], v[192:195], a[216:219], v[68:71]
s_and_b32 s24, s24, 3
s_mul_i32 s24, s24, 245760
s_add_u32 s25, s3, 1
v_mfma_f32_16x16x32_bf16 v[72:75], v[192:195], a[240:243], v[24:27]
s_and_b32 s25, s25, 3
s_mul_i32 s25, s25, 245760
s_add_u32 s26, s3, 2
v_mfma_f32_16x16x32_bf16 v[72:75], v[196:199], a[244:247], v[72:75]
s_and_b32 s26, s26, 3
s_mul_i32 s26, s26, 245760
ds_read_b128 v[232:235], v1 offset:6400
v_mfma_f32_16x16x32_bf16 v[72:75], v[200:203], a[248:251], v[72:75]
s_add_u32 s27, s3, 3
s_and_b32 s27, s27, 3
s_mul_i32 s27, s27, 245760
v_mfma_f32_16x16x32_bf16 v[72:75], v[204:207], a[252:255], v[72:75]
v_exp_f32 v64, v64
v_mfma_f32_16x16x32_bf16 v[72:75], v[208:211], v[32:35], v[72:75]
ds_read_b128 v[236:239], v2 offset:6400
v_add_f32 v10, v10, v64
v_mfma_f32_16x16x32_bf16 v[72:75], v[212:215], v[36:39], v[72:75]
v_exp_f32 v65, v65
v_mfma_f32_16x16x32_bf16 v[76:79], v[212:215], v[60:63], v[28:31]
v_exp_f32 v66, v66
v_mfma_f32_16x16x32_bf16 v[76:79], v[208:211], v[56:59], v[76:79]
v_exp_f32 v67, v67
v_mfma_f32_16x16x32_bf16 v[76:79], v[204:207], v[52:55], v[76:79]
v_exp_f32 v68, v68
v_mfma_f32_16x16x32_bf16 v[76:79], v[200:203], v[48:51], v[76:79]
v_add_f32 v10, v10, v65
v_cvt_pk_bf16_f32 v160, v64, v65
v_mfma_f32_16x16x32_bf16 v[76:79], v[196:199], v[44:47], v[76:79]
v_exp_f32 v69, v69
v_mfma_f32_16x16x32_bf16 v[76:79], v[192:195], v[40:43], v[76:79]
s_waitcnt lgkmcnt(0)
v_add_f32 v10, v10, v66
v_add_f32 v10, v10, v67
v_mfma_f32_16x16x32_bf16 v[80:83], v[216:219], a[192:195], v[16:19]
v_cvt_pk_bf16_f32 v161, v66, v67
v_add_f32 v11, v11, v68
v_mfma_f32_16x16x32_bf16 v[80:83], v[220:223], a[196:199], v[80:83]
ds_read_b128 v[192:195], v1 offset:12288
v_add_f32 v11, v11, v69
v_mfma_f32_16x16x32_bf16 v[80:83], v[224:227], a[200:203], v[80:83]
v_exp_f32 v70, v70
v_mfma_f32_16x16x32_bf16 v[80:83], v[228:231], a[204:207], v[80:83]
v_exp_f32 v71, v71
v_mfma_f32_16x16x32_bf16 v[80:83], v[232:235], a[208:211], v[80:83]
ds_read_b128 v[196:199], v2 offset:12288
v_cvt_pk_bf16_f32 v168, v68, v69
v_mfma_f32_16x16x32_bf16 v[80:83], v[236:239], a[212:215], v[80:83]
v_exp_f32 v72, v72
v_mfma_f32_16x16x32_bf16 v[84:87], v[236:239], a[236:239], v[20:23]
v_add_f32 v11, v11, v70
v_add_f32 v11, v11, v71
v_mfma_f32_16x16x32_bf16 v[84:87], v[232:235], a[232:235], v[84:87]
ds_read_b128 v[200:203], v1 offset:12416
v_cvt_pk_bf16_f32 v169, v70, v71
v_mfma_f32_16x16x32_bf16 v[84:87], v[228:231], a[228:231], v[84:87]
v_exp_f32 v73, v73
v_mfma_f32_16x16x32_bf16 v[84:87], v[224:227], a[224:227], v[84:87]
v_add_f32 v12, v12, v72
v_add_f32 v12, v12, v73
v_mfma_f32_16x16x32_bf16 v[84:87], v[220:223], a[220:223], v[84:87]
ds_read_b128 v[204:207], v2 offset:12416
v_cvt_pk_bf16_f32 v176, v72, v73
v_mfma_f32_16x16x32_bf16 v[84:87], v[216:219], a[216:219], v[84:87]
v_exp_f32 v74, v74
v_mfma_f32_16x16x32_bf16 v[88:91], v[216:219], a[240:243], v[24:27]
v_exp_f32 v75, v75
v_mfma_f32_16x16x32_bf16 v[88:91], v[220:223], a[244:247], v[88:91]
ds_read_b128 v[208:211], v1 offset:12544
v_add_f32 v12, v12, v74
v_mfma_f32_16x16x32_bf16 v[88:91], v[224:227], a[248:251], v[88:91]
v_add_f32 v12, v12, v75
v_cvt_pk_bf16_f32 v177, v74, v75
v_mfma_f32_16x16x32_bf16 v[88:91], v[228:231], a[252:255], v[88:91]
v_exp_f32 v76, v76
v_mfma_f32_16x16x32_bf16 v[88:91], v[232:235], v[32:35], v[88:91]
ds_read_b128 v[212:215], v2 offset:12544
v_add_f32 v13, v13, v76
v_mfma_f32_16x16x32_bf16 v[88:91], v[236:239], v[36:39], v[88:91]
v_exp_f32 v77, v77
v_mfma_f32_16x16x32_bf16 v[92:95], v[236:239], v[60:63], v[28:31]
v_add_f32 v13, v13, v77
v_cvt_pk_bf16_f32 v184, v76, v77
v_mfma_f32_16x16x32_bf16 v[92:95], v[232:235], v[56:59], v[92:95]
v_exp_f32 v78, v78
v_mfma_f32_16x16x32_bf16 v[92:95], v[228:231], v[52:55], v[92:95]
v_add_f32 v13, v13, v78
v_mfma_f32_16x16x32_bf16 v[92:95], v[224:227], v[48:51], v[92:95]
v_mfma_f32_16x16x32_bf16 v[92:95], v[220:223], v[44:47], v[92:95]
v_exp_f32 v79, v79
v_mfma_f32_16x16x32_bf16 v[92:95], v[216:219], v[40:43], v[92:95]
s_waitcnt lgkmcnt(0)
v_add_f32 v13, v13, v79
v_cvt_pk_bf16_f32 v185, v78, v79
v_mfma_f32_16x16x32_bf16 v[96:99], v[192:195], a[192:195], v[16:19]
v_exp_f32 v80, v80
v_mfma_f32_16x16x32_bf16 v[96:99], v[196:199], a[196:199], v[96:99]
ds_read_b128 v[216:219], v1 offset:18432
v_add_f32 v10, v10, v80
v_mfma_f32_16x16x32_bf16 v[96:99], v[200:203], a[200:203], v[96:99]
v_exp_f32 v81, v81
v_mfma_f32_16x16x32_bf16 v[96:99], v[204:207], a[204:207], v[96:99]
v_add_f32 v10, v10, v81
v_cvt_pk_bf16_f32 v162, v80, v81
v_mfma_f32_16x16x32_bf16 v[96:99], v[208:211], a[208:211], v[96:99]
ds_read_b128 v[220:223], v2 offset:18432
v_mfma_f32_16x16x32_bf16 v[96:99], v[212:215], a[212:215], v[96:99]
v_exp_f32 v82, v82
v_mfma_f32_16x16x32_bf16 v[100:103], v[212:215], a[236:239], v[20:23]
v_add_f32 v10, v10, v82
v_mfma_f32_16x16x32_bf16 v[100:103], v[208:211], a[232:235], v[100:103]
ds_read_b128 v[224:227], v1 offset:18560
v_mfma_f32_16x16x32_bf16 v[100:103], v[204:207], a[228:231], v[100:103]
v_exp_f32 v83, v83
v_mfma_f32_16x16x32_bf16 v[100:103], v[200:203], a[224:227], v[100:103]
v_exp_f32 v84, v84
v_mfma_f32_16x16x32_bf16 v[100:103], v[196:199], a[220:223], v[100:103]
ds_read_b128 v[228:231], v2 offset:18560
v_add_f32 v10, v10, v83
v_mfma_f32_16x16x32_bf16 v[100:103], v[192:195], a[216:219], v[100:103]
v_cvt_pk_bf16_f32 v163, v82, v83
v_add_f32 v11, v11, v84
v_mfma_f32_16x16x32_bf16 v[104:107], v[192:195], a[240:243], v[24:27]
v_exp_f32 v85, v85
v_mfma_f32_16x16x32_bf16 v[104:107], v[196:199], a[244:247], v[104:107]
ds_read_b128 v[232:235], v1 offset:18688
v_add_f32 v11, v11, v85
v_mfma_f32_16x16x32_bf16 v[104:107], v[200:203], a[248:251], v[104:107]
v_exp_f32 v86, v86
v_mfma_f32_16x16x32_bf16 v[104:107], v[204:207], a[252:255], v[104:107]
v_cvt_pk_bf16_f32 v170, v84, v85
v_add_f32 v11, v11, v86
v_mfma_f32_16x16x32_bf16 v[104:107], v[208:211], v[32:35], v[104:107]
ds_read_b128 v[236:239], v2 offset:18688
v_mfma_f32_16x16x32_bf16 v[104:107], v[212:215], v[36:39], v[104:107]
v_exp_f32 v87, v87
v_mfma_f32_16x16x32_bf16 v[108:111], v[212:215], v[60:63], v[28:31]
v_add_f32 v11, v11, v87
v_cvt_pk_bf16_f32 v171, v86, v87
v_mfma_f32_16x16x32_bf16 v[108:111], v[208:211], v[56:59], v[108:111]
v_exp_f32 v88, v88
v_mfma_f32_16x16x32_bf16 v[108:111], v[204:207], v[52:55], v[108:111]
v_add_f32 v12, v12, v88
v_mfma_f32_16x16x32_bf16 v[108:111], v[200:203], v[48:51], v[108:111]
v_exp_f32 v89, v89
v_mfma_f32_16x16x32_bf16 v[108:111], v[196:199], v[44:47], v[108:111]
v_add_f32 v12, v12, v89
v_cvt_pk_bf16_f32 v178, v88, v89
v_mfma_f32_16x16x32_bf16 v[108:111], v[192:195], v[40:43], v[108:111]
s_waitcnt lgkmcnt(0)
v_exp_f32 v90, v90
v_mfma_f32_16x16x32_bf16 v[112:115], v[216:219], a[192:195], v[16:19]
v_add_f32 v12, v12, v90
v_mfma_f32_16x16x32_bf16 v[112:115], v[220:223], a[196:199], v[112:115]
ds_read_b64_tr_b16 v[192:193], v3
v_mfma_f32_16x16x32_bf16 v[112:115], v[224:227], a[200:203], v[112:115]
ds_read_b64_tr_b16 v[194:195], v3 offset:6144
v_mfma_f32_16x16x32_bf16 v[112:115], v[228:231], a[204:207], v[112:115]
v_exp_f32 v91, v91
v_mfma_f32_16x16x32_bf16 v[112:115], v[232:235], a[208:211], v[112:115]
ds_read_b64_tr_b16 v[196:197], v3 offset:12288
v_add_f32 v12, v12, v91
v_mfma_f32_16x16x32_bf16 v[112:115], v[236:239], a[212:215], v[112:115]
ds_read_b64_tr_b16 v[198:199], v3 offset:18432
v_cvt_pk_bf16_f32 v179, v90, v91
v_mfma_f32_16x16x32_bf16 v[116:119], v[236:239], a[236:239], v[20:23]
v_exp_f32 v92, v92
v_mfma_f32_16x16x32_bf16 v[116:119], v[232:235], a[232:235], v[116:119]
ds_read_b64_tr_b16 v[200:201], v4
v_add_f32 v13, v13, v92
v_mfma_f32_16x16x32_bf16 v[116:119], v[228:231], a[228:231], v[116:119]
ds_read_b64_tr_b16 v[202:203], v4 offset:6144
v_mfma_f32_16x16x32_bf16 v[116:119], v[224:227], a[224:227], v[116:119]
v_exp_f32 v93, v93
v_mfma_f32_16x16x32_bf16 v[116:119], v[220:223], a[220:223], v[116:119]
ds_read_b64_tr_b16 v[204:205], v4 offset:12288
v_add_f32 v13, v13, v93
v_mfma_f32_16x16x32_bf16 v[116:119], v[216:219], a[216:219], v[116:119]
ds_read_b64_tr_b16 v[206:207], v4 offset:18432
v_cvt_pk_bf16_f32 v186, v92, v93
v_mfma_f32_16x16x32_bf16 v[120:123], v[216:219], a[240:243], v[24:27]
v_exp_f32 v94, v94
v_mfma_f32_16x16x32_bf16 v[120:123], v[220:223], a[244:247], v[120:123]
ds_read_b64_tr_b16 v[208:209], v5
v_add_f32 v13, v13, v94
v_mfma_f32_16x16x32_bf16 v[120:123], v[224:227], a[248:251], v[120:123]
ds_read_b64_tr_b16 v[210:211], v5 offset:6144
v_mfma_f32_16x16x32_bf16 v[120:123], v[228:231], a[252:255], v[120:123]
v_exp_f32 v95, v95
v_mfma_f32_16x16x32_bf16 v[120:123], v[232:235], v[32:35], v[120:123]
ds_read_b64_tr_b16 v[212:213], v5 offset:12288
v_add_f32 v13, v13, v95
v_mfma_f32_16x16x32_bf16 v[120:123], v[236:239], v[36:39], v[120:123]
ds_read_b64_tr_b16 v[214:215], v5 offset:18432
v_cvt_pk_bf16_f32 v187, v94, v95
v_mfma_f32_16x16x32_bf16 v[124:127], v[236:239], v[60:63], v[28:31]
v_exp_f32 v96, v96
v_mfma_f32_16x16x32_bf16 v[124:127], v[232:235], v[56:59], v[124:127]
v_exp_f32 v97, v97
v_mfma_f32_16x16x32_bf16 v[124:127], v[228:231], v[52:55], v[124:127]
s_waitcnt vmcnt(0)
s_barrier
v_add_f32 v10, v10, v96
v_mfma_f32_16x16x32_bf16 v[124:127], v[224:227], v[48:51], v[124:127]
v_exp_f32 v98, v98
v_mfma_f32_16x16x32_bf16 v[124:127], v[220:223], v[44:47], v[124:127]
v_exp_f32 v99, v99
v_cmp_ne_u32 vcc, s70, v14
v_cmp_ne_u32 s[64:65], s71, v15
s_nop 0
s_or_b32 s64, vcc_lo, s64
s_and_b32 s64, s64, s60
s_cmp_lg_u32 s64, 0
s_cbranch_scc1 L_o1
L_o1_r:
v_mfma_f32_16x16x32_bf16 v[124:127], v[216:219], v[40:43], v[124:127]
s_waitcnt lgkmcnt(8)
v_exp_f32 v100, v100
v_mfma_f32_16x16x32_bf16 a[0:3], v[192:195], v[128:131], a[0:3]
s_add_u32 s62, s61, 0
s_add_u32 s59, s58, 20480
ds_read_b64_tr_b16 v[216:217], v6
v_mfma_f32_16x16x32_bf16 a[0:3], v[196:199], v[132:135], a[0:3]
s_add_u32 m0, s62, 0
v_exp_f32 v101, v101
v_mfma_f32_16x16x32_bf16 a[4:7], v[196:199], v[140:143], a[4:7]
ds_read_b64_tr_b16 v[218:219], v6 offset:6144
buffer_load_dwordx4 v240, s[48:51], s58 offen lds
v_mfma_f32_16x16x32_bf16 a[4:7], v[192:195], v[136:139], a[4:7]
v_add_f32 v10, v10, v97
v_cvt_pk_bf16_f32 v164, v96, v97
v_mfma_f32_16x16x32_bf16 a[8:11], v[192:195], v[144:147], a[8:11]
ds_read_b64_tr_b16 v[220:221], v6 offset:12288
v_add_f32 v10, v10, v98
v_mfma_f32_16x16x32_bf16 a[8:11], v[196:199], v[148:151], a[8:11]
buffer_load_dwordx4 v241, s[48:51], s58 offen offset:1024 lds
v_add_f32 v10, v10, v99
v_mfma_f32_16x16x32_bf16 a[12:15], v[196:199], v[156:159], a[12:15]
ds_read_b64_tr_b16 v[222:223], v6 offset:18432
v_cvt_pk_bf16_f32 v165, v98, v99
v_mfma_f32_16x16x32_bf16 a[12:15], v[192:195], v[152:155], a[12:15]
s_waitcnt lgkmcnt(8)
v_exp_f32 v102, v102
v_mfma_f32_16x16x32_bf16 a[16:19], v[200:203], v[128:131], a[16:19]
ds_read_b64_tr_b16 v[224:225], v3 offset:128
v_add_f32 v11, v11, v100
v_mfma_f32_16x16x32_bf16 a[16:19], v[204:207], v[132:135], a[16:19]
v_exp_f32 v103, v103
v_mfma_f32_16x16x32_bf16 a[20:23], v[204:207], v[140:143], a[20:23]
ds_read_b64_tr_b16 v[226:227], v3 offset:6272
buffer_load_dwordx4 v242, s[48:51], s58 offen offset:2048 lds
v_mfma_f32_16x16x32_bf16 a[20:23], v[200:203], v[136:139], a[20:23]
v_exp_f32 v104, v104
v_mfma_f32_16x16x32_bf16 a[24:27], v[200:203], v[144:147], a[24:27]
ds_read_b64_tr_b16 v[228:229], v3 offset:12416
v_add_f32 v11, v11, v101
v_mfma_f32_16x16x32_bf16 a[24:27], v[204:207], v[148:151], a[24:27]
v_exp_f32 v105, v105
v_mfma_f32_16x16x32_bf16 a[28:31], v[204:207], v[156:159], a[28:31]
ds_read_b64_tr_b16 v[230:231], v3 offset:18560
buffer_load_dwordx4 v243, s[48:51], s58 offen offset:3072 lds
v_mfma_f32_16x16x32_bf16 a[28:31], v[200:203], v[152:155], a[28:31]
s_waitcnt lgkmcnt(8)
s_add_u32 m0, s62, 4096
v_cvt_pk_bf16_f32 v172, v100, v101
v_mfma_f32_16x16x32_bf16 a[32:35], v[208:211], v[128:131], a[32:35]
ds_read_b64_tr_b16 v[232:233], v4 offset:128
v_add_f32 v11, v11, v102
v_mfma_f32_16x16x32_bf16 a[32:35], v[212:215], v[132:135], a[32:35]
v_exp_f32 v106, v106
v_mfma_f32_16x16x32_bf16 a[36:39], v[212:215], v[140:143], a[36:39]
ds_read_b64_tr_b16 v[234:235], v4 offset:6272
v_add_f32 v11, v11, v103
v_mfma_f32_16x16x32_bf16 a[36:39], v[208:211], v[136:139], a[36:39]
buffer_load_dwordx4 v244, s[48:51], s58 offen lds
v_cvt_pk_bf16_f32 v173, v102, v103
v_mfma_f32_16x16x32_bf16 a[40:43], v[208:211], v[144:147], a[40:43]
s_add_u32 m0, s62, 5120
ds_read_b64_tr_b16 v[236:237], v4 offset:12416
v_add_f32 v12, v12, v104
v_mfma_f32_16x16x32_bf16 a[40:43], v[212:215], v[148:151], a[40:43]
v_exp_f32 v107, v107
v_mfma_f32_16x16x32_bf16 a[44:47], v[212:215], v[156:159], a[44:47]
ds_read_b64_tr_b16 v[238:239], v4 offset:18560
v_add_f32 v12, v12, v105
v_mfma_f32_16x16x32_bf16 a[44:47], v[208:211], v[152:155], a[44:47]
s_waitcnt lgkmcnt(8)
buffer_load_dwordx4 v240, s[48:51], s59 offen lds
v_cvt_pk_bf16_f32 v180, v104, v105
v_mfma_f32_16x16x32_bf16 a[48:51], v[216:219], v[128:131], a[48:51]
ds_read_b64_tr_b16 v[192:193], v5 offset:128
v_add_f32 v12, v12, v106
v_mfma_f32_16x16x32_bf16 a[48:51], v[220:223], v[132:135], a[48:51]
v_exp_f32 v108, v108
v_mfma_f32_16x16x32_bf16 a[52:55], v[220:223], v[140:143], a[52:55]
ds_read_b64_tr_b16 v[194:195], v5 offset:6272
v_add_f32 v12, v12, v107
v_mfma_f32_16x16x32_bf16 a[52:55], v[216:219], v[136:139], a[52:55]
v_exp_f32 v109, v109
v_mfma_f32_16x16x32_bf16 a[56:59], v[216:219], v[144:147], a[56:59]
ds_read_b64_tr_b16 v[196:197], v5 offset:12416
buffer_load_dwordx4 v241, s[48:51], s59 offen offset:1024 lds
v_mfma_f32_16x16x32_bf16 a[56:59], v[220:223], v[148:151], a[56:59]
v_exp_f32 v110, v110
v_mfma_f32_16x16x32_bf16 a[60:63], v[220:223], v[156:159], a[60:63]
ds_read_b64_tr_b16 v[198:199], v5 offset:18560
v_cvt_pk_bf16_f32 v181, v106, v107
v_mfma_f32_16x16x32_bf16 a[60:63], v[216:219], v[152:155], a[60:63]
s_waitcnt lgkmcnt(8)
v_exp_f32 v111, v111
v_mfma_f32_16x16x32_bf16 a[64:67], v[224:227], v[128:131], a[64:67]
ds_read_b64_tr_b16 v[200:201], v6 offset:128
buffer_load_dwordx4 v242, s[48:51], s59 offen offset:2048 lds
v_mfma_f32_16x16x32_bf16 a[64:67], v[228:231], v[132:135], a[64:67]
v_exp_f32 v112, v112
v_mfma_f32_16x16x32_bf16 a[68:71], v[228:231], v[140:143], a[68:71]
ds_read_b64_tr_b16 v[202:203], v6 offset:6272
v_add_f32 v13, v13, v108
v_mfma_f32_16x16x32_bf16 a[68:71], v[224:227], v[136:139], a[68:71]
v_exp_f32 v113, v113
v_mfma_f32_16x16x32_bf16 a[72:75], v[224:227], v[144:147], a[72:75]
ds_read_b64_tr_b16 v[204:205], v6 offset:12416
v_add_f32 v13, v13, v109
v_mfma_f32_16x16x32_bf16 a[72:75], v[228:231], v[148:151], a[72:75]
buffer_load_dwordx4 v243, s[48:51], s59 offen offset:3072 lds
v_cvt_pk_bf16_f32 v188, v108, v109
v_mfma_f32_16x16x32_bf16 a[76:79], v[228:231], v[156:159], a[76:79]
s_add_u32 m0, s62, 9216
ds_read_b64_tr_b16 v[206:207], v6 offset:18560
v_add_f32 v13, v13, v110
v_mfma_f32_16x16x32_bf16 a[76:79], v[224:227], v[152:155], a[76:79]
s_waitcnt lgkmcnt(8)
v_exp_f32 v114, v114
v_mfma_f32_16x16x32_bf16 a[80:83], v[232:235], v[128:131], a[80:83]
ds_read_b64_tr_b16 v[208:209], v3 offset:256
v_add_f32 v13, v13, v111
v_mfma_f32_16x16x32_bf16 a[80:83], v[236:239], v[132:135], a[80:83]
buffer_load_dwordx4 v244, s[48:51], s59 offen lds
v_cvt_pk_bf16_f32 v189, v110, v111
v_mfma_f32_16x16x32_bf16 a[84:87], v[236:239], v[140:143], a[84:87]
s_add_u32 s58, s58, 81920
s_add_u32 s62, s61, 40960
ds_read_b64_tr_b16 v[210:211], v3 offset:6400
v_mfma_f32_16x16x32_bf16 a[84:87], v[232:235], v[136:139], a[84:87]
s_add_u32 s59, s58, 20480
s_add_u32 m0, s62, 0
v_add_f32 v10, v10, v112
v_mfma_f32_16x16x32_bf16 a[88:91], v[232:235], v[144:147], a[88:91]
ds_read_b64_tr_b16 v[212:213], v3 offset:12544
v_add_f32 v10, v10, v113
v_mfma_f32_16x16x32_bf16 a[88:91], v[236:239], v[148:151], a[88:91]
v_exp_f32 v115, v115
v_mfma_f32_16x16x32_bf16 a[92:95], v[236:239], v[156:159], a[92:95]
ds_read_b64_tr_b16 v[214:215], v3 offset:18688
buffer_load_dwordx4 v240, s[48:51], s58 offen lds
v_mfma_f32_16x16x32_bf16 a[92:95], v[232:235], v[152:155], a[92:95]
s_waitcnt lgkmcnt(8)
v_exp_f32 v116, v116
v_mfma_f32_16x16x32_bf16 a[96:99], v[192:195], v[128:131], a[96:99]
ds_read_b64_tr_b16 v[216:217], v4 offset:256
v_cvt_pk_bf16_f32 v166, v112, v113
v_mfma_f32_16x16x32_bf16 a[96:99], v[196:199], v[132:135], a[96:99]
v_exp_f32 v117, v117
v_mfma_f32_16x16x32_bf16 a[100:103], v[196:199], v[140:143], a[100:103]
ds_read_b64_tr_b16 v[218:219], v4 offset:6400
v_add_f32 v10, v10, v114
v_mfma_f32_16x16x32_bf16 a[100:103], v[192:195], v[136:139], a[100:103]
buffer_load_dwordx4 v241, s[48:51], s58 offen offset:1024 lds
v_add_f32 v10, v10, v115
v_mfma_f32_16x16x32_bf16 a[104:107], v[192:195], v[144:147], a[104:107]
ds_read_b64_tr_b16 v[220:221], v4 offset:12544
v_cvt_pk_bf16_f32 v167, v114, v115
v_mfma_f32_16x16x32_bf16 a[104:107], v[196:199], v[148:151], a[104:107]
v_exp_f32 v118, v118
v_mfma_f32_16x16x32_bf16 a[108:111], v[196:199], v[156:159], a[108:111]
ds_read_b64_tr_b16 v[222:223], v4 offset:18688
v_add_f32 v11, v11, v116
v_mfma_f32_16x16x32_bf16 a[108:111], v[192:195], v[152:155], a[108:111]
s_waitcnt lgkmcnt(8)
buffer_load_dwordx4 v242, s[48:51], s58 offen offset:2048 lds
v_add_f32 v11, v11, v117
v_mfma_f32_16x16x32_bf16 a[112:115], v[200:203], v[128:131], a[112:115]
ds_read_b64_tr_b16 v[224:225], v5 offset:256
v_cvt_pk_bf16_f32 v174, v116, v117
v_mfma_f32_16x16x32_bf16 a[112:115], v[204:207], v[132:135], a[112:115]
v_exp_f32 v119, v119
v_mfma_f32_16x16x32_bf16 a[116:119], v[204:207], v[140:143], a[116:119]
ds_read_b64_tr_b16 v[226:227], v5 offset:6400
v_add_f32 v11, v11, v118
v_mfma_f32_16x16x32_bf16 a[116:119], v[200:203], v[136:139], a[116:119]
v_exp_f32 v120, v120
v_mfma_f32_16x16x32_bf16 a[120:123], v[200:203], v[144:147], a[120:123]
ds_read_b64_tr_b16 v[228:229], v5 offset:12544
buffer_load_dwordx4 v243, s[48:51], s58 offen offset:3072 lds
v_mfma_f32_16x16x32_bf16 a[120:123], v[204:207], v[148:151], a[120:123]
s_add_u32 m0, s62, 4096
v_exp_f32 v121, v121
v_mfma_f32_16x16x32_bf16 a[124:127], v[204:207], v[156:159], a[124:127]
ds_read_b64_tr_b16 v[230:231], v5 offset:18688
v_add_f32 v11, v11, v119
v_mfma_f32_16x16x32_bf16 a[124:127], v[200:203], v[152:155], a[124:127]
s_waitcnt lgkmcnt(8)
v_exp_f32 v122, v122
v_mfma_f32_16x16x32_bf16 a[128:131], v[208:211], v[128:131], a[128:131]
ds_read_b64_tr_b16 v[232:233], v6 offset:256
buffer_load_dwordx4 v244, s[48:51], s58 offen lds
v_mfma_f32_16x16x32_bf16 a[128:131], v[212:215], v[132:135], a[128:131]
s_add_u32 m0, s62, 5120
v_exp_f32 v123, v123
v_mfma_f32_16x16x32_bf16 a[132:135], v[212:215], v[140:143], a[132:135]
ds_read_b64_tr_b16 v[234:235], v6 offset:6400
v_cvt_pk_bf16_f32 v175, v118, v119
v_mfma_f32_16x16x32_bf16 a[132:135], v[208:211], v[136:139], a[132:135]
v_exp_f32 v124, v124
v_mfma_f32_16x16x32_bf16 a[136:139], v[208:211], v[144:147], a[136:139]
ds_read_b64_tr_b16 v[236:237], v6 offset:12544
v_add_f32 v12, v12, v120
v_mfma_f32_16x16x32_bf16 a[136:139], v[212:215], v[148:151], a[136:139]
buffer_load_dwordx4 v240, s[48:51], s59 offen lds
v_add_f32 v12, v12, v121
v_mfma_f32_16x16x32_bf16 a[140:143], v[212:215], v[156:159], a[140:143]
ds_read_b64_tr_b16 v[238:239], v6 offset:18688
v_cvt_pk_bf16_f32 v182, v120, v121
v_mfma_f32_16x16x32_bf16 a[140:143], v[208:211], v[152:155], a[140:143]
s_waitcnt lgkmcnt(8)
v_exp_f32 v125, v125
v_mfma_f32_16x16x32_bf16 a[144:147], v[216:219], v[128:131], a[144:147]
v_add_u32 v3, 24576, v3
v_add_f32 v12, v12, v122
v_mfma_f32_16x16x32_bf16 a[144:147], v[220:223], v[132:135], a[144:147]
v_add_u32 v4, 24576, v4
v_add_f32 v12, v12, v123
v_mfma_f32_16x16x32_bf16 a[148:151], v[220:223], v[140:143], a[148:151]
v_add_u32 v5, 24576, v5
v_cvt_pk_bf16_f32 v183, v122, v123
v_mfma_f32_16x16x32_bf16 a[148:151], v[216:219], v[136:139], a[148:151]
v_add_u32 v6, 24576, v6
v_add_f32 v13, v13, v124
v_mfma_f32_16x16x32_bf16 a[152:155], v[216:219], v[144:147], a[152:155]
buffer_load_dwordx4 v241, s[48:51], s59 offen offset:1024 lds
v_add_f32 v13, v13, v125
v_mfma_f32_16x16x32_bf16 a[152:155], v[220:223], v[148:151], a[152:155]
ds_read_b64_tr_b16 v[192:193], v3
v_cvt_pk_bf16_f32 v190, v124, v125
v_mfma_f32_16x16x32_bf16 a[156:159], v[220:223], v[156:159], a[156:159]
ds_read_b64_tr_b16 v[194:195], v3 offset:6144
buffer_load_dwordx4 v242, s[48:51], s59 offen offset:2048 lds
v_mfma_f32_16x16x32_bf16 a[156:159], v[216:219], v[152:155], a[156:159]
s_waitcnt lgkmcnt(6)
v_exp_f32 v126, v126
v_mfma_f32_16x16x32_bf16 a[160:163], v[224:227], v[128:131], a[160:163]
ds_read_b64_tr_b16 v[196:197], v3 offset:12288
v_add_f32 v13, v13, v126
v_mfma_f32_16x16x32_bf16 a[160:163], v[228:231], v[132:135], a[160:163]
ds_read_b64_tr_b16 v[198:199], v3 offset:18432
v_add_u32 v250, s27, v245
v_mfma_f32_16x16x32_bf16 a[164:167], v[228:231], v[140:143], a[164:167]
buffer_load_dwordx4 v243, s[48:51], s59 offen offset:3072 lds
v_add_u32 v249, s26, v245
v_mfma_f32_16x16x32_bf16 a[164:167], v[224:227], v[136:139], a[164:167]
s_add_u32 m0, s62, 9216
ds_read_b64_tr_b16 v[200:201], v4
v_add_u32 v248, s25, v245
v_mfma_f32_16x16x32_bf16 a[168:171], v[224:227], v[144:147], a[168:171]
ds_read_b64_tr_b16 v[202:203], v4 offset:6144
v_add_u32 v247, s24, v245
v_mfma_f32_16x16x32_bf16 a[168:171], v[228:231], v[148:151], a[168:171]
s_mul_i32 s74, s76, 20480
v_exp_f32 v127, v127
v_mfma_f32_16x16x32_bf16 a[172:175], v[228:231], v[156:159], a[172:175]
ds_read_b64_tr_b16 v[204:205], v4 offset:12288
v_add_f32 v13, v13, v127
v_mfma_f32_16x16x32_bf16 a[172:175], v[224:227], v[152:155], a[172:175]
s_waitcnt lgkmcnt(7)
ds_read_b64_tr_b16 v[206:207], v4 offset:18432
buffer_load_dwordx4 v244, s[48:51], s59 offen lds
v_mfma_f32_16x16x32_bf16 a[176:179], v[232:235], v[128:131], a[176:179]
s_add_u32 s58, s58, 81920
v_cvt_pk_bf16_f32 v191, v126, v127
v_lshrrev_b32 v24, 2, v0
v_mfma_f32_16x16x32_bf16 a[176:179], v[236:239], v[132:135], a[176:179]
ds_read_b64_tr_b16 v[208:209], v5
v_mul_u32_u24 v24, 320, v24
v_mfma_f32_16x16x32_bf16 a[180:183], v[236:239], v[140:143], a[180:183]
ds_read_b64_tr_b16 v[210:211], v5 offset:6144
v_and_b32 v25, 3, v0
v_mfma_f32_16x16x32_bf16 a[180:183], v[232:235], v[136:139], a[180:183]
v_lshl_add_u32 v24, v25, 3, v24
v_add_u32 v24, s74, v24
v_mfma_f32_16x16x32_bf16 a[184:187], v[232:235], v[144:147], a[184:187]
ds_read_b64_tr_b16 v[212:213], v5 offset:12288
v_bfe_u32 v25, v0, 4, 1
v_mfma_f32_16x16x32_bf16 a[184:187], v[236:239], v[148:151], a[184:187]
ds_read_b64_tr_b16 v[214:215], v5 offset:18432
v_xor_b32 v26, 1, v25
v_mfma_f32_16x16x32_bf16 a[188:191], v[236:239], v[156:159], a[188:191]
v_lshl_add_u32 v27, v25, 5, v24
v_lshl_add_u32 v28, v26, 5, v24
v_mfma_f32_16x16x32_bf16 a[188:191], v[232:235], v[152:155], a[188:191]
v_add_u32 v29, 128, v28
v_add_u32 v30, 192, v27
s_mul_i32 s64, s55, 245760
s_mul_i32 s65, s53, 6144
s_add_u32 s64, s64, s65
s_add_u32 s64, s64, 4194304
s_add_u32 s65, s64, 245760
s_add_u32 s66, s64, 491520
s_add_u32 s67, s64, 737280
v_lshlrev_b32 v15, 4, v0
v_add_u32 v14, 4096, v15
s_lshl_b32 s16, s52, 2
s_add_u32 s16, s16, 149504
v_mov_b32 v21, s16
v_mov_b32 v22, 149504
v_mov_b32 v16, v10
v_mov_b32 v17, v11
v_mov_b32 v18, v12
v_mov_b32 v19, v13
v_permlane32_swap_b32 v10, v16
v_permlane32_swap_b32 v11, v17
v_permlane32_swap_b32 v12, v18
v_permlane32_swap_b32 v13, v19
v_add_f32 v10, v10, v16
v_add_f32 v11, v11, v17
v_add_f32 v12, v12, v18
v_add_f32 v13, v13, v19
v_mov_b32 v16, v10
v_mov_b32 v17, v11
v_mov_b32 v18, v12
v_mov_b32 v19, v13
v_permlane16_swap_b32 v10, v16
v_permlane16_swap_b32 v11, v17
v_permlane16_swap_b32 v12, v18
v_permlane16_swap_b32 v13, v19
v_add_f32 v10, v10, v16
v_add_f32 v11, v11, v17
v_add_f32 v12, v12, v18
v_add_f32 v13, v13, v19
v_cmp_nge_f32 vcc, s33, v10
v_cmp_nge_f32 s[34:35], s33, v11
s_nop 0
s_or_b64 vcc, vcc, s[34:35]
v_cmp_nge_f32 s[34:35], s33, v12
s_nop 0
s_or_b64 vcc, vcc, s[34:35]
v_cmp_nge_f32 s[34:35], s33, v13
s_nop 0
s_or_b64 vcc, vcc, s[34:35]
s_cmp_lg_u64 vcc, 0
s_cselect_b32 s16, 1, 0
v_mov_b32 v16, s16
ds_write_b32 v21, v16
v_rcp_f32 v10, v10
v_rcp_f32 v11, v11
v_rcp_f32 v12, v12
v_rcp_f32 v13, v13
s_cmp_eq_u32 s76, 0
s_cselect_b64 vcc, -1, 0
v_cndmask_b32 v245, v27, v29, vcc
v_cndmask_b32 v254, v29, v27, vcc
v_cndmask_b32 v246, v28, v30, vcc
v_cndmask_b32 v255, v30, v28, vcc
v_mov_b32 v18, v22
s_waitcnt lgkmcnt(0)
s_barrier
ds_read_b128 v[20:23], v18
v_mfma_f32_16x16x32_bf16 a[0:3], v[192:195], v[160:163], a[0:3]
ds_read_b64_tr_b16 v[216:217], v6
v_mfma_f32_16x16x32_bf16 a[0:3], v[196:199], v[164:167], a[0:3]
v_mfma_f32_16x16x32_bf16 a[4:7], v[196:199], v[172:175], a[4:7]
ds_read_b64_tr_b16 v[218:219], v6 offset:6144
v_mfma_f32_16x16x32_bf16 a[4:7], v[192:195], v[168:171], a[4:7]
s_waitcnt lgkmcnt(2)
v_mfma_f32_16x16x32_bf16 a[8:11], v[192:195], v[176:179], a[8:11]
ds_read_b64_tr_b16 v[220:221], v6 offset:12288
v_or3_b32 v16, v20, v21, v22
v_mfma_f32_16x16x32_bf16 a[8:11], v[196:199], v[180:183], a[8:11]
v_or_b32 v16, v16, v23
v_mfma_f32_16x16x32_bf16 a[12:15], v[196:199], v[188:191], a[12:15]
ds_read_b64_tr_b16 v[222:223], v6 offset:18432
v_mfma_f32_16x16x32_bf16 a[12:15], v[192:195], v[184:187], a[12:15]
s_waitcnt lgkmcnt(4)
v_readfirstlane_b32 s74, v16
v_mfma_f32_16x16x32_bf16 a[16:19], v[200:203], v[160:163], a[16:19]
ds_read_b64_tr_b16 v[224:225], v3 offset:128
v_mfma_f32_16x16x32_bf16 a[16:19], v[204:207], v[164:167], a[16:19]
s_cmp_lg_u32 s74, 0
s_cbranch_scc1 L_safe
v_mfma_f32_16x16x32_bf16 a[20:23], v[204:207], v[172:175], a[20:23]
ds_read_b64_tr_b16 v[226:227], v3 offset:6272
v_mfma_f32_16x16x32_bf16 a[20:23], v[200:203], v[168:171], a[20:23]
buffer_load_dwordx4 v[16:19], v247, s[20:23], s56 offen sc1
v_mfma_f32_16x16x32_bf16 a[24:27], v[200:203], v[176:179], a[24:27]
ds_read_b64_tr_b16 v[228:229], v3 offset:12416
v_mfma_f32_16x16x32_bf16 a[24:27], v[204:207], v[180:183], a[24:27]
v_mfma_f32_16x16x32_bf16 a[28:31], v[204:207], v[188:191], a[28:31]
ds_read_b64_tr_b16 v[230:231], v3 offset:18560
buffer_load_dwordx4 v[20:23], v247, s[20:23], s56 offen offset:1024 sc1
v_mfma_f32_16x16x32_bf16 a[28:31], v[200:203], v[184:187], a[28:31]
s_waitcnt lgkmcnt(8)
v_accvgpr_read_b32 v144, a0
v_accvgpr_read_b32 v145, a1
v_mfma_f32_16x16x32_bf16 a[32:35], v[208:211], v[160:163], a[32:35]
ds_read_b64_tr_b16 v[232:233], v4 offset:128
v_accvgpr_read_b32 v146, a2
v_mfma_f32_16x16x32_bf16 a[32:35], v[212:215], v[164:167], a[32:35]
buffer_load_dwordx4 v[24:27], v248, s[20:23], s56 offen sc1
v_accvgpr_read_b32 v147, a3
v_mfma_f32_16x16x32_bf16 a[36:39], v[212:215], v[172:175], a[36:39]
ds_read_b64_tr_b16 v[234:235], v4 offset:6272
v_accvgpr_read_b32 v148, a16
v_mfma_f32_16x16x32_bf16 a[36:39], v[208:211], v[168:171], a[36:39]
v_accvgpr_read_b32 v149, a17
v_accvgpr_read_b32 v150, a18
v_mfma_f32_16x16x32_bf16 a[40:43], v[208:211], v[176:179], a[40:43]
ds_read_b64_tr_b16 v[236:237], v4 offset:12416
buffer_load_dwordx4 v[28:31], v248, s[20:23], s56 offen offset:1024 sc1
v_mfma_f32_16x16x32_bf16 a[40:43], v[212:215], v[180:183], a[40:43]
v_accvgpr_read_b32 v151, a19
v_mul_f32 v144, v144, v10
v_mfma_f32_16x16x32_bf16 a[44:47], v[212:215], v[188:191], a[44:47]
ds_read_b64_tr_b16 v[238:239], v4 offset:18560
v_mul_f32 v145, v145, v10
v_mfma_f32_16x16x32_bf16 a[44:47], v[208:211], v[184:187], a[44:47]
s_waitcnt lgkmcnt(8)
buffer_load_dwordx4 v[32:35], v249, s[20:23], s56 offen sc1
v_mul_f32 v146, v146, v10
v_mfma_f32_16x16x32_bf16 a[48:51], v[216:219], v[160:163], a[48:51]
ds_read_b64_tr_b16 v[192:193], v5 offset:128
v_mul_f32 v147, v147, v10
v_mfma_f32_16x16x32_bf16 a[48:51], v[220:223], v[164:167], a[48:51]
v_mul_f32 v148, v148, v10
v_mul_f32 v149, v149, v10
v_mfma_f32_16x16x32_bf16 a[52:55], v[220:223], v[172:175], a[52:55]
ds_read_b64_tr_b16 v[194:195], v5 offset:6272
buffer_load_dwordx4 v[36:39], v249, s[20:23], s56 offen offset:1024 sc1
v_mfma_f32_16x16x32_bf16 a[52:55], v[216:219], v[168:171], a[52:55]
v_mul_f32 v150, v150, v10
v_mul_f32 v151, v151, v10
v_mfma_f32_16x16x32_bf16 a[56:59], v[216:219], v[176:179], a[56:59]
ds_read_b64_tr_b16 v[196:197], v5 offset:12416
v_cvt_pk_bf16_f32 v80, v144, v145
v_mfma_f32_16x16x32_bf16 a[56:59], v[220:223], v[180:183], a[56:59]
buffer_load_dwordx4 v[40:43], v250, s[20:23], s56 offen sc1
v_cvt_pk_bf16_f32 v81, v146, v147
v_mfma_f32_16x16x32_bf16 a[60:63], v[220:223], v[188:191], a[60:63]
ds_read_b64_tr_b16 v[198:199], v5 offset:18560
v_cvt_pk_bf16_f32 v82, v148, v149
v_mfma_f32_16x16x32_bf16 a[60:63], v[216:219], v[184:187], a[60:63]
s_waitcnt lgkmcnt(8)
v_cvt_pk_bf16_f32 v83, v150, v151
v_mfma_f32_16x16x32_bf16 a[64:67], v[224:227], v[160:163], a[64:67]
ds_read_b64_tr_b16 v[200:201], v6 offset:128
buffer_load_dwordx4 v[44:47], v250, s[20:23], s56 offen offset:1024 sc1
v_mfma_f32_16x16x32_bf16 a[64:67], v[228:231], v[164:167], a[64:67]
s_add_u32 s56, s56, 2048
buffer_store_dwordx4 v[80:83], v15, s[20:23], s64 offen sc1
v_accvgpr_read_b32 v152, a4
v_mfma_f32_16x16x32_bf16 a[68:71], v[228:231], v[172:175], a[68:71]
ds_read_b64_tr_b16 v[202:203], v6 offset:6272
v_accvgpr_read_b32 v153, a5
v_mfma_f32_16x16x32_bf16 a[68:71], v[224:227], v[168:171], a[68:71]
buffer_load_dwordx4 v[48:51], v247, s[20:23], s56 offen sc1
v_accvgpr_read_b32 v154, a6
v_mfma_f32_16x16x32_bf16 a[72:75], v[224:227], v[176:179], a[72:75]
ds_read_b64_tr_b16 v[204:205], v6 offset:12416
v_accvgpr_read_b32 v155, a7
v_mfma_f32_16x16x32_bf16 a[72:75], v[228:231], v[180:183], a[72:75]
v_accvgpr_read_b32 v156, a20
v_accvgpr_read_b32 v157, a21
v_mfma_f32_16x16x32_bf16 a[76:79], v[228:231], v[188:191], a[76:79]
ds_read_b64_tr_b16 v[206:207], v6 offset:18560
v_accvgpr_read_b32 v158, a22
v_mfma_f32_16x16x32_bf16 a[76:79], v[224:227], v[184:187], a[76:79]
s_waitcnt lgkmcnt(8)
buffer_load_dwordx4 v[52:55], v247, s[20:23], s56 offen offset:1024 sc1
v_accvgpr_read_b32 v159, a23
v_mfma_f32_16x16x32_bf16 a[80:83], v[232:235], v[160:163], a[80:83]
ds_read_b64_tr_b16 v[208:209], v3 offset:256
v_mul_f32 v152, v152, v11
v_mfma_f32_16x16x32_bf16 a[80:83], v[236:239], v[164:167], a[80:83]
v_mul_f32 v153, v153, v11
v_mul_f32 v154, v154, v11
v_mfma_f32_16x16x32_bf16 a[84:87], v[236:239], v[172:175], a[84:87]
ds_read_b64_tr_b16 v[210:211], v3 offset:6400
buffer_load_dwordx4 v[56:59], v248, s[20:23], s56 offen sc1
v_mfma_f32_16x16x32_bf16 a[84:87], v[232:235], v[168:171], a[84:87]
v_mul_f32 v155, v155, v11
v_mul_f32 v156, v156, v11
v_mfma_f32_16x16x32_bf16 a[88:91], v[232:235], v[176:179], a[88:91]
ds_read_b64_tr_b16 v[212:213], v3 offset:12544
v_mul_f32 v157, v157, v11
v_mfma_f32_16x16x32_bf16 a[88:91], v[236:239], v[180:183], a[88:91]
buffer_load_dwordx4 v[60:63], v248, s[20:23], s56 offen offset:1024 sc1
v_mul_f32 v158, v158, v11
v_mfma_f32_16x16x32_bf16 a[92:95], v[236:239], v[188:191], a[92:95]
ds_read_b64_tr_b16 v[214:215], v3 offset:18688
v_mul_f32 v159, v159, v11
v_mfma_f32_16x16x32_bf16 a[92:95], v[232:235], v[184:187], a[92:95]
s_waitcnt lgkmcnt(8)
v_cvt_pk_bf16_f32 v84, v152, v153
v_cvt_pk_bf16_f32 v85, v154, v155
v_mfma_f32_16x16x32_bf16 a[96:99], v[192:195], v[160:163], a[96:99]
ds_read_b64_tr_b16 v[216:217], v4 offset:256
buffer_load_dwordx4 v[64:67], v249, s[20:23], s56 offen sc1
v_mfma_f32_16x16x32_bf16 a[96:99], v[196:199], v[164:167], a[96:99]
v_cvt_pk_bf16_f32 v86, v156, v157
v_cvt_pk_bf16_f32 v87, v158, v159
v_mfma_f32_16x16x32_bf16 a[100:103], v[196:199], v[172:175], a[100:103]
ds_read_b64_tr_b16 v[218:219], v4 offset:6400
buffer_store_dwordx4 v[84:87], v15, s[20:23], s65 offen sc1
v_mfma_f32_16x16x32_bf16 a[100:103], v[192:195], v[168:171], a[100:103]
buffer_load_dwordx4 v[68:71], v249, s[20:23], s56 offen offset:1024 sc1
v_accvgpr_read_b32 v144, a8
v_mfma_f32_16x16x32_bf16 a[104:107], v[192:195], v[176:179], a[104:107]
ds_read_b64_tr_b16 v[220:221], v4 offset:12544
v_accvgpr_read_b32 v145, a9
v_mfma_f32_16x16x32_bf16 a[104:107], v[196:199], v[180:183], a[104:107]
v_accvgpr_read_b32 v146, a10
v_accvgpr_read_b32 v147, a11
v_mfma_f32_16x16x32_bf16 a[108:111], v[196:199], v[188:191], a[108:111]
ds_read_b64_tr_b16 v[222:223], v4 offset:18688
buffer_load_dwordx4 v[72:75], v250, s[20:23], s56 offen sc1
v_mfma_f32_16x16x32_bf16 a[108:111], v[192:195], v[184:187], a[108:111]
s_waitcnt lgkmcnt(8)
v_accvgpr_read_b32 v148, a24
v_accvgpr_read_b32 v149, a25
v_mfma_f32_16x16x32_bf16 a[112:115], v[200:203], v[160:163], a[112:115]
ds_read_b64_tr_b16 v[224:225], v5 offset:256
v_accvgpr_read_b32 v150, a26
v_mfma_f32_16x16x32_bf16 a[112:115], v[204:207], v[164:167], a[112:115]
buffer_load_dwordx4 v[76:79], v250, s[20:23], s56 offen offset:1024 sc1
v_accvgpr_read_b32 v151, a27
v_mfma_f32_16x16x32_bf16 a[116:119], v[204:207], v[172:175], a[116:119]
s_add_u32 s56, s56, 2048
s_add_u32 s62, s61, 81920
ds_read_b64_tr_b16 v[226:227], v5 offset:6400
v_mfma_f32_16x16x32_bf16 a[116:119], v[200:203], v[168:171], a[116:119]
s_add_u32 s59, s58, 20480
s_add_u32 m0, s62, 0
v_mul_f32 v144, v144, v12
v_mfma_f32_16x16x32_bf16 a[120:123], v[200:203], v[176:179], a[120:123]
ds_read_b64_tr_b16 v[228:229], v5 offset:12544
buffer_load_dwordx4 v240, s[48:51], s58 offen lds
v_mfma_f32_16x16x32_bf16 a[120:123], v[204:207], v[180:183], a[120:123]
v_mul_f32 v145, v145, v12
v_mul_f32 v146, v146, v12
v_mfma_f32_16x16x32_bf16 a[124:127], v[204:207], v[188:191], a[124:127]
ds_read_b64_tr_b16 v[230:231], v5 offset:18688
v_mul_f32 v147, v147, v12
v_mfma_f32_16x16x32_bf16 a[124:127], v[200:203], v[184:187], a[124:127]
s_waitcnt lgkmcnt(8)
buffer_load_dwordx4 v241, s[48:51], s58 offen offset:1024 lds
v_mul_f32 v148, v148, v12
v_mfma_f32_16x16x32_bf16 a[128:131], v[208:211], v[160:163], a[128:131]
ds_read_b64_tr_b16 v[232:233], v6 offset:256
v_mul_f32 v149, v149, v12
v_mfma_f32_16x16x32_bf16 a[128:131], v[212:215], v[164:167], a[128:131]
v_mul_f32 v150, v150, v12
v_mul_f32 v151, v151, v12
v_mfma_f32_16x16x32_bf16 a[132:135], v[212:215], v[172:175], a[132:135]
ds_read_b64_tr_b16 v[234:235], v6 offset:6400
v_cvt_pk_bf16_f32 v88, v144, v145
v_mfma_f32_16x16x32_bf16 a[132:135], v[208:211], v[168:171], a[132:135]
buffer_load_dwordx4 v242, s[48:51], s58 offen offset:2048 lds
v_cvt_pk_bf16_f32 v89, v146, v147
v_mfma_f32_16x16x32_bf16 a[136:139], v[208:211], v[176:179], a[136:139]
ds_read_b64_tr_b16 v[236:237], v6 offset:12544
v_cvt_pk_bf16_f32 v90, v148, v149
v_mfma_f32_16x16x32_bf16 a[136:139], v[212:215], v[180:183], a[136:139]
v_cvt_pk_bf16_f32 v91, v150, v151
v_mfma_f32_16x16x32_bf16 a[140:143], v[212:215], v[188:191], a[140:143]
ds_read_b64_tr_b16 v[238:239], v6 offset:18688
buffer_load_dwordx4 v243, s[48:51], s58 offen offset:3072 lds
v_mfma_f32_16x16x32_bf16 a[140:143], v[208:211], v[184:187], a[140:143]
s_waitcnt lgkmcnt(8)
s_add_u32 m0, s62, 4096
buffer_store_dwordx4 v[88:91], v15, s[20:23], s66 offen sc1
v_mfma_f32_16x16x32_bf16 a[144:147], v[216:219], v[160:163], a[144:147]
v_accvgpr_read_b32 v152, a12
v_accvgpr_read_b32 v153, a13
v_mfma_f32_16x16x32_bf16 a[144:147], v[220:223], v[164:167], a[144:147]
buffer_load_dwordx4 v244, s[48:51], s58 offen lds
v_accvgpr_read_b32 v154, a14
v_mfma_f32_16x16x32_bf16 a[148:151], v[220:223], v[172:175], a[148:151]
s_add_u32 m0, s62, 5120
v_accvgpr_read_b32 v155, a15
v_accvgpr_read_b32 v156, a28
v_mfma_f32_16x16x32_bf16 a[148:151], v[216:219], v[168:171], a[148:151]
v_accvgpr_read_b32 v157, a29
v_accvgpr_read_b32 v158, a30
v_mfma_f32_16x16x32_bf16 a[152:155], v[216:219], v[176:179], a[152:155]
buffer_load_dwordx4 v240, s[48:51], s59 offen lds
v_accvgpr_read_b32 v159, a31
v_mfma_f32_16x16x32_bf16 a[152:155], v[220:223], v[180:183], a[152:155]
v_mul_f32 v152, v152, v13
v_mul_f32 v153, v153, v13
v_mfma_f32_16x16x32_bf16 a[156:159], v[220:223], v[188:191], a[156:159]
v_mul_f32 v154, v154, v13
v_mul_f32 v155, v155, v13
v_mfma_f32_16x16x32_bf16 a[156:159], v[216:219], v[184:187], a[156:159]
s_waitcnt lgkmcnt(4)
buffer_load_dwordx4 v241, s[48:51], s59 offen offset:1024 lds
v_mul_f32 v156, v156, v13
v_mfma_f32_16x16x32_bf16 a[160:163], v[224:227], v[160:163], a[160:163]
v_mul_f32 v157, v157, v13
v_mul_f32 v158, v158, v13
v_mfma_f32_16x16x32_bf16 a[160:163], v[228:231], v[164:167], a[160:163]
v_mul_f32 v159, v159, v13
v_cvt_pk_bf16_f32 v92, v152, v153
v_mfma_f32_16x16x32_bf16 a[164:167], v[228:231], v[172:175], a[164:167]
buffer_load_dwordx4 v242, s[48:51], s59 offen offset:2048 lds
v_cvt_pk_bf16_f32 v93, v154, v155
v_mfma_f32_16x16x32_bf16 a[164:167], v[224:227], v[168:171], a[164:167]
v_cvt_pk_bf16_f32 v94, v156, v157
v_cvt_pk_bf16_f32 v95, v158, v159
v_mfma_f32_16x16x32_bf16 a[168:171], v[224:227], v[176:179], a[168:171]
buffer_store_dwordx4 v[92:95], v15, s[20:23], s67 offen sc1
v_accvgpr_read_b32 v144, a32
v_mfma_f32_16x16x32_bf16 a[168:171], v[228:231], v[180:183], a[168:171]
buffer_load_dwordx4 v243, s[48:51], s59 offen offset:3072 lds
v_accvgpr_read_b32 v145, a33
v_mfma_f32_16x16x32_bf16 a[172:175], v[228:231], v[188:191], a[172:175]
s_add_u32 m0, s62, 9216
v_accvgpr_read_b32 v146, a34
v_accvgpr_read_b32 v147, a35
v_mfma_f32_16x16x32_bf16 a[172:175], v[224:227], v[184:187], a[172:175]
s_waitcnt lgkmcnt(0)
v_accvgpr_read_b32 v148, a48
v_accvgpr_read_b32 v149, a49
v_mfma_f32_16x16x32_bf16 a[176:179], v[232:235], v[160:163], a[176:179]
buffer_load_dwordx4 v244, s[48:51], s59 offen lds
v_accvgpr_read_b32 v150, a50
v_mfma_f32_16x16x32_bf16 a[176:179], v[236:239], v[164:167], a[176:179]
s_add_u32 s58, s58, 81920
v_accvgpr_read_b32 v151, a51
v_mul_f32 v144, v144, v10
v_mfma_f32_16x16x32_bf16 a[180:183], v[236:239], v[172:175], a[180:183]
v_mul_f32 v145, v145, v10
v_mul_f32 v146, v146, v10
v_mfma_f32_16x16x32_bf16 a[180:183], v[232:235], v[168:171], a[180:183]
v_mul_f32 v147, v147, v10
v_mul_f32 v148, v148, v10
v_mfma_f32_16x16x32_bf16 a[184:187], v[232:235], v[176:179], a[184:187]
v_mul_f32 v149, v149, v10
v_mul_f32 v150, v150, v10
v_mfma_f32_16x16x32_bf16 a[184:187], v[236:239], v[180:183], a[184:187]
v_mul_f32 v151, v151, v10
v_cvt_pk_bf16_f32 v96, v144, v145
v_mfma_f32_16x16x32_bf16 a[188:191], v[236:239], v[188:191], a[188:191]
v_cvt_pk_bf16_f32 v97, v146, v147
v_cvt_pk_bf16_f32 v98, v148, v149
v_mfma_f32_16x16x32_bf16 a[188:191], v[232:235], v[184:187], a[188:191]
v_cvt_pk_bf16_f32 v99, v150, v151
s_nop 7
buffer_store_dwordx4 v[96:99], v15, s[20:23], s64 offen offset:1024 sc1
v_accvgpr_read_b32 v152, a36
v_accvgpr_read_b32 v153, a37
v_accvgpr_read_b32 v154, a38
v_accvgpr_read_b32 v155, a39
v_accvgpr_read_b32 v156, a52
v_accvgpr_read_b32 v157, a53
v_accvgpr_read_b32 v158, a54
v_accvgpr_read_b32 v159, a55
v_pk_mul_f32 v[152:153], v[152:153], v[10:11] op_sel:[0,1] op_sel_hi:[1,1]
v_pk_mul_f32 v[154:155], v[154:155], v[10:11] op_sel:[0,1] op_sel_hi:[1,1]
v_pk_mul_f32 v[156:157], v[156:157], v[10:11] op_sel:[0,1] op_sel_hi:[1,1]
v_pk_mul_f32 v[158:159], v[158:159], v[10:11] op_sel:[0,1] op_sel_hi:[1,1]
v_cvt_pk_bf16_f32 v100, v152, v153
v_cvt_pk_bf16_f32 v101, v154, v155
v_cvt_pk_bf16_f32 v102, v156, v157
v_cvt_pk_bf16_f32 v103, v158, v159
buffer_store_dwordx4 v[100:103], v15, s[20:23], s65 offen offset:1024 sc1
v_accvgpr_read_b32 v144, a40
v_accvgpr_read_b32 v145, a41
v_accvgpr_read_b32 v146, a42
v_accvgpr_read_b32 v147, a43
v_accvgpr_read_b32 v148, a56
v_accvgpr_read_b32 v149, a57
v_accvgpr_read_b32 v150, a58
v_accvgpr_read_b32 v151, a59
v_pk_mul_f32 v[144:145], v[144:145], v[12:13] op_sel:[0,0] op_sel_hi:[1,0]
v_pk_mul_f32 v[146:147], v[146:147], v[12:13] op_sel:[0,0] op_sel_hi:[1,0]
v_pk_mul_f32 v[148:149], v[148:149], v[12:13] op_sel:[0,0] op_sel_hi:[1,0]
v_pk_mul_f32 v[150:151], v[150:151], v[12:13] op_sel:[0,0] op_sel_hi:[1,0]
v_cvt_pk_bf16_f32 v104, v144, v145
v_cvt_pk_bf16_f32 v105, v146, v147
v_cvt_pk_bf16_f32 v106, v148, v149
v_cvt_pk_bf16_f32 v107, v150, v151
buffer_store_dwordx4 v[104:107], v15, s[20:23], s66 offen offset:1024 sc1
v_accvgpr_read_b32 v152, a44
v_accvgpr_read_b32 v153, a45
v_accvgpr_read_b32 v154, a46
v_accvgpr_read_b32 v155, a47
v_accvgpr_read_b32 v156, a60
v_accvgpr_read_b32 v157, a61
v_accvgpr_read_b32 v158, a62
v_accvgpr_read_b32 v159, a63
v_pk_mul_f32 v[152:153], v[152:153], v[12:13] op_sel:[0,1] op_sel_hi:[1,1]
v_pk_mul_f32 v[154:155], v[154:155], v[12:13] op_sel:[0,1] op_sel_hi:[1,1]
v_pk_mul_f32 v[156:157], v[156:157], v[12:13] op_sel:[0,1] op_sel_hi:[1,1]
v_pk_mul_f32 v[158:159], v[158:159], v[12:13] op_sel:[0,1] op_sel_hi:[1,1]
v_cvt_pk_bf16_f32 v108, v152, v153
v_cvt_pk_bf16_f32 v109, v154, v155
v_cvt_pk_bf16_f32 v110, v156, v157
v_cvt_pk_bf16_f32 v111, v158, v159
buffer_store_dwordx4 v[108:111], v15, s[20:23], s67 offen offset:1024 sc1
v_accvgpr_read_b32 v144, a64
v_accvgpr_read_b32 v145, a65
v_accvgpr_read_b32 v146, a66
v_accvgpr_read_b32 v147, a67
v_accvgpr_read_b32 v148, a80
v_accvgpr_read_b32 v149, a81
v_accvgpr_read_b32 v150, a82
v_accvgpr_read_b32 v151, a83
v_pk_mul_f32 v[144:145], v[144:145], v[10:11] op_sel:[0,0] op_sel_hi:[1,0]
v_pk_mul_f32 v[146:147], v[146:147], v[10:11] op_sel:[0,0] op_sel_hi:[1,0]
v_pk_mul_f32 v[148:149], v[148:149], v[10:11] op_sel:[0,0] op_sel_hi:[1,0]
v_pk_mul_f32 v[150:151], v[150:151], v[10:11] op_sel:[0,0] op_sel_hi:[1,0]
v_cvt_pk_bf16_f32 v112, v144, v145
v_cvt_pk_bf16_f32 v113, v146, v147
v_cvt_pk_bf16_f32 v114, v148, v149
v_cvt_pk_bf16_f32 v115, v150, v151
buffer_store_dwordx4 v[112:115], v15, s[20:23], s64 offen offset:2048 sc1
v_accvgpr_read_b32 v152, a68
v_accvgpr_read_b32 v153, a69
v_accvgpr_read_b32 v154, a70
v_accvgpr_read_b32 v155, a71
v_accvgpr_read_b32 v156, a84
v_accvgpr_read_b32 v157, a85
v_accvgpr_read_b32 v158, a86
v_accvgpr_read_b32 v159, a87
v_pk_mul_f32 v[152:153], v[152:153], v[10:11] op_sel:[0,1] op_sel_hi:[1,1]
v_pk_mul_f32 v[154:155], v[154:155], v[10:11] op_sel:[0,1] op_sel_hi:[1,1]
v_pk_mul_f32 v[156:157], v[156:157], v[10:11] op_sel:[0,1] op_sel_hi:[1,1]
v_pk_mul_f32 v[158:159], v[158:159], v[10:11] op_sel:[0,1] op_sel_hi:[1,1]
v_cvt_pk_bf16_f32 v116, v152, v153
v_cvt_pk_bf16_f32 v117, v154, v155
v_cvt_pk_bf16_f32 v118, v156, v157
v_cvt_pk_bf16_f32 v119, v158, v159
buffer_store_dwordx4 v[116:119], v15, s[20:23], s65 offen offset:2048 sc1
v_accvgpr_read_b32 v144, a72
v_accvgpr_read_b32 v145, a73
v_accvgpr_read_b32 v146, a74
v_accvgpr_read_b32 v147, a75
v_accvgpr_read_b32 v148, a88
v_accvgpr_read_b32 v149, a89
v_accvgpr_read_b32 v150, a90
v_accvgpr_read_b32 v151, a91
v_pk_mul_f32 v[144:145], v[144:145], v[12:13] op_sel:[0,0] op_sel_hi:[1,0]
v_pk_mul_f32 v[146:147], v[146:147], v[12:13] op_sel:[0,0] op_sel_hi:[1,0]
v_pk_mul_f32 v[148:149], v[148:149], v[12:13] op_sel:[0,0] op_sel_hi:[1,0]
v_pk_mul_f32 v[150:151], v[150:151], v[12:13] op_sel:[0,0] op_sel_hi:[1,0]
v_cvt_pk_bf16_f32 v120, v144, v145
v_cvt_pk_bf16_f32 v121, v146, v147
v_cvt_pk_bf16_f32 v122, v148, v149
v_cvt_pk_bf16_f32 v123, v150, v151
v_accvgpr_read_b32 v152, a76
v_accvgpr_read_b32 v153, a77
v_accvgpr_read_b32 v154, a78
v_accvgpr_read_b32 v155, a79
v_accvgpr_read_b32 v156, a92
v_accvgpr_read_b32 v157, a93
v_accvgpr_read_b32 v158, a94
v_accvgpr_read_b32 v159, a95
v_pk_mul_f32 v[152:153], v[152:153], v[12:13] op_sel:[0,1] op_sel_hi:[1,1]
v_pk_mul_f32 v[154:155], v[154:155], v[12:13] op_sel:[0,1] op_sel_hi:[1,1]
v_pk_mul_f32 v[156:157], v[156:157], v[12:13] op_sel:[0,1] op_sel_hi:[1,1]
v_pk_mul_f32 v[158:159], v[158:159], v[12:13] op_sel:[0,1] op_sel_hi:[1,1]
v_cvt_pk_bf16_f32 v124, v152, v153
v_cvt_pk_bf16_f32 v125, v154, v155
v_cvt_pk_bf16_f32 v126, v156, v157
v_cvt_pk_bf16_f32 v127, v158, v159
L_join:
v_mov_b32 v8, v254
v_mov_b32 v9, v255
v_mov_b32 v254, s70
v_mov_b32 v255, s71
s_waitcnt vmcnt(28)
s_barrier
ds_read_b64_tr_b16 v[192:193], v245
ds_read_b64_tr_b16 v[194:195], v245 offset:5120
ds_read_b64_tr_b16 v[196:197], v245 offset:10240
ds_read_b64_tr_b16 v[198:199], v245 offset:15360
ds_read_b64_tr_b16 v[200:201], v246
ds_read_b64_tr_b16 v[202:203], v246 offset:5120
ds_read_b64_tr_b16 v[204:205], v246 offset:10240
ds_read_b64_tr_b16 v[206:207], v246 offset:15360
ds_read_b64_tr_b16 v[208:209], v245 offset:64
ds_read_b64_tr_b16 v[210:211], v245 offset:5184
ds_read_b64_tr_b16 v[212:213], v245 offset:10304
ds_read_b64_tr_b16 v[214:215], v245 offset:15424
s_add_u32 s17, s54, 75497472
s_waitcnt lgkmcnt(0)
v_mfma_f32_16x16x32_bf16 a[192:195], v[192:195], v[16:19], 0
ds_read_b64_tr_b16 v[216:217], v246 offset:64
v_mfma_f32_16x16x32_bf16 a[192:195], v[196:199], v[20:23], a[192:195]
buffer_load_dwordx4 v[160:163], v247, s[20:23], s56 offen sc1
v_mfma_f32_16x16x32_bf16 a[196:199], v[196:199], v[28:31], 0
ds_read_b64_tr_b16 v[218:219], v246 offset:5184
buffer_store_dwordx4 v[120:123], v15, s[20:23], s66 offen offset:2048 sc1
v_mfma_f32_16x16x32_bf16 a[196:199], v[192:195], v[24:27], a[196:199]
v_mfma_f32_16x16x32_bf16 a[200:203], v[192:195], v[32:35], 0
ds_read_b64_tr_b16 v[220:221], v246 offset:10304
v_mfma_f32_16x16x32_bf16 a[200:203], v[196:199], v[36:39], a[200:203]
v_mfma_f32_16x16x32_bf16 a[204:207], v[196:199], v[44:47], 0
ds_read_b64_tr_b16 v[222:223], v246 offset:15424
v_mfma_f32_16x16x32_bf16 a[204:207], v[192:195], v[40:43], a[204:207]
s_waitcnt lgkmcnt(4)
buffer_store_dwordx4 v[124:127], v15, s[20:23], s67 offen offset:2048 sc1
v_accvgpr_read_b32 v144, a96
v_accvgpr_read_b32 v145, a97
v_mfma_f32_16x16x32_bf16 a[208:211], v[200:203], v[16:19], 0
ds_read_b64_tr_b16 v[224:225], v245 offset:128
v_accvgpr_read_b32 v146, a98
v_accvgpr_read_b32 v147, a99
v_mfma_f32_16x16x32_bf16 a[208:211], v[204:207], v[20:23], a[208:211]
v_accvgpr_read_b32 v148, a112
v_accvgpr_read_b32 v149, a113
v_accvgpr_read_b32 v150, a114
v_mfma_f32_16x16x32_bf16 a[212:215], v[204:207], v[28:31], 0
ds_read_b64_tr_b16 v[226:227], v245 offset:5248
buffer_load_dwordx4 v[164:167], v247, s[20:23], s56 offen offset:1024 sc1
v_accvgpr_read_b32 v151, a115
v_mfma_f32_16x16x32_bf16 a[212:215], v[200:203], v[24:27], a[212:215]
v_mul_f32 v144, v144, v10
v_mul_f32 v145, v145, v10
v_mul_f32 v146, v146, v10
v_mfma_f32_16x16x32_bf16 a[216:219], v[200:203], v[32:35], 0
ds_read_b64_tr_b16 v[228:229], v245 offset:10368
v_mul_f32 v147, v147, v10
v_mul_f32 v148, v148, v10
v_mfma_f32_16x16x32_bf16 a[216:219], v[204:207], v[36:39], a[216:219]
v_mul_f32 v149, v149, v10
v_mul_f32 v150, v150, v10
v_mul_f32 v151, v151, v10
v_mfma_f32_16x16x32_bf16 a[220:223], v[204:207], v[44:47], 0
ds_read_b64_tr_b16 v[230:231], v245 offset:15488
v_cvt_pk_bf16_f32 v128, v144, v145
v_cvt_pk_bf16_f32 v129, v146, v147
v_mfma_f32_16x16x32_bf16 a[220:223], v[200:203], v[40:43], a[220:223]
s_waitcnt lgkmcnt(8)
v_cvt_pk_bf16_f32 v130, v148, v149
v_cvt_pk_bf16_f32 v131, v150, v151
v_mfma_f32_16x16x32_bf16 a[224:227], v[208:211], v[16:19], 0
ds_read_b64_tr_b16 v[232:233], v8
buffer_store_dwordx4 v[128:131], v15, s[20:23], s64 offen offset:3072 sc1
v_accvgpr_read_b32 v152, a100
v_mfma_f32_16x16x32_bf16 a[224:227], v[212:215], v[20:23], a[224:227]
v_accvgpr_read_b32 v153, a101
v_accvgpr_read_b32 v154, a102
v_accvgpr_read_b32 v155, a103
v_mfma_f32_16x16x32_bf16 a[228:231], v[212:215], v[28:31], 0
ds_read_b64_tr_b16 v[234:235], v8 offset:5120
v_accvgpr_read_b32 v156, a116
v_accvgpr_read_b32 v157, a117
v_mfma_f32_16x16x32_bf16 a[228:231], v[208:211], v[24:27], a[228:231]
buffer_load_dwordx4 v[168:171], v248, s[20:23], s56 offen sc1
v_accvgpr_read_b32 v158, a118
v_accvgpr_read_b32 v159, a119
v_mfma_f32_16x16x32_bf16 a[232:235], v[208:211], v[32:35], 0
ds_read_b64_tr_b16 v[236:237], v8 offset:10240
v_mul_f32 v152, v152, v11
v_mul_f32 v153, v153, v11
v_mfma_f32_16x16x32_bf16 a[232:235], v[212:215], v[36:39], a[232:235]
v_mul_f32 v154, v154, v11
v_mul_f32 v155, v155, v11
v_mul_f32 v156, v156, v11
v_mfma_f32_16x16x32_bf16 a[236:239], v[212:215], v[44:47], 0
ds_read_b64_tr_b16 v[238:239], v8 offset:15360
v_mul_f32 v157, v157, v11
v_mul_f32 v158, v158, v11
v_mfma_f32_16x16x32_bf16 a[236:239], v[208:211], v[40:43], a[236:239]
s_waitcnt lgkmcnt(8)
v_mul_f32 v159, v159, v11
v_cvt_pk_bf16_f32 v132, v152, v153
v_cvt_pk_bf16_f32 v133, v154, v155
v_mfma_f32_16x16x32_bf16 a[240:243], v[216:219], v[16:19], 0
ds_read_b64_tr_b16 v[192:193], v9
v_cvt_pk_bf16_f32 v134, v156, v157
v_cvt_pk_bf16_f32 v135, v158, v159
v_mfma_f32_16x16x32_bf16 a[240:243], v[220:223], v[20:23], a[240:243]
buffer_store_dwordx4 v[132:135], v15, s[20:23], s65 offen offset:3072 sc1
v_accvgpr_read_b32 v144, a104
v_accvgpr_read_b32 v145, a105
v_mfma_f32_16x16x32_bf16 a[244:247], v[220:223], v[28:31], 0
ds_read_b64_tr_b16 v[194:195], v9 offset:5120
v_accvgpr_read_b32 v146, a106
v_accvgpr_read_b32 v147, a107
v_mfma_f32_16x16x32_bf16 a[244:247], v[216:219], v[24:27], a[244:247]
v_accvgpr_read_b32 v148, a120
v_accvgpr_read_b32 v149, a121
v_accvgpr_read_b32 v150, a122
v_mfma_f32_16x16x32_bf16 a[248:251], v[216:219], v[32:35], 0
ds_read_b64_tr_b16 v[196:197], v9 offset:10240
v_accvgpr_read_b32 v151, a123
v_mul_f32 v144, v144, v12
v_mfma_f32_16x16x32_bf16 a[248:251], v[220:223], v[36:39], a[248:251]
buffer_load_dwordx4 v[172:175], v248, s[20:23], s56 offen offset:1024 sc1
v_mul_f32 v145, v145, v12
v_mul_f32 v146, v146, v12
v_mfma_f32_16x16x32_bf16 a[252:255], v[220:223], v[44:47], 0
ds_read_b64_tr_b16 v[198:199], v9 offset:15360
v_add_u32 v245, 40960, v245
v_mul_f32 v147, v147, v12
v_mfma_f32_16x16x32_bf16 a[252:255], v[216:219], v[40:43], a[252:255]
s_waitcnt lgkmcnt(8)
v_mul_f32 v148, v148, v12
v_mul_f32 v149, v149, v12
v_mul_f32 v150, v150, v12
v_mfma_f32_16x16x32_bf16 a[0:3], v[224:227], v[16:19], 0
ds_read_b64_tr_b16 v[200:201], v8 offset:64
v_add_u32 v246, 40960, v246
v_mul_f32 v151, v151, v12
v_mfma_f32_16x16x32_bf16 a[0:3], v[228:231], v[20:23], a[0:3]
v_cvt_pk_bf16_f32 v136, v144, v145
v_cvt_pk_bf16_f32 v137, v146, v147
v_cvt_pk_bf16_f32 v138, v148, v149
v_mfma_f32_16x16x32_bf16 a[4:7], v[228:231], v[28:31], 0
ds_read_b64_tr_b16 v[202:203], v8 offset:5184
v_cvt_pk_bf16_f32 v139, v150, v151
v_mfma_f32_16x16x32_bf16 a[4:7], v[224:227], v[24:27], a[4:7]
buffer_store_dwordx4 v[136:139], v15, s[20:23], s66 offen offset:3072 sc1
v_accvgpr_read_b32 v152, a108
v_accvgpr_read_b32 v153, a109
v_mfma_f32_16x16x32_bf16 a[8:11], v[224:227], v[32:35], 0
ds_read_b64_tr_b16 v[204:205], v8 offset:10304
v_accvgpr_read_b32 v154, a110
v_accvgpr_read_b32 v155, a111
v_mfma_f32_16x16x32_bf16 a[8:11], v[228:231], v[36:39], a[8:11]
v_accvgpr_read_b32 v156, a124
v_accvgpr_read_b32 v157, a125
v_accvgpr_read_b32 v158, a126
v_mfma_f32_16x16x32_bf16 a[12:15], v[228:231], v[44:47], 0
ds_read_b64_tr_b16 v[206:207], v8 offset:15424
buffer_load_dwordx4 v[176:179], v249, s[20:23], s56 offen sc1
v_accvgpr_read_b32 v159, a127
v_mfma_f32_16x16x32_bf16 a[12:15], v[224:227], v[40:43], a[12:15]
s_waitcnt lgkmcnt(8)
v_mul_f32 v152, v152, v13
v_mul_f32 v153, v153, v13
v_mul_f32 v154, v154, v13
v_mfma_f32_16x16x32_bf16 a[16:19], v[232:235], v[16:19], 0
ds_read_b64_tr_b16 v[208:209], v9 offset:64
v_mul_f32 v155, v155, v13
v_mul_f32 v156, v156, v13
v_mfma_f32_16x16x32_bf16 a[16:19], v[236:239], v[20:23], a[16:19]
v_mul_f32 v157, v157, v13
v_mul_f32 v158, v158, v13
v_mul_f32 v159, v159, v13
v_mfma_f32_16x16x32_bf16 a[20:23], v[236:239], v[28:31], 0
ds_read_b64_tr_b16 v[210:211], v9 offset:5184
v_cvt_pk_bf16_f32 v140, v152, v153
v_cvt_pk_bf16_f32 v141, v154, v155
v_mfma_f32_16x16x32_bf16 a[20:23], v[232:235], v[24:27], a[20:23]
v_cvt_pk_bf16_f32 v142, v156, v157
v_cvt_pk_bf16_f32 v143, v158, v159
v_mfma_f32_16x16x32_bf16 a[24:27], v[232:235], v[32:35], 0
ds_read_b64_tr_b16 v[212:213], v9 offset:10304
buffer_store_dwordx4 v[140:143], v15, s[20:23], s67 offen offset:3072 sc1
v_accvgpr_read_b32 v144, a128
v_mfma_f32_16x16x32_bf16 a[24:27], v[236:239], v[36:39], a[24:27]
v_accvgpr_read_b32 v145, a129
v_accvgpr_read_b32 v146, a130
v_accvgpr_read_b32 v147, a131
v_mfma_f32_16x16x32_bf16 a[28:31], v[236:239], v[44:47], 0
ds_read_b64_tr_b16 v[214:215], v9 offset:15424
v_accvgpr_read_b32 v148, a144
v_accvgpr_read_b32 v149, a145
v_mfma_f32_16x16x32_bf16 a[28:31], v[232:235], v[40:43], a[28:31]
s_waitcnt lgkmcnt(8)
buffer_load_dwordx4 v[180:183], v249, s[20:23], s56 offen offset:1024 sc1
v_accvgpr_read_b32 v150, a146
v_accvgpr_read_b32 v151, a147
v_mfma_f32_16x16x32_bf16 a[32:35], v[192:195], v[16:19], 0
ds_read_b64_tr_b16 v[216:217], v8 offset:128
v_mul_f32 v144, v144, v10
v_mul_f32 v145, v145, v10
v_mfma_f32_16x16x32_bf16 a[32:35], v[196:199], v[20:23], a[32:35]
v_mul_f32 v146, v146, v10
v_mul_f32 v147, v147, v10
v_mul_f32 v148, v148, v10
v_mfma_f32_16x16x32_bf16 a[36:39], v[196:199], v[28:31], 0
ds_read_b64_tr_b16 v[218:219], v8 offset:5248
v_mul_f32 v149, v149, v10
v_mul_f32 v150, v150, v10
v_mfma_f32_16x16x32_bf16 a[36:39], v[192:195], v[24:27], a[36:39]
v_mul_f32 v151, v151, v10
v_cvt_pk_bf16_f32 v80, v144, v145
v_cvt_pk_bf16_f32 v81, v146, v147
v_mfma_f32_16x16x32_bf16 a[40:43], v[192:195], v[32:35], 0
ds_read_b64_tr_b16 v[220:221], v8 offset:10368
v_cvt_pk_bf16_f32 v82, v148, v149
v_cvt_pk_bf16_f32 v83, v150, v151
v_mfma_f32_16x16x32_bf16 a[40:43], v[196:199], v[36:39], a[40:43]
buffer_store_dwordx4 v[80:83], v14, s[20:23], s64 offen sc1
v_accvgpr_read_b32 v152, a132
v_accvgpr_read_b32 v153, a133
v_mfma_f32_16x16x32_bf16 a[44:47], v[196:199], v[44:47], 0
ds_read_b64_tr_b16 v[222:223], v8 offset:15488
v_accvgpr_read_b32 v154, a134
v_accvgpr_read_b32 v155, a135
v_mfma_f32_16x16x32_bf16 a[44:47], v[192:195], v[40:43], a[44:47]
s_waitcnt lgkmcnt(8)
v_accvgpr_read_b32 v156, a148
v_accvgpr_read_b32 v157, a149
v_accvgpr_read_b32 v158, a150
v_mfma_f32_16x16x32_bf16 a[48:51], v[200:203], v[16:19], 0
v_accvgpr_read_b32 v159, a151
v_mul_f32 v152, v152, v11
v_mul_f32 v153, v153, v11
v_mfma_f32_16x16x32_bf16 a[48:51], v[204:207], v[20:23], a[48:51]
buffer_load_dwordx4 v[184:187], v250, s[20:23], s56 offen sc1
v_mul_f32 v154, v154, v11
v_mul_f32 v155, v155, v11
v_mfma_f32_16x16x32_bf16 a[52:55], v[204:207], v[28:31], 0
v_add_u32 v8, 40960, v8
v_mul_f32 v156, v156, v11
v_mul_f32 v157, v157, v11
v_mfma_f32_16x16x32_bf16 a[52:55], v[200:203], v[24:27], a[52:55]
v_add_u32 v9, 40960, v9
v_mul_f32 v158, v158, v11
v_mul_f32 v159, v159, v11
v_mfma_f32_16x16x32_bf16 a[56:59], v[200:203], v[32:35], 0
v_cvt_pk_bf16_f32 v84, v152, v153
v_cvt_pk_bf16_f32 v85, v154, v155
v_cvt_pk_bf16_f32 v86, v156, v157
v_mfma_f32_16x16x32_bf16 a[56:59], v[204:207], v[36:39], a[56:59]
v_cvt_pk_bf16_f32 v87, v158, v159
v_mfma_f32_16x16x32_bf16 a[60:63], v[204:207], v[44:47], 0
s_waitcnt vmcnt(42) lgkmcnt(0)
s_barrier
buffer_store_dwordx4 v[84:87], v14, s[20:23], s65 offen sc1
v_accvgpr_read_b32 v144, a136
v_mfma_f32_16x16x32_bf16 a[60:63], v[200:203], v[40:43], a[60:63]
s_waitcnt lgkmcnt(0)
ds_read_b64_tr_b16 v[224:225], v245
v_accvgpr_read_b32 v145, a137
v_accvgpr_read_b32 v146, a138
v_mfma_f32_16x16x32_bf16 a[64:67], v[208:211], v[16:19], 0
ds_read_b64_tr_b16 v[226:227], v245 offset:5120
v_accvgpr_read_b32 v147, a139
v_accvgpr_read_b32 v148, a152
v_mfma_f32_16x16x32_bf16 a[64:67], v[212:215], v[20:23], a[64:67]
ds_read_b64_tr_b16 v[228:229], v245 offset:10240
v_accvgpr_read_b32 v149, a153
v_accvgpr_read_b32 v150, a154
v_mfma_f32_16x16x32_bf16 a[68:71], v[212:215], v[28:31], 0
ds_read_b64_tr_b16 v[230:231], v245 offset:15360
buffer_load_dwordx4 v[188:191], v250, s[20:23], s56 offen offset:1024 sc1
v_accvgpr_read_b32 v151, a155
v_mfma_f32_16x16x32_bf16 a[68:71], v[208:211], v[24:27], a[68:71]
s_add_u32 s56, s56, 2048
v_mul_f32 v144, v144, v12
v_mul_f32 v145, v145, v12
v_mul_f32 v146, v146, v12
v_mfma_f32_16x16x32_bf16 a[72:75], v[208:211], v[32:35], 0
ds_read_b64_tr_b16 v[232:233], v246
v_mul_f32 v147, v147, v12
v_mul_f32 v148, v148, v12
v_mfma_f32_16x16x32_bf16 a[72:75], v[212:215], v[36:39], a[72:75]
ds_read_b64_tr_b16 v[234:235], v246 offset:5120
v_mul_f32 v149, v149, v12
v_mul_f32 v150, v150, v12
v_mfma_f32_16x16x32_bf16 a[76:79], v[212:215], v[44:47], 0
ds_read_b64_tr_b16 v[236:237], v246 offset:10240
v_mul_f32 v151, v151, v12
v_cvt_pk_bf16_f32 v88, v144, v145
v_mfma_f32_16x16x32_bf16 a[76:79], v[208:211], v[40:43], a[76:79]
s_waitcnt lgkmcnt(7)
ds_read_b64_tr_b16 v[238:239], v246 offset:15360
v_cvt_pk_bf16_f32 v89, v146, v147
v_cvt_pk_bf16_f32 v90, v148, v149
v_mfma_f32_16x16x32_bf16 a[80:83], v[216:219], v[16:19], 0
v_cvt_pk_bf16_f32 v91, v150, v151
v_mfma_f32_16x16x32_bf16 a[80:83], v[220:223], v[20:23], a[80:83]
ds_read_b64_tr_b16 v[192:193], v245 offset:64
buffer_store_dwordx4 v[88:91], v14, s[20:23], s66 offen sc1
v_accvgpr_read_b32 v152, a140
v_mfma_f32_16x16x32_bf16 a[84:87], v[220:223], v[28:31], 0
ds_read_b64_tr_b16 v[194:195], v245 offset:5184
v_accvgpr_read_b32 v153, a141
v_accvgpr_read_b32 v154, a142
v_mfma_f32_16x16x32_bf16 a[84:87], v[216:219], v[24:27], a[84:87]
ds_read_b64_tr_b16 v[196:197], v245 offset:10304
v_accvgpr_read_b32 v155, a143
v_accvgpr_read_b32 v156, a156
v_mfma_f32_16x16x32_bf16 a[88:91], v[216:219], v[32:35], 0
ds_read_b64_tr_b16 v[198:199], v245 offset:15424
v_accvgpr_read_b32 v157, a157
v_accvgpr_read_b32 v158, a158
v_mfma_f32_16x16x32_bf16 a[88:91], v[220:223], v[36:39], a[88:91]
v_accvgpr_read_b32 v159, a159
v_mul_f32 v152, v152, v13
v_mul_f32 v153, v153, v13
v_mfma_f32_16x16x32_bf16 a[92:95], v[220:223], v[44:47], 0
s_waitcnt vmcnt(35)
v_mul_f32 v154, v154, v13
v_mul_f32 v155, v155, v13
v_mul_f32 v156, v156, v13
v_mfma_f32_16x16x32_bf16 a[92:95], v[216:219], v[40:43], a[92:95]
s_waitcnt lgkmcnt(8)
v_mul_f32 v157, v157, v13
v_mul_f32 v158, v158, v13
v_mul_f32 v159, v159, v13
v_cvt_pk_bf16_f32 v92, v152, v153
v_cvt_pk_bf16_f32 v93, v154, v155
v_cvt_pk_bf16_f32 v94, v156, v157
v_cvt_pk_bf16_f32 v95, v158, v159
buffer_store_dwordx4 v[92:95], v14, s[20:23], s67 offen sc1
v_accvgpr_read_b32 v144, a160
v_accvgpr_read_b32 v145, a161
v_accvgpr_read_b32 v146, a162
v_accvgpr_read_b32 v147, a163
v_accvgpr_read_b32 v148, a176
v_accvgpr_read_b32 v149, a177
v_accvgpr_read_b32 v150, a178
v_accvgpr_read_b32 v151, a179
v_pk_mul_f32 v[144:145], v[144:145], v[10:11] op_sel:[0,0] op_sel_hi:[1,0]
v_pk_mul_f32 v[146:147], v[146:147], v[10:11] op_sel:[0,0] op_sel_hi:[1,0]
v_pk_mul_f32 v[148:149], v[148:149], v[10:11] op_sel:[0,0] op_sel_hi:[1,0]
v_pk_mul_f32 v[150:151], v[150:151], v[10:11] op_sel:[0,0] op_sel_hi:[1,0]
v_cvt_pk_bf16_f32 v96, v144, v145
v_cvt_pk_bf16_f32 v97, v146, v147
v_cvt_pk_bf16_f32 v98, v148, v149
v_cvt_pk_bf16_f32 v99, v150, v151
buffer_store_dwordx4 v[96:99], v14, s[20:23], s64 offen offset:1024 sc1
v_accvgpr_read_b32 v152, a164
v_accvgpr_read_b32 v153, a165
v_accvgpr_read_b32 v154, a166
v_accvgpr_read_b32 v155, a167
v_accvgpr_read_b32 v156, a180
v_accvgpr_read_b32 v157, a181
v_accvgpr_read_b32 v158, a182
v_accvgpr_read_b32 v159, a183
v_pk_mul_f32 v[152:153], v[152:153], v[10:11] op_sel:[0,1] op_sel_hi:[1,1]
v_pk_mul_f32 v[154:155], v[154:155], v[10:11] op_sel:[0,1] op_sel_hi:[1,1]
v_pk_mul_f32 v[156:157], v[156:157], v[10:11] op_sel:[0,1] op_sel_hi:[1,1]
v_pk_mul_f32 v[158:159], v[158:159], v[10:11] op_sel:[0,1] op_sel_hi:[1,1]
v_cvt_pk_bf16_f32 v100, v152, v153
v_cvt_pk_bf16_f32 v101, v154, v155
v_cvt_pk_bf16_f32 v102, v156, v157
v_cvt_pk_bf16_f32 v103, v158, v159
buffer_store_dwordx4 v[100:103], v14, s[20:23], s65 offen offset:1024 sc1
v_accvgpr_read_b32 v144, a168
v_accvgpr_read_b32 v145, a169
v_accvgpr_read_b32 v146, a170
v_accvgpr_read_b32 v147, a171
v_accvgpr_read_b32 v148, a184
v_accvgpr_read_b32 v149, a185
v_accvgpr_read_b32 v150, a186
v_accvgpr_read_b32 v151, a187
v_pk_mul_f32 v[144:145], v[144:145], v[12:13] op_sel:[0,0] op_sel_hi:[1,0]
v_pk_mul_f32 v[146:147], v[146:147], v[12:13] op_sel:[0,0] op_sel_hi:[1,0]
v_pk_mul_f32 v[148:149], v[148:149], v[12:13] op_sel:[0,0] op_sel_hi:[1,0]
v_pk_mul_f32 v[150:151], v[150:151], v[12:13] op_sel:[0,0] op_sel_hi:[1,0]
v_cvt_pk_bf16_f32 v104, v144, v145
v_cvt_pk_bf16_f32 v105, v146, v147
v_cvt_pk_bf16_f32 v106, v148, v149
v_cvt_pk_bf16_f32 v107, v150, v151
buffer_store_dwordx4 v[104:107], v14, s[20:23], s66 offen offset:1024 sc1
v_accvgpr_read_b32 v152, a172
v_accvgpr_read_b32 v153, a173
v_accvgpr_read_b32 v154, a174
v_accvgpr_read_b32 v155, a175
v_accvgpr_read_b32 v156, a188
v_accvgpr_read_b32 v157, a189
v_accvgpr_read_b32 v158, a190
v_accvgpr_read_b32 v159, a191
v_pk_mul_f32 v[152:153], v[152:153], v[12:13] op_sel:[0,1] op_sel_hi:[1,1]
v_pk_mul_f32 v[154:155], v[154:155], v[12:13] op_sel:[0,1] op_sel_hi:[1,1]
v_pk_mul_f32 v[156:157], v[156:157], v[12:13] op_sel:[0,1] op_sel_hi:[1,1]
v_pk_mul_f32 v[158:159], v[158:159], v[12:13] op_sel:[0,1] op_sel_hi:[1,1]
v_cvt_pk_bf16_f32 v108, v152, v153
v_cvt_pk_bf16_f32 v109, v154, v155
v_cvt_pk_bf16_f32 v110, v156, v157
v_cvt_pk_bf16_f32 v111, v158, v159
buffer_store_dwordx4 v[108:111], v14, s[20:23], s67 offen offset:1024 sc1
v_mfma_f32_16x16x32_bf16 a[192:195], v[224:227], v[48:51], a[192:195]
s_mov_b32 s58, s15
s_add_u32 s62, s61, 122880
ds_read_b64_tr_b16 v[200:201], v246 offset:64
v_lshlrev_b32 v4, 4, v0
v_mfma_f32_16x16x32_bf16 a[192:195], v[228:231], v[52:55], a[192:195]
s_add_u32 s59, s58, 20480
s_add_u32 m0, s62, 0
s_mul_i32 s74, s52, 10240
v_add_u32 v2, s74, v4
v_mfma_f32_16x16x32_bf16 a[196:199], v[228:231], v[60:63], a[196:199]
s_xor_b32 s74, s52, 2
ds_read_b64_tr_b16 v[202:203], v246 offset:5184
buffer_load_dwordx4 v240, s[40:43], s58 offen lds
v_mfma_f32_16x16x32_bf16 a[196:199], v[224:227], v[56:59], a[196:199]
s_mul_i32 s74, s74, 10240
v_add_u32 v3, s74, v4
v_mfma_f32_16x16x32_bf16 a[200:203], v[224:227], v[64:67], a[200:203]
s_mov_b32 s8, 0x3f80
s_mov_b32 s9, 0x3f800000
ds_read_b64_tr_b16 v[204:205], v246 offset:10304
v_lshlrev_b32 v1, 3, v0
v_mfma_f32_16x16x32_bf16 a[200:203], v[228:231], v[68:71], a[200:203]
v_add_u32 v1, 2048, v1
v_mfma_f32_16x16x32_bf16 a[204:207], v[228:231], v[76:79], a[204:207]
s_add_u32 s14, s13, 75497472
ds_read_b64_tr_b16 v[206:207], v246 offset:15424
buffer_load_dwordx4 v241, s[40:43], s58 offen offset:1024 lds
v_mfma_f32_16x16x32_bf16 a[204:207], v[224:227], v[72:75], a[204:207]
s_waitcnt lgkmcnt(8)
s_mov_b32 s56, s75
v_mfma_f32_16x16x32_bf16 a[208:211], v[232:235], v[48:51], a[208:211]
ds_read_b64_tr_b16 v[208:209], v245 offset:128
v_mfma_f32_16x16x32_bf16 a[208:211], v[236:239], v[52:55], a[208:211]
v_mfma_f32_16x16x32_bf16 a[212:215], v[236:239], v[60:63], a[212:215]
ds_read_b64_tr_b16 v[210:211], v245 offset:5248
v_mfma_f32_16x16x32_bf16 a[212:215], v[232:235], v[56:59], a[212:215]
v_mfma_f32_16x16x32_bf16 a[216:219], v[232:235], v[64:67], a[216:219]
ds_read_b64_tr_b16 v[212:213], v245 offset:10368
buffer_load_dwordx4 v242, s[40:43], s58 offen offset:2048 lds
v_mfma_f32_16x16x32_bf16 a[216:219], v[236:239], v[68:71], a[216:219]
v_mfma_f32_16x16x32_bf16 a[220:223], v[236:239], v[76:79], a[220:223]
ds_read_b64_tr_b16 v[214:215], v245 offset:15488
v_mfma_f32_16x16x32_bf16 a[220:223], v[232:235], v[72:75], a[220:223]
s_waitcnt lgkmcnt(8)
v_mfma_f32_16x16x32_bf16 a[224:227], v[192:195], v[48:51], a[224:227]
ds_read_b64_tr_b16 v[216:217], v8
v_mfma_f32_16x16x32_bf16 a[224:227], v[196:199], v[52:55], a[224:227]
v_mfma_f32_16x16x32_bf16 a[228:231], v[196:199], v[60:63], a[228:231]
ds_read_b64_tr_b16 v[218:219], v8 offset:5120
buffer_load_dwordx4 v243, s[40:43], s58 offen offset:3072 lds
v_mfma_f32_16x16x32_bf16 a[228:231], v[192:195], v[56:59], a[228:231]
s_add_u32 m0, s62, 4096
v_mfma_f32_16x16x32_bf16 a[232:235], v[192:195], v[64:67], a[232:235]
ds_read_b64_tr_b16 v[220:221], v8 offset:10240
v_mfma_f32_16x16x32_bf16 a[232:235], v[196:199], v[68:71], a[232:235]
v_mfma_f32_16x16x32_bf16 a[236:239], v[196:199], v[76:79], a[236:239]
ds_read_b64_tr_b16 v[222:223], v8 offset:15360
v_mfma_f32_16x16x32_bf16 a[236:239], v[192:195], v[72:75], a[236:239]
s_waitcnt lgkmcnt(8)
v_mfma_f32_16x16x32_bf16 a[240:243], v[200:203], v[48:51], a[240:243]
ds_read_b64_tr_b16 v[224:225], v9
buffer_load_dwordx4 v244, s[40:43], s58 offen lds
v_mfma_f32_16x16x32_bf16 a[240:243], v[204:207], v[52:55], a[240:243]
s_add_u32 m0, s62, 5120
v_mfma_f32_16x16x32_bf16 a[244:247], v[204:207], v[60:63], a[244:247]
ds_read_b64_tr_b16 v[226:227], v9 offset:5120
v_mfma_f32_16x16x32_bf16 a[244:247], v[200:203], v[56:59], a[244:247]
v_mfma_f32_16x16x32_bf16 a[248:251], v[200:203], v[64:67], a[248:251]
ds_read_b64_tr_b16 v[228:229], v9 offset:10240
v_mfma_f32_16x16x32_bf16 a[248:251], v[204:207], v[68:71], a[248:251]
v_mfma_f32_16x16x32_bf16 a[252:255], v[204:207], v[76:79], a[252:255]
ds_read_b64_tr_b16 v[230:231], v9 offset:15360
v_add_u32 v245, 40960, v245
v_mfma_f32_16x16x32_bf16 a[252:255], v[200:203], v[72:75], a[252:255]
s_waitcnt lgkmcnt(8)
buffer_load_dwordx4 v240, s[40:43], s59 offen lds
v_mfma_f32_16x16x32_bf16 a[0:3], v[208:211], v[48:51], a[0:3]
ds_read_b64_tr_b16 v[232:233], v8 offset:64
v_add_u32 v246, 40960, v246
v_mfma_f32_16x16x32_bf16 a[0:3], v[212:215], v[52:55], a[0:3]
v_mfma_f32_16x16x32_bf16 a[4:7], v[212:215], v[60:63], a[4:7]
ds_read_b64_tr_b16 v[234:235], v8 offset:5184
v_mfma_f32_16x16x32_bf16 a[4:7], v[208:211], v[56:59], a[4:7]
v_mfma_f32_16x16x32_bf16 a[8:11], v[208:211], v[64:67], a[8:11]
ds_read_b64_tr_b16 v[236:237], v8 offset:10304
buffer_load_dwordx4 v241, s[40:43], s59 offen offset:1024 lds
v_mfma_f32_16x16x32_bf16 a[8:11], v[212:215], v[68:71], a[8:11]
v_mfma_f32_16x16x32_bf16 a[12:15], v[212:215], v[76:79], a[12:15]
ds_read_b64_tr_b16 v[238:239], v8 offset:15424
v_mfma_f32_16x16x32_bf16 a[12:15], v[208:211], v[72:75], a[12:15]
s_waitcnt lgkmcnt(8)
v_mfma_f32_16x16x32_bf16 a[16:19], v[216:219], v[48:51], a[16:19]
s_waitcnt vmcnt(7)
ds_read_b64_tr_b16 v[192:193], v9 offset:64
buffer_store_dwordx2 v[254:255], v252, s[20:23], s17 offen sc1
v_mfma_f32_16x16x32_bf16 a[16:19], v[220:223], v[52:55], a[16:19]
v_mfma_f32_16x16x32_bf16 a[20:23], v[220:223], v[60:63], a[20:23]
ds_read_b64_tr_b16 v[194:195], v9 offset:5184
buffer_load_dwordx4 v242, s[40:43], s59 offen offset:2048 lds
v_mfma_f32_16x16x32_bf16 a[20:23], v[216:219], v[56:59], a[20:23]
v_mfma_f32_16x16x32_bf16 a[24:27], v[216:219], v[64:67], a[24:27]
ds_read_b64_tr_b16 v[196:197], v9 offset:10304
v_mfma_f32_16x16x32_bf16 a[24:27], v[220:223], v[68:71], a[24:27]
v_mfma_f32_16x16x32_bf16 a[28:31], v[220:223], v[76:79], a[28:31]
ds_read_b64_tr_b16 v[198:199], v9 offset:15424
v_mfma_f32_16x16x32_bf16 a[28:31], v[216:219], v[72:75], a[28:31]
s_waitcnt lgkmcnt(8)
v_mfma_f32_16x16x32_bf16 a[32:35], v[224:227], v[48:51], a[32:35]
ds_read_b64_tr_b16 v[200:201], v8 offset:128
buffer_load_dwordx4 v243, s[40:43], s59 offen offset:3072 lds
v_mfma_f32_16x16x32_bf16 a[32:35], v[228:231], v[52:55], a[32:35]
s_add_u32 m0, s62, 9216
v_mfma_f32_16x16x32_bf16 a[36:39], v[228:231], v[60:63], a[36:39]
ds_read_b64_tr_b16 v[202:203], v8 offset:5248
v_mfma_f32_16x16x32_bf16 a[36:39], v[224:227], v[56:59], a[36:39]
v_mfma_f32_16x16x32_bf16 a[40:43], v[224:227], v[64:67], a[40:43]
ds_read_b64_tr_b16 v[204:205], v8 offset:10368
v_mfma_f32_16x16x32_bf16 a[40:43], v[228:231], v[68:71], a[40:43]
v_mfma_f32_16x16x32_bf16 a[44:47], v[228:231], v[76:79], a[44:47]
ds_read_b64_tr_b16 v[206:207], v8 offset:15488
buffer_load_dwordx4 v244, s[40:43], s59 offen lds
v_mfma_f32_16x16x32_bf16 a[44:47], v[224:227], v[72:75], a[44:47]
s_waitcnt lgkmcnt(8)
s_add_u32 s58, s58, 81920
v_mfma_f32_16x16x32_bf16 a[48:51], v[232:235], v[48:51], a[48:51]
v_mfma_f32_16x16x32_bf16 a[48:51], v[236:239], v[52:55], a[48:51]
v_mfma_f32_16x16x32_bf16 a[52:55], v[236:239], v[60:63], a[52:55]
v_add_u32 v8, 40960, v8
v_mfma_f32_16x16x32_bf16 a[52:55], v[232:235], v[56:59], a[52:55]
v_add_u32 v9, 40960, v9
v_mfma_f32_16x16x32_bf16 a[56:59], v[232:235], v[64:67], a[56:59]
v_mfma_f32_16x16x32_bf16 a[56:59], v[236:239], v[68:71], a[56:59]
v_mfma_f32_16x16x32_bf16 a[60:63], v[236:239], v[76:79], a[60:63]
s_waitcnt vmcnt(11) lgkmcnt(0)
s_barrier
v_mfma_f32_16x16x32_bf16 a[60:63], v[232:235], v[72:75], a[60:63]
s_waitcnt lgkmcnt(0)
ds_read_b64_tr_b16 v[208:209], v245
v_mfma_f32_16x16x32_bf16 a[64:67], v[192:195], v[48:51], a[64:67]
ds_read_b64_tr_b16 v[210:211], v245 offset:5120
v_mfma_f32_16x16x32_bf16 a[64:67], v[196:199], v[52:55], a[64:67]
ds_read_b64_tr_b16 v[212:213], v245 offset:10240
v_mfma_f32_16x16x32_bf16 a[68:71], v[196:199], v[60:63], a[68:71]
ds_read_b64_tr_b16 v[214:215], v245 offset:15360
v_mfma_f32_16x16x32_bf16 a[68:71], v[192:195], v[56:59], a[68:71]
v_mfma_f32_16x16x32_bf16 a[72:75], v[192:195], v[64:67], a[72:75]
ds_read_b64_tr_b16 v[216:217], v246
v_mfma_f32_16x16x32_bf16 a[72:75], v[196:199], v[68:71], a[72:75]
ds_read_b64_tr_b16 v[218:219], v246 offset:5120
v_mfma_f32_16x16x32_bf16 a[76:79], v[196:199], v[76:79], a[76:79]
ds_read_b64_tr_b16 v[220:221], v246 offset:10240
v_mfma_f32_16x16x32_bf16 a[76:79], v[192:195], v[72:75], a[76:79]
s_waitcnt lgkmcnt(7)
ds_read_b64_tr_b16 v[222:223], v246 offset:15360
v_mfma_f32_16x16x32_bf16 a[80:83], v[200:203], v[48:51], a[80:83]
v_mfma_f32_16x16x32_bf16 a[80:83], v[204:207], v[52:55], a[80:83]
ds_read_b64_tr_b16 v[224:225], v245 offset:64
v_mfma_f32_16x16x32_bf16 a[84:87], v[204:207], v[60:63], a[84:87]
ds_read_b64_tr_b16 v[226:227], v245 offset:5184
v_mfma_f32_16x16x32_bf16 a[84:87], v[200:203], v[56:59], a[84:87]
ds_read_b64_tr_b16 v[228:229], v245 offset:10304
v_mfma_f32_16x16x32_bf16 a[88:91], v[200:203], v[64:67], a[88:91]
ds_read_b64_tr_b16 v[230:231], v245 offset:15424
v_mfma_f32_16x16x32_bf16 a[88:91], v[204:207], v[68:71], a[88:91]
v_mfma_f32_16x16x32_bf16 a[92:95], v[204:207], v[76:79], a[92:95]
s_waitcnt vmcnt(11)
v_mfma_f32_16x16x32_bf16 a[92:95], v[200:203], v[72:75], a[92:95]
s_waitcnt lgkmcnt(8)
v_mfma_f32_16x16x32_bf16 a[192:195], v[208:211], v[160:163], a[192:195]
s_lshl_b32 s15, s72, 2
s_add_u32 s15, s15, s73
ds_read_b64_tr_b16 v[232:233], v246 offset:64
v_mfma_f32_16x16x32_bf16 a[192:195], v[212:215], v[164:167], a[192:195]
s_mul_i32 s62, s15, 196608
s_mul_i32 s74, s52, 3072
s_add_u32 s62, s62, s74
v_mfma_f32_16x16x32_bf16 a[196:199], v[212:215], v[172:175], a[196:199]
s_add_u32 s62, s62, 37748736
s_mul_i32 s74, s3, 49152
ds_read_b64_tr_b16 v[234:235], v246 offset:5184
v_mfma_f32_16x16x32_bf16 a[196:199], v[208:211], v[168:171], a[196:199]
s_add_u32 s26, s62, s74
s_mul_i32 s74, s3, 12288
s_add_u32 s62, s62, s74
v_mfma_f32_16x16x32_bf16 a[200:203], v[208:211], v[176:179], a[200:203]
s_add_u32 s18, s3, 1
s_and_b32 s18, s18, 3
ds_read_b64_tr_b16 v[236:237], v246 offset:10304
v_mfma_f32_16x16x32_bf16 a[200:203], v[212:215], v[180:183], a[200:203]
s_mul_i32 s18, s18, 49152
s_add_u32 s18, s18, s62
s_add_u32 s19, s3, 2
v_mfma_f32_16x16x32_bf16 a[204:207], v[212:215], v[188:191], a[204:207]
s_and_b32 s19, s19, 3
s_mul_i32 s19, s19, 49152
ds_read_b64_tr_b16 v[238:239], v246 offset:15424
v_mfma_f32_16x16x32_bf16 a[204:207], v[208:211], v[184:187], a[204:207]
s_waitcnt lgkmcnt(8)
s_add_u32 s19, s19, s62
s_add_u32 s16, s3, 3
v_mfma_f32_16x16x32_bf16 a[208:211], v[216:219], v[160:163], a[208:211]
s_and_b32 s16, s16, 3
s_mul_i32 s16, s16, 49152
ds_read_b64_tr_b16 v[192:193], v245 offset:128
v_mfma_f32_16x16x32_bf16 a[208:211], v[220:223], v[164:167], a[208:211]
s_add_u32 s16, s16, s62
s_lshl_b32 s66, s15, 2
s_add_u32 s66, s66, s52
v_accvgpr_read_b32 v140, a192
v_mfma_f32_16x16x32_bf16 a[212:215], v[220:223], v[172:175], a[212:215]
s_lshl_b32 s66, s66, 6
s_add_u32 s24, s66, 75546624
ds_read_b64_tr_b16 v[194:195], v245 offset:5248
v_accvgpr_read_b32 v141, a193
v_mfma_f32_16x16x32_bf16 a[212:215], v[216:219], v[168:171], a[212:215]
s_add_u32 s25, s66, 75530240
v_accvgpr_read_b32 v142, a194
v_accvgpr_read_b32 v143, a195
v_cvt_pk_bf16_f32 v144, v140, v141
v_mfma_f32_16x16x32_bf16 a[216:219], v[216:219], v[176:179], a[216:219]
ds_read_b64_tr_b16 v[196:197], v245 offset:10368
v_cvt_pk_bf16_f32 v145, v142, v143
v_accvgpr_read_b32 v140, a196
v_mfma_f32_16x16x32_bf16 a[216:219], v[220:223], v[180:183], a[216:219]
v_accvgpr_read_b32 v141, a197
v_accvgpr_read_b32 v142, a198
v_accvgpr_read_b32 v143, a199
v_mfma_f32_16x16x32_bf16 a[220:223], v[220:223], v[188:191], a[220:223]
ds_read_b64_tr_b16 v[198:199], v245 offset:15488
v_cvt_pk_bf16_f32 v146, v140, v141
v_cvt_pk_bf16_f32 v147, v142, v143
v_mfma_f32_16x16x32_bf16 a[220:223], v[216:219], v[184:187], a[220:223]
s_waitcnt lgkmcnt(8)
ds_write_b128 v2, v[144:147]
v_accvgpr_read_b32 v148, a200
v_accvgpr_read_b32 v149, a201
v_mfma_f32_16x16x32_bf16 a[224:227], v[224:227], v[160:163], a[224:227]
ds_read_b64_tr_b16 v[200:201], v8
v_accvgpr_read_b32 v150, a202
v_accvgpr_read_b32 v151, a203
v_mfma_f32_16x16x32_bf16 a[224:227], v[228:231], v[164:167], a[224:227]
v_cvt_pk_bf16_f32 v152, v148, v149
v_cvt_pk_bf16_f32 v153, v150, v151
v_accvgpr_read_b32 v148, a204
v_mfma_f32_16x16x32_bf16 a[228:231], v[228:231], v[172:175], a[228:231]
ds_read_b64_tr_b16 v[202:203], v8 offset:5120
v_accvgpr_read_b32 v149, a205
v_accvgpr_read_b32 v150, a206
v_mfma_f32_16x16x32_bf16 a[228:231], v[224:227], v[168:171], a[228:231]
v_accvgpr_read_b32 v151, a207
v_cvt_pk_bf16_f32 v154, v148, v149
v_cvt_pk_bf16_f32 v155, v150, v151
v_mfma_f32_16x16x32_bf16 a[232:235], v[224:227], v[176:179], a[232:235]
ds_read_b64_tr_b16 v[204:205], v8 offset:10240
ds_write_b128 v2, v[152:155] offset:1024
v_accvgpr_read_b32 v140, a208
v_mfma_f32_16x16x32_bf16 a[232:235], v[228:231], v[180:183], a[232:235]
v_accvgpr_read_b32 v141, a209
v_accvgpr_read_b32 v142, a210
v_accvgpr_read_b32 v143, a211
v_mfma_f32_16x16x32_bf16 a[236:239], v[228:231], v[188:191], a[236:239]
ds_read_b64_tr_b16 v[206:207], v8 offset:15360
v_cvt_pk_bf16_f32 v144, v140, v141
v_cvt_pk_bf16_f32 v145, v142, v143
v_mfma_f32_16x16x32_bf16 a[236:239], v[224:227], v[184:187], a[236:239]
s_waitcnt lgkmcnt(10)
v_accvgpr_read_b32 v140, a212
v_accvgpr_read_b32 v141, a213
v_accvgpr_read_b32 v142, a214
v_mfma_f32_16x16x32_bf16 a[240:243], v[232:235], v[160:163], a[240:243]
ds_read_b64_tr_b16 v[208:209], v9
v_accvgpr_read_b32 v143, a215
v_cvt_pk_bf16_f32 v146, v140, v141
v_mfma_f32_16x16x32_bf16 a[240:243], v[236:239], v[164:167], a[240:243]
v_cvt_pk_bf16_f32 v147, v142, v143
v_mfma_f32_16x16x32_bf16 a[244:247], v[236:239], v[172:175], a[244:247]
ds_read_b64_tr_b16 v[210:211], v9 offset:5120
ds_write_b128 v2, v[144:147] offset:2048
v_accvgpr_read_b32 v148, a216
v_mfma_f32_16x16x32_bf16 a[244:247], v[232:235], v[168:171], a[244:247]
v_accvgpr_read_b32 v149, a217
v_accvgpr_read_b32 v150, a218
v_accvgpr_read_b32 v151, a219
v_mfma_f32_16x16x32_bf16 a[248:251], v[232:235], v[176:179], a[248:251]
ds_read_b64_tr_b16 v[212:213], v9 offset:10240
v_cvt_pk_bf16_f32 v152, v148, v149
v_cvt_pk_bf16_f32 v153, v150, v151
v_mfma_f32_16x16x32_bf16 a[248:251], v[236:239], v[180:183], a[248:251]
v_accvgpr_read_b32 v148, a220
v_accvgpr_read_b32 v149, a221
v_accvgpr_read_b32 v150, a222
v_mfma_f32_16x16x32_bf16 a[252:255], v[236:239], v[188:191], a[252:255]
ds_read_b64_tr_b16 v[214:215], v9 offset:15360
v_add_u32 v245, 40960, v245
v_accvgpr_read_b32 v151, a223
v_mfma_f32_16x16x32_bf16 a[252:255], v[232:235], v[184:187], a[252:255]
s_waitcnt lgkmcnt(11)
v_cvt_pk_bf16_f32 v154, v148, v149
v_cvt_pk_bf16_f32 v155, v150, v151
v_mfma_f32_16x16x32_bf16 a[0:3], v[192:195], v[160:163], a[0:3]
ds_read_b64_tr_b16 v[216:217], v8 offset:64
v_add_u32 v246, 40960, v246
v_mfma_f32_16x16x32_bf16 a[0:3], v[196:199], v[164:167], a[0:3]
ds_write_b128 v2, v[152:155] offset:3072
v_accvgpr_read_b32 v140, a224
v_accvgpr_read_b32 v141, a225
v_mfma_f32_16x16x32_bf16 a[4:7], v[196:199], v[172:175], a[4:7]
ds_read_b64_tr_b16 v[218:219], v8 offset:5184
v_accvgpr_read_b32 v142, a226
v_accvgpr_read_b32 v143, a227
v_mfma_f32_16x16x32_bf16 a[4:7], v[192:195], v[168:171], a[4:7]
v_cvt_pk_bf16_f32 v144, v140, v141
v_cvt_pk_bf16_f32 v145, v142, v143
v_accvgpr_read_b32 v140, a228
v_mfma_f32_16x16x32_bf16 a[8:11], v[192:195], v[176:179], a[8:11]
ds_read_b64_tr_b16 v[220:221], v8 offset:10304
v_accvgpr_read_b32 v141, a229
v_accvgpr_read_b32 v142, a230
v_mfma_f32_16x16x32_bf16 a[8:11], v[196:199], v[180:183], a[8:11]
v_accvgpr_read_b32 v143, a231
v_cvt_pk_bf16_f32 v146, v140, v141
v_cvt_pk_bf16_f32 v147, v142, v143
v_mfma_f32_16x16x32_bf16 a[12:15], v[196:199], v[188:191], a[12:15]
ds_read_b64_tr_b16 v[222:223], v8 offset:15424
ds_write_b128 v2, v[144:147] offset:4096
v_accvgpr_read_b32 v148, a232
v_mfma_f32_16x16x32_bf16 a[12:15], v[192:195], v[184:187], a[12:15]
s_waitcnt lgkmcnt(11)
v_accvgpr_read_b32 v149, a233
v_accvgpr_read_b32 v150, a234
v_accvgpr_read_b32 v151, a235
v_mfma_f32_16x16x32_bf16 a[16:19], v[200:203], v[160:163], a[16:19]
ds_read_b64_tr_b16 v[224:225], v9 offset:64
v_cvt_pk_bf16_f32 v152, v148, v149
v_cvt_pk_bf16_f32 v153, v150, v151
v_mfma_f32_16x16x32_bf16 a[16:19], v[204:207], v[164:167], a[16:19]
v_accvgpr_read_b32 v148, a236
v_accvgpr_read_b32 v149, a237
v_accvgpr_read_b32 v150, a238
v_mfma_f32_16x16x32_bf16 a[20:23], v[204:207], v[172:175], a[20:23]
ds_read_b64_tr_b16 v[226:227], v9 offset:5184
v_accvgpr_read_b32 v151, a239
v_cvt_pk_bf16_f32 v154, v148, v149
v_mfma_f32_16x16x32_bf16 a[20:23], v[200:203], v[168:171], a[20:23]
v_cvt_pk_bf16_f32 v155, v150, v151
v_mfma_f32_16x16x32_bf16 a[24:27], v[200:203], v[176:179], a[24:27]
ds_read_b64_tr_b16 v[228:229], v9 offset:10304
ds_write_b128 v2, v[152:155] offset:5120
v_accvgpr_read_b32 v140, a240
v_mfma_f32_16x16x32_bf16 a[24:27], v[204:207], v[180:183], a[24:27]
v_accvgpr_read_b32 v141, a241
v_accvgpr_read_b32 v142, a242
v_accvgpr_read_b32 v143, a243
v_mfma_f32_16x16x32_bf16 a[28:31], v[204:207], v[188:191], a[28:31]
ds_read_b64_tr_b16 v[230:231], v9 offset:15424
v_cvt_pk_bf16_f32 v144, v140, v141
v_cvt_pk_bf16_f32 v145, v142, v143
v_mfma_f32_16x16x32_bf16 a[28:31], v[200:203], v[184:187], a[28:31]
s_waitcnt lgkmcnt(11)
v_accvgpr_read_b32 v140, a244
v_accvgpr_read_b32 v141, a245
v_accvgpr_read_b32 v142, a246
v_mfma_f32_16x16x32_bf16 a[32:35], v[208:211], v[160:163], a[32:35]
ds_read_b64_tr_b16 v[232:233], v8 offset:128
v_accvgpr_read_b32 v143, a247
v_cvt_pk_bf16_f32 v146, v140, v141
v_mfma_f32_16x16x32_bf16 a[32:35], v[212:215], v[164:167], a[32:35]
v_cvt_pk_bf16_f32 v147, v142, v143
v_mfma_f32_16x16x32_bf16 a[36:39], v[212:215], v[172:175], a[36:39]
ds_read_b64_tr_b16 v[234:235], v8 offset:5248
ds_write_b128 v2, v[144:147] offset:6144
v_accvgpr_read_b32 v148, a248
v_mfma_f32_16x16x32_bf16 a[36:39], v[208:211], v[168:171], a[36:39]
v_accvgpr_read_b32 v149, a249
v_accvgpr_read_b32 v150, a250
v_accvgpr_read_b32 v151, a251
v_mfma_f32_16x16x32_bf16 a[40:43], v[208:211], v[176:179], a[40:43]
ds_read_b64_tr_b16 v[236:237], v8 offset:10368
v_cvt_pk_bf16_f32 v152, v148, v149
v_cvt_pk_bf16_f32 v153, v150, v151
v_mfma_f32_16x16x32_bf16 a[40:43], v[212:215], v[180:183], a[40:43]
v_accvgpr_read_b32 v148, a252
v_accvgpr_read_b32 v149, a253
v_accvgpr_read_b32 v150, a254
v_mfma_f32_16x16x32_bf16 a[44:47], v[212:215], v[188:191], a[44:47]
ds_read_b64_tr_b16 v[238:239], v8 offset:15488
v_accvgpr_read_b32 v151, a255
v_cvt_pk_bf16_f32 v154, v148, v149
v_mfma_f32_16x16x32_bf16 a[44:47], v[208:211], v[184:187], a[44:47]
s_waitcnt lgkmcnt(11)
v_cvt_pk_bf16_f32 v155, v150, v151
v_mfma_f32_16x16x32_bf16 a[48:51], v[216:219], v[160:163], a[48:51]
buffer_load_dwordx2 v[14:15], v253, s[20:23], s14 offen sc1
ds_write_b128 v2, v[152:155] offset:7168
v_accvgpr_read_b32 v140, a0
v_mfma_f32_16x16x32_bf16 a[48:51], v[220:223], v[164:167], a[48:51]
v_accvgpr_read_b32 v141, a1
v_accvgpr_read_b32 v142, a2
v_accvgpr_read_b32 v143, a3
v_mfma_f32_16x16x32_bf16 a[52:55], v[220:223], v[172:175], a[52:55]
v_add_u32 v8, 40960, v8
v_cvt_pk_bf16_f32 v144, v140, v141
v_cvt_pk_bf16_f32 v145, v142, v143
v_mfma_f32_16x16x32_bf16 a[52:55], v[216:219], v[168:171], a[52:55]
v_add_u32 v9, 40960, v9
v_accvgpr_read_b32 v140, a4
v_accvgpr_read_b32 v141, a5
v_mfma_f32_16x16x32_bf16 a[56:59], v[216:219], v[176:179], a[56:59]
v_accvgpr_read_b32 v142, a6
v_accvgpr_read_b32 v143, a7
v_cvt_pk_bf16_f32 v146, v140, v141
v_mfma_f32_16x16x32_bf16 a[56:59], v[220:223], v[180:183], a[56:59]
v_cvt_pk_bf16_f32 v147, v142, v143
v_mfma_f32_16x16x32_bf16 a[60:63], v[220:223], v[188:191], a[60:63]
s_waitcnt vmcnt(1) lgkmcnt(0)
s_barrier
ds_write_b128 v2, v[144:147] offset:8192
v_accvgpr_read_b32 v148, a8
v_mfma_f32_16x16x32_bf16 a[60:63], v[216:219], v[184:187], a[60:63]
s_waitcnt lgkmcnt(1)
ds_read_b64_tr_b16 v[192:193], v245
v_accvgpr_read_b32 v149, a9
v_accvgpr_read_b32 v150, a10
v_mfma_f32_16x16x32_bf16 a[64:67], v[224:227], v[160:163], a[64:67]
ds_read_b64_tr_b16 v[194:195], v245 offset:5120
v_accvgpr_read_b32 v151, a11
v_cvt_pk_bf16_f32 v152, v148, v149
v_mfma_f32_16x16x32_bf16 a[64:67], v[228:231], v[164:167], a[64:67]
ds_read_b64_tr_b16 v[196:197], v245 offset:10240
v_cvt_pk_bf16_f32 v153, v150, v151
v_accvgpr_read_b32 v148, a12
v_mfma_f32_16x16x32_bf16 a[68:71], v[228:231], v[172:175], a[68:71]
ds_read_b64_tr_b16 v[198:199], v245 offset:15360
v_accvgpr_read_b32 v149, a13
v_accvgpr_read_b32 v150, a14
v_mfma_f32_16x16x32_bf16 a[68:71], v[224:227], v[168:171], a[68:71]
v_accvgpr_read_b32 v151, a15
v_cvt_pk_bf16_f32 v154, v148, v149
v_cvt_pk_bf16_f32 v155, v150, v151
v_mfma_f32_16x16x32_bf16 a[72:75], v[224:227], v[176:179], a[72:75]
ds_read_b64_tr_b16 v[200:201], v246
ds_write_b128 v2, v[152:155] offset:9216
v_mfma_f32_16x16x32_bf16 a[72:75], v[228:231], v[180:183], a[72:75]
ds_read_b64_tr_b16 v[202:203], v246 offset:5120
v_mfma_f32_16x16x32_bf16 a[76:79], v[228:231], v[188:191], a[76:79]
ds_read_b64_tr_b16 v[204:205], v246 offset:10240
v_mfma_f32_16x16x32_bf16 a[76:79], v[224:227], v[184:187], a[76:79]
s_waitcnt lgkmcnt(9)
ds_read_b64_tr_b16 v[206:207], v246 offset:15360
v_mfma_f32_16x16x32_bf16 a[80:83], v[232:235], v[160:163], a[80:83]
s_waitcnt lgkmcnt(0)
s_barrier
v_mfma_f32_16x16x32_bf16 a[80:83], v[236:239], v[164:167], a[80:83]
ds_read_b64_tr_b16 v[208:209], v245 offset:64
ds_read_b128 v[16:19], v3
v_mfma_f32_16x16x32_bf16 a[84:87], v[236:239], v[172:175], a[84:87]
ds_read_b64_tr_b16 v[210:211], v245 offset:5184
ds_read_b128 v[20:23], v3 offset:1024
v_mfma_f32_16x16x32_bf16 a[84:87], v[232:235], v[168:171], a[84:87]
ds_read_b64_tr_b16 v[212:213], v245 offset:10304
ds_read_b128 v[24:27], v3 offset:2048
v_mfma_f32_16x16x32_bf16 a[88:91], v[232:235], v[176:179], a[88:91]
ds_read_b64_tr_b16 v[214:215], v245 offset:15424
ds_read_b128 v[28:31], v3 offset:3072
v_mfma_f32_16x16x32_bf16 a[88:91], v[236:239], v[180:183], a[88:91]
ds_read_b128 v[32:35], v3 offset:4096
ds_read_b128 v[36:39], v3 offset:5120
v_mfma_f32_16x16x32_bf16 a[92:95], v[236:239], v[188:191], a[92:95]
ds_read_b128 v[40:43], v3 offset:6144
ds_read_b128 v[44:47], v3 offset:7168
v_mfma_f32_16x16x32_bf16 a[92:95], v[232:235], v[184:187], a[92:95]
s_waitcnt lgkmcnt(12)
ds_read_b128 v[130:133], v3 offset:8192
ds_read_b128 v[134:137], v3 offset:9216
s_waitcnt vmcnt(0)
v_cmp_ne_u32 vcc, s70, v14
v_cmp_ne_u32 s[64:65], s71, v15
s_nop 0
s_or_b32 s64, vcc_lo, s64
s_and_b32 s64, s64, s12
s_cmp_lg_u32 s64, 0
s_cselect_b32 s67, 1, 0
s_waitcnt lgkmcnt(0)
s_barrier
s_cmp_lg_u32 s67, 0
s_cbranch_scc1 L_o2
buffer_load_dwordx4 v[48:51], v247, s[20:23], s56 offen sc1
buffer_load_dwordx4 v[52:55], v247, s[20:23], s56 offen offset:1024 sc1
buffer_load_dwordx4 v[56:59], v248, s[20:23], s56 offen sc1
buffer_load_dwordx4 v[60:63], v248, s[20:23], s56 offen offset:1024 sc1
buffer_load_dwordx4 v[64:67], v249, s[20:23], s56 offen sc1
buffer_load_dwordx4 v[68:71], v249, s[20:23], s56 offen offset:1024 sc1
buffer_load_dwordx4 v[72:75], v250, s[20:23], s56 offen sc1
buffer_load_dwordx4 v[76:79], v250, s[20:23], s56 offen offset:1024 sc1
s_add_u32 s56, s56, 2048
v_accvgpr_read_b32 v140, a20
v_accvgpr_read_b32 v141, a21
v_accvgpr_read_b32 v142, a22
v_accvgpr_read_b32 v143, a23
buffer_load_dwordx4 v[160:163], v247, s[20:23], s56 offen sc1
v_accvgpr_read_b32 v144, a36
v_accvgpr_read_b32 v145, a37
v_accvgpr_read_b32 v146, a38
v_accvgpr_read_b32 v147, a39
v_accvgpr_read_b32 v148, a52
v_accvgpr_read_b32 v149, a53
v_accvgpr_read_b32 v150, a54
v_accvgpr_read_b32 v151, a55
buffer_load_dwordx4 v[164:167], v247, s[20:23], s56 offen offset:1024 sc1
v_accvgpr_read_b32 v152, a68
v_accvgpr_read_b32 v153, a69
v_accvgpr_read_b32 v154, a70
v_accvgpr_read_b32 v155, a71
v_accvgpr_read_b32 v156, a84
v_accvgpr_read_b32 v157, a85
v_accvgpr_read_b32 v158, a86
v_accvgpr_read_b32 v159, a87
buffer_load_dwordx4 v[168:171], v248, s[20:23], s56 offen sc1
v_dot2_f32_bf16 v140, v18, s8, v140
v_dot2_f32_bf16 v141, v18, s9, v141
v_dot2_f32_bf16 v142, v19, s8, v142
v_dot2_f32_bf16 v143, v19, s9, v143
v_dot2_f32_bf16 v144, v26, s8, v144
v_dot2_f32_bf16 v145, v26, s9, v145
v_dot2_f32_bf16 v146, v27, s8, v146
v_dot2_f32_bf16 v147, v27, s9, v147
buffer_load_dwordx4 v[172:175], v248, s[20:23], s56 offen offset:1024 sc1
v_dot2_f32_bf16 v148, v34, s8, v148
v_dot2_f32_bf16 v149, v34, s9, v149
v_dot2_f32_bf16 v150, v35, s8, v150
v_dot2_f32_bf16 v151, v35, s9, v151
v_dot2_f32_bf16 v152, v42, s8, v152
v_dot2_f32_bf16 v153, v42, s9, v153
v_dot2_f32_bf16 v154, v43, s8, v154
v_dot2_f32_bf16 v155, v43, s9, v155
buffer_load_dwordx4 v[176:179], v249, s[20:23], s56 offen sc1
v_dot2_f32_bf16 v156, v132, s8, v156
v_dot2_f32_bf16 v157, v132, s9, v157
v_dot2_f32_bf16 v158, v133, s8, v158
v_dot2_f32_bf16 v159, v133, s9, v159
v_cvt_pk_bf16_f32 v100, v140, v141
v_cvt_pk_bf16_f32 v101, v142, v143
v_cvt_pk_bf16_f32 v102, v144, v145
v_cvt_pk_bf16_f32 v103, v146, v147
buffer_load_dwordx4 v[180:183], v249, s[20:23], s56 offen offset:1024 sc1
v_cvt_pk_bf16_f32 v104, v148, v149
v_cvt_pk_bf16_f32 v105, v150, v151
v_cvt_pk_bf16_f32 v106, v152, v153
v_cvt_pk_bf16_f32 v107, v154, v155
v_cvt_pk_bf16_f32 v108, v156, v157
v_cvt_pk_bf16_f32 v109, v158, v159
v_accvgpr_read_b32 v140, a24
v_accvgpr_read_b32 v141, a25
buffer_load_dwordx4 v[184:187], v250, s[20:23], s56 offen sc1
v_accvgpr_read_b32 v142, a26
v_accvgpr_read_b32 v143, a27
v_accvgpr_read_b32 v144, a40
v_accvgpr_read_b32 v145, a41
v_accvgpr_read_b32 v146, a42
v_accvgpr_read_b32 v147, a43
v_accvgpr_read_b32 v148, a56
v_accvgpr_read_b32 v149, a57
buffer_load_dwordx4 v[188:191], v250, s[20:23], s56 offen offset:1024 sc1
v_accvgpr_read_b32 v150, a58
v_accvgpr_read_b32 v151, a59
v_accvgpr_read_b32 v152, a72
v_accvgpr_read_b32 v153, a73
v_accvgpr_read_b32 v154, a74
v_accvgpr_read_b32 v155, a75
v_accvgpr_read_b32 v156, a88
v_accvgpr_read_b32 v157, a89
s_add_u32 s56, s56, 2048
s_add_u32 s62, s61, 81920
s_add_u32 s59, s58, 20480
s_add_u32 m0, s62, 0
s_nop 0
buffer_load_dwordx4 v240, s[40:43], s58 offen lds
v_accvgpr_read_b32 v158, a90
v_accvgpr_read_b32 v159, a91
v_dot2_f32_bf16 v140, v20, s8, v140
v_dot2_f32_bf16 v141, v20, s9, v141
v_dot2_f32_bf16 v142, v21, s8, v142
v_dot2_f32_bf16 v143, v21, s9, v143
v_dot2_f32_bf16 v144, v28, s8, v144
v_dot2_f32_bf16 v145, v28, s9, v145
buffer_load_dwordx4 v241, s[40:43], s58 offen offset:1024 lds
v_dot2_f32_bf16 v146, v29, s8, v146
v_dot2_f32_bf16 v147, v29, s9, v147
v_dot2_f32_bf16 v148, v36, s8, v148
v_dot2_f32_bf16 v149, v36, s9, v149
v_dot2_f32_bf16 v150, v37, s8, v150
v_dot2_f32_bf16 v151, v37, s9, v151
v_dot2_f32_bf16 v152, v44, s8, v152
v_dot2_f32_bf16 v153, v44, s9, v153
buffer_load_dwordx4 v242, s[40:43], s58 offen offset:2048 lds
v_dot2_f32_bf16 v154, v45, s8, v154
v_dot2_f32_bf16 v155, v45, s9, v155
v_dot2_f32_bf16 v156, v134, s8, v156
v_dot2_f32_bf16 v157, v134, s9, v157
v_dot2_f32_bf16 v158, v135, s8, v158
v_dot2_f32_bf16 v159, v135, s9, v159
v_cvt_pk_bf16_f32 v110, v140, v141
v_cvt_pk_bf16_f32 v111, v142, v143
buffer_load_dwordx4 v243, s[40:43], s58 offen offset:3072 lds
v_cvt_pk_bf16_f32 v112, v144, v145
v_cvt_pk_bf16_f32 v113, v146, v147
v_cvt_pk_bf16_f32 v114, v148, v149
v_cvt_pk_bf16_f32 v115, v150, v151
v_cvt_pk_bf16_f32 v116, v152, v153
v_cvt_pk_bf16_f32 v117, v154, v155
v_cvt_pk_bf16_f32 v118, v156, v157
v_cvt_pk_bf16_f32 v119, v158, v159
s_add_u32 m0, s62, 4096
s_nop 0
buffer_load_dwordx4 v244, s[40:43], s58 offen lds
v_accvgpr_read_b32 v140, a28
v_accvgpr_read_b32 v141, a29
v_accvgpr_read_b32 v142, a30
v_accvgpr_read_b32 v143, a31
v_accvgpr_read_b32 v144, a44
v_accvgpr_read_b32 v145, a45
v_accvgpr_read_b32 v146, a46
v_accvgpr_read_b32 v147, a47
s_add_u32 m0, s62, 5120
s_nop 0
buffer_load_dwordx4 v240, s[40:43], s59 offen lds
v_accvgpr_read_b32 v148, a60
v_accvgpr_read_b32 v149, a61
v_accvgpr_read_b32 v150, a62
v_accvgpr_read_b32 v151, a63
v_accvgpr_read_b32 v152, a76
v_accvgpr_read_b32 v153, a77
v_accvgpr_read_b32 v154, a78
v_accvgpr_read_b32 v155, a79
buffer_load_dwordx4 v241, s[40:43], s59 offen offset:1024 lds
v_accvgpr_read_b32 v156, a92
v_accvgpr_read_b32 v157, a93
v_accvgpr_read_b32 v158, a94
v_accvgpr_read_b32 v159, a95
v_dot2_f32_bf16 v140, v22, s8, v140
v_dot2_f32_bf16 v141, v22, s9, v141
v_dot2_f32_bf16 v142, v23, s8, v142
v_dot2_f32_bf16 v143, v23, s9, v143
buffer_load_dwordx4 v242, s[40:43], s59 offen offset:2048 lds
v_dot2_f32_bf16 v144, v30, s8, v144
v_dot2_f32_bf16 v145, v30, s9, v145
v_dot2_f32_bf16 v146, v31, s8, v146
v_dot2_f32_bf16 v147, v31, s9, v147
v_dot2_f32_bf16 v148, v38, s8, v148
v_dot2_f32_bf16 v149, v38, s9, v149
v_dot2_f32_bf16 v150, v39, s8, v150
v_dot2_f32_bf16 v151, v39, s9, v151
buffer_load_dwordx4 v243, s[40:43], s59 offen offset:3072 lds
v_dot2_f32_bf16 v152, v46, s8, v152
v_dot2_f32_bf16 v153, v46, s9, v153
v_dot2_f32_bf16 v154, v47, s8, v154
v_dot2_f32_bf16 v155, v47, s9, v155
v_dot2_f32_bf16 v156, v136, s8, v156
v_dot2_f32_bf16 v157, v136, s9, v157
v_dot2_f32_bf16 v158, v137, s8, v158
v_dot2_f32_bf16 v159, v137, s9, v159
s_add_u32 m0, s62, 9216
s_nop 0
buffer_load_dwordx4 v244, s[40:43], s59 offen lds
s_add_u32 s58, s58, 81920
v_cvt_pk_bf16_f32 v120, v140, v141
v_cvt_pk_bf16_f32 v121, v142, v143
v_cvt_pk_bf16_f32 v122, v144, v145
v_cvt_pk_bf16_f32 v123, v146, v147
v_cvt_pk_bf16_f32 v124, v148, v149
v_cvt_pk_bf16_f32 v125, v150, v151
v_cvt_pk_bf16_f32 v126, v152, v153
v_cvt_pk_bf16_f32 v127, v154, v155
v_cvt_pk_bf16_f32 v128, v156, v157
v_cvt_pk_bf16_f32 v129, v158, v159
v_accvgpr_read_b32 v80, a16
v_accvgpr_read_b32 v81, a17
v_accvgpr_read_b32 v82, a18
v_accvgpr_read_b32 v83, a19
v_accvgpr_read_b32 v84, a32
v_accvgpr_read_b32 v85, a33
v_accvgpr_read_b32 v86, a34
v_accvgpr_read_b32 v87, a35
v_accvgpr_read_b32 v88, a48
v_accvgpr_read_b32 v89, a49
v_accvgpr_read_b32 v90, a50
v_accvgpr_read_b32 v91, a51
v_accvgpr_read_b32 v92, a64
v_accvgpr_read_b32 v93, a65
v_accvgpr_read_b32 v94, a66
v_accvgpr_read_b32 v95, a67
v_accvgpr_read_b32 v96, a80
v_accvgpr_read_b32 v97, a81
v_accvgpr_read_b32 v98, a82
v_accvgpr_read_b32 v99, a83
v_dot2_f32_bf16 v80, v16, s8, v80
v_dot2_f32_bf16 v81, v16, s9, v81
v_dot2_f32_bf16 v82, v17, s8, v82
v_dot2_f32_bf16 v83, v17, s9, v83
v_dot2_f32_bf16 v84, v24, s8, v84
v_dot2_f32_bf16 v85, v24, s9, v85
v_dot2_f32_bf16 v86, v25, s8, v86
v_dot2_f32_bf16 v87, v25, s9, v87
v_dot2_f32_bf16 v88, v32, s8, v88
v_dot2_f32_bf16 v89, v32, s9, v89
v_dot2_f32_bf16 v90, v33, s8, v90
v_dot2_f32_bf16 v91, v33, s9, v91
v_dot2_f32_bf16 v92, v40, s8, v92
v_dot2_f32_bf16 v93, v40, s9, v93
v_dot2_f32_bf16 v94, v41, s8, v94
v_dot2_f32_bf16 v95, v41, s9, v95
v_dot2_f32_bf16 v96, v130, s8, v96
v_dot2_f32_bf16 v97, v130, s9, v97
v_dot2_f32_bf16 v98, v131, s8, v98
v_dot2_f32_bf16 v99, v131, s9, v99
s_waitcnt vmcnt(18)
L_o2_r:
s_mov_b32 s63, 2
s_lshl_b32 s74, s3, 3
s_add_u32 s14, s24, s74
v_mfma_f32_16x16x32_bf16 a[192:195], v[192:195], v[48:51], 0
s_add_u32 s62, s61, 0
s_add_u32 s59, s58, 20480
ds_read_b64_tr_b16 v[216:217], v246 offset:64
v_mfma_f32_16x16x32_bf16 a[192:195], v[196:199], v[52:55], a[192:195]
s_add_u32 m0, s62, 0
v_mfma_f32_16x16x32_bf16 a[196:199], v[196:199], v[60:63], 0
ds_read_b64_tr_b16 v[218:219], v246 offset:5184
buffer_load_dwordx4 v240, s[40:43], s58 offen lds
v_mfma_f32_16x16x32_bf16 a[196:199], v[192:195], v[56:59], a[196:199]
v_mfma_f32_16x16x32_bf16 a[200:203], v[192:195], v[64:67], 0
ds_read_b64_tr_b16 v[220:221], v246 offset:10304
buffer_load_dwordx4 v241, s[40:43], s58 offen offset:1024 lds
v_mfma_f32_16x16x32_bf16 a[200:203], v[196:199], v[68:71], a[200:203]
v_mfma_f32_16x16x32_bf16 a[204:207], v[196:199], v[76:79], 0
ds_read_b64_tr_b16 v[222:223], v246 offset:15424
v_mfma_f32_16x16x32_bf16 a[204:207], v[192:195], v[72:75], a[204:207]
s_waitcnt lgkmcnt(4)
buffer_load_dwordx4 v242, s[40:43], s58 offen offset:2048 lds
v_mfma_f32_16x16x32_bf16 a[208:211], v[200:203], v[48:51], 0
ds_read_b64_tr_b16 v[224:225], v245 offset:128
v_mfma_f32_16x16x32_bf16 a[208:211], v[204:207], v[52:55], a[208:211]
v_mfma_f32_16x16x32_bf16 a[212:215], v[204:207], v[60:63], 0
ds_read_b64_tr_b16 v[226:227], v245 offset:5248
buffer_load_dwordx4 v243, s[40:43], s58 offen offset:3072 lds
v_mfma_f32_16x16x32_bf16 a[212:215], v[200:203], v[56:59], a[212:215]
v_mfma_f32_16x16x32_bf16 a[216:219], v[200:203], v[64:67], 0
ds_read_b64_tr_b16 v[228:229], v245 offset:10368
v_mfma_f32_16x16x32_bf16 a[216:219], v[204:207], v[68:71], a[216:219]
v_mfma_f32_16x16x32_bf16 a[220:223], v[204:207], v[76:79], 0
ds_read_b64_tr_b16 v[230:231], v245 offset:15488
buffer_store_dwordx4 v[100:103], v4, s[20:23], s18 offen sc1
v_mfma_f32_16x16x32_bf16 a[220:223], v[200:203], v[72:75], a[220:223]
s_waitcnt lgkmcnt(8)
s_add_u32 m0, s62, 4096
v_mfma_f32_16x16x32_bf16 a[224:227], v[208:211], v[48:51], 0
ds_read_b64_tr_b16 v[232:233], v8
v_mfma_f32_16x16x32_bf16 a[224:227], v[212:215], v[52:55], a[224:227]
buffer_load_dwordx4 v244, s[40:43], s58 offen lds
v_mfma_f32_16x16x32_bf16 a[228:231], v[212:215], v[60:63], 0
s_add_u32 m0, s62, 5120
ds_read_b64_tr_b16 v[234:235], v8 offset:5120
v_mfma_f32_16x16x32_bf16 a[228:231], v[208:211], v[56:59], a[228:231]
v_mfma_f32_16x16x32_bf16 a[232:235], v[208:211], v[64:67], 0
ds_read_b64_tr_b16 v[236:237], v8 offset:10240
buffer_load_dwordx4 v240, s[40:43], s59 offen lds
v_mfma_f32_16x16x32_bf16 a[232:235], v[212:215], v[68:71], a[232:235]
v_mfma_f32_16x16x32_bf16 a[236:239], v[212:215], v[76:79], 0
ds_read_b64_tr_b16 v[238:239], v8 offset:15360
v_mfma_f32_16x16x32_bf16 a[236:239], v[208:211], v[72:75], a[236:239]
s_waitcnt lgkmcnt(8)
buffer_load_dwordx4 v241, s[40:43], s59 offen offset:1024 lds
v_mfma_f32_16x16x32_bf16 a[240:243], v[216:219], v[48:51], 0
ds_read_b64_tr_b16 v[192:193], v9
v_mfma_f32_16x16x32_bf16 a[240:243], v[220:223], v[52:55], a[240:243]
v_mfma_f32_16x16x32_bf16 a[244:247], v[220:223], v[60:63], 0
ds_read_b64_tr_b16 v[194:195], v9 offset:5120
v_mfma_f32_16x16x32_bf16 a[244:247], v[216:219], v[56:59], a[244:247]
buffer_load_dwordx4 v242, s[40:43], s59 offen offset:2048 lds
v_mfma_f32_16x16x32_bf16 a[248:251], v[216:219], v[64:67], 0
ds_read_b64_tr_b16 v[196:197], v9 offset:10240
v_mfma_f32_16x16x32_bf16 a[248:251], v[220:223], v[68:71], a[248:251]
v_mfma_f32_16x16x32_bf16 a[252:255], v[220:223], v[76:79], 0
ds_read_b64_tr_b16 v[198:199], v9 offset:15360
v_add_u32 v245, 4294926336, v245
v_mfma_f32_16x16x32_bf16 a[252:255], v[216:219], v[72:75], a[252:255]
s_waitcnt lgkmcnt(8)
buffer_store_dwordx4 v[104:107], v4, s[20:23], s18 offen offset:1024 sc1
v_mfma_f32_16x16x32_bf16 a[0:3], v[224:227], v[48:51], 0
ds_read_b64_tr_b16 v[200:201], v8 offset:64
v_add_u32 v246, 4294926336, v246
v_mfma_f32_16x16x32_bf16 a[0:3], v[228:231], v[52:55], a[0:3]
buffer_load_dwordx4 v243, s[40:43], s59 offen offset:3072 lds
v_mfma_f32_16x16x32_bf16 a[4:7], v[228:231], v[60:63], 0
s_add_u32 m0, s62, 9216
ds_read_b64_tr_b16 v[202:203], v8 offset:5184
v_mfma_f32_16x16x32_bf16 a[4:7], v[224:227], v[56:59], a[4:7]
v_mfma_f32_16x16x32_bf16 a[8:11], v[224:227], v[64:67], 0
ds_read_b64_tr_b16 v[204:205], v8 offset:10304
buffer_load_dwordx4 v244, s[40:43], s59 offen lds
v_mfma_f32_16x16x32_bf16 a[8:11], v[228:231], v[68:71], a[8:11]
s_add_u32 s58, s58, 81920
v_mfma_f32_16x16x32_bf16 a[12:15], v[228:231], v[76:79], 0
ds_read_b64_tr_b16 v[206:207], v8 offset:15424
v_mfma_f32_16x16x32_bf16 a[12:15], v[224:227], v[72:75], a[12:15]
s_waitcnt lgkmcnt(8)
v_mfma_f32_16x16x32_bf16 a[16:19], v[232:235], v[48:51], 0
ds_read_b64_tr_b16 v[208:209], v9 offset:64
buffer_load_dwordx4 v[16:19], v247, s[20:23], s56 offen sc1
v_mfma_f32_16x16x32_bf16 a[16:19], v[236:239], v[52:55], a[16:19]
v_mfma_f32_16x16x32_bf16 a[20:23], v[236:239], v[60:63], 0
ds_read_b64_tr_b16 v[210:211], v9 offset:5184
v_mfma_f32_16x16x32_bf16 a[20:23], v[232:235], v[56:59], a[20:23]
buffer_store_dwordx2 v[108:109], v1, s[20:23], s18 offen sc1
v_mfma_f32_16x16x32_bf16 a[24:27], v[232:235], v[64:67], 0
ds_read_b64_tr_b16 v[212:213], v9 offset:10304
v_mfma_f32_16x16x32_bf16 a[24:27], v[236:239], v[68:71], a[24:27]
v_mfma_f32_16x16x32_bf16 a[28:31], v[236:239], v[76:79], 0
ds_read_b64_tr_b16 v[214:215], v9 offset:15424
buffer_load_dwordx4 v[20:23], v247, s[20:23], s56 offen offset:1024 sc1
v_mfma_f32_16x16x32_bf16 a[28:31], v[232:235], v[72:75], a[28:31]
s_waitcnt lgkmcnt(8)
v_mfma_f32_16x16x32_bf16 a[32:35], v[192:195], v[48:51], 0
ds_read_b64_tr_b16 v[216:217], v8 offset:128
v_mfma_f32_16x16x32_bf16 a[32:35], v[196:199], v[52:55], a[32:35]
buffer_load_dwordx4 v[24:27], v248, s[20:23], s56 offen sc1
v_mfma_f32_16x16x32_bf16 a[36:39], v[196:199], v[60:63], 0
ds_read_b64_tr_b16 v[218:219], v8 offset:5248
v_mfma_f32_16x16x32_bf16 a[36:39], v[192:195], v[56:59], a[36:39]
v_mfma_f32_16x16x32_bf16 a[40:43], v[192:195], v[64:67], 0
ds_read_b64_tr_b16 v[220:221], v8 offset:10368
v_mfma_f32_16x16x32_bf16 a[40:43], v[196:199], v[68:71], a[40:43]
buffer_load_dwordx4 v[28:31], v248, s[20:23], s56 offen offset:1024 sc1
v_mfma_f32_16x16x32_bf16 a[44:47], v[196:199], v[76:79], 0
ds_read_b64_tr_b16 v[222:223], v8 offset:15488
v_mfma_f32_16x16x32_bf16 a[44:47], v[192:195], v[72:75], a[44:47]
s_waitcnt lgkmcnt(8)
v_mfma_f32_16x16x32_bf16 a[48:51], v[200:203], v[48:51], 0
buffer_load_dwordx4 v[32:35], v249, s[20:23], s56 offen sc1
v_mfma_f32_16x16x32_bf16 a[48:51], v[204:207], v[52:55], a[48:51]
v_mfma_f32_16x16x32_bf16 a[52:55], v[204:207], v[60:63], 0
v_add_u32 v8, 4294926336, v8
v_mfma_f32_16x16x32_bf16 a[52:55], v[200:203], v[56:59], a[52:55]
v_add_u32 v9, 4294926336, v9
v_mfma_f32_16x16x32_bf16 a[56:59], v[200:203], v[64:67], 0
buffer_store_dwordx4 v[110:113], v4, s[20:23], s19 offen sc1
v_mfma_f32_16x16x32_bf16 a[56:59], v[204:207], v[68:71], a[56:59]
v_mfma_f32_16x16x32_bf16 a[60:63], v[204:207], v[76:79], 0
s_waitcnt vmcnt(19) lgkmcnt(0)
s_barrier
buffer_load_dwordx4 v[36:39], v249, s[20:23], s56 offen offset:1024 sc1
v_mfma_f32_16x16x32_bf16 a[60:63], v[200:203], v[72:75], a[60:63]
s_waitcnt lgkmcnt(0)
ds_read_b64_tr_b16 v[224:225], v245
v_mfma_f32_16x16x32_bf16 a[64:67], v[208:211], v[48:51], 0
ds_read_b64_tr_b16 v[226:227], v245 offset:5120
v_mfma_f32_16x16x32_bf16 a[64:67], v[212:215], v[52:55], a[64:67]
ds_read_b64_tr_b16 v[228:229], v245 offset:10240
v_mfma_f32_16x16x32_bf16 a[68:71], v[212:215], v[60:63], 0
ds_read_b64_tr_b16 v[230:231], v245 offset:15360
buffer_load_dwordx4 v[40:43], v250, s[20:23], s56 offen sc1
v_mfma_f32_16x16x32_bf16 a[68:71], v[208:211], v[56:59], a[68:71]
v_mfma_f32_16x16x32_bf16 a[72:75], v[208:211], v[64:67], 0
ds_read_b64_tr_b16 v[232:233], v246
v_mfma_f32_16x16x32_bf16 a[72:75], v[212:215], v[68:71], a[72:75]
ds_read_b64_tr_b16 v[234:235], v246 offset:5120
buffer_load_dwordx4 v[44:47], v250, s[20:23], s56 offen offset:1024 sc1
v_mfma_f32_16x16x32_bf16 a[76:79], v[212:215], v[76:79], 0
ds_read_b64_tr_b16 v[236:237], v246 offset:10240
v_mfma_f32_16x16x32_bf16 a[76:79], v[208:211], v[72:75], a[76:79]
s_waitcnt lgkmcnt(7)
ds_read_b64_tr_b16 v[238:239], v246 offset:15360
v_mfma_f32_16x16x32_bf16 a[80:83], v[216:219], v[48:51], 0
buffer_store_dwordx4 v[114:117], v4, s[20:23], s19 offen offset:1024 sc1
v_mfma_f32_16x16x32_bf16 a[80:83], v[220:223], v[52:55], a[80:83]
s_add_u32 s56, s56, 2048
ds_read_b64_tr_b16 v[192:193], v245 offset:64
v_mfma_f32_16x16x32_bf16 a[84:87], v[220:223], v[60:63], 0
ds_read_b64_tr_b16 v[194:195], v245 offset:5184
v_mfma_f32_16x16x32_bf16 a[84:87], v[216:219], v[56:59], a[84:87]
ds_read_b64_tr_b16 v[196:197], v245 offset:10304
v_mfma_f32_16x16x32_bf16 a[88:91], v[216:219], v[64:67], 0
ds_read_b64_tr_b16 v[198:199], v245 offset:15424
v_mfma_f32_16x16x32_bf16 a[88:91], v[220:223], v[68:71], a[88:91]
v_mfma_f32_16x16x32_bf16 a[92:95], v[220:223], v[76:79], 0
s_waitcnt vmcnt(23)
v_mfma_f32_16x16x32_bf16 a[92:95], v[216:219], v[72:75], a[92:95]
s_waitcnt lgkmcnt(8)
v_mfma_f32_16x16x32_bf16 a[192:195], v[224:227], v[160:163], a[192:195]
s_add_u32 s62, s61, 40960
s_add_u32 s59, s58, 20480
ds_read_b64_tr_b16 v[200:201], v246 offset:64
v_mfma_f32_16x16x32_bf16 a[192:195], v[228:231], v[164:167], a[192:195]
s_add_u32 m0, s62, 0
v_mfma_f32_16x16x32_bf16 a[196:199], v[228:231], v[172:175], a[196:199]
ds_read_b64_tr_b16 v[202:203], v246 offset:5184
buffer_load_dwordx4 v240, s[40:43], s58 offen lds
v_mfma_f32_16x16x32_bf16 a[196:199], v[224:227], v[168:171], a[196:199]
v_mfma_f32_16x16x32_bf16 a[200:203], v[224:227], v[176:179], a[200:203]
ds_read_b64_tr_b16 v[204:205], v246 offset:10304
buffer_load_dwordx4 v241, s[40:43], s58 offen offset:1024 lds
v_mfma_f32_16x16x32_bf16 a[200:203], v[228:231], v[180:183], a[200:203]
v_mfma_f32_16x16x32_bf16 a[204:207], v[228:231], v[188:191], a[204:207]
ds_read_b64_tr_b16 v[206:207], v246 offset:15424
v_mfma_f32_16x16x32_bf16 a[204:207], v[224:227], v[184:187], a[204:207]
s_waitcnt lgkmcnt(8)
buffer_load_dwordx4 v242, s[40:43], s58 offen offset:2048 lds
v_mfma_f32_16x16x32_bf16 a[208:211], v[232:235], v[160:163], a[208:211]
ds_read_b64_tr_b16 v[208:209], v245 offset:128
v_mfma_f32_16x16x32_bf16 a[208:211], v[236:239], v[164:167], a[208:211]
v_mfma_f32_16x16x32_bf16 a[212:215], v[236:239], v[172:175], a[212:215]
ds_read_b64_tr_b16 v[210:211], v245 offset:5248
v_mfma_f32_16x16x32_bf16 a[212:215], v[232:235], v[168:171], a[212:215]
buffer_load_dwordx4 v243, s[40:43], s58 offen offset:3072 lds
v_mfma_f32_16x16x32_bf16 a[216:219], v[232:235], v[176:179], a[216:219]
s_add_u32 m0, s62, 4096
ds_read_b64_tr_b16 v[212:213], v245 offset:10368
v_mfma_f32_16x16x32_bf16 a[216:219], v[236:239], v[180:183], a[216:219]
v_mfma_f32_16x16x32_bf16 a[220:223], v[236:239], v[188:191], a[220:223]
ds_read_b64_tr_b16 v[214:215], v245 offset:15488
buffer_load_dwordx4 v244, s[40:43], s58 offen lds
v_mfma_f32_16x16x32_bf16 a[220:223], v[232:235], v[184:187], a[220:223]
s_waitcnt lgkmcnt(8)
v_mfma_f32_16x16x32_bf16 a[224:227], v[192:195], v[160:163], a[224:227]
ds_read_b64_tr_b16 v[216:217], v8
v_mfma_f32_16x16x32_bf16 a[224:227], v[196:199], v[164:167], a[224:227]
v_mfma_f32_16x16x32_bf16 a[228:231], v[196:199], v[172:175], a[228:231]
ds_read_b64_tr_b16 v[218:219], v8 offset:5120
buffer_store_dwordx2 v[118:119], v1, s[20:23], s19 offen sc1
v_mfma_f32_16x16x32_bf16 a[228:231], v[192:195], v[168:171], a[228:231]
s_add_u32 m0, s62, 5120
v_mfma_f32_16x16x32_bf16 a[232:235], v[192:195], v[176:179], a[232:235]
ds_read_b64_tr_b16 v[220:221], v8 offset:10240
v_mfma_f32_16x16x32_bf16 a[232:235], v[196:199], v[180:183], a[232:235]
buffer_load_dwordx4 v240, s[40:43], s59 offen lds
v_mfma_f32_16x16x32_bf16 a[236:239], v[196:199], v[188:191], a[236:239]
ds_read_b64_tr_b16 v[222:223], v8 offset:15360
v_mfma_f32_16x16x32_bf16 a[236:239], v[192:195], v[184:187], a[236:239]
s_waitcnt lgkmcnt(8)
v_mfma_f32_16x16x32_bf16 a[240:243], v[200:203], v[160:163], a[240:243]
ds_read_b64_tr_b16 v[224:225], v9
buffer_load_dwordx4 v241, s[40:43], s59 offen offset:1024 lds
v_mfma_f32_16x16x32_bf16 a[240:243], v[204:207], v[164:167], a[240:243]
v_mfma_f32_16x16x32_bf16 a[244:247], v[204:207], v[172:175], a[244:247]
ds_read_b64_tr_b16 v[226:227], v9 offset:5120
v_mfma_f32_16x16x32_bf16 a[244:247], v[200:203], v[168:171], a[244:247]
v_mfma_f32_16x16x32_bf16 a[248:251], v[200:203], v[176:179], a[248:251]
ds_read_b64_tr_b16 v[228:229], v9 offset:10240
buffer_load_dwordx4 v242, s[40:43], s59 offen offset:2048 lds
v_mfma_f32_16x16x32_bf16 a[248:251], v[204:207], v[180:183], a[248:251]
v_mfma_f32_16x16x32_bf16 a[252:255], v[204:207], v[188:191], a[252:255]
ds_read_b64_tr_b16 v[230:231], v9 offset:15360
v_add_u32 v245, 4294885376, v245
v_mfma_f32_16x16x32_bf16 a[252:255], v[200:203], v[184:187], a[252:255]
s_waitcnt lgkmcnt(8)
buffer_load_dwordx4 v243, s[40:43], s59 offen offset:3072 lds
v_mfma_f32_16x16x32_bf16 a[0:3], v[208:211], v[160:163], a[0:3]
ds_read_b64_tr_b16 v[232:233], v8 offset:64
v_add_u32 v246, 4294885376, v246
v_mfma_f32_16x16x32_bf16 a[0:3], v[212:215], v[164:167], a[0:3]
v_mfma_f32_16x16x32_bf16 a[4:7], v[212:215], v[172:175], a[4:7]
ds_read_b64_tr_b16 v[234:235], v8 offset:5184
v_mfma_f32_16x16x32_bf16 a[4:7], v[208:211], v[168:171], a[4:7]
buffer_store_dwordx4 v[120:123], v4, s[20:23], s16 offen sc1
v_mfma_f32_16x16x32_bf16 a[8:11], v[208:211], v[176:179], a[8:11]
s_add_u32 m0, s62, 9216
ds_read_b64_tr_b16 v[236:237], v8 offset:10304
v_mfma_f32_16x16x32_bf16 a[8:11], v[212:215], v[180:183], a[8:11]
v_mfma_f32_16x16x32_bf16 a[12:15], v[212:215], v[188:191], a[12:15]
ds_read_b64_tr_b16 v[238:239], v8 offset:15424
buffer_load_dwordx4 v244, s[40:43], s59 offen lds
v_mfma_f32_16x16x32_bf16 a[12:15], v[208:211], v[184:187], a[12:15]
s_waitcnt lgkmcnt(8)
s_add_u32 s58, s58, 81920
v_mfma_f32_16x16x32_bf16 a[16:19], v[216:219], v[160:163], a[16:19]
ds_read_b64_tr_b16 v[192:193], v9 offset:64
v_mfma_f32_16x16x32_bf16 a[16:19], v[220:223], v[164:167], a[16:19]
buffer_load_dwordx4 v[48:51], v247, s[20:23], s56 offen sc1
v_mfma_f32_16x16x32_bf16 a[20:23], v[220:223], v[172:175], a[20:23]
ds_read_b64_tr_b16 v[194:195], v9 offset:5184
v_mfma_f32_16x16x32_bf16 a[20:23], v[216:219], v[168:171], a[20:23]
v_mfma_f32_16x16x32_bf16 a[24:27], v[216:219], v[176:179], a[24:27]
ds_read_b64_tr_b16 v[196:197], v9 offset:10304
v_mfma_f32_16x16x32_bf16 a[24:27], v[220:223], v[180:183], a[24:27]
buffer_load_dwordx4 v[52:55], v247, s[20:23], s56 offen offset:1024 sc1
v_mfma_f32_16x16x32_bf16 a[28:31], v[220:223], v[188:191], a[28:31]
ds_read_b64_tr_b16 v[198:199], v9 offset:15424
v_mfma_f32_16x16x32_bf16 a[28:31], v[216:219], v[184:187], a[28:31]
s_waitcnt lgkmcnt(8)
v_mfma_f32_16x16x32_bf16 a[32:35], v[224:227], v[160:163], a[32:35]
ds_read_b64_tr_b16 v[200:201], v8 offset:128
buffer_load_dwordx4 v[56:59], v248, s[20:23], s56 offen sc1
v_mfma_f32_16x16x32_bf16 a[32:35], v[228:231], v[164:167], a[32:35]
v_mfma_f32_16x16x32_bf16 a[36:39], v[228:231], v[172:175], a[36:39]
ds_read_b64_tr_b16 v[202:203], v8 offset:5248
v_mfma_f32_16x16x32_bf16 a[36:39], v[224:227], v[168:171], a[36:39]
v_mfma_f32_16x16x32_bf16 a[40:43], v[224:227], v[176:179], a[40:43]
ds_read_b64_tr_b16 v[204:205], v8 offset:10368
buffer_load_dwordx4 v[60:63], v248, s[20:23], s56 offen offset:1024 sc1
v_mfma_f32_16x16x32_bf16 a[40:43], v[228:231], v[180:183], a[40:43]
v_mfma_f32_16x16x32_bf16 a[44:47], v[228:231], v[188:191], a[44:47]
ds_read_b64_tr_b16 v[206:207], v8 offset:15488
v_mfma_f32_16x16x32_bf16 a[44:47], v[224:227], v[184:187], a[44:47]
s_waitcnt lgkmcnt(8)
buffer_store_dwordx4 v[124:127], v4, s[20:23], s16 offen offset:1024 sc1
v_mfma_f32_16x16x32_bf16 a[48:51], v[232:235], v[160:163], a[48:51]
v_mfma_f32_16x16x32_bf16 a[48:51], v[236:239], v[164:167], a[48:51]
v_mfma_f32_16x16x32_bf16 a[52:55], v[236:239], v[172:175], a[52:55]
v_add_u32 v8, 4294885376, v8
v_mfma_f32_16x16x32_bf16 a[52:55], v[232:235], v[168:171], a[52:55]
v_add_u32 v9, 4294885376, v9
v_mfma_f32_16x16x32_bf16 a[56:59], v[232:235], v[176:179], a[56:59]
buffer_load_dwordx4 v[64:67], v249, s[20:23], s56 offen sc1
v_mfma_f32_16x16x32_bf16 a[56:59], v[236:239], v[180:183], a[56:59]
v_mfma_f32_16x16x32_bf16 a[60:63], v[236:239], v[188:191], a[60:63]
s_waitcnt vmcnt(29) lgkmcnt(0)
s_barrier
buffer_load_dwordx4 v[68:71], v249, s[20:23], s56 offen offset:1024 sc1
v_mfma_f32_16x16x32_bf16 a[60:63], v[232:235], v[184:187], a[60:63]
s_waitcnt lgkmcnt(0)
ds_read_b64_tr_b16 v[208:209], v245
v_mfma_f32_16x16x32_bf16 a[64:67], v[192:195], v[160:163], a[64:67]
ds_read_b64_tr_b16 v[210:211], v245 offset:5120
v_mfma_f32_16x16x32_bf16 a[64:67], v[196:199], v[164:167], a[64:67]
ds_read_b64_tr_b16 v[212:213], v245 offset:10240
buffer_load_dwordx4 v[72:75], v250, s[20:23], s56 offen sc1
v_mfma_f32_16x16x32_bf16 a[68:71], v[196:199], v[172:175], a[68:71]
ds_read_b64_tr_b16 v[214:215], v245 offset:15360
v_mfma_f32_16x16x32_bf16 a[68:71], v[192:195], v[168:171], a[68:71]
v_mfma_f32_16x16x32_bf16 a[72:75], v[192:195], v[176:179], a[72:75]
ds_read_b64_tr_b16 v[216:217], v246
v_mfma_f32_16x16x32_bf16 a[72:75], v[196:199], v[180:183], a[72:75]
ds_read_b64_tr_b16 v[218:219], v246 offset:5120
buffer_load_dwordx4 v[76:79], v250, s[20:23], s56 offen offset:1024 sc1
v_mfma_f32_16x16x32_bf16 a[76:79], v[196:199], v[188:191], a[76:79]
ds_read_b64_tr_b16 v[220:221], v246 offset:10240
v_mfma_f32_16x16x32_bf16 a[76:79], v[192:195], v[184:187], a[76:79]
s_waitcnt lgkmcnt(7)
ds_read_b64_tr_b16 v[222:223], v246 offset:15360
v_mfma_f32_16x16x32_bf16 a[80:83], v[200:203], v[160:163], a[80:83]
buffer_store_dwordx2 v[128:129], v1, s[20:23], s16 offen sc1
v_mfma_f32_16x16x32_bf16 a[80:83], v[204:207], v[164:167], a[80:83]
s_add_u32 s56, s56, 2048
ds_read_b64_tr_b16 v[224:225], v245 offset:64
v_mfma_f32_16x16x32_bf16 a[84:87], v[204:207], v[172:175], a[84:87]
ds_read_b64_tr_b16 v[226:227], v245 offset:5184
v_mfma_f32_16x16x32_bf16 a[84:87], v[200:203], v[168:171], a[84:87]
ds_read_b64_tr_b16 v[228:229], v245 offset:10304
v_mfma_f32_16x16x32_bf16 a[88:91], v[200:203], v[176:179], a[88:91]
ds_read_b64_tr_b16 v[230:231], v245 offset:15424
v_mfma_f32_16x16x32_bf16 a[88:91], v[204:207], v[180:183], a[88:91]
v_mfma_f32_16x16x32_bf16 a[92:95], v[204:207], v[188:191], a[92:95]
s_waitcnt vmcnt(23)
v_mfma_f32_16x16x32_bf16 a[92:95], v[200:203], v[184:187], a[92:95]
s_waitcnt lgkmcnt(8)
v_mfma_f32_16x16x32_bf16 a[192:195], v[208:211], v[16:19], a[192:195]
s_add_u32 s62, s61, 81920
s_add_u32 s59, s58, 20480
ds_read_b64_tr_b16 v[232:233], v246 offset:64
v_mfma_f32_16x16x32_bf16 a[192:195], v[212:215], v[20:23], a[192:195]
s_add_u32 m0, s62, 0
v_mfma_f32_16x16x32_bf16 a[196:199], v[212:215], v[28:31], a[196:199]
ds_read_b64_tr_b16 v[234:235], v246 offset:5184
buffer_load_dwordx4 v240, s[40:43], s58 offen lds
v_mfma_f32_16x16x32_bf16 a[196:199], v[208:211], v[24:27], a[196:199]
v_mfma_f32_16x16x32_bf16 a[200:203], v[208:211], v[32:35], a[200:203]
ds_read_b64_tr_b16 v[236:237], v246 offset:10304
v_mfma_f32_16x16x32_bf16 a[200:203], v[212:215], v[36:39], a[200:203]
buffer_load_dwordx4 v241, s[40:43], s58 offen offset:1024 lds
v_mfma_f32_16x16x32_bf16 a[204:207], v[212:215], v[44:47], a[204:207]
ds_read_b64_tr_b16 v[238:239], v246 offset:15424
v_mfma_f32_16x16x32_bf16 a[204:207], v[208:211], v[40:43], a[204:207]
s_waitcnt lgkmcnt(8)
v_mfma_f32_16x16x32_bf16 a[208:211], v[216:219], v[16:19], a[208:211]
ds_read_b64_tr_b16 v[192:193], v245 offset:128
v_mfma_f32_16x16x32_bf16 a[208:211], v[220:223], v[20:23], a[208:211]
buffer_load_dwordx4 v242, s[40:43], s58 offen offset:2048 lds
v_mfma_f32_16x16x32_bf16 a[212:215], v[220:223], v[28:31], a[212:215]
ds_read_b64_tr_b16 v[194:195], v245 offset:5248
v_mfma_f32_16x16x32_bf16 a[212:215], v[216:219], v[24:27], a[212:215]
v_mfma_f32_16x16x32_bf16 a[216:219], v[216:219], v[32:35], a[216:219]
ds_read_b64_tr_b16 v[196:197], v245 offset:10368
v_mfma_f32_16x16x32_bf16 a[216:219], v[220:223], v[36:39], a[216:219]
buffer_load_dwordx4 v243, s[40:43], s58 offen offset:3072 lds
v_mfma_f32_16x16x32_bf16 a[220:223], v[220:223], v[44:47], a[220:223]
s_add_u32 m0, s62, 4096
ds_read_b64_tr_b16 v[198:199], v245 offset:15488
v_mfma_f32_16x16x32_bf16 a[220:223], v[216:219], v[40:43], a[220:223]
s_waitcnt lgkmcnt(8)
v_mfma_f32_16x16x32_bf16 a[224:227], v[224:227], v[16:19], a[224:227]
ds_read_b64_tr_b16 v[200:201], v8
v_mfma_f32_16x16x32_bf16 a[224:227], v[228:231], v[20:23], a[224:227]
buffer_load_dwordx4 v244, s[40:43], s58 offen lds
v_mfma_f32_16x16x32_bf16 a[228:231], v[228:231], v[28:31], a[228:231]
s_add_u32 m0, s62, 5120
ds_read_b64_tr_b16 v[202:203], v8 offset:5120
v_mfma_f32_16x16x32_bf16 a[228:231], v[224:227], v[24:27], a[228:231]
v_mfma_f32_16x16x32_bf16 a[232:235], v[224:227], v[32:35], a[232:235]
ds_read_b64_tr_b16 v[204:205], v8 offset:10240
v_mfma_f32_16x16x32_bf16 a[232:235], v[228:231], v[36:39], a[232:235]
buffer_load_dwordx4 v240, s[40:43], s59 offen lds
v_mfma_f32_16x16x32_bf16 a[236:239], v[228:231], v[44:47], a[236:239]
ds_read_b64_tr_b16 v[206:207], v8 offset:15360
v_mfma_f32_16x16x32_bf16 a[236:239], v[224:227], v[40:43], a[236:239]
s_waitcnt lgkmcnt(8)
v_mfma_f32_16x16x32_bf16 a[240:243], v[232:235], v[16:19], a[240:243]
ds_read_b64_tr_b16 v[208:209], v9
v_mfma_f32_16x16x32_bf16 a[240:243], v[236:239], v[20:23], a[240:243]
v_mfma_f32_16x16x32_bf16 a[244:247], v[236:239], v[28:31], a[244:247]
ds_read_b64_tr_b16 v[210:211], v9 offset:5120
buffer_load_dwordx4 v241, s[40:43], s59 offen offset:1024 lds
v_mfma_f32_16x16x32_bf16 a[244:247], v[232:235], v[24:27], a[244:247]
v_mfma_f32_16x16x32_bf16 a[248:251], v[232:235], v[32:35], a[248:251]
ds_read_b64_tr_b16 v[212:213], v9 offset:10240
v_mfma_f32_16x16x32_bf16 a[248:251], v[236:239], v[36:39], a[248:251]
v_mfma_f32_16x16x32_bf16 a[252:255], v[236:239], v[44:47], a[252:255]
ds_read_b64_tr_b16 v[214:215], v9 offset:15360
v_add_u32 v245, 40960, v245
v_mfma_f32_16x16x32_bf16 a[252:255], v[232:235], v[40:43], a[252:255]
s_waitcnt lgkmcnt(8)
buffer_load_dwordx4 v242, s[40:43], s59 offen offset:2048 lds
v_mfma_f32_16x16x32_bf16 a[0:3], v[192:195], v[16:19], a[0:3]
ds_read_b64_tr_b16 v[216:217], v8 offset:64
v_add_u32 v246, 40960, v246
v_mfma_f32_16x16x32_bf16 a[0:3], v[196:199], v[20:23], a[0:3]
v_mfma_f32_16x16x32_bf16 a[4:7], v[196:199], v[28:31], a[4:7]
ds_read_b64_tr_b16 v[218:219], v8 offset:5184
buffer_load_dwordx4 v243, s[40:43], s59 offen offset:3072 lds
v_mfma_f32_16x16x32_bf16 a[4:7], v[192:195], v[24:27], a[4:7]
s_add_u32 m0, s62, 9216
v_mfma_f32_16x16x32_bf16 a[8:11], v[192:195], v[32:35], a[8:11]
ds_read_b64_tr_b16 v[220:221], v8 offset:10304
v_mfma_f32_16x16x32_bf16 a[8:11], v[196:199], v[36:39], a[8:11]
v_mfma_f32_16x16x32_bf16 a[12:15], v[196:199], v[44:47], a[12:15]
ds_read_b64_tr_b16 v[222:223], v8 offset:15424
buffer_load_dwordx4 v244, s[40:43], s59 offen lds
v_mfma_f32_16x16x32_bf16 a[12:15], v[192:195], v[40:43], a[12:15]
s_waitcnt lgkmcnt(8)
s_add_u32 s58, s58, 81920
v_mfma_f32_16x16x32_bf16 a[16:19], v[200:203], v[16:19], a[16:19]
ds_read_b64_tr_b16 v[224:225], v9 offset:64
v_mfma_f32_16x16x32_bf16 a[16:19], v[204:207], v[20:23], a[16:19]
v_mfma_f32_16x16x32_bf16 a[20:23], v[204:207], v[28:31], a[20:23]
ds_read_b64_tr_b16 v[226:227], v9 offset:5184
buffer_load_dwordx4 v[160:163], v247, s[20:23], s56 offen sc1
v_mfma_f32_16x16x32_bf16 a[20:23], v[200:203], v[24:27], a[20:23]
v_mfma_f32_16x16x32_bf16 a[24:27], v[200:203], v[32:35], a[24:27]
ds_read_b64_tr_b16 v[228:229], v9 offset:10304
v_mfma_f32_16x16x32_bf16 a[24:27], v[204:207], v[36:39], a[24:27]
v_mfma_f32_16x16x32_bf16 a[28:31], v[204:207], v[44:47], a[28:31]
ds_read_b64_tr_b16 v[230:231], v9 offset:15424
buffer_load_dwordx4 v[164:167], v247, s[20:23], s56 offen offset:1024 sc1
v_mfma_f32_16x16x32_bf16 a[28:31], v[200:203], v[40:43], a[28:31]
s_waitcnt lgkmcnt(8)
v_mfma_f32_16x16x32_bf16 a[32:35], v[208:211], v[16:19], a[32:35]
ds_read_b64_tr_b16 v[232:233], v8 offset:128
v_mfma_f32_16x16x32_bf16 a[32:35], v[212:215], v[20:23], a[32:35]
v_mfma_f32_16x16x32_bf16 a[36:39], v[212:215], v[28:31], a[36:39]
ds_read_b64_tr_b16 v[234:235], v8 offset:5248
v_mfma_f32_16x16x32_bf16 a[36:39], v[208:211], v[24:27], a[36:39]
buffer_load_dwordx4 v[168:171], v248, s[20:23], s56 offen sc1
v_mfma_f32_16x16x32_bf16 a[40:43], v[208:211], v[32:35], a[40:43]
ds_read_b64_tr_b16 v[236:237], v8 offset:10368
v_mfma_f32_16x16x32_bf16 a[40:43], v[212:215], v[36:39], a[40:43]
v_mfma_f32_16x16x32_bf16 a[44:47], v[212:215], v[44:47], a[44:47]
ds_read_b64_tr_b16 v[238:239], v8 offset:15488
v_mfma_f32_16x16x32_bf16 a[44:47], v[208:211], v[40:43], a[44:47]
s_waitcnt lgkmcnt(8)
buffer_load_dwordx4 v[172:175], v248, s[20:23], s56 offen offset:1024 sc1
v_mfma_f32_16x16x32_bf16 a[48:51], v[216:219], v[16:19], a[48:51]
v_mfma_f32_16x16x32_bf16 a[48:51], v[220:223], v[20:23], a[48:51]
v_mfma_f32_16x16x32_bf16 a[52:55], v[220:223], v[28:31], a[52:55]
v_add_u32 v8, 40960, v8
v_mfma_f32_16x16x32_bf16 a[52:55], v[216:219], v[24:27], a[52:55]
v_add_u32 v9, 40960, v9
v_mfma_f32_16x16x32_bf16 a[56:59], v[216:219], v[32:35], a[56:59]
buffer_load_dwordx4 v[176:179], v249, s[20:23], s56 offen sc1
v_mfma_f32_16x16x32_bf16 a[56:59], v[220:223], v[36:39], a[56:59]
v_mfma_f32_16x16x32_bf16 a[60:63], v[220:223], v[44:47], a[60:63]
s_waitcnt vmcnt(25) lgkmcnt(0)
s_barrier
v_mfma_f32_16x16x32_bf16 a[60:63], v[216:219], v[40:43], a[60:63]
s_waitcnt lgkmcnt(0)
ds_read_b64_tr_b16 v[192:193], v245
buffer_load_dwordx4 v[180:183], v249, s[20:23], s56 offen offset:1024 sc1
v_mfma_f32_16x16x32_bf16 a[64:67], v[224:227], v[16:19], a[64:67]
ds_read_b64_tr_b16 v[194:195], v245 offset:5120
v_mfma_f32_16x16x32_bf16 a[64:67], v[228:231], v[20:23], a[64:67]
ds_read_b64_tr_b16 v[196:197], v245 offset:10240
v_mfma_f32_16x16x32_bf16 a[68:71], v[228:231], v[28:31], a[68:71]
ds_read_b64_tr_b16 v[198:199], v245 offset:15360
v_mfma_f32_16x16x32_bf16 a[68:71], v[224:227], v[24:27], a[68:71]
buffer_load_dwordx4 v[184:187], v250, s[20:23], s56 offen sc1
v_mfma_f32_16x16x32_bf16 a[72:75], v[224:227], v[32:35], a[72:75]
ds_read_b64_tr_b16 v[200:201], v246
v_mfma_f32_16x16x32_bf16 a[72:75], v[228:231], v[36:39], a[72:75]
ds_read_b64_tr_b16 v[202:203], v246 offset:5120
v_mfma_f32_16x16x32_bf16 a[76:79], v[228:231], v[44:47], a[76:79]
ds_read_b64_tr_b16 v[204:205], v246 offset:10240
v_mfma_f32_16x16x32_bf16 a[76:79], v[224:227], v[40:43], a[76:79]
s_waitcnt lgkmcnt(7)
ds_read_b64_tr_b16 v[206:207], v246 offset:15360
buffer_load_dwordx4 v[188:191], v250, s[20:23], s56 offen offset:1024 sc1
v_mfma_f32_16x16x32_bf16 a[80:83], v[232:235], v[16:19], a[80:83]
s_add_u32 s56, s56, 2048
v_mfma_f32_16x16x32_bf16 a[80:83], v[236:239], v[20:23], a[80:83]
ds_read_b64_tr_b16 v[208:209], v245 offset:64
v_mfma_f32_16x16x32_bf16 a[84:87], v[236:239], v[28:31], a[84:87]
ds_read_b64_tr_b16 v[210:211], v245 offset:5184
v_mfma_f32_16x16x32_bf16 a[84:87], v[232:235], v[24:27], a[84:87]
ds_read_b64_tr_b16 v[212:213], v245 offset:10304
v_mfma_f32_16x16x32_bf16 a[88:91], v[232:235], v[32:35], a[88:91]
ds_read_b64_tr_b16 v[214:215], v245 offset:15424
v_mfma_f32_16x16x32_bf16 a[88:91], v[236:239], v[36:39], a[88:91]
v_mfma_f32_16x16x32_bf16 a[92:95], v[236:239], v[44:47], a[92:95]
s_waitcnt vmcnt(19)
v_mfma_f32_16x16x32_bf16 a[92:95], v[232:235], v[40:43], a[92:95]
s_waitcnt lgkmcnt(8)
.p2align 6
L_bloop:
v_mfma_f32_16x16x32_bf16 a[192:195], v[192:195], v[48:51], a[192:195]
s_sub_u32 s63, s63, 1
ds_read_b64_tr_b16 v[216:217], v246 offset:64
v_mfma_f32_16x16x32_bf16 a[192:195], v[196:199], v[52:55], a[192:195]
s_add_u32 s62, s61, 0
s_add_u32 s59, s58, 20480
s_add_u32 m0, s62, 0
v_mfma_f32_16x16x32_bf16 a[196:199], v[196:199], v[60:63], a[196:199]
ds_read_b64_tr_b16 v[218:219], v246 offset:5184
buffer_load_dwordx4 v240, s[40:43], s58 offen lds
v_mfma_f32_16x16x32_bf16 a[196:199], v[192:195], v[56:59], a[196:199]
v_mfma_f32_16x16x32_bf16 a[200:203], v[192:195], v[64:67], a[200:203]
ds_read_b64_tr_b16 v[220:221], v246 offset:10304
v_mfma_f32_16x16x32_bf16 a[200:203], v[196:199], v[68:71], a[200:203]
v_mfma_f32_16x16x32_bf16 a[204:207], v[196:199], v[76:79], a[204:207]
ds_read_b64_tr_b16 v[222:223], v246 offset:15424
buffer_load_dwordx4 v241, s[40:43], s58 offen offset:1024 lds
v_mfma_f32_16x16x32_bf16 a[204:207], v[192:195], v[72:75], a[204:207]
s_waitcnt lgkmcnt(8)
v_mfma_f32_16x16x32_bf16 a[208:211], v[200:203], v[48:51], a[208:211]
ds_read_b64_tr_b16 v[224:225], v245 offset:128
v_mfma_f32_16x16x32_bf16 a[208:211], v[204:207], v[52:55], a[208:211]
v_mfma_f32_16x16x32_bf16 a[212:215], v[204:207], v[60:63], a[212:215]
ds_read_b64_tr_b16 v[226:227], v245 offset:5248
buffer_load_dwordx4 v242, s[40:43], s58 offen offset:2048 lds
v_mfma_f32_16x16x32_bf16 a[212:215], v[200:203], v[56:59], a[212:215]
v_mfma_f32_16x16x32_bf16 a[216:219], v[200:203], v[64:67], a[216:219]
ds_read_b64_tr_b16 v[228:229], v245 offset:10368
v_mfma_f32_16x16x32_bf16 a[216:219], v[204:207], v[68:71], a[216:219]
v_mfma_f32_16x16x32_bf16 a[220:223], v[204:207], v[76:79], a[220:223]
ds_read_b64_tr_b16 v[230:231], v245 offset:15488
buffer_load_dwordx4 v243, s[40:43], s58 offen offset:3072 lds
v_mfma_f32_16x16x32_bf16 a[220:223], v[200:203], v[72:75], a[220:223]
s_waitcnt lgkmcnt(8)
s_add_u32 m0, s62, 4096
v_mfma_f32_16x16x32_bf16 a[224:227], v[208:211], v[48:51], a[224:227]
ds_read_b64_tr_b16 v[232:233], v8
v_mfma_f32_16x16x32_bf16 a[224:227], v[212:215], v[52:55], a[224:227]
v_mfma_f32_16x16x32_bf16 a[228:231], v[212:215], v[60:63], a[228:231]
ds_read_b64_tr_b16 v[234:235], v8 offset:5120
buffer_load_dwordx4 v244, s[40:43], s58 offen lds
v_mfma_f32_16x16x32_bf16 a[228:231], v[208:211], v[56:59], a[228:231]
s_add_u32 m0, s62, 5120
v_mfma_f32_16x16x32_bf16 a[232:235], v[208:211], v[64:67], a[232:235]
ds_read_b64_tr_b16 v[236:237], v8 offset:10240
v_mfma_f32_16x16x32_bf16 a[232:235], v[212:215], v[68:71], a[232:235]
v_mfma_f32_16x16x32_bf16 a[236:239], v[212:215], v[76:79], a[236:239]
ds_read_b64_tr_b16 v[238:239], v8 offset:15360
buffer_load_dwordx4 v240, s[40:43], s59 offen lds
v_mfma_f32_16x16x32_bf16 a[236:239], v[208:211], v[72:75], a[236:239]
s_waitcnt lgkmcnt(8)
v_mfma_f32_16x16x32_bf16 a[240:243], v[216:219], v[48:51], a[240:243]
ds_read_b64_tr_b16 v[192:193], v9
v_mfma_f32_16x16x32_bf16 a[240:243], v[220:223], v[52:55], a[240:243]
v_mfma_f32_16x16x32_bf16 a[244:247], v[220:223], v[60:63], a[244:247]
ds_read_b64_tr_b16 v[194:195], v9 offset:5120
buffer_load_dwordx4 v241, s[40:43], s59 offen offset:1024 lds
v_mfma_f32_16x16x32_bf16 a[244:247], v[216:219], v[56:59], a[244:247]
v_mfma_f32_16x16x32_bf16 a[248:251], v[216:219], v[64:67], a[248:251]
ds_read_b64_tr_b16 v[196:197], v9 offset:10240
v_mfma_f32_16x16x32_bf16 a[248:251], v[220:223], v[68:71], a[248:251]
v_mfma_f32_16x16x32_bf16 a[252:255], v[220:223], v[76:79], a[252:255]
ds_read_b64_tr_b16 v[198:199], v9 offset:15360
v_add_u32 v245, 40960, v245
v_mfma_f32_16x16x32_bf16 a[252:255], v[216:219], v[72:75], a[252:255]
s_waitcnt lgkmcnt(8)
buffer_load_dwordx4 v242, s[40:43], s59 offen offset:2048 lds
v_mfma_f32_16x16x32_bf16 a[0:3], v[224:227], v[48:51], a[0:3]
ds_read_b64_tr_b16 v[200:201], v8 offset:64
v_add_u32 v246, 40960, v246
v_mfma_f32_16x16x32_bf16 a[0:3], v[228:231], v[52:55], a[0:3]
v_mfma_f32_16x16x32_bf16 a[4:7], v[228:231], v[60:63], a[4:7]
ds_read_b64_tr_b16 v[202:203], v8 offset:5184
buffer_load_dwordx4 v243, s[40:43], s59 offen offset:3072 lds
v_mfma_f32_16x16x32_bf16 a[4:7], v[224:227], v[56:59], a[4:7]
s_add_u32 m0, s62, 9216
v_mfma_f32_16x16x32_bf16 a[8:11], v[224:227], v[64:67], a[8:11]
ds_read_b64_tr_b16 v[204:205], v8 offset:10304
v_mfma_f32_16x16x32_bf16 a[8:11], v[228:231], v[68:71], a[8:11]
v_mfma_f32_16x16x32_bf16 a[12:15], v[228:231], v[76:79], a[12:15]
ds_read_b64_tr_b16 v[206:207], v8 offset:15424
v_mfma_f32_16x16x32_bf16 a[12:15], v[224:227], v[72:75], a[12:15]
s_waitcnt lgkmcnt(8)
buffer_load_dwordx4 v244, s[40:43], s59 offen lds
v_mfma_f32_16x16x32_bf16 a[16:19], v[232:235], v[48:51], a[16:19]
s_add_u32 s58, s58, 81920
ds_read_b64_tr_b16 v[208:209], v9 offset:64
v_mfma_f32_16x16x32_bf16 a[16:19], v[236:239], v[52:55], a[16:19]
v_mfma_f32_16x16x32_bf16 a[20:23], v[236:239], v[60:63], a[20:23]
ds_read_b64_tr_b16 v[210:211], v9 offset:5184
v_mfma_f32_16x16x32_bf16 a[20:23], v[232:235], v[56:59], a[20:23]
buffer_load_dwordx4 v[16:19], v247, s[20:23], s56 offen sc1
v_mfma_f32_16x16x32_bf16 a[24:27], v[232:235], v[64:67], a[24:27]
ds_read_b64_tr_b16 v[212:213], v9 offset:10304
v_mfma_f32_16x16x32_bf16 a[24:27], v[236:239], v[68:71], a[24:27]
v_mfma_f32_16x16x32_bf16 a[28:31], v[236:239], v[76:79], a[28:31]
ds_read_b64_tr_b16 v[214:215], v9 offset:15424
v_mfma_f32_16x16x32_bf16 a[28:31], v[232:235], v[72:75], a[28:31]
s_waitcnt lgkmcnt(8)
buffer_load_dwordx4 v[20:23], v247, s[20:23], s56 offen offset:1024 sc1
v_mfma_f32_16x16x32_bf16 a[32:35], v[192:195], v[48:51], a[32:35]
ds_read_b64_tr_b16 v[216:217], v8 offset:128
v_mfma_f32_16x16x32_bf16 a[32:35], v[196:199], v[52:55], a[32:35]
v_mfma_f32_16x16x32_bf16 a[36:39], v[196:199], v[60:63], a[36:39]
ds_read_b64_tr_b16 v[218:219], v8 offset:5248
v_mfma_f32_16x16x32_bf16 a[36:39], v[192:195], v[56:59], a[36:39]
buffer_load_dwordx4 v[24:27], v248, s[20:23], s56 offen sc1
v_mfma_f32_16x16x32_bf16 a[40:43], v[192:195], v[64:67], a[40:43]
ds_read_b64_tr_b16 v[220:221], v8 offset:10368
v_mfma_f32_16x16x32_bf16 a[40:43], v[196:199], v[68:71], a[40:43]
v_mfma_f32_16x16x32_bf16 a[44:47], v[196:199], v[76:79], a[44:47]
ds_read_b64_tr_b16 v[222:223], v8 offset:15488
v_mfma_f32_16x16x32_bf16 a[44:47], v[192:195], v[72:75], a[44:47]
s_waitcnt lgkmcnt(8)
buffer_load_dwordx4 v[28:31], v248, s[20:23], s56 offen offset:1024 sc1
v_mfma_f32_16x16x32_bf16 a[48:51], v[200:203], v[48:51], a[48:51]
v_mfma_f32_16x16x32_bf16 a[48:51], v[204:207], v[52:55], a[48:51]
v_mfma_f32_16x16x32_bf16 a[52:55], v[204:207], v[60:63], a[52:55]
v_add_u32 v8, 40960, v8
v_mfma_f32_16x16x32_bf16 a[52:55], v[200:203], v[56:59], a[52:55]
v_add_u32 v9, 40960, v9
v_mfma_f32_16x16x32_bf16 a[56:59], v[200:203], v[64:67], a[56:59]
buffer_load_dwordx4 v[32:35], v249, s[20:23], s56 offen sc1
v_mfma_f32_16x16x32_bf16 a[56:59], v[204:207], v[68:71], a[56:59]
v_mfma_f32_16x16x32_bf16 a[60:63], v[204:207], v[76:79], a[60:63]
s_waitcnt vmcnt(23) lgkmcnt(0)
s_barrier
v_mfma_f32_16x16x32_bf16 a[60:63], v[200:203], v[72:75], a[60:63]
s_waitcnt lgkmcnt(0)
ds_read_b64_tr_b16 v[224:225], v245
buffer_load_dwordx4 v[36:39], v249, s[20:23], s56 offen offset:1024 sc1
v_mfma_f32_16x16x32_bf16 a[64:67], v[208:211], v[48:51], a[64:67]
ds_read_b64_tr_b16 v[226:227], v245 offset:5120
v_mfma_f32_16x16x32_bf16 a[64:67], v[212:215], v[52:55], a[64:67]
ds_read_b64_tr_b16 v[228:229], v245 offset:10240
v_mfma_f32_16x16x32_bf16 a[68:71], v[212:215], v[60:63], a[68:71]
ds_read_b64_tr_b16 v[230:231], v245 offset:15360
v_mfma_f32_16x16x32_bf16 a[68:71], v[208:211], v[56:59], a[68:71]
buffer_load_dwordx4 v[40:43], v250, s[20:23], s56 offen sc1
v_mfma_f32_16x16x32_bf16 a[72:75], v[208:211], v[64:67], a[72:75]
ds_read_b64_tr_b16 v[232:233], v246
v_mfma_f32_16x16x32_bf16 a[72:75], v[212:215], v[68:71], a[72:75]
ds_read_b64_tr_b16 v[234:235], v246 offset:5120
v_mfma_f32_16x16x32_bf16 a[76:79], v[212:215], v[76:79], a[76:79]
ds_read_b64_tr_b16 v[236:237], v246 offset:10240
v_mfma_f32_16x16x32_bf16 a[76:79], v[208:211], v[72:75], a[76:79]
s_waitcnt lgkmcnt(7)
ds_read_b64_tr_b16 v[238:239], v246 offset:15360
buffer_load_dwordx4 v[44:47], v250, s[20:23], s56 offen offset:1024 sc1
v_mfma_f32_16x16x32_bf16 a[80:83], v[216:219], v[48:51], a[80:83]
s_add_u32 s56, s56, 2048
v_mfma_f32_16x16x32_bf16 a[80:83], v[220:223], v[52:55], a[80:83]
ds_read_b64_tr_b16 v[192:193], v245 offset:64
v_mfma_f32_16x16x32_bf16 a[84:87], v[220:223], v[60:63], a[84:87]
ds_read_b64_tr_b16 v[194:195], v245 offset:5184
v_mfma_f32_16x16x32_bf16 a[84:87], v[216:219], v[56:59], a[84:87]
ds_read_b64_tr_b16 v[196:197], v245 offset:10304
v_mfma_f32_16x16x32_bf16 a[88:91], v[216:219], v[64:67], a[88:91]
ds_read_b64_tr_b16 v[198:199], v245 offset:15424
v_mfma_f32_16x16x32_bf16 a[88:91], v[220:223], v[68:71], a[88:91]
v_mfma_f32_16x16x32_bf16 a[92:95], v[220:223], v[76:79], a[92:95]
s_waitcnt vmcnt(18)
v_mfma_f32_16x16x32_bf16 a[92:95], v[216:219], v[72:75], a[92:95]
s_waitcnt lgkmcnt(8)
v_mfma_f32_16x16x32_bf16 a[192:195], v[224:227], v[160:163], a[192:195]
s_add_u32 s62, s61, 40960
s_add_u32 s59, s58, 20480
ds_read_b64_tr_b16 v[200:201], v246 offset:64
v_mfma_f32_16x16x32_bf16 a[192:195], v[228:231], v[164:167], a[192:195]
s_add_u32 m0, s62, 0
v_mfma_f32_16x16x32_bf16 a[196:199], v[228:231], v[172:175], a[196:199]
ds_read_b64_tr_b16 v[202:203], v246 offset:5184
buffer_load_dwordx4 v240, s[40:43], s58 offen lds
v_mfma_f32_16x16x32_bf16 a[196:199], v[224:227], v[168:171], a[196:199]
v_mfma_f32_16x16x32_bf16 a[200:203], v[224:227], v[176:179], a[200:203]
ds_read_b64_tr_b16 v[204:205], v246 offset:10304
v_mfma_f32_16x16x32_bf16 a[200:203], v[228:231], v[180:183], a[200:203]
buffer_load_dwordx4 v241, s[40:43], s58 offen offset:1024 lds
v_mfma_f32_16x16x32_bf16 a[204:207], v[228:231], v[188:191], a[204:207]
ds_read_b64_tr_b16 v[206:207], v246 offset:15424
v_mfma_f32_16x16x32_bf16 a[204:207], v[224:227], v[184:187], a[204:207]
s_waitcnt lgkmcnt(8)
v_mfma_f32_16x16x32_bf16 a[208:211], v[232:235], v[160:163], a[208:211]
ds_read_b64_tr_b16 v[208:209], v245 offset:128
v_mfma_f32_16x16x32_bf16 a[208:211], v[236:239], v[164:167], a[208:211]
buffer_load_dwordx4 v242, s[40:43], s58 offen offset:2048 lds
v_mfma_f32_16x16x32_bf16 a[212:215], v[236:239], v[172:175], a[212:215]
ds_read_b64_tr_b16 v[210:211], v245 offset:5248
v_mfma_f32_16x16x32_bf16 a[212:215], v[232:235], v[168:171], a[212:215]
v_mfma_f32_16x16x32_bf16 a[216:219], v[232:235], v[176:179], a[216:219]
ds_read_b64_tr_b16 v[212:213], v245 offset:10368
v_mfma_f32_16x16x32_bf16 a[216:219], v[236:239], v[180:183], a[216:219]
buffer_load_dwordx4 v243, s[40:43], s58 offen offset:3072 lds
v_mfma_f32_16x16x32_bf16 a[220:223], v[236:239], v[188:191], a[220:223]
s_add_u32 m0, s62, 4096
ds_read_b64_tr_b16 v[214:215], v245 offset:15488
v_mfma_f32_16x16x32_bf16 a[220:223], v[232:235], v[184:187], a[220:223]
s_waitcnt lgkmcnt(8)
v_mfma_f32_16x16x32_bf16 a[224:227], v[192:195], v[160:163], a[224:227]
ds_read_b64_tr_b16 v[216:217], v8
v_mfma_f32_16x16x32_bf16 a[224:227], v[196:199], v[164:167], a[224:227]
buffer_load_dwordx4 v244, s[40:43], s58 offen lds
v_mfma_f32_16x16x32_bf16 a[228:231], v[196:199], v[172:175], a[228:231]
s_add_u32 m0, s62, 5120
ds_read_b64_tr_b16 v[218:219], v8 offset:5120
v_mfma_f32_16x16x32_bf16 a[228:231], v[192:195], v[168:171], a[228:231]
v_mfma_f32_16x16x32_bf16 a[232:235], v[192:195], v[176:179], a[232:235]
ds_read_b64_tr_b16 v[220:221], v8 offset:10240
v_mfma_f32_16x16x32_bf16 a[232:235], v[196:199], v[180:183], a[232:235]
buffer_load_dwordx4 v240, s[40:43], s59 offen lds
v_mfma_f32_16x16x32_bf16 a[236:239], v[196:199], v[188:191], a[236:239]
ds_read_b64_tr_b16 v[222:223], v8 offset:15360
v_mfma_f32_16x16x32_bf16 a[236:239], v[192:195], v[184:187], a[236:239]
s_waitcnt lgkmcnt(8)
v_mfma_f32_16x16x32_bf16 a[240:243], v[200:203], v[160:163], a[240:243]
ds_read_b64_tr_b16 v[224:225], v9
v_mfma_f32_16x16x32_bf16 a[240:243], v[204:207], v[164:167], a[240:243]
v_mfma_f32_16x16x32_bf16 a[244:247], v[204:207], v[172:175], a[244:247]
ds_read_b64_tr_b16 v[226:227], v9 offset:5120
buffer_load_dwordx4 v241, s[40:43], s59 offen offset:1024 lds
v_mfma_f32_16x16x32_bf16 a[244:247], v[200:203], v[168:171], a[244:247]
v_mfma_f32_16x16x32_bf16 a[248:251], v[200:203], v[176:179], a[248:251]
ds_read_b64_tr_b16 v[228:229], v9 offset:10240
v_mfma_f32_16x16x32_bf16 a[248:251], v[204:207], v[180:183], a[248:251]
v_mfma_f32_16x16x32_bf16 a[252:255], v[204:207], v[188:191], a[252:255]
ds_read_b64_tr_b16 v[230:231], v9 offset:15360
v_add_u32 v245, 4294885376, v245
v_mfma_f32_16x16x32_bf16 a[252:255], v[200:203], v[184:187], a[252:255]
s_waitcnt lgkmcnt(8)
buffer_load_dwordx4 v242, s[40:43], s59 offen offset:2048 lds
v_mfma_f32_16x16x32_bf16 a[0:3], v[208:211], v[160:163], a[0:3]
ds_read_b64_tr_b16 v[232:233], v8 offset:64
v_add_u32 v246, 4294885376, v246
v_mfma_f32_16x16x32_bf16 a[0:3], v[212:215], v[164:167], a[0:3]
v_mfma_f32_16x16x32_bf16 a[4:7], v[212:215], v[172:175], a[4:7]
ds_read_b64_tr_b16 v[234:235], v8 offset:5184
buffer_load_dwordx4 v243, s[40:43], s59 offen offset:3072 lds
v_mfma_f32_16x16x32_bf16 a[4:7], v[208:211], v[168:171], a[4:7]
s_add_u32 m0, s62, 9216
v_mfma_f32_16x16x32_bf16 a[8:11], v[208:211], v[176:179], a[8:11]
ds_read_b64_tr_b16 v[236:237], v8 offset:10304
v_mfma_f32_16x16x32_bf16 a[8:11], v[212:215], v[180:183], a[8:11]
v_mfma_f32_16x16x32_bf16 a[12:15], v[212:215], v[188:191], a[12:15]
ds_read_b64_tr_b16 v[238:239], v8 offset:15424
buffer_load_dwordx4 v244, s[40:43], s59 offen lds
v_mfma_f32_16x16x32_bf16 a[12:15], v[208:211], v[184:187], a[12:15]
s_waitcnt lgkmcnt(8)
s_add_u32 s58, s58, 81920
v_mfma_f32_16x16x32_bf16 a[16:19], v[216:219], v[160:163], a[16:19]
ds_read_b64_tr_b16 v[192:193], v9 offset:64
v_mfma_f32_16x16x32_bf16 a[16:19], v[220:223], v[164:167], a[16:19]
v_mfma_f32_16x16x32_bf16 a[20:23], v[220:223], v[172:175], a[20:23]
ds_read_b64_tr_b16 v[194:195], v9 offset:5184
buffer_load_dwordx4 v[48:51], v247, s[20:23], s56 offen sc1
v_mfma_f32_16x16x32_bf16 a[20:23], v[216:219], v[168:171], a[20:23]
v_mfma_f32_16x16x32_bf16 a[24:27], v[216:219], v[176:179], a[24:27]
ds_read_b64_tr_b16 v[196:197], v9 offset:10304
v_mfma_f32_16x16x32_bf16 a[24:27], v[220:223], v[180:183], a[24:27]
v_mfma_f32_16x16x32_bf16 a[28:31], v[220:223], v[188:191], a[28:31]
ds_read_b64_tr_b16 v[198:199], v9 offset:15424
buffer_load_dwordx4 v[52:55], v247, s[20:23], s56 offen offset:1024 sc1
v_mfma_f32_16x16x32_bf16 a[28:31], v[216:219], v[184:187], a[28:31]
s_waitcnt lgkmcnt(8)
v_mfma_f32_16x16x32_bf16 a[32:35], v[224:227], v[160:163], a[32:35]
ds_read_b64_tr_b16 v[200:201], v8 offset:128
v_mfma_f32_16x16x32_bf16 a[32:35], v[228:231], v[164:167], a[32:35]
v_mfma_f32_16x16x32_bf16 a[36:39], v[228:231], v[172:175], a[36:39]
ds_read_b64_tr_b16 v[202:203], v8 offset:5248
v_mfma_f32_16x16x32_bf16 a[36:39], v[224:227], v[168:171], a[36:39]
buffer_load_dwordx4 v[56:59], v248, s[20:23], s56 offen sc1
v_mfma_f32_16x16x32_bf16 a[40:43], v[224:227], v[176:179], a[40:43]
ds_read_b64_tr_b16 v[204:205], v8 offset:10368
v_mfma_f32_16x16x32_bf16 a[40:43], v[228:231], v[180:183], a[40:43]
v_mfma_f32_16x16x32_bf16 a[44:47], v[228:231], v[188:191], a[44:47]
ds_read_b64_tr_b16 v[206:207], v8 offset:15488
v_mfma_f32_16x16x32_bf16 a[44:47], v[224:227], v[184:187], a[44:47]
s_waitcnt lgkmcnt(8)
buffer_load_dwordx4 v[60:63], v248, s[20:23], s56 offen offset:1024 sc1
v_mfma_f32_16x16x32_bf16 a[48:51], v[232:235], v[160:163], a[48:51]
v_mfma_f32_16x16x32_bf16 a[48:51], v[236:239], v[164:167], a[48:51]
v_mfma_f32_16x16x32_bf16 a[52:55], v[236:239], v[172:175], a[52:55]
v_add_u32 v8, 4294885376, v8
v_mfma_f32_16x16x32_bf16 a[52:55], v[232:235], v[168:171], a[52:55]
v_add_u32 v9, 4294885376, v9
v_mfma_f32_16x16x32_bf16 a[56:59], v[232:235], v[176:179], a[56:59]
buffer_load_dwordx4 v[64:67], v249, s[20:23], s56 offen sc1
v_mfma_f32_16x16x32_bf16 a[56:59], v[236:239], v[180:183], a[56:59]
v_mfma_f32_16x16x32_bf16 a[60:63], v[236:239], v[188:191], a[60:63]
s_waitcnt vmcnt(23) lgkmcnt(0)
s_barrier
v_mfma_f32_16x16x32_bf16 a[60:63], v[232:235], v[184:187], a[60:63]
s_waitcnt lgkmcnt(0)
buffer_store_dwordx2 v[254:255], v252, s[20:23], s14 offen sc1
ds_read_b64_tr_b16 v[208:209], v245
v_mfma_f32_16x16x32_bf16 a[64:67], v[192:195], v[160:163], a[64:67]
ds_read_b64_tr_b16 v[210:211], v245 offset:5120
buffer_load_dwordx4 v[68:71], v249, s[20:23], s56 offen offset:1024 sc1
v_mfma_f32_16x16x32_bf16 a[64:67], v[196:199], v[164:167], a[64:67]
ds_read_b64_tr_b16 v[212:213], v245 offset:10240
v_mfma_f32_16x16x32_bf16 a[68:71], v[196:199], v[172:175], a[68:71]
ds_read_b64_tr_b16 v[214:215], v245 offset:15360
v_mfma_f32_16x16x32_bf16 a[68:71], v[192:195], v[168:171], a[68:71]
buffer_load_dwordx4 v[72:75], v250, s[20:23], s56 offen sc1
v_mfma_f32_16x16x32_bf16 a[72:75], v[192:195], v[176:179], a[72:75]
ds_read_b64_tr_b16 v[216:217], v246
v_mfma_f32_16x16x32_bf16 a[72:75], v[196:199], v[180:183], a[72:75]
ds_read_b64_tr_b16 v[218:219], v246 offset:5120
v_mfma_f32_16x16x32_bf16 a[76:79], v[196:199], v[188:191], a[76:79]
ds_read_b64_tr_b16 v[220:221], v246 offset:10240
v_mfma_f32_16x16x32_bf16 a[76:79], v[192:195], v[184:187], a[76:79]
s_waitcnt lgkmcnt(7)
ds_read_b64_tr_b16 v[222:223], v246 offset:15360
buffer_load_dwordx4 v[76:79], v250, s[20:23], s56 offen offset:1024 sc1
v_mfma_f32_16x16x32_bf16 a[80:83], v[200:203], v[160:163], a[80:83]
s_add_u32 s56, s56, 2048
v_mfma_f32_16x16x32_bf16 a[80:83], v[204:207], v[164:167], a[80:83]
ds_read_b64_tr_b16 v[224:225], v245 offset:64
v_mfma_f32_16x16x32_bf16 a[84:87], v[204:207], v[172:175], a[84:87]
ds_read_b64_tr_b16 v[226:227], v245 offset:5184
v_mfma_f32_16x16x32_bf16 a[84:87], v[200:203], v[168:171], a[84:87]
ds_read_b64_tr_b16 v[228:229], v245 offset:10304
v_mfma_f32_16x16x32_bf16 a[88:91], v[200:203], v[176:179], a[88:91]
ds_read_b64_tr_b16 v[230:231], v245 offset:15424
v_mfma_f32_16x16x32_bf16 a[88:91], v[204:207], v[180:183], a[88:91]
v_mfma_f32_16x16x32_bf16 a[92:95], v[204:207], v[188:191], a[92:95]
s_waitcnt vmcnt(19)
v_mfma_f32_16x16x32_bf16 a[92:95], v[200:203], v[184:187], a[92:95]
s_waitcnt lgkmcnt(8)
v_mfma_f32_16x16x32_bf16 a[192:195], v[208:211], v[16:19], a[192:195]
s_add_u32 s62, s61, 81920
s_add_u32 s59, s58, 20480
ds_read_b64_tr_b16 v[232:233], v246 offset:64
v_mfma_f32_16x16x32_bf16 a[192:195], v[212:215], v[20:23], a[192:195]
s_add_u32 m0, s62, 0
v_mfma_f32_16x16x32_bf16 a[196:199], v[212:215], v[28:31], a[196:199]
ds_read_b64_tr_b16 v[234:235], v246 offset:5184
buffer_load_dwordx4 v240, s[40:43], s58 offen lds
v_mfma_f32_16x16x32_bf16 a[196:199], v[208:211], v[24:27], a[196:199]
v_mfma_f32_16x16x32_bf16 a[200:203], v[208:211], v[32:35], a[200:203]
ds_read_b64_tr_b16 v[236:237], v246 offset:10304
v_mfma_f32_16x16x32_bf16 a[200:203], v[212:215], v[36:39], a[200:203]
buffer_load_dwordx4 v241, s[40:43], s58 offen offset:1024 lds
v_mfma_f32_16x16x32_bf16 a[204:207], v[212:215], v[44:47], a[204:207]
ds_read_b64_tr_b16 v[238:239], v246 offset:15424
v_mfma_f32_16x16x32_bf16 a[204:207], v[208:211], v[40:43], a[204:207]
s_waitcnt lgkmcnt(8)
v_mfma_f32_16x16x32_bf16 a[208:211], v[216:219], v[16:19], a[208:211]
ds_read_b64_tr_b16 v[192:193], v245 offset:128
v_mfma_f32_16x16x32_bf16 a[208:211], v[220:223], v[20:23], a[208:211]
buffer_load_dwordx4 v242, s[40:43], s58 offen offset:2048 lds
v_mfma_f32_16x16x32_bf16 a[212:215], v[220:223], v[28:31], a[212:215]
ds_read_b64_tr_b16 v[194:195], v245 offset:5248
v_mfma_f32_16x16x32_bf16 a[212:215], v[216:219], v[24:27], a[212:215]
v_mfma_f32_16x16x32_bf16 a[216:219], v[216:219], v[32:35], a[216:219]
ds_read_b64_tr_b16 v[196:197], v245 offset:10368
v_mfma_f32_16x16x32_bf16 a[216:219], v[220:223], v[36:39], a[216:219]
buffer_load_dwordx4 v243, s[40:43], s58 offen offset:3072 lds
v_mfma_f32_16x16x32_bf16 a[220:223], v[220:223], v[44:47], a[220:223]
s_add_u32 m0, s62, 4096
ds_read_b64_tr_b16 v[198:199], v245 offset:15488
v_mfma_f32_16x16x32_bf16 a[220:223], v[216:219], v[40:43], a[220:223]
s_waitcnt lgkmcnt(8)
v_mfma_f32_16x16x32_bf16 a[224:227], v[224:227], v[16:19], a[224:227]
ds_read_b64_tr_b16 v[200:201], v8
v_mfma_f32_16x16x32_bf16 a[224:227], v[228:231], v[20:23], a[224:227]
buffer_load_dwordx4 v244, s[40:43], s58 offen lds
v_mfma_f32_16x16x32_bf16 a[228:231], v[228:231], v[28:31], a[228:231]
s_add_u32 m0, s62, 5120
ds_read_b64_tr_b16 v[202:203], v8 offset:5120
v_mfma_f32_16x16x32_bf16 a[228:231], v[224:227], v[24:27], a[228:231]
v_mfma_f32_16x16x32_bf16 a[232:235], v[224:227], v[32:35], a[232:235]
ds_read_b64_tr_b16 v[204:205], v8 offset:10240
v_mfma_f32_16x16x32_bf16 a[232:235], v[228:231], v[36:39], a[232:235]
buffer_load_dwordx4 v240, s[40:43], s59 offen lds
v_mfma_f32_16x16x32_bf16 a[236:239], v[228:231], v[44:47], a[236:239]
ds_read_b64_tr_b16 v[206:207], v8 offset:15360
v_mfma_f32_16x16x32_bf16 a[236:239], v[224:227], v[40:43], a[236:239]
s_waitcnt lgkmcnt(8)
v_mfma_f32_16x16x32_bf16 a[240:243], v[232:235], v[16:19], a[240:243]
ds_read_b64_tr_b16 v[208:209], v9
v_mfma_f32_16x16x32_bf16 a[240:243], v[236:239], v[20:23], a[240:243]
v_mfma_f32_16x16x32_bf16 a[244:247], v[236:239], v[28:31], a[244:247]
ds_read_b64_tr_b16 v[210:211], v9 offset:5120
buffer_load_dwordx4 v241, s[40:43], s59 offen offset:1024 lds
v_mfma_f32_16x16x32_bf16 a[244:247], v[232:235], v[24:27], a[244:247]
v_mfma_f32_16x16x32_bf16 a[248:251], v[232:235], v[32:35], a[248:251]
ds_read_b64_tr_b16 v[212:213], v9 offset:10240
v_mfma_f32_16x16x32_bf16 a[248:251], v[236:239], v[36:39], a[248:251]
v_mfma_f32_16x16x32_bf16 a[252:255], v[236:239], v[44:47], a[252:255]
ds_read_b64_tr_b16 v[214:215], v9 offset:15360
v_add_u32 v245, 40960, v245
v_mfma_f32_16x16x32_bf16 a[252:255], v[232:235], v[40:43], a[252:255]
s_waitcnt lgkmcnt(8)
buffer_load_dwordx4 v242, s[40:43], s59 offen offset:2048 lds
v_mfma_f32_16x16x32_bf16 a[0:3], v[192:195], v[16:19], a[0:3]
ds_read_b64_tr_b16 v[216:217], v8 offset:64
v_add_u32 v246, 40960, v246
v_mfma_f32_16x16x32_bf16 a[0:3], v[196:199], v[20:23], a[0:3]
v_mfma_f32_16x16x32_bf16 a[4:7], v[196:199], v[28:31], a[4:7]
ds_read_b64_tr_b16 v[218:219], v8 offset:5184
buffer_load_dwordx4 v243, s[40:43], s59 offen offset:3072 lds
v_mfma_f32_16x16x32_bf16 a[4:7], v[192:195], v[24:27], a[4:7]
s_add_u32 m0, s62, 9216
v_mfma_f32_16x16x32_bf16 a[8:11], v[192:195], v[32:35], a[8:11]
ds_read_b64_tr_b16 v[220:221], v8 offset:10304
v_mfma_f32_16x16x32_bf16 a[8:11], v[196:199], v[36:39], a[8:11]
v_mfma_f32_16x16x32_bf16 a[12:15], v[196:199], v[44:47], a[12:15]
ds_read_b64_tr_b16 v[222:223], v8 offset:15424
buffer_load_dwordx4 v244, s[40:43], s59 offen lds
v_mfma_f32_16x16x32_bf16 a[12:15], v[192:195], v[40:43], a[12:15]
s_waitcnt lgkmcnt(8)
s_add_u32 s58, s58, 81920
v_mfma_f32_16x16x32_bf16 a[16:19], v[200:203], v[16:19], a[16:19]
ds_read_b64_tr_b16 v[224:225], v9 offset:64
v_mfma_f32_16x16x32_bf16 a[16:19], v[204:207], v[20:23], a[16:19]
v_mfma_f32_16x16x32_bf16 a[20:23], v[204:207], v[28:31], a[20:23]
ds_read_b64_tr_b16 v[226:227], v9 offset:5184
buffer_load_dwordx4 v[160:163], v247, s[20:23], s56 offen sc1
v_mfma_f32_16x16x32_bf16 a[20:23], v[200:203], v[24:27], a[20:23]
v_mfma_f32_16x16x32_bf16 a[24:27], v[200:203], v[32:35], a[24:27]
ds_read_b64_tr_b16 v[228:229], v9 offset:10304
v_mfma_f32_16x16x32_bf16 a[24:27], v[204:207], v[36:39], a[24:27]
v_mfma_f32_16x16x32_bf16 a[28:31], v[204:207], v[44:47], a[28:31]
ds_read_b64_tr_b16 v[230:231], v9 offset:15424
buffer_load_dwordx4 v[164:167], v247, s[20:23], s56 offen offset:1024 sc1
v_mfma_f32_16x16x32_bf16 a[28:31], v[200:203], v[40:43], a[28:31]
s_waitcnt lgkmcnt(8)
v_mfma_f32_16x16x32_bf16 a[32:35], v[208:211], v[16:19], a[32:35]
ds_read_b64_tr_b16 v[232:233], v8 offset:128
v_mfma_f32_16x16x32_bf16 a[32:35], v[212:215], v[20:23], a[32:35]
v_mfma_f32_16x16x32_bf16 a[36:39], v[212:215], v[28:31], a[36:39]
ds_read_b64_tr_b16 v[234:235], v8 offset:5248
v_mfma_f32_16x16x32_bf16 a[36:39], v[208:211], v[24:27], a[36:39]
buffer_load_dwordx4 v[168:171], v248, s[20:23], s56 offen sc1
v_mfma_f32_16x16x32_bf16 a[40:43], v[208:211], v[32:35], a[40:43]
ds_read_b64_tr_b16 v[236:237], v8 offset:10368
v_mfma_f32_16x16x32_bf16 a[40:43], v[212:215], v[36:39], a[40:43]
v_mfma_f32_16x16x32_bf16 a[44:47], v[212:215], v[44:47], a[44:47]
ds_read_b64_tr_b16 v[238:239], v8 offset:15488
v_mfma_f32_16x16x32_bf16 a[44:47], v[208:211], v[40:43], a[44:47]
s_waitcnt lgkmcnt(8)
buffer_load_dwordx4 v[172:175], v248, s[20:23], s56 offen offset:1024 sc1
v_mfma_f32_16x16x32_bf16 a[48:51], v[216:219], v[16:19], a[48:51]
v_mfma_f32_16x16x32_bf16 a[48:51], v[220:223], v[20:23], a[48:51]
v_mfma_f32_16x16x32_bf16 a[52:55], v[220:223], v[28:31], a[52:55]
v_add_u32 v8, 40960, v8
v_mfma_f32_16x16x32_bf16 a[52:55], v[216:219], v[24:27], a[52:55]
v_add_u32 v9, 40960, v9
v_mfma_f32_16x16x32_bf16 a[56:59], v[216:219], v[32:35], a[56:59]
buffer_load_dwordx4 v[176:179], v249, s[20:23], s56 offen sc1
v_mfma_f32_16x16x32_bf16 a[56:59], v[220:223], v[36:39], a[56:59]
v_mfma_f32_16x16x32_bf16 a[60:63], v[220:223], v[44:47], a[60:63]
s_waitcnt vmcnt(24) lgkmcnt(0)
s_barrier
v_mfma_f32_16x16x32_bf16 a[60:63], v[216:219], v[40:43], a[60:63]
s_waitcnt lgkmcnt(0)
ds_read_b64_tr_b16 v[192:193], v245
buffer_load_dwordx4 v[180:183], v249, s[20:23], s56 offen offset:1024 sc1
v_mfma_f32_16x16x32_bf16 a[64:67], v[224:227], v[16:19], a[64:67]
ds_read_b64_tr_b16 v[194:195], v245 offset:5120
v_mfma_f32_16x16x32_bf16 a[64:67], v[228:231], v[20:23], a[64:67]
ds_read_b64_tr_b16 v[196:197], v245 offset:10240
v_mfma_f32_16x16x32_bf16 a[68:71], v[228:231], v[28:31], a[68:71]
ds_read_b64_tr_b16 v[198:199], v245 offset:15360
v_mfma_f32_16x16x32_bf16 a[68:71], v[224:227], v[24:27], a[68:71]
buffer_load_dwordx4 v[184:187], v250, s[20:23], s56 offen sc1
v_mfma_f32_16x16x32_bf16 a[72:75], v[224:227], v[32:35], a[72:75]
ds_read_b64_tr_b16 v[200:201], v246
v_mfma_f32_16x16x32_bf16 a[72:75], v[228:231], v[36:39], a[72:75]
ds_read_b64_tr_b16 v[202:203], v246 offset:5120
v_mfma_f32_16x16x32_bf16 a[76:79], v[228:231], v[44:47], a[76:79]
ds_read_b64_tr_b16 v[204:205], v246 offset:10240
v_mfma_f32_16x16x32_bf16 a[76:79], v[224:227], v[40:43], a[76:79]
s_waitcnt lgkmcnt(7)
ds_read_b64_tr_b16 v[206:207], v246 offset:15360
buffer_load_dwordx4 v[188:191], v250, s[20:23], s56 offen offset:1024 sc1
v_mfma_f32_16x16x32_bf16 a[80:83], v[232:235], v[16:19], a[80:83]
s_add_u32 s56, s56, 2048
s_cmp_lg_u32 s63, 0
v_mfma_f32_16x16x32_bf16 a[80:83], v[236:239], v[20:23], a[80:83]
ds_read_b64_tr_b16 v[208:209], v245 offset:64
v_mfma_f32_16x16x32_bf16 a[84:87], v[236:239], v[28:31], a[84:87]
ds_read_b64_tr_b16 v[210:211], v245 offset:5184
v_mfma_f32_16x16x32_bf16 a[84:87], v[232:235], v[24:27], a[84:87]
ds_read_b64_tr_b16 v[212:213], v245 offset:10304
v_mfma_f32_16x16x32_bf16 a[88:91], v[232:235], v[32:35], a[88:91]
ds_read_b64_tr_b16 v[214:215], v245 offset:15424
v_mfma_f32_16x16x32_bf16 a[88:91], v[236:239], v[36:39], a[88:91]
v_mfma_f32_16x16x32_bf16 a[92:95], v[236:239], v[44:47], a[92:95]
s_waitcnt vmcnt(18)
v_mfma_f32_16x16x32_bf16 a[92:95], v[232:235], v[40:43], a[92:95]
s_waitcnt lgkmcnt(8)
s_cbranch_scc1 L_bloop
v_and_b32 v6, 3, v0
v_lshlrev_b32 v6, 3, v6
s_lshl_b32 s12, 1, s3
s_xor_b32 s12, s12, 15
v_mfma_f32_16x16x32_bf16 a[192:195], v[192:195], v[48:51], a[192:195]
ds_read_b64_tr_b16 v[216:217], v246 offset:64
v_add_u32 v2, 40960, v2
v_add_u32 v3, 40960, v3
v_mfma_f32_16x16x32_bf16 a[192:195], v[196:199], v[52:55], a[192:195]
buffer_load_dwordx2 v[14:15], v6, s[20:23], s24 offen sc1
v_lshrrev_b32 v7, 4, v0
v_lshlrev_b32 v7, 3, v7
v_mfma_f32_16x16x32_bf16 a[196:199], v[196:199], v[60:63], a[196:199]
s_add_u32 s62, s61, 0
s_add_u32 s59, s58, 20480
ds_read_b64_tr_b16 v[218:219], v246 offset:5184
v_and_b32 v5, 15, v0
v_mfma_f32_16x16x32_bf16 a[196:199], v[192:195], v[56:59], a[196:199]
s_add_u32 m0, s62, 0
v_mul_u32_u24 v5, 1280, v5
v_add_u32 v5, v5, v7
v_mfma_f32_16x16x32_bf16 a[200:203], v[192:195], v[64:67], a[200:203]
ds_read_b64_tr_b16 v[220:221], v246 offset:10304
buffer_load_dwordx4 v240, s[40:43], s58 offen lds
v_mfma_f32_16x16x32_bf16 a[200:203], v[196:199], v[68:71], a[200:203]
v_mfma_f32_16x16x32_bf16 a[204:207], v[196:199], v[76:79], a[204:207]
ds_read_b64_tr_b16 v[222:223], v246 offset:15424
v_mfma_f32_16x16x32_bf16 a[204:207], v[192:195], v[72:75], a[204:207]
s_waitcnt lgkmcnt(8)
v_mfma_f32_16x16x32_bf16 a[208:211], v[200:203], v[48:51], a[208:211]
ds_read_b64_tr_b16 v[224:225], v245 offset:128
buffer_load_dwordx4 v241, s[40:43], s58 offen offset:1024 lds
v_mfma_f32_16x16x32_bf16 a[208:211], v[204:207], v[52:55], a[208:211]
v_mfma_f32_16x16x32_bf16 a[212:215], v[204:207], v[60:63], a[212:215]
ds_read_b64_tr_b16 v[226:227], v245 offset:5248
v_mfma_f32_16x16x32_bf16 a[212:215], v[200:203], v[56:59], a[212:215]
v_mfma_f32_16x16x32_bf16 a[216:219], v[200:203], v[64:67], a[216:219]
ds_read_b64_tr_b16 v[228:229], v245 offset:10368
buffer_load_dwordx4 v242, s[40:43], s58 offen offset:2048 lds
v_mfma_f32_16x16x32_bf16 a[216:219], v[204:207], v[68:71], a[216:219]
v_mfma_f32_16x16x32_bf16 a[220:223], v[204:207], v[76:79], a[220:223]
ds_read_b64_tr_b16 v[230:231], v245 offset:15488
v_mfma_f32_16x16x32_bf16 a[220:223], v[200:203], v[72:75], a[220:223]
s_waitcnt lgkmcnt(8)
v_mfma_f32_16x16x32_bf16 a[224:227], v[208:211], v[48:51], a[224:227]
ds_read_b64_tr_b16 v[232:233], v8
buffer_load_dwordx4 v243, s[40:43], s58 offen offset:3072 lds
v_mfma_f32_16x16x32_bf16 a[224:227], v[212:215], v[52:55], a[224:227]
s_add_u32 m0, s62, 4096
v_mfma_f32_16x16x32_bf16 a[228:231], v[212:215], v[60:63], a[228:231]
ds_read_b64_tr_b16 v[234:235], v8 offset:5120
v_mfma_f32_16x16x32_bf16 a[228:231], v[208:211], v[56:59], a[228:231]
v_mfma_f32_16x16x32_bf16 a[232:235], v[208:211], v[64:67], a[232:235]
ds_read_b64_tr_b16 v[236:237], v8 offset:10240
buffer_load_dwordx4 v244, s[40:43], s58 offen lds
v_mfma_f32_16x16x32_bf16 a[232:235], v[212:215], v[68:71], a[232:235]
s_add_u32 m0, s62, 5120
v_mfma_f32_16x16x32_bf16 a[236:239], v[212:215], v[76:79], a[236:239]
ds_read_b64_tr_b16 v[238:239], v8 offset:15360
v_mfma_f32_16x16x32_bf16 a[236:239], v[208:211], v[72:75], a[236:239]
s_waitcnt lgkmcnt(8)
v_mfma_f32_16x16x32_bf16 a[240:243], v[216:219], v[48:51], a[240:243]
ds_read_b64_tr_b16 v[192:193], v9
buffer_load_dwordx4 v240, s[40:43], s59 offen lds
v_mfma_f32_16x16x32_bf16 a[240:243], v[220:223], v[52:55], a[240:243]
v_mfma_f32_16x16x32_bf16 a[244:247], v[220:223], v[60:63], a[244:247]
ds_read_b64_tr_b16 v[194:195], v9 offset:5120
v_mfma_f32_16x16x32_bf16 a[244:247], v[216:219], v[56:59], a[244:247]
v_mfma_f32_16x16x32_bf16 a[248:251], v[216:219], v[64:67], a[248:251]
ds_read_b64_tr_b16 v[196:197], v9 offset:10240
buffer_load_dwordx4 v241, s[40:43], s59 offen offset:1024 lds
v_mfma_f32_16x16x32_bf16 a[248:251], v[220:223], v[68:71], a[248:251]
v_mfma_f32_16x16x32_bf16 a[252:255], v[220:223], v[76:79], a[252:255]
ds_read_b64_tr_b16 v[198:199], v9 offset:15360
v_add_u32 v245, 40960, v245
v_mfma_f32_16x16x32_bf16 a[252:255], v[216:219], v[72:75], a[252:255]
s_waitcnt lgkmcnt(8)
v_mfma_f32_16x16x32_bf16 a[0:3], v[224:227], v[48:51], a[0:3]
ds_read_b64_tr_b16 v[200:201], v8 offset:64
v_add_u32 v246, 40960, v246
v_mfma_f32_16x16x32_bf16 a[0:3], v[228:231], v[52:55], a[0:3]
buffer_load_dwordx4 v242, s[40:43], s59 offen offset:2048 lds
v_mfma_f32_16x16x32_bf16 a[4:7], v[228:231], v[60:63], a[4:7]
ds_read_b64_tr_b16 v[202:203], v8 offset:5184
v_mfma_f32_16x16x32_bf16 a[4:7], v[224:227], v[56:59], a[4:7]
v_mfma_f32_16x16x32_bf16 a[8:11], v[224:227], v[64:67], a[8:11]
ds_read_b64_tr_b16 v[204:205], v8 offset:10304
buffer_load_dwordx4 v243, s[40:43], s59 offen offset:3072 lds
v_mfma_f32_16x16x32_bf16 a[8:11], v[228:231], v[68:71], a[8:11]
s_add_u32 m0, s62, 9216
v_mfma_f32_16x16x32_bf16 a[12:15], v[228:231], v[76:79], a[12:15]
ds_read_b64_tr_b16 v[206:207], v8 offset:15424
v_mfma_f32_16x16x32_bf16 a[12:15], v[224:227], v[72:75], a[12:15]
s_waitcnt lgkmcnt(8)
v_mfma_f32_16x16x32_bf16 a[16:19], v[232:235], v[48:51], a[16:19]
ds_read_b64_tr_b16 v[208:209], v9 offset:64
buffer_load_dwordx4 v244, s[40:43], s59 offen lds
v_mfma_f32_16x16x32_bf16 a[16:19], v[236:239], v[52:55], a[16:19]
s_add_u32 s58, s58, 81920
v_mfma_f32_16x16x32_bf16 a[20:23], v[236:239], v[60:63], a[20:23]
ds_read_b64_tr_b16 v[210:211], v9 offset:5184
v_mfma_f32_16x16x32_bf16 a[20:23], v[232:235], v[56:59], a[20:23]
v_mfma_f32_16x16x32_bf16 a[24:27], v[232:235], v[64:67], a[24:27]
ds_read_b64_tr_b16 v[212:213], v9 offset:10304
buffer_load_dwordx4 v[16:19], v247, s[20:23], s56 offen sc1
v_mfma_f32_16x16x32_bf16 a[24:27], v[236:239], v[68:71], a[24:27]
v_mfma_f32_16x16x32_bf16 a[28:31], v[236:239], v[76:79], a[28:31]
ds_read_b64_tr_b16 v[214:215], v9 offset:15424
v_mfma_f32_16x16x32_bf16 a[28:31], v[232:235], v[72:75], a[28:31]
s_waitcnt lgkmcnt(8)
v_mfma_f32_16x16x32_bf16 a[32:35], v[192:195], v[48:51], a[32:35]
ds_read_b64_tr_b16 v[216:217], v8 offset:128
buffer_load_dwordx4 v[20:23], v247, s[20:23], s56 offen offset:1024 sc1
v_mfma_f32_16x16x32_bf16 a[32:35], v[196:199], v[52:55], a[32:35]
v_mfma_f32_16x16x32_bf16 a[36:39], v[196:199], v[60:63], a[36:39]
ds_read_b64_tr_b16 v[218:219], v8 offset:5248
v_mfma_f32_16x16x32_bf16 a[36:39], v[192:195], v[56:59], a[36:39]
v_mfma_f32_16x16x32_bf16 a[40:43], v[192:195], v[64:67], a[40:43]
ds_read_b64_tr_b16 v[220:221], v8 offset:10368
buffer_load_dwordx4 v[24:27], v248, s[20:23], s56 offen sc1
v_mfma_f32_16x16x32_bf16 a[40:43], v[196:199], v[68:71], a[40:43]
v_mfma_f32_16x16x32_bf16 a[44:47], v[196:199], v[76:79], a[44:47]
ds_read_b64_tr_b16 v[222:223], v8 offset:15488
v_mfma_f32_16x16x32_bf16 a[44:47], v[192:195], v[72:75], a[44:47]
s_waitcnt lgkmcnt(8)
v_mfma_f32_16x16x32_bf16 a[48:51], v[200:203], v[48:51], a[48:51]
buffer_load_dwordx4 v[28:31], v248, s[20:23], s56 offen offset:1024 sc1
v_mfma_f32_16x16x32_bf16 a[48:51], v[204:207], v[52:55], a[48:51]
v_mfma_f32_16x16x32_bf16 a[52:55], v[204:207], v[60:63], a[52:55]
v_add_u32 v8, 40960, v8
v_mfma_f32_16x16x32_bf16 a[52:55], v[200:203], v[56:59], a[52:55]
v_add_u32 v9, 40960, v9
v_mfma_f32_16x16x32_bf16 a[56:59], v[200:203], v[64:67], a[56:59]
buffer_load_dwordx4 v[32:35], v249, s[20:23], s56 offen sc1
v_mfma_f32_16x16x32_bf16 a[56:59], v[204:207], v[68:71], a[56:59]
v_mfma_f32_16x16x32_bf16 a[60:63], v[204:207], v[76:79], a[60:63]
s_waitcnt vmcnt(24) lgkmcnt(0)
s_barrier
v_mfma_f32_16x16x32_bf16 a[60:63], v[200:203], v[72:75], a[60:63]
s_waitcnt lgkmcnt(0)
ds_read_b64_tr_b16 v[224:225], v245
v_mfma_f32_16x16x32_bf16 a[64:67], v[208:211], v[48:51], a[64:67]
ds_read_b64_tr_b16 v[226:227], v245 offset:5120
buffer_load_dwordx4 v[36:39], v249, s[20:23], s56 offen offset:1024 sc1
v_mfma_f32_16x16x32_bf16 a[64:67], v[212:215], v[52:55], a[64:67]
ds_read_b64_tr_b16 v[228:229], v245 offset:10240
v_mfma_f32_16x16x32_bf16 a[68:71], v[212:215], v[60:63], a[68:71]
ds_read_b64_tr_b16 v[230:231], v245 offset:15360
v_mfma_f32_16x16x32_bf16 a[68:71], v[208:211], v[56:59], a[68:71]
v_mfma_f32_16x16x32_bf16 a[72:75], v[208:211], v[64:67], a[72:75]
ds_read_b64_tr_b16 v[232:233], v246
buffer_load_dwordx4 v[40:43], v250, s[20:23], s56 offen sc1
v_mfma_f32_16x16x32_bf16 a[72:75], v[212:215], v[68:71], a[72:75]
ds_read_b64_tr_b16 v[234:235], v246 offset:5120
v_mfma_f32_16x16x32_bf16 a[76:79], v[212:215], v[76:79], a[76:79]
ds_read_b64_tr_b16 v[236:237], v246 offset:10240
v_mfma_f32_16x16x32_bf16 a[76:79], v[208:211], v[72:75], a[76:79]
s_waitcnt lgkmcnt(7)
ds_read_b64_tr_b16 v[238:239], v246 offset:15360
v_mfma_f32_16x16x32_bf16 a[80:83], v[216:219], v[48:51], a[80:83]
buffer_load_dwordx4 v[44:47], v250, s[20:23], s56 offen offset:1024 sc1
v_mfma_f32_16x16x32_bf16 a[80:83], v[220:223], v[52:55], a[80:83]
s_add_u32 s56, s56, 2048
ds_read_b64_tr_b16 v[192:193], v245 offset:64
v_mfma_f32_16x16x32_bf16 a[84:87], v[220:223], v[60:63], a[84:87]
ds_read_b64_tr_b16 v[194:195], v245 offset:5184
v_mfma_f32_16x16x32_bf16 a[84:87], v[216:219], v[56:59], a[84:87]
ds_read_b64_tr_b16 v[196:197], v245 offset:10304
v_mfma_f32_16x16x32_bf16 a[88:91], v[216:219], v[64:67], a[88:91]
ds_read_b64_tr_b16 v[198:199], v245 offset:15424
v_mfma_f32_16x16x32_bf16 a[88:91], v[220:223], v[68:71], a[88:91]
v_mfma_f32_16x16x32_bf16 a[92:95], v[220:223], v[76:79], a[92:95]
s_waitcnt vmcnt(19)
v_mfma_f32_16x16x32_bf16 a[92:95], v[216:219], v[72:75], a[92:95]
s_waitcnt lgkmcnt(8)
s_waitcnt vmcnt(18)
v_cmp_ne_u32 vcc, s70, v14
v_cmp_ne_u32 s[64:65], s71, v15
s_nop 0
s_or_b32 s64, vcc_lo, s64
s_and_b32 s64, s64, s12
s_cmp_lg_u32 s64, 0
s_cbranch_scc0 L_py_ok
s_mov_b32 s74, 262144
L_py:
buffer_load_dwordx2 v[14:15], v6, s[20:23], s24 offen sc1
s_waitcnt vmcnt(0)
v_cmp_ne_u32 vcc, s70, v14
v_cmp_ne_u32 s[64:65], s71, v15
s_nop 0
s_or_b32 s64, vcc_lo, s64
s_and_b32 s64, s64, s12
s_cmp_lg_u32 s64, 0
s_cbranch_scc0 L_py_ok
s_sleep 4
s_sub_u32 s74, s74, 1
s_cmp_lg_u32 s74, 0
s_cbranch_scc1 L_py
L_py_ok:
v_mfma_f32_16x16x32_bf16 a[192:195], v[224:227], v[160:163], a[192:195]
s_add_u32 s64, s3, 1
s_and_b32 s64, s64, 3
ds_read_b64_tr_b16 v[200:201], v246 offset:64
v_mfma_f32_16x16x32_bf16 a[192:195], v[228:231], v[164:167], a[192:195]
s_mul_i32 s64, s64, 12288
s_add_u32 s64, s64, s26
buffer_load_dwordx4 v[100:103], v4, s[20:23], s64 offen sc1
v_mfma_f32_16x16x32_bf16 a[196:199], v[228:231], v[172:175], a[196:199]
ds_read_b64_tr_b16 v[202:203], v246 offset:5184
v_mfma_f32_16x16x32_bf16 a[196:199], v[224:227], v[168:171], a[196:199]
v_mfma_f32_16x16x32_bf16 a[200:203], v[224:227], v[176:179], a[200:203]
ds_read_b64_tr_b16 v[204:205], v246 offset:10304
v_mfma_f32_16x16x32_bf16 a[200:203], v[228:231], v[180:183], a[200:203]
v_mfma_f32_16x16x32_bf16 a[204:207], v[228:231], v[188:191], a[204:207]
ds_read_b64_tr_b16 v[206:207], v246 offset:15424
buffer_load_dwordx4 v[104:107], v4, s[20:23], s64 offen offset:1024 sc1
v_mfma_f32_16x16x32_bf16 a[204:207], v[224:227], v[184:187], a[204:207]
s_waitcnt lgkmcnt(8)
v_mfma_f32_16x16x32_bf16 a[208:211], v[232:235], v[160:163], a[208:211]
ds_read_b64_tr_b16 v[208:209], v245 offset:128
v_mfma_f32_16x16x32_bf16 a[208:211], v[236:239], v[164:167], a[208:211]
v_mfma_f32_16x16x32_bf16 a[212:215], v[236:239], v[172:175], a[212:215]
ds_read_b64_tr_b16 v[210:211], v245 offset:5248
v_mfma_f32_16x16x32_bf16 a[212:215], v[232:235], v[168:171], a[212:215]
buffer_load_dwordx2 v[108:109], v1, s[20:23], s64 offen sc1
v_mfma_f32_16x16x32_bf16 a[216:219], v[232:235], v[176:179], a[216:219]
s_add_u32 s64, s3, 2
s_and_b32 s64, s64, 3
ds_read_b64_tr_b16 v[212:213], v245 offset:10368
v_mfma_f32_16x16x32_bf16 a[216:219], v[236:239], v[180:183], a[216:219]
s_mul_i32 s64, s64, 12288
s_add_u32 s64, s64, s26
v_mfma_f32_16x16x32_bf16 a[220:223], v[236:239], v[188:191], a[220:223]
ds_read_b64_tr_b16 v[214:215], v245 offset:15488
v_mfma_f32_16x16x32_bf16 a[220:223], v[232:235], v[184:187], a[220:223]
s_waitcnt lgkmcnt(8)
v_mfma_f32_16x16x32_bf16 a[224:227], v[192:195], v[160:163], a[224:227]
ds_read_b64_tr_b16 v[216:217], v8
v_mfma_f32_16x16x32_bf16 a[224:227], v[196:199], v[164:167], a[224:227]
buffer_load_dwordx4 v[110:113], v4, s[20:23], s64 offen sc1
v_mfma_f32_16x16x32_bf16 a[228:231], v[196:199], v[172:175], a[228:231]
ds_read_b64_tr_b16 v[218:219], v8 offset:5120
v_mfma_f32_16x16x32_bf16 a[228:231], v[192:195], v[168:171], a[228:231]
v_mfma_f32_16x16x32_bf16 a[232:235], v[192:195], v[176:179], a[232:235]
ds_read_b64_tr_b16 v[220:221], v8 offset:10240
v_mfma_f32_16x16x32_bf16 a[232:235], v[196:199], v[180:183], a[232:235]
v_mfma_f32_16x16x32_bf16 a[236:239], v[196:199], v[188:191], a[236:239]
ds_read_b64_tr_b16 v[222:223], v8 offset:15360
buffer_load_dwordx4 v[114:117], v4, s[20:23], s64 offen offset:1024 sc1
v_mfma_f32_16x16x32_bf16 a[236:239], v[192:195], v[184:187], a[236:239]
s_waitcnt lgkmcnt(8)
v_mfma_f32_16x16x32_bf16 a[240:243], v[200:203], v[160:163], a[240:243]
ds_read_b64_tr_b16 v[224:225], v9
v_mfma_f32_16x16x32_bf16 a[240:243], v[204:207], v[164:167], a[240:243]
v_mfma_f32_16x16x32_bf16 a[244:247], v[204:207], v[172:175], a[244:247]
ds_read_b64_tr_b16 v[226:227], v9 offset:5120
v_mfma_f32_16x16x32_bf16 a[244:247], v[200:203], v[168:171], a[244:247]
v_mfma_f32_16x16x32_bf16 a[248:251], v[200:203], v[176:179], a[248:251]
ds_read_b64_tr_b16 v[228:229], v9 offset:10240
buffer_load_dwordx2 v[118:119], v1, s[20:23], s64 offen sc1
v_mfma_f32_16x16x32_bf16 a[248:251], v[204:207], v[180:183], a[248:251]
s_add_u32 s64, s3, 3
s_and_b32 s64, s64, 3
s_mul_i32 s64, s64, 12288
v_mfma_f32_16x16x32_bf16 a[252:255], v[204:207], v[188:191], a[252:255]
s_add_u32 s64, s64, s26
ds_read_b64_tr_b16 v[230:231], v9 offset:15360
v_add_u32 v245, 4294885376, v245
v_mfma_f32_16x16x32_bf16 a[252:255], v[200:203], v[184:187], a[252:255]
s_waitcnt lgkmcnt(8)
v_mfma_f32_16x16x32_bf16 a[0:3], v[208:211], v[160:163], a[0:3]
ds_read_b64_tr_b16 v[232:233], v8 offset:64
v_add_u32 v246, 4294885376, v246
v_mfma_f32_16x16x32_bf16 a[0:3], v[212:215], v[164:167], a[0:3]
buffer_load_dwordx4 v[120:123], v4, s[20:23], s64 offen sc1
v_mfma_f32_16x16x32_bf16 a[4:7], v[212:215], v[172:175], a[4:7]
ds_read_b64_tr_b16 v[234:235], v8 offset:5184
v_mfma_f32_16x16x32_bf16 a[4:7], v[208:211], v[168:171], a[4:7]
v_mfma_f32_16x16x32_bf16 a[8:11], v[208:211], v[176:179], a[8:11]
ds_read_b64_tr_b16 v[236:237], v8 offset:10304
v_mfma_f32_16x16x32_bf16 a[8:11], v[212:215], v[180:183], a[8:11]
v_mfma_f32_16x16x32_bf16 a[12:15], v[212:215], v[188:191], a[12:15]
ds_read_b64_tr_b16 v[238:239], v8 offset:15424
v_mfma_f32_16x16x32_bf16 a[12:15], v[208:211], v[184:187], a[12:15]
s_waitcnt lgkmcnt(8)
buffer_load_dwordx4 v[124:127], v4, s[20:23], s64 offen offset:1024 sc1
v_mfma_f32_16x16x32_bf16 a[16:19], v[216:219], v[160:163], a[16:19]
ds_read_b64_tr_b16 v[192:193], v9 offset:64
v_mfma_f32_16x16x32_bf16 a[16:19], v[220:223], v[164:167], a[16:19]
v_mfma_f32_16x16x32_bf16 a[20:23], v[220:223], v[172:175], a[20:23]
ds_read_b64_tr_b16 v[194:195], v9 offset:5184
v_mfma_f32_16x16x32_bf16 a[20:23], v[216:219], v[168:171], a[20:23]
v_mfma_f32_16x16x32_bf16 a[24:27], v[216:219], v[176:179], a[24:27]
ds_read_b64_tr_b16 v[196:197], v9 offset:10304
buffer_load_dwordx2 v[128:129], v1, s[20:23], s64 offen sc1
v_mfma_f32_16x16x32_bf16 a[24:27], v[220:223], v[180:183], a[24:27]
s_lshr_b32 s66, s13, 6
s_add_u32 s66, s66, s3
s_mul_i32 s56, s66, 20480
v_mfma_f32_16x16x32_bf16 a[28:31], v[220:223], v[188:191], a[28:31]
s_mul_i32 s66, s73, 320
s_mul_i32 s65, s76, 160
ds_read_b64_tr_b16 v[198:199], v9 offset:15424
v_mfma_f32_16x16x32_bf16 a[28:31], v[216:219], v[184:187], a[28:31]
s_waitcnt lgkmcnt(8)
s_add_u32 s66, s66, s65
s_add_u32 s56, s56, s66
v_mfma_f32_16x16x32_bf16 a[32:35], v[224:227], v[160:163], a[32:35]
ds_read_b64_tr_b16 v[200:201], v8 offset:128
v_mfma_f32_16x16x32_bf16 a[32:35], v[228:231], v[164:167], a[32:35]
v_mfma_f32_16x16x32_bf16 a[36:39], v[228:231], v[172:175], a[36:39]
ds_read_b64_tr_b16 v[202:203], v8 offset:5248
v_mfma_f32_16x16x32_bf16 a[36:39], v[224:227], v[168:171], a[36:39]
v_mfma_f32_16x16x32_bf16 a[40:43], v[224:227], v[176:179], a[40:43]
ds_read_b64_tr_b16 v[204:205], v8 offset:10368
v_mfma_f32_16x16x32_bf16 a[40:43], v[228:231], v[180:183], a[40:43]
v_mfma_f32_16x16x32_bf16 a[44:47], v[228:231], v[188:191], a[44:47]
ds_read_b64_tr_b16 v[206:207], v8 offset:15488
v_mfma_f32_16x16x32_bf16 a[44:47], v[224:227], v[184:187], a[44:47]
s_waitcnt lgkmcnt(8)
v_mfma_f32_16x16x32_bf16 a[48:51], v[232:235], v[160:163], a[48:51]
v_mfma_f32_16x16x32_bf16 a[48:51], v[236:239], v[164:167], a[48:51]
v_mfma_f32_16x16x32_bf16 a[52:55], v[236:239], v[172:175], a[52:55]
v_add_u32 v8, 4294885376, v8
v_mfma_f32_16x16x32_bf16 a[52:55], v[232:235], v[168:171], a[52:55]
v_add_u32 v9, 4294885376, v9
v_mfma_f32_16x16x32_bf16 a[56:59], v[232:235], v[176:179], a[56:59]
v_mfma_f32_16x16x32_bf16 a[56:59], v[236:239], v[180:183], a[56:59]
v_mfma_f32_16x16x32_bf16 a[60:63], v[236:239], v[188:191], a[60:63]
s_waitcnt vmcnt(9) lgkmcnt(0)
s_barrier
v_mfma_f32_16x16x32_bf16 a[60:63], v[232:235], v[184:187], a[60:63]
s_waitcnt lgkmcnt(0)
ds_read_b64_tr_b16 v[208:209], v245
v_mfma_f32_16x16x32_bf16 a[64:67], v[192:195], v[160:163], a[64:67]
ds_read_b64_tr_b16 v[210:211], v245 offset:5120
v_mfma_f32_16x16x32_bf16 a[64:67], v[196:199], v[164:167], a[64:67]
ds_read_b64_tr_b16 v[212:213], v245 offset:10240
v_mfma_f32_16x16x32_bf16 a[68:71], v[196:199], v[172:175], a[68:71]
ds_read_b64_tr_b16 v[214:215], v245 offset:15360
v_mfma_f32_16x16x32_bf16 a[68:71], v[192:195], v[168:171], a[68:71]
v_mfma_f32_16x16x32_bf16 a[72:75], v[192:195], v[176:179], a[72:75]
ds_read_b64_tr_b16 v[216:217], v246
v_mfma_f32_16x16x32_bf16 a[72:75], v[196:199], v[180:183], a[72:75]
ds_read_b64_tr_b16 v[218:219], v246 offset:5120
v_mfma_f32_16x16x32_bf16 a[76:79], v[196:199], v[188:191], a[76:79]
ds_read_b64_tr_b16 v[220:221], v246 offset:10240
v_mfma_f32_16x16x32_bf16 a[76:79], v[192:195], v[184:187], a[76:79]
s_waitcnt lgkmcnt(7)
ds_read_b64_tr_b16 v[222:223], v246 offset:15360
v_mfma_f32_16x16x32_bf16 a[80:83], v[200:203], v[160:163], a[80:83]
v_mfma_f32_16x16x32_bf16 a[80:83], v[204:207], v[164:167], a[80:83]
ds_read_b64_tr_b16 v[224:225], v245 offset:64
v_mfma_f32_16x16x32_bf16 a[84:87], v[204:207], v[172:175], a[84:87]
ds_read_b64_tr_b16 v[226:227], v245 offset:5184
v_mfma_f32_16x16x32_bf16 a[84:87], v[200:203], v[168:171], a[84:87]
ds_read_b64_tr_b16 v[228:229], v245 offset:10304
v_mfma_f32_16x16x32_bf16 a[88:91], v[200:203], v[176:179], a[88:91]
ds_read_b64_tr_b16 v[230:231], v245 offset:15424
v_mfma_f32_16x16x32_bf16 a[88:91], v[204:207], v[180:183], a[88:91]
v_mfma_f32_16x16x32_bf16 a[92:95], v[204:207], v[188:191], a[92:95]
s_waitcnt vmcnt(9)
v_mfma_f32_16x16x32_bf16 a[92:95], v[200:203], v[184:187], a[92:95]
s_waitcnt lgkmcnt(8)
v_mfma_f32_16x16x32_bf16 a[192:195], v[208:211], v[16:19], a[192:195]
s_lshl_b32 s64, s15, 4
s_add_u32 s64, s64, s52
ds_read_b64_tr_b16 v[232:233], v246 offset:64
v_mfma_f32_16x16x32_bf16 a[192:195], v[212:215], v[20:23], a[192:195]
s_mul_i32 s64, s64, 10240
s_add_u32 s64, s64, 62914560
buffer_load_dwordx2 v[58:59], v7, s[44:47], s66 offen
v_mfma_f32_16x16x32_bf16 a[196:199], v[212:215], v[28:31], a[196:199]
s_mul_i32 s74, s3, 40960
s_add_u32 s27, s64, s74
ds_read_b64_tr_b16 v[234:235], v246 offset:5184
v_mfma_f32_16x16x32_bf16 a[196:199], v[208:211], v[24:27], a[196:199]
s_add_u32 s18, s3, 1
s_and_b32 s18, s18, 3
s_mul_i32 s18, s18, 40960
v_mfma_f32_16x16x32_bf16 a[200:203], v[208:211], v[32:35], a[200:203]
s_add_u32 s18, s18, s64
ds_read_b64_tr_b16 v[236:237], v246 offset:10304
buffer_load_dwordx2 v[60:61], v7, s[44:47], s66 offen offset:32
v_mfma_f32_16x16x32_bf16 a[200:203], v[212:215], v[36:39], a[200:203]
s_add_u32 s18, s18, 5120
s_add_u32 s19, s3, 2
s_and_b32 s19, s19, 3
v_mfma_f32_16x16x32_bf16 a[204:207], v[212:215], v[44:47], a[204:207]
s_mul_i32 s19, s19, 40960
s_add_u32 s19, s19, s64
ds_read_b64_tr_b16 v[238:239], v246 offset:15424
v_mfma_f32_16x16x32_bf16 a[204:207], v[208:211], v[40:43], a[204:207]
s_waitcnt lgkmcnt(8)
s_add_u32 s19, s19, 2560
s_add_u32 s16, s3, 3
v_mfma_f32_16x16x32_bf16 a[208:211], v[216:219], v[16:19], a[208:211]
s_and_b32 s16, s16, 3
ds_read_b64_tr_b16 v[192:193], v245 offset:128
buffer_load_dwordx2 v[62:63], v7, s[44:47], s66 offen offset:64
v_mfma_f32_16x16x32_bf16 a[208:211], v[220:223], v[20:23], a[208:211]
v_accvgpr_read_b32 v130, a192
v_accvgpr_read_b32 v131, a193
v_accvgpr_read_b32 v132, a194
v_mfma_f32_16x16x32_bf16 a[212:215], v[220:223], v[28:31], a[212:215]
ds_read_b64_tr_b16 v[194:195], v245 offset:5248
v_accvgpr_read_b32 v133, a195
v_cvt_pk_bf16_f32 v134, v130, v131
v_mfma_f32_16x16x32_bf16 a[212:215], v[216:219], v[24:27], a[212:215]
buffer_load_dwordx2 v[64:65], v7, s[44:47], s66 offen offset:96
v_cvt_pk_bf16_f32 v135, v132, v133
v_accvgpr_read_b32 v130, a196
v_mfma_f32_16x16x32_bf16 a[216:219], v[216:219], v[32:35], a[216:219]
ds_read_b64_tr_b16 v[196:197], v245 offset:10368
v_accvgpr_read_b32 v131, a197
v_accvgpr_read_b32 v132, a198
v_mfma_f32_16x16x32_bf16 a[216:219], v[220:223], v[36:39], a[216:219]
v_accvgpr_read_b32 v133, a199
v_cvt_pk_bf16_f32 v136, v130, v131
v_cvt_pk_bf16_f32 v137, v132, v133
v_mfma_f32_16x16x32_bf16 a[220:223], v[220:223], v[44:47], a[220:223]
ds_read_b64_tr_b16 v[198:199], v245 offset:15488
ds_write_b128 v2, v[134:137]
v_accvgpr_read_b32 v138, a200
v_mfma_f32_16x16x32_bf16 a[220:223], v[216:219], v[40:43], a[220:223]
s_waitcnt lgkmcnt(9)
buffer_load_dwordx2 v[66:67], v7, s[44:47], s66 offen offset:128
v_accvgpr_read_b32 v139, a201
v_accvgpr_read_b32 v140, a202
v_mfma_f32_16x16x32_bf16 a[224:227], v[224:227], v[16:19], a[224:227]
ds_read_b64_tr_b16 v[200:201], v8
v_accvgpr_read_b32 v141, a203
v_cvt_pk_bf16_f32 v142, v138, v139
v_mfma_f32_16x16x32_bf16 a[224:227], v[228:231], v[20:23], a[224:227]
v_cvt_pk_bf16_f32 v143, v140, v141
v_accvgpr_read_b32 v138, a204
v_accvgpr_read_b32 v139, a205
v_mfma_f32_16x16x32_bf16 a[228:231], v[228:231], v[28:31], a[228:231]
ds_read_b64_tr_b16 v[202:203], v8 offset:5120
buffer_load_dwordx2 v[48:49], v5, s[28:31], s56 offen
v_accvgpr_read_b32 v140, a206
v_mfma_f32_16x16x32_bf16 a[228:231], v[224:227], v[24:27], a[228:231]
v_accvgpr_read_b32 v141, a207
v_cvt_pk_bf16_f32 v144, v138, v139
v_cvt_pk_bf16_f32 v145, v140, v141
v_mfma_f32_16x16x32_bf16 a[232:235], v[224:227], v[32:35], a[232:235]
ds_read_b64_tr_b16 v[204:205], v8 offset:10240
ds_write_b128 v2, v[142:145] offset:1024
v_accvgpr_read_b32 v130, a208
v_mfma_f32_16x16x32_bf16 a[232:235], v[228:231], v[36:39], a[232:235]
v_accvgpr_read_b32 v131, a209
v_accvgpr_read_b32 v132, a210
v_accvgpr_read_b32 v133, a211
v_mfma_f32_16x16x32_bf16 a[236:239], v[228:231], v[44:47], a[236:239]
ds_read_b64_tr_b16 v[206:207], v8 offset:15360
buffer_load_dwordx2 v[50:51], v5, s[28:31], s56 offen offset:32
v_cvt_pk_bf16_f32 v134, v130, v131
v_mfma_f32_16x16x32_bf16 a[236:239], v[224:227], v[40:43], a[236:239]
s_waitcnt lgkmcnt(10)
v_cvt_pk_bf16_f32 v135, v132, v133
v_accvgpr_read_b32 v130, a212
v_accvgpr_read_b32 v131, a213
v_mfma_f32_16x16x32_bf16 a[240:243], v[232:235], v[16:19], a[240:243]
ds_read_b64_tr_b16 v[208:209], v9
v_accvgpr_read_b32 v132, a214
v_accvgpr_read_b32 v133, a215
v_mfma_f32_16x16x32_bf16 a[240:243], v[236:239], v[20:23], a[240:243]
buffer_load_dwordx2 v[52:53], v5, s[28:31], s56 offen offset:64
v_cvt_pk_bf16_f32 v136, v130, v131
v_cvt_pk_bf16_f32 v137, v132, v133
v_mfma_f32_16x16x32_bf16 a[244:247], v[236:239], v[28:31], a[244:247]
ds_read_b64_tr_b16 v[210:211], v9 offset:5120
ds_write_b128 v2, v[134:137] offset:2048
v_accvgpr_read_b32 v138, a216
v_mfma_f32_16x16x32_bf16 a[244:247], v[232:235], v[24:27], a[244:247]
v_accvgpr_read_b32 v139, a217
v_accvgpr_read_b32 v140, a218
v_accvgpr_read_b32 v141, a219
v_mfma_f32_16x16x32_bf16 a[248:251], v[232:235], v[32:35], a[248:251]
ds_read_b64_tr_b16 v[212:213], v9 offset:10240
v_cvt_pk_bf16_f32 v142, v138, v139
v_cvt_pk_bf16_f32 v143, v140, v141
v_mfma_f32_16x16x32_bf16 a[248:251], v[236:239], v[36:39], a[248:251]
buffer_load_dwordx2 v[54:55], v5, s[28:31], s56 offen offset:96
v_accvgpr_read_b32 v138, a220
v_accvgpr_read_b32 v139, a221
v_mfma_f32_16x16x32_bf16 a[252:255], v[236:239], v[44:47], a[252:255]
ds_read_b64_tr_b16 v[214:215], v9 offset:15360
v_accvgpr_read_b32 v140, a222
v_accvgpr_read_b32 v141, a223
v_mfma_f32_16x16x32_bf16 a[252:255], v[232:235], v[40:43], a[252:255]
s_waitcnt lgkmcnt(11)
v_cvt_pk_bf16_f32 v144, v138, v139
v_cvt_pk_bf16_f32 v145, v140, v141
v_mfma_f32_16x16x32_bf16 a[0:3], v[192:195], v[16:19], a[0:3]
ds_read_b64_tr_b16 v[216:217], v8 offset:64
buffer_load_dwordx2 v[56:57], v5, s[28:31], s56 offen offset:128
ds_write_b128 v2, v[142:145] offset:3072
v_mfma_f32_16x16x32_bf16 a[0:3], v[196:199], v[20:23], a[0:3]
v_accvgpr_read_b32 v130, a224
v_accvgpr_read_b32 v131, a225
v_accvgpr_read_b32 v132, a226
v_mfma_f32_16x16x32_bf16 a[4:7], v[196:199], v[28:31], a[4:7]
ds_read_b64_tr_b16 v[218:219], v8 offset:5184
v_accvgpr_read_b32 v133, a227
v_cvt_pk_bf16_f32 v134, v130, v131
v_mfma_f32_16x16x32_bf16 a[4:7], v[192:195], v[24:27], a[4:7]
v_cvt_pk_bf16_f32 v135, v132, v133
v_accvgpr_read_b32 v130, a228
v_accvgpr_read_b32 v131, a229
v_mfma_f32_16x16x32_bf16 a[8:11], v[192:195], v[32:35], a[8:11]
ds_read_b64_tr_b16 v[220:221], v8 offset:10304
v_accvgpr_read_b32 v132, a230
v_accvgpr_read_b32 v133, a231
v_mfma_f32_16x16x32_bf16 a[8:11], v[196:199], v[36:39], a[8:11]
s_mul_i32 s16, s16, 40960
v_cvt_pk_bf16_f32 v136, v130, v131
v_cvt_pk_bf16_f32 v137, v132, v133
v_mfma_f32_16x16x32_bf16 a[12:15], v[196:199], v[44:47], a[12:15]
ds_read_b64_tr_b16 v[222:223], v8 offset:15424
ds_write_b128 v2, v[134:137] offset:4096
v_accvgpr_read_b32 v138, a232
v_mfma_f32_16x16x32_bf16 a[12:15], v[192:195], v[40:43], a[12:15]
s_waitcnt lgkmcnt(11)
v_accvgpr_read_b32 v139, a233
v_accvgpr_read_b32 v140, a234
v_accvgpr_read_b32 v141, a235
v_mfma_f32_16x16x32_bf16 a[16:19], v[200:203], v[16:19], a[16:19]
ds_read_b64_tr_b16 v[224:225], v9 offset:64
v_cvt_pk_bf16_f32 v142, v138, v139
v_cvt_pk_bf16_f32 v143, v140, v141
v_mfma_f32_16x16x32_bf16 a[16:19], v[204:207], v[20:23], a[16:19]
v_accvgpr_read_b32 v138, a236
v_accvgpr_read_b32 v139, a237
v_accvgpr_read_b32 v140, a238
v_mfma_f32_16x16x32_bf16 a[20:23], v[204:207], v[28:31], a[20:23]
ds_read_b64_tr_b16 v[226:227], v9 offset:5184
v_accvgpr_read_b32 v141, a239
v_cvt_pk_bf16_f32 v144, v138, v139
v_mfma_f32_16x16x32_bf16 a[20:23], v[200:203], v[24:27], a[20:23]
s_add_u32 s16, s16, s64
s_add_u32 s16, s16, 0
v_cvt_pk_bf16_f32 v145, v140, v141
v_min_u32 v6, 2, v0
v_mfma_f32_16x16x32_bf16 a[24:27], v[200:203], v[32:35], a[24:27]
ds_read_b64_tr_b16 v[228:229], v9 offset:10304
ds_write_b128 v2, v[142:145] offset:5120
v_accvgpr_read_b32 v130, a240
v_mfma_f32_16x16x32_bf16 a[24:27], v[204:207], v[36:39], a[24:27]
v_accvgpr_read_b32 v131, a241
v_accvgpr_read_b32 v132, a242
v_accvgpr_read_b32 v133, a243
v_mfma_f32_16x16x32_bf16 a[28:31], v[204:207], v[44:47], a[28:31]
ds_read_b64_tr_b16 v[230:231], v9 offset:15424
v_cvt_pk_bf16_f32 v134, v130, v131
v_cvt_pk_bf16_f32 v135, v132, v133
v_mfma_f32_16x16x32_bf16 a[28:31], v[200:203], v[40:43], a[28:31]
s_waitcnt lgkmcnt(11)
v_accvgpr_read_b32 v130, a244
v_accvgpr_read_b32 v131, a245
v_accvgpr_read_b32 v132, a246
v_mfma_f32_16x16x32_bf16 a[32:35], v[208:211], v[16:19], a[32:35]
ds_read_b64_tr_b16 v[232:233], v8 offset:128
v_accvgpr_read_b32 v133, a247
v_cvt_pk_bf16_f32 v136, v130, v131
v_mfma_f32_16x16x32_bf16 a[32:35], v[212:215], v[20:23], a[32:35]
v_cvt_pk_bf16_f32 v137, v132, v133
v_mul_u32_u24 v6, 2560, v6
v_add_u32 v6, 2556, v6
v_mfma_f32_16x16x32_bf16 a[36:39], v[212:215], v[28:31], a[36:39]
ds_read_b64_tr_b16 v[234:235], v8 offset:5248
ds_write_b128 v2, v[134:137] offset:6144
v_accvgpr_read_b32 v138, a248
v_mfma_f32_16x16x32_bf16 a[36:39], v[208:211], v[24:27], a[36:39]
v_accvgpr_read_b32 v139, a249
v_accvgpr_read_b32 v140, a250
v_accvgpr_read_b32 v141, a251
v_mfma_f32_16x16x32_bf16 a[40:43], v[208:211], v[32:35], a[40:43]
ds_read_b64_tr_b16 v[236:237], v8 offset:10368
v_cvt_pk_bf16_f32 v142, v138, v139
v_cvt_pk_bf16_f32 v143, v140, v141
v_mfma_f32_16x16x32_bf16 a[40:43], v[212:215], v[36:39], a[40:43]
v_accvgpr_read_b32 v138, a252
v_accvgpr_read_b32 v139, a253
v_accvgpr_read_b32 v140, a254
v_mfma_f32_16x16x32_bf16 a[44:47], v[212:215], v[44:47], a[44:47]
ds_read_b64_tr_b16 v[238:239], v8 offset:15488
v_accvgpr_read_b32 v141, a255
v_cvt_pk_bf16_f32 v144, v138, v139
v_mfma_f32_16x16x32_bf16 a[44:47], v[208:211], v[40:43], a[44:47]
s_waitcnt lgkmcnt(11)
s_add_u32 s25, s27, 2560
v_cvt_pk_bf16_f32 v145, v140, v141
v_mfma_f32_16x16x32_bf16 a[48:51], v[216:219], v[16:19], a[48:51]
ds_write_b128 v2, v[142:145] offset:7168
v_accvgpr_read_b32 v130, a0
v_accvgpr_read_b32 v131, a1
v_mfma_f32_16x16x32_bf16 a[48:51], v[220:223], v[20:23], a[48:51]
v_accvgpr_read_b32 v132, a2
v_accvgpr_read_b32 v133, a3
v_cvt_pk_bf16_f32 v134, v130, v131
v_mfma_f32_16x16x32_bf16 a[52:55], v[220:223], v[28:31], a[52:55]
v_cvt_pk_bf16_f32 v135, v132, v133
v_accvgpr_read_b32 v130, a4
v_accvgpr_read_b32 v131, a5
v_mfma_f32_16x16x32_bf16 a[52:55], v[216:219], v[24:27], a[52:55]
v_accvgpr_read_b32 v132, a6
v_accvgpr_read_b32 v133, a7
v_cvt_pk_bf16_f32 v136, v130, v131
v_mfma_f32_16x16x32_bf16 a[56:59], v[216:219], v[32:35], a[56:59]
s_add_u32 s24, s27, 5120
v_cvt_pk_bf16_f32 v137, v132, v133
v_mfma_f32_16x16x32_bf16 a[56:59], v[220:223], v[36:39], a[56:59]
ds_write_b128 v2, v[134:137] offset:8192
v_accvgpr_read_b32 v138, a8
v_accvgpr_read_b32 v139, a9
v_mfma_f32_16x16x32_bf16 a[60:63], v[220:223], v[44:47], a[60:63]
v_accvgpr_read_b32 v140, a10
v_accvgpr_read_b32 v141, a11
v_cvt_pk_bf16_f32 v142, v138, v139
v_mfma_f32_16x16x32_bf16 a[60:63], v[216:219], v[40:43], a[60:63]
s_waitcnt lgkmcnt(7)
v_cvt_pk_bf16_f32 v143, v140, v141
v_accvgpr_read_b32 v138, a12
v_accvgpr_read_b32 v139, a13
v_mfma_f32_16x16x32_bf16 a[64:67], v[224:227], v[16:19], a[64:67]
v_accvgpr_read_b32 v140, a14
v_accvgpr_read_b32 v141, a15
v_cvt_pk_bf16_f32 v144, v138, v139
v_mfma_f32_16x16x32_bf16 a[64:67], v[228:231], v[20:23], a[64:67]
v_cvt_pk_bf16_f32 v145, v140, v141
v_mfma_f32_16x16x32_bf16 a[68:71], v[228:231], v[28:31], a[68:71]
ds_write_b128 v2, v[142:145] offset:9216
v_mfma_f32_16x16x32_bf16 a[68:71], v[224:227], v[24:27], a[68:71]
v_mfma_f32_16x16x32_bf16 a[72:75], v[224:227], v[32:35], a[72:75]
v_mfma_f32_16x16x32_bf16 a[72:75], v[228:231], v[36:39], a[72:75]
v_mfma_f32_16x16x32_bf16 a[76:79], v[228:231], v[44:47], a[76:79]
v_mfma_f32_16x16x32_bf16 a[76:79], v[224:227], v[40:43], a[76:79]
s_waitcnt lgkmcnt(3)
v_mfma_f32_16x16x32_bf16 a[80:83], v[232:235], v[16:19], a[80:83]
s_waitcnt lgkmcnt(0)
s_barrier
v_mfma_f32_16x16x32_bf16 a[80:83], v[236:239], v[20:23], a[80:83]
ds_read_b128 v[160:163], v3
ds_read_b128 v[164:167], v3 offset:1024
v_mfma_f32_16x16x32_bf16 a[84:87], v[236:239], v[28:31], a[84:87]
ds_read_b128 v[168:171], v3 offset:2048
ds_read_b128 v[172:175], v3 offset:3072
v_mfma_f32_16x16x32_bf16 a[84:87], v[232:235], v[24:27], a[84:87]
ds_read_b128 v[176:179], v3 offset:4096
v_mfma_f32_16x16x32_bf16 a[88:91], v[232:235], v[32:35], a[88:91]
ds_read_b128 v[180:183], v3 offset:5120
ds_read_b128 v[184:187], v3 offset:6144
v_mfma_f32_16x16x32_bf16 a[88:91], v[236:239], v[36:39], a[88:91]
ds_read_b128 v[188:191], v3 offset:7168
ds_read_b128 v[192:195], v3 offset:8192
v_mfma_f32_16x16x32_bf16 a[92:95], v[236:239], v[44:47], a[92:95]
ds_read_b128 v[196:199], v3 offset:9216
v_mfma_f32_16x16x32_bf16 a[92:95], v[232:235], v[40:43], a[92:95]
s_waitcnt lgkmcnt(0)
s_nop 3
v_accvgpr_read_b32 v200, a20
v_accvgpr_read_b32 v201, a21
v_accvgpr_read_b32 v202, a22
v_accvgpr_read_b32 v203, a23
v_accvgpr_read_b32 v204, a36
v_accvgpr_read_b32 v205, a37
v_accvgpr_read_b32 v206, a38
v_accvgpr_read_b32 v207, a39
v_accvgpr_read_b32 v208, a52
v_accvgpr_read_b32 v209, a53
v_accvgpr_read_b32 v210, a54
v_accvgpr_read_b32 v211, a55
v_accvgpr_read_b32 v212, a68
v_accvgpr_read_b32 v213, a69
v_accvgpr_read_b32 v214, a70
v_accvgpr_read_b32 v215, a71
v_accvgpr_read_b32 v216, a84
v_accvgpr_read_b32 v217, a85
v_accvgpr_read_b32 v218, a86
v_accvgpr_read_b32 v219, a87
v_dot2_f32_bf16 v200, v162, s8, v200
v_dot2_f32_bf16 v201, v162, s9, v201
v_dot2_f32_bf16 v202, v163, s8, v202
v_dot2_f32_bf16 v203, v163, s9, v203
v_dot2_f32_bf16 v204, v170, s8, v204
v_dot2_f32_bf16 v205, v170, s9, v205
v_dot2_f32_bf16 v206, v171, s8, v206
v_dot2_f32_bf16 v207, v171, s9, v207
v_dot2_f32_bf16 v208, v178, s8, v208
v_dot2_f32_bf16 v209, v178, s9, v209
v_dot2_f32_bf16 v210, v179, s8, v210
v_dot2_f32_bf16 v211, v179, s9, v211
v_dot2_f32_bf16 v212, v186, s8, v212
v_dot2_f32_bf16 v213, v186, s9, v213
v_dot2_f32_bf16 v214, v187, s8, v214
v_dot2_f32_bf16 v215, v187, s9, v215
v_dot2_f32_bf16 v216, v194, s8, v216
v_dot2_f32_bf16 v217, v194, s9, v217
v_dot2_f32_bf16 v218, v195, s8, v218
v_dot2_f32_bf16 v219, v195, s9, v219
v_cvt_pk_bf16_f32 v16, v200, v201
v_cvt_pk_bf16_f32 v17, v202, v203
v_cvt_pk_bf16_f32 v18, v204, v205
v_cvt_pk_bf16_f32 v19, v206, v207
v_cvt_pk_bf16_f32 v20, v208, v209
v_cvt_pk_bf16_f32 v21, v210, v211
v_cvt_pk_bf16_f32 v22, v212, v213
v_cvt_pk_bf16_f32 v23, v214, v215
v_cvt_pk_bf16_f32 v24, v216, v217
v_cvt_pk_bf16_f32 v25, v218, v219
buffer_store_dwordx4 v[16:19], v4, s[20:23], s18 offen sc1
buffer_store_dwordx4 v[20:23], v4, s[20:23], s18 offen offset:1024 sc1
buffer_store_dwordx2 v[24:25], v1, s[20:23], s18 offen sc1
v_accvgpr_read_b32 v200, a24
v_accvgpr_read_b32 v201, a25
v_accvgpr_read_b32 v202, a26
v_accvgpr_read_b32 v203, a27
v_accvgpr_read_b32 v204, a40
v_accvgpr_read_b32 v205, a41
v_accvgpr_read_b32 v206, a42
v_accvgpr_read_b32 v207, a43
v_accvgpr_read_b32 v208, a56
v_accvgpr_read_b32 v209, a57
v_accvgpr_read_b32 v210, a58
v_accvgpr_read_b32 v211, a59
v_accvgpr_read_b32 v212, a72
v_accvgpr_read_b32 v213, a73
v_accvgpr_read_b32 v214, a74
v_accvgpr_read_b32 v215, a75
v_accvgpr_read_b32 v216, a88
v_accvgpr_read_b32 v217, a89
v_accvgpr_read_b32 v218, a90
v_accvgpr_read_b32 v219, a91
v_dot2_f32_bf16 v200, v164, s8, v200
v_dot2_f32_bf16 v201, v164, s9, v201
v_dot2_f32_bf16 v202, v165, s8, v202
v_dot2_f32_bf16 v203, v165, s9, v203
v_dot2_f32_bf16 v204, v172, s8, v204
v_dot2_f32_bf16 v205, v172, s9, v205
v_dot2_f32_bf16 v206, v173, s8, v206
v_dot2_f32_bf16 v207, v173, s9, v207
v_dot2_f32_bf16 v208, v180, s8, v208
v_dot2_f32_bf16 v209, v180, s9, v209
v_dot2_f32_bf16 v210, v181, s8, v210
v_dot2_f32_bf16 v211, v181, s9, v211
v_dot2_f32_bf16 v212, v188, s8, v212
v_dot2_f32_bf16 v213, v188, s9, v213
v_dot2_f32_bf16 v214, v189, s8, v214
v_dot2_f32_bf16 v215, v189, s9, v215
v_dot2_f32_bf16 v216, v196, s8, v216
v_dot2_f32_bf16 v217, v196, s9, v217
v_dot2_f32_bf16 v218, v197, s8, v218
v_dot2_f32_bf16 v219, v197, s9, v219
v_cvt_pk_bf16_f32 v26, v200, v201
v_cvt_pk_bf16_f32 v27, v202, v203
v_cvt_pk_bf16_f32 v28, v204, v205
v_cvt_pk_bf16_f32 v29, v206, v207
v_cvt_pk_bf16_f32 v30, v208, v209
v_cvt_pk_bf16_f32 v31, v210, v211
v_cvt_pk_bf16_f32 v32, v212, v213
v_cvt_pk_bf16_f32 v33, v214, v215
v_cvt_pk_bf16_f32 v34, v216, v217
v_cvt_pk_bf16_f32 v35, v218, v219
buffer_store_dwordx4 v[26:29], v4, s[20:23], s19 offen sc1
buffer_store_dwordx4 v[30:33], v4, s[20:23], s19 offen offset:1024 sc1
buffer_store_dwordx2 v[34:35], v1, s[20:23], s19 offen sc1
v_accvgpr_read_b32 v200, a28
v_accvgpr_read_b32 v201, a29
v_accvgpr_read_b32 v202, a30
v_accvgpr_read_b32 v203, a31
v_accvgpr_read_b32 v204, a44
v_accvgpr_read_b32 v205, a45
v_accvgpr_read_b32 v206, a46
v_accvgpr_read_b32 v207, a47
v_accvgpr_read_b32 v208, a60
v_accvgpr_read_b32 v209, a61
v_accvgpr_read_b32 v210, a62
v_accvgpr_read_b32 v211, a63
v_accvgpr_read_b32 v212, a76
v_accvgpr_read_b32 v213, a77
v_accvgpr_read_b32 v214, a78
v_accvgpr_read_b32 v215, a79
v_accvgpr_read_b32 v216, a92
v_accvgpr_read_b32 v217, a93
v_accvgpr_read_b32 v218, a94
v_accvgpr_read_b32 v219, a95
v_dot2_f32_bf16 v200, v166, s8, v200
v_dot2_f32_bf16 v201, v166, s9, v201
v_dot2_f32_bf16 v202, v167, s8, v202
v_dot2_f32_bf16 v203, v167, s9, v203
v_dot2_f32_bf16 v204, v174, s8, v204
v_dot2_f32_bf16 v205, v174, s9, v205
v_dot2_f32_bf16 v206, v175, s8, v206
v_dot2_f32_bf16 v207, v175, s9, v207
v_dot2_f32_bf16 v208, v182, s8, v208
v_dot2_f32_bf16 v209, v182, s9, v209
v_dot2_f32_bf16 v210, v183, s8, v210
v_dot2_f32_bf16 v211, v183, s9, v211
v_dot2_f32_bf16 v212, v190, s8, v212
v_dot2_f32_bf16 v213, v190, s9, v213
v_dot2_f32_bf16 v214, v191, s8, v214
v_dot2_f32_bf16 v215, v191, s9, v215
v_dot2_f32_bf16 v216, v198, s8, v216
v_dot2_f32_bf16 v217, v198, s9, v217
v_dot2_f32_bf16 v218, v199, s8, v218
v_dot2_f32_bf16 v219, v199, s9, v219
v_cvt_pk_bf16_f32 v36, v200, v201
v_cvt_pk_bf16_f32 v37, v202, v203
v_cvt_pk_bf16_f32 v38, v204, v205
v_cvt_pk_bf16_f32 v39, v206, v207
v_cvt_pk_bf16_f32 v40, v208, v209
v_cvt_pk_bf16_f32 v41, v210, v211
v_cvt_pk_bf16_f32 v42, v212, v213
v_cvt_pk_bf16_f32 v43, v214, v215
v_cvt_pk_bf16_f32 v44, v216, v217
v_cvt_pk_bf16_f32 v45, v218, v219
buffer_store_dwordx4 v[36:39], v4, s[20:23], s16 offen sc1
buffer_store_dwordx4 v[40:43], v4, s[20:23], s16 offen offset:1024 sc1
buffer_store_dwordx2 v[44:45], v1, s[20:23], s16 offen sc1
v_accvgpr_read_b32 v130, a16
v_accvgpr_read_b32 v131, a17
v_accvgpr_read_b32 v132, a18
v_accvgpr_read_b32 v133, a19
v_accvgpr_read_b32 v134, a32
v_accvgpr_read_b32 v135, a33
v_accvgpr_read_b32 v136, a34
v_accvgpr_read_b32 v137, a35
v_accvgpr_read_b32 v138, a48
v_accvgpr_read_b32 v139, a49
v_accvgpr_read_b32 v140, a50
v_accvgpr_read_b32 v141, a51
v_accvgpr_read_b32 v142, a64
v_accvgpr_read_b32 v143, a65
v_accvgpr_read_b32 v144, a66
v_accvgpr_read_b32 v145, a67
v_accvgpr_read_b32 v146, a80
v_accvgpr_read_b32 v147, a81
v_accvgpr_read_b32 v148, a82
v_accvgpr_read_b32 v149, a83
v_dot2_f32_bf16 v130, v160, s8, v130
v_dot2_f32_bf16 v131, v160, s9, v131
v_dot2_f32_bf16 v132, v161, s8, v132
v_dot2_f32_bf16 v133, v161, s9, v133
v_dot2_f32_bf16 v134, v168, s8, v134
v_dot2_f32_bf16 v135, v168, s9, v135
v_dot2_f32_bf16 v136, v169, s8, v136
v_dot2_f32_bf16 v137, v169, s9, v137
v_dot2_f32_bf16 v138, v176, s8, v138
v_dot2_f32_bf16 v139, v176, s9, v139
v_dot2_f32_bf16 v140, v177, s8, v140
v_dot2_f32_bf16 v141, v177, s9, v141
v_dot2_f32_bf16 v142, v184, s8, v142
v_dot2_f32_bf16 v143, v184, s9, v143
v_dot2_f32_bf16 v144, v185, s8, v144
v_dot2_f32_bf16 v145, v185, s9, v145
v_dot2_f32_bf16 v146, v192, s8, v146
v_dot2_f32_bf16 v147, v192, s9, v147
v_dot2_f32_bf16 v148, v193, s8, v148
v_dot2_f32_bf16 v149, v193, s9, v149
s_waitcnt vmcnt(9)
s_mov_b32 s66, 0x3f80
s_mov_b32 s67, 0x3f800000
v_dot2_f32_bf16 v80, v100, s66, v80
v_dot2_f32_bf16 v81, v100, s67, v81
v_dot2_f32_bf16 v82, v101, s66, v82
v_dot2_f32_bf16 v83, v101, s67, v83
v_dot2_f32_bf16 v84, v102, s66, v84
v_dot2_f32_bf16 v85, v102, s67, v85
v_dot2_f32_bf16 v86, v103, s66, v86
v_dot2_f32_bf16 v87, v103, s67, v87
v_dot2_f32_bf16 v88, v104, s66, v88
v_dot2_f32_bf16 v89, v104, s67, v89
v_dot2_f32_bf16 v90, v105, s66, v90
v_dot2_f32_bf16 v91, v105, s67, v91
v_dot2_f32_bf16 v92, v106, s66, v92
v_dot2_f32_bf16 v93, v106, s67, v93
v_dot2_f32_bf16 v94, v107, s66, v94
v_dot2_f32_bf16 v95, v107, s67, v95
v_dot2_f32_bf16 v96, v108, s66, v96
v_dot2_f32_bf16 v97, v108, s67, v97
v_dot2_f32_bf16 v98, v109, s66, v98
v_dot2_f32_bf16 v99, v109, s67, v99
v_dot2_f32_bf16 v80, v110, s66, v80
v_dot2_f32_bf16 v81, v110, s67, v81
v_dot2_f32_bf16 v82, v111, s66, v82
v_dot2_f32_bf16 v83, v111, s67, v83
v_dot2_f32_bf16 v84, v112, s66, v84
v_dot2_f32_bf16 v85, v112, s67, v85
v_dot2_f32_bf16 v86, v113, s66, v86
v_dot2_f32_bf16 v87, v113, s67, v87
v_dot2_f32_bf16 v88, v114, s66, v88
v_dot2_f32_bf16 v89, v114, s67, v89
v_dot2_f32_bf16 v90, v115, s66, v90
v_dot2_f32_bf16 v91, v115, s67, v91
v_dot2_f32_bf16 v92, v116, s66, v92
v_dot2_f32_bf16 v93, v116, s67, v93
v_dot2_f32_bf16 v94, v117, s66, v94
v_dot2_f32_bf16 v95, v117, s67, v95
v_dot2_f32_bf16 v96, v118, s66, v96
v_dot2_f32_bf16 v97, v118, s67, v97
v_dot2_f32_bf16 v98, v119, s66, v98
v_dot2_f32_bf16 v99, v119, s67, v99
v_dot2_f32_bf16 v80, v120, s66, v80
v_dot2_f32_bf16 v81, v120, s67, v81
v_dot2_f32_bf16 v82, v121, s66, v82
v_dot2_f32_bf16 v83, v121, s67, v83
v_dot2_f32_bf16 v84, v122, s66, v84
v_dot2_f32_bf16 v85, v122, s67, v85
v_dot2_f32_bf16 v86, v123, s66, v86
v_dot2_f32_bf16 v87, v123, s67, v87
v_dot2_f32_bf16 v88, v124, s66, v88
v_dot2_f32_bf16 v89, v124, s67, v89
v_dot2_f32_bf16 v90, v125, s66, v90
v_dot2_f32_bf16 v91, v125, s67, v91
v_dot2_f32_bf16 v92, v126, s66, v92
v_dot2_f32_bf16 v93, v126, s67, v93
v_dot2_f32_bf16 v94, v127, s66, v94
v_dot2_f32_bf16 v95, v127, s67, v95
v_dot2_f32_bf16 v96, v128, s66, v96
v_dot2_f32_bf16 v97, v128, s67, v97
v_dot2_f32_bf16 v98, v129, s66, v98
v_dot2_f32_bf16 v99, v129, s67, v99
v_dot2_f32_bf16 v80, v58, s66, v80
v_dot2_f32_bf16 v81, v58, s67, v81
v_dot2_f32_bf16 v82, v59, s66, v82
v_dot2_f32_bf16 v83, v59, s67, v83
v_dot2_f32_bf16 v84, v60, s66, v84
v_dot2_f32_bf16 v85, v60, s67, v85
v_dot2_f32_bf16 v86, v61, s66, v86
v_dot2_f32_bf16 v87, v61, s67, v87
v_dot2_f32_bf16 v88, v62, s66, v88
v_dot2_f32_bf16 v89, v62, s67, v89
v_dot2_f32_bf16 v90, v63, s66, v90
v_dot2_f32_bf16 v91, v63, s67, v91
v_dot2_f32_bf16 v92, v64, s66, v92
v_dot2_f32_bf16 v93, v64, s67, v93
v_dot2_f32_bf16 v94, v65, s66, v94
v_dot2_f32_bf16 v95, v65, s67, v95
v_dot2_f32_bf16 v96, v66, s66, v96
v_dot2_f32_bf16 v97, v66, s67, v97
v_dot2_f32_bf16 v98, v67, s66, v98
v_dot2_f32_bf16 v99, v67, s67, v99
buffer_load_dwordx4 v[200:203], v4, s[20:23], s27 offen sc1
buffer_load_dwordx4 v[204:207], v4, s[20:23], s27 offen offset:1024 sc1
buffer_load_dwordx2 v[208:209], v1, s[20:23], s27 offen sc1
buffer_load_dwordx4 v[210:213], v4, s[20:23], s25 offen sc1
buffer_load_dwordx4 v[214:217], v4, s[20:23], s25 offen offset:1024 sc1
buffer_load_dwordx2 v[218:219], v1, s[20:23], s25 offen sc1
buffer_load_dwordx4 v[220:223], v4, s[20:23], s24 offen sc1
buffer_load_dwordx4 v[224:227], v4, s[20:23], s24 offen offset:1024 sc1
buffer_load_dwordx2 v[228:229], v1, s[20:23], s24 offen sc1
v_mul_f32 v160, 0xbfb8aa3b, v80
v_mul_f32 v161, 0xbfb8aa3b, v81
v_mul_f32 v162, 0xbfb8aa3b, v82
v_mul_f32 v163, 0xbfb8aa3b, v83
v_exp_f32 v160, v160
v_exp_f32 v161, v161
v_exp_f32 v162, v162
v_exp_f32 v163, v163
v_add_f32 v160, 1.0, v160
v_add_f32 v161, 1.0, v161
v_add_f32 v162, 1.0, v162
v_add_f32 v163, 1.0, v163
v_rcp_f32 v160, v160
v_rcp_f32 v161, v161
v_rcp_f32 v162, v162
v_rcp_f32 v163, v163
v_mul_f32 v80, v80, v160
v_mul_f32 v81, v81, v161
v_mul_f32 v82, v82, v162
v_mul_f32 v83, v83, v163
v_lshlrev_b32 v160, 16, v48
v_and_b32 v161, 0xffff0000, v48
v_lshlrev_b32 v162, 16, v49
v_and_b32 v163, 0xffff0000, v49
v_mul_f32 v164, 0xbfb8aa3b, v84
v_mul_f32 v165, 0xbfb8aa3b, v85
v_mul_f32 v166, 0xbfb8aa3b, v86
v_mul_f32 v167, 0xbfb8aa3b, v87
v_exp_f32 v164, v164
v_exp_f32 v165, v165
v_exp_f32 v166, v166
v_exp_f32 v167, v167
v_add_f32 v164, 1.0, v164
v_add_f32 v165, 1.0, v165
v_add_f32 v166, 1.0, v166
v_add_f32 v167, 1.0, v167
v_rcp_f32 v164, v164
v_rcp_f32 v165, v165
v_rcp_f32 v166, v166
v_rcp_f32 v167, v167
v_mul_f32 v84, v84, v164
v_mul_f32 v85, v85, v165
v_mul_f32 v86, v86, v166
v_mul_f32 v87, v87, v167
v_lshlrev_b32 v164, 16, v50
v_and_b32 v165, 0xffff0000, v50
v_lshlrev_b32 v166, 16, v51
v_and_b32 v167, 0xffff0000, v51
v_mul_f32 v168, 0xbfb8aa3b, v88
v_mul_f32 v169, 0xbfb8aa3b, v89
v_mul_f32 v170, 0xbfb8aa3b, v90
v_mul_f32 v171, 0xbfb8aa3b, v91
v_exp_f32 v168, v168
v_exp_f32 v169, v169
v_exp_f32 v170, v170
v_exp_f32 v171, v171
v_add_f32 v168, 1.0, v168
v_add_f32 v169, 1.0, v169
v_add_f32 v170, 1.0, v170
v_add_f32 v171, 1.0, v171
v_rcp_f32 v168, v168
v_rcp_f32 v169, v169
v_rcp_f32 v170, v170
v_rcp_f32 v171, v171
v_mul_f32 v88, v88, v168
v_mul_f32 v89, v89, v169
v_mul_f32 v90, v90, v170
v_mul_f32 v91, v91, v171
v_lshlrev_b32 v168, 16, v52
v_and_b32 v169, 0xffff0000, v52
v_lshlrev_b32 v170, 16, v53
v_and_b32 v171, 0xffff0000, v53
v_mul_f32 v172, 0xbfb8aa3b, v92
v_mul_f32 v173, 0xbfb8aa3b, v93
v_mul_f32 v174, 0xbfb8aa3b, v94
v_mul_f32 v175, 0xbfb8aa3b, v95
v_exp_f32 v172, v172
v_exp_f32 v173, v173
v_exp_f32 v174, v174
v_exp_f32 v175, v175
v_add_f32 v172, 1.0, v172
v_add_f32 v173, 1.0, v173
v_add_f32 v174, 1.0, v174
v_add_f32 v175, 1.0, v175
v_rcp_f32 v172, v172
v_rcp_f32 v173, v173
v_rcp_f32 v174, v174
v_rcp_f32 v175, v175
v_mul_f32 v92, v92, v172
v_mul_f32 v93, v93, v173
v_mul_f32 v94, v94, v174
v_mul_f32 v95, v95, v175
v_lshlrev_b32 v172, 16, v54
v_and_b32 v173, 0xffff0000, v54
v_lshlrev_b32 v174, 16, v55
v_and_b32 v175, 0xffff0000, v55
v_mul_f32 v176, 0xbfb8aa3b, v96
v_mul_f32 v177, 0xbfb8aa3b, v97
v_mul_f32 v178, 0xbfb8aa3b, v98
v_mul_f32 v179, 0xbfb8aa3b, v99
v_exp_f32 v176, v176
v_exp_f32 v177, v177
v_exp_f32 v178, v178
v_exp_f32 v179, v179
v_add_f32 v176, 1.0, v176
v_add_f32 v177, 1.0, v177
v_add_f32 v178, 1.0, v178
v_add_f32 v179, 1.0, v179
v_rcp_f32 v176, v176
v_rcp_f32 v177, v177
v_rcp_f32 v178, v178
v_rcp_f32 v179, v179
v_mul_f32 v96, v96, v176
v_mul_f32 v97, v97, v177
v_mul_f32 v98, v98, v178
v_mul_f32 v99, v99, v179
v_lshlrev_b32 v176, 16, v56
v_and_b32 v177, 0xffff0000, v56
v_lshlrev_b32 v178, 16, v57
v_and_b32 v179, 0xffff0000, v57
s_mov_b32 s14, 262144
L_x2:
s_waitcnt vmcnt(6)
v_dot2_f32_bf16 v180, v200, s66, v130
v_dot2_f32_bf16 v181, v200, s67, v131
v_dot2_f32_bf16 v182, v201, s66, v132
v_dot2_f32_bf16 v183, v201, s67, v133
v_dot2_f32_bf16 v184, v202, s66, v134
v_dot2_f32_bf16 v185, v202, s67, v135
v_dot2_f32_bf16 v186, v203, s66, v136
v_dot2_f32_bf16 v187, v203, s67, v137
v_dot2_f32_bf16 v188, v204, s66, v138
v_dot2_f32_bf16 v189, v204, s67, v139
v_dot2_f32_bf16 v190, v205, s66, v140
v_dot2_f32_bf16 v191, v205, s67, v141
v_dot2_f32_bf16 v192, v206, s66, v142
v_dot2_f32_bf16 v193, v206, s67, v143
v_dot2_f32_bf16 v194, v207, s66, v144
v_dot2_f32_bf16 v195, v207, s67, v145
v_dot2_f32_bf16 v196, v208, s66, v146
v_dot2_f32_bf16 v197, v208, s67, v147
v_dot2_f32_bf16 v198, v209, s66, v148
v_dot2_f32_bf16 v199, v209, s67, v149
s_waitcnt vmcnt(3)
v_dot2_f32_bf16 v180, v210, s66, v180
v_dot2_f32_bf16 v181, v210, s67, v181
v_dot2_f32_bf16 v182, v211, s66, v182
v_dot2_f32_bf16 v183, v211, s67, v183
v_dot2_f32_bf16 v184, v212, s66, v184
v_dot2_f32_bf16 v185, v212, s67, v185
v_dot2_f32_bf16 v186, v213, s66, v186
v_dot2_f32_bf16 v187, v213, s67, v187
v_dot2_f32_bf16 v188, v214, s66, v188
v_dot2_f32_bf16 v189, v214, s67, v189
v_dot2_f32_bf16 v190, v215, s66, v190
v_dot2_f32_bf16 v191, v215, s67, v191
v_dot2_f32_bf16 v192, v216, s66, v192
v_dot2_f32_bf16 v193, v216, s67, v193
v_dot2_f32_bf16 v194, v217, s66, v194
v_dot2_f32_bf16 v195, v217, s67, v195
v_dot2_f32_bf16 v196, v218, s66, v196
v_dot2_f32_bf16 v197, v218, s67, v197
v_dot2_f32_bf16 v198, v219, s66, v198
v_dot2_f32_bf16 v199, v219, s67, v199
s_waitcnt vmcnt(0)
v_dot2_f32_bf16 v180, v220, s66, v180
v_dot2_f32_bf16 v181, v220, s67, v181
v_dot2_f32_bf16 v182, v221, s66, v182
v_dot2_f32_bf16 v183, v221, s67, v183
v_dot2_f32_bf16 v184, v222, s66, v184
v_dot2_f32_bf16 v185, v222, s67, v185
v_dot2_f32_bf16 v186, v223, s66, v186
v_dot2_f32_bf16 v187, v223, s67, v187
v_dot2_f32_bf16 v188, v224, s66, v188
v_dot2_f32_bf16 v189, v224, s67, v189
v_dot2_f32_bf16 v190, v225, s66, v190
v_dot2_f32_bf16 v191, v225, s67, v191
v_dot2_f32_bf16 v192, v226, s66, v192
v_dot2_f32_bf16 v193, v226, s67, v193
v_dot2_f32_bf16 v194, v227, s66, v194
v_dot2_f32_bf16 v195, v227, s67, v195
v_dot2_f32_bf16 v196, v228, s66, v196
v_dot2_f32_bf16 v197, v228, s67, v197
v_dot2_f32_bf16 v198, v229, s66, v198
v_dot2_f32_bf16 v199, v229, s67, v199
v_cmp_u_f32 vcc, v180, v181
v_cmp_u_f32 s[64:65], v182, v183
s_nop 0
s_or_b64 vcc, vcc, s[64:65]
v_cmp_u_f32 s[64:65], v184, v185
s_nop 0
s_or_b64 vcc, vcc, s[64:65]
v_cmp_u_f32 s[64:65], v186, v187
s_nop 0
s_or_b64 vcc, vcc, s[64:65]
v_cmp_u_f32 s[64:65], v188, v189
s_nop 0
s_or_b64 vcc, vcc, s[64:65]
v_cmp_u_f32 s[64:65], v190, v191
s_nop 0
s_or_b64 vcc, vcc, s[64:65]
v_cmp_u_f32 s[64:65], v192, v193
s_nop 0
s_or_b64 vcc, vcc, s[64:65]
v_cmp_u_f32 s[64:65], v194, v195
s_nop 0
s_or_b64 vcc, vcc, s[64:65]
v_cmp_u_f32 s[64:65], v196, v197
s_nop 0
s_or_b64 vcc, vcc, s[64:65]
v_cmp_u_f32 s[64:65], v198, v199
s_nop 0
s_or_b64 vcc, vcc, s[64:65]
s_cmp_lg_u64 vcc, 0
s_cbranch_scc1 L_o4
L_o4_r:
v_pk_fma_f32 v[180:181], v[180:181], v[80:81], v[160:161]
v_pk_fma_f32 v[182:183], v[182:183], v[82:83], v[162:163]
v_cvt_pk_bf16_f32 v130, v180, v181
v_cvt_pk_bf16_f32 v131, v182, v183
buffer_store_dwordx2 v[130:131], v5, s[36:39], s56 offen
v_pk_fma_f32 v[184:185], v[184:185], v[84:85], v[164:165]
v_pk_fma_f32 v[186:187], v[186:187], v[86:87], v[166:167]
v_cvt_pk_bf16_f32 v134, v184, v185
v_cvt_pk_bf16_f32 v135, v186, v187
buffer_store_dwordx2 v[134:135], v5, s[36:39], s56 offen offset:32
v_pk_fma_f32 v[188:189], v[188:189], v[88:89], v[168:169]
v_pk_fma_f32 v[190:191], v[190:191], v[90:91], v[170:171]
v_cvt_pk_bf16_f32 v138, v188, v189
v_cvt_pk_bf16_f32 v139, v190, v191
buffer_store_dwordx2 v[138:139], v5, s[36:39], s56 offen offset:64
v_pk_fma_f32 v[192:193], v[192:193], v[92:93], v[172:173]
v_pk_fma_f32 v[194:195], v[194:195], v[94:95], v[174:175]
v_cvt_pk_bf16_f32 v142, v192, v193
v_cvt_pk_bf16_f32 v143, v194, v195
buffer_store_dwordx2 v[142:143], v5, s[36:39], s56 offen offset:96
v_pk_fma_f32 v[196:197], v[196:197], v[96:97], v[176:177]
v_pk_fma_f32 v[198:199], v[198:199], v[98:99], v[178:179]
v_cvt_pk_bf16_f32 v146, v196, v197
v_cvt_pk_bf16_f32 v147, v198, v199
buffer_store_dwordx2 v[146:147], v5, s[36:39], s56 offen offset:128
L_done:
s_endpgm
L_o1:
s_mov_b32 s74, 262144
L_ph:
buffer_load_dwordx2 v[14:15], v253, s[20:23], s14 offen sc1
s_waitcnt vmcnt(0)
v_cmp_ne_u32 vcc, s70, v14
v_cmp_ne_u32 s[64:65], s71, v15
s_nop 0
s_or_b32 s64, vcc_lo, s64
s_and_b32 s64, s64, s60
s_cmp_lg_u32 s64, 0
s_cbranch_scc0 L_ph_ok
s_sleep 8
s_sub_u32 s74, s74, 1
s_cmp_lg_u32 s74, 0
s_cbranch_scc1 L_ph
L_ph_ok:
s_branch L_o1_r
L_o2:
s_add_u32 s62, s61, 81920
s_add_u32 s59, s58, 20480
s_add_u32 m0, s62, 0
s_nop 0
buffer_load_dwordx4 v240, s[40:43], s58 offen lds
buffer_load_dwordx4 v241, s[40:43], s58 offen offset:1024 lds
buffer_load_dwordx4 v242, s[40:43], s58 offen offset:2048 lds
buffer_load_dwordx4 v243, s[40:43], s58 offen offset:3072 lds
s_add_u32 m0, s62, 4096
s_nop 0
buffer_load_dwordx4 v244, s[40:43], s58 offen lds
s_add_u32 m0, s62, 5120
s_nop 0
buffer_load_dwordx4 v240, s[40:43], s59 offen lds
buffer_load_dwordx4 v241, s[40:43], s59 offen offset:1024 lds
buffer_load_dwordx4 v242, s[40:43], s59 offen offset:2048 lds
buffer_load_dwordx4 v243, s[40:43], s59 offen offset:3072 lds
s_add_u32 m0, s62, 9216
s_nop 0
buffer_load_dwordx4 v244, s[40:43], s59 offen lds
s_add_u32 s58, s58, 81920
v_accvgpr_read_b32 v140, a20
v_accvgpr_read_b32 v141, a21
v_accvgpr_read_b32 v142, a22
v_accvgpr_read_b32 v143, a23
v_accvgpr_read_b32 v144, a36
v_accvgpr_read_b32 v145, a37
v_accvgpr_read_b32 v146, a38
v_accvgpr_read_b32 v147, a39
v_accvgpr_read_b32 v148, a52
v_accvgpr_read_b32 v149, a53
v_accvgpr_read_b32 v150, a54
v_accvgpr_read_b32 v151, a55
v_accvgpr_read_b32 v152, a68
v_accvgpr_read_b32 v153, a69
v_accvgpr_read_b32 v154, a70
v_accvgpr_read_b32 v155, a71
v_accvgpr_read_b32 v156, a84
v_accvgpr_read_b32 v157, a85
v_accvgpr_read_b32 v158, a86
v_accvgpr_read_b32 v159, a87
v_dot2_f32_bf16 v140, v18, s8, v140
v_dot2_f32_bf16 v141, v18, s9, v141
v_dot2_f32_bf16 v142, v19, s8, v142
v_dot2_f32_bf16 v143, v19, s9, v143
v_dot2_f32_bf16 v144, v26, s8, v144
v_dot2_f32_bf16 v145, v26, s9, v145
v_dot2_f32_bf16 v146, v27, s8, v146
v_dot2_f32_bf16 v147, v27, s9, v147
v_dot2_f32_bf16 v148, v34, s8, v148
v_dot2_f32_bf16 v149, v34, s9, v149
v_dot2_f32_bf16 v150, v35, s8, v150
v_dot2_f32_bf16 v151, v35, s9, v151
v_dot2_f32_bf16 v152, v42, s8, v152
v_dot2_f32_bf16 v153, v42, s9, v153
v_dot2_f32_bf16 v154, v43, s8, v154
v_dot2_f32_bf16 v155, v43, s9, v155
v_dot2_f32_bf16 v156, v132, s8, v156
v_dot2_f32_bf16 v157, v132, s9, v157
v_dot2_f32_bf16 v158, v133, s8, v158
v_dot2_f32_bf16 v159, v133, s9, v159
v_cvt_pk_bf16_f32 v100, v140, v141
v_cvt_pk_bf16_f32 v101, v142, v143
v_cvt_pk_bf16_f32 v102, v144, v145
v_cvt_pk_bf16_f32 v103, v146, v147
v_cvt_pk_bf16_f32 v104, v148, v149
v_cvt_pk_bf16_f32 v105, v150, v151
v_cvt_pk_bf16_f32 v106, v152, v153
v_cvt_pk_bf16_f32 v107, v154, v155
v_cvt_pk_bf16_f32 v108, v156, v157
v_cvt_pk_bf16_f32 v109, v158, v159
v_accvgpr_read_b32 v140, a24
v_accvgpr_read_b32 v141, a25
v_accvgpr_read_b32 v142, a26
v_accvgpr_read_b32 v143, a27
v_accvgpr_read_b32 v144, a40
v_accvgpr_read_b32 v145, a41
v_accvgpr_read_b32 v146, a42
v_accvgpr_read_b32 v147, a43
v_accvgpr_read_b32 v148, a56
v_accvgpr_read_b32 v149, a57
v_accvgpr_read_b32 v150, a58
v_accvgpr_read_b32 v151, a59
v_accvgpr_read_b32 v152, a72
v_accvgpr_read_b32 v153, a73
v_accvgpr_read_b32 v154, a74
v_accvgpr_read_b32 v155, a75
v_accvgpr_read_b32 v156, a88
v_accvgpr_read_b32 v157, a89
v_accvgpr_read_b32 v158, a90
v_accvgpr_read_b32 v159, a91
v_dot2_f32_bf16 v140, v20, s8, v140
v_dot2_f32_bf16 v141, v20, s9, v141
v_dot2_f32_bf16 v142, v21, s8, v142
v_dot2_f32_bf16 v143, v21, s9, v143
v_dot2_f32_bf16 v144, v28, s8, v144
v_dot2_f32_bf16 v145, v28, s9, v145
v_dot2_f32_bf16 v146, v29, s8, v146
v_dot2_f32_bf16 v147, v29, s9, v147
v_dot2_f32_bf16 v148, v36, s8, v148
v_dot2_f32_bf16 v149, v36, s9, v149
v_dot2_f32_bf16 v150, v37, s8, v150
v_dot2_f32_bf16 v151, v37, s9, v151
v_dot2_f32_bf16 v152, v44, s8, v152
v_dot2_f32_bf16 v153, v44, s9, v153
v_dot2_f32_bf16 v154, v45, s8, v154
v_dot2_f32_bf16 v155, v45, s9, v155
v_dot2_f32_bf16 v156, v134, s8, v156
v_dot2_f32_bf16 v157, v134, s9, v157
v_dot2_f32_bf16 v158, v135, s8, v158
v_dot2_f32_bf16 v159, v135, s9, v159
v_cvt_pk_bf16_f32 v110, v140, v141
v_cvt_pk_bf16_f32 v111, v142, v143
v_cvt_pk_bf16_f32 v112, v144, v145
v_cvt_pk_bf16_f32 v113, v146, v147
v_cvt_pk_bf16_f32 v114, v148, v149
v_cvt_pk_bf16_f32 v115, v150, v151
v_cvt_pk_bf16_f32 v116, v152, v153
v_cvt_pk_bf16_f32 v117, v154, v155
v_cvt_pk_bf16_f32 v118, v156, v157
v_cvt_pk_bf16_f32 v119, v158, v159
v_accvgpr_read_b32 v140, a28
v_accvgpr_read_b32 v141, a29
v_accvgpr_read_b32 v142, a30
v_accvgpr_read_b32 v143, a31
v_accvgpr_read_b32 v144, a44
v_accvgpr_read_b32 v145, a45
v_accvgpr_read_b32 v146, a46
v_accvgpr_read_b32 v147, a47
v_accvgpr_read_b32 v148, a60
v_accvgpr_read_b32 v149, a61
v_accvgpr_read_b32 v150, a62
v_accvgpr_read_b32 v151, a63
v_accvgpr_read_b32 v152, a76
v_accvgpr_read_b32 v153, a77
v_accvgpr_read_b32 v154, a78
v_accvgpr_read_b32 v155, a79
v_accvgpr_read_b32 v156, a92
v_accvgpr_read_b32 v157, a93
v_accvgpr_read_b32 v158, a94
v_accvgpr_read_b32 v159, a95
v_dot2_f32_bf16 v140, v22, s8, v140
v_dot2_f32_bf16 v141, v22, s9, v141
v_dot2_f32_bf16 v142, v23, s8, v142
v_dot2_f32_bf16 v143, v23, s9, v143
v_dot2_f32_bf16 v144, v30, s8, v144
v_dot2_f32_bf16 v145, v30, s9, v145
v_dot2_f32_bf16 v146, v31, s8, v146
v_dot2_f32_bf16 v147, v31, s9, v147
v_dot2_f32_bf16 v148, v38, s8, v148
v_dot2_f32_bf16 v149, v38, s9, v149
v_dot2_f32_bf16 v150, v39, s8, v150
v_dot2_f32_bf16 v151, v39, s9, v151
v_dot2_f32_bf16 v152, v46, s8, v152
v_dot2_f32_bf16 v153, v46, s9, v153
v_dot2_f32_bf16 v154, v47, s8, v154
v_dot2_f32_bf16 v155, v47, s9, v155
v_dot2_f32_bf16 v156, v136, s8, v156
v_dot2_f32_bf16 v157, v136, s9, v157
v_dot2_f32_bf16 v158, v137, s8, v158
v_dot2_f32_bf16 v159, v137, s9, v159
v_cvt_pk_bf16_f32 v120, v140, v141
v_cvt_pk_bf16_f32 v121, v142, v143
v_cvt_pk_bf16_f32 v122, v144, v145
v_cvt_pk_bf16_f32 v123, v146, v147
v_cvt_pk_bf16_f32 v124, v148, v149
v_cvt_pk_bf16_f32 v125, v150, v151
v_cvt_pk_bf16_f32 v126, v152, v153
v_cvt_pk_bf16_f32 v127, v154, v155
v_cvt_pk_bf16_f32 v128, v156, v157
v_cvt_pk_bf16_f32 v129, v158, v159
v_accvgpr_read_b32 v80, a16
v_accvgpr_read_b32 v81, a17
v_accvgpr_read_b32 v82, a18
v_accvgpr_read_b32 v83, a19
v_accvgpr_read_b32 v84, a32
v_accvgpr_read_b32 v85, a33
v_accvgpr_read_b32 v86, a34
v_accvgpr_read_b32 v87, a35
v_accvgpr_read_b32 v88, a48
v_accvgpr_read_b32 v89, a49
v_accvgpr_read_b32 v90, a50
v_accvgpr_read_b32 v91, a51
v_accvgpr_read_b32 v92, a64
v_accvgpr_read_b32 v93, a65
v_accvgpr_read_b32 v94, a66
v_accvgpr_read_b32 v95, a67
v_accvgpr_read_b32 v96, a80
v_accvgpr_read_b32 v97, a81
v_accvgpr_read_b32 v98, a82
v_accvgpr_read_b32 v99, a83
v_dot2_f32_bf16 v80, v16, s8, v80
v_dot2_f32_bf16 v81, v16, s9, v81
v_dot2_f32_bf16 v82, v17, s8, v82
v_dot2_f32_bf16 v83, v17, s9, v83
v_dot2_f32_bf16 v84, v24, s8, v84
v_dot2_f32_bf16 v85, v24, s9, v85
v_dot2_f32_bf16 v86, v25, s8, v86
v_dot2_f32_bf16 v87, v25, s9, v87
v_dot2_f32_bf16 v88, v32, s8, v88
v_dot2_f32_bf16 v89, v32, s9, v89
v_dot2_f32_bf16 v90, v33, s8, v90
v_dot2_f32_bf16 v91, v33, s9, v91
v_dot2_f32_bf16 v92, v40, s8, v92
v_dot2_f32_bf16 v93, v40, s9, v93
v_dot2_f32_bf16 v94, v41, s8, v94
v_dot2_f32_bf16 v95, v41, s9, v95
v_dot2_f32_bf16 v96, v130, s8, v96
v_dot2_f32_bf16 v97, v130, s9, v97
v_dot2_f32_bf16 v98, v131, s8, v98
v_dot2_f32_bf16 v99, v131, s9, v99
s_mov_b32 s74, 262144
L_pat:
buffer_load_dwordx2 v[14:15], v253, s[20:23], s14 offen sc1
s_waitcnt vmcnt(0)
v_cmp_ne_u32 vcc, s70, v14
v_cmp_ne_u32 s[64:65], s71, v15
s_nop 0
s_or_b32 s64, vcc_lo, s64
s_and_b32 s64, s64, s12
s_cmp_lg_u32 s64, 0
s_cbranch_scc0 L_pat_ok
s_sleep 4
s_sub_u32 s74, s74, 1
s_cmp_lg_u32 s74, 0
s_cbranch_scc1 L_pat
L_pat_ok:
buffer_load_dwordx4 v[48:51], v247, s[20:23], s56 offen sc1
buffer_load_dwordx4 v[52:55], v247, s[20:23], s56 offen offset:1024 sc1
buffer_load_dwordx4 v[56:59], v248, s[20:23], s56 offen sc1
buffer_load_dwordx4 v[60:63], v248, s[20:23], s56 offen offset:1024 sc1
buffer_load_dwordx4 v[64:67], v249, s[20:23], s56 offen sc1
buffer_load_dwordx4 v[68:71], v249, s[20:23], s56 offen offset:1024 sc1
buffer_load_dwordx4 v[72:75], v250, s[20:23], s56 offen sc1
buffer_load_dwordx4 v[76:79], v250, s[20:23], s56 offen offset:1024 sc1
s_add_u32 s56, s56, 2048
buffer_load_dwordx4 v[160:163], v247, s[20:23], s56 offen sc1
buffer_load_dwordx4 v[164:167], v247, s[20:23], s56 offen offset:1024 sc1
buffer_load_dwordx4 v[168:171], v248, s[20:23], s56 offen sc1
buffer_load_dwordx4 v[172:175], v248, s[20:23], s56 offen offset:1024 sc1
buffer_load_dwordx4 v[176:179], v249, s[20:23], s56 offen sc1
buffer_load_dwordx4 v[180:183], v249, s[20:23], s56 offen offset:1024 sc1
buffer_load_dwordx4 v[184:187], v250, s[20:23], s56 offen sc1
buffer_load_dwordx4 v[188:191], v250, s[20:23], s56 offen offset:1024 sc1
s_add_u32 s56, s56, 2048
s_waitcnt vmcnt(8)
s_branch L_o2_r
L_o4:
s_mov_b32 s74, 2139193217
s_mov_b64 vcc, 0
v_cmp_eq_u32 s[64:65], s74, v200
s_nop 0
s_or_b64 vcc, vcc, s[64:65]
v_cmp_eq_u32 s[64:65], s74, v201
s_nop 0
s_or_b64 vcc, vcc, s[64:65]
v_cmp_eq_u32 s[64:65], s74, v202
s_nop 0
s_or_b64 vcc, vcc, s[64:65]
v_cmp_eq_u32 s[64:65], s74, v203
s_nop 0
s_or_b64 vcc, vcc, s[64:65]
v_cmp_eq_u32 s[64:65], s74, v204
s_nop 0
s_or_b64 vcc, vcc, s[64:65]
v_cmp_eq_u32 s[64:65], s74, v205
s_nop 0
s_or_b64 vcc, vcc, s[64:65]
v_cmp_eq_u32 s[64:65], s74, v206
s_nop 0
s_or_b64 vcc, vcc, s[64:65]
v_cmp_eq_u32 s[64:65], s74, v207
s_nop 0
s_or_b64 vcc, vcc, s[64:65]
v_cmp_eq_u32 s[64:65], s74, v208
s_nop 0
s_or_b64 vcc, vcc, s[64:65]
v_cmp_eq_u32 s[64:65], s74, v209
s_nop 0
s_or_b64 vcc, vcc, s[64:65]
v_cmp_eq_u32 s[64:65], s74, v210
s_nop 0
s_or_b64 vcc, vcc, s[64:65]
v_cmp_eq_u32 s[64:65], s74, v211
s_nop 0
s_or_b64 vcc, vcc, s[64:65]
v_cmp_eq_u32 s[64:65], s74, v212
s_nop 0
s_or_b64 vcc, vcc, s[64:65]
v_cmp_eq_u32 s[64:65], s74, v213
s_nop 0
s_or_b64 vcc, vcc, s[64:65]
v_cmp_eq_u32 s[64:65], s74, v214
s_nop 0
s_or_b64 vcc, vcc, s[64:65]
v_cmp_eq_u32 s[64:65], s74, v215
s_nop 0
s_or_b64 vcc, vcc, s[64:65]
v_cmp_eq_u32 s[64:65], s74, v216
s_nop 0
s_or_b64 vcc, vcc, s[64:65]
v_cmp_eq_u32 s[64:65], s74, v217
s_nop 0
s_or_b64 vcc, vcc, s[64:65]
v_cmp_eq_u32 s[64:65], s74, v218
s_nop 0
s_or_b64 vcc, vcc, s[64:65]
v_cmp_eq_u32 s[64:65], s74, v219
s_nop 0
s_or_b64 vcc, vcc, s[64:65]
v_cmp_eq_u32 s[64:65], s74, v220
s_nop 0
s_or_b64 vcc, vcc, s[64:65]
v_cmp_eq_u32 s[64:65], s74, v221
s_nop 0
s_or_b64 vcc, vcc, s[64:65]
v_cmp_eq_u32 s[64:65], s74, v222
s_nop 0
s_or_b64 vcc, vcc, s[64:65]
v_cmp_eq_u32 s[64:65], s74, v223
s_nop 0
s_or_b64 vcc, vcc, s[64:65]
v_cmp_eq_u32 s[64:65], s74, v224
s_nop 0
s_or_b64 vcc, vcc, s[64:65]
v_cmp_eq_u32 s[64:65], s74, v225
s_nop 0
s_or_b64 vcc, vcc, s[64:65]
v_cmp_eq_u32 s[64:65], s74, v226
s_nop 0
s_or_b64 vcc, vcc, s[64:65]
v_cmp_eq_u32 s[64:65], s74, v227
s_nop 0
s_or_b64 vcc, vcc, s[64:65]
v_cmp_eq_u32 s[64:65], s74, v228
s_nop 0
s_or_b64 vcc, vcc, s[64:65]
v_cmp_eq_u32 s[64:65], s74, v229
s_nop 0
s_or_b64 vcc, vcc, s[64:65]
s_cmp_lg_u64 vcc, 0
s_cbranch_scc0 L_o4_r
L_px:
s_sub_u32 s14, s14, 1
s_cmp_eq_u32 s14, 0
s_cbranch_scc1 L_o4_r
buffer_load_dword v14, v6, s[20:23], s27 offen sc1
s_waitcnt vmcnt(0)
v_cmp_eq_u32 vcc, s74, v14
s_nop 0
s_cmp_lg_u64 vcc, 0
s_cbranch_scc0 L_px_ok
s_sleep 1
s_branch L_px
L_px_ok:
buffer_load_dwordx4 v[200:203], v4, s[20:23], s27 offen sc1
buffer_load_dwordx4 v[204:207], v4, s[20:23], s27 offen offset:1024 sc1
buffer_load_dwordx2 v[208:209], v1, s[20:23], s27 offen sc1
buffer_load_dwordx4 v[210:213], v4, s[20:23], s25 offen sc1
buffer_load_dwordx4 v[214:217], v4, s[20:23], s25 offen offset:1024 sc1
buffer_load_dwordx2 v[218:219], v1, s[20:23], s25 offen sc1
buffer_load_dwordx4 v[220:223], v4, s[20:23], s24 offen sc1
buffer_load_dwordx4 v[224:227], v4, s[20:23], s24 offen offset:1024 sc1
buffer_load_dwordx2 v[228:229], v1, s[20:23], s24 offen sc1
s_branch L_x2
L_fo:
ds_read_b64_tr_b16 v[224:225], v240
ds_read_b64_tr_b16 v[226:227], v240 offset:6144
ds_read_b64_tr_b16 v[228:229], v240 offset:12288
ds_read_b64_tr_b16 v[230:231], v240 offset:18432
ds_read_b64_tr_b16 v[232:233], v240 offset:8
ds_read_b64_tr_b16 v[234:235], v240 offset:6152
ds_read_b64_tr_b16 v[236:237], v240 offset:12296
ds_read_b64_tr_b16 v[238:239], v240 offset:18440
ds_read_b64_tr_b16 v[192:193], v241
ds_read_b64_tr_b16 v[194:195], v241 offset:6144
ds_read_b64_tr_b16 v[196:197], v241 offset:12288
ds_read_b64_tr_b16 v[198:199], v241 offset:18432
s_waitcnt lgkmcnt(8)
v_readfirstlane_b32 s70, v42
v_readfirstlane_b32 s71, v43
s_waitcnt vmcnt(8)
v_mfma_f32_16x16x32_bf16 a[0:3], v[224:227], v[64:67], 0
s_add_u32 m0, s68, 122880
ds_read_b64_tr_b16 v[200:201], v241 offset:8
v_mfma_f32_16x16x32_bf16 a[0:3], v[228:231], v[68:71], a[0:3]
buffer_load_dwordx4 v247, s[12:15], s64 offen lds
v_mfma_f32_16x16x32_bf16 a[4:7], v[228:231], v[76:79], 0
ds_read_b64_tr_b16 v[202:203], v241 offset:6152
v_mfma_f32_16x16x32_bf16 a[4:7], v[224:227], v[72:75], a[4:7]
v_mfma_f32_16x16x32_bf16 a[8:11], v[224:227], v[80:83], 0
ds_read_b64_tr_b16 v[204:205], v241 offset:12296
v_mfma_f32_16x16x32_bf16 a[8:11], v[228:231], v[84:87], a[8:11]
v_mfma_f32_16x16x32_bf16 a[12:15], v[228:231], v[92:95], 0
ds_read_b64_tr_b16 v[206:207], v241 offset:18440
v_mfma_f32_16x16x32_bf16 a[12:15], v[224:227], v[88:91], a[12:15]
s_waitcnt lgkmcnt(8)
buffer_load_dwordx4 v248, s[12:15], s64 offen offset:1024 lds
v_mfma_f32_16x16x32_bf16 a[16:19], v[232:235], v[64:67], 0
ds_read_b64_tr_b16 v[208:209], v240 offset:128
v_mfma_f32_16x16x32_bf16 a[16:19], v[236:239], v[68:71], a[16:19]
v_mfma_f32_16x16x32_bf16 a[20:23], v[236:239], v[76:79], 0
ds_read_b64_tr_b16 v[210:211], v240 offset:6272
v_mfma_f32_16x16x32_bf16 a[20:23], v[232:235], v[72:75], a[20:23]
v_mfma_f32_16x16x32_bf16 a[24:27], v[232:235], v[80:83], 0
ds_read_b64_tr_b16 v[212:213], v240 offset:12416
v_mfma_f32_16x16x32_bf16 a[24:27], v[236:239], v[84:87], a[24:27]
v_mfma_f32_16x16x32_bf16 a[28:31], v[236:239], v[92:95], 0
ds_read_b64_tr_b16 v[214:215], v240 offset:18560
buffer_load_dwordx4 v249, s[12:15], s64 offen offset:2048 lds
v_mfma_f32_16x16x32_bf16 a[28:31], v[232:235], v[88:91], a[28:31]
s_waitcnt lgkmcnt(8)
s_add_u32 s64, s64, 98304
s_add_u32 m0, s68, 125952
v_mfma_f32_16x16x32_bf16 a[32:35], v[192:195], v[64:67], 0
ds_read_b64_tr_b16 v[216:217], v240 offset:136
v_mfma_f32_16x16x32_bf16 a[32:35], v[196:199], v[68:71], a[32:35]
v_mfma_f32_16x16x32_bf16 a[36:39], v[196:199], v[76:79], 0
ds_read_b64_tr_b16 v[218:219], v240 offset:6280
v_mfma_f32_16x16x32_bf16 a[36:39], v[192:195], v[72:75], a[36:39]
v_mfma_f32_16x16x32_bf16 a[40:43], v[192:195], v[80:83], 0
ds_read_b64_tr_b16 v[220:221], v240 offset:12424
v_mfma_f32_16x16x32_bf16 a[40:43], v[196:199], v[84:87], a[40:43]
buffer_load_dwordx4 v247, s[12:15], s64 offen lds
v_mfma_f32_16x16x32_bf16 a[44:47], v[196:199], v[92:95], 0
ds_read_b64_tr_b16 v[222:223], v240 offset:18568
v_mfma_f32_16x16x32_bf16 a[44:47], v[192:195], v[88:91], a[44:47]
s_waitcnt lgkmcnt(8)
v_mfma_f32_16x16x32_bf16 a[48:51], v[200:203], v[64:67], 0
ds_read_b64_tr_b16 v[224:225], v241 offset:128
v_mfma_f32_16x16x32_bf16 a[48:51], v[204:207], v[68:71], a[48:51]
v_mfma_f32_16x16x32_bf16 a[52:55], v[204:207], v[76:79], 0
ds_read_b64_tr_b16 v[226:227], v241 offset:6272
v_mfma_f32_16x16x32_bf16 a[52:55], v[200:203], v[72:75], a[52:55]
v_mfma_f32_16x16x32_bf16 a[56:59], v[200:203], v[80:83], 0
ds_read_b64_tr_b16 v[228:229], v241 offset:12416
buffer_load_dwordx4 v248, s[12:15], s64 offen offset:1024 lds
v_mfma_f32_16x16x32_bf16 a[56:59], v[204:207], v[84:87], a[56:59]
v_mfma_f32_16x16x32_bf16 a[60:63], v[204:207], v[92:95], 0
ds_read_b64_tr_b16 v[230:231], v241 offset:18560
v_mfma_f32_16x16x32_bf16 a[60:63], v[200:203], v[88:91], a[60:63]
s_waitcnt lgkmcnt(8)
v_mfma_f32_16x16x32_bf16 a[64:67], v[208:211], v[64:67], 0
ds_read_b64_tr_b16 v[232:233], v241 offset:136
v_mfma_f32_16x16x32_bf16 a[64:67], v[212:215], v[68:71], a[64:67]
v_mfma_f32_16x16x32_bf16 a[68:71], v[212:215], v[76:79], 0
ds_read_b64_tr_b16 v[234:235], v241 offset:6280
buffer_load_dwordx4 v249, s[12:15], s64 offen offset:2048 lds
v_mfma_f32_16x16x32_bf16 a[68:71], v[208:211], v[72:75], a[68:71]
s_add_u32 s64, s64, 688128
s_add_u32 m0, s61, 65536
v_mfma_f32_16x16x32_bf16 a[72:75], v[208:211], v[80:83], 0
ds_read_b64_tr_b16 v[236:237], v241 offset:12424
v_mfma_f32_16x16x32_bf16 a[72:75], v[212:215], v[84:87], a[72:75]
v_mfma_f32_16x16x32_bf16 a[76:79], v[212:215], v[92:95], 0
ds_read_b64_tr_b16 v[238:239], v241 offset:18568
v_mfma_f32_16x16x32_bf16 a[76:79], v[208:211], v[88:91], a[76:79]
s_waitcnt lgkmcnt(8)
v_mfma_f32_16x16x32_bf16 a[80:83], v[216:219], v[64:67], 0
ds_read_b64_tr_b16 v[192:193], v240 offset:256
v_mfma_f32_16x16x32_bf16 a[80:83], v[220:223], v[68:71], a[80:83]
buffer_load_dwordx4 v250, s[16:19], s65 offen lds
v_mfma_f32_16x16x32_bf16 a[84:87], v[220:223], v[76:79], 0
s_add_u32 s65, s65, 23552
ds_read_b64_tr_b16 v[194:195], v240 offset:6400
v_mfma_f32_16x16x32_bf16 a[84:87], v[216:219], v[72:75], a[84:87]
v_mfma_f32_16x16x32_bf16 a[88:91], v[216:219], v[80:83], 0
ds_read_b64_tr_b16 v[196:197], v240 offset:12544
v_mfma_f32_16x16x32_bf16 a[88:91], v[220:223], v[84:87], a[88:91]
v_mfma_f32_16x16x32_bf16 a[92:95], v[220:223], v[92:95], 0
ds_read_b64_tr_b16 v[198:199], v240 offset:18688
v_mfma_f32_16x16x32_bf16 a[92:95], v[216:219], v[88:91], a[92:95]
s_waitcnt lgkmcnt(8)
v_mfma_f32_16x16x32_bf16 a[96:99], v[224:227], v[64:67], 0
ds_read_b64_tr_b16 v[200:201], v240 offset:264
buffer_load_dwordx4 v250, s[16:19], s65 offen offset:1024 lds
v_mfma_f32_16x16x32_bf16 a[96:99], v[228:231], v[68:71], a[96:99]
s_add_u32 s65, s65, 173056
v_mfma_f32_16x16x32_bf16 a[100:103], v[228:231], v[76:79], 0
ds_read_b64_tr_b16 v[202:203], v240 offset:6408
v_mfma_f32_16x16x32_bf16 a[100:103], v[224:227], v[72:75], a[100:103]
v_mfma_f32_16x16x32_bf16 a[104:107], v[224:227], v[80:83], 0
ds_read_b64_tr_b16 v[204:205], v240 offset:12552
v_mfma_f32_16x16x32_bf16 a[104:107], v[228:231], v[84:87], a[104:107]
v_mfma_f32_16x16x32_bf16 a[108:111], v[228:231], v[92:95], 0
ds_read_b64_tr_b16 v[206:207], v240 offset:18696
v_mfma_f32_16x16x32_bf16 a[108:111], v[224:227], v[88:91], a[108:111]
s_waitcnt lgkmcnt(8)
buffer_load_dwordx4 v[128:131], v251, s[20:23], s66 offen sc1
v_mfma_f32_16x16x32_bf16 a[112:115], v[232:235], v[64:67], 0
ds_read_b64_tr_b16 v[208:209], v241 offset:256
v_mfma_f32_16x16x32_bf16 a[112:115], v[236:239], v[68:71], a[112:115]
v_mfma_f32_16x16x32_bf16 a[116:119], v[236:239], v[76:79], 0
ds_read_b64_tr_b16 v[210:211], v241 offset:6400
v_mfma_f32_16x16x32_bf16 a[116:119], v[232:235], v[72:75], a[116:119]
v_mfma_f32_16x16x32_bf16 a[120:123], v[232:235], v[80:83], 0
ds_read_b64_tr_b16 v[212:213], v241 offset:12544
v_mfma_f32_16x16x32_bf16 a[120:123], v[236:239], v[84:87], a[120:123]
buffer_load_dwordx4 v[132:135], v251, s[20:23], s66 offen offset:1024 sc1
v_mfma_f32_16x16x32_bf16 a[124:127], v[236:239], v[92:95], 0
ds_read_b64_tr_b16 v[214:215], v241 offset:18688
v_mfma_f32_16x16x32_bf16 a[124:127], v[232:235], v[88:91], a[124:127]
s_waitcnt lgkmcnt(8)
v_mfma_f32_16x16x32_bf16 a[128:131], v[192:195], v[64:67], 0
ds_read_b64_tr_b16 v[216:217], v241 offset:264
v_mfma_f32_16x16x32_bf16 a[128:131], v[196:199], v[68:71], a[128:131]
v_mfma_f32_16x16x32_bf16 a[132:135], v[196:199], v[76:79], 0
ds_read_b64_tr_b16 v[218:219], v241 offset:6408
v_mfma_f32_16x16x32_bf16 a[132:135], v[192:195], v[72:75], a[132:135]
v_mfma_f32_16x16x32_bf16 a[136:139], v[192:195], v[80:83], 0
ds_read_b64_tr_b16 v[220:221], v241 offset:12552
buffer_load_dwordx4 v[136:139], v252, s[20:23], s66 offen sc1
v_mfma_f32_16x16x32_bf16 a[136:139], v[196:199], v[84:87], a[136:139]
v_mfma_f32_16x16x32_bf16 a[140:143], v[196:199], v[92:95], 0
ds_read_b64_tr_b16 v[222:223], v241 offset:18696
v_mfma_f32_16x16x32_bf16 a[140:143], v[192:195], v[88:91], a[140:143]
s_waitcnt lgkmcnt(8)
v_mfma_f32_16x16x32_bf16 a[144:147], v[200:203], v[64:67], 0
ds_read_b64_tr_b16 v[224:225], v244
v_mfma_f32_16x16x32_bf16 a[144:147], v[204:207], v[68:71], a[144:147]
v_mfma_f32_16x16x32_bf16 a[148:151], v[204:207], v[76:79], 0
ds_read_b64_tr_b16 v[226:227], v244 offset:2048
v_mfma_f32_16x16x32_bf16 a[148:151], v[200:203], v[72:75], a[148:151]
buffer_load_dwordx4 v[140:143], v252, s[20:23], s66 offen offset:1024 sc1
v_mfma_f32_16x16x32_bf16 a[152:155], v[200:203], v[80:83], 0
ds_read_b64_tr_b16 v[228:229], v244 offset:4096
v_mfma_f32_16x16x32_bf16 a[152:155], v[204:207], v[84:87], a[152:155]
v_mfma_f32_16x16x32_bf16 a[156:159], v[204:207], v[92:95], 0
ds_read_b64_tr_b16 v[230:231], v244 offset:6144
v_mfma_f32_16x16x32_bf16 a[156:159], v[200:203], v[88:91], a[156:159]
s_waitcnt lgkmcnt(8)
v_mfma_f32_16x16x32_bf16 a[160:163], v[208:211], v[64:67], 0
ds_read_b64_tr_b16 v[232:233], v245
v_mfma_f32_16x16x32_bf16 a[160:163], v[212:215], v[68:71], a[160:163]
v_mfma_f32_16x16x32_bf16 a[164:167], v[212:215], v[76:79], 0
ds_read_b64_tr_b16 v[234:235], v245 offset:2048
buffer_load_dwordx4 v[144:147], v253, s[20:23], s66 offen sc1
v_mfma_f32_16x16x32_bf16 a[164:167], v[208:211], v[72:75], a[164:167]
v_mfma_f32_16x16x32_bf16 a[168:171], v[208:211], v[80:83], 0
ds_read_b64_tr_b16 v[236:237], v245 offset:4096
v_mfma_f32_16x16x32_bf16 a[168:171], v[212:215], v[84:87], a[168:171]
v_mfma_f32_16x16x32_bf16 a[172:175], v[212:215], v[92:95], 0
ds_read_b64_tr_b16 v[238:239], v245 offset:6144
v_mfma_f32_16x16x32_bf16 a[172:175], v[208:211], v[88:91], a[172:175]
s_waitcnt lgkmcnt(8)
v_mfma_f32_16x16x32_bf16 a[176:179], v[216:219], v[64:67], 0
buffer_load_dwordx4 v[148:151], v253, s[20:23], s66 offen offset:1024 sc1
v_mfma_f32_16x16x32_bf16 a[176:179], v[220:223], v[68:71], a[176:179]
v_mfma_f32_16x16x32_bf16 a[180:183], v[220:223], v[76:79], 0
v_mfma_f32_16x16x32_bf16 a[180:183], v[216:219], v[72:75], a[180:183]
v_mfma_f32_16x16x32_bf16 a[184:187], v[216:219], v[80:83], 0
v_mfma_f32_16x16x32_bf16 a[184:187], v[220:223], v[84:87], a[184:187]
v_mfma_f32_16x16x32_bf16 a[188:191], v[220:223], v[92:95], 0
s_waitcnt vmcnt(22) lgkmcnt(0)
s_barrier
v_mfma_f32_16x16x32_bf16 a[188:191], v[216:219], v[88:91], a[188:191]
s_waitcnt lgkmcnt(0)
ds_read_b64_tr_b16 v[192:193], v240 offset:24576
buffer_load_dwordx4 v[152:155], v254, s[20:23], s66 offen sc1
v_mfma_f32_16x16x32_bf16 v[160:163], v[224:227], v[64:67], v[160:163]
ds_read_b64_tr_b16 v[194:195], v240 offset:30720
v_mfma_f32_16x16x32_bf16 v[160:163], v[228:231], v[68:71], v[160:163]
ds_read_b64_tr_b16 v[196:197], v240 offset:36864
v_mfma_f32_16x16x32_bf16 v[164:167], v[228:231], v[76:79], v[164:167]
ds_read_b64_tr_b16 v[198:199], v240 offset:43008
v_mfma_f32_16x16x32_bf16 v[164:167], v[224:227], v[72:75], v[164:167]
v_mfma_f32_16x16x32_bf16 v[168:171], v[224:227], v[80:83], v[168:171]
ds_read_b64_tr_b16 v[200:201], v240 offset:24584
v_mfma_f32_16x16x32_bf16 v[168:171], v[228:231], v[84:87], v[168:171]
ds_read_b64_tr_b16 v[202:203], v240 offset:30728
v_mfma_f32_16x16x32_bf16 v[172:175], v[228:231], v[92:95], v[172:175]
ds_read_b64_tr_b16 v[204:205], v240 offset:36872
buffer_load_dwordx4 v[156:159], v254, s[20:23], s66 offen offset:1024 sc1
v_mfma_f32_16x16x32_bf16 v[172:175], v[224:227], v[88:91], v[172:175]
s_waitcnt lgkmcnt(7)
s_add_u32 s66, s66, 2048
ds_read_b64_tr_b16 v[206:207], v240 offset:43016
v_mfma_f32_16x16x32_bf16 v[176:179], v[232:235], v[64:67], v[176:179]
v_mfma_f32_16x16x32_bf16 v[176:179], v[236:239], v[68:71], v[176:179]
ds_read_b64_tr_b16 v[208:209], v241 offset:24576
v_mfma_f32_16x16x32_bf16 v[180:183], v[236:239], v[76:79], v[180:183]
ds_read_b64_tr_b16 v[210:211], v241 offset:30720
v_mfma_f32_16x16x32_bf16 v[180:183], v[232:235], v[72:75], v[180:183]
ds_read_b64_tr_b16 v[212:213], v241 offset:36864
v_mfma_f32_16x16x32_bf16 v[184:187], v[232:235], v[80:83], v[184:187]
ds_read_b64_tr_b16 v[214:215], v241 offset:43008
v_mfma_f32_16x16x32_bf16 v[184:187], v[236:239], v[84:87], v[184:187]
v_mfma_f32_16x16x32_bf16 v[188:191], v[236:239], v[92:95], v[188:191]
s_waitcnt vmcnt(16)
v_mfma_f32_16x16x32_bf16 v[188:191], v[232:235], v[88:91], v[188:191]
s_waitcnt lgkmcnt(8)
v_mfma_f32_16x16x32_bf16 a[0:3], v[192:195], v[96:99], a[0:3]
s_add_u32 m0, s68, 73728
ds_read_b64_tr_b16 v[216:217], v241 offset:24584
v_mfma_f32_16x16x32_bf16 a[0:3], v[196:199], v[100:103], a[0:3]
buffer_load_dwordx4 v247, s[12:15], s64 offen lds
v_mfma_f32_16x16x32_bf16 a[4:7], v[196:199], v[108:111], a[4:7]
ds_read_b64_tr_b16 v[218:219], v241 offset:30728
v_mfma_f32_16x16x32_bf16 a[4:7], v[192:195], v[104:107], a[4:7]
v_mfma_f32_16x16x32_bf16 a[8:11], v[192:195], v[112:115], a[8:11]
ds_read_b64_tr_b16 v[220:221], v241 offset:36872
v_mfma_f32_16x16x32_bf16 a[8:11], v[196:199], v[116:119], a[8:11]
v_mfma_f32_16x16x32_bf16 a[12:15], v[196:199], v[124:127], a[12:15]
ds_read_b64_tr_b16 v[222:223], v241 offset:43016
v_mfma_f32_16x16x32_bf16 a[12:15], v[192:195], v[120:123], a[12:15]
s_waitcnt lgkmcnt(8)
buffer_load_dwordx4 v248, s[12:15], s64 offen offset:1024 lds
v_mfma_f32_16x16x32_bf16 a[16:19], v[200:203], v[96:99], a[16:19]
ds_read_b64_tr_b16 v[224:225], v240 offset:24704
v_mfma_f32_16x16x32_bf16 a[16:19], v[204:207], v[100:103], a[16:19]
v_mfma_f32_16x16x32_bf16 a[20:23], v[204:207], v[108:111], a[20:23]
ds_read_b64_tr_b16 v[226:227], v240 offset:30848
v_mfma_f32_16x16x32_bf16 a[20:23], v[200:203], v[104:107], a[20:23]
v_mfma_f32_16x16x32_bf16 a[24:27], v[200:203], v[112:115], a[24:27]
ds_read_b64_tr_b16 v[228:229], v240 offset:36992
v_mfma_f32_16x16x32_bf16 a[24:27], v[204:207], v[116:119], a[24:27]
v_mfma_f32_16x16x32_bf16 a[28:31], v[204:207], v[124:127], a[28:31]
ds_read_b64_tr_b16 v[230:231], v240 offset:43136
buffer_load_dwordx4 v249, s[12:15], s64 offen offset:2048 lds
v_mfma_f32_16x16x32_bf16 a[28:31], v[200:203], v[120:123], a[28:31]
s_waitcnt lgkmcnt(8)
s_add_u32 s64, s64, 98304
s_add_u32 m0, s68, 76800
v_mfma_f32_16x16x32_bf16 a[32:35], v[208:211], v[96:99], a[32:35]
ds_read_b64_tr_b16 v[232:233], v240 offset:24712
v_mfma_f32_16x16x32_bf16 a[32:35], v[212:215], v[100:103], a[32:35]
v_mfma_f32_16x16x32_bf16 a[36:39], v[212:215], v[108:111], a[36:39]
ds_read_b64_tr_b16 v[234:235], v240 offset:30856
v_mfma_f32_16x16x32_bf16 a[36:39], v[208:211], v[104:107], a[36:39]
v_mfma_f32_16x16x32_bf16 a[40:43], v[208:211], v[112:115], a[40:43]
ds_read_b64_tr_b16 v[236:237], v240 offset:37000
v_mfma_f32_16x16x32_bf16 a[40:43], v[212:215], v[116:119], a[40:43]
buffer_load_dwordx4 v247, s[12:15], s64 offen lds
v_mfma_f32_16x16x32_bf16 a[44:47], v[212:215], v[124:127], a[44:47]
ds_read_b64_tr_b16 v[238:239], v240 offset:43144
v_mfma_f32_16x16x32_bf16 a[44:47], v[208:211], v[120:123], a[44:47]
s_waitcnt lgkmcnt(8)
v_mfma_f32_16x16x32_bf16 a[48:51], v[216:219], v[96:99], a[48:51]
ds_read_b64_tr_b16 v[192:193], v241 offset:24704
v_mfma_f32_16x16x32_bf16 a[48:51], v[220:223], v[100:103], a[48:51]
v_mfma_f32_16x16x32_bf16 a[52:55], v[220:223], v[108:111], a[52:55]
ds_read_b64_tr_b16 v[194:195], v241 offset:30848
v_mfma_f32_16x16x32_bf16 a[52:55], v[216:219], v[104:107], a[52:55]
v_mfma_f32_16x16x32_bf16 a[56:59], v[216:219], v[112:115], a[56:59]
ds_read_b64_tr_b16 v[196:197], v241 offset:36992
buffer_load_dwordx4 v248, s[12:15], s64 offen offset:1024 lds
v_mfma_f32_16x16x32_bf16 a[56:59], v[220:223], v[116:119], a[56:59]
v_mfma_f32_16x16x32_bf16 a[60:63], v[220:223], v[124:127], a[60:63]
ds_read_b64_tr_b16 v[198:199], v241 offset:43136
v_mfma_f32_16x16x32_bf16 a[60:63], v[216:219], v[120:123], a[60:63]
s_waitcnt lgkmcnt(8)
v_mfma_f32_16x16x32_bf16 a[64:67], v[224:227], v[96:99], a[64:67]
ds_read_b64_tr_b16 v[200:201], v241 offset:24712
v_mfma_f32_16x16x32_bf16 a[64:67], v[228:231], v[100:103], a[64:67]
v_mfma_f32_16x16x32_bf16 a[68:71], v[228:231], v[108:111], a[68:71]
ds_read_b64_tr_b16 v[202:203], v241 offset:30856
buffer_load_dwordx4 v249, s[12:15], s64 offen offset:2048 lds
v_mfma_f32_16x16x32_bf16 a[68:71], v[224:227], v[104:107], a[68:71]
s_add_u32 s64, s64, 688128
s_add_u32 m0, s61, 49152
v_mfma_f32_16x16x32_bf16 a[72:75], v[224:227], v[112:115], a[72:75]
ds_read_b64_tr_b16 v[204:205], v241 offset:37000
v_mfma_f32_16x16x32_bf16 a[72:75], v[228:231], v[116:119], a[72:75]
v_mfma_f32_16x16x32_bf16 a[76:79], v[228:231], v[124:127], a[76:79]
ds_read_b64_tr_b16 v[206:207], v241 offset:43144
v_mfma_f32_16x16x32_bf16 a[76:79], v[224:227], v[120:123], a[76:79]
s_waitcnt lgkmcnt(8)
v_mfma_f32_16x16x32_bf16 a[80:83], v[232:235], v[96:99], a[80:83]
ds_read_b64_tr_b16 v[208:209], v240 offset:24832
v_mfma_f32_16x16x32_bf16 a[80:83], v[236:239], v[100:103], a[80:83]
buffer_load_dwordx4 v250, s[16:19], s65 offen lds
v_mfma_f32_16x16x32_bf16 a[84:87], v[236:239], v[108:111], a[84:87]
s_add_u32 s65, s65, 23552
ds_read_b64_tr_b16 v[210:211], v240 offset:30976
v_mfma_f32_16x16x32_bf16 a[84:87], v[232:235], v[104:107], a[84:87]
v_mfma_f32_16x16x32_bf16 a[88:91], v[232:235], v[112:115], a[88:91]
ds_read_b64_tr_b16 v[212:213], v240 offset:37120
v_mfma_f32_16x16x32_bf16 a[88:91], v[236:239], v[116:119], a[88:91]
v_mfma_f32_16x16x32_bf16 a[92:95], v[236:239], v[124:127], a[92:95]
ds_read_b64_tr_b16 v[214:215], v240 offset:43264
v_mfma_f32_16x16x32_bf16 a[92:95], v[232:235], v[120:123], a[92:95]
s_waitcnt lgkmcnt(8)
v_mfma_f32_16x16x32_bf16 a[96:99], v[192:195], v[96:99], a[96:99]
ds_read_b64_tr_b16 v[216:217], v240 offset:24840
buffer_load_dwordx4 v250, s[16:19], s65 offen offset:1024 lds
v_mfma_f32_16x16x32_bf16 a[96:99], v[196:199], v[100:103], a[96:99]
s_add_u32 s65, s65, 173056
v_mfma_f32_16x16x32_bf16 a[100:103], v[196:199], v[108:111], a[100:103]
ds_read_b64_tr_b16 v[218:219], v240 offset:30984
v_mfma_f32_16x16x32_bf16 a[100:103], v[192:195], v[104:107], a[100:103]
v_mfma_f32_16x16x32_bf16 a[104:107], v[192:195], v[112:115], a[104:107]
ds_read_b64_tr_b16 v[220:221], v240 offset:37128
v_mfma_f32_16x16x32_bf16 a[104:107], v[196:199], v[116:119], a[104:107]
v_mfma_f32_16x16x32_bf16 a[108:111], v[196:199], v[124:127], a[108:111]
ds_read_b64_tr_b16 v[222:223], v240 offset:43272
v_mfma_f32_16x16x32_bf16 a[108:111], v[192:195], v[120:123], a[108:111]
s_waitcnt lgkmcnt(8)
buffer_load_dwordx4 v[64:67], v251, s[20:23], s66 offen sc1
v_mfma_f32_16x16x32_bf16 a[112:115], v[200:203], v[96:99], a[112:115]
ds_read_b64_tr_b16 v[224:225], v241 offset:24832
v_mfma_f32_16x16x32_bf16 a[112:115], v[204:207], v[100:103], a[112:115]
v_mfma_f32_16x16x32_bf16 a[116:119], v[204:207], v[108:111], a[116:119]
ds_read_b64_tr_b16 v[226:227], v241 offset:30976
v_mfma_f32_16x16x32_bf16 a[116:119], v[200:203], v[104:107], a[116:119]
v_mfma_f32_16x16x32_bf16 a[120:123], v[200:203], v[112:115], a[120:123]
ds_read_b64_tr_b16 v[228:229], v241 offset:37120
v_mfma_f32_16x16x32_bf16 a[120:123], v[204:207], v[116:119], a[120:123]
buffer_load_dwordx4 v[68:71], v251, s[20:23], s66 offen offset:1024 sc1
v_mfma_f32_16x16x32_bf16 a[124:127], v[204:207], v[124:127], a[124:127]
ds_read_b64_tr_b16 v[230:231], v241 offset:43264
v_mfma_f32_16x16x32_bf16 a[124:127], v[200:203], v[120:123], a[124:127]
s_waitcnt lgkmcnt(8)
v_mfma_f32_16x16x32_bf16 a[128:131], v[208:211], v[96:99], a[128:131]
ds_read_b64_tr_b16 v[232:233], v241 offset:24840
v_mfma_f32_16x16x32_bf16 a[128:131], v[212:215], v[100:103], a[128:131]
v_mfma_f32_16x16x32_bf16 a[132:135], v[212:215], v[108:111], a[132:135]
ds_read_b64_tr_b16 v[234:235], v241 offset:30984
v_mfma_f32_16x16x32_bf16 a[132:135], v[208:211], v[104:107], a[132:135]
v_mfma_f32_16x16x32_bf16 a[136:139], v[208:211], v[112:115], a[136:139]
ds_read_b64_tr_b16 v[236:237], v241 offset:37128
buffer_load_dwordx4 v[72:75], v252, s[20:23], s66 offen sc1
v_mfma_f32_16x16x32_bf16 a[136:139], v[212:215], v[116:119], a[136:139]
v_mfma_f32_16x16x32_bf16 a[140:143], v[212:215], v[124:127], a[140:143]
ds_read_b64_tr_b16 v[238:239], v241 offset:43272
v_mfma_f32_16x16x32_bf16 a[140:143], v[208:211], v[120:123], a[140:143]
s_waitcnt lgkmcnt(8)
v_mfma_f32_16x16x32_bf16 a[144:147], v[216:219], v[96:99], a[144:147]
ds_read_b64_tr_b16 v[192:193], v244 offset:8192
v_mfma_f32_16x16x32_bf16 a[144:147], v[220:223], v[100:103], a[144:147]
v_mfma_f32_16x16x32_bf16 a[148:151], v[220:223], v[108:111], a[148:151]
ds_read_b64_tr_b16 v[194:195], v244 offset:10240
v_mfma_f32_16x16x32_bf16 a[148:151], v[216:219], v[104:107], a[148:151]
buffer_load_dwordx4 v[76:79], v252, s[20:23], s66 offen offset:1024 sc1
v_mfma_f32_16x16x32_bf16 a[152:155], v[216:219], v[112:115], a[152:155]
ds_read_b64_tr_b16 v[196:197], v244 offset:12288
v_mfma_f32_16x16x32_bf16 a[152:155], v[220:223], v[116:119], a[152:155]
v_mfma_f32_16x16x32_bf16 a[156:159], v[220:223], v[124:127], a[156:159]
ds_read_b64_tr_b16 v[198:199], v244 offset:14336
v_mfma_f32_16x16x32_bf16 a[156:159], v[216:219], v[120:123], a[156:159]
s_waitcnt lgkmcnt(8)
v_mfma_f32_16x16x32_bf16 a[160:163], v[224:227], v[96:99], a[160:163]
ds_read_b64_tr_b16 v[200:201], v245 offset:8192
v_mfma_f32_16x16x32_bf16 a[160:163], v[228:231], v[100:103], a[160:163]
v_mfma_f32_16x16x32_bf16 a[164:167], v[228:231], v[108:111], a[164:167]
ds_read_b64_tr_b16 v[202:203], v245 offset:10240
buffer_load_dwordx4 v[80:83], v253, s[20:23], s66 offen sc1
v_mfma_f32_16x16x32_bf16 a[164:167], v[224:227], v[104:107], a[164:167]
v_mfma_f32_16x16x32_bf16 a[168:171], v[224:227], v[112:115], a[168:171]
ds_read_b64_tr_b16 v[204:205], v245 offset:12288
v_mfma_f32_16x16x32_bf16 a[168:171], v[228:231], v[116:119], a[168:171]
v_mfma_f32_16x16x32_bf16 a[172:175], v[228:231], v[124:127], a[172:175]
ds_read_b64_tr_b16 v[206:207], v245 offset:14336
v_mfma_f32_16x16x32_bf16 a[172:175], v[224:227], v[120:123], a[172:175]
s_waitcnt lgkmcnt(8)
v_mfma_f32_16x16x32_bf16 a[176:179], v[232:235], v[96:99], a[176:179]
buffer_load_dwordx4 v[84:87], v253, s[20:23], s66 offen offset:1024 sc1
v_mfma_f32_16x16x32_bf16 a[176:179], v[236:239], v[100:103], a[176:179]
v_mfma_f32_16x16x32_bf16 a[180:183], v[236:239], v[108:111], a[180:183]
v_mfma_f32_16x16x32_bf16 a[180:183], v[232:235], v[104:107], a[180:183]
v_mfma_f32_16x16x32_bf16 a[184:187], v[232:235], v[112:115], a[184:187]
v_mfma_f32_16x16x32_bf16 a[184:187], v[236:239], v[116:119], a[184:187]
v_mfma_f32_16x16x32_bf16 a[188:191], v[236:239], v[124:127], a[188:191]
s_waitcnt vmcnt(22) lgkmcnt(0)
s_barrier
v_mfma_f32_16x16x32_bf16 a[188:191], v[232:235], v[120:123], a[188:191]
s_waitcnt lgkmcnt(0)
ds_read_b64_tr_b16 v[208:209], v242
buffer_load_dwordx4 v[88:91], v254, s[20:23], s66 offen sc1
v_mfma_f32_16x16x32_bf16 v[160:163], v[192:195], v[96:99], v[160:163]
ds_read_b64_tr_b16 v[210:211], v242 offset:6144
v_mfma_f32_16x16x32_bf16 v[160:163], v[196:199], v[100:103], v[160:163]
ds_read_b64_tr_b16 v[212:213], v242 offset:12288
v_mfma_f32_16x16x32_bf16 v[164:167], v[196:199], v[108:111], v[164:167]
ds_read_b64_tr_b16 v[214:215], v242 offset:18432
v_mfma_f32_16x16x32_bf16 v[164:167], v[192:195], v[104:107], v[164:167]
v_mfma_f32_16x16x32_bf16 v[168:171], v[192:195], v[112:115], v[168:171]
ds_read_b64_tr_b16 v[216:217], v242 offset:8
v_mfma_f32_16x16x32_bf16 v[168:171], v[196:199], v[116:119], v[168:171]
ds_read_b64_tr_b16 v[218:219], v242 offset:6152
v_mfma_f32_16x16x32_bf16 v[172:175], v[196:199], v[124:127], v[172:175]
ds_read_b64_tr_b16 v[220:221], v242 offset:12296
buffer_load_dwordx4 v[92:95], v254, s[20:23], s66 offen offset:1024 sc1
v_mfma_f32_16x16x32_bf16 v[172:175], v[192:195], v[120:123], v[172:175]
s_waitcnt lgkmcnt(7)
s_add_u32 s66, s66, 2048
ds_read_b64_tr_b16 v[222:223], v242 offset:18440
v_mfma_f32_16x16x32_bf16 v[176:179], v[200:203], v[96:99], v[176:179]
v_mfma_f32_16x16x32_bf16 v[176:179], v[204:207], v[100:103], v[176:179]
ds_read_b64_tr_b16 v[224:225], v243
v_mfma_f32_16x16x32_bf16 v[180:183], v[204:207], v[108:111], v[180:183]
ds_read_b64_tr_b16 v[226:227], v243 offset:6144
v_mfma_f32_16x16x32_bf16 v[180:183], v[200:203], v[104:107], v[180:183]
ds_read_b64_tr_b16 v[228:229], v243 offset:12288
v_mfma_f32_16x16x32_bf16 v[184:187], v[200:203], v[112:115], v[184:187]
ds_read_b64_tr_b16 v[230:231], v243 offset:18432
v_mfma_f32_16x16x32_bf16 v[184:187], v[204:207], v[116:119], v[184:187]
v_mfma_f32_16x16x32_bf16 v[188:191], v[204:207], v[124:127], v[188:191]
s_waitcnt vmcnt(16)
v_mfma_f32_16x16x32_bf16 v[188:191], v[200:203], v[120:123], v[188:191]
s_waitcnt lgkmcnt(8)
v_mfma_f32_16x16x32_bf16 a[0:3], v[208:211], v[128:131], a[0:3]
s_add_u32 m0, s68, 98304
ds_read_b64_tr_b16 v[232:233], v243 offset:8
v_mfma_f32_16x16x32_bf16 a[0:3], v[212:215], v[132:135], a[0:3]
buffer_load_dwordx4 v247, s[12:15], s64 offen lds
v_mfma_f32_16x16x32_bf16 a[4:7], v[212:215], v[140:143], a[4:7]
ds_read_b64_tr_b16 v[234:235], v243 offset:6152
v_mfma_f32_16x16x32_bf16 a[4:7], v[208:211], v[136:139], a[4:7]
v_mfma_f32_16x16x32_bf16 a[8:11], v[208:211], v[144:147], a[8:11]
ds_read_b64_tr_b16 v[236:237], v243 offset:12296
v_mfma_f32_16x16x32_bf16 a[8:11], v[212:215], v[148:151], a[8:11]
v_mfma_f32_16x16x32_bf16 a[12:15], v[212:215], v[156:159], a[12:15]
ds_read_b64_tr_b16 v[238:239], v243 offset:18440
v_mfma_f32_16x16x32_bf16 a[12:15], v[208:211], v[152:155], a[12:15]
s_waitcnt lgkmcnt(8)
buffer_load_dwordx4 v248, s[12:15], s64 offen offset:1024 lds
v_mfma_f32_16x16x32_bf16 a[16:19], v[216:219], v[128:131], a[16:19]
ds_read_b64_tr_b16 v[192:193], v242 offset:128
v_mfma_f32_16x16x32_bf16 a[16:19], v[220:223], v[132:135], a[16:19]
v_mfma_f32_16x16x32_bf16 a[20:23], v[220:223], v[140:143], a[20:23]
ds_read_b64_tr_b16 v[194:195], v242 offset:6272
v_mfma_f32_16x16x32_bf16 a[20:23], v[216:219], v[136:139], a[20:23]
v_mfma_f32_16x16x32_bf16 a[24:27], v[216:219], v[144:147], a[24:27]
ds_read_b64_tr_b16 v[196:197], v242 offset:12416
v_mfma_f32_16x16x32_bf16 a[24:27], v[220:223], v[148:151], a[24:27]
v_mfma_f32_16x16x32_bf16 a[28:31], v[220:223], v[156:159], a[28:31]
ds_read_b64_tr_b16 v[198:199], v242 offset:18560
buffer_load_dwordx4 v249, s[12:15], s64 offen offset:2048 lds
v_mfma_f32_16x16x32_bf16 a[28:31], v[216:219], v[152:155], a[28:31]
s_waitcnt lgkmcnt(8)
s_add_u32 s64, s64, 98304
s_add_u32 m0, s68, 101376
v_mfma_f32_16x16x32_bf16 a[32:35], v[224:227], v[128:131], a[32:35]
ds_read_b64_tr_b16 v[200:201], v242 offset:136
v_mfma_f32_16x16x32_bf16 a[32:35], v[228:231], v[132:135], a[32:35]
v_mfma_f32_16x16x32_bf16 a[36:39], v[228:231], v[140:143], a[36:39]
ds_read_b64_tr_b16 v[202:203], v242 offset:6280
v_mfma_f32_16x16x32_bf16 a[36:39], v[224:227], v[136:139], a[36:39]
v_mfma_f32_16x16x32_bf16 a[40:43], v[224:227], v[144:147], a[40:43]
ds_read_b64_tr_b16 v[204:205], v242 offset:12424
v_mfma_f32_16x16x32_bf16 a[40:43], v[228:231], v[148:151], a[40:43]
buffer_load_dwordx4 v247, s[12:15], s64 offen lds
v_mfma_f32_16x16x32_bf16 a[44:47], v[228:231], v[156:159], a[44:47]
ds_read_b64_tr_b16 v[206:207], v242 offset:18568
v_mfma_f32_16x16x32_bf16 a[44:47], v[224:227], v[152:155], a[44:47]
s_waitcnt lgkmcnt(8)
v_mfma_f32_16x16x32_bf16 a[48:51], v[232:235], v[128:131], a[48:51]
ds_read_b64_tr_b16 v[208:209], v243 offset:128
v_mfma_f32_16x16x32_bf16 a[48:51], v[236:239], v[132:135], a[48:51]
v_mfma_f32_16x16x32_bf16 a[52:55], v[236:239], v[140:143], a[52:55]
ds_read_b64_tr_b16 v[210:211], v243 offset:6272
v_mfma_f32_16x16x32_bf16 a[52:55], v[232:235], v[136:139], a[52:55]
v_mfma_f32_16x16x32_bf16 a[56:59], v[232:235], v[144:147], a[56:59]
ds_read_b64_tr_b16 v[212:213], v243 offset:12416
buffer_load_dwordx4 v248, s[12:15], s64 offen offset:1024 lds
v_mfma_f32_16x16x32_bf16 a[56:59], v[236:239], v[148:151], a[56:59]
v_mfma_f32_16x16x32_bf16 a[60:63], v[236:239], v[156:159], a[60:63]
ds_read_b64_tr_b16 v[214:215], v243 offset:18560
v_mfma_f32_16x16x32_bf16 a[60:63], v[232:235], v[152:155], a[60:63]
s_waitcnt lgkmcnt(8)
v_mfma_f32_16x16x32_bf16 a[64:67], v[192:195], v[128:131], a[64:67]
ds_read_b64_tr_b16 v[216:217], v243 offset:136
v_mfma_f32_16x16x32_bf16 a[64:67], v[196:199], v[132:135], a[64:67]
v_mfma_f32_16x16x32_bf16 a[68:71], v[196:199], v[140:143], a[68:71]
ds_read_b64_tr_b16 v[218:219], v243 offset:6280
buffer_load_dwordx4 v249, s[12:15], s64 offen offset:2048 lds
v_mfma_f32_16x16x32_bf16 a[68:71], v[192:195], v[136:139], a[68:71]
s_add_u32 s64, s64, 688128
s_add_u32 m0, s61, 57344
v_mfma_f32_16x16x32_bf16 a[72:75], v[192:195], v[144:147], a[72:75]
ds_read_b64_tr_b16 v[220:221], v243 offset:12424
v_mfma_f32_16x16x32_bf16 a[72:75], v[196:199], v[148:151], a[72:75]
v_mfma_f32_16x16x32_bf16 a[76:79], v[196:199], v[156:159], a[76:79]
ds_read_b64_tr_b16 v[222:223], v243 offset:18568
v_mfma_f32_16x16x32_bf16 a[76:79], v[192:195], v[152:155], a[76:79]
s_waitcnt lgkmcnt(8)
v_mfma_f32_16x16x32_bf16 a[80:83], v[200:203], v[128:131], a[80:83]
ds_read_b64_tr_b16 v[224:225], v242 offset:256
v_mfma_f32_16x16x32_bf16 a[80:83], v[204:207], v[132:135], a[80:83]
buffer_load_dwordx4 v250, s[16:19], s65 offen lds
v_mfma_f32_16x16x32_bf16 a[84:87], v[204:207], v[140:143], a[84:87]
s_add_u32 s65, s65, 23552
ds_read_b64_tr_b16 v[226:227], v242 offset:6400
v_mfma_f32_16x16x32_bf16 a[84:87], v[200:203], v[136:139], a[84:87]
v_mfma_f32_16x16x32_bf16 a[88:91], v[200:203], v[144:147], a[88:91]
ds_read_b64_tr_b16 v[228:229], v242 offset:12544
v_mfma_f32_16x16x32_bf16 a[88:91], v[204:207], v[148:151], a[88:91]
v_mfma_f32_16x16x32_bf16 a[92:95], v[204:207], v[156:159], a[92:95]
ds_read_b64_tr_b16 v[230:231], v242 offset:18688
v_mfma_f32_16x16x32_bf16 a[92:95], v[200:203], v[152:155], a[92:95]
s_waitcnt lgkmcnt(8)
v_mfma_f32_16x16x32_bf16 a[96:99], v[208:211], v[128:131], a[96:99]
ds_read_b64_tr_b16 v[232:233], v242 offset:264
buffer_load_dwordx4 v250, s[16:19], s65 offen offset:1024 lds
v_mfma_f32_16x16x32_bf16 a[96:99], v[212:215], v[132:135], a[96:99]
s_add_u32 s65, s65, 173056
v_mfma_f32_16x16x32_bf16 a[100:103], v[212:215], v[140:143], a[100:103]
ds_read_b64_tr_b16 v[234:235], v242 offset:6408
v_mfma_f32_16x16x32_bf16 a[100:103], v[208:211], v[136:139], a[100:103]
v_mfma_f32_16x16x32_bf16 a[104:107], v[208:211], v[144:147], a[104:107]
ds_read_b64_tr_b16 v[236:237], v242 offset:12552
v_mfma_f32_16x16x32_bf16 a[104:107], v[212:215], v[148:151], a[104:107]
v_mfma_f32_16x16x32_bf16 a[108:111], v[212:215], v[156:159], a[108:111]
ds_read_b64_tr_b16 v[238:239], v242 offset:18696
v_mfma_f32_16x16x32_bf16 a[108:111], v[208:211], v[152:155], a[108:111]
s_waitcnt lgkmcnt(8)
buffer_load_dwordx4 v[96:99], v251, s[20:23], s66 offen sc1
v_mfma_f32_16x16x32_bf16 a[112:115], v[216:219], v[128:131], a[112:115]
ds_read_b64_tr_b16 v[192:193], v243 offset:256
v_mfma_f32_16x16x32_bf16 a[112:115], v[220:223], v[132:135], a[112:115]
v_mfma_f32_16x16x32_bf16 a[116:119], v[220:223], v[140:143], a[116:119]
ds_read_b64_tr_b16 v[194:195], v243 offset:6400
v_mfma_f32_16x16x32_bf16 a[116:119], v[216:219], v[136:139], a[116:119]
v_mfma_f32_16x16x32_bf16 a[120:123], v[216:219], v[144:147], a[120:123]
ds_read_b64_tr_b16 v[196:197], v243 offset:12544
v_mfma_f32_16x16x32_bf16 a[120:123], v[220:223], v[148:151], a[120:123]
buffer_load_dwordx4 v[100:103], v251, s[20:23], s66 offen offset:1024 sc1
v_mfma_f32_16x16x32_bf16 a[124:127], v[220:223], v[156:159], a[124:127]
ds_read_b64_tr_b16 v[198:199], v243 offset:18688
v_mfma_f32_16x16x32_bf16 a[124:127], v[216:219], v[152:155], a[124:127]
s_waitcnt lgkmcnt(8)
v_mfma_f32_16x16x32_bf16 a[128:131], v[224:227], v[128:131], a[128:131]
ds_read_b64_tr_b16 v[200:201], v243 offset:264
v_mfma_f32_16x16x32_bf16 a[128:131], v[228:231], v[132:135], a[128:131]
v_mfma_f32_16x16x32_bf16 a[132:135], v[228:231], v[140:143], a[132:135]
ds_read_b64_tr_b16 v[202:203], v243 offset:6408
v_mfma_f32_16x16x32_bf16 a[132:135], v[224:227], v[136:139], a[132:135]
v_mfma_f32_16x16x32_bf16 a[136:139], v[224:227], v[144:147], a[136:139]
ds_read_b64_tr_b16 v[204:205], v243 offset:12552
buffer_load_dwordx4 v[104:107], v252, s[20:23], s66 offen sc1
v_mfma_f32_16x16x32_bf16 a[136:139], v[228:231], v[148:151], a[136:139]
v_mfma_f32_16x16x32_bf16 a[140:143], v[228:231], v[156:159], a[140:143]
ds_read_b64_tr_b16 v[206:207], v243 offset:18696
v_mfma_f32_16x16x32_bf16 a[140:143], v[224:227], v[152:155], a[140:143]
s_waitcnt lgkmcnt(8)
v_mfma_f32_16x16x32_bf16 a[144:147], v[232:235], v[128:131], a[144:147]
ds_read_b64_tr_b16 v[208:209], v244 offset:16384
v_mfma_f32_16x16x32_bf16 a[144:147], v[236:239], v[132:135], a[144:147]
v_mfma_f32_16x16x32_bf16 a[148:151], v[236:239], v[140:143], a[148:151]
ds_read_b64_tr_b16 v[210:211], v244 offset:18432
v_mfma_f32_16x16x32_bf16 a[148:151], v[232:235], v[136:139], a[148:151]
buffer_load_dwordx4 v[108:111], v252, s[20:23], s66 offen offset:1024 sc1
v_mfma_f32_16x16x32_bf16 a[152:155], v[232:235], v[144:147], a[152:155]
ds_read_b64_tr_b16 v[212:213], v244 offset:20480
v_mfma_f32_16x16x32_bf16 a[152:155], v[236:239], v[148:151], a[152:155]
v_mfma_f32_16x16x32_bf16 a[156:159], v[236:239], v[156:159], a[156:159]
ds_read_b64_tr_b16 v[214:215], v244 offset:22528
v_mfma_f32_16x16x32_bf16 a[156:159], v[232:235], v[152:155], a[156:159]
s_waitcnt lgkmcnt(8)
v_mfma_f32_16x16x32_bf16 a[160:163], v[192:195], v[128:131], a[160:163]
ds_read_b64_tr_b16 v[216:217], v245 offset:16384
v_mfma_f32_16x16x32_bf16 a[160:163], v[196:199], v[132:135], a[160:163]
v_mfma_f32_16x16x32_bf16 a[164:167], v[196:199], v[140:143], a[164:167]
ds_read_b64_tr_b16 v[218:219], v245 offset:18432
buffer_load_dwordx4 v[112:115], v253, s[20:23], s66 offen sc1
v_mfma_f32_16x16x32_bf16 a[164:167], v[192:195], v[136:139], a[164:167]
v_mfma_f32_16x16x32_bf16 a[168:171], v[192:195], v[144:147], a[168:171]
ds_read_b64_tr_b16 v[220:221], v245 offset:20480
v_mfma_f32_16x16x32_bf16 a[168:171], v[196:199], v[148:151], a[168:171]
v_mfma_f32_16x16x32_bf16 a[172:175], v[196:199], v[156:159], a[172:175]
ds_read_b64_tr_b16 v[222:223], v245 offset:22528
v_mfma_f32_16x16x32_bf16 a[172:175], v[192:195], v[152:155], a[172:175]
s_waitcnt lgkmcnt(8)
v_mfma_f32_16x16x32_bf16 a[176:179], v[200:203], v[128:131], a[176:179]
buffer_load_dwordx4 v[116:119], v253, s[20:23], s66 offen offset:1024 sc1
v_mfma_f32_16x16x32_bf16 a[176:179], v[204:207], v[132:135], a[176:179]
v_mfma_f32_16x16x32_bf16 a[180:183], v[204:207], v[140:143], a[180:183]
v_mfma_f32_16x16x32_bf16 a[180:183], v[200:203], v[136:139], a[180:183]
v_mfma_f32_16x16x32_bf16 a[184:187], v[200:203], v[144:147], a[184:187]
v_mfma_f32_16x16x32_bf16 a[184:187], v[204:207], v[148:151], a[184:187]
v_mfma_f32_16x16x32_bf16 a[188:191], v[204:207], v[156:159], a[188:191]
s_waitcnt vmcnt(22) lgkmcnt(0)
s_barrier
v_mfma_f32_16x16x32_bf16 a[188:191], v[200:203], v[152:155], a[188:191]
s_waitcnt lgkmcnt(0)
ds_read_b64_tr_b16 v[224:225], v240
buffer_load_dwordx4 v[120:123], v254, s[20:23], s66 offen sc1
v_mfma_f32_16x16x32_bf16 v[160:163], v[208:211], v[128:131], v[160:163]
ds_read_b64_tr_b16 v[226:227], v240 offset:6144
v_mfma_f32_16x16x32_bf16 v[160:163], v[212:215], v[132:135], v[160:163]
ds_read_b64_tr_b16 v[228:229], v240 offset:12288
v_mfma_f32_16x16x32_bf16 v[164:167], v[212:215], v[140:143], v[164:167]
ds_read_b64_tr_b16 v[230:231], v240 offset:18432
v_mfma_f32_16x16x32_bf16 v[164:167], v[208:211], v[136:139], v[164:167]
v_mfma_f32_16x16x32_bf16 v[168:171], v[208:211], v[144:147], v[168:171]
ds_read_b64_tr_b16 v[232:233], v240 offset:8
v_mfma_f32_16x16x32_bf16 v[168:171], v[212:215], v[148:151], v[168:171]
ds_read_b64_tr_b16 v[234:235], v240 offset:6152
v_mfma_f32_16x16x32_bf16 v[172:175], v[212:215], v[156:159], v[172:175]
ds_read_b64_tr_b16 v[236:237], v240 offset:12296
buffer_load_dwordx4 v[124:127], v254, s[20:23], s66 offen offset:1024 sc1
v_mfma_f32_16x16x32_bf16 v[172:175], v[208:211], v[152:155], v[172:175]
s_waitcnt lgkmcnt(7)
s_add_u32 s66, s66, 2048
ds_read_b64_tr_b16 v[238:239], v240 offset:18440
v_mfma_f32_16x16x32_bf16 v[176:179], v[216:219], v[128:131], v[176:179]
v_mfma_f32_16x16x32_bf16 v[176:179], v[220:223], v[132:135], v[176:179]
ds_read_b64_tr_b16 v[192:193], v241
v_mfma_f32_16x16x32_bf16 v[180:183], v[220:223], v[140:143], v[180:183]
ds_read_b64_tr_b16 v[194:195], v241 offset:6144
v_mfma_f32_16x16x32_bf16 v[180:183], v[216:219], v[136:139], v[180:183]
ds_read_b64_tr_b16 v[196:197], v241 offset:12288
v_mfma_f32_16x16x32_bf16 v[184:187], v[216:219], v[144:147], v[184:187]
ds_read_b64_tr_b16 v[198:199], v241 offset:18432
v_mfma_f32_16x16x32_bf16 v[184:187], v[220:223], v[148:151], v[184:187]
v_mfma_f32_16x16x32_bf16 v[188:191], v[220:223], v[156:159], v[188:191]
s_waitcnt vmcnt(16)
v_mfma_f32_16x16x32_bf16 v[188:191], v[216:219], v[152:155], v[188:191]
s_waitcnt lgkmcnt(8)
v_mfma_f32_16x16x32_bf16 a[0:3], v[224:227], v[64:67], a[0:3]
s_add_u32 m0, s68, 122880
ds_read_b64_tr_b16 v[200:201], v241 offset:8
v_mfma_f32_16x16x32_bf16 a[0:3], v[228:231], v[68:71], a[0:3]
buffer_load_dwordx4 v247, s[12:15], s64 offen lds
v_mfma_f32_16x16x32_bf16 a[4:7], v[228:231], v[76:79], a[4:7]
ds_read_b64_tr_b16 v[202:203], v241 offset:6152
v_mfma_f32_16x16x32_bf16 a[4:7], v[224:227], v[72:75], a[4:7]
v_mfma_f32_16x16x32_bf16 a[8:11], v[224:227], v[80:83], a[8:11]
ds_read_b64_tr_b16 v[204:205], v241 offset:12296
v_mfma_f32_16x16x32_bf16 a[8:11], v[228:231], v[84:87], a[8:11]
v_mfma_f32_16x16x32_bf16 a[12:15], v[228:231], v[92:95], a[12:15]
ds_read_b64_tr_b16 v[206:207], v241 offset:18440
v_mfma_f32_16x16x32_bf16 a[12:15], v[224:227], v[88:91], a[12:15]
s_waitcnt lgkmcnt(8)
buffer_load_dwordx4 v248, s[12:15], s64 offen offset:1024 lds
v_mfma_f32_16x16x32_bf16 a[16:19], v[232:235], v[64:67], a[16:19]
ds_read_b64_tr_b16 v[208:209], v240 offset:128
v_mfma_f32_16x16x32_bf16 a[16:19], v[236:239], v[68:71], a[16:19]
v_mfma_f32_16x16x32_bf16 a[20:23], v[236:239], v[76:79], a[20:23]
ds_read_b64_tr_b16 v[210:211], v240 offset:6272
v_mfma_f32_16x16x32_bf16 a[20:23], v[232:235], v[72:75], a[20:23]
v_mfma_f32_16x16x32_bf16 a[24:27], v[232:235], v[80:83], a[24:27]
ds_read_b64_tr_b16 v[212:213], v240 offset:12416
v_mfma_f32_16x16x32_bf16 a[24:27], v[236:239], v[84:87], a[24:27]
v_mfma_f32_16x16x32_bf16 a[28:31], v[236:239], v[92:95], a[28:31]
ds_read_b64_tr_b16 v[214:215], v240 offset:18560
buffer_load_dwordx4 v249, s[12:15], s64 offen offset:2048 lds
v_mfma_f32_16x16x32_bf16 a[28:31], v[232:235], v[88:91], a[28:31]
s_waitcnt lgkmcnt(8)
s_add_u32 s64, s64, 98304
s_add_u32 m0, s68, 125952
v_mfma_f32_16x16x32_bf16 a[32:35], v[192:195], v[64:67], a[32:35]
ds_read_b64_tr_b16 v[216:217], v240 offset:136
v_mfma_f32_16x16x32_bf16 a[32:35], v[196:199], v[68:71], a[32:35]
v_mfma_f32_16x16x32_bf16 a[36:39], v[196:199], v[76:79], a[36:39]
ds_read_b64_tr_b16 v[218:219], v240 offset:6280
v_mfma_f32_16x16x32_bf16 a[36:39], v[192:195], v[72:75], a[36:39]
v_mfma_f32_16x16x32_bf16 a[40:43], v[192:195], v[80:83], a[40:43]
ds_read_b64_tr_b16 v[220:221], v240 offset:12424
v_mfma_f32_16x16x32_bf16 a[40:43], v[196:199], v[84:87], a[40:43]
buffer_load_dwordx4 v247, s[12:15], s64 offen lds
v_mfma_f32_16x16x32_bf16 a[44:47], v[196:199], v[92:95], a[44:47]
ds_read_b64_tr_b16 v[222:223], v240 offset:18568
v_mfma_f32_16x16x32_bf16 a[44:47], v[192:195], v[88:91], a[44:47]
s_waitcnt lgkmcnt(8)
v_mfma_f32_16x16x32_bf16 a[48:51], v[200:203], v[64:67], a[48:51]
ds_read_b64_tr_b16 v[224:225], v241 offset:128
v_mfma_f32_16x16x32_bf16 a[48:51], v[204:207], v[68:71], a[48:51]
v_mfma_f32_16x16x32_bf16 a[52:55], v[204:207], v[76:79], a[52:55]
ds_read_b64_tr_b16 v[226:227], v241 offset:6272
v_mfma_f32_16x16x32_bf16 a[52:55], v[200:203], v[72:75], a[52:55]
v_mfma_f32_16x16x32_bf16 a[56:59], v[200:203], v[80:83], a[56:59]
ds_read_b64_tr_b16 v[228:229], v241 offset:12416
buffer_load_dwordx4 v248, s[12:15], s64 offen offset:1024 lds
v_mfma_f32_16x16x32_bf16 a[56:59], v[204:207], v[84:87], a[56:59]
v_mfma_f32_16x16x32_bf16 a[60:63], v[204:207], v[92:95], a[60:63]
ds_read_b64_tr_b16 v[230:231], v241 offset:18560
v_mfma_f32_16x16x32_bf16 a[60:63], v[200:203], v[88:91], a[60:63]
s_waitcnt lgkmcnt(8)
v_mfma_f32_16x16x32_bf16 a[64:67], v[208:211], v[64:67], a[64:67]
ds_read_b64_tr_b16 v[232:233], v241 offset:136
v_mfma_f32_16x16x32_bf16 a[64:67], v[212:215], v[68:71], a[64:67]
v_mfma_f32_16x16x32_bf16 a[68:71], v[212:215], v[76:79], a[68:71]
ds_read_b64_tr_b16 v[234:235], v241 offset:6280
buffer_load_dwordx4 v249, s[12:15], s64 offen offset:2048 lds
v_mfma_f32_16x16x32_bf16 a[68:71], v[208:211], v[72:75], a[68:71]
s_add_u32 s64, s64, 688128
s_add_u32 m0, s61, 65536
v_mfma_f32_16x16x32_bf16 a[72:75], v[208:211], v[80:83], a[72:75]
ds_read_b64_tr_b16 v[236:237], v241 offset:12424
v_mfma_f32_16x16x32_bf16 a[72:75], v[212:215], v[84:87], a[72:75]
v_mfma_f32_16x16x32_bf16 a[76:79], v[212:215], v[92:95], a[76:79]
ds_read_b64_tr_b16 v[238:239], v241 offset:18568
v_mfma_f32_16x16x32_bf16 a[76:79], v[208:211], v[88:91], a[76:79]
s_waitcnt lgkmcnt(8)
v_mfma_f32_16x16x32_bf16 a[80:83], v[216:219], v[64:67], a[80:83]
ds_read_b64_tr_b16 v[192:193], v240 offset:256
v_mfma_f32_16x16x32_bf16 a[80:83], v[220:223], v[68:71], a[80:83]
buffer_load_dwordx4 v250, s[16:19], s65 offen lds
v_mfma_f32_16x16x32_bf16 a[84:87], v[220:223], v[76:79], a[84:87]
s_add_u32 s65, s65, 23552
ds_read_b64_tr_b16 v[194:195], v240 offset:6400
v_mfma_f32_16x16x32_bf16 a[84:87], v[216:219], v[72:75], a[84:87]
v_mfma_f32_16x16x32_bf16 a[88:91], v[216:219], v[80:83], a[88:91]
ds_read_b64_tr_b16 v[196:197], v240 offset:12544
v_mfma_f32_16x16x32_bf16 a[88:91], v[220:223], v[84:87], a[88:91]
v_mfma_f32_16x16x32_bf16 a[92:95], v[220:223], v[92:95], a[92:95]
ds_read_b64_tr_b16 v[198:199], v240 offset:18688
v_mfma_f32_16x16x32_bf16 a[92:95], v[216:219], v[88:91], a[92:95]
s_waitcnt lgkmcnt(8)
v_mfma_f32_16x16x32_bf16 a[96:99], v[224:227], v[64:67], a[96:99]
ds_read_b64_tr_b16 v[200:201], v240 offset:264
buffer_load_dwordx4 v250, s[16:19], s65 offen offset:1024 lds
v_mfma_f32_16x16x32_bf16 a[96:99], v[228:231], v[68:71], a[96:99]
s_add_u32 s65, s65, 173056
v_mfma_f32_16x16x32_bf16 a[100:103], v[228:231], v[76:79], a[100:103]
ds_read_b64_tr_b16 v[202:203], v240 offset:6408
v_mfma_f32_16x16x32_bf16 a[100:103], v[224:227], v[72:75], a[100:103]
v_mfma_f32_16x16x32_bf16 a[104:107], v[224:227], v[80:83], a[104:107]
ds_read_b64_tr_b16 v[204:205], v240 offset:12552
v_mfma_f32_16x16x32_bf16 a[104:107], v[228:231], v[84:87], a[104:107]
v_mfma_f32_16x16x32_bf16 a[108:111], v[228:231], v[92:95], a[108:111]
ds_read_b64_tr_b16 v[206:207], v240 offset:18696
v_mfma_f32_16x16x32_bf16 a[108:111], v[224:227], v[88:91], a[108:111]
s_waitcnt lgkmcnt(8)
buffer_load_dwordx4 v[128:131], v251, s[20:23], s66 offen sc1
v_mfma_f32_16x16x32_bf16 a[112:115], v[232:235], v[64:67], a[112:115]
ds_read_b64_tr_b16 v[208:209], v241 offset:256
v_mfma_f32_16x16x32_bf16 a[112:115], v[236:239], v[68:71], a[112:115]
v_mfma_f32_16x16x32_bf16 a[116:119], v[236:239], v[76:79], a[116:119]
ds_read_b64_tr_b16 v[210:211], v241 offset:6400
v_mfma_f32_16x16x32_bf16 a[116:119], v[232:235], v[72:75], a[116:119]
v_mfma_f32_16x16x32_bf16 a[120:123], v[232:235], v[80:83], a[120:123]
ds_read_b64_tr_b16 v[212:213], v241 offset:12544
v_mfma_f32_16x16x32_bf16 a[120:123], v[236:239], v[84:87], a[120:123]
buffer_load_dwordx4 v[132:135], v251, s[20:23], s66 offen offset:1024 sc1
v_mfma_f32_16x16x32_bf16 a[124:127], v[236:239], v[92:95], a[124:127]
ds_read_b64_tr_b16 v[214:215], v241 offset:18688
v_mfma_f32_16x16x32_bf16 a[124:127], v[232:235], v[88:91], a[124:127]
s_waitcnt lgkmcnt(8)
v_mfma_f32_16x16x32_bf16 a[128:131], v[192:195], v[64:67], a[128:131]
ds_read_b64_tr_b16 v[216:217], v241 offset:264
v_mfma_f32_16x16x32_bf16 a[128:131], v[196:199], v[68:71], a[128:131]
v_mfma_f32_16x16x32_bf16 a[132:135], v[196:199], v[76:79], a[132:135]
ds_read_b64_tr_b16 v[218:219], v241 offset:6408
v_mfma_f32_16x16x32_bf16 a[132:135], v[192:195], v[72:75], a[132:135]
v_mfma_f32_16x16x32_bf16 a[136:139], v[192:195], v[80:83], a[136:139]
ds_read_b64_tr_b16 v[220:221], v241 offset:12552
buffer_load_dwordx4 v[136:139], v252, s[20:23], s66 offen sc1
v_mfma_f32_16x16x32_bf16 a[136:139], v[196:199], v[84:87], a[136:139]
v_mfma_f32_16x16x32_bf16 a[140:143], v[196:199], v[92:95], a[140:143]
ds_read_b64_tr_b16 v[222:223], v241 offset:18696
v_mfma_f32_16x16x32_bf16 a[140:143], v[192:195], v[88:91], a[140:143]
s_waitcnt lgkmcnt(8)
v_mfma_f32_16x16x32_bf16 a[144:147], v[200:203], v[64:67], a[144:147]
ds_read_b64_tr_b16 v[224:225], v244
v_mfma_f32_16x16x32_bf16 a[144:147], v[204:207], v[68:71], a[144:147]
v_mfma_f32_16x16x32_bf16 a[148:151], v[204:207], v[76:79], a[148:151]
ds_read_b64_tr_b16 v[226:227], v244 offset:2048
v_mfma_f32_16x16x32_bf16 a[148:151], v[200:203], v[72:75], a[148:151]
buffer_load_dwordx4 v[140:143], v252, s[20:23], s66 offen offset:1024 sc1
v_mfma_f32_16x16x32_bf16 a[152:155], v[200:203], v[80:83], a[152:155]
ds_read_b64_tr_b16 v[228:229], v244 offset:4096
v_mfma_f32_16x16x32_bf16 a[152:155], v[204:207], v[84:87], a[152:155]
v_mfma_f32_16x16x32_bf16 a[156:159], v[204:207], v[92:95], a[156:159]
ds_read_b64_tr_b16 v[230:231], v244 offset:6144
v_mfma_f32_16x16x32_bf16 a[156:159], v[200:203], v[88:91], a[156:159]
s_waitcnt lgkmcnt(8)
v_mfma_f32_16x16x32_bf16 a[160:163], v[208:211], v[64:67], a[160:163]
ds_read_b64_tr_b16 v[232:233], v245
v_mfma_f32_16x16x32_bf16 a[160:163], v[212:215], v[68:71], a[160:163]
v_mfma_f32_16x16x32_bf16 a[164:167], v[212:215], v[76:79], a[164:167]
ds_read_b64_tr_b16 v[234:235], v245 offset:2048
buffer_load_dwordx4 v[144:147], v253, s[20:23], s66 offen sc1
v_mfma_f32_16x16x32_bf16 a[164:167], v[208:211], v[72:75], a[164:167]
v_mfma_f32_16x16x32_bf16 a[168:171], v[208:211], v[80:83], a[168:171]
ds_read_b64_tr_b16 v[236:237], v245 offset:4096
v_mfma_f32_16x16x32_bf16 a[168:171], v[212:215], v[84:87], a[168:171]
v_mfma_f32_16x16x32_bf16 a[172:175], v[212:215], v[92:95], a[172:175]
ds_read_b64_tr_b16 v[238:239], v245 offset:6144
v_mfma_f32_16x16x32_bf16 a[172:175], v[208:211], v[88:91], a[172:175]
s_waitcnt lgkmcnt(8)
v_mfma_f32_16x16x32_bf16 a[176:179], v[216:219], v[64:67], a[176:179]
buffer_load_dwordx4 v[148:151], v253, s[20:23], s66 offen offset:1024 sc1
v_mfma_f32_16x16x32_bf16 a[176:179], v[220:223], v[68:71], a[176:179]
v_mfma_f32_16x16x32_bf16 a[180:183], v[220:223], v[76:79], a[180:183]
v_mfma_f32_16x16x32_bf16 a[180:183], v[216:219], v[72:75], a[180:183]
v_mfma_f32_16x16x32_bf16 a[184:187], v[216:219], v[80:83], a[184:187]
v_mfma_f32_16x16x32_bf16 a[184:187], v[220:223], v[84:87], a[184:187]
v_mfma_f32_16x16x32_bf16 a[188:191], v[220:223], v[92:95], a[188:191]
s_waitcnt vmcnt(22) lgkmcnt(0)
s_barrier
v_mfma_f32_16x16x32_bf16 a[188:191], v[216:219], v[88:91], a[188:191]
s_waitcnt lgkmcnt(0)
ds_read_b64_tr_b16 v[192:193], v240 offset:24576
buffer_load_dwordx4 v[152:155], v254, s[20:23], s66 offen sc1
v_mfma_f32_16x16x32_bf16 v[160:163], v[224:227], v[64:67], v[160:163]
ds_read_b64_tr_b16 v[194:195], v240 offset:30720
v_mfma_f32_16x16x32_bf16 v[160:163], v[228:231], v[68:71], v[160:163]
ds_read_b64_tr_b16 v[196:197], v240 offset:36864
v_mfma_f32_16x16x32_bf16 v[164:167], v[228:231], v[76:79], v[164:167]
ds_read_b64_tr_b16 v[198:199], v240 offset:43008
v_mfma_f32_16x16x32_bf16 v[164:167], v[224:227], v[72:75], v[164:167]
v_mfma_f32_16x16x32_bf16 v[168:171], v[224:227], v[80:83], v[168:171]
ds_read_b64_tr_b16 v[200:201], v240 offset:24584
v_mfma_f32_16x16x32_bf16 v[168:171], v[228:231], v[84:87], v[168:171]
ds_read_b64_tr_b16 v[202:203], v240 offset:30728
v_mfma_f32_16x16x32_bf16 v[172:175], v[228:231], v[92:95], v[172:175]
ds_read_b64_tr_b16 v[204:205], v240 offset:36872
buffer_load_dwordx4 v[156:159], v254, s[20:23], s66 offen offset:1024 sc1
v_mfma_f32_16x16x32_bf16 v[172:175], v[224:227], v[88:91], v[172:175]
s_waitcnt lgkmcnt(7)
s_add_u32 s66, s66, 2048
ds_read_b64_tr_b16 v[206:207], v240 offset:43016
v_mfma_f32_16x16x32_bf16 v[176:179], v[232:235], v[64:67], v[176:179]
v_mfma_f32_16x16x32_bf16 v[176:179], v[236:239], v[68:71], v[176:179]
ds_read_b64_tr_b16 v[208:209], v241 offset:24576
v_mfma_f32_16x16x32_bf16 v[180:183], v[236:239], v[76:79], v[180:183]
ds_read_b64_tr_b16 v[210:211], v241 offset:30720
v_mfma_f32_16x16x32_bf16 v[180:183], v[232:235], v[72:75], v[180:183]
ds_read_b64_tr_b16 v[212:213], v241 offset:36864
v_mfma_f32_16x16x32_bf16 v[184:187], v[232:235], v[80:83], v[184:187]
ds_read_b64_tr_b16 v[214:215], v241 offset:43008
v_mfma_f32_16x16x32_bf16 v[184:187], v[236:239], v[84:87], v[184:187]
v_mfma_f32_16x16x32_bf16 v[188:191], v[236:239], v[92:95], v[188:191]
s_waitcnt vmcnt(16)
v_mfma_f32_16x16x32_bf16 v[188:191], v[232:235], v[88:91], v[188:191]
s_waitcnt lgkmcnt(8)
v_mfma_f32_16x16x32_bf16 a[0:3], v[192:195], v[96:99], a[0:3]
s_add_u32 m0, s68, 73728
ds_read_b64_tr_b16 v[216:217], v241 offset:24584
v_mfma_f32_16x16x32_bf16 a[0:3], v[196:199], v[100:103], a[0:3]
buffer_load_dwordx4 v247, s[12:15], s64 offen lds
v_mfma_f32_16x16x32_bf16 a[4:7], v[196:199], v[108:111], a[4:7]
ds_read_b64_tr_b16 v[218:219], v241 offset:30728
v_mfma_f32_16x16x32_bf16 a[4:7], v[192:195], v[104:107], a[4:7]
v_mfma_f32_16x16x32_bf16 a[8:11], v[192:195], v[112:115], a[8:11]
ds_read_b64_tr_b16 v[220:221], v241 offset:36872
v_mfma_f32_16x16x32_bf16 a[8:11], v[196:199], v[116:119], a[8:11]
v_mfma_f32_16x16x32_bf16 a[12:15], v[196:199], v[124:127], a[12:15]
ds_read_b64_tr_b16 v[222:223], v241 offset:43016
v_mfma_f32_16x16x32_bf16 a[12:15], v[192:195], v[120:123], a[12:15]
s_waitcnt lgkmcnt(8)
buffer_load_dwordx4 v248, s[12:15], s64 offen offset:1024 lds
v_mfma_f32_16x16x32_bf16 a[16:19], v[200:203], v[96:99], a[16:19]
ds_read_b64_tr_b16 v[224:225], v240 offset:24704
v_mfma_f32_16x16x32_bf16 a[16:19], v[204:207], v[100:103], a[16:19]
v_mfma_f32_16x16x32_bf16 a[20:23], v[204:207], v[108:111], a[20:23]
ds_read_b64_tr_b16 v[226:227], v240 offset:30848
v_mfma_f32_16x16x32_bf16 a[20:23], v[200:203], v[104:107], a[20:23]
v_mfma_f32_16x16x32_bf16 a[24:27], v[200:203], v[112:115], a[24:27]
ds_read_b64_tr_b16 v[228:229], v240 offset:36992
v_mfma_f32_16x16x32_bf16 a[24:27], v[204:207], v[116:119], a[24:27]
v_mfma_f32_16x16x32_bf16 a[28:31], v[204:207], v[124:127], a[28:31]
ds_read_b64_tr_b16 v[230:231], v240 offset:43136
buffer_load_dwordx4 v249, s[12:15], s64 offen offset:2048 lds
v_mfma_f32_16x16x32_bf16 a[28:31], v[200:203], v[120:123], a[28:31]
s_waitcnt lgkmcnt(8)
s_add_u32 s64, s64, 98304
s_add_u32 m0, s68, 76800
v_mfma_f32_16x16x32_bf16 a[32:35], v[208:211], v[96:99], a[32:35]
ds_read_b64_tr_b16 v[232:233], v240 offset:24712
v_mfma_f32_16x16x32_bf16 a[32:35], v[212:215], v[100:103], a[32:35]
v_mfma_f32_16x16x32_bf16 a[36:39], v[212:215], v[108:111], a[36:39]
ds_read_b64_tr_b16 v[234:235], v240 offset:30856
v_mfma_f32_16x16x32_bf16 a[36:39], v[208:211], v[104:107], a[36:39]
v_mfma_f32_16x16x32_bf16 a[40:43], v[208:211], v[112:115], a[40:43]
ds_read_b64_tr_b16 v[236:237], v240 offset:37000
v_mfma_f32_16x16x32_bf16 a[40:43], v[212:215], v[116:119], a[40:43]
buffer_load_dwordx4 v247, s[12:15], s64 offen lds
v_mfma_f32_16x16x32_bf16 a[44:47], v[212:215], v[124:127], a[44:47]
ds_read_b64_tr_b16 v[238:239], v240 offset:43144
v_mfma_f32_16x16x32_bf16 a[44:47], v[208:211], v[120:123], a[44:47]
s_waitcnt lgkmcnt(8)
v_mfma_f32_16x16x32_bf16 a[48:51], v[216:219], v[96:99], a[48:51]
ds_read_b64_tr_b16 v[192:193], v241 offset:24704
v_mfma_f32_16x16x32_bf16 a[48:51], v[220:223], v[100:103], a[48:51]
v_mfma_f32_16x16x32_bf16 a[52:55], v[220:223], v[108:111], a[52:55]
ds_read_b64_tr_b16 v[194:195], v241 offset:30848
v_mfma_f32_16x16x32_bf16 a[52:55], v[216:219], v[104:107], a[52:55]
v_mfma_f32_16x16x32_bf16 a[56:59], v[216:219], v[112:115], a[56:59]
ds_read_b64_tr_b16 v[196:197], v241 offset:36992
buffer_load_dwordx4 v248, s[12:15], s64 offen offset:1024 lds
v_mfma_f32_16x16x32_bf16 a[56:59], v[220:223], v[116:119], a[56:59]
v_mfma_f32_16x16x32_bf16 a[60:63], v[220:223], v[124:127], a[60:63]
ds_read_b64_tr_b16 v[198:199], v241 offset:43136
v_mfma_f32_16x16x32_bf16 a[60:63], v[216:219], v[120:123], a[60:63]
s_waitcnt lgkmcnt(8)
v_mfma_f32_16x16x32_bf16 a[64:67], v[224:227], v[96:99], a[64:67]
ds_read_b64_tr_b16 v[200:201], v241 offset:24712
v_mfma_f32_16x16x32_bf16 a[64:67], v[228:231], v[100:103], a[64:67]
v_mfma_f32_16x16x32_bf16 a[68:71], v[228:231], v[108:111], a[68:71]
ds_read_b64_tr_b16 v[202:203], v241 offset:30856
buffer_load_dwordx4 v249, s[12:15], s64 offen offset:2048 lds
v_mfma_f32_16x16x32_bf16 a[68:71], v[224:227], v[104:107], a[68:71]
s_add_u32 s64, s64, 688128
s_add_u32 m0, s61, 49152
v_mfma_f32_16x16x32_bf16 a[72:75], v[224:227], v[112:115], a[72:75]
ds_read_b64_tr_b16 v[204:205], v241 offset:37000
v_mfma_f32_16x16x32_bf16 a[72:75], v[228:231], v[116:119], a[72:75]
v_mfma_f32_16x16x32_bf16 a[76:79], v[228:231], v[124:127], a[76:79]
ds_read_b64_tr_b16 v[206:207], v241 offset:43144
v_mfma_f32_16x16x32_bf16 a[76:79], v[224:227], v[120:123], a[76:79]
s_waitcnt lgkmcnt(8)
v_mfma_f32_16x16x32_bf16 a[80:83], v[232:235], v[96:99], a[80:83]
ds_read_b64_tr_b16 v[208:209], v240 offset:24832
v_mfma_f32_16x16x32_bf16 a[80:83], v[236:239], v[100:103], a[80:83]
buffer_load_dwordx4 v250, s[16:19], s65 offen lds
v_mfma_f32_16x16x32_bf16 a[84:87], v[236:239], v[108:111], a[84:87]
s_add_u32 s65, s65, 23552
ds_read_b64_tr_b16 v[210:211], v240 offset:30976
v_mfma_f32_16x16x32_bf16 a[84:87], v[232:235], v[104:107], a[84:87]
v_mfma_f32_16x16x32_bf16 a[88:91], v[232:235], v[112:115], a[88:91]
ds_read_b64_tr_b16 v[212:213], v240 offset:37120
v_mfma_f32_16x16x32_bf16 a[88:91], v[236:239], v[116:119], a[88:91]
v_mfma_f32_16x16x32_bf16 a[92:95], v[236:239], v[124:127], a[92:95]
ds_read_b64_tr_b16 v[214:215], v240 offset:43264
v_mfma_f32_16x16x32_bf16 a[92:95], v[232:235], v[120:123], a[92:95]
s_waitcnt lgkmcnt(8)
v_mfma_f32_16x16x32_bf16 a[96:99], v[192:195], v[96:99], a[96:99]
ds_read_b64_tr_b16 v[216:217], v240 offset:24840
buffer_load_dwordx4 v250, s[16:19], s65 offen offset:1024 lds
v_mfma_f32_16x16x32_bf16 a[96:99], v[196:199], v[100:103], a[96:99]
s_add_u32 s65, s65, 173056
v_mfma_f32_16x16x32_bf16 a[100:103], v[196:199], v[108:111], a[100:103]
ds_read_b64_tr_b16 v[218:219], v240 offset:30984
v_mfma_f32_16x16x32_bf16 a[100:103], v[192:195], v[104:107], a[100:103]
v_mfma_f32_16x16x32_bf16 a[104:107], v[192:195], v[112:115], a[104:107]
ds_read_b64_tr_b16 v[220:221], v240 offset:37128
v_mfma_f32_16x16x32_bf16 a[104:107], v[196:199], v[116:119], a[104:107]
v_mfma_f32_16x16x32_bf16 a[108:111], v[196:199], v[124:127], a[108:111]
ds_read_b64_tr_b16 v[222:223], v240 offset:43272
v_mfma_f32_16x16x32_bf16 a[108:111], v[192:195], v[120:123], a[108:111]
s_waitcnt lgkmcnt(8)
buffer_load_dwordx4 v[64:67], v251, s[20:23], s66 offen sc1
v_mfma_f32_16x16x32_bf16 a[112:115], v[200:203], v[96:99], a[112:115]
ds_read_b64_tr_b16 v[224:225], v241 offset:24832
v_mfma_f32_16x16x32_bf16 a[112:115], v[204:207], v[100:103], a[112:115]
v_mfma_f32_16x16x32_bf16 a[116:119], v[204:207], v[108:111], a[116:119]
ds_read_b64_tr_b16 v[226:227], v241 offset:30976
v_mfma_f32_16x16x32_bf16 a[116:119], v[200:203], v[104:107], a[116:119]
v_mfma_f32_16x16x32_bf16 a[120:123], v[200:203], v[112:115], a[120:123]
ds_read_b64_tr_b16 v[228:229], v241 offset:37120
v_mfma_f32_16x16x32_bf16 a[120:123], v[204:207], v[116:119], a[120:123]
buffer_load_dwordx4 v[68:71], v251, s[20:23], s66 offen offset:1024 sc1
v_mfma_f32_16x16x32_bf16 a[124:127], v[204:207], v[124:127], a[124:127]
ds_read_b64_tr_b16 v[230:231], v241 offset:43264
v_mfma_f32_16x16x32_bf16 a[124:127], v[200:203], v[120:123], a[124:127]
s_waitcnt lgkmcnt(8)
v_mfma_f32_16x16x32_bf16 a[128:131], v[208:211], v[96:99], a[128:131]
ds_read_b64_tr_b16 v[232:233], v241 offset:24840
v_mfma_f32_16x16x32_bf16 a[128:131], v[212:215], v[100:103], a[128:131]
v_mfma_f32_16x16x32_bf16 a[132:135], v[212:215], v[108:111], a[132:135]
ds_read_b64_tr_b16 v[234:235], v241 offset:30984
v_mfma_f32_16x16x32_bf16 a[132:135], v[208:211], v[104:107], a[132:135]
v_mfma_f32_16x16x32_bf16 a[136:139], v[208:211], v[112:115], a[136:139]
ds_read_b64_tr_b16 v[236:237], v241 offset:37128
buffer_load_dwordx4 v[72:75], v252, s[20:23], s66 offen sc1
v_mfma_f32_16x16x32_bf16 a[136:139], v[212:215], v[116:119], a[136:139]
v_mfma_f32_16x16x32_bf16 a[140:143], v[212:215], v[124:127], a[140:143]
ds_read_b64_tr_b16 v[238:239], v241 offset:43272
v_mfma_f32_16x16x32_bf16 a[140:143], v[208:211], v[120:123], a[140:143]
s_waitcnt lgkmcnt(8)
v_mfma_f32_16x16x32_bf16 a[144:147], v[216:219], v[96:99], a[144:147]
ds_read_b64_tr_b16 v[192:193], v244 offset:8192
v_mfma_f32_16x16x32_bf16 a[144:147], v[220:223], v[100:103], a[144:147]
v_mfma_f32_16x16x32_bf16 a[148:151], v[220:223], v[108:111], a[148:151]
ds_read_b64_tr_b16 v[194:195], v244 offset:10240
v_mfma_f32_16x16x32_bf16 a[148:151], v[216:219], v[104:107], a[148:151]
buffer_load_dwordx4 v[76:79], v252, s[20:23], s66 offen offset:1024 sc1
v_mfma_f32_16x16x32_bf16 a[152:155], v[216:219], v[112:115], a[152:155]
ds_read_b64_tr_b16 v[196:197], v244 offset:12288
v_mfma_f32_16x16x32_bf16 a[152:155], v[220:223], v[116:119], a[152:155]
v_mfma_f32_16x16x32_bf16 a[156:159], v[220:223], v[124:127], a[156:159]
ds_read_b64_tr_b16 v[198:199], v244 offset:14336
v_mfma_f32_16x16x32_bf16 a[156:159], v[216:219], v[120:123], a[156:159]
s_waitcnt lgkmcnt(8)
v_mfma_f32_16x16x32_bf16 a[160:163], v[224:227], v[96:99], a[160:163]
ds_read_b64_tr_b16 v[200:201], v245 offset:8192
v_mfma_f32_16x16x32_bf16 a[160:163], v[228:231], v[100:103], a[160:163]
v_mfma_f32_16x16x32_bf16 a[164:167], v[228:231], v[108:111], a[164:167]
ds_read_b64_tr_b16 v[202:203], v245 offset:10240
buffer_load_dwordx4 v[80:83], v253, s[20:23], s66 offen sc1
v_mfma_f32_16x16x32_bf16 a[164:167], v[224:227], v[104:107], a[164:167]
v_mfma_f32_16x16x32_bf16 a[168:171], v[224:227], v[112:115], a[168:171]
ds_read_b64_tr_b16 v[204:205], v245 offset:12288
v_mfma_f32_16x16x32_bf16 a[168:171], v[228:231], v[116:119], a[168:171]
v_mfma_f32_16x16x32_bf16 a[172:175], v[228:231], v[124:127], a[172:175]
ds_read_b64_tr_b16 v[206:207], v245 offset:14336
v_mfma_f32_16x16x32_bf16 a[172:175], v[224:227], v[120:123], a[172:175]
s_waitcnt lgkmcnt(8)
v_mfma_f32_16x16x32_bf16 a[176:179], v[232:235], v[96:99], a[176:179]
buffer_load_dwordx4 v[84:87], v253, s[20:23], s66 offen offset:1024 sc1
v_mfma_f32_16x16x32_bf16 a[176:179], v[236:239], v[100:103], a[176:179]
v_mfma_f32_16x16x32_bf16 a[180:183], v[236:239], v[108:111], a[180:183]
v_mfma_f32_16x16x32_bf16 a[180:183], v[232:235], v[104:107], a[180:183]
v_mfma_f32_16x16x32_bf16 a[184:187], v[232:235], v[112:115], a[184:187]
v_mfma_f32_16x16x32_bf16 a[184:187], v[236:239], v[116:119], a[184:187]
v_mfma_f32_16x16x32_bf16 a[188:191], v[236:239], v[124:127], a[188:191]
s_waitcnt vmcnt(22) lgkmcnt(0)
s_barrier
v_mfma_f32_16x16x32_bf16 a[188:191], v[232:235], v[120:123], a[188:191]
s_waitcnt lgkmcnt(0)
ds_read_b64_tr_b16 v[208:209], v242
buffer_load_dwordx4 v[88:91], v254, s[20:23], s66 offen sc1
v_mfma_f32_16x16x32_bf16 v[160:163], v[192:195], v[96:99], v[160:163]
ds_read_b64_tr_b16 v[210:211], v242 offset:6144
v_mfma_f32_16x16x32_bf16 v[160:163], v[196:199], v[100:103], v[160:163]
ds_read_b64_tr_b16 v[212:213], v242 offset:12288
v_mfma_f32_16x16x32_bf16 v[164:167], v[196:199], v[108:111], v[164:167]
ds_read_b64_tr_b16 v[214:215], v242 offset:18432
v_mfma_f32_16x16x32_bf16 v[164:167], v[192:195], v[104:107], v[164:167]
v_mfma_f32_16x16x32_bf16 v[168:171], v[192:195], v[112:115], v[168:171]
ds_read_b64_tr_b16 v[216:217], v242 offset:8
v_mfma_f32_16x16x32_bf16 v[168:171], v[196:199], v[116:119], v[168:171]
ds_read_b64_tr_b16 v[218:219], v242 offset:6152
v_mfma_f32_16x16x32_bf16 v[172:175], v[196:199], v[124:127], v[172:175]
ds_read_b64_tr_b16 v[220:221], v242 offset:12296
buffer_load_dwordx4 v[92:95], v254, s[20:23], s66 offen offset:1024 sc1
v_mfma_f32_16x16x32_bf16 v[172:175], v[192:195], v[120:123], v[172:175]
s_waitcnt lgkmcnt(7)
s_add_u32 s66, s66, 2048
ds_read_b64_tr_b16 v[222:223], v242 offset:18440
v_mfma_f32_16x16x32_bf16 v[176:179], v[200:203], v[96:99], v[176:179]
v_mfma_f32_16x16x32_bf16 v[176:179], v[204:207], v[100:103], v[176:179]
ds_read_b64_tr_b16 v[224:225], v243
v_mfma_f32_16x16x32_bf16 v[180:183], v[204:207], v[108:111], v[180:183]
ds_read_b64_tr_b16 v[226:227], v243 offset:6144
v_mfma_f32_16x16x32_bf16 v[180:183], v[200:203], v[104:107], v[180:183]
ds_read_b64_tr_b16 v[228:229], v243 offset:12288
v_mfma_f32_16x16x32_bf16 v[184:187], v[200:203], v[112:115], v[184:187]
ds_read_b64_tr_b16 v[230:231], v243 offset:18432
v_mfma_f32_16x16x32_bf16 v[184:187], v[204:207], v[116:119], v[184:187]
v_mfma_f32_16x16x32_bf16 v[188:191], v[204:207], v[124:127], v[188:191]
s_waitcnt vmcnt(16)
v_mfma_f32_16x16x32_bf16 v[188:191], v[200:203], v[120:123], v[188:191]
s_waitcnt lgkmcnt(8)
v_mfma_f32_16x16x32_bf16 a[0:3], v[208:211], v[128:131], a[0:3]
s_add_u32 m0, s68, 98304
ds_read_b64_tr_b16 v[232:233], v243 offset:8
v_mfma_f32_16x16x32_bf16 a[0:3], v[212:215], v[132:135], a[0:3]
buffer_load_dwordx4 v247, s[12:15], s64 offen lds
v_mfma_f32_16x16x32_bf16 a[4:7], v[212:215], v[140:143], a[4:7]
ds_read_b64_tr_b16 v[234:235], v243 offset:6152
v_mfma_f32_16x16x32_bf16 a[4:7], v[208:211], v[136:139], a[4:7]
v_mfma_f32_16x16x32_bf16 a[8:11], v[208:211], v[144:147], a[8:11]
ds_read_b64_tr_b16 v[236:237], v243 offset:12296
v_mfma_f32_16x16x32_bf16 a[8:11], v[212:215], v[148:151], a[8:11]
v_mfma_f32_16x16x32_bf16 a[12:15], v[212:215], v[156:159], a[12:15]
ds_read_b64_tr_b16 v[238:239], v243 offset:18440
v_mfma_f32_16x16x32_bf16 a[12:15], v[208:211], v[152:155], a[12:15]
s_waitcnt lgkmcnt(8)
buffer_load_dwordx4 v248, s[12:15], s64 offen offset:1024 lds
v_mfma_f32_16x16x32_bf16 a[16:19], v[216:219], v[128:131], a[16:19]
ds_read_b64_tr_b16 v[192:193], v242 offset:128
v_mfma_f32_16x16x32_bf16 a[16:19], v[220:223], v[132:135], a[16:19]
v_mfma_f32_16x16x32_bf16 a[20:23], v[220:223], v[140:143], a[20:23]
ds_read_b64_tr_b16 v[194:195], v242 offset:6272
v_mfma_f32_16x16x32_bf16 a[20:23], v[216:219], v[136:139], a[20:23]
v_mfma_f32_16x16x32_bf16 a[24:27], v[216:219], v[144:147], a[24:27]
ds_read_b64_tr_b16 v[196:197], v242 offset:12416
v_mfma_f32_16x16x32_bf16 a[24:27], v[220:223], v[148:151], a[24:27]
v_mfma_f32_16x16x32_bf16 a[28:31], v[220:223], v[156:159], a[28:31]
ds_read_b64_tr_b16 v[198:199], v242 offset:18560
buffer_load_dwordx4 v249, s[12:15], s64 offen offset:2048 lds
v_mfma_f32_16x16x32_bf16 a[28:31], v[216:219], v[152:155], a[28:31]
s_waitcnt lgkmcnt(8)
s_add_u32 s64, s64, 98304
s_add_u32 m0, s68, 101376
v_mfma_f32_16x16x32_bf16 a[32:35], v[224:227], v[128:131], a[32:35]
ds_read_b64_tr_b16 v[200:201], v242 offset:136
v_mfma_f32_16x16x32_bf16 a[32:35], v[228:231], v[132:135], a[32:35]
v_mfma_f32_16x16x32_bf16 a[36:39], v[228:231], v[140:143], a[36:39]
ds_read_b64_tr_b16 v[202:203], v242 offset:6280
v_mfma_f32_16x16x32_bf16 a[36:39], v[224:227], v[136:139], a[36:39]
v_mfma_f32_16x16x32_bf16 a[40:43], v[224:227], v[144:147], a[40:43]
ds_read_b64_tr_b16 v[204:205], v242 offset:12424
v_mfma_f32_16x16x32_bf16 a[40:43], v[228:231], v[148:151], a[40:43]
buffer_load_dwordx4 v247, s[12:15], s64 offen lds
v_mfma_f32_16x16x32_bf16 a[44:47], v[228:231], v[156:159], a[44:47]
ds_read_b64_tr_b16 v[206:207], v242 offset:18568
v_mfma_f32_16x16x32_bf16 a[44:47], v[224:227], v[152:155], a[44:47]
s_waitcnt lgkmcnt(8)
v_mfma_f32_16x16x32_bf16 a[48:51], v[232:235], v[128:131], a[48:51]
ds_read_b64_tr_b16 v[208:209], v243 offset:128
v_mfma_f32_16x16x32_bf16 a[48:51], v[236:239], v[132:135], a[48:51]
v_mfma_f32_16x16x32_bf16 a[52:55], v[236:239], v[140:143], a[52:55]
ds_read_b64_tr_b16 v[210:211], v243 offset:6272
v_mfma_f32_16x16x32_bf16 a[52:55], v[232:235], v[136:139], a[52:55]
v_mfma_f32_16x16x32_bf16 a[56:59], v[232:235], v[144:147], a[56:59]
ds_read_b64_tr_b16 v[212:213], v243 offset:12416
buffer_load_dwordx4 v248, s[12:15], s64 offen offset:1024 lds
v_mfma_f32_16x16x32_bf16 a[56:59], v[236:239], v[148:151], a[56:59]
v_mfma_f32_16x16x32_bf16 a[60:63], v[236:239], v[156:159], a[60:63]
ds_read_b64_tr_b16 v[214:215], v243 offset:18560
v_mfma_f32_16x16x32_bf16 a[60:63], v[232:235], v[152:155], a[60:63]
s_waitcnt lgkmcnt(8)
v_mfma_f32_16x16x32_bf16 a[64:67], v[192:195], v[128:131], a[64:67]
ds_read_b64_tr_b16 v[216:217], v243 offset:136
v_mfma_f32_16x16x32_bf16 a[64:67], v[196:199], v[132:135], a[64:67]
v_mfma_f32_16x16x32_bf16 a[68:71], v[196:199], v[140:143], a[68:71]
ds_read_b64_tr_b16 v[218:219], v243 offset:6280
buffer_load_dwordx4 v249, s[12:15], s64 offen offset:2048 lds
v_mfma_f32_16x16x32_bf16 a[68:71], v[192:195], v[136:139], a[68:71]
s_add_u32 s64, s64, 688128
s_add_u32 m0, s61, 57344
v_mfma_f32_16x16x32_bf16 a[72:75], v[192:195], v[144:147], a[72:75]
ds_read_b64_tr_b16 v[220:221], v243 offset:12424
v_mfma_f32_16x16x32_bf16 a[72:75], v[196:199], v[148:151], a[72:75]
v_mfma_f32_16x16x32_bf16 a[76:79], v[196:199], v[156:159], a[76:79]
ds_read_b64_tr_b16 v[222:223], v243 offset:18568
v_mfma_f32_16x16x32_bf16 a[76:79], v[192:195], v[152:155], a[76:79]
s_waitcnt lgkmcnt(8)
v_mfma_f32_16x16x32_bf16 a[80:83], v[200:203], v[128:131], a[80:83]
ds_read_b64_tr_b16 v[224:225], v242 offset:256
v_mfma_f32_16x16x32_bf16 a[80:83], v[204:207], v[132:135], a[80:83]
buffer_load_dwordx4 v250, s[16:19], s65 offen lds
v_mfma_f32_16x16x32_bf16 a[84:87], v[204:207], v[140:143], a[84:87]
s_add_u32 s65, s65, 23552
ds_read_b64_tr_b16 v[226:227], v242 offset:6400
v_mfma_f32_16x16x32_bf16 a[84:87], v[200:203], v[136:139], a[84:87]
v_mfma_f32_16x16x32_bf16 a[88:91], v[200:203], v[144:147], a[88:91]
ds_read_b64_tr_b16 v[228:229], v242 offset:12544
v_mfma_f32_16x16x32_bf16 a[88:91], v[204:207], v[148:151], a[88:91]
v_mfma_f32_16x16x32_bf16 a[92:95], v[204:207], v[156:159], a[92:95]
ds_read_b64_tr_b16 v[230:231], v242 offset:18688
v_mfma_f32_16x16x32_bf16 a[92:95], v[200:203], v[152:155], a[92:95]
s_waitcnt lgkmcnt(8)
v_mfma_f32_16x16x32_bf16 a[96:99], v[208:211], v[128:131], a[96:99]
ds_read_b64_tr_b16 v[232:233], v242 offset:264
buffer_load_dwordx4 v250, s[16:19], s65 offen offset:1024 lds
v_mfma_f32_16x16x32_bf16 a[96:99], v[212:215], v[132:135], a[96:99]
s_add_u32 s65, s65, 173056
v_mfma_f32_16x16x32_bf16 a[100:103], v[212:215], v[140:143], a[100:103]
ds_read_b64_tr_b16 v[234:235], v242 offset:6408
v_mfma_f32_16x16x32_bf16 a[100:103], v[208:211], v[136:139], a[100:103]
v_mfma_f32_16x16x32_bf16 a[104:107], v[208:211], v[144:147], a[104:107]
ds_read_b64_tr_b16 v[236:237], v242 offset:12552
v_mfma_f32_16x16x32_bf16 a[104:107], v[212:215], v[148:151], a[104:107]
v_mfma_f32_16x16x32_bf16 a[108:111], v[212:215], v[156:159], a[108:111]
ds_read_b64_tr_b16 v[238:239], v242 offset:18696
v_mfma_f32_16x16x32_bf16 a[108:111], v[208:211], v[152:155], a[108:111]
s_waitcnt lgkmcnt(8)
buffer_load_dwordx4 v[96:99], v251, s[20:23], s66 offen sc1
v_mfma_f32_16x16x32_bf16 a[112:115], v[216:219], v[128:131], a[112:115]
ds_read_b64_tr_b16 v[192:193], v243 offset:256
v_mfma_f32_16x16x32_bf16 a[112:115], v[220:223], v[132:135], a[112:115]
v_mfma_f32_16x16x32_bf16 a[116:119], v[220:223], v[140:143], a[116:119]
ds_read_b64_tr_b16 v[194:195], v243 offset:6400
v_mfma_f32_16x16x32_bf16 a[116:119], v[216:219], v[136:139], a[116:119]
v_mfma_f32_16x16x32_bf16 a[120:123], v[216:219], v[144:147], a[120:123]
ds_read_b64_tr_b16 v[196:197], v243 offset:12544
v_mfma_f32_16x16x32_bf16 a[120:123], v[220:223], v[148:151], a[120:123]
buffer_load_dwordx4 v[100:103], v251, s[20:23], s66 offen offset:1024 sc1
v_mfma_f32_16x16x32_bf16 a[124:127], v[220:223], v[156:159], a[124:127]
ds_read_b64_tr_b16 v[198:199], v243 offset:18688
v_mfma_f32_16x16x32_bf16 a[124:127], v[216:219], v[152:155], a[124:127]
s_waitcnt lgkmcnt(8)
v_mfma_f32_16x16x32_bf16 a[128:131], v[224:227], v[128:131], a[128:131]
ds_read_b64_tr_b16 v[200:201], v243 offset:264
v_mfma_f32_16x16x32_bf16 a[128:131], v[228:231], v[132:135], a[128:131]
v_mfma_f32_16x16x32_bf16 a[132:135], v[228:231], v[140:143], a[132:135]
ds_read_b64_tr_b16 v[202:203], v243 offset:6408
v_mfma_f32_16x16x32_bf16 a[132:135], v[224:227], v[136:139], a[132:135]
v_mfma_f32_16x16x32_bf16 a[136:139], v[224:227], v[144:147], a[136:139]
ds_read_b64_tr_b16 v[204:205], v243 offset:12552
buffer_load_dwordx4 v[104:107], v252, s[20:23], s66 offen sc1
v_mfma_f32_16x16x32_bf16 a[136:139], v[228:231], v[148:151], a[136:139]
v_mfma_f32_16x16x32_bf16 a[140:143], v[228:231], v[156:159], a[140:143]
ds_read_b64_tr_b16 v[206:207], v243 offset:18696
v_mfma_f32_16x16x32_bf16 a[140:143], v[224:227], v[152:155], a[140:143]
s_waitcnt lgkmcnt(8)
v_mfma_f32_16x16x32_bf16 a[144:147], v[232:235], v[128:131], a[144:147]
ds_read_b64_tr_b16 v[208:209], v244 offset:16384
v_mfma_f32_16x16x32_bf16 a[144:147], v[236:239], v[132:135], a[144:147]
v_mfma_f32_16x16x32_bf16 a[148:151], v[236:239], v[140:143], a[148:151]
ds_read_b64_tr_b16 v[210:211], v244 offset:18432
v_mfma_f32_16x16x32_bf16 a[148:151], v[232:235], v[136:139], a[148:151]
buffer_load_dwordx4 v[108:111], v252, s[20:23], s66 offen offset:1024 sc1
v_mfma_f32_16x16x32_bf16 a[152:155], v[232:235], v[144:147], a[152:155]
ds_read_b64_tr_b16 v[212:213], v244 offset:20480
v_mfma_f32_16x16x32_bf16 a[152:155], v[236:239], v[148:151], a[152:155]
v_mfma_f32_16x16x32_bf16 a[156:159], v[236:239], v[156:159], a[156:159]
ds_read_b64_tr_b16 v[214:215], v244 offset:22528
v_mfma_f32_16x16x32_bf16 a[156:159], v[232:235], v[152:155], a[156:159]
s_waitcnt lgkmcnt(8)
v_mfma_f32_16x16x32_bf16 a[160:163], v[192:195], v[128:131], a[160:163]
ds_read_b64_tr_b16 v[216:217], v245 offset:16384
v_mfma_f32_16x16x32_bf16 a[160:163], v[196:199], v[132:135], a[160:163]
v_mfma_f32_16x16x32_bf16 a[164:167], v[196:199], v[140:143], a[164:167]
ds_read_b64_tr_b16 v[218:219], v245 offset:18432
buffer_load_dwordx4 v[112:115], v253, s[20:23], s66 offen sc1
v_mfma_f32_16x16x32_bf16 a[164:167], v[192:195], v[136:139], a[164:167]
v_mfma_f32_16x16x32_bf16 a[168:171], v[192:195], v[144:147], a[168:171]
ds_read_b64_tr_b16 v[220:221], v245 offset:20480
v_mfma_f32_16x16x32_bf16 a[168:171], v[196:199], v[148:151], a[168:171]
v_mfma_f32_16x16x32_bf16 a[172:175], v[196:199], v[156:159], a[172:175]
ds_read_b64_tr_b16 v[222:223], v245 offset:22528
v_mfma_f32_16x16x32_bf16 a[172:175], v[192:195], v[152:155], a[172:175]
s_waitcnt lgkmcnt(8)
v_mfma_f32_16x16x32_bf16 a[176:179], v[200:203], v[128:131], a[176:179]
buffer_load_dwordx4 v[116:119], v253, s[20:23], s66 offen offset:1024 sc1
v_mfma_f32_16x16x32_bf16 a[176:179], v[204:207], v[132:135], a[176:179]
v_mfma_f32_16x16x32_bf16 a[180:183], v[204:207], v[140:143], a[180:183]
v_mfma_f32_16x16x32_bf16 a[180:183], v[200:203], v[136:139], a[180:183]
v_mfma_f32_16x16x32_bf16 a[184:187], v[200:203], v[144:147], a[184:187]
v_mfma_f32_16x16x32_bf16 a[184:187], v[204:207], v[148:151], a[184:187]
v_mfma_f32_16x16x32_bf16 a[188:191], v[204:207], v[156:159], a[188:191]
s_waitcnt vmcnt(22) lgkmcnt(0)
s_barrier
v_mfma_f32_16x16x32_bf16 a[188:191], v[200:203], v[152:155], a[188:191]
s_waitcnt lgkmcnt(0)
ds_read_b64_tr_b16 v[224:225], v240
buffer_load_dwordx4 v[120:123], v254, s[20:23], s66 offen sc1
v_mfma_f32_16x16x32_bf16 v[160:163], v[208:211], v[128:131], v[160:163]
ds_read_b64_tr_b16 v[226:227], v240 offset:6144
v_mfma_f32_16x16x32_bf16 v[160:163], v[212:215], v[132:135], v[160:163]
ds_read_b64_tr_b16 v[228:229], v240 offset:12288
v_mfma_f32_16x16x32_bf16 v[164:167], v[212:215], v[140:143], v[164:167]
ds_read_b64_tr_b16 v[230:231], v240 offset:18432
v_mfma_f32_16x16x32_bf16 v[164:167], v[208:211], v[136:139], v[164:167]
v_mfma_f32_16x16x32_bf16 v[168:171], v[208:211], v[144:147], v[168:171]
ds_read_b64_tr_b16 v[232:233], v240 offset:8
v_mfma_f32_16x16x32_bf16 v[168:171], v[212:215], v[148:151], v[168:171]
ds_read_b64_tr_b16 v[234:235], v240 offset:6152
v_mfma_f32_16x16x32_bf16 v[172:175], v[212:215], v[156:159], v[172:175]
ds_read_b64_tr_b16 v[236:237], v240 offset:12296
buffer_load_dwordx4 v[124:127], v254, s[20:23], s66 offen offset:1024 sc1
v_mfma_f32_16x16x32_bf16 v[172:175], v[208:211], v[152:155], v[172:175]
s_waitcnt lgkmcnt(7)
s_add_u32 s66, s66, 2048
ds_read_b64_tr_b16 v[238:239], v240 offset:18440
v_mfma_f32_16x16x32_bf16 v[176:179], v[216:219], v[128:131], v[176:179]
v_mfma_f32_16x16x32_bf16 v[176:179], v[220:223], v[132:135], v[176:179]
ds_read_b64_tr_b16 v[192:193], v241
v_mfma_f32_16x16x32_bf16 v[180:183], v[220:223], v[140:143], v[180:183]
ds_read_b64_tr_b16 v[194:195], v241 offset:6144
v_mfma_f32_16x16x32_bf16 v[180:183], v[216:219], v[136:139], v[180:183]
ds_read_b64_tr_b16 v[196:197], v241 offset:12288
v_mfma_f32_16x16x32_bf16 v[184:187], v[216:219], v[144:147], v[184:187]
ds_read_b64_tr_b16 v[198:199], v241 offset:18432
v_mfma_f32_16x16x32_bf16 v[184:187], v[220:223], v[148:151], v[184:187]
v_mfma_f32_16x16x32_bf16 v[188:191], v[220:223], v[156:159], v[188:191]
s_waitcnt vmcnt(16)
v_mfma_f32_16x16x32_bf16 v[188:191], v[216:219], v[152:155], v[188:191]
s_waitcnt lgkmcnt(8)
v_mfma_f32_16x16x32_bf16 a[0:3], v[224:227], v[64:67], a[0:3]
s_add_u32 m0, s68, 122880
ds_read_b64_tr_b16 v[200:201], v241 offset:8
v_mfma_f32_16x16x32_bf16 a[0:3], v[228:231], v[68:71], a[0:3]
buffer_load_dwordx4 v247, s[12:15], s64 offen lds
v_mfma_f32_16x16x32_bf16 a[4:7], v[228:231], v[76:79], a[4:7]
ds_read_b64_tr_b16 v[202:203], v241 offset:6152
v_mfma_f32_16x16x32_bf16 a[4:7], v[224:227], v[72:75], a[4:7]
s_getpc_b64 s[34:35]
L_pc3o:
s_bfe_u32 s74, s2, 0x10003
s_lshl_b32 s74, s74, 2
s_add_u32 s74, s74, s52
s_min_u32 s74, s74, 4
s_lshl_b32 s74, s74, 13
s_add_u32 s56, s74, L_mido-L_pc3o
s_add_u32 s74, s74, L_common-L_pc3o-8192
s_cmp_eq_u32 s56, L_mido-L_pc3o
s_cselect_b32 s74, s56, s74
s_ashr_i32 s56, s74, 31
s_add_u32 s34, s34, s74
s_addc_u32 s35, s35, s56
v_mfma_f32_16x16x32_bf16 a[8:11], v[224:227], v[80:83], a[8:11]
ds_read_b64_tr_b16 v[204:205], v241 offset:12296
v_mfma_f32_16x16x32_bf16 a[8:11], v[228:231], v[84:87], a[8:11]
buffer_load_dwordx4 v248, s[12:15], s64 offen offset:1024 lds
v_lshlrev_b32 v47, 7, v0
v_mfma_f32_16x16x32_bf16 a[12:15], v[228:231], v[92:95], a[12:15]
ds_read_b64_tr_b16 v[206:207], v241 offset:18440
v_mfma_f32_16x16x32_bf16 a[12:15], v[224:227], v[88:91], a[12:15]
s_waitcnt lgkmcnt(8)
v_mfma_f32_16x16x32_bf16 a[16:19], v[232:235], v[64:67], a[16:19]
ds_read_b64_tr_b16 v[208:209], v240 offset:128
v_mfma_f32_16x16x32_bf16 a[16:19], v[236:239], v[68:71], a[16:19]
global_load_dword v47, v47, s[34:35]
v_mfma_f32_16x16x32_bf16 a[20:23], v[236:239], v[76:79], a[20:23]
ds_read_b64_tr_b16 v[210:211], v240 offset:6272
buffer_load_dwordx4 v249, s[12:15], s64 offen offset:2048 lds
v_mfma_f32_16x16x32_bf16 a[20:23], v[232:235], v[72:75], a[20:23]
s_add_u32 s64, s64, 98304
s_add_u32 m0, s68, 125952
v_mfma_f32_16x16x32_bf16 a[24:27], v[232:235], v[80:83], a[24:27]
ds_read_b64_tr_b16 v[212:213], v240 offset:12416
v_mfma_f32_16x16x32_bf16 a[24:27], v[236:239], v[84:87], a[24:27]
v_mfma_f32_16x16x32_bf16 a[28:31], v[236:239], v[92:95], a[28:31]
ds_read_b64_tr_b16 v[214:215], v240 offset:18560
v_mfma_f32_16x16x32_bf16 a[28:31], v[232:235], v[88:91], a[28:31]
s_waitcnt lgkmcnt(8)
buffer_load_dwordx4 v247, s[12:15], s64 offen lds
v_mfma_f32_16x16x32_bf16 a[32:35], v[192:195], v[64:67], a[32:35]
ds_read_b64_tr_b16 v[216:217], v240 offset:136
v_mfma_f32_16x16x32_bf16 a[32:35], v[196:199], v[68:71], a[32:35]
v_mfma_f32_16x16x32_bf16 a[36:39], v[196:199], v[76:79], a[36:39]
ds_read_b64_tr_b16 v[218:219], v240 offset:6280
v_mfma_f32_16x16x32_bf16 a[36:39], v[192:195], v[72:75], a[36:39]
v_mfma_f32_16x16x32_bf16 a[40:43], v[192:195], v[80:83], a[40:43]
ds_read_b64_tr_b16 v[220:221], v240 offset:12424
buffer_load_dwordx4 v248, s[12:15], s64 offen offset:1024 lds
v_mfma_f32_16x16x32_bf16 a[40:43], v[196:199], v[84:87], a[40:43]
v_mfma_f32_16x16x32_bf16 a[44:47], v[196:199], v[92:95], a[44:47]
ds_read_b64_tr_b16 v[222:223], v240 offset:18568
v_mfma_f32_16x16x32_bf16 a[44:47], v[192:195], v[88:91], a[44:47]
s_waitcnt lgkmcnt(8)
v_mfma_f32_16x16x32_bf16 a[48:51], v[200:203], v[64:67], a[48:51]
ds_read_b64_tr_b16 v[224:225], v241 offset:128
v_mfma_f32_16x16x32_bf16 a[48:51], v[204:207], v[68:71], a[48:51]
buffer_load_dwordx4 v249, s[12:15], s64 offen offset:2048 lds
v_mfma_f32_16x16x32_bf16 a[52:55], v[204:207], v[76:79], a[52:55]
s_add_u32 s64, s64, 688128
s_add_u32 m0, s61, 65536
ds_read_b64_tr_b16 v[226:227], v241 offset:6272
v_mfma_f32_16x16x32_bf16 a[52:55], v[200:203], v[72:75], a[52:55]
v_mfma_f32_16x16x32_bf16 a[56:59], v[200:203], v[80:83], a[56:59]
ds_read_b64_tr_b16 v[228:229], v241 offset:12416
v_mfma_f32_16x16x32_bf16 a[56:59], v[204:207], v[84:87], a[56:59]
v_mfma_f32_16x16x32_bf16 a[60:63], v[204:207], v[92:95], a[60:63]
ds_read_b64_tr_b16 v[230:231], v241 offset:18560
buffer_load_dwordx4 v250, s[16:19], s65 offen lds
v_mfma_f32_16x16x32_bf16 a[60:63], v[200:203], v[88:91], a[60:63]
s_waitcnt lgkmcnt(8)
s_add_u32 s65, s65, 23552
v_mfma_f32_16x16x32_bf16 a[64:67], v[208:211], v[64:67], a[64:67]
ds_read_b64_tr_b16 v[232:233], v241 offset:136
v_mfma_f32_16x16x32_bf16 a[64:67], v[212:215], v[68:71], a[64:67]
v_mfma_f32_16x16x32_bf16 a[68:71], v[212:215], v[76:79], a[68:71]
ds_read_b64_tr_b16 v[234:235], v241 offset:6280
v_mfma_f32_16x16x32_bf16 a[68:71], v[208:211], v[72:75], a[68:71]
buffer_load_dwordx4 v250, s[16:19], s65 offen offset:1024 lds
v_mfma_f32_16x16x32_bf16 a[72:75], v[208:211], v[80:83], a[72:75]
s_add_u32 s65, s65, 173056
ds_read_b64_tr_b16 v[236:237], v241 offset:12424
v_mfma_f32_16x16x32_bf16 a[72:75], v[212:215], v[84:87], a[72:75]
v_mfma_f32_16x16x32_bf16 a[76:79], v[212:215], v[92:95], a[76:79]
ds_read_b64_tr_b16 v[238:239], v241 offset:18568
v_mfma_f32_16x16x32_bf16 a[76:79], v[208:211], v[88:91], a[76:79]
s_waitcnt lgkmcnt(8)
v_mfma_f32_16x16x32_bf16 a[80:83], v[216:219], v[64:67], a[80:83]
ds_read_b64_tr_b16 v[192:193], v240 offset:256
buffer_load_dwordx4 v[128:131], v251, s[20:23], s66 offen sc1
v_mfma_f32_16x16x32_bf16 a[80:83], v[220:223], v[68:71], a[80:83]
v_mfma_f32_16x16x32_bf16 a[84:87], v[220:223], v[76:79], a[84:87]
ds_read_b64_tr_b16 v[194:195], v240 offset:6400
v_mfma_f32_16x16x32_bf16 a[84:87], v[216:219], v[72:75], a[84:87]
v_mfma_f32_16x16x32_bf16 a[88:91], v[216:219], v[80:83], a[88:91]
ds_read_b64_tr_b16 v[196:197], v240 offset:12544
v_mfma_f32_16x16x32_bf16 a[88:91], v[220:223], v[84:87], a[88:91]
buffer_load_dwordx4 v[132:135], v251, s[20:23], s66 offen offset:1024 sc1
v_mfma_f32_16x16x32_bf16 a[92:95], v[220:223], v[92:95], a[92:95]
ds_read_b64_tr_b16 v[198:199], v240 offset:18688
v_mfma_f32_16x16x32_bf16 a[92:95], v[216:219], v[88:91], a[92:95]
s_waitcnt lgkmcnt(8)
v_mfma_f32_16x16x32_bf16 a[96:99], v[224:227], v[64:67], a[96:99]
ds_read_b64_tr_b16 v[200:201], v240 offset:264
v_mfma_f32_16x16x32_bf16 a[96:99], v[228:231], v[68:71], a[96:99]
v_mfma_f32_16x16x32_bf16 a[100:103], v[228:231], v[76:79], a[100:103]
ds_read_b64_tr_b16 v[202:203], v240 offset:6408
buffer_load_dwordx4 v[136:139], v252, s[20:23], s66 offen sc1
v_mfma_f32_16x16x32_bf16 a[100:103], v[224:227], v[72:75], a[100:103]
v_mfma_f32_16x16x32_bf16 a[104:107], v[224:227], v[80:83], a[104:107]
ds_read_b64_tr_b16 v[204:205], v240 offset:12552
v_mfma_f32_16x16x32_bf16 a[104:107], v[228:231], v[84:87], a[104:107]
v_mfma_f32_16x16x32_bf16 a[108:111], v[228:231], v[92:95], a[108:111]
ds_read_b64_tr_b16 v[206:207], v240 offset:18696
v_mfma_f32_16x16x32_bf16 a[108:111], v[224:227], v[88:91], a[108:111]
s_waitcnt lgkmcnt(8)
buffer_load_dwordx4 v[140:143], v252, s[20:23], s66 offen offset:1024 sc1
v_mfma_f32_16x16x32_bf16 a[112:115], v[232:235], v[64:67], a[112:115]
ds_read_b64_tr_b16 v[208:209], v241 offset:256
v_mfma_f32_16x16x32_bf16 a[112:115], v[236:239], v[68:71], a[112:115]
v_mfma_f32_16x16x32_bf16 a[116:119], v[236:239], v[76:79], a[116:119]
ds_read_b64_tr_b16 v[210:211], v241 offset:6400
v_mfma_f32_16x16x32_bf16 a[116:119], v[232:235], v[72:75], a[116:119]
buffer_load_dwordx4 v[144:147], v253, s[20:23], s66 offen sc1
v_mfma_f32_16x16x32_bf16 a[120:123], v[232:235], v[80:83], a[120:123]
ds_read_b64_tr_b16 v[212:213], v241 offset:12544
v_mfma_f32_16x16x32_bf16 a[120:123], v[236:239], v[84:87], a[120:123]
v_mfma_f32_16x16x32_bf16 a[124:127], v[236:239], v[92:95], a[124:127]
ds_read_b64_tr_b16 v[214:215], v241 offset:18688
v_mfma_f32_16x16x32_bf16 a[124:127], v[232:235], v[88:91], a[124:127]
s_waitcnt lgkmcnt(8)
v_mfma_f32_16x16x32_bf16 a[128:131], v[192:195], v[64:67], a[128:131]
ds_read_b64_tr_b16 v[216:217], v241 offset:264
buffer_load_dwordx4 v[148:151], v253, s[20:23], s66 offen offset:1024 sc1
v_mfma_f32_16x16x32_bf16 a[128:131], v[196:199], v[68:71], a[128:131]
v_mfma_f32_16x16x32_bf16 a[132:135], v[196:199], v[76:79], a[132:135]
ds_read_b64_tr_b16 v[218:219], v241 offset:6408
v_mfma_f32_16x16x32_bf16 a[132:135], v[192:195], v[72:75], a[132:135]
v_mfma_f32_16x16x32_bf16 a[136:139], v[192:195], v[80:83], a[136:139]
ds_read_b64_tr_b16 v[220:221], v241 offset:12552
v_mfma_f32_16x16x32_bf16 a[136:139], v[196:199], v[84:87], a[136:139]
buffer_load_dwordx4 v[152:155], v254, s[20:23], s66 offen sc1
v_mfma_f32_16x16x32_bf16 a[140:143], v[196:199], v[92:95], a[140:143]
ds_read_b64_tr_b16 v[222:223], v241 offset:18696
v_mfma_f32_16x16x32_bf16 a[140:143], v[192:195], v[88:91], a[140:143]
s_waitcnt lgkmcnt(8)
v_mfma_f32_16x16x32_bf16 a[144:147], v[200:203], v[64:67], a[144:147]
ds_read_b64_tr_b16 v[224:225], v244
v_mfma_f32_16x16x32_bf16 a[144:147], v[204:207], v[68:71], a[144:147]
v_mfma_f32_16x16x32_bf16 a[148:151], v[204:207], v[76:79], a[148:151]
ds_read_b64_tr_b16 v[226:227], v244 offset:2048
buffer_load_dwordx4 v[156:159], v254, s[20:23], s66 offen offset:1024 sc1
v_mfma_f32_16x16x32_bf16 a[148:151], v[200:203], v[72:75], a[148:151]
s_add_u32 s66, s66, 2048
s_add_u32 s57, s68, 0
s_add_u32 m0, s68, 0
v_mfma_f32_16x16x32_bf16 a[152:155], v[200:203], v[80:83], a[152:155]
ds_read_b64_tr_b16 v[228:229], v244 offset:4096
v_mfma_f32_16x16x32_bf16 a[152:155], v[204:207], v[84:87], a[152:155]
v_mfma_f32_16x16x32_bf16 a[156:159], v[204:207], v[92:95], a[156:159]
ds_read_b64_tr_b16 v[230:231], v244 offset:6144
v_mfma_f32_16x16x32_bf16 a[156:159], v[200:203], v[88:91], a[156:159]
s_waitcnt lgkmcnt(8)
buffer_load_dwordx4 v7, s[4:7], s57 offen lds
v_mfma_f32_16x16x32_bf16 a[160:163], v[208:211], v[64:67], a[160:163]
ds_read_b64_tr_b16 v[232:233], v245
v_mfma_f32_16x16x32_bf16 a[160:163], v[212:215], v[68:71], a[160:163]
v_mfma_f32_16x16x32_bf16 a[164:167], v[212:215], v[76:79], a[164:167]
ds_read_b64_tr_b16 v[234:235], v245 offset:2048
v_mfma_f32_16x16x32_bf16 a[164:167], v[208:211], v[72:75], a[164:167]
v_mfma_f32_16x16x32_bf16 a[168:171], v[208:211], v[80:83], a[168:171]
ds_read_b64_tr_b16 v[236:237], v245 offset:4096
buffer_load_dwordx4 v8, s[4:7], s57 offen offset:1024 lds
v_mfma_f32_16x16x32_bf16 a[168:171], v[212:215], v[84:87], a[168:171]
v_mfma_f32_16x16x32_bf16 a[172:175], v[212:215], v[92:95], a[172:175]
ds_read_b64_tr_b16 v[238:239], v245 offset:6144
v_mfma_f32_16x16x32_bf16 a[172:175], v[208:211], v[88:91], a[172:175]
s_waitcnt lgkmcnt(8)
v_mfma_f32_16x16x32_bf16 a[176:179], v[216:219], v[64:67], a[176:179]
v_mfma_f32_16x16x32_bf16 a[176:179], v[220:223], v[68:71], a[176:179]
buffer_load_dwordx4 v9, s[4:7], s57 offen offset:2048 lds
v_mfma_f32_16x16x32_bf16 a[180:183], v[220:223], v[76:79], a[180:183]
s_add_u32 s57, s68, 3072
s_add_u32 m0, s68, 3072
v_mfma_f32_16x16x32_bf16 a[180:183], v[216:219], v[72:75], a[180:183]
v_mfma_f32_16x16x32_bf16 a[184:187], v[216:219], v[80:83], a[184:187]
v_mfma_f32_16x16x32_bf16 a[184:187], v[220:223], v[84:87], a[184:187]
v_mfma_f32_16x16x32_bf16 a[188:191], v[220:223], v[92:95], a[188:191]
s_waitcnt vmcnt(28) lgkmcnt(0)
s_barrier
buffer_load_dwordx4 v7, s[4:7], s57 offen lds
v_mfma_f32_16x16x32_bf16 a[188:191], v[216:219], v[88:91], a[188:191]
s_waitcnt lgkmcnt(0)
ds_read_b64_tr_b16 v[192:193], v240 offset:24576
v_mfma_f32_16x16x32_bf16 v[160:163], v[224:227], v[64:67], v[160:163]
ds_read_b64_tr_b16 v[194:195], v240 offset:30720
v_mfma_f32_16x16x32_bf16 v[160:163], v[228:231], v[68:71], v[160:163]
ds_read_b64_tr_b16 v[196:197], v240 offset:36864
v_mfma_f32_16x16x32_bf16 v[164:167], v[228:231], v[76:79], v[164:167]
ds_read_b64_tr_b16 v[198:199], v240 offset:43008
v_mfma_f32_16x16x32_bf16 v[164:167], v[224:227], v[72:75], v[164:167]
buffer_load_dwordx4 v8, s[4:7], s57 offen offset:1024 lds
v_mfma_f32_16x16x32_bf16 v[168:171], v[224:227], v[80:83], v[168:171]
ds_read_b64_tr_b16 v[200:201], v240 offset:24584
v_mfma_f32_16x16x32_bf16 v[168:171], v[228:231], v[84:87], v[168:171]
ds_read_b64_tr_b16 v[202:203], v240 offset:30728
v_mfma_f32_16x16x32_bf16 v[172:175], v[228:231], v[92:95], v[172:175]
ds_read_b64_tr_b16 v[204:205], v240 offset:36872
v_mfma_f32_16x16x32_bf16 v[172:175], v[224:227], v[88:91], v[172:175]
s_waitcnt lgkmcnt(7)
ds_read_b64_tr_b16 v[206:207], v240 offset:43016
v_mfma_f32_16x16x32_bf16 v[176:179], v[232:235], v[64:67], v[176:179]
buffer_load_dwordx4 v9, s[4:7], s57 offen offset:2048 lds
v_mfma_f32_16x16x32_bf16 v[176:179], v[236:239], v[68:71], v[176:179]
ds_read_b64_tr_b16 v[208:209], v241 offset:24576
v_mfma_f32_16x16x32_bf16 v[180:183], v[236:239], v[76:79], v[180:183]
ds_read_b64_tr_b16 v[210:211], v241 offset:30720
v_mfma_f32_16x16x32_bf16 v[180:183], v[232:235], v[72:75], v[180:183]
ds_read_b64_tr_b16 v[212:213], v241 offset:36864
v_mfma_f32_16x16x32_bf16 v[184:187], v[232:235], v[80:83], v[184:187]
ds_read_b64_tr_b16 v[214:215], v241 offset:43008
v_mfma_f32_16x16x32_bf16 v[184:187], v[236:239], v[84:87], v[184:187]
v_mfma_f32_16x16x32_bf16 v[188:191], v[236:239], v[92:95], v[188:191]
s_waitcnt vmcnt(23)
v_mfma_f32_16x16x32_bf16 v[188:191], v[232:235], v[88:91], v[188:191]
s_waitcnt lgkmcnt(8)
v_mfma_f32_16x16x32_bf16 a[0:3], v[192:195], v[96:99], a[0:3]
s_add_u32 m0, s68, 73728
ds_read_b64_tr_b16 v[216:217], v241 offset:24584
v_mfma_f32_16x16x32_bf16 a[0:3], v[196:199], v[100:103], a[0:3]
buffer_load_dwordx4 v247, s[12:15], s64 offen lds
v_mfma_f32_16x16x32_bf16 a[4:7], v[196:199], v[108:111], a[4:7]
ds_read_b64_tr_b16 v[218:219], v241 offset:30728
v_mfma_f32_16x16x32_bf16 a[4:7], v[192:195], v[104:107], a[4:7]
v_mfma_f32_16x16x32_bf16 a[8:11], v[192:195], v[112:115], a[8:11]
ds_read_b64_tr_b16 v[220:221], v241 offset:36872
v_mfma_f32_16x16x32_bf16 a[8:11], v[196:199], v[116:119], a[8:11]
buffer_load_dwordx4 v248, s[12:15], s64 offen offset:1024 lds
v_mfma_f32_16x16x32_bf16 a[12:15], v[196:199], v[124:127], a[12:15]
ds_read_b64_tr_b16 v[222:223], v241 offset:43016
v_mfma_f32_16x16x32_bf16 a[12:15], v[192:195], v[120:123], a[12:15]
s_waitcnt lgkmcnt(8)
v_mfma_f32_16x16x32_bf16 a[16:19], v[200:203], v[96:99], a[16:19]
ds_read_b64_tr_b16 v[224:225], v240 offset:24704
v_mfma_f32_16x16x32_bf16 a[16:19], v[204:207], v[100:103], a[16:19]
v_mfma_f32_16x16x32_bf16 a[20:23], v[204:207], v[108:111], a[20:23]
ds_read_b64_tr_b16 v[226:227], v240 offset:30848
buffer_load_dwordx4 v249, s[12:15], s64 offen offset:2048 lds
v_mfma_f32_16x16x32_bf16 a[20:23], v[200:203], v[104:107], a[20:23]
s_add_u32 s64, s64, 98304
s_add_u32 m0, s68, 76800
v_mfma_f32_16x16x32_bf16 a[24:27], v[200:203], v[112:115], a[24:27]
ds_read_b64_tr_b16 v[228:229], v240 offset:36992
v_mfma_f32_16x16x32_bf16 a[24:27], v[204:207], v[116:119], a[24:27]
v_mfma_f32_16x16x32_bf16 a[28:31], v[204:207], v[124:127], a[28:31]
ds_read_b64_tr_b16 v[230:231], v240 offset:43136
v_mfma_f32_16x16x32_bf16 a[28:31], v[200:203], v[120:123], a[28:31]
s_waitcnt lgkmcnt(8)
buffer_load_dwordx4 v247, s[12:15], s64 offen lds
v_mfma_f32_16x16x32_bf16 a[32:35], v[208:211], v[96:99], a[32:35]
ds_read_b64_tr_b16 v[232:233], v240 offset:24712
v_mfma_f32_16x16x32_bf16 a[32:35], v[212:215], v[100:103], a[32:35]
v_mfma_f32_16x16x32_bf16 a[36:39], v[212:215], v[108:111], a[36:39]
ds_read_b64_tr_b16 v[234:235], v240 offset:30856
v_mfma_f32_16x16x32_bf16 a[36:39], v[208:211], v[104:107], a[36:39]
v_mfma_f32_16x16x32_bf16 a[40:43], v[208:211], v[112:115], a[40:43]
ds_read_b64_tr_b16 v[236:237], v240 offset:37000
buffer_load_dwordx4 v248, s[12:15], s64 offen offset:1024 lds
v_mfma_f32_16x16x32_bf16 a[40:43], v[212:215], v[116:119], a[40:43]
v_mfma_f32_16x16x32_bf16 a[44:47], v[212:215], v[124:127], a[44:47]
ds_read_b64_tr_b16 v[238:239], v240 offset:43144
v_mfma_f32_16x16x32_bf16 a[44:47], v[208:211], v[120:123], a[44:47]
s_waitcnt lgkmcnt(8)
v_mfma_f32_16x16x32_bf16 a[48:51], v[216:219], v[96:99], a[48:51]
ds_read_b64_tr_b16 v[192:193], v241 offset:24704
v_mfma_f32_16x16x32_bf16 a[48:51], v[220:223], v[100:103], a[48:51]
buffer_load_dwordx4 v249, s[12:15], s64 offen offset:2048 lds
v_mfma_f32_16x16x32_bf16 a[52:55], v[220:223], v[108:111], a[52:55]
s_add_u32 s64, s64, 688128
s_add_u32 m0, s61, 49152
ds_read_b64_tr_b16 v[194:195], v241 offset:30848
v_mfma_f32_16x16x32_bf16 a[52:55], v[216:219], v[104:107], a[52:55]
v_mfma_f32_16x16x32_bf16 a[56:59], v[216:219], v[112:115], a[56:59]
ds_read_b64_tr_b16 v[196:197], v241 offset:36992
v_mfma_f32_16x16x32_bf16 a[56:59], v[220:223], v[116:119], a[56:59]
v_mfma_f32_16x16x32_bf16 a[60:63], v[220:223], v[124:127], a[60:63]
ds_read_b64_tr_b16 v[198:199], v241 offset:43136
buffer_load_dwordx4 v250, s[16:19], s65 offen lds
v_mfma_f32_16x16x32_bf16 a[60:63], v[216:219], v[120:123], a[60:63]
s_waitcnt lgkmcnt(8)
s_add_u32 s65, s65, 23552
v_mfma_f32_16x16x32_bf16 a[64:67], v[224:227], v[96:99], a[64:67]
ds_read_b64_tr_b16 v[200:201], v241 offset:24712
v_mfma_f32_16x16x32_bf16 a[64:67], v[228:231], v[100:103], a[64:67]
v_mfma_f32_16x16x32_bf16 a[68:71], v[228:231], v[108:111], a[68:71]
ds_read_b64_tr_b16 v[202:203], v241 offset:30856
v_mfma_f32_16x16x32_bf16 a[68:71], v[224:227], v[104:107], a[68:71]
buffer_load_dwordx4 v250, s[16:19], s65 offen offset:1024 lds
v_mfma_f32_16x16x32_bf16 a[72:75], v[224:227], v[112:115], a[72:75]
s_add_u32 s65, s65, 173056
ds_read_b64_tr_b16 v[204:205], v241 offset:37000
v_mfma_f32_16x16x32_bf16 a[72:75], v[228:231], v[116:119], a[72:75]
v_mfma_f32_16x16x32_bf16 a[76:79], v[228:231], v[124:127], a[76:79]
ds_read_b64_tr_b16 v[206:207], v241 offset:43144
v_mfma_f32_16x16x32_bf16 a[76:79], v[224:227], v[120:123], a[76:79]
s_waitcnt lgkmcnt(8)
v_mfma_f32_16x16x32_bf16 a[80:83], v[232:235], v[96:99], a[80:83]
ds_read_b64_tr_b16 v[208:209], v240 offset:24832
buffer_load_dwordx4 v[64:67], v251, s[20:23], s66 offen sc1
v_mfma_f32_16x16x32_bf16 a[80:83], v[236:239], v[100:103], a[80:83]
v_mfma_f32_16x16x32_bf16 a[84:87], v[236:239], v[108:111], a[84:87]
ds_read_b64_tr_b16 v[210:211], v240 offset:30976
v_mfma_f32_16x16x32_bf16 a[84:87], v[232:235], v[104:107], a[84:87]
v_mfma_f32_16x16x32_bf16 a[88:91], v[232:235], v[112:115], a[88:91]
ds_read_b64_tr_b16 v[212:213], v240 offset:37120
v_mfma_f32_16x16x32_bf16 a[88:91], v[236:239], v[116:119], a[88:91]
buffer_load_dwordx4 v[68:71], v251, s[20:23], s66 offen offset:1024 sc1
v_mfma_f32_16x16x32_bf16 a[92:95], v[236:239], v[124:127], a[92:95]
ds_read_b64_tr_b16 v[214:215], v240 offset:43264
v_mfma_f32_16x16x32_bf16 a[92:95], v[232:235], v[120:123], a[92:95]
s_waitcnt lgkmcnt(8)
v_mfma_f32_16x16x32_bf16 a[96:99], v[192:195], v[96:99], a[96:99]
ds_read_b64_tr_b16 v[216:217], v240 offset:24840
v_mfma_f32_16x16x32_bf16 a[96:99], v[196:199], v[100:103], a[96:99]
v_mfma_f32_16x16x32_bf16 a[100:103], v[196:199], v[108:111], a[100:103]
ds_read_b64_tr_b16 v[218:219], v240 offset:30984
buffer_load_dwordx4 v[72:75], v252, s[20:23], s66 offen sc1
v_mfma_f32_16x16x32_bf16 a[100:103], v[192:195], v[104:107], a[100:103]
v_mfma_f32_16x16x32_bf16 a[104:107], v[192:195], v[112:115], a[104:107]
ds_read_b64_tr_b16 v[220:221], v240 offset:37128
v_mfma_f32_16x16x32_bf16 a[104:107], v[196:199], v[116:119], a[104:107]
v_mfma_f32_16x16x32_bf16 a[108:111], v[196:199], v[124:127], a[108:111]
ds_read_b64_tr_b16 v[222:223], v240 offset:43272
v_mfma_f32_16x16x32_bf16 a[108:111], v[192:195], v[120:123], a[108:111]
s_waitcnt lgkmcnt(8)
buffer_load_dwordx4 v[76:79], v252, s[20:23], s66 offen offset:1024 sc1
v_mfma_f32_16x16x32_bf16 a[112:115], v[200:203], v[96:99], a[112:115]
ds_read_b64_tr_b16 v[224:225], v241 offset:24832
v_mfma_f32_16x16x32_bf16 a[112:115], v[204:207], v[100:103], a[112:115]
v_mfma_f32_16x16x32_bf16 a[116:119], v[204:207], v[108:111], a[116:119]
ds_read_b64_tr_b16 v[226:227], v241 offset:30976
v_mfma_f32_16x16x32_bf16 a[116:119], v[200:203], v[104:107], a[116:119]
buffer_load_dwordx4 v[80:83], v253, s[20:23], s66 offen sc1
v_mfma_f32_16x16x32_bf16 a[120:123], v[200:203], v[112:115], a[120:123]
ds_read_b64_tr_b16 v[228:229], v241 offset:37120
v_mfma_f32_16x16x32_bf16 a[120:123], v[204:207], v[116:119], a[120:123]
v_mfma_f32_16x16x32_bf16 a[124:127], v[204:207], v[124:127], a[124:127]
ds_read_b64_tr_b16 v[230:231], v241 offset:43264
v_mfma_f32_16x16x32_bf16 a[124:127], v[200:203], v[120:123], a[124:127]
s_waitcnt lgkmcnt(8)
v_mfma_f32_16x16x32_bf16 a[128:131], v[208:211], v[96:99], a[128:131]
ds_read_b64_tr_b16 v[232:233], v241 offset:24840
buffer_load_dwordx4 v[84:87], v253, s[20:23], s66 offen offset:1024 sc1
v_mfma_f32_16x16x32_bf16 a[128:131], v[212:215], v[100:103], a[128:131]
v_mfma_f32_16x16x32_bf16 a[132:135], v[212:215], v[108:111], a[132:135]
ds_read_b64_tr_b16 v[234:235], v241 offset:30984
v_mfma_f32_16x16x32_bf16 a[132:135], v[208:211], v[104:107], a[132:135]
v_mfma_f32_16x16x32_bf16 a[136:139], v[208:211], v[112:115], a[136:139]
ds_read_b64_tr_b16 v[236:237], v241 offset:37128
v_mfma_f32_16x16x32_bf16 a[136:139], v[212:215], v[116:119], a[136:139]
buffer_load_dwordx4 v[88:91], v254, s[20:23], s66 offen sc1
v_mfma_f32_16x16x32_bf16 a[140:143], v[212:215], v[124:127], a[140:143]
ds_read_b64_tr_b16 v[238:239], v241 offset:43272
v_mfma_f32_16x16x32_bf16 a[140:143], v[208:211], v[120:123], a[140:143]
s_waitcnt lgkmcnt(8)
v_mfma_f32_16x16x32_bf16 a[144:147], v[216:219], v[96:99], a[144:147]
ds_read_b64_tr_b16 v[192:193], v244 offset:8192
v_mfma_f32_16x16x32_bf16 a[144:147], v[220:223], v[100:103], a[144:147]
v_mfma_f32_16x16x32_bf16 a[148:151], v[220:223], v[108:111], a[148:151]
ds_read_b64_tr_b16 v[194:195], v244 offset:10240
buffer_load_dwordx4 v[92:95], v254, s[20:23], s66 offen offset:1024 sc1
v_mfma_f32_16x16x32_bf16 a[148:151], v[216:219], v[104:107], a[148:151]
s_add_u32 s66, s66, 2048
s_add_u32 s57, s68, 24576
s_add_u32 m0, s68, 24576
v_mfma_f32_16x16x32_bf16 a[152:155], v[216:219], v[112:115], a[152:155]
ds_read_b64_tr_b16 v[196:197], v244 offset:12288
v_mfma_f32_16x16x32_bf16 a[152:155], v[220:223], v[116:119], a[152:155]
v_mfma_f32_16x16x32_bf16 a[156:159], v[220:223], v[124:127], a[156:159]
ds_read_b64_tr_b16 v[198:199], v244 offset:14336
v_mfma_f32_16x16x32_bf16 a[156:159], v[216:219], v[120:123], a[156:159]
s_waitcnt lgkmcnt(8)
buffer_load_dwordx4 v7, s[4:7], s57 offen lds
v_mfma_f32_16x16x32_bf16 a[160:163], v[224:227], v[96:99], a[160:163]
ds_read_b64_tr_b16 v[200:201], v245 offset:8192
v_mfma_f32_16x16x32_bf16 a[160:163], v[228:231], v[100:103], a[160:163]
v_mfma_f32_16x16x32_bf16 a[164:167], v[228:231], v[108:111], a[164:167]
ds_read_b64_tr_b16 v[202:203], v245 offset:10240
v_mfma_f32_16x16x32_bf16 a[164:167], v[224:227], v[104:107], a[164:167]
v_mfma_f32_16x16x32_bf16 a[168:171], v[224:227], v[112:115], a[168:171]
ds_read_b64_tr_b16 v[204:205], v245 offset:12288
buffer_load_dwordx4 v8, s[4:7], s57 offen offset:1024 lds
v_mfma_f32_16x16x32_bf16 a[168:171], v[228:231], v[116:119], a[168:171]
v_mfma_f32_16x16x32_bf16 a[172:175], v[228:231], v[124:127], a[172:175]
ds_read_b64_tr_b16 v[206:207], v245 offset:14336
v_mfma_f32_16x16x32_bf16 a[172:175], v[224:227], v[120:123], a[172:175]
s_waitcnt lgkmcnt(8)
v_mfma_f32_16x16x32_bf16 a[176:179], v[232:235], v[96:99], a[176:179]
v_mfma_f32_16x16x32_bf16 a[176:179], v[236:239], v[100:103], a[176:179]
buffer_load_dwordx4 v9, s[4:7], s57 offen offset:2048 lds
v_mfma_f32_16x16x32_bf16 a[180:183], v[236:239], v[108:111], a[180:183]
s_add_u32 s57, s68, 27648
s_add_u32 m0, s68, 27648
v_mfma_f32_16x16x32_bf16 a[180:183], v[232:235], v[104:107], a[180:183]
v_mfma_f32_16x16x32_bf16 a[184:187], v[232:235], v[112:115], a[184:187]
v_mfma_f32_16x16x32_bf16 a[184:187], v[236:239], v[116:119], a[184:187]
v_mfma_f32_16x16x32_bf16 a[188:191], v[236:239], v[124:127], a[188:191]
s_waitcnt vmcnt(33) lgkmcnt(0)
s_barrier
buffer_load_dwordx4 v7, s[4:7], s57 offen lds
v_mfma_f32_16x16x32_bf16 a[188:191], v[232:235], v[120:123], a[188:191]
s_waitcnt lgkmcnt(0)
ds_read_b64_tr_b16 v[208:209], v242
v_mfma_f32_16x16x32_bf16 v[160:163], v[192:195], v[96:99], v[160:163]
ds_read_b64_tr_b16 v[210:211], v242 offset:6144
v_mfma_f32_16x16x32_bf16 v[160:163], v[196:199], v[100:103], v[160:163]
ds_read_b64_tr_b16 v[212:213], v242 offset:12288
v_mfma_f32_16x16x32_bf16 v[164:167], v[196:199], v[108:111], v[164:167]
ds_read_b64_tr_b16 v[214:215], v242 offset:18432
v_mfma_f32_16x16x32_bf16 v[164:167], v[192:195], v[104:107], v[164:167]
buffer_load_dwordx4 v8, s[4:7], s57 offen offset:1024 lds
v_mfma_f32_16x16x32_bf16 v[168:171], v[192:195], v[112:115], v[168:171]
ds_read_b64_tr_b16 v[216:217], v242 offset:8
v_mfma_f32_16x16x32_bf16 v[168:171], v[196:199], v[116:119], v[168:171]
ds_read_b64_tr_b16 v[218:219], v242 offset:6152
v_mfma_f32_16x16x32_bf16 v[172:175], v[196:199], v[124:127], v[172:175]
ds_read_b64_tr_b16 v[220:221], v242 offset:12296
v_mfma_f32_16x16x32_bf16 v[172:175], v[192:195], v[120:123], v[172:175]
s_waitcnt lgkmcnt(7)
ds_read_b64_tr_b16 v[222:223], v242 offset:18440
v_mfma_f32_16x16x32_bf16 v[176:179], v[200:203], v[96:99], v[176:179]
buffer_load_dwordx4 v9, s[4:7], s57 offen offset:2048 lds
v_mfma_f32_16x16x32_bf16 v[176:179], v[204:207], v[100:103], v[176:179]
ds_read_b64_tr_b16 v[224:225], v243
v_mfma_f32_16x16x32_bf16 v[180:183], v[204:207], v[108:111], v[180:183]
ds_read_b64_tr_b16 v[226:227], v243 offset:6144
v_mfma_f32_16x16x32_bf16 v[180:183], v[200:203], v[104:107], v[180:183]
ds_read_b64_tr_b16 v[228:229], v243 offset:12288
v_mfma_f32_16x16x32_bf16 v[184:187], v[200:203], v[112:115], v[184:187]
ds_read_b64_tr_b16 v[230:231], v243 offset:18432
v_mfma_f32_16x16x32_bf16 v[184:187], v[204:207], v[116:119], v[184:187]
v_mfma_f32_16x16x32_bf16 v[188:191], v[204:207], v[124:127], v[188:191]
s_waitcnt vmcnt(28)
v_mfma_f32_16x16x32_bf16 v[188:191], v[200:203], v[120:123], v[188:191]
s_waitcnt lgkmcnt(8)
v_mfma_f32_16x16x32_bf16 a[0:3], v[208:211], v[128:131], a[0:3]
s_add_u32 s57, s68, 0
s_add_u32 m0, s68, 98304
ds_read_b64_tr_b16 v[232:233], v243 offset:8
v_mfma_f32_16x16x32_bf16 a[0:3], v[212:215], v[132:135], a[0:3]
buffer_load_dwordx4 v7, s[8:11], s57 offen lds
v_mfma_f32_16x16x32_bf16 a[4:7], v[212:215], v[140:143], a[4:7]
s_mov_b32 s64, 0x3dd53b95
ds_read_b64_tr_b16 v[234:235], v243 offset:6152
v_mfma_f32_16x16x32_bf16 a[4:7], v[208:211], v[136:139], a[4:7]
s_mov_b32 s65, 0xc2b669c2
v_mfma_f32_16x16x32_bf16 a[8:11], v[208:211], v[144:147], a[8:11]
s_mul_i32 s66, s55, 245760
ds_read_b64_tr_b16 v[236:237], v243 offset:12296
v_mfma_f32_16x16x32_bf16 a[8:11], v[212:215], v[148:151], a[8:11]
s_add_u32 s66, s66, 4392960
v_mfma_f32_16x16x32_bf16 a[12:15], v[212:215], v[156:159], a[12:15]
s_mul_i32 s67, s69, 3072
ds_read_b64_tr_b16 v[238:239], v243 offset:18440
v_mfma_f32_16x16x32_bf16 a[12:15], v[208:211], v[152:155], a[12:15]
s_waitcnt lgkmcnt(8)
s_add_u32 s59, s66, s67
v_mfma_f32_16x16x32_bf16 a[16:19], v[216:219], v[128:131], a[16:19]
s_add_u32 s58, s59, 1024
ds_read_b64_tr_b16 v[192:193], v242 offset:128
v_mfma_f32_16x16x32_bf16 a[16:19], v[220:223], v[132:135], a[16:19]
s_lshl_b32 s13, s72, 1
v_mfma_f32_16x16x32_bf16 a[20:23], v[220:223], v[140:143], a[20:23]
s_add_u32 s13, s13, s77
ds_read_b64_tr_b16 v[194:195], v242 offset:6272
v_mfma_f32_16x16x32_bf16 a[20:23], v[216:219], v[136:139], a[20:23]
s_lshl_b32 s13, s13, 8
v_mfma_f32_16x16x32_bf16 a[24:27], v[216:219], v[144:147], a[24:27]
s_add_u32 s14, s13, 75513856
ds_read_b64_tr_b16 v[196:197], v242 offset:12416
v_mfma_f32_16x16x32_bf16 a[24:27], v[220:223], v[148:151], a[24:27]
s_lshl_b32 s74, s3, 1
v_mfma_f32_16x16x32_bf16 a[28:31], v[220:223], v[156:159], a[28:31]
s_add_u32 s74, s74, s76
ds_read_b64_tr_b16 v[198:199], v242 offset:18560
v_mfma_f32_16x16x32_bf16 a[28:31], v[216:219], v[152:155], a[28:31]
s_waitcnt lgkmcnt(8)
s_lshl_b32 s74, s74, 2
v_mfma_f32_16x16x32_bf16 a[32:35], v[224:227], v[128:131], a[32:35]
s_lshl_b32 s12, 15, s74
ds_read_b64_tr_b16 v[200:201], v242 offset:136
v_mfma_f32_16x16x32_bf16 a[32:35], v[228:231], v[132:135], a[32:35]
s_lshl_b32 s74, s3, 3
v_mfma_f32_16x16x32_bf16 a[36:39], v[228:231], v[140:143], a[36:39]
s_lshl_b32 s67, s76, 1
ds_read_b64_tr_b16 v[202:203], v242 offset:6280
v_mfma_f32_16x16x32_bf16 a[36:39], v[224:227], v[136:139], a[36:39]
s_add_u32 s74, s74, s67
buffer_load_dwordx4 v8, s[8:11], s57 offen offset:1024 lds
v_mfma_f32_16x16x32_bf16 a[40:43], v[224:227], v[144:147], a[40:43]
s_lshl_b32 s60, 0x33, s74
ds_read_b64_tr_b16 v[204:205], v242 offset:12424
v_mfma_f32_16x16x32_bf16 a[40:43], v[228:231], v[148:151], a[40:43]
s_lshl_b32 s74, s55, 6
v_mfma_f32_16x16x32_bf16 a[44:47], v[228:231], v[156:159], a[44:47]
s_and_b32 s74, s74, 0xffffff00
ds_read_b64_tr_b16 v[206:207], v242 offset:18568
v_mfma_f32_16x16x32_bf16 a[44:47], v[224:227], v[152:155], a[44:47]
s_waitcnt lgkmcnt(8)
s_lshl_b32 s67, s53, 3
v_mfma_f32_16x16x32_bf16 a[48:51], v[232:235], v[128:131], a[48:51]
s_add_u32 s54, s74, s67
ds_read_b64_tr_b16 v[208:209], v243 offset:128
v_mfma_f32_16x16x32_bf16 a[48:51], v[236:239], v[132:135], a[48:51]
v_mfma_f32_16x16x32_bf16 a[52:55], v[236:239], v[140:143], a[52:55]
ds_read_b64_tr_b16 v[210:211], v243 offset:6272
v_mfma_f32_16x16x32_bf16 a[52:55], v[232:235], v[136:139], a[52:55]
v_mfma_f32_16x16x32_bf16 a[56:59], v[232:235], v[144:147], a[56:59]
ds_read_b64_tr_b16 v[212:213], v243 offset:12416
v_mfma_f32_16x16x32_bf16 a[56:59], v[236:239], v[148:151], a[56:59]
v_mfma_f32_16x16x32_bf16 a[60:63], v[236:239], v[156:159], a[60:63]
ds_read_b64_tr_b16 v[214:215], v243 offset:18560
v_mfma_f32_16x16x32_bf16 a[60:63], v[232:235], v[152:155], a[60:63]
s_waitcnt lgkmcnt(8)
v_mfma_f32_16x16x32_bf16 a[64:67], v[192:195], v[128:131], a[64:67]
ds_read_b64_tr_b16 v[216:217], v243 offset:136
v_mfma_f32_16x16x32_bf16 a[64:67], v[196:199], v[132:135], a[64:67]
v_mfma_f32_16x16x32_bf16 a[68:71], v[196:199], v[140:143], a[68:71]
ds_read_b64_tr_b16 v[218:219], v243 offset:6280
v_mfma_f32_16x16x32_bf16 a[68:71], v[192:195], v[136:139], a[68:71]
v_mfma_f32_16x16x32_bf16 a[72:75], v[192:195], v[144:147], a[72:75]
ds_read_b64_tr_b16 v[220:221], v243 offset:12424
v_mfma_f32_16x16x32_bf16 a[72:75], v[196:199], v[148:151], a[72:75]
buffer_load_dwordx4 v9, s[8:11], s57 offen offset:2048 lds
v_mfma_f32_16x16x32_bf16 a[76:79], v[196:199], v[156:159], a[76:79]
s_add_u32 s57, s68, 3072
s_add_u32 m0, s68, 101376
ds_read_b64_tr_b16 v[222:223], v243 offset:18568
v_mfma_f32_16x16x32_bf16 a[76:79], v[192:195], v[152:155], a[76:79]
s_waitcnt lgkmcnt(8)
v_mfma_f32_16x16x32_bf16 a[80:83], v[200:203], v[128:131], a[80:83]
ds_read_b64_tr_b16 v[224:225], v242 offset:256
v_mfma_f32_16x16x32_bf16 a[80:83], v[204:207], v[132:135], a[80:83]
v_mfma_f32_16x16x32_bf16 a[84:87], v[204:207], v[140:143], a[84:87]
ds_read_b64_tr_b16 v[226:227], v242 offset:6400
v_mfma_f32_16x16x32_bf16 a[84:87], v[200:203], v[136:139], a[84:87]
v_mfma_f32_16x16x32_bf16 a[88:91], v[200:203], v[144:147], a[88:91]
ds_read_b64_tr_b16 v[228:229], v242 offset:12544
v_mfma_f32_16x16x32_bf16 a[88:91], v[204:207], v[148:151], a[88:91]
v_mfma_f32_16x16x32_bf16 a[92:95], v[204:207], v[156:159], a[92:95]
ds_read_b64_tr_b16 v[230:231], v242 offset:18688
v_mfma_f32_16x16x32_bf16 a[92:95], v[200:203], v[152:155], a[92:95]
s_waitcnt lgkmcnt(8)
v_mfma_f32_16x16x32_bf16 a[96:99], v[208:211], v[128:131], a[96:99]
ds_read_b64_tr_b16 v[232:233], v242 offset:264
v_mfma_f32_16x16x32_bf16 a[96:99], v[212:215], v[132:135], a[96:99]
v_mfma_f32_16x16x32_bf16 a[100:103], v[212:215], v[140:143], a[100:103]
ds_read_b64_tr_b16 v[234:235], v242 offset:6408
v_mfma_f32_16x16x32_bf16 a[100:103], v[208:211], v[136:139], a[100:103]
v_mfma_f32_16x16x32_bf16 a[104:107], v[208:211], v[144:147], a[104:107]
ds_read_b64_tr_b16 v[236:237], v242 offset:12552
v_mfma_f32_16x16x32_bf16 a[104:107], v[212:215], v[148:151], a[104:107]
v_mfma_f32_16x16x32_bf16 a[108:111], v[212:215], v[156:159], a[108:111]
ds_read_b64_tr_b16 v[238:239], v242 offset:18696
v_mfma_f32_16x16x32_bf16 a[108:111], v[208:211], v[152:155], a[108:111]
s_waitcnt lgkmcnt(8)
buffer_load_dwordx4 v7, s[8:11], s57 offen lds
v_mfma_f32_16x16x32_bf16 a[112:115], v[216:219], v[128:131], a[112:115]
ds_read_b64_tr_b16 v[192:193], v243 offset:256
v_mfma_f32_16x16x32_bf16 a[112:115], v[220:223], v[132:135], a[112:115]
v_mfma_f32_16x16x32_bf16 a[116:119], v[220:223], v[140:143], a[116:119]
ds_read_b64_tr_b16 v[194:195], v243 offset:6400
v_mfma_f32_16x16x32_bf16 a[116:119], v[216:219], v[136:139], a[116:119]
v_mfma_f32_16x16x32_bf16 a[120:123], v[216:219], v[144:147], a[120:123]
ds_read_b64_tr_b16 v[196:197], v243 offset:12544
v_mfma_f32_16x16x32_bf16 a[120:123], v[220:223], v[148:151], a[120:123]
v_mfma_f32_16x16x32_bf16 a[124:127], v[220:223], v[156:159], a[124:127]
ds_read_b64_tr_b16 v[198:199], v243 offset:18688
v_mfma_f32_16x16x32_bf16 a[124:127], v[216:219], v[152:155], a[124:127]
s_waitcnt lgkmcnt(8)
v_mfma_f32_16x16x32_bf16 a[128:131], v[224:227], v[128:131], a[128:131]
ds_read_b64_tr_b16 v[200:201], v243 offset:264
v_mfma_f32_16x16x32_bf16 a[128:131], v[228:231], v[132:135], a[128:131]
v_mfma_f32_16x16x32_bf16 a[132:135], v[228:231], v[140:143], a[132:135]
ds_read_b64_tr_b16 v[202:203], v243 offset:6408
v_mfma_f32_16x16x32_bf16 a[132:135], v[224:227], v[136:139], a[132:135]
v_mfma_f32_16x16x32_bf16 a[136:139], v[224:227], v[144:147], a[136:139]
ds_read_b64_tr_b16 v[204:205], v243 offset:12552
v_mfma_f32_16x16x32_bf16 a[136:139], v[228:231], v[148:151], a[136:139]
v_mfma_f32_16x16x32_bf16 a[140:143], v[228:231], v[156:159], a[140:143]
ds_read_b64_tr_b16 v[206:207], v243 offset:18696
v_mfma_f32_16x16x32_bf16 a[140:143], v[224:227], v[152:155], a[140:143]
s_waitcnt lgkmcnt(8)
v_mfma_f32_16x16x32_bf16 a[144:147], v[232:235], v[128:131], a[144:147]
ds_read_b64_tr_b16 v[208:209], v244 offset:16384
v_mfma_f32_16x16x32_bf16 a[144:147], v[236:239], v[132:135], a[144:147]
buffer_load_dwordx4 v8, s[8:11], s57 offen offset:1024 lds
v_mfma_f32_16x16x32_bf16 a[148:151], v[236:239], v[140:143], a[148:151]
ds_read_b64_tr_b16 v[210:211], v244 offset:18432
v_mfma_f32_16x16x32_bf16 a[148:151], v[232:235], v[136:139], a[148:151]
v_mfma_f32_16x16x32_bf16 a[152:155], v[232:235], v[144:147], a[152:155]
ds_read_b64_tr_b16 v[212:213], v244 offset:20480
v_mfma_f32_16x16x32_bf16 a[152:155], v[236:239], v[148:151], a[152:155]
v_mfma_f32_16x16x32_bf16 a[156:159], v[236:239], v[156:159], a[156:159]
ds_read_b64_tr_b16 v[214:215], v244 offset:22528
v_mfma_f32_16x16x32_bf16 a[156:159], v[232:235], v[152:155], a[156:159]
s_waitcnt lgkmcnt(8)
v_mfma_f32_16x16x32_bf16 a[160:163], v[192:195], v[128:131], a[160:163]
ds_read_b64_tr_b16 v[216:217], v245 offset:16384
v_mfma_f32_16x16x32_bf16 a[160:163], v[196:199], v[132:135], a[160:163]
v_mfma_f32_16x16x32_bf16 a[164:167], v[196:199], v[140:143], a[164:167]
ds_read_b64_tr_b16 v[218:219], v245 offset:18432
v_mov_b32 v14, 0xc1b0e49c
v_mfma_f32_16x16x32_bf16 a[164:167], v[192:195], v[136:139], a[164:167]
v_mfma_f32_16x16x32_bf16 a[168:171], v[192:195], v[144:147], a[168:171]
ds_read_b64_tr_b16 v[220:221], v245 offset:20480
v_mfma_f32_16x16x32_bf16 a[168:171], v[196:199], v[148:151], a[168:171]
v_mfma_f32_16x16x32_bf16 a[172:175], v[196:199], v[156:159], a[172:175]
ds_read_b64_tr_b16 v[222:223], v245 offset:22528
v_lshlrev_b32 v10, 4, v0
v_mfma_f32_16x16x32_bf16 a[172:175], v[192:195], v[152:155], a[172:175]
s_waitcnt lgkmcnt(8)
v_mfma_f32_16x16x32_bf16 a[176:179], v[200:203], v[128:131], a[176:179]
v_mfma_f32_16x16x32_bf16 a[176:179], v[204:207], v[132:135], a[176:179]
v_mfma_f32_16x16x32_bf16 a[180:183], v[204:207], v[140:143], a[180:183]
v_mfma_f32_16x16x32_bf16 a[180:183], v[200:203], v[136:139], a[180:183]
buffer_load_dwordx4 v9, s[8:11], s57 offen offset:2048 lds
v_mfma_f32_16x16x32_bf16 a[184:187], v[200:203], v[144:147], a[184:187]
v_mfma_f32_16x16x32_bf16 a[184:187], v[204:207], v[148:151], a[184:187]
v_mfma_f32_16x16x32_bf16 a[188:191], v[204:207], v[156:159], a[188:191]
s_waitcnt vmcnt(20) lgkmcnt(0)
s_barrier
v_mfma_f32_16x16x32_bf16 a[188:191], v[200:203], v[152:155], a[188:191]
s_waitcnt lgkmcnt(0)
ds_read_b64_tr_b16 v[224:225], v244
v_mfma_f32_16x16x32_bf16 v[160:163], v[208:211], v[128:131], v[160:163]
ds_read_b64_tr_b16 v[226:227], v244 offset:2048
v_mfma_f32_16x16x32_bf16 v[160:163], v[212:215], v[132:135], v[160:163]
ds_read_b64_tr_b16 v[228:229], v244 offset:4096
v_mfma_f32_16x16x32_bf16 v[164:167], v[212:215], v[140:143], v[164:167]
ds_read_b64_tr_b16 v[230:231], v244 offset:6144
v_mfma_f32_16x16x32_bf16 v[164:167], v[208:211], v[136:139], v[164:167]
v_mfma_f32_16x16x32_bf16 v[168:171], v[208:211], v[144:147], v[168:171]
ds_read_b64_tr_b16 v[232:233], v245
v_mfma_f32_16x16x32_bf16 v[168:171], v[212:215], v[148:151], v[168:171]
ds_read_b64_tr_b16 v[234:235], v245 offset:2048
v_mfma_f32_16x16x32_bf16 v[172:175], v[212:215], v[156:159], v[172:175]
ds_read_b64_tr_b16 v[236:237], v245 offset:4096
v_mfma_f32_16x16x32_bf16 v[172:175], v[208:211], v[152:155], v[172:175]
s_waitcnt lgkmcnt(7)
ds_read_b64_tr_b16 v[238:239], v245 offset:6144
v_mfma_f32_16x16x32_bf16 v[176:179], v[216:219], v[128:131], v[176:179]
v_mfma_f32_16x16x32_bf16 v[176:179], v[220:223], v[132:135], v[176:179]
ds_read_b64_tr_b16 v[192:193], v240
v_mfma_f32_16x16x32_bf16 v[180:183], v[220:223], v[140:143], v[180:183]
ds_read_b64_tr_b16 v[194:195], v240 offset:6144
v_mfma_f32_16x16x32_bf16 v[180:183], v[216:219], v[136:139], v[180:183]
ds_read_b64_tr_b16 v[196:197], v240 offset:12288
v_mfma_f32_16x16x32_bf16 v[184:187], v[216:219], v[144:147], v[184:187]
ds_read_b64_tr_b16 v[198:199], v240 offset:18432
v_mfma_f32_16x16x32_bf16 v[184:187], v[220:223], v[148:151], v[184:187]
v_mfma_f32_16x16x32_bf16 v[188:191], v[220:223], v[156:159], v[188:191]
s_waitcnt vmcnt(12)
v_mfma_f32_16x16x32_bf16 v[188:191], v[216:219], v[152:155], v[188:191]
s_waitcnt lgkmcnt(8)
v_mfma_f32_16x16x32_bf16 v[160:163], v[224:227], v[64:67], v[160:163]
s_add_u32 s57, s68, 24576
ds_read_b64_tr_b16 v[200:201], v240 offset:8
ds_read_b64_tr_b16 v[202:203], v240 offset:6152
v_mfma_f32_16x16x32_bf16 v[160:163], v[228:231], v[68:71], v[160:163]
s_add_u32 m0, s68, 122880
v_mfma_f32_16x16x32_bf16 v[164:167], v[228:231], v[76:79], v[164:167]
buffer_load_dwordx4 v7, s[8:11], s57 offen lds
v_mfma_f32_16x16x32_bf16 v[164:167], v[224:227], v[72:75], v[164:167]
v_mfma_f32_16x16x32_bf16 v[168:171], v[224:227], v[80:83], v[168:171]
ds_read_b64_tr_b16 v[204:205], v240 offset:12296
ds_read_b64_tr_b16 v[206:207], v240 offset:18440
v_mfma_f32_16x16x32_bf16 v[168:171], v[228:231], v[84:87], v[168:171]
v_mfma_f32_16x16x32_bf16 v[172:175], v[228:231], v[92:95], v[172:175]
v_mfma_f32_16x16x32_bf16 v[172:175], v[224:227], v[88:91], v[172:175]
s_waitcnt lgkmcnt(8)
v_mfma_f32_16x16x32_bf16 v[176:179], v[232:235], v[64:67], v[176:179]
ds_read_b64_tr_b16 v[208:209], v241
ds_read_b64_tr_b16 v[210:211], v241 offset:6144
v_mfma_f32_16x16x32_bf16 v[176:179], v[236:239], v[68:71], v[176:179]
v_mfma_f32_16x16x32_bf16 v[180:183], v[236:239], v[76:79], v[180:183]
v_mfma_f32_16x16x32_bf16 v[180:183], v[232:235], v[72:75], v[180:183]
v_mfma_f32_16x16x32_bf16 v[184:187], v[232:235], v[80:83], v[184:187]
ds_read_b64_tr_b16 v[212:213], v241 offset:12288
ds_read_b64_tr_b16 v[214:215], v241 offset:18432
v_mfma_f32_16x16x32_bf16 v[184:187], v[236:239], v[84:87], v[184:187]
v_mfma_f32_16x16x32_bf16 v[188:191], v[236:239], v[92:95], v[188:191]
v_mfma_f32_16x16x32_bf16 v[188:191], v[232:235], v[88:91], v[188:191]
s_waitcnt lgkmcnt(8)
v_mfma_f32_16x16x32_bf16 a[0:3], v[192:195], v[64:67], a[0:3]
ds_read_b64_tr_b16 v[216:217], v241 offset:8
ds_read_b64_tr_b16 v[218:219], v241 offset:6152
v_mfma_f32_16x16x32_bf16 a[0:3], v[196:199], v[68:71], a[0:3]
buffer_load_dwordx4 v8, s[8:11], s57 offen offset:1024 lds
v_mfma_f32_16x16x32_bf16 a[4:7], v[196:199], v[76:79], a[4:7]
v_mfma_f32_16x16x32_bf16 a[4:7], v[192:195], v[72:75], a[4:7]
v_mfma_f32_16x16x32_bf16 a[8:11], v[192:195], v[80:83], a[8:11]
ds_read_b64_tr_b16 v[220:221], v241 offset:12296
ds_read_b64_tr_b16 v[222:223], v241 offset:18440
v_mfma_f32_16x16x32_bf16 a[8:11], v[196:199], v[84:87], a[8:11]
v_mul_f32 v96, v160, v160
v_mul_f32 v97, v161, v161
v_mfma_f32_16x16x32_bf16 a[12:15], v[196:199], v[92:95], a[12:15]
v_mul_f32 v98, v162, v162
v_mul_f32 v99, v163, v163
v_mfma_f32_16x16x32_bf16 a[12:15], v[192:195], v[88:91], a[12:15]
s_waitcnt lgkmcnt(8)
v_fma_f32 v96, v96, s65, v14
v_fma_f32 v97, v97, s65, v14
v_mfma_f32_16x16x32_bf16 a[16:19], v[200:203], v[64:67], a[16:19]
ds_read_b64_tr_b16 v[224:225], v240 offset:128
ds_read_b64_tr_b16 v[226:227], v240 offset:6272
v_mfma_f32_16x16x32_bf16 a[16:19], v[204:207], v[68:71], a[16:19]
v_fma_f32 v98, v98, s65, v14
v_fma_f32 v99, v99, s65, v14
v_mfma_f32_16x16x32_bf16 a[20:23], v[204:207], v[76:79], a[20:23]
v_mul_f32 v96, v96, v160
v_mul_f32 v97, v97, v161
v_mfma_f32_16x16x32_bf16 a[20:23], v[200:203], v[72:75], a[20:23]
v_mul_f32 v98, v98, v162
v_mul_f32 v99, v99, v163
v_mfma_f32_16x16x32_bf16 a[24:27], v[200:203], v[80:83], a[24:27]
ds_read_b64_tr_b16 v[228:229], v240 offset:12416
ds_read_b64_tr_b16 v[230:231], v240 offset:18560
v_mfma_f32_16x16x32_bf16 a[24:27], v[204:207], v[84:87], a[24:27]
v_exp_f32 v96, v96
v_mfma_f32_16x16x32_bf16 a[28:31], v[204:207], v[92:95], a[28:31]
v_exp_f32 v97, v97
v_mfma_f32_16x16x32_bf16 a[28:31], v[200:203], v[88:91], a[28:31]
s_waitcnt lgkmcnt(8)
buffer_load_dwordx4 v9, s[8:11], s57 offen offset:2048 lds
v_accvgpr_read_b32 v128, a0
v_mfma_f32_16x16x32_bf16 a[32:35], v[208:211], v[64:67], a[32:35]
s_add_u32 s57, s68, 27648
ds_read_b64_tr_b16 v[232:233], v240 offset:136
ds_read_b64_tr_b16 v[234:235], v240 offset:6280
v_mfma_f32_16x16x32_bf16 a[32:35], v[212:215], v[68:71], a[32:35]
s_add_u32 m0, s68, 125952
v_exp_f32 v98, v98
v_mfma_f32_16x16x32_bf16 a[36:39], v[212:215], v[76:79], a[36:39]
v_exp_f32 v99, v99
v_mfma_f32_16x16x32_bf16 a[36:39], v[208:211], v[72:75], a[36:39]
v_fma_f32 v96, v96, s64, s64
v_fma_f32 v97, v97, s64, s64
v_mfma_f32_16x16x32_bf16 a[40:43], v[208:211], v[80:83], a[40:43]
ds_read_b64_tr_b16 v[236:237], v240 offset:12424
ds_read_b64_tr_b16 v[238:239], v240 offset:18568
v_mfma_f32_16x16x32_bf16 a[40:43], v[212:215], v[84:87], a[40:43]
v_fma_f32 v98, v98, s64, s64
v_fma_f32 v99, v99, s64, s64
v_mfma_f32_16x16x32_bf16 a[44:47], v[212:215], v[92:95], a[44:47]
v_rcp_f32 v96, v96
v_mfma_f32_16x16x32_bf16 a[44:47], v[208:211], v[88:91], a[44:47]
s_waitcnt lgkmcnt(8)
v_rcp_f32 v97, v97
v_mfma_f32_16x16x32_bf16 a[48:51], v[216:219], v[64:67], a[48:51]
ds_read_b64_tr_b16 v[192:193], v241 offset:128
ds_read_b64_tr_b16 v[194:195], v241 offset:6272
v_mfma_f32_16x16x32_bf16 a[48:51], v[220:223], v[68:71], a[48:51]
v_rcp_f32 v98, v98
v_mfma_f32_16x16x32_bf16 a[52:55], v[220:223], v[76:79], a[52:55]
v_rcp_f32 v99, v99
v_mfma_f32_16x16x32_bf16 a[52:55], v[216:219], v[72:75], a[52:55]
v_mul_f32 v96, v96, v160
v_mul_f32 v97, v97, v161
v_mfma_f32_16x16x32_bf16 a[56:59], v[216:219], v[80:83], a[56:59]
ds_read_b64_tr_b16 v[196:197], v241 offset:12416
ds_read_b64_tr_b16 v[198:199], v241 offset:18560
v_mfma_f32_16x16x32_bf16 a[56:59], v[220:223], v[84:87], a[56:59]
v_mul_f32 v98, v98, v162
v_mul_f32 v99, v99, v163
v_mfma_f32_16x16x32_bf16 a[60:63], v[220:223], v[92:95], a[60:63]
buffer_load_dwordx4 v7, s[8:11], s57 offen lds
v_cvt_pk_bf16_f32 v100, v96, v97
v_mfma_f32_16x16x32_bf16 a[60:63], v[216:219], v[88:91], a[60:63]
s_waitcnt lgkmcnt(8)
v_cvt_pk_bf16_f32 v101, v98, v99
v_mul_f32 v96, v176, v176
v_mfma_f32_16x16x32_bf16 a[64:67], v[224:227], v[64:67], a[64:67]
ds_read_b64_tr_b16 v[200:201], v241 offset:136
ds_read_b64_tr_b16 v[202:203], v241 offset:6280
v_mfma_f32_16x16x32_bf16 a[64:67], v[228:231], v[68:71], a[64:67]
v_mul_f32 v97, v177, v177
v_mul_f32 v98, v178, v178
v_mfma_f32_16x16x32_bf16 a[68:71], v[228:231], v[76:79], a[68:71]
v_mul_f32 v99, v179, v179
v_fma_f32 v96, v96, s65, v14
v_mfma_f32_16x16x32_bf16 a[68:71], v[224:227], v[72:75], a[68:71]
v_fma_f32 v97, v97, s65, v14
v_fma_f32 v98, v98, s65, v14
v_mfma_f32_16x16x32_bf16 a[72:75], v[224:227], v[80:83], a[72:75]
ds_read_b64_tr_b16 v[204:205], v241 offset:12424
ds_read_b64_tr_b16 v[206:207], v241 offset:18568
v_mfma_f32_16x16x32_bf16 a[72:75], v[228:231], v[84:87], a[72:75]
v_fma_f32 v99, v99, s65, v14
v_mul_f32 v96, v96, v176
v_mfma_f32_16x16x32_bf16 a[76:79], v[228:231], v[92:95], a[76:79]
v_mul_f32 v97, v97, v177
v_mul_f32 v98, v98, v178
v_mfma_f32_16x16x32_bf16 a[76:79], v[224:227], v[88:91], a[76:79]
s_waitcnt lgkmcnt(8)
v_mul_f32 v99, v99, v179
v_accvgpr_read_b32 v129, a1
v_mfma_f32_16x16x32_bf16 a[80:83], v[232:235], v[64:67], a[80:83]
ds_read_b64_tr_b16 v[208:209], v240 offset:256
ds_read_b64_tr_b16 v[210:211], v240 offset:6400
v_mfma_f32_16x16x32_bf16 a[80:83], v[236:239], v[68:71], a[80:83]
v_exp_f32 v96, v96
v_mfma_f32_16x16x32_bf16 a[84:87], v[236:239], v[76:79], a[84:87]
v_exp_f32 v97, v97
v_mfma_f32_16x16x32_bf16 a[84:87], v[232:235], v[72:75], a[84:87]
v_exp_f32 v98, v98
v_mfma_f32_16x16x32_bf16 a[88:91], v[232:235], v[80:83], a[88:91]
ds_read_b64_tr_b16 v[212:213], v240 offset:12544
ds_read_b64_tr_b16 v[214:215], v240 offset:18688
v_mfma_f32_16x16x32_bf16 a[88:91], v[236:239], v[84:87], a[88:91]
buffer_load_dwordx4 v8, s[8:11], s57 offen offset:1024 lds
v_accvgpr_read_b32 v130, a2
v_mfma_f32_16x16x32_bf16 a[92:95], v[236:239], v[92:95], a[92:95]
v_exp_f32 v99, v99
v_mfma_f32_16x16x32_bf16 a[92:95], v[232:235], v[88:91], a[92:95]
s_waitcnt lgkmcnt(8)
v_fma_f32 v96, v96, s64, s64
v_fma_f32 v97, v97, s64, s64
v_mfma_f32_16x16x32_bf16 a[96:99], v[192:195], v[64:67], a[96:99]
ds_read_b64_tr_b16 v[216:217], v240 offset:264
ds_read_b64_tr_b16 v[218:219], v240 offset:6408
v_mfma_f32_16x16x32_bf16 a[96:99], v[196:199], v[68:71], a[96:99]
v_fma_f32 v98, v98, s64, s64
v_fma_f32 v99, v99, s64, s64
v_mfma_f32_16x16x32_bf16 a[100:103], v[196:199], v[76:79], a[100:103]
v_rcp_f32 v96, v96
v_mfma_f32_16x16x32_bf16 a[100:103], v[192:195], v[72:75], a[100:103]
v_rcp_f32 v97, v97
v_mfma_f32_16x16x32_bf16 a[104:107], v[192:195], v[80:83], a[104:107]
ds_read_b64_tr_b16 v[220:221], v240 offset:12552
ds_read_b64_tr_b16 v[222:223], v240 offset:18696
v_mfma_f32_16x16x32_bf16 a[104:107], v[196:199], v[84:87], a[104:107]
v_rcp_f32 v98, v98
v_mfma_f32_16x16x32_bf16 a[108:111], v[196:199], v[92:95], a[108:111]
v_rcp_f32 v99, v99
v_mfma_f32_16x16x32_bf16 a[108:111], v[192:195], v[88:91], a[108:111]
s_waitcnt lgkmcnt(8)
v_mul_f32 v96, v96, v176
v_mul_f32 v97, v97, v177
v_mfma_f32_16x16x32_bf16 a[112:115], v[200:203], v[64:67], a[112:115]
ds_read_b64_tr_b16 v[224:225], v241 offset:256
ds_read_b64_tr_b16 v[226:227], v241 offset:6400
v_mfma_f32_16x16x32_bf16 a[112:115], v[204:207], v[68:71], a[112:115]
v_mul_f32 v98, v98, v178
v_mul_f32 v99, v99, v179
v_mfma_f32_16x16x32_bf16 a[116:119], v[204:207], v[76:79], a[116:119]
v_cvt_pk_bf16_f32 v102, v96, v97
v_cvt_pk_bf16_f32 v103, v98, v99
v_mfma_f32_16x16x32_bf16 a[116:119], v[200:203], v[72:75], a[116:119]
s_add_u32 s74, s59, 0
buffer_store_dwordx4 v[100:103], v10, s[20:23], s74 offen sc1
v_accvgpr_read_b32 v131, a3
v_mfma_f32_16x16x32_bf16 a[120:123], v[200:203], v[80:83], a[120:123]
ds_read_b64_tr_b16 v[228:229], v241 offset:12544
ds_read_b64_tr_b16 v[230:231], v241 offset:18688
v_mfma_f32_16x16x32_bf16 a[120:123], v[204:207], v[84:87], a[120:123]
buffer_load_dwordx4 v9, s[8:11], s57 offen offset:2048 lds
v_accvgpr_read_b32 v132, a16
v_mfma_f32_16x16x32_bf16 a[124:127], v[204:207], v[92:95], a[124:127]
v_accvgpr_read_b32 v133, a17
v_accvgpr_read_b32 v134, a18
v_mfma_f32_16x16x32_bf16 a[124:127], v[200:203], v[88:91], a[124:127]
s_waitcnt lgkmcnt(8)
v_accvgpr_read_b32 v135, a19
v_cvt_pk_bf16_f32 v136, v128, v129
v_mfma_f32_16x16x32_bf16 a[128:131], v[208:211], v[64:67], a[128:131]
ds_read_b64_tr_b16 v[232:233], v241 offset:264
ds_read_b64_tr_b16 v[234:235], v241 offset:6408
v_mfma_f32_16x16x32_bf16 a[128:131], v[212:215], v[68:71], a[128:131]
v_cvt_pk_bf16_f32 v137, v130, v131
v_cvt_pk_bf16_f32 v138, v132, v133
v_mfma_f32_16x16x32_bf16 a[132:135], v[212:215], v[76:79], a[132:135]
v_cvt_pk_bf16_f32 v139, v134, v135
v_accvgpr_write_b32 a192, v136
v_mfma_f32_16x16x32_bf16 a[132:135], v[208:211], v[72:75], a[132:135]
v_accvgpr_write_b32 a193, v137
v_accvgpr_write_b32 a194, v138
v_mfma_f32_16x16x32_bf16 a[136:139], v[208:211], v[80:83], a[136:139]
ds_read_b64_tr_b16 v[236:237], v241 offset:12552
ds_read_b64_tr_b16 v[238:239], v241 offset:18696
v_mfma_f32_16x16x32_bf16 a[136:139], v[212:215], v[84:87], a[136:139]
v_accvgpr_write_b32 a195, v139
v_accvgpr_read_b32 v144, a4
v_mfma_f32_16x16x32_bf16 a[140:143], v[212:215], v[92:95], a[140:143]
v_accvgpr_read_b32 v145, a5
v_accvgpr_read_b32 v146, a6
v_mfma_f32_16x16x32_bf16 a[140:143], v[208:211], v[88:91], a[140:143]
s_waitcnt lgkmcnt(8)
v_accvgpr_read_b32 v147, a7
v_accvgpr_read_b32 v148, a20
v_mfma_f32_16x16x32_bf16 a[144:147], v[216:219], v[64:67], a[144:147]
v_accvgpr_read_b32 v149, a21
v_accvgpr_read_b32 v150, a22
v_mfma_f32_16x16x32_bf16 a[144:147], v[220:223], v[68:71], a[144:147]
v_accvgpr_read_b32 v151, a23
v_cvt_pk_bf16_f32 v152, v144, v145
v_mfma_f32_16x16x32_bf16 a[148:151], v[220:223], v[76:79], a[148:151]
v_cvt_pk_bf16_f32 v153, v146, v147
v_cvt_pk_bf16_f32 v154, v148, v149
v_mfma_f32_16x16x32_bf16 a[148:151], v[216:219], v[72:75], a[148:151]
v_cvt_pk_bf16_f32 v155, v150, v151
v_accvgpr_write_b32 a216, v152
v_mfma_f32_16x16x32_bf16 a[152:155], v[216:219], v[80:83], a[152:155]
v_accvgpr_write_b32 a217, v153
v_accvgpr_write_b32 a218, v154
v_mfma_f32_16x16x32_bf16 a[152:155], v[220:223], v[84:87], a[152:155]
v_accvgpr_write_b32 a219, v155
v_accvgpr_read_b32 v128, a8
v_mfma_f32_16x16x32_bf16 a[156:159], v[220:223], v[92:95], a[156:159]
s_waitcnt vmcnt(7) lgkmcnt(0)
s_barrier
v_accvgpr_read_b32 v129, a9
v_mfma_f32_16x16x32_bf16 a[156:159], v[216:219], v[88:91], a[156:159]
s_waitcnt lgkmcnt(0)
s_add_u32 s57, s68, 49152
ds_read_b128 v[192:195], v1
v_mfma_f32_16x16x32_bf16 a[160:163], v[224:227], v[64:67], a[160:163]
s_add_u32 m0, s68, 49152
v_accvgpr_read_b32 v130, a10
v_accvgpr_read_b32 v131, a11
v_mfma_f32_16x16x32_bf16 a[160:163], v[228:231], v[68:71], a[160:163]
ds_read_b128 v[196:199], v2
buffer_load_dwordx4 v7, s[4:7], s57 offen lds
v_mfma_f32_16x16x32_bf16 a[164:167], v[228:231], v[76:79], a[164:167]
buffer_load_dwordx4 v8, s[4:7], s57 offen offset:1024 lds
v_accvgpr_read_b32 v132, a24
v_mfma_f32_16x16x32_bf16 a[164:167], v[224:227], v[72:75], a[164:167]
ds_read_b128 v[200:203], v1 offset:128
v_accvgpr_read_b32 v133, a25
v_mfma_f32_16x16x32_bf16 a[168:171], v[224:227], v[80:83], a[168:171]
v_accvgpr_read_b32 v134, a26
v_accvgpr_read_b32 v135, a27
v_mfma_f32_16x16x32_bf16 a[168:171], v[228:231], v[84:87], a[168:171]
ds_read_b128 v[204:207], v2 offset:128
buffer_load_dwordx4 v9, s[4:7], s57 offen offset:2048 lds
v_mfma_f32_16x16x32_bf16 a[172:175], v[228:231], v[92:95], a[172:175]
s_add_u32 s57, s68, 52224
s_add_u32 m0, s68, 52224
v_cvt_pk_bf16_f32 v136, v128, v129
v_mfma_f32_16x16x32_bf16 a[172:175], v[224:227], v[88:91], a[172:175]
s_waitcnt lgkmcnt(4)
ds_read_b128 v[208:211], v1 offset:256
buffer_load_dwordx4 v7, s[4:7], s57 offen lds
v_mfma_f32_16x16x32_bf16 a[176:179], v[232:235], v[64:67], a[176:179]
v_cvt_pk_bf16_f32 v137, v130, v131
v_cvt_pk_bf16_f32 v138, v132, v133
v_mfma_f32_16x16x32_bf16 a[176:179], v[236:239], v[68:71], a[176:179]
ds_read_b128 v[212:215], v2 offset:256
v_cvt_pk_bf16_f32 v139, v134, v135
v_mfma_f32_16x16x32_bf16 a[180:183], v[236:239], v[76:79], a[180:183]
buffer_load_dwordx4 v8, s[4:7], s57 offen offset:1024 lds
v_accvgpr_write_b32 a240, v136
v_mfma_f32_16x16x32_bf16 a[180:183], v[232:235], v[72:75], a[180:183]
v_accvgpr_write_b32 a241, v137
v_accvgpr_write_b32 a242, v138
v_mfma_f32_16x16x32_bf16 a[184:187], v[232:235], v[80:83], a[184:187]
buffer_load_dwordx4 v9, s[4:7], s57 offen offset:2048 lds
v_accvgpr_write_b32 a243, v139
v_mfma_f32_16x16x32_bf16 a[184:187], v[236:239], v[84:87], a[184:187]
v_accvgpr_read_b32 v144, a12
v_accvgpr_read_b32 v145, a13
v_mfma_f32_16x16x32_bf16 a[188:191], v[236:239], v[92:95], a[188:191]
v_accvgpr_read_b32 v146, a14
v_accvgpr_read_b32 v147, a15
v_mfma_f32_16x16x32_bf16 a[188:191], v[232:235], v[88:91], a[188:191]
v_accvgpr_read_b32 v148, a28
v_accvgpr_read_b32 v149, a29
L_mido:
s_nop 7
v_accvgpr_read_b32 v150, a30
v_accvgpr_read_b32 v151, a31
v_cvt_pk_bf16_f32 v40, v144, v145
v_cvt_pk_bf16_f32 v41, v146, v147
v_cvt_pk_bf16_f32 v42, v148, v149
v_cvt_pk_bf16_f32 v43, v150, v151
v_accvgpr_read_b32 v128, a32
v_accvgpr_read_b32 v129, a33
v_accvgpr_read_b32 v130, a34
v_accvgpr_read_b32 v131, a35
v_accvgpr_read_b32 v132, a48
v_accvgpr_read_b32 v133, a49
v_accvgpr_read_b32 v134, a50
v_accvgpr_read_b32 v135, a51
v_cvt_pk_bf16_f32 v136, v128, v129
v_cvt_pk_bf16_f32 v137, v130, v131
v_cvt_pk_bf16_f32 v138, v132, v133
v_cvt_pk_bf16_f32 v139, v134, v135
v_accvgpr_write_b32 a196, v136
v_accvgpr_write_b32 a197, v137
v_accvgpr_write_b32 a198, v138
v_accvgpr_write_b32 a199, v139
v_accvgpr_read_b32 v144, a36
v_accvgpr_read_b32 v145, a37
v_accvgpr_read_b32 v146, a38
v_accvgpr_read_b32 v147, a39
v_accvgpr_read_b32 v148, a52
v_accvgpr_read_b32 v149, a53
v_accvgpr_read_b32 v150, a54
v_accvgpr_read_b32 v151, a55
v_cvt_pk_bf16_f32 v152, v144, v145
v_cvt_pk_bf16_f32 v153, v146, v147
v_cvt_pk_bf16_f32 v154, v148, v149
v_cvt_pk_bf16_f32 v155, v150, v151
v_accvgpr_write_b32 a220, v152
v_accvgpr_write_b32 a221, v153
v_accvgpr_write_b32 a222, v154
v_accvgpr_write_b32 a223, v155
v_accvgpr_read_b32 v128, a40
v_accvgpr_read_b32 v129, a41
v_accvgpr_read_b32 v130, a42
v_accvgpr_read_b32 v131, a43
v_accvgpr_read_b32 v132, a56
v_accvgpr_read_b32 v133, a57
v_accvgpr_read_b32 v134, a58
v_accvgpr_read_b32 v135, a59
v_cvt_pk_bf16_f32 v136, v128, v129
v_cvt_pk_bf16_f32 v137, v130, v131
v_cvt_pk_bf16_f32 v138, v132, v133
v_cvt_pk_bf16_f32 v139, v134, v135
v_accvgpr_write_b32 a244, v136
v_accvgpr_write_b32 a245, v137
v_accvgpr_write_b32 a246, v138
v_accvgpr_write_b32 a247, v139
v_accvgpr_read_b32 v144, a44
v_accvgpr_read_b32 v145, a45
v_accvgpr_read_b32 v146, a46
v_accvgpr_read_b32 v147, a47
v_accvgpr_read_b32 v148, a60
v_accvgpr_read_b32 v149, a61
v_accvgpr_read_b32 v150, a62
v_accvgpr_read_b32 v151, a63
v_cvt_pk_bf16_f32 v44, v144, v145
v_cvt_pk_bf16_f32 v45, v146, v147
v_cvt_pk_bf16_f32 v46, v148, v149
v_cvt_pk_bf16_f32 v47, v150, v151
v_accvgpr_read_b32 v128, a64
v_accvgpr_read_b32 v129, a65
v_accvgpr_read_b32 v130, a66
v_accvgpr_read_b32 v131, a67
v_accvgpr_read_b32 v132, a80
v_accvgpr_read_b32 v133, a81
v_accvgpr_read_b32 v134, a82
v_accvgpr_read_b32 v135, a83
v_cvt_pk_bf16_f32 v136, v128, v129
v_cvt_pk_bf16_f32 v137, v130, v131
v_cvt_pk_bf16_f32 v138, v132, v133
v_cvt_pk_bf16_f32 v139, v134, v135
v_accvgpr_write_b32 a200, v136
v_accvgpr_write_b32 a201, v137
v_accvgpr_write_b32 a202, v138
v_accvgpr_write_b32 a203, v139
v_accvgpr_read_b32 v144, a68
v_accvgpr_read_b32 v145, a69
v_accvgpr_read_b32 v146, a70
v_accvgpr_read_b32 v147, a71
v_accvgpr_read_b32 v148, a84
v_accvgpr_read_b32 v149, a85
v_accvgpr_read_b32 v150, a86
v_accvgpr_read_b32 v151, a87
v_cvt_pk_bf16_f32 v152, v144, v145
v_cvt_pk_bf16_f32 v153, v146, v147
v_cvt_pk_bf16_f32 v154, v148, v149
v_cvt_pk_bf16_f32 v155, v150, v151
v_accvgpr_write_b32 a224, v152
v_accvgpr_write_b32 a225, v153
v_accvgpr_write_b32 a226, v154
v_accvgpr_write_b32 a227, v155
v_accvgpr_read_b32 v128, a72
v_accvgpr_read_b32 v129, a73
v_accvgpr_read_b32 v130, a74
v_accvgpr_read_b32 v131, a75
v_accvgpr_read_b32 v132, a88
v_accvgpr_read_b32 v133, a89
v_accvgpr_read_b32 v134, a90
v_accvgpr_read_b32 v135, a91
v_cvt_pk_bf16_f32 v136, v128, v129
v_cvt_pk_bf16_f32 v137, v130, v131
v_cvt_pk_bf16_f32 v138, v132, v133
v_cvt_pk_bf16_f32 v139, v134, v135
v_accvgpr_write_b32 a248, v136
v_accvgpr_write_b32 a249, v137
v_accvgpr_write_b32 a250, v138
v_accvgpr_write_b32 a251, v139
v_accvgpr_read_b32 v144, a76
v_accvgpr_read_b32 v145, a77
v_accvgpr_read_b32 v146, a78
v_accvgpr_read_b32 v147, a79
v_accvgpr_read_b32 v148, a92
v_accvgpr_read_b32 v149, a93
v_accvgpr_read_b32 v150, a94
v_accvgpr_read_b32 v151, a95
v_cvt_pk_bf16_f32 v48, v144, v145
v_cvt_pk_bf16_f32 v49, v146, v147
v_cvt_pk_bf16_f32 v50, v148, v149
v_cvt_pk_bf16_f32 v51, v150, v151
v_accvgpr_read_b32 v128, a96
v_accvgpr_read_b32 v129, a97
v_accvgpr_read_b32 v130, a98
v_accvgpr_read_b32 v131, a99
v_accvgpr_read_b32 v132, a112
v_accvgpr_read_b32 v133, a113
v_accvgpr_read_b32 v134, a114
v_accvgpr_read_b32 v135, a115
v_cvt_pk_bf16_f32 v136, v128, v129
v_cvt_pk_bf16_f32 v137, v130, v131
v_cvt_pk_bf16_f32 v138, v132, v133
v_cvt_pk_bf16_f32 v139, v134, v135
v_accvgpr_write_b32 a204, v136
v_accvgpr_write_b32 a205, v137
v_accvgpr_write_b32 a206, v138
v_accvgpr_write_b32 a207, v139
v_accvgpr_read_b32 v144, a100
v_accvgpr_read_b32 v145, a101
v_accvgpr_read_b32 v146, a102
v_accvgpr_read_b32 v147, a103
v_accvgpr_read_b32 v148, a116
v_accvgpr_read_b32 v149, a117
v_accvgpr_read_b32 v150, a118
v_accvgpr_read_b32 v151, a119
v_cvt_pk_bf16_f32 v152, v144, v145
v_cvt_pk_bf16_f32 v153, v146, v147
v_cvt_pk_bf16_f32 v154, v148, v149
v_cvt_pk_bf16_f32 v155, v150, v151
v_accvgpr_write_b32 a228, v152
v_accvgpr_write_b32 a229, v153
v_accvgpr_write_b32 a230, v154
v_accvgpr_write_b32 a231, v155
v_accvgpr_read_b32 v128, a104
v_accvgpr_read_b32 v129, a105
v_accvgpr_read_b32 v130, a106
v_accvgpr_read_b32 v131, a107
v_accvgpr_read_b32 v132, a120
v_accvgpr_read_b32 v133, a121
v_accvgpr_read_b32 v134, a122
v_accvgpr_read_b32 v135, a123
v_cvt_pk_bf16_f32 v136, v128, v129
v_cvt_pk_bf16_f32 v137, v130, v131
v_cvt_pk_bf16_f32 v138, v132, v133
v_cvt_pk_bf16_f32 v139, v134, v135
v_accvgpr_write_b32 a252, v136
v_accvgpr_write_b32 a253, v137
v_accvgpr_write_b32 a254, v138
v_accvgpr_write_b32 a255, v139
v_accvgpr_read_b32 v144, a108
v_accvgpr_read_b32 v145, a109
v_accvgpr_read_b32 v146, a110
v_accvgpr_read_b32 v147, a111
v_accvgpr_read_b32 v148, a124
v_accvgpr_read_b32 v149, a125
v_accvgpr_read_b32 v150, a126
v_accvgpr_read_b32 v151, a127
v_cvt_pk_bf16_f32 v52, v144, v145
v_cvt_pk_bf16_f32 v53, v146, v147
v_cvt_pk_bf16_f32 v54, v148, v149
v_cvt_pk_bf16_f32 v55, v150, v151
v_accvgpr_read_b32 v128, a128
v_accvgpr_read_b32 v129, a129
v_accvgpr_read_b32 v130, a130
v_accvgpr_read_b32 v131, a131
v_accvgpr_read_b32 v132, a144
v_accvgpr_read_b32 v133, a145
v_accvgpr_read_b32 v134, a146
v_accvgpr_read_b32 v135, a147
v_cvt_pk_bf16_f32 v136, v128, v129
v_cvt_pk_bf16_f32 v137, v130, v131
v_cvt_pk_bf16_f32 v138, v132, v133
v_cvt_pk_bf16_f32 v139, v134, v135
v_accvgpr_write_b32 a208, v136
v_accvgpr_write_b32 a209, v137
v_accvgpr_write_b32 a210, v138
v_accvgpr_write_b32 a211, v139
v_accvgpr_read_b32 v144, a132
v_accvgpr_read_b32 v145, a133
v_accvgpr_read_b32 v146, a134
v_accvgpr_read_b32 v147, a135
v_accvgpr_read_b32 v148, a148
v_accvgpr_read_b32 v149, a149
v_accvgpr_read_b32 v150, a150
v_accvgpr_read_b32 v151, a151
v_cvt_pk_bf16_f32 v152, v144, v145
v_cvt_pk_bf16_f32 v153, v146, v147
v_cvt_pk_bf16_f32 v154, v148, v149
v_cvt_pk_bf16_f32 v155, v150, v151
v_accvgpr_write_b32 a232, v152
v_accvgpr_write_b32 a233, v153
v_accvgpr_write_b32 a234, v154
v_accvgpr_write_b32 a235, v155
v_accvgpr_read_b32 v128, a136
v_accvgpr_read_b32 v129, a137
v_accvgpr_read_b32 v130, a138
v_accvgpr_read_b32 v131, a139
v_accvgpr_read_b32 v132, a152
v_accvgpr_read_b32 v133, a153
v_accvgpr_read_b32 v134, a154
v_accvgpr_read_b32 v135, a155
v_cvt_pk_bf16_f32 v32, v128, v129
v_cvt_pk_bf16_f32 v33, v130, v131
v_cvt_pk_bf16_f32 v34, v132, v133
v_cvt_pk_bf16_f32 v35, v134, v135
v_accvgpr_read_b32 v144, a140
v_accvgpr_read_b32 v145, a141
v_accvgpr_read_b32 v146, a142
v_accvgpr_read_b32 v147, a143
v_accvgpr_read_b32 v148, a156
v_accvgpr_read_b32 v149, a157
v_accvgpr_read_b32 v150, a158
v_accvgpr_read_b32 v151, a159
v_cvt_pk_bf16_f32 v56, v144, v145
v_cvt_pk_bf16_f32 v57, v146, v147
v_cvt_pk_bf16_f32 v58, v148, v149
v_cvt_pk_bf16_f32 v59, v150, v151
v_accvgpr_read_b32 v128, a160
v_accvgpr_read_b32 v129, a161
v_accvgpr_read_b32 v130, a162
v_accvgpr_read_b32 v131, a163
v_accvgpr_read_b32 v132, a176
v_accvgpr_read_b32 v133, a177
v_accvgpr_read_b32 v134, a178
v_accvgpr_read_b32 v135, a179
v_cvt_pk_bf16_f32 v136, v128, v129
v_cvt_pk_bf16_f32 v137, v130, v131
v_cvt_pk_bf16_f32 v138, v132, v133
v_cvt_pk_bf16_f32 v139, v134, v135
v_accvgpr_write_b32 a212, v136
v_accvgpr_write_b32 a213, v137
v_accvgpr_write_b32 a214, v138
v_accvgpr_write_b32 a215, v139
v_accvgpr_read_b32 v144, a164
v_accvgpr_read_b32 v145, a165
v_accvgpr_read_b32 v146, a166
v_accvgpr_read_b32 v147, a167
v_accvgpr_read_b32 v148, a180
v_accvgpr_read_b32 v149, a181
v_accvgpr_read_b32 v150, a182
v_accvgpr_read_b32 v151, a183
v_cvt_pk_bf16_f32 v152, v144, v145
v_cvt_pk_bf16_f32 v153, v146, v147
v_cvt_pk_bf16_f32 v154, v148, v149
v_cvt_pk_bf16_f32 v155, v150, v151
v_accvgpr_write_b32 a236, v152
v_accvgpr_write_b32 a237, v153
v_accvgpr_write_b32 a238, v154
v_accvgpr_write_b32 a239, v155
v_accvgpr_read_b32 v128, a168
v_accvgpr_read_b32 v129, a169
v_accvgpr_read_b32 v130, a170
v_accvgpr_read_b32 v131, a171
v_accvgpr_read_b32 v132, a184
v_accvgpr_read_b32 v133, a185
v_accvgpr_read_b32 v134, a186
v_accvgpr_read_b32 v135, a187
v_cvt_pk_bf16_f32 v36, v128, v129
v_cvt_pk_bf16_f32 v37, v130, v131
v_cvt_pk_bf16_f32 v38, v132, v133
v_cvt_pk_bf16_f32 v39, v134, v135
v_accvgpr_read_b32 v144, a172
v_accvgpr_read_b32 v145, a173
v_accvgpr_read_b32 v146, a174
v_accvgpr_read_b32 v147, a175
v_accvgpr_read_b32 v148, a188
v_accvgpr_read_b32 v149, a189
v_accvgpr_read_b32 v150, a190
v_accvgpr_read_b32 v151, a191
v_cvt_pk_bf16_f32 v60, v144, v145
v_cvt_pk_bf16_f32 v61, v146, v147
v_cvt_pk_bf16_f32 v62, v148, v149
v_cvt_pk_bf16_f32 v63, v150, v151
ds_read_b64 v[244:245], v3
ds_read_b64 v[246:247], v4 offset:6144
ds_read_b64 v[248:249], v5 offset:12288
ds_read_b64 v[250:251], v6 offset:18432
s_waitcnt lgkmcnt(0)
v_and_b32 v244, 0x7fff7fff, v244
v_and_b32 v245, 0x7fff7fff, v245
v_and_b32 v246, 0x7fff7fff, v246
v_and_b32 v247, 0x7fff7fff, v247
v_and_b32 v248, 0x7fff7fff, v248
v_and_b32 v249, 0x7fff7fff, v249
v_and_b32 v250, 0x7fff7fff, v250
v_and_b32 v251, 0x7fff7fff, v251
v_pk_max_u16 v244, v244, v248
v_pk_max_u16 v245, v245, v249
v_pk_max_u16 v246, v246, v250
v_pk_max_u16 v247, v247, v251
v_pk_max_u16 v244, v244, v245
v_pk_max_u16 v246, v246, v247
v_pk_max_u16 v244, v244, v246
v_lshlrev_b32 v245, 16, v244
v_max_u32 v244, v244, v245
v_cmp_le_u32 vcc, 0x3c800000, v244
s_mov_b32 s32, 0xc2400000
s_mov_b32 s33, 0x5f800000
s_cmp_lg_u64 vcc, 0
s_cselect_b32 s32, 0xc2cc0000, s32
s_cselect_b32 s33, 0x44800000, s33
v_mfma_f32_16x16x32_bf16 v[64:67], v[192:195], a[192:195], 0
v_mul_f32 v248, v164, v164
v_mul_f32 v249, v165, v165
v_mfma_f32_16x16x32_bf16 v[64:67], v[196:199], a[196:199], v[64:67]
s_waitcnt lgkmcnt(0)
ds_read_b128 v[216:219], v1 offset:6144
v_mul_f32 v250, v166, v166
v_mfma_f32_16x16x32_bf16 v[64:67], v[200:203], a[200:203], v[64:67]
v_mul_f32 v251, v167, v167
v_fma_f32 v248, v248, s65, v14
v_mfma_f32_16x16x32_bf16 v[64:67], v[204:207], a[204:207], v[64:67]
s_waitcnt lgkmcnt(1)
v_fma_f32 v249, v249, s65, v14
v_fma_f32 v250, v250, s65, v14
v_mfma_f32_16x16x32_bf16 v[64:67], v[208:211], a[208:211], v[64:67]
ds_read_b128 v[220:223], v2 offset:6144
v_fma_f32 v251, v251, s65, v14
v_mfma_f32_16x16x32_bf16 v[64:67], v[212:215], a[212:215], v[64:67]
v_mul_f32 v248, v248, v164
v_mul_f32 v249, v249, v165
v_mfma_f32_16x16x32_bf16 v[68:71], v[212:215], a[236:239], 0
v_mul_f32 v250, v250, v166
v_mul_f32 v251, v251, v167
v_mfma_f32_16x16x32_bf16 v[68:71], v[208:211], a[232:235], v[68:71]
ds_read_b128 v[224:227], v1 offset:6272
v_mul_f32 v240, v168, v168
v_mfma_f32_16x16x32_bf16 v[68:71], v[204:207], a[228:231], v[68:71]
v_exp_f32 v248, v248
v_mfma_f32_16x16x32_bf16 v[68:71], v[200:203], a[224:227], v[68:71]
v_exp_f32 v249, v249
v_mfma_f32_16x16x32_bf16 v[68:71], v[196:199], a[220:223], v[68:71]
ds_read_b128 v[228:231], v2 offset:6272
v_mul_f32 v241, v169, v169
v_mfma_f32_16x16x32_bf16 v[68:71], v[192:195], a[216:219], v[68:71]
v_exp_f32 v250, v250
v_mfma_f32_16x16x32_bf16 v[72:75], v[192:195], a[240:243], 0
v_exp_f32 v251, v251
v_mfma_f32_16x16x32_bf16 v[72:75], v[196:199], a[244:247], v[72:75]
ds_read_b128 v[232:235], v1 offset:6400
v_max3_f32 v16, v64, v65, v66
v_mfma_f32_16x16x32_bf16 v[72:75], v[200:203], a[248:251], v[72:75]
v_max_f32 v16, v16, v67
v_fma_f32 v248, v248, s64, s64
v_mfma_f32_16x16x32_bf16 v[72:75], v[204:207], a[252:255], v[72:75]
v_fma_f32 v249, v249, s64, s64
v_fma_f32 v250, v250, s64, s64
v_mfma_f32_16x16x32_bf16 v[72:75], v[208:211], v[32:35], v[72:75]
ds_read_b128 v[236:239], v2 offset:6400
v_fma_f32 v251, v251, s64, s64
v_mfma_f32_16x16x32_bf16 v[72:75], v[212:215], v[36:39], v[72:75]
v_rcp_f32 v248, v248
v_mfma_f32_16x16x32_bf16 v[76:79], v[212:215], v[60:63], 0
v_rcp_f32 v249, v249
v_mfma_f32_16x16x32_bf16 v[76:79], v[208:211], v[56:59], v[76:79]
v_max3_f32 v20, v68, v69, v70
v_max_f32 v20, v20, v71
v_mfma_f32_16x16x32_bf16 v[76:79], v[204:207], v[52:55], v[76:79]
v_rcp_f32 v250, v250
v_mfma_f32_16x16x32_bf16 v[76:79], v[200:203], v[48:51], v[76:79]
v_rcp_f32 v251, v251
v_mfma_f32_16x16x32_bf16 v[76:79], v[196:199], v[44:47], v[76:79]
v_mul_f32 v248, v248, v164
v_mul_f32 v249, v249, v165
v_mfma_f32_16x16x32_bf16 v[76:79], v[192:195], v[40:43], v[76:79]
s_waitcnt lgkmcnt(0)
v_mul_f32 v250, v250, v166
v_mul_f32 v251, v251, v167
v_mfma_f32_16x16x32_bf16 v[80:83], v[216:219], a[192:195], 0
v_cvt_pk_bf16_f32 v252, v248, v249
v_cvt_pk_bf16_f32 v253, v250, v251
v_mfma_f32_16x16x32_bf16 v[80:83], v[220:223], a[196:199], v[80:83]
ds_read_b128 v[192:195], v1 offset:12288
v_max3_f32 v24, v72, v73, v74
v_mfma_f32_16x16x32_bf16 v[80:83], v[224:227], a[200:203], v[80:83]
v_max_f32 v24, v24, v75
v_mul_f32 v248, v180, v180
v_mfma_f32_16x16x32_bf16 v[80:83], v[228:231], a[204:207], v[80:83]
v_mul_f32 v249, v181, v181
v_mul_f32 v250, v182, v182
v_mfma_f32_16x16x32_bf16 v[80:83], v[232:235], a[208:211], v[80:83]
ds_read_b128 v[196:199], v2 offset:12288
v_mul_f32 v251, v183, v183
v_mfma_f32_16x16x32_bf16 v[80:83], v[236:239], a[212:215], v[80:83]
v_fma_f32 v248, v248, s65, v14
v_fma_f32 v249, v249, s65, v14
v_mfma_f32_16x16x32_bf16 v[84:87], v[236:239], a[236:239], 0
v_fma_f32 v250, v250, s65, v14
v_fma_f32 v251, v251, s65, v14
v_mfma_f32_16x16x32_bf16 v[84:87], v[232:235], a[232:235], v[84:87]
ds_read_b128 v[200:203], v1 offset:12416
v_max3_f32 v28, v76, v77, v78
v_mfma_f32_16x16x32_bf16 v[84:87], v[228:231], a[228:231], v[84:87]
v_max_f32 v28, v28, v79
v_mul_f32 v248, v248, v180
v_mfma_f32_16x16x32_bf16 v[84:87], v[224:227], a[224:227], v[84:87]
v_mul_f32 v249, v249, v181
v_mul_f32 v250, v250, v182
v_mfma_f32_16x16x32_bf16 v[84:87], v[220:223], a[220:223], v[84:87]
ds_read_b128 v[204:207], v2 offset:12416
v_mul_f32 v251, v251, v183
v_mfma_f32_16x16x32_bf16 v[84:87], v[216:219], a[216:219], v[84:87]
v_exp_f32 v248, v248
v_mfma_f32_16x16x32_bf16 v[88:91], v[216:219], a[240:243], 0
v_exp_f32 v249, v249
v_mfma_f32_16x16x32_bf16 v[88:91], v[220:223], a[244:247], v[88:91]
ds_read_b128 v[208:211], v1 offset:12544
v_max3_f32 v16, v16, v80, v81
v_mfma_f32_16x16x32_bf16 v[88:91], v[224:227], a[248:251], v[88:91]
v_max3_f32 v16, v16, v82, v83
v_mul_f32 v242, v170, v170
v_mfma_f32_16x16x32_bf16 v[88:91], v[228:231], a[252:255], v[88:91]
v_exp_f32 v250, v250
v_mfma_f32_16x16x32_bf16 v[88:91], v[232:235], v[32:35], v[88:91]
ds_read_b128 v[212:215], v2 offset:12544
v_mul_f32 v243, v171, v171
v_mfma_f32_16x16x32_bf16 v[88:91], v[236:239], v[36:39], v[88:91]
v_exp_f32 v251, v251
v_mfma_f32_16x16x32_bf16 v[92:95], v[236:239], v[60:63], 0
v_fma_f32 v248, v248, s64, s64
v_fma_f32 v249, v249, s64, s64
v_mfma_f32_16x16x32_bf16 v[92:95], v[232:235], v[56:59], v[92:95]
v_max3_f32 v20, v20, v84, v85
v_max3_f32 v20, v20, v86, v87
v_mfma_f32_16x16x32_bf16 v[92:95], v[228:231], v[52:55], v[92:95]
v_fma_f32 v250, v250, s64, s64
v_fma_f32 v251, v251, s64, s64
v_mfma_f32_16x16x32_bf16 v[92:95], v[224:227], v[48:51], v[92:95]
v_rcp_f32 v248, v248
v_mfma_f32_16x16x32_bf16 v[92:95], v[220:223], v[44:47], v[92:95]
v_rcp_f32 v249, v249
v_mfma_f32_16x16x32_bf16 v[92:95], v[216:219], v[40:43], v[92:95]
s_waitcnt lgkmcnt(0)
v_rcp_f32 v250, v250
v_mfma_f32_16x16x32_bf16 v[96:99], v[192:195], a[192:195], 0
v_rcp_f32 v251, v251
v_mfma_f32_16x16x32_bf16 v[96:99], v[196:199], a[196:199], v[96:99]
ds_read_b128 v[216:219], v1 offset:18432
v_max3_f32 v24, v24, v88, v89
v_mfma_f32_16x16x32_bf16 v[96:99], v[200:203], a[200:203], v[96:99]
v_max3_f32 v24, v24, v90, v91
v_mul_f32 v248, v248, v180
v_mfma_f32_16x16x32_bf16 v[96:99], v[204:207], a[204:207], v[96:99]
v_mul_f32 v249, v249, v181
v_mul_f32 v250, v250, v182
v_mfma_f32_16x16x32_bf16 v[96:99], v[208:211], a[208:211], v[96:99]
ds_read_b128 v[220:223], v2 offset:18432
v_mul_f32 v251, v251, v183
v_mfma_f32_16x16x32_bf16 v[96:99], v[212:215], a[212:215], v[96:99]
v_cvt_pk_bf16_f32 v254, v248, v249
v_cvt_pk_bf16_f32 v255, v250, v251
v_mfma_f32_16x16x32_bf16 v[100:103], v[212:215], a[236:239], 0
s_add_u32 s75, s59, 245760
buffer_store_dwordx4 v[252:255], v10, s[20:23], s75 offen sc1
v_fma_f32 v240, v240, s65, v14
v_mfma_f32_16x16x32_bf16 v[100:103], v[208:211], a[232:235], v[100:103]
ds_read_b128 v[224:227], v1 offset:18560
v_max3_f32 v28, v28, v92, v93
v_mfma_f32_16x16x32_bf16 v[100:103], v[204:207], a[228:231], v[100:103]
v_max3_f32 v28, v28, v94, v95
v_fma_f32 v241, v241, s65, v14
v_mfma_f32_16x16x32_bf16 v[100:103], v[200:203], a[224:227], v[100:103]
v_fma_f32 v242, v242, s65, v14
v_fma_f32 v243, v243, s65, v14
v_mfma_f32_16x16x32_bf16 v[100:103], v[196:199], a[220:223], v[100:103]
ds_read_b128 v[228:231], v2 offset:18560
v_mul_f32 v240, v240, v168
v_mfma_f32_16x16x32_bf16 v[100:103], v[192:195], a[216:219], v[100:103]
v_mul_f32 v241, v241, v169
v_mul_f32 v242, v242, v170
v_mfma_f32_16x16x32_bf16 v[104:107], v[192:195], a[240:243], 0
v_mul_f32 v243, v243, v171
v_mfma_f32_16x16x32_bf16 v[104:107], v[196:199], a[244:247], v[104:107]
ds_read_b128 v[232:235], v1 offset:18688
v_max3_f32 v16, v16, v96, v97
v_mfma_f32_16x16x32_bf16 v[104:107], v[200:203], a[248:251], v[104:107]
v_max3_f32 v16, v16, v98, v99
v_mfma_f32_16x16x32_bf16 v[104:107], v[204:207], a[252:255], v[104:107]
v_exp_f32 v240, v240
v_mfma_f32_16x16x32_bf16 v[104:107], v[208:211], v[32:35], v[104:107]
ds_read_b128 v[236:239], v2 offset:18688
v_mfma_f32_16x16x32_bf16 v[104:107], v[212:215], v[36:39], v[104:107]
v_exp_f32 v241, v241
v_mfma_f32_16x16x32_bf16 v[108:111], v[212:215], v[60:63], 0
v_exp_f32 v242, v242
v_mfma_f32_16x16x32_bf16 v[108:111], v[208:211], v[56:59], v[108:111]
v_max3_f32 v20, v20, v100, v101
v_max3_f32 v20, v20, v102, v103
v_mfma_f32_16x16x32_bf16 v[108:111], v[204:207], v[52:55], v[108:111]
v_exp_f32 v243, v243
v_mfma_f32_16x16x32_bf16 v[108:111], v[200:203], v[48:51], v[108:111]
v_fma_f32 v240, v240, s64, s64
v_fma_f32 v241, v241, s64, s64
v_mfma_f32_16x16x32_bf16 v[108:111], v[196:199], v[44:47], v[108:111]
v_fma_f32 v242, v242, s64, s64
v_fma_f32 v243, v243, s64, s64
v_mfma_f32_16x16x32_bf16 v[108:111], v[192:195], v[40:43], v[108:111]
s_waitcnt lgkmcnt(0)
v_rcp_f32 v240, v240
v_mfma_f32_16x16x32_bf16 v[112:115], v[216:219], a[192:195], 0
v_rcp_f32 v241, v241
v_mfma_f32_16x16x32_bf16 v[112:115], v[220:223], a[196:199], v[112:115]
v_max3_f32 v24, v24, v104, v105
v_max3_f32 v24, v24, v106, v107
v_mfma_f32_16x16x32_bf16 v[112:115], v[224:227], a[200:203], v[112:115]
v_rcp_f32 v242, v242
v_mfma_f32_16x16x32_bf16 v[112:115], v[228:231], a[204:207], v[112:115]
v_rcp_f32 v243, v243
v_mfma_f32_16x16x32_bf16 v[112:115], v[232:235], a[208:211], v[112:115]
v_mul_f32 v240, v240, v168
v_mul_f32 v241, v241, v169
v_mfma_f32_16x16x32_bf16 v[112:115], v[236:239], a[212:215], v[112:115]
v_mul_f32 v242, v242, v170
v_mul_f32 v243, v243, v171
v_mfma_f32_16x16x32_bf16 v[116:119], v[236:239], a[236:239], 0
v_cvt_pk_bf16_f32 v244, v240, v241
v_cvt_pk_bf16_f32 v245, v242, v243
v_mfma_f32_16x16x32_bf16 v[116:119], v[232:235], a[232:235], v[116:119]
v_max3_f32 v28, v28, v108, v109
v_max3_f32 v28, v28, v110, v111
v_mfma_f32_16x16x32_bf16 v[116:119], v[228:231], a[228:231], v[116:119]
v_mul_f32 v240, v184, v184
v_mul_f32 v241, v185, v185
v_mfma_f32_16x16x32_bf16 v[116:119], v[224:227], a[224:227], v[116:119]
v_mul_f32 v242, v186, v186
v_mul_f32 v243, v187, v187
v_mfma_f32_16x16x32_bf16 v[116:119], v[220:223], a[220:223], v[116:119]
v_fma_f32 v240, v240, s65, v14
v_fma_f32 v241, v241, s65, v14
v_mfma_f32_16x16x32_bf16 v[116:119], v[216:219], a[216:219], v[116:119]
v_fma_f32 v242, v242, s65, v14
v_fma_f32 v243, v243, s65, v14
v_mfma_f32_16x16x32_bf16 v[120:123], v[216:219], a[240:243], 0
v_mul_f32 v240, v240, v184
v_mul_f32 v241, v241, v185
v_mfma_f32_16x16x32_bf16 v[120:123], v[220:223], a[244:247], v[120:123]
v_max3_f32 v16, v16, v112, v113
v_max3_f32 v16, v16, v114, v115
v_mfma_f32_16x16x32_bf16 v[120:123], v[224:227], a[248:251], v[120:123]
v_mul_f32 v242, v242, v186
v_mul_f32 v243, v243, v187
v_mfma_f32_16x16x32_bf16 v[120:123], v[228:231], a[252:255], v[120:123]
v_exp_f32 v240, v240
v_mfma_f32_16x16x32_bf16 v[120:123], v[232:235], v[32:35], v[120:123]
v_exp_f32 v241, v241
v_mfma_f32_16x16x32_bf16 v[120:123], v[236:239], v[36:39], v[120:123]
v_exp_f32 v242, v242
v_mfma_f32_16x16x32_bf16 v[124:127], v[236:239], v[60:63], 0
v_exp_f32 v243, v243
v_mfma_f32_16x16x32_bf16 v[124:127], v[232:235], v[56:59], v[124:127]
v_max3_f32 v20, v20, v116, v117
v_max3_f32 v20, v20, v118, v119
v_mfma_f32_16x16x32_bf16 v[124:127], v[228:231], v[52:55], v[124:127]
v_fma_f32 v240, v240, s64, s64
v_fma_f32 v241, v241, s64, s64
v_mfma_f32_16x16x32_bf16 v[124:127], v[224:227], v[48:51], v[124:127]
v_fma_f32 v242, v242, s64, s64
v_fma_f32 v243, v243, s64, s64
v_mfma_f32_16x16x32_bf16 v[124:127], v[220:223], v[44:47], v[124:127]
v_rcp_f32 v240, v240
v_mfma_f32_16x16x32_bf16 v[124:127], v[216:219], v[40:43], v[124:127]
v_rcp_f32 v241, v241
s_waitcnt vmcnt(14)
s_barrier
v_add_u32 v1, 24576, v1
v_add_u32 v2, 24576, v2
s_nop 4
ds_read_b128 v[192:195], v1
ds_read_b128 v[196:199], v2
ds_read_b128 v[200:203], v1 offset:128
ds_read_b128 v[204:207], v2 offset:128
ds_read_b128 v[208:211], v1 offset:256
ds_read_b128 v[212:215], v2 offset:256
v_max3_f32 v24, v24, v120, v121
v_max3_f32 v24, v24, v122, v123
v_max3_f32 v28, v28, v124, v125
v_max3_f32 v28, v28, v126, v127
v_mov_b32 v17, v16
v_mov_b32 v21, v20
v_mov_b32 v25, v24
v_mov_b32 v29, v28
v_permlane32_swap_b32 v16, v17
v_permlane32_swap_b32 v20, v21
v_permlane32_swap_b32 v24, v25
v_permlane32_swap_b32 v28, v29
v_max_f32 v16, v16, v17
v_max_f32 v20, v20, v21
v_max_f32 v24, v24, v25
v_max_f32 v28, v28, v29
v_mov_b32 v17, v16
v_mov_b32 v21, v20
v_mov_b32 v25, v24
v_mov_b32 v29, v28
v_permlane16_swap_b32 v16, v17
v_permlane16_swap_b32 v20, v21
v_permlane16_swap_b32 v24, v25
v_permlane16_swap_b32 v28, v29
v_max_f32 v16, v16, v17
v_max_f32 v20, v20, v21
v_max_f32 v24, v24, v25
v_max_f32 v28, v28, v29
v_sub_f32 v16, s32, v16
v_sub_f32 v20, s32, v20
v_sub_f32 v24, s32, v24
v_sub_f32 v28, s32, v28
v_mov_b32 v17, v16
v_mov_b32 v18, v16
v_mov_b32 v19, v16
v_mov_b32 v21, v20
v_mov_b32 v22, v20
v_mov_b32 v23, v20
v_mov_b32 v25, v24
v_mov_b32 v26, v24
v_mov_b32 v27, v24
v_mov_b32 v29, v28
v_mov_b32 v30, v28
v_mov_b32 v31, v28
v_rcp_f32 v242, v242
v_rcp_f32 v243, v243
v_mul_f32 v240, v240, v184
v_mul_f32 v241, v241, v185
v_mul_f32 v242, v242, v186
v_mul_f32 v243, v243, v187
v_cvt_pk_bf16_f32 v246, v240, v241
v_cvt_pk_bf16_f32 v247, v242, v243
s_add_u32 s74, s59, 491520
buffer_store_dwordx4 v[244:247], v10, s[20:23], s74 offen sc1
v_pk_mul_f32 v[248:249], v[172:173], v[172:173]
v_pk_mul_f32 v[250:251], v[174:175], v[174:175]
v_pk_fma_f32 v[248:249], v[248:249], s[64:65], v[14:15] op_sel:[0,1,0] op_sel_hi:[1,1,0]
v_pk_fma_f32 v[250:251], v[250:251], s[64:65], v[14:15] op_sel:[0,1,0] op_sel_hi:[1,1,0]
v_pk_mul_f32 v[248:249], v[248:249], v[172:173]
v_pk_mul_f32 v[250:251], v[250:251], v[174:175]
v_exp_f32 v248, v248
v_exp_f32 v249, v249
v_exp_f32 v250, v250
v_exp_f32 v251, v251
s_nop 0
v_pk_fma_f32 v[248:249], v[248:249], s[64:65], s[64:65] op_sel_hi:[1,0,0]
v_pk_fma_f32 v[250:251], v[250:251], s[64:65], s[64:65] op_sel_hi:[1,0,0]
v_rcp_f32 v248, v248
v_rcp_f32 v249, v249
v_rcp_f32 v250, v250
v_rcp_f32 v251, v251
s_nop 0
v_pk_mul_f32 v[248:249], v[248:249], v[172:173]
v_pk_mul_f32 v[250:251], v[250:251], v[174:175]
v_cvt_pk_bf16_f32 v252, v248, v249
v_cvt_pk_bf16_f32 v253, v250, v251
v_pk_mul_f32 v[248:249], v[188:189], v[188:189]
v_pk_mul_f32 v[250:251], v[190:191], v[190:191]
v_pk_fma_f32 v[248:249], v[248:249], s[64:65], v[14:15] op_sel:[0,1,0] op_sel_hi:[1,1,0]
v_pk_fma_f32 v[250:251], v[250:251], s[64:65], v[14:15] op_sel:[0,1,0] op_sel_hi:[1,1,0]
v_pk_mul_f32 v[248:249], v[248:249], v[188:189]
v_pk_mul_f32 v[250:251], v[250:251], v[190:191]
v_exp_f32 v248, v248
v_exp_f32 v249, v249
v_exp_f32 v250, v250
v_exp_f32 v251, v251
s_nop 0
v_pk_fma_f32 v[248:249], v[248:249], s[64:65], s[64:65] op_sel_hi:[1,0,0]
v_pk_fma_f32 v[250:251], v[250:251], s[64:65], s[64:65] op_sel_hi:[1,0,0]
v_rcp_f32 v248, v248
v_rcp_f32 v249, v249
v_rcp_f32 v250, v250
v_rcp_f32 v251, v251
s_nop 0
v_pk_mul_f32 v[248:249], v[248:249], v[188:189]
v_pk_mul_f32 v[250:251], v[250:251], v[190:191]
v_cvt_pk_bf16_f32 v254, v248, v249
v_cvt_pk_bf16_f32 v255, v250, v251
s_add_u32 s75, s59, 737280
buffer_store_dwordx4 v[252:255], v10, s[20:23], s75 offen sc1
s_branch L_common
L_safe:
s_waitcnt vmcnt(0) lgkmcnt(0)
s_nop 7
v_subrev_u32 v1, 24576, v1
v_subrev_u32 v2, 24576, v2
v_subrev_u32 v3, 49152, v3
v_subrev_u32 v4, 49152, v4
v_subrev_u32 v5, 49152, v5
v_subrev_u32 v6, 49152, v6
v_accvgpr_write_b32 a0, 0
v_accvgpr_write_b32 a1, 0
v_accvgpr_write_b32 a2, 0
v_accvgpr_write_b32 a3, 0
v_accvgpr_write_b32 a4, 0
v_accvgpr_write_b32 a5, 0
v_accvgpr_write_b32 a6, 0
v_accvgpr_write_b32 a7, 0
v_accvgpr_write_b32 a8, 0
v_accvgpr_write_b32 a9, 0
v_accvgpr_write_b32 a10, 0
v_accvgpr_write_b32 a11, 0
v_accvgpr_write_b32 a12, 0
v_accvgpr_write_b32 a13, 0
v_accvgpr_write_b32 a14, 0
v_accvgpr_write_b32 a15, 0
v_accvgpr_write_b32 a16, 0
v_accvgpr_write_b32 a17, 0
v_accvgpr_write_b32 a18, 0
v_accvgpr_write_b32 a19, 0
v_accvgpr_write_b32 a20, 0
v_accvgpr_write_b32 a21, 0
v_accvgpr_write_b32 a22, 0
v_accvgpr_write_b32 a23, 0
v_accvgpr_write_b32 a24, 0
v_accvgpr_write_b32 a25, 0
v_accvgpr_write_b32 a26, 0
v_accvgpr_write_b32 a27, 0
v_accvgpr_write_b32 a28, 0
v_accvgpr_write_b32 a29, 0
v_accvgpr_write_b32 a30, 0
v_accvgpr_write_b32 a31, 0
v_accvgpr_write_b32 a32, 0
v_accvgpr_write_b32 a33, 0
v_accvgpr_write_b32 a34, 0
v_accvgpr_write_b32 a35, 0
v_accvgpr_write_b32 a36, 0
v_accvgpr_write_b32 a37, 0
v_accvgpr_write_b32 a38, 0
v_accvgpr_write_b32 a39, 0
v_accvgpr_write_b32 a40, 0
v_accvgpr_write_b32 a41, 0
v_accvgpr_write_b32 a42, 0
v_accvgpr_write_b32 a43, 0
v_accvgpr_write_b32 a44, 0
v_accvgpr_write_b32 a45, 0
v_accvgpr_write_b32 a46, 0
v_accvgpr_write_b32 a47, 0
v_accvgpr_write_b32 a48, 0
v_accvgpr_write_b32 a49, 0
v_accvgpr_write_b32 a50, 0
v_accvgpr_write_b32 a51, 0
v_accvgpr_write_b32 a52, 0
v_accvgpr_write_b32 a53, 0
v_accvgpr_write_b32 a54, 0
v_accvgpr_write_b32 a55, 0
v_accvgpr_write_b32 a56, 0
v_accvgpr_write_b32 a57, 0
v_accvgpr_write_b32 a58, 0
v_accvgpr_write_b32 a59, 0
v_accvgpr_write_b32 a60, 0
v_accvgpr_write_b32 a61, 0
v_accvgpr_write_b32 a62, 0
v_accvgpr_write_b32 a63, 0
v_accvgpr_write_b32 a64, 0
v_accvgpr_write_b32 a65, 0
v_accvgpr_write_b32 a66, 0
v_accvgpr_write_b32 a67, 0
v_accvgpr_write_b32 a68, 0
v_accvgpr_write_b32 a69, 0
v_accvgpr_write_b32 a70, 0
v_accvgpr_write_b32 a71, 0
v_accvgpr_write_b32 a72, 0
v_accvgpr_write_b32 a73, 0
v_accvgpr_write_b32 a74, 0
v_accvgpr_write_b32 a75, 0
v_accvgpr_write_b32 a76, 0
v_accvgpr_write_b32 a77, 0
v_accvgpr_write_b32 a78, 0
v_accvgpr_write_b32 a79, 0
v_accvgpr_write_b32 a80, 0
v_accvgpr_write_b32 a81, 0
v_accvgpr_write_b32 a82, 0
v_accvgpr_write_b32 a83, 0
v_accvgpr_write_b32 a84, 0
v_accvgpr_write_b32 a85, 0
v_accvgpr_write_b32 a86, 0
v_accvgpr_write_b32 a87, 0
v_accvgpr_write_b32 a88, 0
v_accvgpr_write_b32 a89, 0
v_accvgpr_write_b32 a90, 0
v_accvgpr_write_b32 a91, 0
v_accvgpr_write_b32 a92, 0
v_accvgpr_write_b32 a93, 0
v_accvgpr_write_b32 a94, 0
v_accvgpr_write_b32 a95, 0
v_accvgpr_write_b32 a96, 0
v_accvgpr_write_b32 a97, 0
v_accvgpr_write_b32 a98, 0
v_accvgpr_write_b32 a99, 0
v_accvgpr_write_b32 a100, 0
v_accvgpr_write_b32 a101, 0
v_accvgpr_write_b32 a102, 0
v_accvgpr_write_b32 a103, 0
v_accvgpr_write_b32 a104, 0
v_accvgpr_write_b32 a105, 0
v_accvgpr_write_b32 a106, 0
v_accvgpr_write_b32 a107, 0
v_accvgpr_write_b32 a108, 0
v_accvgpr_write_b32 a109, 0
v_accvgpr_write_b32 a110, 0
v_accvgpr_write_b32 a111, 0
v_accvgpr_write_b32 a112, 0
v_accvgpr_write_b32 a113, 0
v_accvgpr_write_b32 a114, 0
v_accvgpr_write_b32 a115, 0
v_accvgpr_write_b32 a116, 0
v_accvgpr_write_b32 a117, 0
v_accvgpr_write_b32 a118, 0
v_accvgpr_write_b32 a119, 0
v_accvgpr_write_b32 a120, 0
v_accvgpr_write_b32 a121, 0
v_accvgpr_write_b32 a122, 0
v_accvgpr_write_b32 a123, 0
v_accvgpr_write_b32 a124, 0
v_accvgpr_write_b32 a125, 0
v_accvgpr_write_b32 a126, 0
v_accvgpr_write_b32 a127, 0
v_accvgpr_write_b32 a128, 0
v_accvgpr_write_b32 a129, 0
v_accvgpr_write_b32 a130, 0
v_accvgpr_write_b32 a131, 0
v_accvgpr_write_b32 a132, 0
v_accvgpr_write_b32 a133, 0
v_accvgpr_write_b32 a134, 0
v_accvgpr_write_b32 a135, 0
v_accvgpr_write_b32 a136, 0
v_accvgpr_write_b32 a137, 0
v_accvgpr_write_b32 a138, 0
v_accvgpr_write_b32 a139, 0
v_accvgpr_write_b32 a140, 0
v_accvgpr_write_b32 a141, 0
v_accvgpr_write_b32 a142, 0
v_accvgpr_write_b32 a143, 0
v_accvgpr_write_b32 a144, 0
v_accvgpr_write_b32 a145, 0
v_accvgpr_write_b32 a146, 0
v_accvgpr_write_b32 a147, 0
v_accvgpr_write_b32 a148, 0
v_accvgpr_write_b32 a149, 0
v_accvgpr_write_b32 a150, 0
v_accvgpr_write_b32 a151, 0
v_accvgpr_write_b32 a152, 0
v_accvgpr_write_b32 a153, 0
v_accvgpr_write_b32 a154, 0
v_accvgpr_write_b32 a155, 0
v_accvgpr_write_b32 a156, 0
v_accvgpr_write_b32 a157, 0
v_accvgpr_write_b32 a158, 0
v_accvgpr_write_b32 a159, 0
v_accvgpr_write_b32 a160, 0
v_accvgpr_write_b32 a161, 0
v_accvgpr_write_b32 a162, 0
v_accvgpr_write_b32 a163, 0
v_accvgpr_write_b32 a164, 0
v_accvgpr_write_b32 a165, 0
v_accvgpr_write_b32 a166, 0
v_accvgpr_write_b32 a167, 0
v_accvgpr_write_b32 a168, 0
v_accvgpr_write_b32 a169, 0
v_accvgpr_write_b32 a170, 0
v_accvgpr_write_b32 a171, 0
v_accvgpr_write_b32 a172, 0
v_accvgpr_write_b32 a173, 0
v_accvgpr_write_b32 a174, 0
v_accvgpr_write_b32 a175, 0
v_accvgpr_write_b32 a176, 0
v_accvgpr_write_b32 a177, 0
v_accvgpr_write_b32 a178, 0
v_accvgpr_write_b32 a179, 0
v_accvgpr_write_b32 a180, 0
v_accvgpr_write_b32 a181, 0
v_accvgpr_write_b32 a182, 0
v_accvgpr_write_b32 a183, 0
v_accvgpr_write_b32 a184, 0
v_accvgpr_write_b32 a185, 0
v_accvgpr_write_b32 a186, 0
v_accvgpr_write_b32 a187, 0
v_accvgpr_write_b32 a188, 0
v_accvgpr_write_b32 a189, 0
v_accvgpr_write_b32 a190, 0
v_accvgpr_write_b32 a191, 0
v_mov_b32 v10, 0
v_mov_b32 v160, 0xff7fffff
v_mov_b32 v11, 0
v_mov_b32 v161, 0xff7fffff
v_mov_b32 v12, 0
v_mov_b32 v162, 0xff7fffff
v_mov_b32 v13, 0
v_mov_b32 v163, 0xff7fffff
s_mov_b32 s60, s68
s_mov_b32 s63, 32
L_sloop:
s_barrier
s_add_u32 s62, s60, 0
s_add_u32 m0, s68, 0
s_nop 0
buffer_load_dwordx4 v7, s[4:7], s62 offen lds
buffer_load_dwordx4 v8, s[4:7], s62 offen offset:1024 lds
buffer_load_dwordx4 v9, s[4:7], s62 offen offset:2048 lds
s_add_u32 s62, s60, 3072
s_add_u32 m0, s68, 3072
s_nop 0
buffer_load_dwordx4 v7, s[4:7], s62 offen lds
buffer_load_dwordx4 v8, s[4:7], s62 offen offset:1024 lds
buffer_load_dwordx4 v9, s[4:7], s62 offen offset:2048 lds
s_add_u32 s62, s60, 0
s_add_u32 m0, s68, 73728
s_nop 0
buffer_load_dwordx4 v7, s[8:11], s62 offen lds
buffer_load_dwordx4 v8, s[8:11], s62 offen offset:1024 lds
buffer_load_dwordx4 v9, s[8:11], s62 offen offset:2048 lds
s_add_u32 s62, s60, 3072
s_add_u32 m0, s68, 76800
s_nop 0
buffer_load_dwordx4 v7, s[8:11], s62 offen lds
buffer_load_dwordx4 v8, s[8:11], s62 offen offset:1024 lds
buffer_load_dwordx4 v9, s[8:11], s62 offen offset:2048 lds
s_add_u32 s60, s60, 24576
s_waitcnt vmcnt(0)
s_barrier
ds_read_b128 v[192:195], v1
ds_read_b128 v[196:199], v2
ds_read_b128 v[200:203], v1 offset:128
ds_read_b128 v[204:207], v2 offset:128
ds_read_b128 v[208:211], v1 offset:256
ds_read_b128 v[212:215], v2 offset:256
s_waitcnt lgkmcnt(0)
v_mfma_f32_16x16x32_bf16 v[64:67], v[192:195], a[192:195], 0
v_mfma_f32_16x16x32_bf16 v[64:67], v[196:199], a[196:199], v[64:67]
s_waitcnt lgkmcnt(0)
ds_read_b128 v[216:219], v1 offset:6144
v_mfma_f32_16x16x32_bf16 v[64:67], v[200:203], a[200:203], v[64:67]
v_mfma_f32_16x16x32_bf16 v[64:67], v[204:207], a[204:207], v[64:67]
s_waitcnt lgkmcnt(1)
v_mfma_f32_16x16x32_bf16 v[64:67], v[208:211], a[208:211], v[64:67]
ds_read_b128 v[220:223], v2 offset:6144
v_mfma_f32_16x16x32_bf16 v[64:67], v[212:215], a[212:215], v[64:67]
v_mfma_f32_16x16x32_bf16 v[68:71], v[212:215], a[236:239], 0
v_mfma_f32_16x16x32_bf16 v[68:71], v[208:211], a[232:235], v[68:71]
ds_read_b128 v[224:227], v1 offset:6272
v_mfma_f32_16x16x32_bf16 v[68:71], v[204:207], a[228:231], v[68:71]
v_mfma_f32_16x16x32_bf16 v[68:71], v[200:203], a[224:227], v[68:71]
v_mfma_f32_16x16x32_bf16 v[68:71], v[196:199], a[220:223], v[68:71]
ds_read_b128 v[228:231], v2 offset:6272
v_mfma_f32_16x16x32_bf16 v[68:71], v[192:195], a[216:219], v[68:71]
v_mfma_f32_16x16x32_bf16 v[72:75], v[192:195], a[240:243], 0
v_mfma_f32_16x16x32_bf16 v[72:75], v[196:199], a[244:247], v[72:75]
ds_read_b128 v[232:235], v1 offset:6400
v_mfma_f32_16x16x32_bf16 v[72:75], v[200:203], a[248:251], v[72:75]
v_mfma_f32_16x16x32_bf16 v[72:75], v[204:207], a[252:255], v[72:75]
v_mfma_f32_16x16x32_bf16 v[72:75], v[208:211], v[32:35], v[72:75]
ds_read_b128 v[236:239], v2 offset:6400
v_mfma_f32_16x16x32_bf16 v[72:75], v[212:215], v[36:39], v[72:75]
v_mfma_f32_16x16x32_bf16 v[76:79], v[212:215], v[60:63], 0
v_mfma_f32_16x16x32_bf16 v[76:79], v[208:211], v[56:59], v[76:79]
v_mfma_f32_16x16x32_bf16 v[76:79], v[204:207], v[52:55], v[76:79]
v_mfma_f32_16x16x32_bf16 v[76:79], v[200:203], v[48:51], v[76:79]
v_mfma_f32_16x16x32_bf16 v[76:79], v[196:199], v[44:47], v[76:79]
v_mfma_f32_16x16x32_bf16 v[76:79], v[192:195], v[40:43], v[76:79]
s_waitcnt lgkmcnt(0)
v_mfma_f32_16x16x32_bf16 v[80:83], v[216:219], a[192:195], 0
v_mfma_f32_16x16x32_bf16 v[80:83], v[220:223], a[196:199], v[80:83]
ds_read_b128 v[192:195], v1 offset:12288
v_mfma_f32_16x16x32_bf16 v[80:83], v[224:227], a[200:203], v[80:83]
v_mfma_f32_16x16x32_bf16 v[80:83], v[228:231], a[204:207], v[80:83]
v_mfma_f32_16x16x32_bf16 v[80:83], v[232:235], a[208:211], v[80:83]
ds_read_b128 v[196:199], v2 offset:12288
v_mfma_f32_16x16x32_bf16 v[80:83], v[236:239], a[212:215], v[80:83]
v_mfma_f32_16x16x32_bf16 v[84:87], v[236:239], a[236:239], 0
v_mfma_f32_16x16x32_bf16 v[84:87], v[232:235], a[232:235], v[84:87]
ds_read_b128 v[200:203], v1 offset:12416
v_mfma_f32_16x16x32_bf16 v[84:87], v[228:231], a[228:231], v[84:87]
v_mfma_f32_16x16x32_bf16 v[84:87], v[224:227], a[224:227], v[84:87]
v_mfma_f32_16x16x32_bf16 v[84:87], v[220:223], a[220:223], v[84:87]
ds_read_b128 v[204:207], v2 offset:12416
v_mfma_f32_16x16x32_bf16 v[84:87], v[216:219], a[216:219], v[84:87]
v_mfma_f32_16x16x32_bf16 v[88:91], v[216:219], a[240:243], 0
v_mfma_f32_16x16x32_bf16 v[88:91], v[220:223], a[244:247], v[88:91]
ds_read_b128 v[208:211], v1 offset:12544
v_mfma_f32_16x16x32_bf16 v[88:91], v[224:227], a[248:251], v[88:91]
v_mfma_f32_16x16x32_bf16 v[88:91], v[228:231], a[252:255], v[88:91]
v_mfma_f32_16x16x32_bf16 v[88:91], v[232:235], v[32:35], v[88:91]
ds_read_b128 v[212:215], v2 offset:12544
v_mfma_f32_16x16x32_bf16 v[88:91], v[236:239], v[36:39], v[88:91]
v_mfma_f32_16x16x32_bf16 v[92:95], v[236:239], v[60:63], 0
v_mfma_f32_16x16x32_bf16 v[92:95], v[232:235], v[56:59], v[92:95]
v_mfma_f32_16x16x32_bf16 v[92:95], v[228:231], v[52:55], v[92:95]
v_mfma_f32_16x16x32_bf16 v[92:95], v[224:227], v[48:51], v[92:95]
v_mfma_f32_16x16x32_bf16 v[92:95], v[220:223], v[44:47], v[92:95]
v_mfma_f32_16x16x32_bf16 v[92:95], v[216:219], v[40:43], v[92:95]
s_waitcnt lgkmcnt(0)
v_mfma_f32_16x16x32_bf16 v[96:99], v[192:195], a[192:195], 0
v_mfma_f32_16x16x32_bf16 v[96:99], v[196:199], a[196:199], v[96:99]
ds_read_b128 v[216:219], v1 offset:18432
v_mfma_f32_16x16x32_bf16 v[96:99], v[200:203], a[200:203], v[96:99]
v_mfma_f32_16x16x32_bf16 v[96:99], v[204:207], a[204:207], v[96:99]
v_mfma_f32_16x16x32_bf16 v[96:99], v[208:211], a[208:211], v[96:99]
ds_read_b128 v[220:223], v2 offset:18432
v_mfma_f32_16x16x32_bf16 v[96:99], v[212:215], a[212:215], v[96:99]
v_mfma_f32_16x16x32_bf16 v[100:103], v[212:215], a[236:239], 0
v_mfma_f32_16x16x32_bf16 v[100:103], v[208:211], a[232:235], v[100:103]
ds_read_b128 v[224:227], v1 offset:18560
v_mfma_f32_16x16x32_bf16 v[100:103], v[204:207], a[228:231], v[100:103]
v_mfma_f32_16x16x32_bf16 v[100:103], v[200:203], a[224:227], v[100:103]
v_mfma_f32_16x16x32_bf16 v[100:103], v[196:199], a[220:223], v[100:103]
ds_read_b128 v[228:231], v2 offset:18560
v_mfma_f32_16x16x32_bf16 v[100:103], v[192:195], a[216:219], v[100:103]
v_mfma_f32_16x16x32_bf16 v[104:107], v[192:195], a[240:243], 0
v_mfma_f32_16x16x32_bf16 v[104:107], v[196:199], a[244:247], v[104:107]
ds_read_b128 v[232:235], v1 offset:18688
v_mfma_f32_16x16x32_bf16 v[104:107], v[200:203], a[248:251], v[104:107]
v_mfma_f32_16x16x32_bf16 v[104:107], v[204:207], a[252:255], v[104:107]
v_mfma_f32_16x16x32_bf16 v[104:107], v[208:211], v[32:35], v[104:107]
ds_read_b128 v[236:239], v2 offset:18688
v_mfma_f32_16x16x32_bf16 v[104:107], v[212:215], v[36:39], v[104:107]
v_mfma_f32_16x16x32_bf16 v[108:111], v[212:215], v[60:63], 0
v_mfma_f32_16x16x32_bf16 v[108:111], v[208:211], v[56:59], v[108:111]
v_mfma_f32_16x16x32_bf16 v[108:111], v[204:207], v[52:55], v[108:111]
v_mfma_f32_16x16x32_bf16 v[108:111], v[200:203], v[48:51], v[108:111]
v_mfma_f32_16x16x32_bf16 v[108:111], v[196:199], v[44:47], v[108:111]
v_mfma_f32_16x16x32_bf16 v[108:111], v[192:195], v[40:43], v[108:111]
s_waitcnt lgkmcnt(0)
v_mfma_f32_16x16x32_bf16 v[112:115], v[216:219], a[192:195], 0
v_mfma_f32_16x16x32_bf16 v[112:115], v[220:223], a[196:199], v[112:115]
ds_read_b64_tr_b16 v[192:193], v3
v_mfma_f32_16x16x32_bf16 v[112:115], v[224:227], a[200:203], v[112:115]
ds_read_b64_tr_b16 v[194:195], v3 offset:6144
v_mfma_f32_16x16x32_bf16 v[112:115], v[228:231], a[204:207], v[112:115]
v_mfma_f32_16x16x32_bf16 v[112:115], v[232:235], a[208:211], v[112:115]
ds_read_b64_tr_b16 v[196:197], v3 offset:12288
v_mfma_f32_16x16x32_bf16 v[112:115], v[236:239], a[212:215], v[112:115]
ds_read_b64_tr_b16 v[198:199], v3 offset:18432
v_mfma_f32_16x16x32_bf16 v[116:119], v[236:239], a[236:239], 0
v_mfma_f32_16x16x32_bf16 v[116:119], v[232:235], a[232:235], v[116:119]
ds_read_b64_tr_b16 v[200:201], v4
v_mfma_f32_16x16x32_bf16 v[116:119], v[228:231], a[228:231], v[116:119]
ds_read_b64_tr_b16 v[202:203], v4 offset:6144
v_mfma_f32_16x16x32_bf16 v[116:119], v[224:227], a[224:227], v[116:119]
v_mfma_f32_16x16x32_bf16 v[116:119], v[220:223], a[220:223], v[116:119]
ds_read_b64_tr_b16 v[204:205], v4 offset:12288
v_mfma_f32_16x16x32_bf16 v[116:119], v[216:219], a[216:219], v[116:119]
ds_read_b64_tr_b16 v[206:207], v4 offset:18432
v_mfma_f32_16x16x32_bf16 v[120:123], v[216:219], a[240:243], 0
v_mfma_f32_16x16x32_bf16 v[120:123], v[220:223], a[244:247], v[120:123]
ds_read_b64_tr_b16 v[208:209], v5
v_mfma_f32_16x16x32_bf16 v[120:123], v[224:227], a[248:251], v[120:123]
ds_read_b64_tr_b16 v[210:211], v5 offset:6144
v_mfma_f32_16x16x32_bf16 v[120:123], v[228:231], a[252:255], v[120:123]
v_mfma_f32_16x16x32_bf16 v[120:123], v[232:235], v[32:35], v[120:123]
ds_read_b64_tr_b16 v[212:213], v5 offset:12288
v_mfma_f32_16x16x32_bf16 v[120:123], v[236:239], v[36:39], v[120:123]
ds_read_b64_tr_b16 v[214:215], v5 offset:18432
v_mfma_f32_16x16x32_bf16 v[124:127], v[236:239], v[60:63], 0
v_mfma_f32_16x16x32_bf16 v[124:127], v[232:235], v[56:59], v[124:127]
v_mfma_f32_16x16x32_bf16 v[124:127], v[228:231], v[52:55], v[124:127]
v_mfma_f32_16x16x32_bf16 v[124:127], v[224:227], v[48:51], v[124:127]
v_mfma_f32_16x16x32_bf16 v[124:127], v[220:223], v[44:47], v[124:127]
v_mfma_f32_16x16x32_bf16 v[124:127], v[216:219], v[40:43], v[124:127]
s_nop 7
v_max3_f32 v16, v64, v65, v160
v_max3_f32 v16, v16, v66, v67
v_max3_f32 v16, v16, v80, v81
v_max3_f32 v16, v16, v82, v83
v_max3_f32 v16, v16, v96, v97
v_max3_f32 v16, v16, v98, v99
v_max3_f32 v16, v16, v112, v113
v_max3_f32 v16, v16, v114, v115
v_max3_f32 v20, v68, v69, v161
v_max3_f32 v20, v20, v70, v71
v_max3_f32 v20, v20, v84, v85
v_max3_f32 v20, v20, v86, v87
v_max3_f32 v20, v20, v100, v101
v_max3_f32 v20, v20, v102, v103
v_max3_f32 v20, v20, v116, v117
v_max3_f32 v20, v20, v118, v119
v_max3_f32 v24, v72, v73, v162
v_max3_f32 v24, v24, v74, v75
v_max3_f32 v24, v24, v88, v89
v_max3_f32 v24, v24, v90, v91
v_max3_f32 v24, v24, v104, v105
v_max3_f32 v24, v24, v106, v107
v_max3_f32 v24, v24, v120, v121
v_max3_f32 v24, v24, v122, v123
v_max3_f32 v28, v76, v77, v163
v_max3_f32 v28, v28, v78, v79
v_max3_f32 v28, v28, v92, v93
v_max3_f32 v28, v28, v94, v95
v_max3_f32 v28, v28, v108, v109
v_max3_f32 v28, v28, v110, v111
v_max3_f32 v28, v28, v124, v125
v_max3_f32 v28, v28, v126, v127
v_mov_b32 v17, v16
v_mov_b32 v21, v20
v_mov_b32 v25, v24
v_mov_b32 v29, v28
v_permlane32_swap_b32 v16, v17
v_permlane32_swap_b32 v20, v21
v_permlane32_swap_b32 v24, v25
v_permlane32_swap_b32 v28, v29
v_max_f32 v16, v16, v17
v_max_f32 v20, v20, v21
v_max_f32 v24, v24, v25
v_max_f32 v28, v28, v29
v_mov_b32 v17, v16
v_mov_b32 v21, v20
v_mov_b32 v25, v24
v_mov_b32 v29, v28
v_permlane16_swap_b32 v16, v17
v_permlane16_swap_b32 v20, v21
v_permlane16_swap_b32 v24, v25
v_permlane16_swap_b32 v28, v29
v_max_f32 v16, v16, v17
v_max_f32 v20, v20, v21
v_max_f32 v24, v24, v25
v_max_f32 v28, v28, v29
v_sub_f32 v17, v160, v16
v_sub_f32 v21, v161, v20
v_sub_f32 v25, v162, v24
v_sub_f32 v29, v163, v28
v_exp_f32 v17, v17
v_exp_f32 v21, v21
v_exp_f32 v25, v25
v_exp_f32 v29, v29
v_mov_b32 v160, v16
v_mov_b32 v161, v20
v_mov_b32 v162, v24
v_mov_b32 v163, v28
v_mul_f32 v10, v10, v17
v_mul_f32 v11, v11, v21
v_mul_f32 v12, v12, v25
v_mul_f32 v13, v13, v29
v_accvgpr_read_b32 v168, a0
v_accvgpr_read_b32 v169, a1
v_accvgpr_read_b32 v170, a2
v_accvgpr_read_b32 v171, a3
v_mul_f32 v168, v168, v17
v_mul_f32 v169, v169, v17
v_mul_f32 v170, v170, v17
v_mul_f32 v171, v171, v17
v_accvgpr_write_b32 a0, v168
v_accvgpr_write_b32 a1, v169
v_accvgpr_write_b32 a2, v170
v_accvgpr_write_b32 a3, v171
v_accvgpr_read_b32 v172, a4
v_accvgpr_read_b32 v173, a5
v_accvgpr_read_b32 v174, a6
v_accvgpr_read_b32 v175, a7
v_mul_f32 v172, v172, v21
v_mul_f32 v173, v173, v21
v_mul_f32 v174, v174, v21
v_mul_f32 v175, v175, v21
v_accvgpr_write_b32 a4, v172
v_accvgpr_write_b32 a5, v173
v_accvgpr_write_b32 a6, v174
v_accvgpr_write_b32 a7, v175
v_accvgpr_read_b32 v176, a8
v_accvgpr_read_b32 v177, a9
v_accvgpr_read_b32 v178, a10
v_accvgpr_read_b32 v179, a11
v_mul_f32 v176, v176, v25
v_mul_f32 v177, v177, v25
v_mul_f32 v178, v178, v25
v_mul_f32 v179, v179, v25
v_accvgpr_write_b32 a8, v176
v_accvgpr_write_b32 a9, v177
v_accvgpr_write_b32 a10, v178
v_accvgpr_write_b32 a11, v179
v_accvgpr_read_b32 v180, a12
v_accvgpr_read_b32 v181, a13
v_accvgpr_read_b32 v182, a14
v_accvgpr_read_b32 v183, a15
v_mul_f32 v180, v180, v29
v_mul_f32 v181, v181, v29
v_mul_f32 v182, v182, v29
v_mul_f32 v183, v183, v29
v_accvgpr_write_b32 a12, v180
v_accvgpr_write_b32 a13, v181
v_accvgpr_write_b32 a14, v182
v_accvgpr_write_b32 a15, v183
v_accvgpr_read_b32 v168, a16
v_accvgpr_read_b32 v169, a17
v_accvgpr_read_b32 v170, a18
v_accvgpr_read_b32 v171, a19
v_mul_f32 v168, v168, v17
v_mul_f32 v169, v169, v17
v_mul_f32 v170, v170, v17
v_mul_f32 v171, v171, v17
v_accvgpr_write_b32 a16, v168
v_accvgpr_write_b32 a17, v169
v_accvgpr_write_b32 a18, v170
v_accvgpr_write_b32 a19, v171
v_accvgpr_read_b32 v172, a20
v_accvgpr_read_b32 v173, a21
v_accvgpr_read_b32 v174, a22
v_accvgpr_read_b32 v175, a23
v_mul_f32 v172, v172, v21
v_mul_f32 v173, v173, v21
v_mul_f32 v174, v174, v21
v_mul_f32 v175, v175, v21
v_accvgpr_write_b32 a20, v172
v_accvgpr_write_b32 a21, v173
v_accvgpr_write_b32 a22, v174
v_accvgpr_write_b32 a23, v175
v_accvgpr_read_b32 v176, a24
v_accvgpr_read_b32 v177, a25
v_accvgpr_read_b32 v178, a26
v_accvgpr_read_b32 v179, a27
v_mul_f32 v176, v176, v25
v_mul_f32 v177, v177, v25
v_mul_f32 v178, v178, v25
v_mul_f32 v179, v179, v25
v_accvgpr_write_b32 a24, v176
v_accvgpr_write_b32 a25, v177
v_accvgpr_write_b32 a26, v178
v_accvgpr_write_b32 a27, v179
v_accvgpr_read_b32 v180, a28
v_accvgpr_read_b32 v181, a29
v_accvgpr_read_b32 v182, a30
v_accvgpr_read_b32 v183, a31
v_mul_f32 v180, v180, v29
v_mul_f32 v181, v181, v29
v_mul_f32 v182, v182, v29
v_mul_f32 v183, v183, v29
v_accvgpr_write_b32 a28, v180
v_accvgpr_write_b32 a29, v181
v_accvgpr_write_b32 a30, v182
v_accvgpr_write_b32 a31, v183
v_accvgpr_read_b32 v168, a32
v_accvgpr_read_b32 v169, a33
v_accvgpr_read_b32 v170, a34
v_accvgpr_read_b32 v171, a35
v_mul_f32 v168, v168, v17
v_mul_f32 v169, v169, v17
v_mul_f32 v170, v170, v17
v_mul_f32 v171, v171, v17
v_accvgpr_write_b32 a32, v168
v_accvgpr_write_b32 a33, v169
v_accvgpr_write_b32 a34, v170
v_accvgpr_write_b32 a35, v171
v_accvgpr_read_b32 v172, a36
v_accvgpr_read_b32 v173, a37
v_accvgpr_read_b32 v174, a38
v_accvgpr_read_b32 v175, a39
v_mul_f32 v172, v172, v21
v_mul_f32 v173, v173, v21
v_mul_f32 v174, v174, v21
v_mul_f32 v175, v175, v21
v_accvgpr_write_b32 a36, v172
v_accvgpr_write_b32 a37, v173
v_accvgpr_write_b32 a38, v174
v_accvgpr_write_b32 a39, v175
v_accvgpr_read_b32 v176, a40
v_accvgpr_read_b32 v177, a41
v_accvgpr_read_b32 v178, a42
v_accvgpr_read_b32 v179, a43
v_mul_f32 v176, v176, v25
v_mul_f32 v177, v177, v25
v_mul_f32 v178, v178, v25
v_mul_f32 v179, v179, v25
v_accvgpr_write_b32 a40, v176
v_accvgpr_write_b32 a41, v177
v_accvgpr_write_b32 a42, v178
v_accvgpr_write_b32 a43, v179
v_accvgpr_read_b32 v180, a44
v_accvgpr_read_b32 v181, a45
v_accvgpr_read_b32 v182, a46
v_accvgpr_read_b32 v183, a47
v_mul_f32 v180, v180, v29
v_mul_f32 v181, v181, v29
v_mul_f32 v182, v182, v29
v_mul_f32 v183, v183, v29
v_accvgpr_write_b32 a44, v180
v_accvgpr_write_b32 a45, v181
v_accvgpr_write_b32 a46, v182
v_accvgpr_write_b32 a47, v183
v_accvgpr_read_b32 v168, a48
v_accvgpr_read_b32 v169, a49
v_accvgpr_read_b32 v170, a50
v_accvgpr_read_b32 v171, a51
v_mul_f32 v168, v168, v17
v_mul_f32 v169, v169, v17
v_mul_f32 v170, v170, v17
v_mul_f32 v171, v171, v17
v_accvgpr_write_b32 a48, v168
v_accvgpr_write_b32 a49, v169
v_accvgpr_write_b32 a50, v170
v_accvgpr_write_b32 a51, v171
v_accvgpr_read_b32 v172, a52
v_accvgpr_read_b32 v173, a53
v_accvgpr_read_b32 v174, a54
v_accvgpr_read_b32 v175, a55
v_mul_f32 v172, v172, v21
v_mul_f32 v173, v173, v21
v_mul_f32 v174, v174, v21
v_mul_f32 v175, v175, v21
v_accvgpr_write_b32 a52, v172
v_accvgpr_write_b32 a53, v173
v_accvgpr_write_b32 a54, v174
v_accvgpr_write_b32 a55, v175
v_accvgpr_read_b32 v176, a56
v_accvgpr_read_b32 v177, a57
v_accvgpr_read_b32 v178, a58
v_accvgpr_read_b32 v179, a59
v_mul_f32 v176, v176, v25
v_mul_f32 v177, v177, v25
v_mul_f32 v178, v178, v25
v_mul_f32 v179, v179, v25
v_accvgpr_write_b32 a56, v176
v_accvgpr_write_b32 a57, v177
v_accvgpr_write_b32 a58, v178
v_accvgpr_write_b32 a59, v179
v_accvgpr_read_b32 v180, a60
v_accvgpr_read_b32 v181, a61
v_accvgpr_read_b32 v182, a62
v_accvgpr_read_b32 v183, a63
v_mul_f32 v180, v180, v29
v_mul_f32 v181, v181, v29
v_mul_f32 v182, v182, v29
v_mul_f32 v183, v183, v29
v_accvgpr_write_b32 a60, v180
v_accvgpr_write_b32 a61, v181
v_accvgpr_write_b32 a62, v182
v_accvgpr_write_b32 a63, v183
v_accvgpr_read_b32 v168, a64
v_accvgpr_read_b32 v169, a65
v_accvgpr_read_b32 v170, a66
v_accvgpr_read_b32 v171, a67
v_mul_f32 v168, v168, v17
v_mul_f32 v169, v169, v17
v_mul_f32 v170, v170, v17
v_mul_f32 v171, v171, v17
v_accvgpr_write_b32 a64, v168
v_accvgpr_write_b32 a65, v169
v_accvgpr_write_b32 a66, v170
v_accvgpr_write_b32 a67, v171
v_accvgpr_read_b32 v172, a68
v_accvgpr_read_b32 v173, a69
v_accvgpr_read_b32 v174, a70
v_accvgpr_read_b32 v175, a71
v_mul_f32 v172, v172, v21
v_mul_f32 v173, v173, v21
v_mul_f32 v174, v174, v21
v_mul_f32 v175, v175, v21
v_accvgpr_write_b32 a68, v172
v_accvgpr_write_b32 a69, v173
v_accvgpr_write_b32 a70, v174
v_accvgpr_write_b32 a71, v175
v_accvgpr_read_b32 v176, a72
v_accvgpr_read_b32 v177, a73
v_accvgpr_read_b32 v178, a74
v_accvgpr_read_b32 v179, a75
v_mul_f32 v176, v176, v25
v_mul_f32 v177, v177, v25
v_mul_f32 v178, v178, v25
v_mul_f32 v179, v179, v25
v_accvgpr_write_b32 a72, v176
v_accvgpr_write_b32 a73, v177
v_accvgpr_write_b32 a74, v178
v_accvgpr_write_b32 a75, v179
v_accvgpr_read_b32 v180, a76
v_accvgpr_read_b32 v181, a77
v_accvgpr_read_b32 v182, a78
v_accvgpr_read_b32 v183, a79
v_mul_f32 v180, v180, v29
v_mul_f32 v181, v181, v29
v_mul_f32 v182, v182, v29
v_mul_f32 v183, v183, v29
v_accvgpr_write_b32 a76, v180
v_accvgpr_write_b32 a77, v181
v_accvgpr_write_b32 a78, v182
v_accvgpr_write_b32 a79, v183
v_accvgpr_read_b32 v168, a80
v_accvgpr_read_b32 v169, a81
v_accvgpr_read_b32 v170, a82
v_accvgpr_read_b32 v171, a83
v_mul_f32 v168, v168, v17
v_mul_f32 v169, v169, v17
v_mul_f32 v170, v170, v17
v_mul_f32 v171, v171, v17
v_accvgpr_write_b32 a80, v168
v_accvgpr_write_b32 a81, v169
v_accvgpr_write_b32 a82, v170
v_accvgpr_write_b32 a83, v171
v_accvgpr_read_b32 v172, a84
v_accvgpr_read_b32 v173, a85
v_accvgpr_read_b32 v174, a86
v_accvgpr_read_b32 v175, a87
v_mul_f32 v172, v172, v21
v_mul_f32 v173, v173, v21
v_mul_f32 v174, v174, v21
v_mul_f32 v175, v175, v21
v_accvgpr_write_b32 a84, v172
v_accvgpr_write_b32 a85, v173
v_accvgpr_write_b32 a86, v174
v_accvgpr_write_b32 a87, v175
v_accvgpr_read_b32 v176, a88
v_accvgpr_read_b32 v177, a89
v_accvgpr_read_b32 v178, a90
v_accvgpr_read_b32 v179, a91
v_mul_f32 v176, v176, v25
v_mul_f32 v177, v177, v25
v_mul_f32 v178, v178, v25
v_mul_f32 v179, v179, v25
v_accvgpr_write_b32 a88, v176
v_accvgpr_write_b32 a89, v177
v_accvgpr_write_b32 a90, v178
v_accvgpr_write_b32 a91, v179
v_accvgpr_read_b32 v180, a92
v_accvgpr_read_b32 v181, a93
v_accvgpr_read_b32 v182, a94
v_accvgpr_read_b32 v183, a95
v_mul_f32 v180, v180, v29
v_mul_f32 v181, v181, v29
v_mul_f32 v182, v182, v29
v_mul_f32 v183, v183, v29
v_accvgpr_write_b32 a92, v180
v_accvgpr_write_b32 a93, v181
v_accvgpr_write_b32 a94, v182
v_accvgpr_write_b32 a95, v183
v_accvgpr_read_b32 v168, a96
v_accvgpr_read_b32 v169, a97
v_accvgpr_read_b32 v170, a98
v_accvgpr_read_b32 v171, a99
v_mul_f32 v168, v168, v17
v_mul_f32 v169, v169, v17
v_mul_f32 v170, v170, v17
v_mul_f32 v171, v171, v17
v_accvgpr_write_b32 a96, v168
v_accvgpr_write_b32 a97, v169
v_accvgpr_write_b32 a98, v170
v_accvgpr_write_b32 a99, v171
v_accvgpr_read_b32 v172, a100
v_accvgpr_read_b32 v173, a101
v_accvgpr_read_b32 v174, a102
v_accvgpr_read_b32 v175, a103
v_mul_f32 v172, v172, v21
v_mul_f32 v173, v173, v21
v_mul_f32 v174, v174, v21
v_mul_f32 v175, v175, v21
v_accvgpr_write_b32 a100, v172
v_accvgpr_write_b32 a101, v173
v_accvgpr_write_b32 a102, v174
v_accvgpr_write_b32 a103, v175
v_accvgpr_read_b32 v176, a104
v_accvgpr_read_b32 v177, a105
v_accvgpr_read_b32 v178, a106
v_accvgpr_read_b32 v179, a107
v_mul_f32 v176, v176, v25
v_mul_f32 v177, v177, v25
v_mul_f32 v178, v178, v25
v_mul_f32 v179, v179, v25
v_accvgpr_write_b32 a104, v176
v_accvgpr_write_b32 a105, v177
v_accvgpr_write_b32 a106, v178
v_accvgpr_write_b32 a107, v179
v_accvgpr_read_b32 v180, a108
v_accvgpr_read_b32 v181, a109
v_accvgpr_read_b32 v182, a110
v_accvgpr_read_b32 v183, a111
v_mul_f32 v180, v180, v29
v_mul_f32 v181, v181, v29
v_mul_f32 v182, v182, v29
v_mul_f32 v183, v183, v29
v_accvgpr_write_b32 a108, v180
v_accvgpr_write_b32 a109, v181
v_accvgpr_write_b32 a110, v182
v_accvgpr_write_b32 a111, v183
v_accvgpr_read_b32 v168, a112
v_accvgpr_read_b32 v169, a113
v_accvgpr_read_b32 v170, a114
v_accvgpr_read_b32 v171, a115
v_mul_f32 v168, v168, v17
v_mul_f32 v169, v169, v17
v_mul_f32 v170, v170, v17
v_mul_f32 v171, v171, v17
v_accvgpr_write_b32 a112, v168
v_accvgpr_write_b32 a113, v169
v_accvgpr_write_b32 a114, v170
v_accvgpr_write_b32 a115, v171
v_accvgpr_read_b32 v172, a116
v_accvgpr_read_b32 v173, a117
v_accvgpr_read_b32 v174, a118
v_accvgpr_read_b32 v175, a119
v_mul_f32 v172, v172, v21
v_mul_f32 v173, v173, v21
v_mul_f32 v174, v174, v21
v_mul_f32 v175, v175, v21
v_accvgpr_write_b32 a116, v172
v_accvgpr_write_b32 a117, v173
v_accvgpr_write_b32 a118, v174
v_accvgpr_write_b32 a119, v175
v_accvgpr_read_b32 v176, a120
v_accvgpr_read_b32 v177, a121
v_accvgpr_read_b32 v178, a122
v_accvgpr_read_b32 v179, a123
v_mul_f32 v176, v176, v25
v_mul_f32 v177, v177, v25
v_mul_f32 v178, v178, v25
v_mul_f32 v179, v179, v25
v_accvgpr_write_b32 a120, v176
v_accvgpr_write_b32 a121, v177
v_accvgpr_write_b32 a122, v178
v_accvgpr_write_b32 a123, v179
v_accvgpr_read_b32 v180, a124
v_accvgpr_read_b32 v181, a125
v_accvgpr_read_b32 v182, a126
v_accvgpr_read_b32 v183, a127
v_mul_f32 v180, v180, v29
v_mul_f32 v181, v181, v29
v_mul_f32 v182, v182, v29
v_mul_f32 v183, v183, v29
v_accvgpr_write_b32 a124, v180
v_accvgpr_write_b32 a125, v181
v_accvgpr_write_b32 a126, v182
v_accvgpr_write_b32 a127, v183
v_accvgpr_read_b32 v168, a128
v_accvgpr_read_b32 v169, a129
v_accvgpr_read_b32 v170, a130
v_accvgpr_read_b32 v171, a131
v_mul_f32 v168, v168, v17
v_mul_f32 v169, v169, v17
v_mul_f32 v170, v170, v17
v_mul_f32 v171, v171, v17
v_accvgpr_write_b32 a128, v168
v_accvgpr_write_b32 a129, v169
v_accvgpr_write_b32 a130, v170
v_accvgpr_write_b32 a131, v171
v_accvgpr_read_b32 v172, a132
v_accvgpr_read_b32 v173, a133
v_accvgpr_read_b32 v174, a134
v_accvgpr_read_b32 v175, a135
v_mul_f32 v172, v172, v21
v_mul_f32 v173, v173, v21
v_mul_f32 v174, v174, v21
v_mul_f32 v175, v175, v21
v_accvgpr_write_b32 a132, v172
v_accvgpr_write_b32 a133, v173
v_accvgpr_write_b32 a134, v174
v_accvgpr_write_b32 a135, v175
v_accvgpr_read_b32 v176, a136
v_accvgpr_read_b32 v177, a137
v_accvgpr_read_b32 v178, a138
v_accvgpr_read_b32 v179, a139
v_mul_f32 v176, v176, v25
v_mul_f32 v177, v177, v25
v_mul_f32 v178, v178, v25
v_mul_f32 v179, v179, v25
v_accvgpr_write_b32 a136, v176
v_accvgpr_write_b32 a137, v177
v_accvgpr_write_b32 a138, v178
v_accvgpr_write_b32 a139, v179
v_accvgpr_read_b32 v180, a140
v_accvgpr_read_b32 v181, a141
v_accvgpr_read_b32 v182, a142
v_accvgpr_read_b32 v183, a143
v_mul_f32 v180, v180, v29
v_mul_f32 v181, v181, v29
v_mul_f32 v182, v182, v29
v_mul_f32 v183, v183, v29
v_accvgpr_write_b32 a140, v180
v_accvgpr_write_b32 a141, v181
v_accvgpr_write_b32 a142, v182
v_accvgpr_write_b32 a143, v183
v_accvgpr_read_b32 v168, a144
v_accvgpr_read_b32 v169, a145
v_accvgpr_read_b32 v170, a146
v_accvgpr_read_b32 v171, a147
v_mul_f32 v168, v168, v17
v_mul_f32 v169, v169, v17
v_mul_f32 v170, v170, v17
v_mul_f32 v171, v171, v17
v_accvgpr_write_b32 a144, v168
v_accvgpr_write_b32 a145, v169
v_accvgpr_write_b32 a146, v170
v_accvgpr_write_b32 a147, v171
v_accvgpr_read_b32 v172, a148
v_accvgpr_read_b32 v173, a149
v_accvgpr_read_b32 v174, a150
v_accvgpr_read_b32 v175, a151
v_mul_f32 v172, v172, v21
v_mul_f32 v173, v173, v21
v_mul_f32 v174, v174, v21
v_mul_f32 v175, v175, v21
v_accvgpr_write_b32 a148, v172
v_accvgpr_write_b32 a149, v173
v_accvgpr_write_b32 a150, v174
v_accvgpr_write_b32 a151, v175
v_accvgpr_read_b32 v176, a152
v_accvgpr_read_b32 v177, a153
v_accvgpr_read_b32 v178, a154
v_accvgpr_read_b32 v179, a155
v_mul_f32 v176, v176, v25
v_mul_f32 v177, v177, v25
v_mul_f32 v178, v178, v25
v_mul_f32 v179, v179, v25
v_accvgpr_write_b32 a152, v176
v_accvgpr_write_b32 a153, v177
v_accvgpr_write_b32 a154, v178
v_accvgpr_write_b32 a155, v179
v_accvgpr_read_b32 v180, a156
v_accvgpr_read_b32 v181, a157
v_accvgpr_read_b32 v182, a158
v_accvgpr_read_b32 v183, a159
v_mul_f32 v180, v180, v29
v_mul_f32 v181, v181, v29
v_mul_f32 v182, v182, v29
v_mul_f32 v183, v183, v29
v_accvgpr_write_b32 a156, v180
v_accvgpr_write_b32 a157, v181
v_accvgpr_write_b32 a158, v182
v_accvgpr_write_b32 a159, v183
v_accvgpr_read_b32 v168, a160
v_accvgpr_read_b32 v169, a161
v_accvgpr_read_b32 v170, a162
v_accvgpr_read_b32 v171, a163
v_mul_f32 v168, v168, v17
v_mul_f32 v169, v169, v17
v_mul_f32 v170, v170, v17
v_mul_f32 v171, v171, v17
v_accvgpr_write_b32 a160, v168
v_accvgpr_write_b32 a161, v169
v_accvgpr_write_b32 a162, v170
v_accvgpr_write_b32 a163, v171
v_accvgpr_read_b32 v172, a164
v_accvgpr_read_b32 v173, a165
v_accvgpr_read_b32 v174, a166
v_accvgpr_read_b32 v175, a167
v_mul_f32 v172, v172, v21
v_mul_f32 v173, v173, v21
v_mul_f32 v174, v174, v21
v_mul_f32 v175, v175, v21
v_accvgpr_write_b32 a164, v172
v_accvgpr_write_b32 a165, v173
v_accvgpr_write_b32 a166, v174
v_accvgpr_write_b32 a167, v175
v_accvgpr_read_b32 v176, a168
v_accvgpr_read_b32 v177, a169
v_accvgpr_read_b32 v178, a170
v_accvgpr_read_b32 v179, a171
v_mul_f32 v176, v176, v25
v_mul_f32 v177, v177, v25
v_mul_f32 v178, v178, v25
v_mul_f32 v179, v179, v25
v_accvgpr_write_b32 a168, v176
v_accvgpr_write_b32 a169, v177
v_accvgpr_write_b32 a170, v178
v_accvgpr_write_b32 a171, v179
v_accvgpr_read_b32 v180, a172
v_accvgpr_read_b32 v181, a173
v_accvgpr_read_b32 v182, a174
v_accvgpr_read_b32 v183, a175
v_mul_f32 v180, v180, v29
v_mul_f32 v181, v181, v29
v_mul_f32 v182, v182, v29
v_mul_f32 v183, v183, v29
v_accvgpr_write_b32 a172, v180
v_accvgpr_write_b32 a173, v181
v_accvgpr_write_b32 a174, v182
v_accvgpr_write_b32 a175, v183
v_accvgpr_read_b32 v168, a176
v_accvgpr_read_b32 v169, a177
v_accvgpr_read_b32 v170, a178
v_accvgpr_read_b32 v171, a179
v_mul_f32 v168, v168, v17
v_mul_f32 v169, v169, v17
v_mul_f32 v170, v170, v17
v_mul_f32 v171, v171, v17
v_accvgpr_write_b32 a176, v168
v_accvgpr_write_b32 a177, v169
v_accvgpr_write_b32 a178, v170
v_accvgpr_write_b32 a179, v171
v_accvgpr_read_b32 v172, a180
v_accvgpr_read_b32 v173, a181
v_accvgpr_read_b32 v174, a182
v_accvgpr_read_b32 v175, a183
v_mul_f32 v172, v172, v21
v_mul_f32 v173, v173, v21
v_mul_f32 v174, v174, v21
v_mul_f32 v175, v175, v21
v_accvgpr_write_b32 a180, v172
v_accvgpr_write_b32 a181, v173
v_accvgpr_write_b32 a182, v174
v_accvgpr_write_b32 a183, v175
v_accvgpr_read_b32 v176, a184
v_accvgpr_read_b32 v177, a185
v_accvgpr_read_b32 v178, a186
v_accvgpr_read_b32 v179, a187
v_mul_f32 v176, v176, v25
v_mul_f32 v177, v177, v25
v_mul_f32 v178, v178, v25
v_mul_f32 v179, v179, v25
v_accvgpr_write_b32 a184, v176
v_accvgpr_write_b32 a185, v177
v_accvgpr_write_b32 a186, v178
v_accvgpr_write_b32 a187, v179
v_accvgpr_read_b32 v180, a188
v_accvgpr_read_b32 v181, a189
v_accvgpr_read_b32 v182, a190
v_accvgpr_read_b32 v183, a191
v_mul_f32 v180, v180, v29
v_mul_f32 v181, v181, v29
v_mul_f32 v182, v182, v29
v_mul_f32 v183, v183, v29
v_accvgpr_write_b32 a188, v180
v_accvgpr_write_b32 a189, v181
v_accvgpr_write_b32 a190, v182
v_accvgpr_write_b32 a191, v183
v_sub_f32 v64, v64, v160
v_sub_f32 v65, v65, v160
v_sub_f32 v66, v66, v160
v_sub_f32 v67, v67, v160
v_sub_f32 v68, v68, v161
v_sub_f32 v69, v69, v161
v_sub_f32 v70, v70, v161
v_sub_f32 v71, v71, v161
v_sub_f32 v72, v72, v162
v_sub_f32 v73, v73, v162
v_sub_f32 v74, v74, v162
v_sub_f32 v75, v75, v162
v_sub_f32 v76, v76, v163
v_sub_f32 v77, v77, v163
v_sub_f32 v78, v78, v163
v_sub_f32 v79, v79, v163
v_sub_f32 v80, v80, v160
v_sub_f32 v81, v81, v160
v_sub_f32 v82, v82, v160
v_sub_f32 v83, v83, v160
v_sub_f32 v84, v84, v161
v_sub_f32 v85, v85, v161
v_sub_f32 v86, v86, v161
v_sub_f32 v87, v87, v161
v_sub_f32 v88, v88, v162
v_sub_f32 v89, v89, v162
v_sub_f32 v90, v90, v162
v_sub_f32 v91, v91, v162
v_sub_f32 v92, v92, v163
v_sub_f32 v93, v93, v163
v_sub_f32 v94, v94, v163
v_sub_f32 v95, v95, v163
v_sub_f32 v96, v96, v160
v_sub_f32 v97, v97, v160
v_sub_f32 v98, v98, v160
v_sub_f32 v99, v99, v160
v_sub_f32 v100, v100, v161
v_sub_f32 v101, v101, v161
v_sub_f32 v102, v102, v161
v_sub_f32 v103, v103, v161
v_sub_f32 v104, v104, v162
v_sub_f32 v105, v105, v162
v_sub_f32 v106, v106, v162
v_sub_f32 v107, v107, v162
v_sub_f32 v108, v108, v163
v_sub_f32 v109, v109, v163
v_sub_f32 v110, v110, v163
v_sub_f32 v111, v111, v163
v_sub_f32 v112, v112, v160
v_sub_f32 v113, v113, v160
v_sub_f32 v114, v114, v160
v_sub_f32 v115, v115, v160
v_sub_f32 v116, v116, v161
v_sub_f32 v117, v117, v161
v_sub_f32 v118, v118, v161
v_sub_f32 v119, v119, v161
v_sub_f32 v120, v120, v162
v_sub_f32 v121, v121, v162
v_sub_f32 v122, v122, v162
v_sub_f32 v123, v123, v162
v_sub_f32 v124, v124, v163
v_sub_f32 v125, v125, v163
v_sub_f32 v126, v126, v163
v_sub_f32 v127, v127, v163
v_exp_f32 v64, v64
v_exp_f32 v65, v65
v_exp_f32 v66, v66
v_exp_f32 v67, v67
s_nop 0
v_add_f32 v10, v10, v64
v_add_f32 v10, v10, v65
v_add_f32 v10, v10, v66
v_add_f32 v10, v10, v67
v_cvt_pk_bf16_f32 v128, v64, v65
v_cvt_pk_bf16_f32 v129, v66, v67
v_exp_f32 v68, v68
v_exp_f32 v69, v69
v_exp_f32 v70, v70
v_exp_f32 v71, v71
s_nop 0
v_add_f32 v11, v11, v68
v_add_f32 v11, v11, v69
v_add_f32 v11, v11, v70
v_add_f32 v11, v11, v71
v_cvt_pk_bf16_f32 v136, v68, v69
v_cvt_pk_bf16_f32 v137, v70, v71
v_exp_f32 v72, v72
v_exp_f32 v73, v73
v_exp_f32 v74, v74
v_exp_f32 v75, v75
s_nop 0
v_add_f32 v12, v12, v72
v_add_f32 v12, v12, v73
v_add_f32 v12, v12, v74
v_add_f32 v12, v12, v75
v_cvt_pk_bf16_f32 v144, v72, v73
v_cvt_pk_bf16_f32 v145, v74, v75
v_exp_f32 v76, v76
v_exp_f32 v77, v77
v_exp_f32 v78, v78
v_exp_f32 v79, v79
s_nop 0
v_add_f32 v13, v13, v76
v_add_f32 v13, v13, v77
v_add_f32 v13, v13, v78
v_add_f32 v13, v13, v79
v_cvt_pk_bf16_f32 v152, v76, v77
v_cvt_pk_bf16_f32 v153, v78, v79
v_exp_f32 v80, v80
v_exp_f32 v81, v81
v_exp_f32 v82, v82
v_exp_f32 v83, v83
s_nop 0
v_add_f32 v10, v10, v80
v_add_f32 v10, v10, v81
v_add_f32 v10, v10, v82
v_add_f32 v10, v10, v83
v_cvt_pk_bf16_f32 v130, v80, v81
v_cvt_pk_bf16_f32 v131, v82, v83
v_exp_f32 v84, v84
v_exp_f32 v85, v85
v_exp_f32 v86, v86
v_exp_f32 v87, v87
s_nop 0
v_add_f32 v11, v11, v84
v_add_f32 v11, v11, v85
v_add_f32 v11, v11, v86
v_add_f32 v11, v11, v87
v_cvt_pk_bf16_f32 v138, v84, v85
v_cvt_pk_bf16_f32 v139, v86, v87
v_exp_f32 v88, v88
v_exp_f32 v89, v89
v_exp_f32 v90, v90
v_exp_f32 v91, v91
s_nop 0
v_add_f32 v12, v12, v88
v_add_f32 v12, v12, v89
v_add_f32 v12, v12, v90
v_add_f32 v12, v12, v91
v_cvt_pk_bf16_f32 v146, v88, v89
v_cvt_pk_bf16_f32 v147, v90, v91
v_exp_f32 v92, v92
v_exp_f32 v93, v93
v_exp_f32 v94, v94
v_exp_f32 v95, v95
s_nop 0
v_add_f32 v13, v13, v92
v_add_f32 v13, v13, v93
v_add_f32 v13, v13, v94
v_add_f32 v13, v13, v95
v_cvt_pk_bf16_f32 v154, v92, v93
v_cvt_pk_bf16_f32 v155, v94, v95
v_exp_f32 v96, v96
v_exp_f32 v97, v97
v_exp_f32 v98, v98
v_exp_f32 v99, v99
s_nop 0
v_add_f32 v10, v10, v96
v_add_f32 v10, v10, v97
v_add_f32 v10, v10, v98
v_add_f32 v10, v10, v99
v_cvt_pk_bf16_f32 v132, v96, v97
v_cvt_pk_bf16_f32 v133, v98, v99
v_exp_f32 v100, v100
v_exp_f32 v101, v101
v_exp_f32 v102, v102
v_exp_f32 v103, v103
s_nop 0
v_add_f32 v11, v11, v100
v_add_f32 v11, v11, v101
v_add_f32 v11, v11, v102
v_add_f32 v11, v11, v103
v_cvt_pk_bf16_f32 v140, v100, v101
v_cvt_pk_bf16_f32 v141, v102, v103
v_exp_f32 v104, v104
v_exp_f32 v105, v105
v_exp_f32 v106, v106
v_exp_f32 v107, v107
s_nop 0
v_add_f32 v12, v12, v104
v_add_f32 v12, v12, v105
v_add_f32 v12, v12, v106
v_add_f32 v12, v12, v107
v_cvt_pk_bf16_f32 v148, v104, v105
v_cvt_pk_bf16_f32 v149, v106, v107
v_exp_f32 v108, v108
v_exp_f32 v109, v109
v_exp_f32 v110, v110
v_exp_f32 v111, v111
s_nop 0
v_add_f32 v13, v13, v108
v_add_f32 v13, v13, v109
v_add_f32 v13, v13, v110
v_add_f32 v13, v13, v111
v_cvt_pk_bf16_f32 v156, v108, v109
v_cvt_pk_bf16_f32 v157, v110, v111
v_exp_f32 v112, v112
v_exp_f32 v113, v113
v_exp_f32 v114, v114
v_exp_f32 v115, v115
s_nop 0
v_add_f32 v10, v10, v112
v_add_f32 v10, v10, v113
v_add_f32 v10, v10, v114
v_add_f32 v10, v10, v115
v_cvt_pk_bf16_f32 v134, v112, v113
v_cvt_pk_bf16_f32 v135, v114, v115
v_exp_f32 v116, v116
v_exp_f32 v117, v117
v_exp_f32 v118, v118
v_exp_f32 v119, v119
s_nop 0
v_add_f32 v11, v11, v116
v_add_f32 v11, v11, v117
v_add_f32 v11, v11, v118
v_add_f32 v11, v11, v119
v_cvt_pk_bf16_f32 v142, v116, v117
v_cvt_pk_bf16_f32 v143, v118, v119
v_exp_f32 v120, v120
v_exp_f32 v121, v121
v_exp_f32 v122, v122
v_exp_f32 v123, v123
s_nop 0
v_add_f32 v12, v12, v120
v_add_f32 v12, v12, v121
v_add_f32 v12, v12, v122
v_add_f32 v12, v12, v123
v_cvt_pk_bf16_f32 v150, v120, v121
v_cvt_pk_bf16_f32 v151, v122, v123
v_exp_f32 v124, v124
v_exp_f32 v125, v125
v_exp_f32 v126, v126
v_exp_f32 v127, v127
s_nop 0
v_add_f32 v13, v13, v124
v_add_f32 v13, v13, v125
v_add_f32 v13, v13, v126
v_add_f32 v13, v13, v127
v_cvt_pk_bf16_f32 v158, v124, v125
v_cvt_pk_bf16_f32 v159, v126, v127
s_waitcnt lgkmcnt(0)
s_nop 1
v_mfma_f32_16x16x32_bf16 a[0:3], v[192:195], v[128:131], a[0:3]
ds_read_b64_tr_b16 v[216:217], v6
v_mfma_f32_16x16x32_bf16 a[0:3], v[196:199], v[132:135], a[0:3]
v_mfma_f32_16x16x32_bf16 a[4:7], v[196:199], v[140:143], a[4:7]
ds_read_b64_tr_b16 v[218:219], v6 offset:6144
v_mfma_f32_16x16x32_bf16 a[4:7], v[192:195], v[136:139], a[4:7]
v_mfma_f32_16x16x32_bf16 a[8:11], v[192:195], v[144:147], a[8:11]
ds_read_b64_tr_b16 v[220:221], v6 offset:12288
v_mfma_f32_16x16x32_bf16 a[8:11], v[196:199], v[148:151], a[8:11]
v_mfma_f32_16x16x32_bf16 a[12:15], v[196:199], v[156:159], a[12:15]
ds_read_b64_tr_b16 v[222:223], v6 offset:18432
v_mfma_f32_16x16x32_bf16 a[12:15], v[192:195], v[152:155], a[12:15]
s_waitcnt lgkmcnt(4)
v_mfma_f32_16x16x32_bf16 a[16:19], v[200:203], v[128:131], a[16:19]
ds_read_b64_tr_b16 v[224:225], v3 offset:128
v_mfma_f32_16x16x32_bf16 a[16:19], v[204:207], v[132:135], a[16:19]
v_mfma_f32_16x16x32_bf16 a[20:23], v[204:207], v[140:143], a[20:23]
ds_read_b64_tr_b16 v[226:227], v3 offset:6272
v_mfma_f32_16x16x32_bf16 a[20:23], v[200:203], v[136:139], a[20:23]
v_mfma_f32_16x16x32_bf16 a[24:27], v[200:203], v[144:147], a[24:27]
ds_read_b64_tr_b16 v[228:229], v3 offset:12416
v_mfma_f32_16x16x32_bf16 a[24:27], v[204:207], v[148:151], a[24:27]
v_mfma_f32_16x16x32_bf16 a[28:31], v[204:207], v[156:159], a[28:31]
ds_read_b64_tr_b16 v[230:231], v3 offset:18560
v_mfma_f32_16x16x32_bf16 a[28:31], v[200:203], v[152:155], a[28:31]
s_waitcnt lgkmcnt(8)
v_mfma_f32_16x16x32_bf16 a[32:35], v[208:211], v[128:131], a[32:35]
ds_read_b64_tr_b16 v[232:233], v4 offset:128
v_mfma_f32_16x16x32_bf16 a[32:35], v[212:215], v[132:135], a[32:35]
v_mfma_f32_16x16x32_bf16 a[36:39], v[212:215], v[140:143], a[36:39]
ds_read_b64_tr_b16 v[234:235], v4 offset:6272
v_mfma_f32_16x16x32_bf16 a[36:39], v[208:211], v[136:139], a[36:39]
v_mfma_f32_16x16x32_bf16 a[40:43], v[208:211], v[144:147], a[40:43]
ds_read_b64_tr_b16 v[236:237], v4 offset:12416
v_mfma_f32_16x16x32_bf16 a[40:43], v[212:215], v[148:151], a[40:43]
v_mfma_f32_16x16x32_bf16 a[44:47], v[212:215], v[156:159], a[44:47]
ds_read_b64_tr_b16 v[238:239], v4 offset:18560
v_mfma_f32_16x16x32_bf16 a[44:47], v[208:211], v[152:155], a[44:47]
s_waitcnt lgkmcnt(8)
v_mfma_f32_16x16x32_bf16 a[48:51], v[216:219], v[128:131], a[48:51]
ds_read_b64_tr_b16 v[192:193], v5 offset:128
v_mfma_f32_16x16x32_bf16 a[48:51], v[220:223], v[132:135], a[48:51]
v_mfma_f32_16x16x32_bf16 a[52:55], v[220:223], v[140:143], a[52:55]
ds_read_b64_tr_b16 v[194:195], v5 offset:6272
v_mfma_f32_16x16x32_bf16 a[52:55], v[216:219], v[136:139], a[52:55]
v_mfma_f32_16x16x32_bf16 a[56:59], v[216:219], v[144:147], a[56:59]
ds_read_b64_tr_b16 v[196:197], v5 offset:12416
v_mfma_f32_16x16x32_bf16 a[56:59], v[220:223], v[148:151], a[56:59]
v_mfma_f32_16x16x32_bf16 a[60:63], v[220:223], v[156:159], a[60:63]
ds_read_b64_tr_b16 v[198:199], v5 offset:18560
v_mfma_f32_16x16x32_bf16 a[60:63], v[216:219], v[152:155], a[60:63]
s_waitcnt lgkmcnt(8)
v_mfma_f32_16x16x32_bf16 a[64:67], v[224:227], v[128:131], a[64:67]
ds_read_b64_tr_b16 v[200:201], v6 offset:128
v_mfma_f32_16x16x32_bf16 a[64:67], v[228:231], v[132:135], a[64:67]
v_mfma_f32_16x16x32_bf16 a[68:71], v[228:231], v[140:143], a[68:71]
ds_read_b64_tr_b16 v[202:203], v6 offset:6272
v_mfma_f32_16x16x32_bf16 a[68:71], v[224:227], v[136:139], a[68:71]
v_mfma_f32_16x16x32_bf16 a[72:75], v[224:227], v[144:147], a[72:75]
ds_read_b64_tr_b16 v[204:205], v6 offset:12416
v_mfma_f32_16x16x32_bf16 a[72:75], v[228:231], v[148:151], a[72:75]
v_mfma_f32_16x16x32_bf16 a[76:79], v[228:231], v[156:159], a[76:79]
ds_read_b64_tr_b16 v[206:207], v6 offset:18560
v_mfma_f32_16x16x32_bf16 a[76:79], v[224:227], v[152:155], a[76:79]
s_waitcnt lgkmcnt(8)
v_mfma_f32_16x16x32_bf16 a[80:83], v[232:235], v[128:131], a[80:83]
ds_read_b64_tr_b16 v[208:209], v3 offset:256
v_mfma_f32_16x16x32_bf16 a[80:83], v[236:239], v[132:135], a[80:83]
v_mfma_f32_16x16x32_bf16 a[84:87], v[236:239], v[140:143], a[84:87]
ds_read_b64_tr_b16 v[210:211], v3 offset:6400
v_mfma_f32_16x16x32_bf16 a[84:87], v[232:235], v[136:139], a[84:87]
v_mfma_f32_16x16x32_bf16 a[88:91], v[232:235], v[144:147], a[88:91]
ds_read_b64_tr_b16 v[212:213], v3 offset:12544
v_mfma_f32_16x16x32_bf16 a[88:91], v[236:239], v[148:151], a[88:91]
v_mfma_f32_16x16x32_bf16 a[92:95], v[236:239], v[156:159], a[92:95]
ds_read_b64_tr_b16 v[214:215], v3 offset:18688
v_mfma_f32_16x16x32_bf16 a[92:95], v[232:235], v[152:155], a[92:95]
s_waitcnt lgkmcnt(8)
v_mfma_f32_16x16x32_bf16 a[96:99], v[192:195], v[128:131], a[96:99]
ds_read_b64_tr_b16 v[216:217], v4 offset:256
v_mfma_f32_16x16x32_bf16 a[96:99], v[196:199], v[132:135], a[96:99]
v_mfma_f32_16x16x32_bf16 a[100:103], v[196:199], v[140:143], a[100:103]
ds_read_b64_tr_b16 v[218:219], v4 offset:6400
v_mfma_f32_16x16x32_bf16 a[100:103], v[192:195], v[136:139], a[100:103]
v_mfma_f32_16x16x32_bf16 a[104:107], v[192:195], v[144:147], a[104:107]
ds_read_b64_tr_b16 v[220:221], v4 offset:12544
v_mfma_f32_16x16x32_bf16 a[104:107], v[196:199], v[148:151], a[104:107]
v_mfma_f32_16x16x32_bf16 a[108:111], v[196:199], v[156:159], a[108:111]
ds_read_b64_tr_b16 v[222:223], v4 offset:18688
v_mfma_f32_16x16x32_bf16 a[108:111], v[192:195], v[152:155], a[108:111]
s_waitcnt lgkmcnt(8)
v_mfma_f32_16x16x32_bf16 a[112:115], v[200:203], v[128:131], a[112:115]
ds_read_b64_tr_b16 v[224:225], v5 offset:256
v_mfma_f32_16x16x32_bf16 a[112:115], v[204:207], v[132:135], a[112:115]
v_mfma_f32_16x16x32_bf16 a[116:119], v[204:207], v[140:143], a[116:119]
ds_read_b64_tr_b16 v[226:227], v5 offset:6400
v_mfma_f32_16x16x32_bf16 a[116:119], v[200:203], v[136:139], a[116:119]
v_mfma_f32_16x16x32_bf16 a[120:123], v[200:203], v[144:147], a[120:123]
ds_read_b64_tr_b16 v[228:229], v5 offset:12544
v_mfma_f32_16x16x32_bf16 a[120:123], v[204:207], v[148:151], a[120:123]
v_mfma_f32_16x16x32_bf16 a[124:127], v[204:207], v[156:159], a[124:127]
ds_read_b64_tr_b16 v[230:231], v5 offset:18688
v_mfma_f32_16x16x32_bf16 a[124:127], v[200:203], v[152:155], a[124:127]
s_waitcnt lgkmcnt(8)
v_mfma_f32_16x16x32_bf16 a[128:131], v[208:211], v[128:131], a[128:131]
ds_read_b64_tr_b16 v[232:233], v6 offset:256
v_mfma_f32_16x16x32_bf16 a[128:131], v[212:215], v[132:135], a[128:131]
v_mfma_f32_16x16x32_bf16 a[132:135], v[212:215], v[140:143], a[132:135]
ds_read_b64_tr_b16 v[234:235], v6 offset:6400
v_mfma_f32_16x16x32_bf16 a[132:135], v[208:211], v[136:139], a[132:135]
v_mfma_f32_16x16x32_bf16 a[136:139], v[208:211], v[144:147], a[136:139]
ds_read_b64_tr_b16 v[236:237], v6 offset:12544
v_mfma_f32_16x16x32_bf16 a[136:139], v[212:215], v[148:151], a[136:139]
v_mfma_f32_16x16x32_bf16 a[140:143], v[212:215], v[156:159], a[140:143]
ds_read_b64_tr_b16 v[238:239], v6 offset:18688
v_mfma_f32_16x16x32_bf16 a[140:143], v[208:211], v[152:155], a[140:143]
s_waitcnt lgkmcnt(8)
v_mfma_f32_16x16x32_bf16 a[144:147], v[216:219], v[128:131], a[144:147]
v_mfma_f32_16x16x32_bf16 a[144:147], v[220:223], v[132:135], a[144:147]
v_mfma_f32_16x16x32_bf16 a[148:151], v[220:223], v[140:143], a[148:151]
v_mfma_f32_16x16x32_bf16 a[148:151], v[216:219], v[136:139], a[148:151]
v_mfma_f32_16x16x32_bf16 a[152:155], v[216:219], v[144:147], a[152:155]
v_mfma_f32_16x16x32_bf16 a[152:155], v[220:223], v[148:151], a[152:155]
v_mfma_f32_16x16x32_bf16 a[156:159], v[220:223], v[156:159], a[156:159]
v_mfma_f32_16x16x32_bf16 a[156:159], v[216:219], v[152:155], a[156:159]
s_waitcnt lgkmcnt(4)
v_mfma_f32_16x16x32_bf16 a[160:163], v[224:227], v[128:131], a[160:163]
v_mfma_f32_16x16x32_bf16 a[160:163], v[228:231], v[132:135], a[160:163]
v_mfma_f32_16x16x32_bf16 a[164:167], v[228:231], v[140:143], a[164:167]
v_mfma_f32_16x16x32_bf16 a[164:167], v[224:227], v[136:139], a[164:167]
v_mfma_f32_16x16x32_bf16 a[168:171], v[224:227], v[144:147], a[168:171]
v_mfma_f32_16x16x32_bf16 a[168:171], v[228:231], v[148:151], a[168:171]
v_mfma_f32_16x16x32_bf16 a[172:175], v[228:231], v[156:159], a[172:175]
v_mfma_f32_16x16x32_bf16 a[172:175], v[224:227], v[152:155], a[172:175]
s_waitcnt lgkmcnt(0)
v_mfma_f32_16x16x32_bf16 a[176:179], v[232:235], v[128:131], a[176:179]
v_mfma_f32_16x16x32_bf16 a[176:179], v[236:239], v[132:135], a[176:179]
v_mfma_f32_16x16x32_bf16 a[180:183], v[236:239], v[140:143], a[180:183]
v_mfma_f32_16x16x32_bf16 a[180:183], v[232:235], v[136:139], a[180:183]
v_mfma_f32_16x16x32_bf16 a[184:187], v[232:235], v[144:147], a[184:187]
v_mfma_f32_16x16x32_bf16 a[184:187], v[236:239], v[148:151], a[184:187]
v_mfma_f32_16x16x32_bf16 a[188:191], v[236:239], v[156:159], a[188:191]
v_mfma_f32_16x16x32_bf16 a[188:191], v[232:235], v[152:155], a[188:191]
s_sub_u32 s63, s63, 1
s_cmp_lg_u32 s63, 0
s_cbranch_scc1 L_sloop
s_waitcnt lgkmcnt(0)
s_barrier
v_mov_b32 v16, v10
v_mov_b32 v17, v11
v_mov_b32 v18, v12
v_mov_b32 v19, v13
v_permlane32_swap_b32 v10, v16
v_permlane32_swap_b32 v11, v17
v_permlane32_swap_b32 v12, v18
v_permlane32_swap_b32 v13, v19
v_add_f32 v10, v10, v16
v_add_f32 v11, v11, v17
v_add_f32 v12, v12, v18
v_add_f32 v13, v13, v19
v_mov_b32 v16, v10
v_mov_b32 v17, v11
v_mov_b32 v18, v12
v_mov_b32 v19, v13
v_permlane16_swap_b32 v10, v16
v_permlane16_swap_b32 v11, v17
v_permlane16_swap_b32 v12, v18
v_permlane16_swap_b32 v13, v19
v_add_f32 v10, v10, v16
v_add_f32 v11, v11, v17
v_add_f32 v12, v12, v18
v_add_f32 v13, v13, v19
v_rcp_f32 v10, v10
v_rcp_f32 v11, v11
v_rcp_f32 v12, v12
v_rcp_f32 v13, v13
s_lshl_b32 s64, s3, 1
s_add_u32 s64, s64, s76
s_mul_i32 s65, s77, 40960
s_mul_i32 s66, s73, 320
s_add_u32 s65, s65, s66
s_mul_i32 s58, s64, 245760
s_add_u32 s58, s58, s65
s_mul_i32 s15, s64, 983040
s_add_u32 s15, s15, s65
s_mul_i32 s65, s13, 3840
s_add_u32 s65, s65, 4194304
s_mul_i32 s56, s64, 6144
s_add_u32 s56, s56, s65
s_add_u32 s56, s56, 196608
s_mul_i32 s75, s64, 24576
s_add_u32 s75, s75, s65
s_mul_i32 s61, s52, 10240
s_add_u32 s24, s3, 0
s_and_b32 s24, s24, 3
s_mul_i32 s24, s24, 245760
s_add_u32 s25, s3, 1
s_and_b32 s25, s25, 3
s_mul_i32 s25, s25, 245760
s_add_u32 s26, s3, 2
s_and_b32 s26, s26, 3
s_mul_i32 s26, s26, 245760
s_add_u32 s27, s3, 3
s_and_b32 s27, s27, 3
s_mul_i32 s27, s27, 245760
s_mul_i32 s64, s55, 245760
s_mul_i32 s65, s53, 6144
s_add_u32 s64, s64, s65
s_add_u32 s64, s64, 4194304
s_add_u32 s65, s64, 245760
s_add_u32 s66, s64, 491520
s_add_u32 s67, s64, 737280
v_lshlrev_b32 v15, 4, v0
v_add_u32 v14, 4096, v15
s_add_u32 s62, s61, 0
s_add_u32 s59, s58, 20480
s_add_u32 m0, s62, 0
s_nop 0
buffer_load_dwordx4 v240, s[48:51], s58 offen lds
buffer_load_dwordx4 v241, s[48:51], s58 offen offset:1024 lds
buffer_load_dwordx4 v242, s[48:51], s58 offen offset:2048 lds
buffer_load_dwordx4 v243, s[48:51], s58 offen offset:3072 lds
s_add_u32 m0, s62, 4096
s_nop 0
buffer_load_dwordx4 v244, s[48:51], s58 offen lds
s_add_u32 m0, s62, 5120
s_nop 0
buffer_load_dwordx4 v240, s[48:51], s59 offen lds
buffer_load_dwordx4 v241, s[48:51], s59 offen offset:1024 lds
buffer_load_dwordx4 v242, s[48:51], s59 offen offset:2048 lds
buffer_load_dwordx4 v243, s[48:51], s59 offen offset:3072 lds
s_add_u32 m0, s62, 9216
s_nop 0
buffer_load_dwordx4 v244, s[48:51], s59 offen lds
s_add_u32 s58, s58, 81920
s_add_u32 s62, s61, 40960
s_add_u32 s59, s58, 20480
s_add_u32 m0, s62, 0
s_nop 0
buffer_load_dwordx4 v240, s[48:51], s58 offen lds
buffer_load_dwordx4 v241, s[48:51], s58 offen offset:1024 lds
buffer_load_dwordx4 v242, s[48:51], s58 offen offset:2048 lds
buffer_load_dwordx4 v243, s[48:51], s58 offen offset:3072 lds
s_add_u32 m0, s62, 4096
s_nop 0
buffer_load_dwordx4 v244, s[48:51], s58 offen lds
s_add_u32 m0, s62, 5120
s_nop 0
buffer_load_dwordx4 v240, s[48:51], s59 offen lds
buffer_load_dwordx4 v241, s[48:51], s59 offen offset:1024 lds
buffer_load_dwordx4 v242, s[48:51], s59 offen offset:2048 lds
buffer_load_dwordx4 v243, s[48:51], s59 offen offset:3072 lds
s_add_u32 m0, s62, 9216
s_nop 0
buffer_load_dwordx4 v244, s[48:51], s59 offen lds
s_add_u32 s58, s58, 81920
buffer_load_dwordx4 v[16:19], v247, s[20:23], s56 offen sc1
buffer_load_dwordx4 v[20:23], v247, s[20:23], s56 offen offset:1024 sc1
buffer_load_dwordx4 v[24:27], v248, s[20:23], s56 offen sc1
buffer_load_dwordx4 v[28:31], v248, s[20:23], s56 offen offset:1024 sc1
buffer_load_dwordx4 v[32:35], v249, s[20:23], s56 offen sc1
buffer_load_dwordx4 v[36:39], v249, s[20:23], s56 offen offset:1024 sc1
buffer_load_dwordx4 v[40:43], v250, s[20:23], s56 offen sc1
buffer_load_dwordx4 v[44:47], v250, s[20:23], s56 offen offset:1024 sc1
s_add_u32 s56, s56, 2048
buffer_load_dwordx4 v[48:51], v247, s[20:23], s56 offen sc1
buffer_load_dwordx4 v[52:55], v247, s[20:23], s56 offen offset:1024 sc1
buffer_load_dwordx4 v[56:59], v248, s[20:23], s56 offen sc1
buffer_load_dwordx4 v[60:63], v248, s[20:23], s56 offen offset:1024 sc1
buffer_load_dwordx4 v[64:67], v249, s[20:23], s56 offen sc1
buffer_load_dwordx4 v[68:71], v249, s[20:23], s56 offen offset:1024 sc1
buffer_load_dwordx4 v[72:75], v250, s[20:23], s56 offen sc1
buffer_load_dwordx4 v[76:79], v250, s[20:23], s56 offen offset:1024 sc1
s_add_u32 s56, s56, 2048
s_add_u32 s62, s61, 81920
s_add_u32 s59, s58, 20480
s_add_u32 m0, s62, 0
s_nop 0
buffer_load_dwordx4 v240, s[48:51], s58 offen lds
buffer_load_dwordx4 v241, s[48:51], s58 offen offset:1024 lds
buffer_load_dwordx4 v242, s[48:51], s58 offen offset:2048 lds
buffer_load_dwordx4 v243, s[48:51], s58 offen offset:3072 lds
s_add_u32 m0, s62, 4096
s_nop 0
buffer_load_dwordx4 v244, s[48:51], s58 offen lds
s_add_u32 m0, s62, 5120
s_nop 0
buffer_load_dwordx4 v240, s[48:51], s59 offen lds
buffer_load_dwordx4 v241, s[48:51], s59 offen offset:1024 lds
buffer_load_dwordx4 v242, s[48:51], s59 offen offset:2048 lds
buffer_load_dwordx4 v243, s[48:51], s59 offen offset:3072 lds
s_add_u32 m0, s62, 9216
s_nop 0
buffer_load_dwordx4 v244, s[48:51], s59 offen lds
s_add_u32 s58, s58, 81920
v_accvgpr_read_b32 v144, a0
v_accvgpr_read_b32 v145, a1
v_accvgpr_read_b32 v146, a2
v_accvgpr_read_b32 v147, a3
v_accvgpr_read_b32 v148, a16
v_accvgpr_read_b32 v149, a17
v_accvgpr_read_b32 v150, a18
v_accvgpr_read_b32 v151, a19
v_mul_f32 v144, v144, v10
v_mul_f32 v145, v145, v10
v_mul_f32 v146, v146, v10
v_mul_f32 v147, v147, v10
v_mul_f32 v148, v148, v10
v_mul_f32 v149, v149, v10
v_mul_f32 v150, v150, v10
v_mul_f32 v151, v151, v10
v_cvt_pk_bf16_f32 v80, v144, v145
v_cvt_pk_bf16_f32 v81, v146, v147
v_cvt_pk_bf16_f32 v82, v148, v149
v_cvt_pk_bf16_f32 v83, v150, v151
buffer_store_dwordx4 v[80:83], v15, s[20:23], s64 offen sc1
v_accvgpr_read_b32 v152, a4
v_accvgpr_read_b32 v153, a5
v_accvgpr_read_b32 v154, a6
v_accvgpr_read_b32 v155, a7
v_accvgpr_read_b32 v156, a20
v_accvgpr_read_b32 v157, a21
v_accvgpr_read_b32 v158, a22
v_accvgpr_read_b32 v159, a23
v_mul_f32 v152, v152, v11
v_mul_f32 v153, v153, v11
v_mul_f32 v154, v154, v11
v_mul_f32 v155, v155, v11
v_mul_f32 v156, v156, v11
v_mul_f32 v157, v157, v11
v_mul_f32 v158, v158, v11
v_mul_f32 v159, v159, v11
v_cvt_pk_bf16_f32 v84, v152, v153
v_cvt_pk_bf16_f32 v85, v154, v155
v_cvt_pk_bf16_f32 v86, v156, v157
v_cvt_pk_bf16_f32 v87, v158, v159
buffer_store_dwordx4 v[84:87], v15, s[20:23], s65 offen sc1
v_accvgpr_read_b32 v144, a8
v_accvgpr_read_b32 v145, a9
v_accvgpr_read_b32 v146, a10
v_accvgpr_read_b32 v147, a11
v_accvgpr_read_b32 v148, a24
v_accvgpr_read_b32 v149, a25
v_accvgpr_read_b32 v150, a26
v_accvgpr_read_b32 v151, a27
v_mul_f32 v144, v144, v12
v_mul_f32 v145, v145, v12
v_mul_f32 v146, v146, v12
v_mul_f32 v147, v147, v12
v_mul_f32 v148, v148, v12
v_mul_f32 v149, v149, v12
v_mul_f32 v150, v150, v12
v_mul_f32 v151, v151, v12
v_cvt_pk_bf16_f32 v88, v144, v145
v_cvt_pk_bf16_f32 v89, v146, v147
v_cvt_pk_bf16_f32 v90, v148, v149
v_cvt_pk_bf16_f32 v91, v150, v151
buffer_store_dwordx4 v[88:91], v15, s[20:23], s66 offen sc1
v_accvgpr_read_b32 v152, a12
v_accvgpr_read_b32 v153, a13
v_accvgpr_read_b32 v154, a14
v_accvgpr_read_b32 v155, a15
v_accvgpr_read_b32 v156, a28
v_accvgpr_read_b32 v157, a29
v_accvgpr_read_b32 v158, a30
v_accvgpr_read_b32 v159, a31
v_mul_f32 v152, v152, v13
v_mul_f32 v153, v153, v13
v_mul_f32 v154, v154, v13
v_mul_f32 v155, v155, v13
v_mul_f32 v156, v156, v13
v_mul_f32 v157, v157, v13
v_mul_f32 v158, v158, v13
v_mul_f32 v159, v159, v13
v_cvt_pk_bf16_f32 v92, v152, v153
v_cvt_pk_bf16_f32 v93, v154, v155
v_cvt_pk_bf16_f32 v94, v156, v157
v_cvt_pk_bf16_f32 v95, v158, v159
buffer_store_dwordx4 v[92:95], v15, s[20:23], s67 offen sc1
v_accvgpr_read_b32 v144, a32
v_accvgpr_read_b32 v145, a33
v_accvgpr_read_b32 v146, a34
v_accvgpr_read_b32 v147, a35
v_accvgpr_read_b32 v148, a48
v_accvgpr_read_b32 v149, a49
v_accvgpr_read_b32 v150, a50
v_accvgpr_read_b32 v151, a51
v_mul_f32 v144, v144, v10
v_mul_f32 v145, v145, v10
v_mul_f32 v146, v146, v10
v_mul_f32 v147, v147, v10
v_mul_f32 v148, v148, v10
v_mul_f32 v149, v149, v10
v_mul_f32 v150, v150, v10
v_mul_f32 v151, v151, v10
v_cvt_pk_bf16_f32 v96, v144, v145
v_cvt_pk_bf16_f32 v97, v146, v147
v_cvt_pk_bf16_f32 v98, v148, v149
v_cvt_pk_bf16_f32 v99, v150, v151
buffer_store_dwordx4 v[96:99], v15, s[20:23], s64 offen offset:1024 sc1
v_accvgpr_read_b32 v152, a36
v_accvgpr_read_b32 v153, a37
v_accvgpr_read_b32 v154, a38
v_accvgpr_read_b32 v155, a39
v_accvgpr_read_b32 v156, a52
v_accvgpr_read_b32 v157, a53
v_accvgpr_read_b32 v158, a54
v_accvgpr_read_b32 v159, a55
v_mul_f32 v152, v152, v11
v_mul_f32 v153, v153, v11
v_mul_f32 v154, v154, v11
v_mul_f32 v155, v155, v11
v_mul_f32 v156, v156, v11
v_mul_f32 v157, v157, v11
v_mul_f32 v158, v158, v11
v_mul_f32 v159, v159, v11
v_cvt_pk_bf16_f32 v100, v152, v153
v_cvt_pk_bf16_f32 v101, v154, v155
v_cvt_pk_bf16_f32 v102, v156, v157
v_cvt_pk_bf16_f32 v103, v158, v159
buffer_store_dwordx4 v[100:103], v15, s[20:23], s65 offen offset:1024 sc1
v_accvgpr_read_b32 v144, a40
v_accvgpr_read_b32 v145, a41
v_accvgpr_read_b32 v146, a42
v_accvgpr_read_b32 v147, a43
v_accvgpr_read_b32 v148, a56
v_accvgpr_read_b32 v149, a57
v_accvgpr_read_b32 v150, a58
v_accvgpr_read_b32 v151, a59
v_mul_f32 v144, v144, v12
v_mul_f32 v145, v145, v12
v_mul_f32 v146, v146, v12
v_mul_f32 v147, v147, v12
v_mul_f32 v148, v148, v12
v_mul_f32 v149, v149, v12
v_mul_f32 v150, v150, v12
v_mul_f32 v151, v151, v12
v_cvt_pk_bf16_f32 v104, v144, v145
v_cvt_pk_bf16_f32 v105, v146, v147
v_cvt_pk_bf16_f32 v106, v148, v149
v_cvt_pk_bf16_f32 v107, v150, v151
buffer_store_dwordx4 v[104:107], v15, s[20:23], s66 offen offset:1024 sc1
v_accvgpr_read_b32 v152, a44
v_accvgpr_read_b32 v153, a45
v_accvgpr_read_b32 v154, a46
v_accvgpr_read_b32 v155, a47
v_accvgpr_read_b32 v156, a60
v_accvgpr_read_b32 v157, a61
v_accvgpr_read_b32 v158, a62
v_accvgpr_read_b32 v159, a63
v_mul_f32 v152, v152, v13
v_mul_f32 v153, v153, v13
v_mul_f32 v154, v154, v13
v_mul_f32 v155, v155, v13
v_mul_f32 v156, v156, v13
v_mul_f32 v157, v157, v13
v_mul_f32 v158, v158, v13
v_mul_f32 v159, v159, v13
v_cvt_pk_bf16_f32 v108, v152, v153
v_cvt_pk_bf16_f32 v109, v154, v155
v_cvt_pk_bf16_f32 v110, v156, v157
v_cvt_pk_bf16_f32 v111, v158, v159
buffer_store_dwordx4 v[108:111], v15, s[20:23], s67 offen offset:1024 sc1
v_accvgpr_read_b32 v144, a64
v_accvgpr_read_b32 v145, a65
v_accvgpr_read_b32 v146, a66
v_accvgpr_read_b32 v147, a67
v_accvgpr_read_b32 v148, a80
v_accvgpr_read_b32 v149, a81
v_accvgpr_read_b32 v150, a82
v_accvgpr_read_b32 v151, a83
v_mul_f32 v144, v144, v10
v_mul_f32 v145, v145, v10
v_mul_f32 v146, v146, v10
v_mul_f32 v147, v147, v10
v_mul_f32 v148, v148, v10
v_mul_f32 v149, v149, v10
v_mul_f32 v150, v150, v10
v_mul_f32 v151, v151, v10
v_cvt_pk_bf16_f32 v112, v144, v145
v_cvt_pk_bf16_f32 v113, v146, v147
v_cvt_pk_bf16_f32 v114, v148, v149
v_cvt_pk_bf16_f32 v115, v150, v151
buffer_store_dwordx4 v[112:115], v15, s[20:23], s64 offen offset:2048 sc1
v_accvgpr_read_b32 v152, a68
v_accvgpr_read_b32 v153, a69
v_accvgpr_read_b32 v154, a70
v_accvgpr_read_b32 v155, a71
v_accvgpr_read_b32 v156, a84
v_accvgpr_read_b32 v157, a85
v_accvgpr_read_b32 v158, a86
v_accvgpr_read_b32 v159, a87
v_mul_f32 v152, v152, v11
v_mul_f32 v153, v153, v11
v_mul_f32 v154, v154, v11
v_mul_f32 v155, v155, v11
v_mul_f32 v156, v156, v11
v_mul_f32 v157, v157, v11
v_mul_f32 v158, v158, v11
v_mul_f32 v159, v159, v11
v_cvt_pk_bf16_f32 v116, v152, v153
v_cvt_pk_bf16_f32 v117, v154, v155
v_cvt_pk_bf16_f32 v118, v156, v157
v_cvt_pk_bf16_f32 v119, v158, v159
buffer_store_dwordx4 v[116:119], v15, s[20:23], s65 offen offset:2048 sc1
v_accvgpr_read_b32 v144, a72
v_accvgpr_read_b32 v145, a73
v_accvgpr_read_b32 v146, a74
v_accvgpr_read_b32 v147, a75
v_accvgpr_read_b32 v148, a88
v_accvgpr_read_b32 v149, a89
v_accvgpr_read_b32 v150, a90
v_accvgpr_read_b32 v151, a91
v_mul_f32 v144, v144, v12
v_mul_f32 v145, v145, v12
v_mul_f32 v146, v146, v12
v_mul_f32 v147, v147, v12
v_mul_f32 v148, v148, v12
v_mul_f32 v149, v149, v12
v_mul_f32 v150, v150, v12
v_mul_f32 v151, v151, v12
v_cvt_pk_bf16_f32 v120, v144, v145
v_cvt_pk_bf16_f32 v121, v146, v147
v_cvt_pk_bf16_f32 v122, v148, v149
v_cvt_pk_bf16_f32 v123, v150, v151
v_accvgpr_read_b32 v152, a76
v_accvgpr_read_b32 v153, a77
v_accvgpr_read_b32 v154, a78
v_accvgpr_read_b32 v155, a79
v_accvgpr_read_b32 v156, a92
v_accvgpr_read_b32 v157, a93
v_accvgpr_read_b32 v158, a94
v_accvgpr_read_b32 v159, a95
v_mul_f32 v152, v152, v13
v_mul_f32 v153, v153, v13
v_mul_f32 v154, v154, v13
v_mul_f32 v155, v155, v13
v_mul_f32 v156, v156, v13
v_mul_f32 v157, v157, v13
v_mul_f32 v158, v158, v13
v_mul_f32 v159, v159, v13
v_cvt_pk_bf16_f32 v124, v152, v153
v_cvt_pk_bf16_f32 v125, v154, v155
v_cvt_pk_bf16_f32 v126, v156, v157
v_cvt_pk_bf16_f32 v127, v158, v159
s_waitcnt vmcnt(0)
s_branch L_join
s_endpgm
.fill 256, 4, 0xbf800000
.section .rodata,"a"
.p2align 6
.amdhsa_kernel recurrent_scan__gqa_block_cached__dense_activation_gelu__prompt_kernel
  .amdhsa_next_free_vgpr 512
  .amdhsa_next_free_sgpr 102
  .amdhsa_accum_offset 256
  .amdhsa_group_segment_fixed_size 0
  .amdhsa_kernarg_size 104
  .amdhsa_user_sgpr_count 2
  .amdhsa_user_sgpr_kernarg_segment_ptr 1
  .amdhsa_system_sgpr_workgroup_id_x 1
.end_amdhsa_kernel
```
